```python
import torch

def _softmax(x, axis=-1):
    return torch.softmax(x, dim=axis)
def _gelu(x):
    return torch.nn.functional.gelu(x, approximate="tanh")
def _silu(x):
    return torch.nn.functional.silu(x)
def _sigmoid(x):
    return torch.sigmoid(x)
def _layernorm(x, axis=-1, eps=1e-5):
    m = x.mean(dim=axis, keepdim=True)
    v = x.var(dim=axis, keepdim=True, unbiased=False)
    return (x - m) / torch.sqrt(v + eps)
def _scatter_add(tgt, idx, src, axis=0):
    return tgt.clone().index_add_(axis, idx, src)
def _segment_sum(src, seg, n):
    out = torch.zeros((n,) + src.shape[1:], dtype=src.dtype)
    return out.index_add_(0, seg, src)
def _pad(x, pw):
    flat = tuple(v for pair in reversed(pw) for v in pair)
    return torch.nn.functional.pad(x, flat)

kernel_name = 'recurrent_scan__compressed_kv_cla__moe_arch_mod__prompt'

def setup_inputs():

    _w = (lambda a: (lambda t: t.to(torch.bfloat16) if t.is_floating_point() else t)(torch.as_tensor(a)))
    def _A_setup():
        B, H, Sq, Sk, D, M = 1, 32, 2048, 2048, 128, 1024
        Dc = 4 * D
        return {
            "x": _w((lambda *s: torch.randn(*s, dtype=torch.bfloat16) * 0.05)(B, Sq, M)),
            "c_kv": _w((lambda *s: torch.randn(*s, dtype=torch.bfloat16) * 0.2)(B, Sk, Dc)),
            "w_q": _w((lambda *s: torch.randn(*s, dtype=torch.bfloat16) * 3.2)(M, H, D) * (M ** -0.5)),
            "w_uk": _w((lambda *s: torch.randn(*s, dtype=torch.bfloat16) * 3.2)(Dc, H, D) * (Dc ** -0.5)),
            "w_uv": _w((lambda *s: torch.randn(*s, dtype=torch.bfloat16) * 0.2)(Dc, H, D) * (Dc ** -0.5)),
            "w_o": _w((lambda *s: torch.randn(*s, dtype=torch.bfloat16) * 0.2)(H, D, M) * ((H * D) ** -0.5)),
        }
    _A_in = _A_setup()

    def _B_setup():
        B, S, D, F, C = 1, 2048, 1024, 3584, 2
        return {
            "x": _w((lambda *s: torch.randn(*s, dtype=torch.bfloat16) * 0.05)(B, S, D)),
            "w_r": _w((lambda *s: torch.randn(*s, dtype=torch.bfloat16) * 0.2)(D)),
            "w_gate": _w((lambda *s: torch.randn(*s, dtype=torch.bfloat16) * 0.1)(D, F)),
            "w_up": _w((lambda *s: torch.randn(*s, dtype=torch.bfloat16) * 0.1)(D, F)),
            "w_down": _w((lambda *s: torch.randn(*s, dtype=torch.bfloat16) * 0.1)(F, D)),
        }
    _B_in = _B_setup()

    return {
        "A_x": _A_in["x"],
        "A_c_kv": _A_in["c_kv"],
        "A_w_q": _A_in["w_q"],
        "A_w_uk": _A_in["w_uk"],
        "A_w_uv": _A_in["w_uv"],
        "A_w_o": _A_in["w_o"],
        "B_x": _B_in["x"],
        "B_w_r": _B_in["w_r"],
        "B_w_gate": _B_in["w_gate"],
        "B_w_up": _B_in["w_up"],
        "B_w_down": _B_in["w_down"],
    }

def reference(A_x, A_c_kv, A_w_q, A_w_uk, A_w_uv, A_w_o, B_x, B_w_r, B_w_gate, B_w_up, B_w_down):
    def _A_ref(x, c_kv, w_q, w_uk, w_uv, w_o):
        B, Sq, M = x.shape[0], x.shape[1], x.shape[2]
        Sk = c_kv.shape[1]
        H, D = w_q.shape[1], w_q.shape[2]
        q = torch.einsum("bqm,mhd->bhqd", x, w_q)
        k = torch.einsum("bkc,chd->bhkd", c_kv, w_uk)
        v = torch.einsum("bkc,chd->bhkd", c_kv, w_uv)
        scores = torch.einsum("bhqd,bhkd->bhqk", q, k) * (D ** -0.5)
        off = Sk - Sq
        qi = torch.arange(Sq)[:, None]
        kj = torch.arange(Sk)[None, :]
        cmask = kj <= (qi + off)
        scores = torch.where(cmask[None, None], scores, -1e9)
        p = _softmax(scores, axis=-1)
        ctx = torch.einsum("bhqk,bhkd->bhqd", p, v)
        return torch.einsum("bhqd,hdm->bqm", ctx, w_o)

    def _B_ref(x, w_r, w_gate, w_up, w_down):
        B, S, D = x.shape
        C = 2
        r = x @ w_r
        idx = torch.argsort(-r, axis=-1)[:, :C]
        idx_e = (lambda x, n, axis: torch.repeat_interleave(x, n, dim=axis))(idx.reshape(B, C, 1), D, axis=2)
        x_sel = (lambda x, i, axis: torch.take_along_dim(x, i, dim=axis))(x, idx_e, axis=1)
        g = _silu(x_sel @ w_gate)
        u = x_sel @ w_up
        y = (g * u) @ w_down
        r_sel = _sigmoid((lambda x, i, axis: torch.take_along_dim(x, i, dim=axis))(r, idx, axis=1))
        y = y * r_sel.reshape(B, C, 1)
        b_off = (torch.arange(B) * S).reshape(B, 1)
        flat_idx = (idx + b_off).reshape(B * C)
        zero = (x * 0.0).reshape(B * S, D)
        upd = _scatter_add(zero, flat_idx, y.reshape(B * C, D), axis=0)
        return x + upd.reshape(B, S, D)

    x = A_x
    xn = _layernorm(x, axis=-1)
    s = _A_ref(xn, A_c_kv, A_w_q, A_w_uk, A_w_uv, A_w_o)
    g = _silu(_B_ref(xn, B_w_r, B_w_gate, B_w_up, B_w_down))
    return x + s * g
```

```asm
; @launch kernel=kv_kernel grid=(256,1,1) block=(512,1,1) lds=131072
; @launch kernel=ffn1_kernel grid=(224,1,1) block=(512,1,1) lds=65536
; @launch kernel=ffn2_kernel grid=(256,1,1) block=(512,1,1) lds=65536
; @launch kernel=attn_kernel grid=(256,1,1) block=(512,1,1) lds=163840
; @launch kernel=oproj_kernel grid=(256,1,1) block=(512,1,1) lds=131072
.amdgcn_target "amdgcn-amd-amdhsa--gfx950"
.text
.globl kv_kernel
.p2align 8
.type kv_kernel,@function
kv_kernel:
    s_cmp_ge_u32 s2, 256
    s_cbranch_scc1 L_kv_end
    s_load_dwordx4 s[44:47], s[0:1], 0
    s_load_dwordx4 s[48:51], s[0:1], 24
    s_load_dwordx2 s[52:53], s[0:1], 56
    s_load_dwordx2 s[54:55], s[0:1], 104
    v_and_b32 v1, 63, v0
    v_lshrrev_b32 v16, 6, v0
    s_and_b32 s29, s2, 7
    v_readfirstlane_b32 s28, v16
    s_lshl_b32 s29, s29, 2
    s_bfe_u32 s36, s2, 0x20003
    s_add_u32 s29, s29, s36
    s_lshr_b32 s30, s2, 5
    s_lshl_b32 s42, s2, 3
    s_add_u32 s42, s42, s28
    v_lshrrev_b32 v16, 3, v1
    s_lshl_b32 s36, s30, 8
    s_lshl_b32 s37, s28, 5
    s_add_u32 s36, s36, s37
    v_add_u32 v16, s36, v16
    v_lshlrev_b32 v16, 10, v16
    v_lshrrev_b32 v18, 4, v1
    v_and_b32 v19, 7, v1
    v_xor_b32 v19, v19, v18
    v_lshl_add_u32 v2, v19, 4, v16
    v_xor_b32 v19, 4, v19
    v_lshl_add_u32 v3, v19, 4, v16
    v_add_u32 v3, 7168, v3
    v_add_u32 v4, 14336, v2
    v_add_u32 v5, 14336, v3
    s_and_b32 s36, s28, 3
    s_lshl_b32 s37, s36, 4
    v_add_u32 v16, s37, v18
    v_lshlrev_b32 v16, 13, v16
    s_lshl_b32 s37, s29, 8
    v_add_u32 v16, s37, v16
    v_and_b32 v19, 15, v1
    v_lshlrev_b32 v18, 1, v18
    v_xor_b32 v19, v19, v18
    v_lshl_add_u32 v6, v19, 4, v16
    v_add_u32 v7, 31744, v6
    v_xor_b32 v19, 8, v19
    v_lshl_add_u32 v8, v19, 4, v16
    v_add_u32 v8, 63488, v8
    v_add_u32 v9, 31744, v8
    s_lshl_b32 s33, s28, 12
    s_add_u32 s34, s33, 65536
    s_mov_b32 s31, 0
    s_mov_b32 s32, 0
    s_waitcnt lgkmcnt(0)
    s_mov_b32 s4, s46
    s_and_b32 s5, s47, 0xffff
    s_mov_b32 s6, 2097152
    s_mov_b32 s7, 0x20000
    s_cmp_lt_u32 s28, 4
    s_cselect_b32 s8, s48, s50
    s_cselect_b32 s9, s49, s51
    s_and_b32 s9, s9, 0xffff
    s_mov_b32 s10, 4194304
    s_mov_b32 s11, 0x20000
    s_add_u32 m0, s33, 0
    s_nop 0
    buffer_load_dwordx4 v2, s[4:7], s31 offen offset:0 lds
    buffer_load_dwordx4 v3, s[4:7], s31 offen offset:1024 lds
    buffer_load_dwordx4 v4, s[4:7], s31 offen offset:2048 lds
    buffer_load_dwordx4 v5, s[4:7], s31 offen offset:3072 lds
    s_add_u32 m0, s34, 0
    s_nop 0
    buffer_load_dwordx4 v6, s[8:11], s32 offen offset:0 lds
    buffer_load_dwordx4 v7, s[8:11], s32 offen offset:1024 lds
    buffer_load_dwordx4 v8, s[8:11], s32 offen offset:2048 lds
    buffer_load_dwordx4 v9, s[8:11], s32 offen offset:3072 lds
    s_add_u32 s31, s31, 128
    s_add_u32 s32, s32, 524288
    s_mov_b32 s16, s44
    s_and_b32 s17, s45, 0xffff
    s_mov_b32 s18, 4194304
    s_mov_b32 s19, 0x20000
    s_mov_b32 s20, s52
    s_and_b32 s21, s53, 0xffff
    s_mov_b32 s22, 2048
    s_mov_b32 s23, 0x20000
    s_add_u32 s12, s54, 8388608
    s_addc_u32 s13, s55, 0
    s_and_b32 s13, s13, 0xffff
    s_mov_b32 s14, 33554432
    s_mov_b32 s15, 0x20000
    s_mov_b32 s24, s54
    s_and_b32 s25, s55, 0xffff
    s_mov_b32 s26, 8388608
    s_mov_b32 s27, 0x20000
    v_and_b32 v16, 15, v1
    v_lshrrev_b32 v17, 4, v1
    s_bfe_u32 s36, s28, 0x10001
    s_lshl_b32 s36, s36, 14
    v_lshl_add_u32 v18, v16, 7, s36
    v_lshrrev_b32 v19, 1, v16
    v_xor_b32 v19, v19, v17
    v_lshl_add_u32 v10, v19, 4, v18
    v_xor_b32 v19, 4, v19
    v_lshl_add_u32 v11, v19, 4, v18
    v_lshrrev_b32 v16, 2, v16
    v_lshl_add_u32 v18, v17, 3, v16
    v_lshlrev_b32 v18, 8, v18
    s_lshr_b32 s36, s28, 2
    s_lshl_b32 s36, s36, 14
    s_add_u32 s36, s36, 65536
    v_add_u32 v18, s36, v18
    v_and_b32 v19, 3, v1
    v_lshl_add_u32 v18, v19, 3, v18
    v_and_b32 v17, 1, v17
    v_lshl_add_u32 v16, v17, 2, v16
    s_and_b32 s36, s28, 1
    s_lshl_b32 s36, s36, 2
    s_add_u32 s37, s36, 0
    v_xor_b32 v19, s37, v16
    v_lshl_add_u32 v12, v19, 5, v18
    s_add_u32 s37, s36, 1
    v_xor_b32 v19, s37, v16
    v_lshl_add_u32 v13, v19, 5, v18
    s_add_u32 s37, s36, 2
    v_xor_b32 v19, s37, v16
    v_lshl_add_u32 v14, v19, 5, v18
    s_add_u32 s37, s36, 3
    v_xor_b32 v19, s37, v16
    v_lshl_add_u32 v15, v19, 5, v18
    s_add_u32 m0, s33, 32768
    s_nop 0
    buffer_load_dwordx4 v2, s[4:7], s31 offen offset:0 lds
    buffer_load_dwordx4 v3, s[4:7], s31 offen offset:1024 lds
    buffer_load_dwordx4 v4, s[4:7], s31 offen offset:2048 lds
    buffer_load_dwordx4 v5, s[4:7], s31 offen offset:3072 lds
    s_add_u32 m0, s34, 32768
    s_nop 0
    buffer_load_dwordx4 v6, s[8:11], s32 offen offset:0 lds
    buffer_load_dwordx4 v7, s[8:11], s32 offen offset:1024 lds
    buffer_load_dwordx4 v8, s[8:11], s32 offen offset:2048 lds
    buffer_load_dwordx4 v9, s[8:11], s32 offen offset:3072 lds
    s_add_u32 s31, s31, 128
    s_add_u32 s32, s32, 524288
    v_mov_b32 v128, 0
    v_mov_b32 v129, 0
    v_mov_b32 v130, 0
    v_mov_b32 v131, 0
    v_mov_b32 v132, 0
    v_mov_b32 v133, 0
    v_mov_b32 v134, 0
    v_mov_b32 v135, 0
    v_mov_b32 v136, 0
    v_mov_b32 v137, 0
    v_mov_b32 v138, 0
    v_mov_b32 v139, 0
    v_mov_b32 v140, 0
    v_mov_b32 v141, 0
    v_mov_b32 v142, 0
    v_mov_b32 v143, 0
    v_mov_b32 v144, 0
    v_mov_b32 v145, 0
    v_mov_b32 v146, 0
    v_mov_b32 v147, 0
    v_mov_b32 v148, 0
    v_mov_b32 v149, 0
    v_mov_b32 v150, 0
    v_mov_b32 v151, 0
    v_mov_b32 v152, 0
    v_mov_b32 v153, 0
    v_mov_b32 v154, 0
    v_mov_b32 v155, 0
    v_mov_b32 v156, 0
    v_mov_b32 v157, 0
    v_mov_b32 v158, 0
    v_mov_b32 v159, 0
    v_mov_b32 v160, 0
    v_mov_b32 v161, 0
    v_mov_b32 v162, 0
    v_mov_b32 v163, 0
    v_mov_b32 v164, 0
    v_mov_b32 v165, 0
    v_mov_b32 v166, 0
    v_mov_b32 v167, 0
    v_mov_b32 v168, 0
    v_mov_b32 v169, 0
    v_mov_b32 v170, 0
    v_mov_b32 v171, 0
    v_mov_b32 v172, 0
    v_mov_b32 v173, 0
    v_mov_b32 v174, 0
    v_mov_b32 v175, 0
    v_mov_b32 v176, 0
    v_mov_b32 v177, 0
    v_mov_b32 v178, 0
    v_mov_b32 v179, 0
    v_mov_b32 v180, 0
    v_mov_b32 v181, 0
    v_mov_b32 v182, 0
    v_mov_b32 v183, 0
    v_mov_b32 v184, 0
    v_mov_b32 v185, 0
    v_mov_b32 v186, 0
    v_mov_b32 v187, 0
    v_mov_b32 v188, 0
    v_mov_b32 v189, 0
    v_mov_b32 v190, 0
    v_mov_b32 v191, 0
    v_mov_b32 v192, 0
    v_mov_b32 v193, 0
    v_mov_b32 v194, 0
    v_mov_b32 v195, 0
    v_mov_b32 v196, 0
    v_mov_b32 v197, 0
    v_mov_b32 v198, 0
    v_mov_b32 v199, 0
    v_mov_b32 v200, 0
    v_mov_b32 v201, 0
    v_mov_b32 v202, 0
    v_mov_b32 v203, 0
    v_mov_b32 v204, 0
    v_mov_b32 v205, 0
    v_mov_b32 v206, 0
    v_mov_b32 v207, 0
    v_mov_b32 v208, 0
    v_mov_b32 v209, 0
    v_mov_b32 v210, 0
    v_mov_b32 v211, 0
    v_mov_b32 v212, 0
    v_mov_b32 v213, 0
    v_mov_b32 v214, 0
    v_mov_b32 v215, 0
    v_mov_b32 v216, 0
    v_mov_b32 v217, 0
    v_mov_b32 v218, 0
    v_mov_b32 v219, 0
    v_mov_b32 v220, 0
    v_mov_b32 v221, 0
    v_mov_b32 v222, 0
    v_mov_b32 v223, 0
    v_mov_b32 v224, 0
    v_mov_b32 v225, 0
    v_mov_b32 v226, 0
    v_mov_b32 v227, 0
    v_mov_b32 v228, 0
    v_mov_b32 v229, 0
    v_mov_b32 v230, 0
    v_mov_b32 v231, 0
    v_mov_b32 v232, 0
    v_mov_b32 v233, 0
    v_mov_b32 v234, 0
    v_mov_b32 v235, 0
    v_mov_b32 v236, 0
    v_mov_b32 v237, 0
    v_mov_b32 v238, 0
    v_mov_b32 v239, 0
    v_mov_b32 v240, 0
    v_mov_b32 v241, 0
    v_mov_b32 v242, 0
    v_mov_b32 v243, 0
    v_mov_b32 v244, 0
    v_mov_b32 v245, 0
    v_mov_b32 v246, 0
    v_mov_b32 v247, 0
    v_mov_b32 v248, 0
    v_mov_b32 v249, 0
    v_mov_b32 v250, 0
    v_mov_b32 v251, 0
    v_mov_b32 v252, 0
    v_mov_b32 v253, 0
    v_mov_b32 v254, 0
    v_mov_b32 v255, 0
    s_waitcnt vmcnt(8)
    s_barrier
    ds_read_b128 v[20:23], v10 offset:0
    ds_read_b64_tr_b16 v[52:53], v12 offset:0
    ds_read_b64_tr_b16 v[54:55], v12 offset:1024
    ds_read_b64_tr_b16 v[56:57], v13 offset:0
    ds_read_b64_tr_b16 v[58:59], v13 offset:1024
    ds_read_b64_tr_b16 v[60:61], v14 offset:0
    ds_read_b64_tr_b16 v[62:63], v14 offset:1024
    ds_read_b64_tr_b16 v[64:65], v15 offset:0
    ds_read_b64_tr_b16 v[66:67], v15 offset:1024
    ds_read_b128 v[24:27], v10 offset:2048
    ds_read_b128 v[28:31], v10 offset:4096
    ds_read_b128 v[32:35], v10 offset:6144
    ds_read_b128 v[36:39], v10 offset:8192
    ds_read_b128 v[40:43], v10 offset:10240
    ds_read_b128 v[44:47], v10 offset:12288
    ds_read_b128 v[48:51], v10 offset:14336
    s_mov_b32 s35, 0
    s_cmp_lt_u32 s28, 4
    s_cbranch_scc0 L_kv_vloop
    .p2align 6
L_kv_kloop:
    s_cmp_lt_u32 s35, 3
    s_cselect_b32 s6, 2097152, 0
    s_cselect_b32 s10, 4194304, 0
    s_waitcnt lgkmcnt(0)
    v_mfma_f32_16x16x32_bf16 v[128:131], v[52:55], v[20:23], v[128:131]
    ds_read_b128 v[68:71], v11 offset:0
    v_mfma_f32_16x16x32_bf16 v[132:135], v[56:59], v[20:23], v[132:135]
    ds_read_b64_tr_b16 v[100:101], v12 offset:8192
    v_mfma_f32_16x16x32_bf16 v[136:139], v[60:63], v[20:23], v[136:139]
    ds_read_b64_tr_b16 v[102:103], v12 offset:9216
    v_mfma_f32_16x16x32_bf16 v[140:143], v[64:67], v[20:23], v[140:143]
    ds_read_b64_tr_b16 v[104:105], v13 offset:8192
    v_mfma_f32_16x16x32_bf16 v[144:147], v[52:55], v[24:27], v[144:147]
    ds_read_b64_tr_b16 v[106:107], v13 offset:9216
    v_mfma_f32_16x16x32_bf16 v[148:151], v[56:59], v[24:27], v[148:151]
    ds_read_b64_tr_b16 v[108:109], v14 offset:8192
    v_mfma_f32_16x16x32_bf16 v[152:155], v[60:63], v[24:27], v[152:155]
    ds_read_b64_tr_b16 v[110:111], v14 offset:9216
    v_mfma_f32_16x16x32_bf16 v[156:159], v[64:67], v[24:27], v[156:159]
    ds_read_b64_tr_b16 v[112:113], v15 offset:8192
    v_mfma_f32_16x16x32_bf16 v[160:163], v[52:55], v[28:31], v[160:163]
    ds_read_b64_tr_b16 v[114:115], v15 offset:9216
    v_mfma_f32_16x16x32_bf16 v[164:167], v[56:59], v[28:31], v[164:167]
    ds_read_b128 v[72:75], v11 offset:2048
    v_mfma_f32_16x16x32_bf16 v[168:171], v[60:63], v[28:31], v[168:171]
    ds_read_b128 v[76:79], v11 offset:4096
    v_mfma_f32_16x16x32_bf16 v[172:175], v[64:67], v[28:31], v[172:175]
    ds_read_b128 v[80:83], v11 offset:6144
    v_mfma_f32_16x16x32_bf16 v[176:179], v[52:55], v[32:35], v[176:179]
    ds_read_b128 v[84:87], v11 offset:8192
    v_mfma_f32_16x16x32_bf16 v[180:183], v[56:59], v[32:35], v[180:183]
    ds_read_b128 v[88:91], v11 offset:10240
    v_mfma_f32_16x16x32_bf16 v[184:187], v[60:63], v[32:35], v[184:187]
    ds_read_b128 v[92:95], v11 offset:12288
    v_mfma_f32_16x16x32_bf16 v[188:191], v[64:67], v[32:35], v[188:191]
    ds_read_b128 v[96:99], v11 offset:14336
    v_mfma_f32_16x16x32_bf16 v[192:195], v[52:55], v[36:39], v[192:195]
    v_mfma_f32_16x16x32_bf16 v[196:199], v[56:59], v[36:39], v[196:199]
    v_mfma_f32_16x16x32_bf16 v[200:203], v[60:63], v[36:39], v[200:203]
    v_mfma_f32_16x16x32_bf16 v[204:207], v[64:67], v[36:39], v[204:207]
    v_mfma_f32_16x16x32_bf16 v[208:211], v[52:55], v[40:43], v[208:211]
    v_mfma_f32_16x16x32_bf16 v[212:215], v[56:59], v[40:43], v[212:215]
    v_mfma_f32_16x16x32_bf16 v[216:219], v[60:63], v[40:43], v[216:219]
    v_mfma_f32_16x16x32_bf16 v[220:223], v[64:67], v[40:43], v[220:223]
    v_mfma_f32_16x16x32_bf16 v[224:227], v[52:55], v[44:47], v[224:227]
    v_mfma_f32_16x16x32_bf16 v[228:231], v[56:59], v[44:47], v[228:231]
    v_mfma_f32_16x16x32_bf16 v[232:235], v[60:63], v[44:47], v[232:235]
    v_mfma_f32_16x16x32_bf16 v[236:239], v[64:67], v[44:47], v[236:239]
    v_mfma_f32_16x16x32_bf16 v[240:243], v[52:55], v[48:51], v[240:243]
    v_mfma_f32_16x16x32_bf16 v[244:247], v[56:59], v[48:51], v[244:247]
    v_mfma_f32_16x16x32_bf16 v[248:251], v[60:63], v[48:51], v[248:251]
    v_mfma_f32_16x16x32_bf16 v[252:255], v[64:67], v[48:51], v[252:255]
    s_waitcnt vmcnt(0) lgkmcnt(0)
    s_barrier
    v_mfma_f32_16x16x32_bf16 v[128:131], v[100:103], v[68:71], v[128:131]
    ds_read_b128 v[20:23], v10 offset:32768
    s_add_u32 m0, s33, 0
    v_mfma_f32_16x16x32_bf16 v[132:135], v[104:107], v[68:71], v[132:135]
    ds_read_b64_tr_b16 v[52:53], v12 offset:32768
    buffer_load_dwordx4 v2, s[4:7], s31 offen offset:0 lds
    v_mfma_f32_16x16x32_bf16 v[136:139], v[108:111], v[68:71], v[136:139]
    ds_read_b64_tr_b16 v[54:55], v12 offset:33792
    v_mfma_f32_16x16x32_bf16 v[140:143], v[112:115], v[68:71], v[140:143]
    ds_read_b64_tr_b16 v[56:57], v13 offset:32768
    v_mfma_f32_16x16x32_bf16 v[144:147], v[100:103], v[72:75], v[144:147]
    ds_read_b64_tr_b16 v[58:59], v13 offset:33792
    buffer_load_dwordx4 v3, s[4:7], s31 offen offset:1024 lds
    v_mfma_f32_16x16x32_bf16 v[148:151], v[104:107], v[72:75], v[148:151]
    ds_read_b64_tr_b16 v[60:61], v14 offset:32768
    v_mfma_f32_16x16x32_bf16 v[152:155], v[108:111], v[72:75], v[152:155]
    ds_read_b64_tr_b16 v[62:63], v14 offset:33792
    v_mfma_f32_16x16x32_bf16 v[156:159], v[112:115], v[72:75], v[156:159]
    ds_read_b64_tr_b16 v[64:65], v15 offset:32768
    buffer_load_dwordx4 v4, s[4:7], s31 offen offset:2048 lds
    v_mfma_f32_16x16x32_bf16 v[160:163], v[100:103], v[76:79], v[160:163]
    ds_read_b64_tr_b16 v[66:67], v15 offset:33792
    v_mfma_f32_16x16x32_bf16 v[164:167], v[104:107], v[76:79], v[164:167]
    ds_read_b128 v[24:27], v10 offset:34816
    v_mfma_f32_16x16x32_bf16 v[168:171], v[108:111], v[76:79], v[168:171]
    ds_read_b128 v[28:31], v10 offset:36864
    buffer_load_dwordx4 v5, s[4:7], s31 offen offset:3072 lds
    v_mfma_f32_16x16x32_bf16 v[172:175], v[112:115], v[76:79], v[172:175]
    ds_read_b128 v[32:35], v10 offset:38912
    v_mfma_f32_16x16x32_bf16 v[176:179], v[100:103], v[80:83], v[176:179]
    ds_read_b128 v[36:39], v10 offset:40960
    s_add_u32 m0, s34, 0
    v_mfma_f32_16x16x32_bf16 v[180:183], v[104:107], v[80:83], v[180:183]
    ds_read_b128 v[40:43], v10 offset:43008
    buffer_load_dwordx4 v6, s[8:11], s32 offen offset:0 lds
    v_mfma_f32_16x16x32_bf16 v[184:187], v[108:111], v[80:83], v[184:187]
    ds_read_b128 v[44:47], v10 offset:45056
    v_mfma_f32_16x16x32_bf16 v[188:191], v[112:115], v[80:83], v[188:191]
    ds_read_b128 v[48:51], v10 offset:47104
    v_mfma_f32_16x16x32_bf16 v[192:195], v[100:103], v[84:87], v[192:195]
    buffer_load_dwordx4 v7, s[8:11], s32 offen offset:1024 lds
    v_mfma_f32_16x16x32_bf16 v[196:199], v[104:107], v[84:87], v[196:199]
    v_mfma_f32_16x16x32_bf16 v[200:203], v[108:111], v[84:87], v[200:203]
    v_mfma_f32_16x16x32_bf16 v[204:207], v[112:115], v[84:87], v[204:207]
    buffer_load_dwordx4 v8, s[8:11], s32 offen offset:2048 lds
    v_mfma_f32_16x16x32_bf16 v[208:211], v[100:103], v[88:91], v[208:211]
    v_mfma_f32_16x16x32_bf16 v[212:215], v[104:107], v[88:91], v[212:215]
    v_mfma_f32_16x16x32_bf16 v[216:219], v[108:111], v[88:91], v[216:219]
    buffer_load_dwordx4 v9, s[8:11], s32 offen offset:3072 lds
    v_mfma_f32_16x16x32_bf16 v[220:223], v[112:115], v[88:91], v[220:223]
    v_mfma_f32_16x16x32_bf16 v[224:227], v[100:103], v[92:95], v[224:227]
    v_mfma_f32_16x16x32_bf16 v[228:231], v[104:107], v[92:95], v[228:231]
    v_mfma_f32_16x16x32_bf16 v[232:235], v[108:111], v[92:95], v[232:235]
    v_mfma_f32_16x16x32_bf16 v[236:239], v[112:115], v[92:95], v[236:239]
    v_mfma_f32_16x16x32_bf16 v[240:243], v[100:103], v[96:99], v[240:243]
    v_mfma_f32_16x16x32_bf16 v[244:247], v[104:107], v[96:99], v[244:247]
    v_mfma_f32_16x16x32_bf16 v[248:251], v[108:111], v[96:99], v[248:251]
    v_mfma_f32_16x16x32_bf16 v[252:255], v[112:115], v[96:99], v[252:255]
    s_add_u32 s31, s31, 128
    s_add_u32 s32, s32, 524288
    s_waitcnt lgkmcnt(0)
    v_mfma_f32_16x16x32_bf16 v[128:131], v[52:55], v[20:23], v[128:131]
    ds_read_b128 v[68:71], v11 offset:32768
    v_mfma_f32_16x16x32_bf16 v[132:135], v[56:59], v[20:23], v[132:135]
    ds_read_b64_tr_b16 v[100:101], v12 offset:40960
    v_mfma_f32_16x16x32_bf16 v[136:139], v[60:63], v[20:23], v[136:139]
    ds_read_b64_tr_b16 v[102:103], v12 offset:41984
    v_mfma_f32_16x16x32_bf16 v[140:143], v[64:67], v[20:23], v[140:143]
    ds_read_b64_tr_b16 v[104:105], v13 offset:40960
    v_mfma_f32_16x16x32_bf16 v[144:147], v[52:55], v[24:27], v[144:147]
    ds_read_b64_tr_b16 v[106:107], v13 offset:41984
    v_mfma_f32_16x16x32_bf16 v[148:151], v[56:59], v[24:27], v[148:151]
    ds_read_b64_tr_b16 v[108:109], v14 offset:40960
    v_mfma_f32_16x16x32_bf16 v[152:155], v[60:63], v[24:27], v[152:155]
    ds_read_b64_tr_b16 v[110:111], v14 offset:41984
    v_mfma_f32_16x16x32_bf16 v[156:159], v[64:67], v[24:27], v[156:159]
    ds_read_b64_tr_b16 v[112:113], v15 offset:40960
    v_mfma_f32_16x16x32_bf16 v[160:163], v[52:55], v[28:31], v[160:163]
    ds_read_b64_tr_b16 v[114:115], v15 offset:41984
    v_mfma_f32_16x16x32_bf16 v[164:167], v[56:59], v[28:31], v[164:167]
    ds_read_b128 v[72:75], v11 offset:34816
    v_mfma_f32_16x16x32_bf16 v[168:171], v[60:63], v[28:31], v[168:171]
    ds_read_b128 v[76:79], v11 offset:36864
    v_mfma_f32_16x16x32_bf16 v[172:175], v[64:67], v[28:31], v[172:175]
    ds_read_b128 v[80:83], v11 offset:38912
    v_mfma_f32_16x16x32_bf16 v[176:179], v[52:55], v[32:35], v[176:179]
    ds_read_b128 v[84:87], v11 offset:40960
    v_mfma_f32_16x16x32_bf16 v[180:183], v[56:59], v[32:35], v[180:183]
    ds_read_b128 v[88:91], v11 offset:43008
    v_mfma_f32_16x16x32_bf16 v[184:187], v[60:63], v[32:35], v[184:187]
    ds_read_b128 v[92:95], v11 offset:45056
    v_mfma_f32_16x16x32_bf16 v[188:191], v[64:67], v[32:35], v[188:191]
    ds_read_b128 v[96:99], v11 offset:47104
    v_mfma_f32_16x16x32_bf16 v[192:195], v[52:55], v[36:39], v[192:195]
    v_mfma_f32_16x16x32_bf16 v[196:199], v[56:59], v[36:39], v[196:199]
    v_mfma_f32_16x16x32_bf16 v[200:203], v[60:63], v[36:39], v[200:203]
    v_mfma_f32_16x16x32_bf16 v[204:207], v[64:67], v[36:39], v[204:207]
    v_mfma_f32_16x16x32_bf16 v[208:211], v[52:55], v[40:43], v[208:211]
    v_mfma_f32_16x16x32_bf16 v[212:215], v[56:59], v[40:43], v[212:215]
    v_mfma_f32_16x16x32_bf16 v[216:219], v[60:63], v[40:43], v[216:219]
    v_mfma_f32_16x16x32_bf16 v[220:223], v[64:67], v[40:43], v[220:223]
    v_mfma_f32_16x16x32_bf16 v[224:227], v[52:55], v[44:47], v[224:227]
    v_mfma_f32_16x16x32_bf16 v[228:231], v[56:59], v[44:47], v[228:231]
    v_mfma_f32_16x16x32_bf16 v[232:235], v[60:63], v[44:47], v[232:235]
    v_mfma_f32_16x16x32_bf16 v[236:239], v[64:67], v[44:47], v[236:239]
    v_mfma_f32_16x16x32_bf16 v[240:243], v[52:55], v[48:51], v[240:243]
    v_mfma_f32_16x16x32_bf16 v[244:247], v[56:59], v[48:51], v[244:247]
    v_mfma_f32_16x16x32_bf16 v[248:251], v[60:63], v[48:51], v[248:251]
    v_mfma_f32_16x16x32_bf16 v[252:255], v[64:67], v[48:51], v[252:255]
    s_waitcnt vmcnt(0) lgkmcnt(0)
    s_barrier
    v_mfma_f32_16x16x32_bf16 v[128:131], v[100:103], v[68:71], v[128:131]
    ds_read_b128 v[20:23], v10 offset:0
    s_add_u32 m0, s33, 32768
    v_mfma_f32_16x16x32_bf16 v[132:135], v[104:107], v[68:71], v[132:135]
    ds_read_b64_tr_b16 v[52:53], v12 offset:0
    buffer_load_dwordx4 v2, s[4:7], s31 offen offset:0 lds
    v_mfma_f32_16x16x32_bf16 v[136:139], v[108:111], v[68:71], v[136:139]
    ds_read_b64_tr_b16 v[54:55], v12 offset:1024
    v_mfma_f32_16x16x32_bf16 v[140:143], v[112:115], v[68:71], v[140:143]
    ds_read_b64_tr_b16 v[56:57], v13 offset:0
    v_mfma_f32_16x16x32_bf16 v[144:147], v[100:103], v[72:75], v[144:147]
    ds_read_b64_tr_b16 v[58:59], v13 offset:1024
    buffer_load_dwordx4 v3, s[4:7], s31 offen offset:1024 lds
    v_mfma_f32_16x16x32_bf16 v[148:151], v[104:107], v[72:75], v[148:151]
    ds_read_b64_tr_b16 v[60:61], v14 offset:0
    v_mfma_f32_16x16x32_bf16 v[152:155], v[108:111], v[72:75], v[152:155]
    ds_read_b64_tr_b16 v[62:63], v14 offset:1024
    v_mfma_f32_16x16x32_bf16 v[156:159], v[112:115], v[72:75], v[156:159]
    ds_read_b64_tr_b16 v[64:65], v15 offset:0
    buffer_load_dwordx4 v4, s[4:7], s31 offen offset:2048 lds
    v_mfma_f32_16x16x32_bf16 v[160:163], v[100:103], v[76:79], v[160:163]
    ds_read_b64_tr_b16 v[66:67], v15 offset:1024
    v_mfma_f32_16x16x32_bf16 v[164:167], v[104:107], v[76:79], v[164:167]
    ds_read_b128 v[24:27], v10 offset:2048
    v_mfma_f32_16x16x32_bf16 v[168:171], v[108:111], v[76:79], v[168:171]
    ds_read_b128 v[28:31], v10 offset:4096
    buffer_load_dwordx4 v5, s[4:7], s31 offen offset:3072 lds
    v_mfma_f32_16x16x32_bf16 v[172:175], v[112:115], v[76:79], v[172:175]
    ds_read_b128 v[32:35], v10 offset:6144
    v_mfma_f32_16x16x32_bf16 v[176:179], v[100:103], v[80:83], v[176:179]
    ds_read_b128 v[36:39], v10 offset:8192
    s_add_u32 m0, s34, 32768
    v_mfma_f32_16x16x32_bf16 v[180:183], v[104:107], v[80:83], v[180:183]
    ds_read_b128 v[40:43], v10 offset:10240
    buffer_load_dwordx4 v6, s[8:11], s32 offen offset:0 lds
    v_mfma_f32_16x16x32_bf16 v[184:187], v[108:111], v[80:83], v[184:187]
    ds_read_b128 v[44:47], v10 offset:12288
    v_mfma_f32_16x16x32_bf16 v[188:191], v[112:115], v[80:83], v[188:191]
    ds_read_b128 v[48:51], v10 offset:14336
    v_mfma_f32_16x16x32_bf16 v[192:195], v[100:103], v[84:87], v[192:195]
    buffer_load_dwordx4 v7, s[8:11], s32 offen offset:1024 lds
    v_mfma_f32_16x16x32_bf16 v[196:199], v[104:107], v[84:87], v[196:199]
    v_mfma_f32_16x16x32_bf16 v[200:203], v[108:111], v[84:87], v[200:203]
    v_mfma_f32_16x16x32_bf16 v[204:207], v[112:115], v[84:87], v[204:207]
    buffer_load_dwordx4 v8, s[8:11], s32 offen offset:2048 lds
    v_mfma_f32_16x16x32_bf16 v[208:211], v[100:103], v[88:91], v[208:211]
    v_mfma_f32_16x16x32_bf16 v[212:215], v[104:107], v[88:91], v[212:215]
    v_mfma_f32_16x16x32_bf16 v[216:219], v[108:111], v[88:91], v[216:219]
    buffer_load_dwordx4 v9, s[8:11], s32 offen offset:3072 lds
    v_mfma_f32_16x16x32_bf16 v[220:223], v[112:115], v[88:91], v[220:223]
    v_mfma_f32_16x16x32_bf16 v[224:227], v[100:103], v[92:95], v[224:227]
    v_mfma_f32_16x16x32_bf16 v[228:231], v[104:107], v[92:95], v[228:231]
    v_mfma_f32_16x16x32_bf16 v[232:235], v[108:111], v[92:95], v[232:235]
    v_mfma_f32_16x16x32_bf16 v[236:239], v[112:115], v[92:95], v[236:239]
    v_mfma_f32_16x16x32_bf16 v[240:243], v[100:103], v[96:99], v[240:243]
    v_mfma_f32_16x16x32_bf16 v[244:247], v[104:107], v[96:99], v[244:247]
    v_mfma_f32_16x16x32_bf16 v[248:251], v[108:111], v[96:99], v[248:251]
    v_mfma_f32_16x16x32_bf16 v[252:255], v[112:115], v[96:99], v[252:255]
    s_add_u32 s31, s31, 128
    s_add_u32 s32, s32, 524288
    s_add_u32 s35, s35, 1
    s_cmp_lt_u32 s35, 4
    s_cbranch_scc1 L_kv_kloop
    s_waitcnt lgkmcnt(0)
    v_lshlrev_b32 v17, 4, v1
    s_lshl_b32 s36, s42, 11
    v_add_u32 v18, s36, v17
    buffer_load_dwordx4 v[20:23], v18, s[16:19], 0 offen
    buffer_load_dwordx4 v[24:27], v18, s[16:19], 0 offen offset:1024
    buffer_load_dwordx4 v[28:31], v17, s[20:23], 0 offen
    buffer_load_dwordx4 v[32:35], v17, s[20:23], 0 offen offset:1024
    s_lshl_b32 s36, s29, 20
    s_lshl_b32 s37, s30, 17
    s_add_u32 s36, s36, s37
    s_bfe_u32 s37, s28, 0x10001
    s_lshl_b32 s37, s37, 16
    s_add_u32 s36, s36, s37
    s_and_b32 s37, s28, 1
    s_lshl_b32 s37, s37, 11
    s_add_u32 s36, s36, s37
    v_cvt_pk_bf16_f32 v128, v128, v129
    v_cvt_pk_bf16_f32 v129, v130, v131
    v_cvt_pk_bf16_f32 v130, v132, v133
    v_cvt_pk_bf16_f32 v131, v134, v135
    buffer_store_dwordx4 v[128:131], v17, s[12:15], s36 offen offset:0
    v_cvt_pk_bf16_f32 v136, v136, v137
    v_cvt_pk_bf16_f32 v137, v138, v139
    v_cvt_pk_bf16_f32 v138, v140, v141
    v_cvt_pk_bf16_f32 v139, v142, v143
    buffer_store_dwordx4 v[136:139], v17, s[12:15], s36 offen offset:1024
    s_add_u32 s36, s36, 4096
    v_cvt_pk_bf16_f32 v144, v144, v145
    v_cvt_pk_bf16_f32 v145, v146, v147
    v_cvt_pk_bf16_f32 v146, v148, v149
    v_cvt_pk_bf16_f32 v147, v150, v151
    buffer_store_dwordx4 v[144:147], v17, s[12:15], s36 offen offset:0
    v_cvt_pk_bf16_f32 v152, v152, v153
    v_cvt_pk_bf16_f32 v153, v154, v155
    v_cvt_pk_bf16_f32 v154, v156, v157
    v_cvt_pk_bf16_f32 v155, v158, v159
    buffer_store_dwordx4 v[152:155], v17, s[12:15], s36 offen offset:1024
    s_add_u32 s36, s36, 4096
    v_cvt_pk_bf16_f32 v160, v160, v161
    v_cvt_pk_bf16_f32 v161, v162, v163
    v_cvt_pk_bf16_f32 v162, v164, v165
    v_cvt_pk_bf16_f32 v163, v166, v167
    buffer_store_dwordx4 v[160:163], v17, s[12:15], s36 offen offset:0
    v_cvt_pk_bf16_f32 v168, v168, v169
    v_cvt_pk_bf16_f32 v169, v170, v171
    v_cvt_pk_bf16_f32 v170, v172, v173
    v_cvt_pk_bf16_f32 v171, v174, v175
    buffer_store_dwordx4 v[168:171], v17, s[12:15], s36 offen offset:1024
    s_add_u32 s36, s36, 4096
    v_cvt_pk_bf16_f32 v176, v176, v177
    v_cvt_pk_bf16_f32 v177, v178, v179
    v_cvt_pk_bf16_f32 v178, v180, v181
    v_cvt_pk_bf16_f32 v179, v182, v183
    buffer_store_dwordx4 v[176:179], v17, s[12:15], s36 offen offset:0
    v_cvt_pk_bf16_f32 v184, v184, v185
    v_cvt_pk_bf16_f32 v185, v186, v187
    v_cvt_pk_bf16_f32 v186, v188, v189
    v_cvt_pk_bf16_f32 v187, v190, v191
    buffer_store_dwordx4 v[184:187], v17, s[12:15], s36 offen offset:1024
    s_add_u32 s36, s36, 4096
    v_cvt_pk_bf16_f32 v192, v192, v193
    v_cvt_pk_bf16_f32 v193, v194, v195
    v_cvt_pk_bf16_f32 v194, v196, v197
    v_cvt_pk_bf16_f32 v195, v198, v199
    buffer_store_dwordx4 v[192:195], v17, s[12:15], s36 offen offset:0
    v_cvt_pk_bf16_f32 v200, v200, v201
    v_cvt_pk_bf16_f32 v201, v202, v203
    v_cvt_pk_bf16_f32 v202, v204, v205
    v_cvt_pk_bf16_f32 v203, v206, v207
    buffer_store_dwordx4 v[200:203], v17, s[12:15], s36 offen offset:1024
    s_add_u32 s36, s36, 4096
    v_cvt_pk_bf16_f32 v208, v208, v209
    v_cvt_pk_bf16_f32 v209, v210, v211
    v_cvt_pk_bf16_f32 v210, v212, v213
    v_cvt_pk_bf16_f32 v211, v214, v215
    buffer_store_dwordx4 v[208:211], v17, s[12:15], s36 offen offset:0
    v_cvt_pk_bf16_f32 v216, v216, v217
    v_cvt_pk_bf16_f32 v217, v218, v219
    v_cvt_pk_bf16_f32 v218, v220, v221
    v_cvt_pk_bf16_f32 v219, v222, v223
    buffer_store_dwordx4 v[216:219], v17, s[12:15], s36 offen offset:1024
    s_add_u32 s36, s36, 4096
    v_cvt_pk_bf16_f32 v224, v224, v225
    v_cvt_pk_bf16_f32 v225, v226, v227
    v_cvt_pk_bf16_f32 v226, v228, v229
    v_cvt_pk_bf16_f32 v227, v230, v231
    buffer_store_dwordx4 v[224:227], v17, s[12:15], s36 offen offset:0
    v_cvt_pk_bf16_f32 v232, v232, v233
    v_cvt_pk_bf16_f32 v233, v234, v235
    v_cvt_pk_bf16_f32 v234, v236, v237
    v_cvt_pk_bf16_f32 v235, v238, v239
    buffer_store_dwordx4 v[232:235], v17, s[12:15], s36 offen offset:1024
    s_add_u32 s36, s36, 4096
    v_cvt_pk_bf16_f32 v240, v240, v241
    v_cvt_pk_bf16_f32 v241, v242, v243
    v_cvt_pk_bf16_f32 v242, v244, v245
    v_cvt_pk_bf16_f32 v243, v246, v247
    buffer_store_dwordx4 v[240:243], v17, s[12:15], s36 offen offset:0
    v_cvt_pk_bf16_f32 v248, v248, v249
    v_cvt_pk_bf16_f32 v249, v250, v251
    v_cvt_pk_bf16_f32 v250, v252, v253
    v_cvt_pk_bf16_f32 v251, v254, v255
    buffer_store_dwordx4 v[248:251], v17, s[12:15], s36 offen offset:1024
    s_branch L_kv_ln
    .p2align 6
L_kv_vloop:
    s_cmp_lt_u32 s35, 3
    s_cselect_b32 s6, 2097152, 0
    s_cselect_b32 s10, 4194304, 0
    s_waitcnt lgkmcnt(0)
    v_mfma_f32_16x16x32_bf16 v[128:131], v[20:23], v[52:55], v[128:131]
    ds_read_b128 v[68:71], v11 offset:0
    v_mfma_f32_16x16x32_bf16 v[160:163], v[20:23], v[56:59], v[160:163]
    ds_read_b64_tr_b16 v[100:101], v12 offset:8192
    v_mfma_f32_16x16x32_bf16 v[192:195], v[20:23], v[60:63], v[192:195]
    ds_read_b64_tr_b16 v[102:103], v12 offset:9216
    v_mfma_f32_16x16x32_bf16 v[224:227], v[20:23], v[64:67], v[224:227]
    ds_read_b64_tr_b16 v[104:105], v13 offset:8192
    v_mfma_f32_16x16x32_bf16 v[132:135], v[24:27], v[52:55], v[132:135]
    ds_read_b64_tr_b16 v[106:107], v13 offset:9216
    v_mfma_f32_16x16x32_bf16 v[164:167], v[24:27], v[56:59], v[164:167]
    ds_read_b64_tr_b16 v[108:109], v14 offset:8192
    v_mfma_f32_16x16x32_bf16 v[196:199], v[24:27], v[60:63], v[196:199]
    ds_read_b64_tr_b16 v[110:111], v14 offset:9216
    v_mfma_f32_16x16x32_bf16 v[228:231], v[24:27], v[64:67], v[228:231]
    ds_read_b64_tr_b16 v[112:113], v15 offset:8192
    v_mfma_f32_16x16x32_bf16 v[136:139], v[28:31], v[52:55], v[136:139]
    ds_read_b64_tr_b16 v[114:115], v15 offset:9216
    v_mfma_f32_16x16x32_bf16 v[168:171], v[28:31], v[56:59], v[168:171]
    ds_read_b128 v[72:75], v11 offset:2048
    v_mfma_f32_16x16x32_bf16 v[200:203], v[28:31], v[60:63], v[200:203]
    ds_read_b128 v[76:79], v11 offset:4096
    v_mfma_f32_16x16x32_bf16 v[232:235], v[28:31], v[64:67], v[232:235]
    ds_read_b128 v[80:83], v11 offset:6144
    v_mfma_f32_16x16x32_bf16 v[140:143], v[32:35], v[52:55], v[140:143]
    ds_read_b128 v[84:87], v11 offset:8192
    v_mfma_f32_16x16x32_bf16 v[172:175], v[32:35], v[56:59], v[172:175]
    ds_read_b128 v[88:91], v11 offset:10240
    v_mfma_f32_16x16x32_bf16 v[204:207], v[32:35], v[60:63], v[204:207]
    ds_read_b128 v[92:95], v11 offset:12288
    v_mfma_f32_16x16x32_bf16 v[236:239], v[32:35], v[64:67], v[236:239]
    ds_read_b128 v[96:99], v11 offset:14336
    v_mfma_f32_16x16x32_bf16 v[144:147], v[36:39], v[52:55], v[144:147]
    v_mfma_f32_16x16x32_bf16 v[176:179], v[36:39], v[56:59], v[176:179]
    v_mfma_f32_16x16x32_bf16 v[208:211], v[36:39], v[60:63], v[208:211]
    v_mfma_f32_16x16x32_bf16 v[240:243], v[36:39], v[64:67], v[240:243]
    v_mfma_f32_16x16x32_bf16 v[148:151], v[40:43], v[52:55], v[148:151]
    v_mfma_f32_16x16x32_bf16 v[180:183], v[40:43], v[56:59], v[180:183]
    v_mfma_f32_16x16x32_bf16 v[212:215], v[40:43], v[60:63], v[212:215]
    v_mfma_f32_16x16x32_bf16 v[244:247], v[40:43], v[64:67], v[244:247]
    v_mfma_f32_16x16x32_bf16 v[152:155], v[44:47], v[52:55], v[152:155]
    v_mfma_f32_16x16x32_bf16 v[184:187], v[44:47], v[56:59], v[184:187]
    v_mfma_f32_16x16x32_bf16 v[216:219], v[44:47], v[60:63], v[216:219]
    v_mfma_f32_16x16x32_bf16 v[248:251], v[44:47], v[64:67], v[248:251]
    v_mfma_f32_16x16x32_bf16 v[156:159], v[48:51], v[52:55], v[156:159]
    v_mfma_f32_16x16x32_bf16 v[188:191], v[48:51], v[56:59], v[188:191]
    v_mfma_f32_16x16x32_bf16 v[220:223], v[48:51], v[60:63], v[220:223]
    v_mfma_f32_16x16x32_bf16 v[252:255], v[48:51], v[64:67], v[252:255]
    s_waitcnt vmcnt(0) lgkmcnt(0)
    s_barrier
    s_add_u32 m0, s33, 0
    s_nop 0
    buffer_load_dwordx4 v2, s[4:7], s31 offen offset:0 lds
    buffer_load_dwordx4 v3, s[4:7], s31 offen offset:1024 lds
    buffer_load_dwordx4 v4, s[4:7], s31 offen offset:2048 lds
    buffer_load_dwordx4 v5, s[4:7], s31 offen offset:3072 lds
    s_add_u32 m0, s34, 0
    s_nop 0
    buffer_load_dwordx4 v6, s[8:11], s32 offen offset:0 lds
    buffer_load_dwordx4 v7, s[8:11], s32 offen offset:1024 lds
    buffer_load_dwordx4 v8, s[8:11], s32 offen offset:2048 lds
    buffer_load_dwordx4 v9, s[8:11], s32 offen offset:3072 lds
    s_add_u32 s31, s31, 128
    s_add_u32 s32, s32, 524288
    v_mfma_f32_16x16x32_bf16 v[128:131], v[68:71], v[100:103], v[128:131]
    ds_read_b128 v[20:23], v10 offset:32768
    v_mfma_f32_16x16x32_bf16 v[160:163], v[68:71], v[104:107], v[160:163]
    ds_read_b64_tr_b16 v[52:53], v12 offset:32768
    v_mfma_f32_16x16x32_bf16 v[192:195], v[68:71], v[108:111], v[192:195]
    ds_read_b64_tr_b16 v[54:55], v12 offset:33792
    v_mfma_f32_16x16x32_bf16 v[224:227], v[68:71], v[112:115], v[224:227]
    ds_read_b64_tr_b16 v[56:57], v13 offset:32768
    v_mfma_f32_16x16x32_bf16 v[132:135], v[72:75], v[100:103], v[132:135]
    ds_read_b64_tr_b16 v[58:59], v13 offset:33792
    v_mfma_f32_16x16x32_bf16 v[164:167], v[72:75], v[104:107], v[164:167]
    ds_read_b64_tr_b16 v[60:61], v14 offset:32768
    v_mfma_f32_16x16x32_bf16 v[196:199], v[72:75], v[108:111], v[196:199]
    ds_read_b64_tr_b16 v[62:63], v14 offset:33792
    v_mfma_f32_16x16x32_bf16 v[228:231], v[72:75], v[112:115], v[228:231]
    ds_read_b64_tr_b16 v[64:65], v15 offset:32768
    v_mfma_f32_16x16x32_bf16 v[136:139], v[76:79], v[100:103], v[136:139]
    ds_read_b64_tr_b16 v[66:67], v15 offset:33792
    v_mfma_f32_16x16x32_bf16 v[168:171], v[76:79], v[104:107], v[168:171]
    ds_read_b128 v[24:27], v10 offset:34816
    v_mfma_f32_16x16x32_bf16 v[200:203], v[76:79], v[108:111], v[200:203]
    ds_read_b128 v[28:31], v10 offset:36864
    v_mfma_f32_16x16x32_bf16 v[232:235], v[76:79], v[112:115], v[232:235]
    ds_read_b128 v[32:35], v10 offset:38912
    v_mfma_f32_16x16x32_bf16 v[140:143], v[80:83], v[100:103], v[140:143]
    ds_read_b128 v[36:39], v10 offset:40960
    v_mfma_f32_16x16x32_bf16 v[172:175], v[80:83], v[104:107], v[172:175]
    ds_read_b128 v[40:43], v10 offset:43008
    v_mfma_f32_16x16x32_bf16 v[204:207], v[80:83], v[108:111], v[204:207]
    ds_read_b128 v[44:47], v10 offset:45056
    v_mfma_f32_16x16x32_bf16 v[236:239], v[80:83], v[112:115], v[236:239]
    ds_read_b128 v[48:51], v10 offset:47104
    v_mfma_f32_16x16x32_bf16 v[144:147], v[84:87], v[100:103], v[144:147]
    v_mfma_f32_16x16x32_bf16 v[176:179], v[84:87], v[104:107], v[176:179]
    v_mfma_f32_16x16x32_bf16 v[208:211], v[84:87], v[108:111], v[208:211]
    v_mfma_f32_16x16x32_bf16 v[240:243], v[84:87], v[112:115], v[240:243]
    v_mfma_f32_16x16x32_bf16 v[148:151], v[88:91], v[100:103], v[148:151]
    v_mfma_f32_16x16x32_bf16 v[180:183], v[88:91], v[104:107], v[180:183]
    v_mfma_f32_16x16x32_bf16 v[212:215], v[88:91], v[108:111], v[212:215]
    v_mfma_f32_16x16x32_bf16 v[244:247], v[88:91], v[112:115], v[244:247]
    v_mfma_f32_16x16x32_bf16 v[152:155], v[92:95], v[100:103], v[152:155]
    v_mfma_f32_16x16x32_bf16 v[184:187], v[92:95], v[104:107], v[184:187]
    v_mfma_f32_16x16x32_bf16 v[216:219], v[92:95], v[108:111], v[216:219]
    v_mfma_f32_16x16x32_bf16 v[248:251], v[92:95], v[112:115], v[248:251]
    v_mfma_f32_16x16x32_bf16 v[156:159], v[96:99], v[100:103], v[156:159]
    v_mfma_f32_16x16x32_bf16 v[188:191], v[96:99], v[104:107], v[188:191]
    v_mfma_f32_16x16x32_bf16 v[220:223], v[96:99], v[108:111], v[220:223]
    v_mfma_f32_16x16x32_bf16 v[252:255], v[96:99], v[112:115], v[252:255]
    s_waitcnt lgkmcnt(0)
    v_mfma_f32_16x16x32_bf16 v[128:131], v[20:23], v[52:55], v[128:131]
    ds_read_b128 v[68:71], v11 offset:32768
    v_mfma_f32_16x16x32_bf16 v[160:163], v[20:23], v[56:59], v[160:163]
    ds_read_b64_tr_b16 v[100:101], v12 offset:40960
    v_mfma_f32_16x16x32_bf16 v[192:195], v[20:23], v[60:63], v[192:195]
    ds_read_b64_tr_b16 v[102:103], v12 offset:41984
    v_mfma_f32_16x16x32_bf16 v[224:227], v[20:23], v[64:67], v[224:227]
    ds_read_b64_tr_b16 v[104:105], v13 offset:40960
    v_mfma_f32_16x16x32_bf16 v[132:135], v[24:27], v[52:55], v[132:135]
    ds_read_b64_tr_b16 v[106:107], v13 offset:41984
    v_mfma_f32_16x16x32_bf16 v[164:167], v[24:27], v[56:59], v[164:167]
    ds_read_b64_tr_b16 v[108:109], v14 offset:40960
    v_mfma_f32_16x16x32_bf16 v[196:199], v[24:27], v[60:63], v[196:199]
    ds_read_b64_tr_b16 v[110:111], v14 offset:41984
    v_mfma_f32_16x16x32_bf16 v[228:231], v[24:27], v[64:67], v[228:231]
    ds_read_b64_tr_b16 v[112:113], v15 offset:40960
    v_mfma_f32_16x16x32_bf16 v[136:139], v[28:31], v[52:55], v[136:139]
    ds_read_b64_tr_b16 v[114:115], v15 offset:41984
    v_mfma_f32_16x16x32_bf16 v[168:171], v[28:31], v[56:59], v[168:171]
    ds_read_b128 v[72:75], v11 offset:34816
    v_mfma_f32_16x16x32_bf16 v[200:203], v[28:31], v[60:63], v[200:203]
    ds_read_b128 v[76:79], v11 offset:36864
    v_mfma_f32_16x16x32_bf16 v[232:235], v[28:31], v[64:67], v[232:235]
    ds_read_b128 v[80:83], v11 offset:38912
    v_mfma_f32_16x16x32_bf16 v[140:143], v[32:35], v[52:55], v[140:143]
    ds_read_b128 v[84:87], v11 offset:40960
    v_mfma_f32_16x16x32_bf16 v[172:175], v[32:35], v[56:59], v[172:175]
    ds_read_b128 v[88:91], v11 offset:43008
    v_mfma_f32_16x16x32_bf16 v[204:207], v[32:35], v[60:63], v[204:207]
    ds_read_b128 v[92:95], v11 offset:45056
    v_mfma_f32_16x16x32_bf16 v[236:239], v[32:35], v[64:67], v[236:239]
    ds_read_b128 v[96:99], v11 offset:47104
    v_mfma_f32_16x16x32_bf16 v[144:147], v[36:39], v[52:55], v[144:147]
    v_mfma_f32_16x16x32_bf16 v[176:179], v[36:39], v[56:59], v[176:179]
    v_mfma_f32_16x16x32_bf16 v[208:211], v[36:39], v[60:63], v[208:211]
    v_mfma_f32_16x16x32_bf16 v[240:243], v[36:39], v[64:67], v[240:243]
    v_mfma_f32_16x16x32_bf16 v[148:151], v[40:43], v[52:55], v[148:151]
    v_mfma_f32_16x16x32_bf16 v[180:183], v[40:43], v[56:59], v[180:183]
    v_mfma_f32_16x16x32_bf16 v[212:215], v[40:43], v[60:63], v[212:215]
    v_mfma_f32_16x16x32_bf16 v[244:247], v[40:43], v[64:67], v[244:247]
    v_mfma_f32_16x16x32_bf16 v[152:155], v[44:47], v[52:55], v[152:155]
    v_mfma_f32_16x16x32_bf16 v[184:187], v[44:47], v[56:59], v[184:187]
    v_mfma_f32_16x16x32_bf16 v[216:219], v[44:47], v[60:63], v[216:219]
    v_mfma_f32_16x16x32_bf16 v[248:251], v[44:47], v[64:67], v[248:251]
    v_mfma_f32_16x16x32_bf16 v[156:159], v[48:51], v[52:55], v[156:159]
    v_mfma_f32_16x16x32_bf16 v[188:191], v[48:51], v[56:59], v[188:191]
    v_mfma_f32_16x16x32_bf16 v[220:223], v[48:51], v[60:63], v[220:223]
    v_mfma_f32_16x16x32_bf16 v[252:255], v[48:51], v[64:67], v[252:255]
    s_waitcnt vmcnt(0) lgkmcnt(0)
    s_barrier
    s_add_u32 m0, s33, 32768
    s_nop 0
    buffer_load_dwordx4 v2, s[4:7], s31 offen offset:0 lds
    buffer_load_dwordx4 v3, s[4:7], s31 offen offset:1024 lds
    buffer_load_dwordx4 v4, s[4:7], s31 offen offset:2048 lds
    buffer_load_dwordx4 v5, s[4:7], s31 offen offset:3072 lds
    s_add_u32 m0, s34, 32768
    s_nop 0
    buffer_load_dwordx4 v6, s[8:11], s32 offen offset:0 lds
    buffer_load_dwordx4 v7, s[8:11], s32 offen offset:1024 lds
    buffer_load_dwordx4 v8, s[8:11], s32 offen offset:2048 lds
    buffer_load_dwordx4 v9, s[8:11], s32 offen offset:3072 lds
    s_add_u32 s31, s31, 128
    s_add_u32 s32, s32, 524288
    v_mfma_f32_16x16x32_bf16 v[128:131], v[68:71], v[100:103], v[128:131]
    ds_read_b128 v[20:23], v10 offset:0
    v_mfma_f32_16x16x32_bf16 v[160:163], v[68:71], v[104:107], v[160:163]
    ds_read_b64_tr_b16 v[52:53], v12 offset:0
    v_mfma_f32_16x16x32_bf16 v[192:195], v[68:71], v[108:111], v[192:195]
    ds_read_b64_tr_b16 v[54:55], v12 offset:1024
    v_mfma_f32_16x16x32_bf16 v[224:227], v[68:71], v[112:115], v[224:227]
    ds_read_b64_tr_b16 v[56:57], v13 offset:0
    v_mfma_f32_16x16x32_bf16 v[132:135], v[72:75], v[100:103], v[132:135]
    ds_read_b64_tr_b16 v[58:59], v13 offset:1024
    v_mfma_f32_16x16x32_bf16 v[164:167], v[72:75], v[104:107], v[164:167]
    ds_read_b64_tr_b16 v[60:61], v14 offset:0
    v_mfma_f32_16x16x32_bf16 v[196:199], v[72:75], v[108:111], v[196:199]
    ds_read_b64_tr_b16 v[62:63], v14 offset:1024
    v_mfma_f32_16x16x32_bf16 v[228:231], v[72:75], v[112:115], v[228:231]
    ds_read_b64_tr_b16 v[64:65], v15 offset:0
    v_mfma_f32_16x16x32_bf16 v[136:139], v[76:79], v[100:103], v[136:139]
    ds_read_b64_tr_b16 v[66:67], v15 offset:1024
    v_mfma_f32_16x16x32_bf16 v[168:171], v[76:79], v[104:107], v[168:171]
    ds_read_b128 v[24:27], v10 offset:2048
    v_mfma_f32_16x16x32_bf16 v[200:203], v[76:79], v[108:111], v[200:203]
    ds_read_b128 v[28:31], v10 offset:4096
    v_mfma_f32_16x16x32_bf16 v[232:235], v[76:79], v[112:115], v[232:235]
    ds_read_b128 v[32:35], v10 offset:6144
    v_mfma_f32_16x16x32_bf16 v[140:143], v[80:83], v[100:103], v[140:143]
    ds_read_b128 v[36:39], v10 offset:8192
    v_mfma_f32_16x16x32_bf16 v[172:175], v[80:83], v[104:107], v[172:175]
    ds_read_b128 v[40:43], v10 offset:10240
    v_mfma_f32_16x16x32_bf16 v[204:207], v[80:83], v[108:111], v[204:207]
    ds_read_b128 v[44:47], v10 offset:12288
    v_mfma_f32_16x16x32_bf16 v[236:239], v[80:83], v[112:115], v[236:239]
    ds_read_b128 v[48:51], v10 offset:14336
    v_mfma_f32_16x16x32_bf16 v[144:147], v[84:87], v[100:103], v[144:147]
    v_mfma_f32_16x16x32_bf16 v[176:179], v[84:87], v[104:107], v[176:179]
    v_mfma_f32_16x16x32_bf16 v[208:211], v[84:87], v[108:111], v[208:211]
    v_mfma_f32_16x16x32_bf16 v[240:243], v[84:87], v[112:115], v[240:243]
    v_mfma_f32_16x16x32_bf16 v[148:151], v[88:91], v[100:103], v[148:151]
    v_mfma_f32_16x16x32_bf16 v[180:183], v[88:91], v[104:107], v[180:183]
    v_mfma_f32_16x16x32_bf16 v[212:215], v[88:91], v[108:111], v[212:215]
    v_mfma_f32_16x16x32_bf16 v[244:247], v[88:91], v[112:115], v[244:247]
    v_mfma_f32_16x16x32_bf16 v[152:155], v[92:95], v[100:103], v[152:155]
    v_mfma_f32_16x16x32_bf16 v[184:187], v[92:95], v[104:107], v[184:187]
    v_mfma_f32_16x16x32_bf16 v[216:219], v[92:95], v[108:111], v[216:219]
    v_mfma_f32_16x16x32_bf16 v[248:251], v[92:95], v[112:115], v[248:251]
    v_mfma_f32_16x16x32_bf16 v[156:159], v[96:99], v[100:103], v[156:159]
    v_mfma_f32_16x16x32_bf16 v[188:191], v[96:99], v[104:107], v[188:191]
    v_mfma_f32_16x16x32_bf16 v[220:223], v[96:99], v[108:111], v[220:223]
    v_mfma_f32_16x16x32_bf16 v[252:255], v[96:99], v[112:115], v[252:255]
    s_add_u32 s35, s35, 1
    s_cmp_lt_u32 s35, 4
    s_cbranch_scc1 L_kv_vloop
    s_waitcnt lgkmcnt(0)
    v_lshlrev_b32 v17, 4, v1
    s_lshl_b32 s36, s42, 11
    v_add_u32 v18, s36, v17
    buffer_load_dwordx4 v[20:23], v18, s[16:19], 0 offen
    buffer_load_dwordx4 v[24:27], v18, s[16:19], 0 offen offset:1024
    buffer_load_dwordx4 v[28:31], v17, s[20:23], 0 offen
    buffer_load_dwordx4 v[32:35], v17, s[20:23], 0 offen offset:1024
    s_lshl_b32 s36, s29, 20
    s_lshl_b32 s37, s30, 17
    s_add_u32 s36, s36, s37
    s_bfe_u32 s37, s28, 0x10001
    s_lshl_b32 s37, s37, 16
    s_add_u32 s36, s36, s37
    s_and_b32 s37, s28, 1
    s_lshl_b32 s37, s37, 12
    s_add_u32 s36, s36, s37
    s_add_u32 s36, s36, 32768
    v_cvt_pk_bf16_f32 v128, v128, v129
    v_cvt_pk_bf16_f32 v129, v130, v131
    v_cvt_pk_bf16_f32 v130, v132, v133
    v_cvt_pk_bf16_f32 v131, v134, v135
    buffer_store_dwordx4 v[128:131], v17, s[12:15], s36 offen offset:0
    v_cvt_pk_bf16_f32 v160, v160, v161
    v_cvt_pk_bf16_f32 v161, v162, v163
    v_cvt_pk_bf16_f32 v162, v164, v165
    v_cvt_pk_bf16_f32 v163, v166, v167
    buffer_store_dwordx4 v[160:163], v17, s[12:15], s36 offen offset:1024
    v_cvt_pk_bf16_f32 v192, v192, v193
    v_cvt_pk_bf16_f32 v193, v194, v195
    v_cvt_pk_bf16_f32 v194, v196, v197
    v_cvt_pk_bf16_f32 v195, v198, v199
    buffer_store_dwordx4 v[192:195], v17, s[12:15], s36 offen offset:2048
    v_cvt_pk_bf16_f32 v224, v224, v225
    v_cvt_pk_bf16_f32 v225, v226, v227
    v_cvt_pk_bf16_f32 v226, v228, v229
    v_cvt_pk_bf16_f32 v227, v230, v231
    buffer_store_dwordx4 v[224:227], v17, s[12:15], s36 offen offset:3072
    s_add_u32 s36, s36, 8192
    v_cvt_pk_bf16_f32 v136, v136, v137
    v_cvt_pk_bf16_f32 v137, v138, v139
    v_cvt_pk_bf16_f32 v138, v140, v141
    v_cvt_pk_bf16_f32 v139, v142, v143
    buffer_store_dwordx4 v[136:139], v17, s[12:15], s36 offen offset:0
    v_cvt_pk_bf16_f32 v168, v168, v169
    v_cvt_pk_bf16_f32 v169, v170, v171
    v_cvt_pk_bf16_f32 v170, v172, v173
    v_cvt_pk_bf16_f32 v171, v174, v175
    buffer_store_dwordx4 v[168:171], v17, s[12:15], s36 offen offset:1024
    v_cvt_pk_bf16_f32 v200, v200, v201
    v_cvt_pk_bf16_f32 v201, v202, v203
    v_cvt_pk_bf16_f32 v202, v204, v205
    v_cvt_pk_bf16_f32 v203, v206, v207
    buffer_store_dwordx4 v[200:203], v17, s[12:15], s36 offen offset:2048
    v_cvt_pk_bf16_f32 v232, v232, v233
    v_cvt_pk_bf16_f32 v233, v234, v235
    v_cvt_pk_bf16_f32 v234, v236, v237
    v_cvt_pk_bf16_f32 v235, v238, v239
    buffer_store_dwordx4 v[232:235], v17, s[12:15], s36 offen offset:3072
    s_add_u32 s36, s36, 8192
    v_cvt_pk_bf16_f32 v144, v144, v145
    v_cvt_pk_bf16_f32 v145, v146, v147
    v_cvt_pk_bf16_f32 v146, v148, v149
    v_cvt_pk_bf16_f32 v147, v150, v151
    buffer_store_dwordx4 v[144:147], v17, s[12:15], s36 offen offset:0
    v_cvt_pk_bf16_f32 v176, v176, v177
    v_cvt_pk_bf16_f32 v177, v178, v179
    v_cvt_pk_bf16_f32 v178, v180, v181
    v_cvt_pk_bf16_f32 v179, v182, v183
    buffer_store_dwordx4 v[176:179], v17, s[12:15], s36 offen offset:1024
    v_cvt_pk_bf16_f32 v208, v208, v209
    v_cvt_pk_bf16_f32 v209, v210, v211
    v_cvt_pk_bf16_f32 v210, v212, v213
    v_cvt_pk_bf16_f32 v211, v214, v215
    buffer_store_dwordx4 v[208:211], v17, s[12:15], s36 offen offset:2048
    v_cvt_pk_bf16_f32 v240, v240, v241
    v_cvt_pk_bf16_f32 v241, v242, v243
    v_cvt_pk_bf16_f32 v242, v244, v245
    v_cvt_pk_bf16_f32 v243, v246, v247
    buffer_store_dwordx4 v[240:243], v17, s[12:15], s36 offen offset:3072
    s_add_u32 s36, s36, 8192
    v_cvt_pk_bf16_f32 v152, v152, v153
    v_cvt_pk_bf16_f32 v153, v154, v155
    v_cvt_pk_bf16_f32 v154, v156, v157
    v_cvt_pk_bf16_f32 v155, v158, v159
    buffer_store_dwordx4 v[152:155], v17, s[12:15], s36 offen offset:0
    v_cvt_pk_bf16_f32 v184, v184, v185
    v_cvt_pk_bf16_f32 v185, v186, v187
    v_cvt_pk_bf16_f32 v186, v188, v189
    v_cvt_pk_bf16_f32 v187, v190, v191
    buffer_store_dwordx4 v[184:187], v17, s[12:15], s36 offen offset:1024
    v_cvt_pk_bf16_f32 v216, v216, v217
    v_cvt_pk_bf16_f32 v217, v218, v219
    v_cvt_pk_bf16_f32 v218, v220, v221
    v_cvt_pk_bf16_f32 v219, v222, v223
    buffer_store_dwordx4 v[216:219], v17, s[12:15], s36 offen offset:2048
    v_cvt_pk_bf16_f32 v248, v248, v249
    v_cvt_pk_bf16_f32 v249, v250, v251
    v_cvt_pk_bf16_f32 v250, v252, v253
    v_cvt_pk_bf16_f32 v251, v254, v255
    buffer_store_dwordx4 v[248:251], v17, s[12:15], s36 offen offset:3072
L_kv_ln:
    s_waitcnt vmcnt(16)
    v_lshlrev_b32 v36, 16, v20
    v_and_b32 v37, 0xffff0000, v20
    v_lshlrev_b32 v38, 16, v21
    v_and_b32 v39, 0xffff0000, v21
    v_lshlrev_b32 v40, 16, v22
    v_and_b32 v41, 0xffff0000, v22
    v_lshlrev_b32 v42, 16, v23
    v_and_b32 v43, 0xffff0000, v23
    v_lshlrev_b32 v44, 16, v24
    v_and_b32 v45, 0xffff0000, v24
    v_lshlrev_b32 v46, 16, v25
    v_and_b32 v47, 0xffff0000, v25
    v_lshlrev_b32 v48, 16, v26
    v_and_b32 v49, 0xffff0000, v26
    v_lshlrev_b32 v50, 16, v27
    v_and_b32 v51, 0xffff0000, v27
    v_add_f32 v52, v36, v37
    v_add_f32 v52, v52, v38
    v_add_f32 v52, v52, v39
    v_add_f32 v52, v52, v40
    v_add_f32 v52, v52, v41
    v_add_f32 v52, v52, v42
    v_add_f32 v52, v52, v43
    v_add_f32 v52, v52, v44
    v_add_f32 v52, v52, v45
    v_add_f32 v52, v52, v46
    v_add_f32 v52, v52, v47
    v_add_f32 v52, v52, v48
    v_add_f32 v52, v52, v49
    v_add_f32 v52, v52, v50
    v_add_f32 v52, v52, v51
    s_nop 1
    v_add_f32_dpp v52, v52, v52 quad_perm:[1,0,3,2] row_mask:0xf bank_mask:0xf
    s_nop 1
    v_add_f32_dpp v52, v52, v52 quad_perm:[2,3,0,1] row_mask:0xf bank_mask:0xf
    s_nop 1
    v_add_f32_dpp v52, v52, v52 row_half_mirror row_mask:0xf bank_mask:0xf
    s_nop 1
    v_add_f32_dpp v52, v52, v52 row_mirror row_mask:0xf bank_mask:0xf
    s_nop 0
    v_readlane_b32 s36, v52, 0
    v_readlane_b32 s37, v52, 16
    v_readlane_b32 s38, v52, 32
    v_readlane_b32 s39, v52, 48
    v_mov_b32 v53, s36
    v_add_f32 v53, s37, v53
    v_add_f32 v53, s38, v53
    v_add_f32 v53, s39, v53
    v_mul_f32 v53, 0x3a800000, v53
    v_sub_f32 v54, v36, v53
    v_mul_f32 v52, v54, v54
    v_sub_f32 v54, v37, v53
    v_fmac_f32 v52, v54, v54
    v_sub_f32 v54, v38, v53
    v_fmac_f32 v52, v54, v54
    v_sub_f32 v54, v39, v53
    v_fmac_f32 v52, v54, v54
    v_sub_f32 v54, v40, v53
    v_fmac_f32 v52, v54, v54
    v_sub_f32 v54, v41, v53
    v_fmac_f32 v52, v54, v54
    v_sub_f32 v54, v42, v53
    v_fmac_f32 v52, v54, v54
    v_sub_f32 v54, v43, v53
    v_fmac_f32 v52, v54, v54
    v_sub_f32 v54, v44, v53
    v_fmac_f32 v52, v54, v54
    v_sub_f32 v54, v45, v53
    v_fmac_f32 v52, v54, v54
    v_sub_f32 v54, v46, v53
    v_fmac_f32 v52, v54, v54
    v_sub_f32 v54, v47, v53
    v_fmac_f32 v52, v54, v54
    v_sub_f32 v54, v48, v53
    v_fmac_f32 v52, v54, v54
    v_sub_f32 v54, v49, v53
    v_fmac_f32 v52, v54, v54
    v_sub_f32 v54, v50, v53
    v_fmac_f32 v52, v54, v54
    v_sub_f32 v54, v51, v53
    v_fmac_f32 v52, v54, v54
    s_nop 1
    v_add_f32_dpp v52, v52, v52 quad_perm:[1,0,3,2] row_mask:0xf bank_mask:0xf
    s_nop 1
    v_add_f32_dpp v52, v52, v52 quad_perm:[2,3,0,1] row_mask:0xf bank_mask:0xf
    s_nop 1
    v_add_f32_dpp v52, v52, v52 row_half_mirror row_mask:0xf bank_mask:0xf
    s_nop 1
    v_add_f32_dpp v52, v52, v52 row_mirror row_mask:0xf bank_mask:0xf
    s_nop 0
    v_readlane_b32 s36, v52, 0
    v_readlane_b32 s37, v52, 16
    v_readlane_b32 s38, v52, 32
    v_readlane_b32 s39, v52, 48
    v_mov_b32 v54, s36
    v_add_f32 v54, s37, v54
    v_add_f32 v54, s38, v54
    v_add_f32 v54, s39, v54
    v_mul_f32 v54, 0x3a800000, v54
    v_cvt_pk_bf16_f32 v55, v53, v54
    v_lshlrev_b32 v58, 16, v55
    v_and_b32 v54, 0xffff0000, v55
    v_add_f32 v54, 0x3727c5ac, v54
    v_cvt_pk_bf16_f32 v54, v54, v54
    v_lshlrev_b32 v54, 16, v54
    v_sqrt_f32 v54, v54
    s_nop 0
    v_cvt_pk_bf16_f32 v54, v54, v54
    v_lshlrev_b32 v54, 16, v54
    v_rcp_f32 v59, v54
    s_nop 0
    v_fma_f32 v56, -v54, v59, 1.0
    v_fma_f32 v59, v56, v59, v59
    v_sub_f32 v36, v36, v58
    v_sub_f32 v37, v37, v58
    v_cvt_pk_bf16_f32 v56, v36, v37
    v_lshlrev_b32 v36, 16, v56
    v_and_b32 v37, 0xffff0000, v56
    v_mul_f32 v36, v36, v59
    v_mul_f32 v37, v37, v59
    v_cvt_pk_bf16_f32 v20, v36, v37
    v_lshlrev_b32 v36, 16, v20
    v_and_b32 v37, 0xffff0000, v20
    v_sub_f32 v38, v38, v58
    v_sub_f32 v39, v39, v58
    v_cvt_pk_bf16_f32 v56, v38, v39
    v_lshlrev_b32 v38, 16, v56
    v_and_b32 v39, 0xffff0000, v56
    v_mul_f32 v38, v38, v59
    v_mul_f32 v39, v39, v59
    v_cvt_pk_bf16_f32 v21, v38, v39
    v_lshlrev_b32 v38, 16, v21
    v_and_b32 v39, 0xffff0000, v21
    v_sub_f32 v40, v40, v58
    v_sub_f32 v41, v41, v58
    v_cvt_pk_bf16_f32 v56, v40, v41
    v_lshlrev_b32 v40, 16, v56
    v_and_b32 v41, 0xffff0000, v56
    v_mul_f32 v40, v40, v59
    v_mul_f32 v41, v41, v59
    v_cvt_pk_bf16_f32 v22, v40, v41
    v_lshlrev_b32 v40, 16, v22
    v_and_b32 v41, 0xffff0000, v22
    v_sub_f32 v42, v42, v58
    v_sub_f32 v43, v43, v58
    v_cvt_pk_bf16_f32 v56, v42, v43
    v_lshlrev_b32 v42, 16, v56
    v_and_b32 v43, 0xffff0000, v56
    v_mul_f32 v42, v42, v59
    v_mul_f32 v43, v43, v59
    v_cvt_pk_bf16_f32 v23, v42, v43
    v_lshlrev_b32 v42, 16, v23
    v_and_b32 v43, 0xffff0000, v23
    v_sub_f32 v44, v44, v58
    v_sub_f32 v45, v45, v58
    v_cvt_pk_bf16_f32 v56, v44, v45
    v_lshlrev_b32 v44, 16, v56
    v_and_b32 v45, 0xffff0000, v56
    v_mul_f32 v44, v44, v59
    v_mul_f32 v45, v45, v59
    v_cvt_pk_bf16_f32 v24, v44, v45
    v_lshlrev_b32 v44, 16, v24
    v_and_b32 v45, 0xffff0000, v24
    v_sub_f32 v46, v46, v58
    v_sub_f32 v47, v47, v58
    v_cvt_pk_bf16_f32 v56, v46, v47
    v_lshlrev_b32 v46, 16, v56
    v_and_b32 v47, 0xffff0000, v56
    v_mul_f32 v46, v46, v59
    v_mul_f32 v47, v47, v59
    v_cvt_pk_bf16_f32 v25, v46, v47
    v_lshlrev_b32 v46, 16, v25
    v_and_b32 v47, 0xffff0000, v25
    v_sub_f32 v48, v48, v58
    v_sub_f32 v49, v49, v58
    v_cvt_pk_bf16_f32 v56, v48, v49
    v_lshlrev_b32 v48, 16, v56
    v_and_b32 v49, 0xffff0000, v56
    v_mul_f32 v48, v48, v59
    v_mul_f32 v49, v49, v59
    v_cvt_pk_bf16_f32 v26, v48, v49
    v_lshlrev_b32 v48, 16, v26
    v_and_b32 v49, 0xffff0000, v26
    v_sub_f32 v50, v50, v58
    v_sub_f32 v51, v51, v58
    v_cvt_pk_bf16_f32 v56, v50, v51
    v_lshlrev_b32 v50, 16, v56
    v_and_b32 v51, 0xffff0000, v56
    v_mul_f32 v50, v50, v59
    v_mul_f32 v51, v51, v59
    v_cvt_pk_bf16_f32 v27, v50, v51
    v_lshlrev_b32 v50, 16, v27
    v_and_b32 v51, 0xffff0000, v27
    s_lshr_b32 s40, s42, 4
    s_lshl_b32 s40, s40, 15
    s_and_b32 s41, s42, 15
    s_lshl_b32 s41, s41, 4
    s_add_u32 s40, s40, s41
    s_add_u32 s41, s40, 16384
    v_lshlrev_b32 v55, 8, v1
    buffer_store_dwordx4 v[20:23], v55, s[24:27], s40 offen
    buffer_store_dwordx4 v[24:27], v55, s[24:27], s41 offen
    v_lshlrev_b32 v56, 16, v28
    v_and_b32 v57, 0xffff0000, v28
    v_mul_f32 v52, v36, v56
    v_fmac_f32 v52, v37, v57
    v_lshlrev_b32 v56, 16, v29
    v_and_b32 v57, 0xffff0000, v29
    v_fmac_f32 v52, v38, v56
    v_fmac_f32 v52, v39, v57
    v_lshlrev_b32 v56, 16, v30
    v_and_b32 v57, 0xffff0000, v30
    v_fmac_f32 v52, v40, v56
    v_fmac_f32 v52, v41, v57
    v_lshlrev_b32 v56, 16, v31
    v_and_b32 v57, 0xffff0000, v31
    v_fmac_f32 v52, v42, v56
    v_fmac_f32 v52, v43, v57
    v_lshlrev_b32 v56, 16, v32
    v_and_b32 v57, 0xffff0000, v32
    v_fmac_f32 v52, v44, v56
    v_fmac_f32 v52, v45, v57
    v_lshlrev_b32 v56, 16, v33
    v_and_b32 v57, 0xffff0000, v33
    v_fmac_f32 v52, v46, v56
    v_fmac_f32 v52, v47, v57
    v_lshlrev_b32 v56, 16, v34
    v_and_b32 v57, 0xffff0000, v34
    v_fmac_f32 v52, v48, v56
    v_fmac_f32 v52, v49, v57
    v_lshlrev_b32 v56, 16, v35
    v_and_b32 v57, 0xffff0000, v35
    v_fmac_f32 v52, v50, v56
    v_fmac_f32 v52, v51, v57
    s_nop 1
    v_add_f32_dpp v52, v52, v52 quad_perm:[1,0,3,2] row_mask:0xf bank_mask:0xf
    s_nop 1
    v_add_f32_dpp v52, v52, v52 quad_perm:[2,3,0,1] row_mask:0xf bank_mask:0xf
    s_nop 1
    v_add_f32_dpp v52, v52, v52 row_half_mirror row_mask:0xf bank_mask:0xf
    s_nop 1
    v_add_f32_dpp v52, v52, v52 row_mirror row_mask:0xf bank_mask:0xf
    s_nop 0
    v_readlane_b32 s36, v52, 0
    v_readlane_b32 s37, v52, 16
    v_readlane_b32 s38, v52, 32
    v_readlane_b32 s39, v52, 48
    v_mov_b32 v53, s36
    v_add_f32 v53, s37, v53
    v_add_f32 v53, s38, v53
    v_add_f32 v53, s39, v53
    v_cvt_pk_bf16_f32 v53, v53, v53
    v_lshlrev_b32 v53, 16, v53
    v_ashrrev_i32 v55, 31, v53
    v_or_b32 v55, 0x80000000, v55
    v_xor_b32 v55, v53, v55
    v_and_b32 v55, 0xffff0000, v55
    s_sub_u32 s40, 0xffff, s42
    v_or_b32 v55, s40, v55
    s_lshl_b32 s40, s42, 3
    s_add_u32 s40, s40, 4194304
    s_lshl_b32 s41, s42, 2
    s_add_u32 s41, s41, 4276224
    v_mov_b32 v54, 0
    s_mov_b64 exec, 1
    buffer_store_dwordx2 v[58:59], v54, s[24:27], s40 offen
    buffer_store_dword v55, v54, s[24:27], s41 offen
    s_mov_b64 exec, -1
L_kv_end:
    s_endpgm
.globl ffn1_kernel
.p2align 8
.type ffn1_kernel,@function
ffn1_kernel:
    s_cmp_ge_u32 s2, 224
    s_cbranch_scc1 L_ffn1_end
    s_load_dwordx4 s[44:47], s[0:1], 64
    s_load_dwordx2 s[54:55], s[0:1], 104
    v_and_b32 v1, 63, v0
    v_lshrrev_b32 v16, 6, v0
    s_nop 0
    v_readfirstlane_b32 s28, v16
    s_waitcnt lgkmcnt(0)
    s_mov_b32 s24, s54
    s_and_b32 s25, s55, 0xffff
    s_mov_b32 s26, 67108864
    s_mov_b32 s27, 0x20000
    s_mov_b32 s4, s44
    s_and_b32 s5, s45, 0xffff
    s_mov_b32 s6, 7340032
    s_mov_b32 s7, 0x20000
    s_mov_b32 s8, s46
    s_and_b32 s9, s47, 0xffff
    s_mov_b32 s10, 7340032
    s_mov_b32 s11, 0x20000
    v_lshlrev_b32 v96, 4, v1
    s_mov_b32 s36, 4276224
    s_mov_b32 s37, 4280320
    buffer_load_dwordx4 v[64:67], v96, s[24:27], s36 offen offset:0
    buffer_load_dwordx4 v[68:71], v96, s[24:27], s36 offen offset:1024
    buffer_load_dwordx4 v[72:75], v96, s[24:27], s36 offen offset:2048
    buffer_load_dwordx4 v[76:79], v96, s[24:27], s36 offen offset:3072
    buffer_load_dwordx4 v[80:83], v96, s[24:27], s37 offen offset:0
    buffer_load_dwordx4 v[84:87], v96, s[24:27], s37 offen offset:1024
    buffer_load_dwordx4 v[88:91], v96, s[24:27], s37 offen offset:2048
    buffer_load_dwordx4 v[92:95], v96, s[24:27], s37 offen offset:3072
    s_and_b32 s29, s2, 3
    s_lshr_b32 s30, s2, 2
    s_lshl_b32 s38, s29, 8
    s_lshl_b32 s39, s30, 7
    v_lshrrev_b32 v7, 3, v1
    s_lshl_b32 s36, s28, 5
    s_add_u32 s36, s36, s38
    v_add_u32 v7, s36, v7
    v_mul_u32_u24 v7, 7168, v7
    v_add_u32 v7, s39, v7
    v_bfe_u32 v8, v1, 4, 1
    v_lshlrev_b32 v8, 1, v8
    v_and_b32 v9, 7, v1
    v_xor_b32 v8, v8, v9
    v_lshl_add_u32 v6, v8, 4, v7
    v_xor_b32 v8, 4, v8
    v_lshl_add_u32 v7, v8, 4, v7
    v_add_u32 v7, 56320, v7
    v_add_u32 v8, 112640, v6
    v_add_u32 v9, 112640, v7
    s_lshl_b32 s33, s28, 12
    s_add_u32 m0, s33, 0
    s_nop 0
    buffer_load_dwordx4 v6, s[4:7], 0 offen offset:0 lds
    buffer_load_dwordx4 v7, s[4:7], 0 offen offset:1024 lds
    buffer_load_dwordx4 v8, s[4:7], 0 offen offset:2048 lds
    buffer_load_dwordx4 v9, s[4:7], 0 offen offset:3072 lds
    s_add_u32 m0, s33, 32768
    s_nop 0
    buffer_load_dwordx4 v6, s[8:11], 0 offen offset:0 lds
    buffer_load_dwordx4 v7, s[8:11], 0 offen offset:1024 lds
    buffer_load_dwordx4 v8, s[8:11], 0 offen offset:2048 lds
    buffer_load_dwordx4 v9, s[8:11], 0 offen offset:3072 lds
    s_waitcnt vmcnt(8)
    v_max_u32 v96, v64, v65
    v_min_u32 v97, v64, v65
    v_med3_u32 v97, v96, v97, v66
    v_max_u32 v96, v96, v66
    v_med3_u32 v97, v96, v97, v67
    v_max_u32 v96, v96, v67
    v_med3_u32 v97, v96, v97, v68
    v_max_u32 v96, v96, v68
    v_med3_u32 v97, v96, v97, v69
    v_max_u32 v96, v96, v69
    v_med3_u32 v97, v96, v97, v70
    v_max_u32 v96, v96, v70
    v_med3_u32 v97, v96, v97, v71
    v_max_u32 v96, v96, v71
    v_med3_u32 v97, v96, v97, v72
    v_max_u32 v96, v96, v72
    v_med3_u32 v97, v96, v97, v73
    v_max_u32 v96, v96, v73
    v_med3_u32 v97, v96, v97, v74
    v_max_u32 v96, v96, v74
    v_med3_u32 v97, v96, v97, v75
    v_max_u32 v96, v96, v75
    v_med3_u32 v97, v96, v97, v76
    v_max_u32 v96, v96, v76
    v_med3_u32 v97, v96, v97, v77
    v_max_u32 v96, v96, v77
    v_med3_u32 v97, v96, v97, v78
    v_max_u32 v96, v96, v78
    v_med3_u32 v97, v96, v97, v79
    v_max_u32 v96, v96, v79
    v_med3_u32 v97, v96, v97, v80
    v_max_u32 v96, v96, v80
    v_med3_u32 v97, v96, v97, v81
    v_max_u32 v96, v96, v81
    v_med3_u32 v97, v96, v97, v82
    v_max_u32 v96, v96, v82
    v_med3_u32 v97, v96, v97, v83
    v_max_u32 v96, v96, v83
    v_med3_u32 v97, v96, v97, v84
    v_max_u32 v96, v96, v84
    v_med3_u32 v97, v96, v97, v85
    v_max_u32 v96, v96, v85
    v_med3_u32 v97, v96, v97, v86
    v_max_u32 v96, v96, v86
    v_med3_u32 v97, v96, v97, v87
    v_max_u32 v96, v96, v87
    v_med3_u32 v97, v96, v97, v88
    v_max_u32 v96, v96, v88
    v_med3_u32 v97, v96, v97, v89
    v_max_u32 v96, v96, v89
    v_med3_u32 v97, v96, v97, v90
    v_max_u32 v96, v96, v90
    v_med3_u32 v97, v96, v97, v91
    v_max_u32 v96, v96, v91
    v_med3_u32 v97, v96, v97, v92
    v_max_u32 v96, v96, v92
    v_med3_u32 v97, v96, v97, v93
    v_max_u32 v96, v96, v93
    v_med3_u32 v97, v96, v97, v94
    v_max_u32 v96, v96, v94
    v_med3_u32 v97, v96, v97, v95
    v_max_u32 v96, v96, v95
    v_mov_b32 v98, v96
    s_nop 1
    v_max_u32_dpp v98, v98, v98 quad_perm:[1,0,3,2] row_mask:0xf bank_mask:0xf
    s_nop 1
    v_max_u32_dpp v98, v98, v98 quad_perm:[2,3,0,1] row_mask:0xf bank_mask:0xf
    s_nop 1
    v_max_u32_dpp v98, v98, v98 row_half_mirror row_mask:0xf bank_mask:0xf
    s_nop 1
    v_max_u32_dpp v98, v98, v98 row_mirror row_mask:0xf bank_mask:0xf
    s_nop 0
    v_readlane_b32 s36, v98, 0
    v_readlane_b32 s37, v98, 16
    v_readlane_b32 s38, v98, 32
    v_readlane_b32 s39, v98, 48
    s_max_u32 s36, s36, s37
    s_max_u32 s38, s38, s39
    s_max_u32 s36, s36, s38
    s_mov_b32 s58, s36
    v_cmp_eq_u32 vcc, s58, v96
    s_nop 1
    v_cndmask_b32 v98, v96, v97, vcc
    s_nop 1
    v_max_u32_dpp v98, v98, v98 quad_perm:[1,0,3,2] row_mask:0xf bank_mask:0xf
    s_nop 1
    v_max_u32_dpp v98, v98, v98 quad_perm:[2,3,0,1] row_mask:0xf bank_mask:0xf
    s_nop 1
    v_max_u32_dpp v98, v98, v98 row_half_mirror row_mask:0xf bank_mask:0xf
    s_nop 1
    v_max_u32_dpp v98, v98, v98 row_mirror row_mask:0xf bank_mask:0xf
    s_nop 0
    v_readlane_b32 s36, v98, 0
    v_readlane_b32 s37, v98, 16
    v_readlane_b32 s38, v98, 32
    v_readlane_b32 s39, v98, 48
    s_max_u32 s36, s36, s37
    s_max_u32 s38, s38, s39
    s_max_u32 s36, s36, s38
    s_mov_b32 s59, s36
    s_and_b32 s36, s58, 0xffff
    s_sub_u32 s56, 0xffff, s36
    s_and_b32 s36, s59, 0xffff
    s_sub_u32 s57, 0xffff, s36
    v_and_b32 v10, 1, v1
    v_mov_b32 v11, s56
    v_mov_b32 v12, s57
    v_cmp_eq_u32 vcc, 1, v10
    s_nop 1
    v_cndmask_b32 v11, v11, v12, vcc
    v_lshrrev_b32 v12, 4, v11
    v_lshlrev_b32 v12, 15, v12
    v_and_b32 v11, 15, v11
    v_lshl_add_u32 v12, v11, 4, v12
    v_lshrrev_b32 v13, 4, v1
    v_lshl_add_u32 v12, v13, 8, v12
    s_lshl_b32 s36, s29, 13
    s_add_u32 s37, s36, 4096
    buffer_load_dwordx4 v[64:67], v12, s[24:27], s36 offen offset:0
    buffer_load_dwordx4 v[68:71], v12, s[24:27], s36 offen offset:1024
    buffer_load_dwordx4 v[72:75], v12, s[24:27], s36 offen offset:2048
    buffer_load_dwordx4 v[76:79], v12, s[24:27], s36 offen offset:3072
    buffer_load_dwordx4 v[80:83], v12, s[24:27], s37 offen offset:0
    buffer_load_dwordx4 v[84:87], v12, s[24:27], s37 offen offset:1024
    buffer_load_dwordx4 v[88:91], v12, s[24:27], s37 offen offset:2048
    buffer_load_dwordx4 v[92:95], v12, s[24:27], s37 offen offset:3072
    v_lshrrev_b32 v16, 4, v1
    v_bfe_u32 v14, v1, 2, 2
    v_lshl_add_u32 v14, v16, 3, v14
    v_lshlrev_b32 v14, 7, v14
    v_and_b32 v15, 3, v1
    v_lshl_add_u32 v14, v15, 3, v14
    v_bfe_u32 v15, v1, 3, 2
    s_and_b32 s36, s28, 3
    v_xor_b32 v15, s36, v15
    v_lshl_add_u32 v14, v15, 5, v14
    s_lshr_b32 s36, s28, 2
    s_lshl_b32 s36, s36, 15
    v_add_u32 v14, s36, v14
    s_waitcnt vmcnt(8)
    s_barrier
    ds_read_b64_tr_b16 v[100:101], v14 offset:0
    ds_read_b64_tr_b16 v[102:103], v14 offset:512
    ds_read_b64_tr_b16 v[104:105], v14 offset:4096
    ds_read_b64_tr_b16 v[106:107], v14 offset:4608
    ds_read_b64_tr_b16 v[108:109], v14 offset:8192
    ds_read_b64_tr_b16 v[110:111], v14 offset:8704
    ds_read_b64_tr_b16 v[112:113], v14 offset:12288
    ds_read_b64_tr_b16 v[114:115], v14 offset:12800
    ds_read_b64_tr_b16 v[116:117], v14 offset:16384
    ds_read_b64_tr_b16 v[118:119], v14 offset:16896
    ds_read_b64_tr_b16 v[120:121], v14 offset:20480
    ds_read_b64_tr_b16 v[122:123], v14 offset:20992
    ds_read_b64_tr_b16 v[124:125], v14 offset:24576
    ds_read_b64_tr_b16 v[126:127], v14 offset:25088
    ds_read_b64_tr_b16 v[128:129], v14 offset:28672
    ds_read_b64_tr_b16 v[130:131], v14 offset:29184
    s_waitcnt vmcnt(0) lgkmcnt(0)
    v_mfma_f32_16x16x32_bf16 v[20:23], v[100:103], v[64:67], 0
    v_mfma_f32_16x16x32_bf16 v[20:23], v[104:107], v[68:71], v[20:23]
    v_mfma_f32_16x16x32_bf16 v[20:23], v[108:111], v[72:75], v[20:23]
    v_mfma_f32_16x16x32_bf16 v[20:23], v[112:115], v[76:79], v[20:23]
    v_mfma_f32_16x16x32_bf16 v[20:23], v[116:119], v[80:83], v[20:23]
    v_mfma_f32_16x16x32_bf16 v[20:23], v[120:123], v[84:87], v[20:23]
    v_mfma_f32_16x16x32_bf16 v[20:23], v[124:127], v[88:91], v[20:23]
    v_mfma_f32_16x16x32_bf16 v[20:23], v[128:131], v[92:95], v[20:23]
    s_lshl_b32 s36, s29, 1
    s_lshr_b32 s37, s28, 2
    s_add_u32 s36, s36, s37
    s_mul_i32 s36, s36, 28672
    s_lshl_b32 s37, s30, 8
    s_add_u32 s36, s36, s37
    s_and_b32 s37, s28, 3
    s_lshl_b32 s37, s37, 6
    s_add_u32 s36, s36, s37
    s_add_u32 s36, s36, 58720256
    v_mul_u32_u24 v10, 14336, v10
    v_lshl_add_u32 v10, v13, 4, v10
    s_mov_b32 exec_lo, 0x00030003
    s_mov_b32 exec_hi, 0x00030003
    buffer_store_dwordx4 v[20:23], v10, s[24:27], s36 offen
L_ffn1_end:
    s_endpgm
.globl ffn2_kernel
.p2align 8
.type ffn2_kernel,@function
ffn2_kernel:
    s_cmp_ge_u32 s2, 256
    s_cbranch_scc1 L_ffn2_end
    s_load_dwordx4 s[44:47], s[0:1], 80
    s_load_dwordx2 s[54:55], s[0:1], 104
    v_and_b32 v1, 63, v0
    v_lshrrev_b32 v16, 6, v0
    s_nop 0
    v_readfirstlane_b32 s28, v16
    s_waitcnt lgkmcnt(0)
    s_mov_b32 s24, s54
    s_and_b32 s25, s55, 0xffff
    s_mov_b32 s26, 67108864
    s_mov_b32 s27, 0x20000
    s_mov_b32 s4, s44
    s_and_b32 s5, s45, 0xffff
    s_mov_b32 s6, 7340032
    s_mov_b32 s7, 0x20000
    s_and_b32 s30, s2, 15
    s_lshr_b32 s29, s2, 4
    v_and_b32 v10, 1, v1
    v_lshrrev_b32 v13, 4, v1
    s_cmp_eq_u32 s28, 7
    s_cbranch_scc1 L_ffn2_w7
    s_mul_i32 s38, s29, 224
    s_lshl_b32 s39, s30, 7
    v_lshrrev_b32 v7, 3, v1
    s_lshl_b32 s36, s28, 5
    s_add_u32 s36, s36, s38
    v_add_u32 v7, s36, v7
    v_mul_u32_u24 v7, 2048, v7
    v_add_u32 v7, s39, v7
    v_bfe_u32 v8, v1, 4, 1
    v_lshlrev_b32 v8, 1, v8
    v_and_b32 v9, 7, v1
    v_xor_b32 v8, v8, v9
    v_lshl_add_u32 v6, v8, 4, v7
    v_xor_b32 v8, 4, v8
    v_lshl_add_u32 v7, v8, 4, v7
    v_add_u32 v7, 15360, v7
    v_add_u32 v8, 30720, v6
    v_add_u32 v9, 30720, v7
    s_lshl_b32 s33, s28, 12
    s_mov_b32 m0, s33
    s_nop 0
    buffer_load_dwordx4 v6, s[4:7], 0 offen offset:0 lds
    buffer_load_dwordx4 v7, s[4:7], 0 offen offset:1024 lds
    buffer_load_dwordx4 v8, s[4:7], 0 offen offset:2048 lds
    buffer_load_dwordx4 v9, s[4:7], 0 offen offset:3072 lds
    s_lshl_b32 s36, s28, 5
    s_add_u32 s36, s36, s38
    s_lshl_b32 s36, s36, 2
    s_add_u32 s36, s36, 58720256
    v_mul_u32_u24 v11, 14336, v10
    v_lshl_add_u32 v11, v13, 5, v11
    buffer_load_dwordx4 v[64:67], v11, s[24:27], s36 offen offset:0
    buffer_load_dwordx4 v[68:71], v11, s[24:27], s36 offen offset:16
    s_add_u32 s36, s36, 28672
    buffer_load_dwordx4 v[72:75], v11, s[24:27], s36 offen offset:0
    buffer_load_dwordx4 v[76:79], v11, s[24:27], s36 offen offset:16
    s_add_u32 s36, s36, 28672
    buffer_load_dwordx4 v[80:83], v11, s[24:27], s36 offen offset:0
    buffer_load_dwordx4 v[84:87], v11, s[24:27], s36 offen offset:16
    s_add_u32 s36, s36, 28672
    buffer_load_dwordx4 v[88:91], v11, s[24:27], s36 offen offset:0
    buffer_load_dwordx4 v[92:95], v11, s[24:27], s36 offen offset:16
    s_add_u32 s36, s36, 28672
    buffer_load_dwordx4 v[96:99], v11, s[24:27], s36 offen offset:0
    buffer_load_dwordx4 v[100:103], v11, s[24:27], s36 offen offset:16
    s_add_u32 s36, s36, 28672
    buffer_load_dwordx4 v[104:107], v11, s[24:27], s36 offen offset:0
    buffer_load_dwordx4 v[108:111], v11, s[24:27], s36 offen offset:16
    s_add_u32 s36, s36, 28672
    buffer_load_dwordx4 v[112:115], v11, s[24:27], s36 offen offset:0
    buffer_load_dwordx4 v[116:119], v11, s[24:27], s36 offen offset:16
    s_add_u32 s36, s36, 28672
    buffer_load_dwordx4 v[120:123], v11, s[24:27], s36 offen offset:0
    buffer_load_dwordx4 v[124:127], v11, s[24:27], s36 offen offset:16
    v_lshrrev_b32 v16, 4, v1
    v_bfe_u32 v14, v1, 2, 2
    v_lshl_add_u32 v14, v16, 3, v14
    v_lshlrev_b32 v14, 7, v14
    v_and_b32 v15, 3, v1
    v_lshl_add_u32 v14, v15, 3, v14
    v_bfe_u32 v15, v1, 3, 2
    v_add_u32 v14, s33, v14
    s_waitcnt vmcnt(0)
    v_xor_b32 v16, 0, v15
    v_lshl_add_u32 v16, v16, 5, v14
    ds_read_b64_tr_b16 v[40:41], v16 offset:0
    ds_read_b64_tr_b16 v[42:43], v16 offset:512
    v_xor_b32 v16, 1, v15
    v_lshl_add_u32 v16, v16, 5, v14
    ds_read_b64_tr_b16 v[44:45], v16 offset:0
    ds_read_b64_tr_b16 v[46:47], v16 offset:512
    v_xor_b32 v16, 2, v15
    v_lshl_add_u32 v16, v16, 5, v14
    ds_read_b64_tr_b16 v[48:49], v16 offset:0
    ds_read_b64_tr_b16 v[50:51], v16 offset:512
    v_xor_b32 v16, 3, v15
    v_lshl_add_u32 v16, v16, 5, v14
    ds_read_b64_tr_b16 v[52:53], v16 offset:0
    ds_read_b64_tr_b16 v[54:55], v16 offset:512
    v_add_f32 v64, v64, v80
    v_add_f32 v64, v64, v96
    v_add_f32 v64, v64, v112
    v_add_f32 v65, v65, v81
    v_add_f32 v65, v65, v97
    v_add_f32 v65, v65, v113
    v_add_f32 v66, v66, v82
    v_add_f32 v66, v66, v98
    v_add_f32 v66, v66, v114
    v_add_f32 v67, v67, v83
    v_add_f32 v67, v67, v99
    v_add_f32 v67, v67, v115
    v_add_f32 v68, v68, v84
    v_add_f32 v68, v68, v100
    v_add_f32 v68, v68, v116
    v_add_f32 v69, v69, v85
    v_add_f32 v69, v69, v101
    v_add_f32 v69, v69, v117
    v_add_f32 v70, v70, v86
    v_add_f32 v70, v70, v102
    v_add_f32 v70, v70, v118
    v_add_f32 v71, v71, v87
    v_add_f32 v71, v71, v103
    v_add_f32 v71, v71, v119
    v_add_f32 v72, v72, v88
    v_add_f32 v72, v72, v104
    v_add_f32 v72, v72, v120
    v_add_f32 v73, v73, v89
    v_add_f32 v73, v73, v105
    v_add_f32 v73, v73, v121
    v_add_f32 v74, v74, v90
    v_add_f32 v74, v74, v106
    v_add_f32 v74, v74, v122
    v_add_f32 v75, v75, v91
    v_add_f32 v75, v75, v107
    v_add_f32 v75, v75, v123
    v_add_f32 v76, v76, v92
    v_add_f32 v76, v76, v108
    v_add_f32 v76, v76, v124
    v_add_f32 v77, v77, v93
    v_add_f32 v77, v77, v109
    v_add_f32 v77, v77, v125
    v_add_f32 v78, v78, v94
    v_add_f32 v78, v78, v110
    v_add_f32 v78, v78, v126
    v_add_f32 v79, v79, v95
    v_add_f32 v79, v79, v111
    v_add_f32 v79, v79, v127
    v_cvt_pk_bf16_f32 v64, v64, v64
    v_lshlrev_b32 v64, 16, v64
    v_cvt_pk_bf16_f32 v72, v72, v72
    v_lshlrev_b32 v72, 16, v72
    v_mul_f32 v17, 0xbfb8aa3b, v64
    v_exp_f32 v17, v17
    s_nop 0
    v_add_f32 v17, 1.0, v17
    v_rcp_f32 v17, v17
    s_nop 0
    v_mul_f32 v64, v64, v17
    v_cvt_pk_bf16_f32 v64, v64, v64
    v_lshlrev_b32 v64, 16, v64
    v_mul_f32 v64, v64, v72
    v_cvt_pk_bf16_f32 v65, v65, v65
    v_lshlrev_b32 v65, 16, v65
    v_cvt_pk_bf16_f32 v73, v73, v73
    v_lshlrev_b32 v73, 16, v73
    v_mul_f32 v17, 0xbfb8aa3b, v65
    v_exp_f32 v17, v17
    s_nop 0
    v_add_f32 v17, 1.0, v17
    v_rcp_f32 v17, v17
    s_nop 0
    v_mul_f32 v65, v65, v17
    v_cvt_pk_bf16_f32 v65, v65, v65
    v_lshlrev_b32 v65, 16, v65
    v_mul_f32 v65, v65, v73
    v_cvt_pk_bf16_f32 v66, v66, v66
    v_lshlrev_b32 v66, 16, v66
    v_cvt_pk_bf16_f32 v74, v74, v74
    v_lshlrev_b32 v74, 16, v74
    v_mul_f32 v17, 0xbfb8aa3b, v66
    v_exp_f32 v17, v17
    s_nop 0
    v_add_f32 v17, 1.0, v17
    v_rcp_f32 v17, v17
    s_nop 0
    v_mul_f32 v66, v66, v17
    v_cvt_pk_bf16_f32 v66, v66, v66
    v_lshlrev_b32 v66, 16, v66
    v_mul_f32 v66, v66, v74
    v_cvt_pk_bf16_f32 v67, v67, v67
    v_lshlrev_b32 v67, 16, v67
    v_cvt_pk_bf16_f32 v75, v75, v75
    v_lshlrev_b32 v75, 16, v75
    v_mul_f32 v17, 0xbfb8aa3b, v67
    v_exp_f32 v17, v17
    s_nop 0
    v_add_f32 v17, 1.0, v17
    v_rcp_f32 v17, v17
    s_nop 0
    v_mul_f32 v67, v67, v17
    v_cvt_pk_bf16_f32 v67, v67, v67
    v_lshlrev_b32 v67, 16, v67
    v_mul_f32 v67, v67, v75
    v_cvt_pk_bf16_f32 v68, v68, v68
    v_lshlrev_b32 v68, 16, v68
    v_cvt_pk_bf16_f32 v76, v76, v76
    v_lshlrev_b32 v76, 16, v76
    v_mul_f32 v17, 0xbfb8aa3b, v68
    v_exp_f32 v17, v17
    s_nop 0
    v_add_f32 v17, 1.0, v17
    v_rcp_f32 v17, v17
    s_nop 0
    v_mul_f32 v68, v68, v17
    v_cvt_pk_bf16_f32 v68, v68, v68
    v_lshlrev_b32 v68, 16, v68
    v_mul_f32 v68, v68, v76
    v_cvt_pk_bf16_f32 v69, v69, v69
    v_lshlrev_b32 v69, 16, v69
    v_cvt_pk_bf16_f32 v77, v77, v77
    v_lshlrev_b32 v77, 16, v77
    v_mul_f32 v17, 0xbfb8aa3b, v69
    v_exp_f32 v17, v17
    s_nop 0
    v_add_f32 v17, 1.0, v17
    v_rcp_f32 v17, v17
    s_nop 0
    v_mul_f32 v69, v69, v17
    v_cvt_pk_bf16_f32 v69, v69, v69
    v_lshlrev_b32 v69, 16, v69
    v_mul_f32 v69, v69, v77
    v_cvt_pk_bf16_f32 v70, v70, v70
    v_lshlrev_b32 v70, 16, v70
    v_cvt_pk_bf16_f32 v78, v78, v78
    v_lshlrev_b32 v78, 16, v78
    v_mul_f32 v17, 0xbfb8aa3b, v70
    v_exp_f32 v17, v17
    s_nop 0
    v_add_f32 v17, 1.0, v17
    v_rcp_f32 v17, v17
    s_nop 0
    v_mul_f32 v70, v70, v17
    v_cvt_pk_bf16_f32 v70, v70, v70
    v_lshlrev_b32 v70, 16, v70
    v_mul_f32 v70, v70, v78
    v_cvt_pk_bf16_f32 v71, v71, v71
    v_lshlrev_b32 v71, 16, v71
    v_cvt_pk_bf16_f32 v79, v79, v79
    v_lshlrev_b32 v79, 16, v79
    v_mul_f32 v17, 0xbfb8aa3b, v71
    v_exp_f32 v17, v17
    s_nop 0
    v_add_f32 v17, 1.0, v17
    v_rcp_f32 v17, v17
    s_nop 0
    v_mul_f32 v71, v71, v17
    v_cvt_pk_bf16_f32 v71, v71, v71
    v_lshlrev_b32 v71, 16, v71
    v_mul_f32 v71, v71, v79
    v_cvt_pk_bf16_f32 v36, v64, v65
    v_cvt_pk_bf16_f32 v37, v66, v67
    v_cvt_pk_bf16_f32 v38, v68, v69
    v_cvt_pk_bf16_f32 v39, v70, v71
    s_waitcnt lgkmcnt(0)
    s_nop 0
    v_mfma_f32_16x16x32_bf16 v[20:23], v[40:43], v[36:39], 0
    v_mfma_f32_16x16x32_bf16 v[24:27], v[44:47], v[36:39], 0
    v_mfma_f32_16x16x32_bf16 v[28:31], v[48:51], v[36:39], 0
    v_mfma_f32_16x16x32_bf16 v[32:35], v[52:55], v[36:39], 0
    s_add_u32 s36, s33, 32768
    v_lshl_add_u32 v16, v1, 4, s36
    s_nop 6
    ds_write_b128 v16, v[20:23] offset:0
    ds_write_b128 v16, v[24:27] offset:1024
    ds_write_b128 v16, v[28:31] offset:2048
    ds_write_b128 v16, v[32:35] offset:3072
    s_waitcnt lgkmcnt(0)
    s_branch L_ffn2_join
L_ffn2_w7:
    s_cmp_lg_u32 s2, 0
    s_cbranch_scc1 L_ffn2_join
    v_lshlrev_b32 v96, 4, v1
    s_mov_b32 s36, 4276224
    s_mov_b32 s37, 4280320
    buffer_load_dwordx4 v[64:67], v96, s[24:27], s36 offen offset:0
    buffer_load_dwordx4 v[68:71], v96, s[24:27], s36 offen offset:1024
    buffer_load_dwordx4 v[72:75], v96, s[24:27], s36 offen offset:2048
    buffer_load_dwordx4 v[76:79], v96, s[24:27], s36 offen offset:3072
    buffer_load_dwordx4 v[80:83], v96, s[24:27], s37 offen offset:0
    buffer_load_dwordx4 v[84:87], v96, s[24:27], s37 offen offset:1024
    buffer_load_dwordx4 v[88:91], v96, s[24:27], s37 offen offset:2048
    buffer_load_dwordx4 v[92:95], v96, s[24:27], s37 offen offset:3072
    s_waitcnt vmcnt(0)
    v_max_u32 v96, v64, v65
    v_min_u32 v97, v64, v65
    v_med3_u32 v97, v96, v97, v66
    v_max_u32 v96, v96, v66
    v_med3_u32 v97, v96, v97, v67
    v_max_u32 v96, v96, v67
    v_med3_u32 v97, v96, v97, v68
    v_max_u32 v96, v96, v68
    v_med3_u32 v97, v96, v97, v69
    v_max_u32 v96, v96, v69
    v_med3_u32 v97, v96, v97, v70
    v_max_u32 v96, v96, v70
    v_med3_u32 v97, v96, v97, v71
    v_max_u32 v96, v96, v71
    v_med3_u32 v97, v96, v97, v72
    v_max_u32 v96, v96, v72
    v_med3_u32 v97, v96, v97, v73
    v_max_u32 v96, v96, v73
    v_med3_u32 v97, v96, v97, v74
    v_max_u32 v96, v96, v74
    v_med3_u32 v97, v96, v97, v75
    v_max_u32 v96, v96, v75
    v_med3_u32 v97, v96, v97, v76
    v_max_u32 v96, v96, v76
    v_med3_u32 v97, v96, v97, v77
    v_max_u32 v96, v96, v77
    v_med3_u32 v97, v96, v97, v78
    v_max_u32 v96, v96, v78
    v_med3_u32 v97, v96, v97, v79
    v_max_u32 v96, v96, v79
    v_med3_u32 v97, v96, v97, v80
    v_max_u32 v96, v96, v80
    v_med3_u32 v97, v96, v97, v81
    v_max_u32 v96, v96, v81
    v_med3_u32 v97, v96, v97, v82
    v_max_u32 v96, v96, v82
    v_med3_u32 v97, v96, v97, v83
    v_max_u32 v96, v96, v83
    v_med3_u32 v97, v96, v97, v84
    v_max_u32 v96, v96, v84
    v_med3_u32 v97, v96, v97, v85
    v_max_u32 v96, v96, v85
    v_med3_u32 v97, v96, v97, v86
    v_max_u32 v96, v96, v86
    v_med3_u32 v97, v96, v97, v87
    v_max_u32 v96, v96, v87
    v_med3_u32 v97, v96, v97, v88
    v_max_u32 v96, v96, v88
    v_med3_u32 v97, v96, v97, v89
    v_max_u32 v96, v96, v89
    v_med3_u32 v97, v96, v97, v90
    v_max_u32 v96, v96, v90
    v_med3_u32 v97, v96, v97, v91
    v_max_u32 v96, v96, v91
    v_med3_u32 v97, v96, v97, v92
    v_max_u32 v96, v96, v92
    v_med3_u32 v97, v96, v97, v93
    v_max_u32 v96, v96, v93
    v_med3_u32 v97, v96, v97, v94
    v_max_u32 v96, v96, v94
    v_med3_u32 v97, v96, v97, v95
    v_max_u32 v96, v96, v95
    v_mov_b32 v98, v96
    s_nop 1
    v_max_u32_dpp v98, v98, v98 quad_perm:[1,0,3,2] row_mask:0xf bank_mask:0xf
    s_nop 1
    v_max_u32_dpp v98, v98, v98 quad_perm:[2,3,0,1] row_mask:0xf bank_mask:0xf
    s_nop 1
    v_max_u32_dpp v98, v98, v98 row_half_mirror row_mask:0xf bank_mask:0xf
    s_nop 1
    v_max_u32_dpp v98, v98, v98 row_mirror row_mask:0xf bank_mask:0xf
    s_nop 0
    v_readlane_b32 s36, v98, 0
    v_readlane_b32 s37, v98, 16
    v_readlane_b32 s38, v98, 32
    v_readlane_b32 s39, v98, 48
    s_max_u32 s36, s36, s37
    s_max_u32 s38, s38, s39
    s_max_u32 s36, s36, s38
    s_mov_b32 s58, s36
    v_cmp_eq_u32 vcc, s58, v96
    s_nop 1
    v_cndmask_b32 v98, v96, v97, vcc
    s_nop 1
    v_max_u32_dpp v98, v98, v98 quad_perm:[1,0,3,2] row_mask:0xf bank_mask:0xf
    s_nop 1
    v_max_u32_dpp v98, v98, v98 quad_perm:[2,3,0,1] row_mask:0xf bank_mask:0xf
    s_nop 1
    v_max_u32_dpp v98, v98, v98 row_half_mirror row_mask:0xf bank_mask:0xf
    s_nop 1
    v_max_u32_dpp v98, v98, v98 row_mirror row_mask:0xf bank_mask:0xf
    s_nop 0
    v_readlane_b32 s36, v98, 0
    v_readlane_b32 s37, v98, 16
    v_readlane_b32 s38, v98, 32
    v_readlane_b32 s39, v98, 48
    s_max_u32 s36, s36, s37
    s_max_u32 s38, s38, s39
    s_max_u32 s36, s36, s38
    s_mov_b32 s59, s36
    s_and_b32 s36, s58, 0xffff
    s_sub_u32 s56, 0xffff, s36
    s_and_b32 s36, s59, 0xffff
    s_sub_u32 s57, 0xffff, s36
    v_mov_b32 v20, s56
    v_mov_b32 v21, s57
    s_and_b32 s36, s58, 0xffff0000
    s_cmp_lt_i32 s36, 0
    s_cselect_b32 s37, 0x80000000, -1
    s_xor_b32 s36, s36, s37
    s_and_b32 s36, s36, 0xffff0000
    v_mov_b32 v22, s36
    v_mul_f32 v22, 0xbfb8aa3b, v22
    v_exp_f32 v22, v22
    s_nop 0
    v_add_f32 v22, 1.0, v22
    v_rcp_f32 v22, v22
    s_nop 0
    v_cvt_pk_bf16_f32 v22, v22, v22
    v_lshlrev_b32 v22, 16, v22
    s_and_b32 s36, s59, 0xffff0000
    s_cmp_lt_i32 s36, 0
    s_cselect_b32 s37, 0x80000000, -1
    s_xor_b32 s36, s36, s37
    s_and_b32 s36, s36, 0xffff0000
    v_mov_b32 v23, s36
    v_mul_f32 v23, 0xbfb8aa3b, v23
    v_exp_f32 v23, v23
    s_nop 0
    v_add_f32 v23, 1.0, v23
    v_rcp_f32 v23, v23
    s_nop 0
    v_cvt_pk_bf16_f32 v23, v23, v23
    v_lshlrev_b32 v23, 16, v23
    v_mov_b32 v16, 0
    s_mov_b32 s36, 60817408
    s_mov_b64 exec, 1
    buffer_store_dwordx4 v[20:23], v16, s[24:27], s36 offen
    s_mov_b64 exec, -1
L_ffn2_join:
    s_barrier
    s_cmp_ge_u32 s28, 4
    s_cbranch_scc1 L_ffn2_end
    s_lshl_b32 s36, s28, 10
    s_add_u32 s36, s36, 32768
    v_lshl_add_u32 v16, v1, 4, s36
    ds_read_b128 v[64:67], v16 offset:0
    ds_read_b128 v[68:71], v16 offset:4096
    ds_read_b128 v[72:75], v16 offset:8192
    ds_read_b128 v[76:79], v16 offset:12288
    ds_read_b128 v[80:83], v16 offset:16384
    ds_read_b128 v[84:87], v16 offset:20480
    ds_read_b128 v[88:91], v16 offset:24576
    s_waitcnt lgkmcnt(0)
    v_add_f32 v64, v64, v68
    v_add_f32 v65, v65, v69
    v_add_f32 v66, v66, v70
    v_add_f32 v67, v67, v71
    v_add_f32 v64, v64, v72
    v_add_f32 v65, v65, v73
    v_add_f32 v66, v66, v74
    v_add_f32 v67, v67, v75
    v_add_f32 v64, v64, v76
    v_add_f32 v65, v65, v77
    v_add_f32 v66, v66, v78
    v_add_f32 v67, v67, v79
    v_add_f32 v64, v64, v80
    v_add_f32 v65, v65, v81
    v_add_f32 v66, v66, v82
    v_add_f32 v67, v67, v83
    v_add_f32 v64, v64, v84
    v_add_f32 v65, v65, v85
    v_add_f32 v66, v66, v86
    v_add_f32 v67, v67, v87
    v_add_f32 v64, v64, v88
    v_add_f32 v65, v65, v89
    v_add_f32 v66, v66, v90
    v_add_f32 v67, v67, v91
    s_lshl_b32 s36, s29, 13
    s_lshl_b32 s37, s30, 8
    s_add_u32 s36, s36, s37
    s_lshl_b32 s37, s28, 6
    s_add_u32 s36, s36, s37
    s_add_u32 s36, s36, 59768832
    v_lshlrev_b32 v10, 12, v10
    v_lshl_add_u32 v10, v13, 4, v10
    s_mov_b32 exec_lo, 0x00030003
    s_mov_b32 exec_hi, 0x00030003
    buffer_store_dwordx4 v[64:67], v10, s[24:27], s36 offen
L_ffn2_end:
    s_endpgm
.globl attn_kernel
.p2align 8
.type attn_kernel,@function
attn_kernel:
    s_cmp_ge_u32 s2, 256
    s_cbranch_scc1 L_attn_end
    s_load_dwordx2 s[50:51], s[0:1], 16
    s_load_dwordx2 s[54:55], s[0:1], 104
    v_and_b32 v1, 63, v0
    v_lshrrev_b32 v16, 6, v0
    s_and_b32 s29, s2, 7
    v_readfirstlane_b32 s28, v16
    s_lshl_b32 s29, s29, 2
    s_bfe_u32 s36, s2, 0x20003
    s_add_u32 s29, s29, s36
    s_lshr_b32 s30, s2, 5
    s_and_b32 s36, s28, 3
    s_sub_u32 s37, 15, s30
    s_cmp_lt_u32 s28, 4
    s_cselect_b32 s37, s37, s30
    s_lshl_b32 s37, s37, 2
    s_add_u32 s37, s37, s36
    s_lshl_b32 s37, s37, 16
    v_lshl_add_u32 v2, v1, 4, s37
    v_add_u32 v3, 32768, v2
    v_lshrrev_b32 v18, 4, v1
    s_lshl_b32 s37, s28, 4
    v_add_u32 v19, s37, v18
    v_lshlrev_b32 v19, 13, v19
    s_lshl_b32 s37, s29, 8
    v_add_u32 v19, s37, v19
    v_and_b32 v20, 15, v1
    v_lshlrev_b32 v21, 1, v18
    v_xor_b32 v21, v20, v21
    v_lshl_add_u32 v6, v21, 4, v19
    v_add_u32 v7, 31744, v6
    v_xor_b32 v21, 8, v21
    v_lshl_add_u32 v8, v21, 4, v19
    v_add_u32 v8, 63488, v8
    v_add_u32 v9, 31744, v8
    s_lshl_b32 s33, s28, 12
    s_add_u32 s33, s33, 98304
    s_mov_b32 s31, 0
    s_mov_b32 s32, 0
    s_waitcnt lgkmcnt(0)
    s_mov_b32 s4, s54
    s_and_b32 s5, s55, 0xffff
    s_mov_b32 s6, 4194304
    s_mov_b32 s7, 0x20000
    s_mov_b32 s8, s50
    s_and_b32 s9, s51, 0xffff
    s_mov_b32 s10, 8388608
    s_mov_b32 s11, 0x20000
    s_mov_b32 s34, s33
    s_add_u32 m0, s34, 0
    s_nop 0
    buffer_load_dwordx4 v6, s[8:11], s32 offen offset:0 lds
    buffer_load_dwordx4 v7, s[8:11], s32 offen offset:1024 lds
    buffer_load_dwordx4 v8, s[8:11], s32 offen offset:2048 lds
    buffer_load_dwordx4 v9, s[8:11], s32 offen offset:3072 lds
    s_add_u32 s32, s32, 1048576
    buffer_load_dwordx4 v[128:131], v2, s[4:7], s31 offen offset:0
    buffer_load_dwordx4 v[132:135], v3, s[4:7], s31 offen offset:0
    buffer_load_dwordx4 v[136:139], v2, s[4:7], s31 offen offset:1024
    buffer_load_dwordx4 v[140:143], v3, s[4:7], s31 offen offset:1024
    buffer_load_dwordx4 v[144:147], v2, s[4:7], s31 offen offset:2048
    buffer_load_dwordx4 v[148:151], v3, s[4:7], s31 offen offset:2048
    buffer_load_dwordx4 v[152:155], v2, s[4:7], s31 offen offset:3072
    buffer_load_dwordx4 v[156:159], v3, s[4:7], s31 offen offset:3072
    s_add_u32 s31, s31, 4096
    s_add_u32 m0, s34, 32768
    s_nop 0
    buffer_load_dwordx4 v6, s[8:11], s32 offen offset:0 lds
    buffer_load_dwordx4 v7, s[8:11], s32 offen offset:1024 lds
    buffer_load_dwordx4 v8, s[8:11], s32 offen offset:2048 lds
    buffer_load_dwordx4 v9, s[8:11], s32 offen offset:3072 lds
    s_add_u32 s32, s32, 1048576
    buffer_load_dwordx4 v[160:163], v2, s[4:7], s31 offen offset:0
    buffer_load_dwordx4 v[164:167], v3, s[4:7], s31 offen offset:0
    buffer_load_dwordx4 v[168:171], v2, s[4:7], s31 offen offset:1024
    buffer_load_dwordx4 v[172:175], v3, s[4:7], s31 offen offset:1024
    buffer_load_dwordx4 v[176:179], v2, s[4:7], s31 offen offset:2048
    buffer_load_dwordx4 v[180:183], v3, s[4:7], s31 offen offset:2048
    s_add_u32 s12, s54, 8388608
    s_addc_u32 s13, s55, 0
    s_and_b32 s13, s13, 0xffff
    s_mov_b32 s14, 33554432
    s_mov_b32 s15, 0x20000
    s_add_u32 s16, s54, 41943040
    s_addc_u32 s17, s55, 0
    s_and_b32 s17, s17, 0xffff
    s_mov_b32 s18, 16777216
    s_mov_b32 s19, 0x20000
    v_lshrrev_b32 v20, 2, v20
    v_lshl_add_u32 v19, v18, 3, v20
    v_lshlrev_b32 v19, 8, v19
    v_add_u32 v19, 98304, v19
    v_and_b32 v21, 3, v1
    v_lshl_add_u32 v19, v21, 3, v19
    v_and_b32 v21, 1, v18
    v_lshl_add_u32 v20, v21, 2, v20
    v_xor_b32 v21, 0, v20
    v_lshl_add_u32 v10, v21, 5, v19
    v_xor_b32 v21, 1, v20
    v_lshl_add_u32 v11, v21, 5, v19
    v_xor_b32 v21, 2, v20
    v_lshl_add_u32 v12, v21, 5, v19
    v_xor_b32 v21, 3, v20
    v_lshl_add_u32 v13, v21, 5, v19
    v_xor_b32 v21, 4, v20
    v_lshl_add_u32 v14, v21, 5, v19
    v_xor_b32 v21, 5, v20
    v_lshl_add_u32 v15, v21, 5, v19
    v_xor_b32 v21, 6, v20
    v_lshl_add_u32 v16, v21, 5, v19
    v_xor_b32 v21, 7, v20
    v_lshl_add_u32 v17, v21, 5, v19
    s_lshl_b32 s43, s28, 12
    v_lshl_add_u32 v4, v1, 4, s43
    s_add_u32 s44, s43, 65536
    s_lshl_b32 s45, s29, 20
    v_mov_b32 v192, 0
    v_mov_b32 v193, 0
    v_mov_b32 v194, 0
    v_mov_b32 v195, 0
    v_mov_b32 v196, 0
    v_mov_b32 v197, 0
    v_mov_b32 v198, 0
    v_mov_b32 v199, 0
    v_mov_b32 v200, 0
    v_mov_b32 v201, 0
    v_mov_b32 v202, 0
    v_mov_b32 v203, 0
    v_mov_b32 v204, 0
    v_mov_b32 v205, 0
    v_mov_b32 v206, 0
    v_mov_b32 v207, 0
    v_mov_b32 v208, 0
    v_mov_b32 v209, 0
    v_mov_b32 v210, 0
    v_mov_b32 v211, 0
    v_mov_b32 v212, 0
    v_mov_b32 v213, 0
    v_mov_b32 v214, 0
    v_mov_b32 v215, 0
    v_mov_b32 v216, 0
    v_mov_b32 v217, 0
    v_mov_b32 v218, 0
    v_mov_b32 v219, 0
    v_mov_b32 v220, 0
    v_mov_b32 v221, 0
    v_mov_b32 v222, 0
    v_mov_b32 v223, 0
    v_mov_b32 v224, 0
    v_mov_b32 v225, 0
    v_mov_b32 v226, 0
    v_mov_b32 v227, 0
    v_mov_b32 v228, 0
    v_mov_b32 v229, 0
    v_mov_b32 v230, 0
    v_mov_b32 v231, 0
    v_mov_b32 v232, 0
    v_mov_b32 v233, 0
    v_mov_b32 v234, 0
    v_mov_b32 v235, 0
    v_mov_b32 v236, 0
    v_mov_b32 v237, 0
    v_mov_b32 v238, 0
    v_mov_b32 v239, 0
    v_mov_b32 v240, 0
    v_mov_b32 v241, 0
    v_mov_b32 v242, 0
    v_mov_b32 v243, 0
    v_mov_b32 v244, 0
    v_mov_b32 v245, 0
    v_mov_b32 v246, 0
    v_mov_b32 v247, 0
    v_mov_b32 v248, 0
    v_mov_b32 v249, 0
    v_mov_b32 v250, 0
    v_mov_b32 v251, 0
    v_mov_b32 v252, 0
    v_mov_b32 v253, 0
    v_mov_b32 v254, 0
    v_mov_b32 v255, 0
    s_waitcnt vmcnt(18)
    s_barrier
    ds_read_b64_tr_b16 v[64:65], v10 offset:0
    ds_read_b64_tr_b16 v[66:67], v10 offset:1024
    ds_read_b64_tr_b16 v[68:69], v11 offset:0
    ds_read_b64_tr_b16 v[70:71], v11 offset:1024
    ds_read_b64_tr_b16 v[72:73], v12 offset:0
    ds_read_b64_tr_b16 v[74:75], v12 offset:1024
    ds_read_b64_tr_b16 v[76:77], v13 offset:0
    ds_read_b64_tr_b16 v[78:79], v13 offset:1024
    ds_read_b64_tr_b16 v[80:81], v14 offset:0
    ds_read_b64_tr_b16 v[82:83], v14 offset:1024
    ds_read_b64_tr_b16 v[84:85], v15 offset:0
    ds_read_b64_tr_b16 v[86:87], v15 offset:1024
    ds_read_b64_tr_b16 v[88:89], v16 offset:0
    ds_read_b64_tr_b16 v[90:91], v16 offset:1024
    ds_read_b64_tr_b16 v[92:93], v17 offset:0
    ds_read_b64_tr_b16 v[94:95], v17 offset:1024
    s_mov_b32 s35, 0
    .p2align 6
L_p2_loop:
    s_cmp_lg_u32 s35, 3
    s_cbranch_scc1 L_p2_nokv
    s_mov_b32 m0, s43
    s_add_u32 s46, s45, 65536
    buffer_load_dwordx4 v4, s[12:15], s45 offen offset:0 lds
    buffer_load_dwordx4 v4, s[12:15], s45 offen offset:1024 lds
    buffer_load_dwordx4 v4, s[12:15], s45 offen offset:2048 lds
    buffer_load_dwordx4 v4, s[12:15], s45 offen offset:3072 lds
    s_add_u32 m0, s43, 32768
    s_add_u32 s47, s45, 32768
    buffer_load_dwordx4 v4, s[12:15], s46 offen offset:0 lds
    buffer_load_dwordx4 v4, s[12:15], s46 offen offset:1024 lds
    buffer_load_dwordx4 v4, s[12:15], s46 offen offset:2048 lds
    buffer_load_dwordx4 v4, s[12:15], s46 offen offset:3072 lds
    s_mov_b32 m0, s44
    s_nop 0
    buffer_load_dwordx4 v4, s[12:15], s47 offen offset:0 lds
    buffer_load_dwordx4 v4, s[12:15], s47 offen offset:1024 lds
    buffer_load_dwordx4 v4, s[12:15], s47 offen offset:2048 lds
    buffer_load_dwordx4 v4, s[12:15], s47 offen offset:3072 lds
L_p2_nokv:
    s_waitcnt lgkmcnt(0)
    s_waitcnt vmcnt(16)
    v_mfma_f32_16x16x32_bf16 v[192:195], v[64:67], v[128:131], v[192:195]
    ds_read_b64_tr_b16 v[96:97], v10 offset:8192
    ds_read_b64_tr_b16 v[98:99], v10 offset:9216
    v_mfma_f32_16x16x32_bf16 v[224:227], v[64:67], v[132:135], v[224:227]
    ds_read_b64_tr_b16 v[100:101], v11 offset:8192
    ds_read_b64_tr_b16 v[102:103], v11 offset:9216
    v_mfma_f32_16x16x32_bf16 v[196:199], v[68:71], v[128:131], v[196:199]
    ds_read_b64_tr_b16 v[104:105], v12 offset:8192
    ds_read_b64_tr_b16 v[106:107], v12 offset:9216
    v_mfma_f32_16x16x32_bf16 v[228:231], v[68:71], v[132:135], v[228:231]
    ds_read_b64_tr_b16 v[108:109], v13 offset:8192
    ds_read_b64_tr_b16 v[110:111], v13 offset:9216
    v_mfma_f32_16x16x32_bf16 v[200:203], v[72:75], v[128:131], v[200:203]
    ds_read_b64_tr_b16 v[112:113], v14 offset:8192
    ds_read_b64_tr_b16 v[114:115], v14 offset:9216
    v_mfma_f32_16x16x32_bf16 v[232:235], v[72:75], v[132:135], v[232:235]
    ds_read_b64_tr_b16 v[116:117], v15 offset:8192
    ds_read_b64_tr_b16 v[118:119], v15 offset:9216
    v_mfma_f32_16x16x32_bf16 v[204:207], v[76:79], v[128:131], v[204:207]
    ds_read_b64_tr_b16 v[120:121], v16 offset:8192
    ds_read_b64_tr_b16 v[122:123], v16 offset:9216
    v_mfma_f32_16x16x32_bf16 v[236:239], v[76:79], v[132:135], v[236:239]
    ds_read_b64_tr_b16 v[124:125], v17 offset:8192
    ds_read_b64_tr_b16 v[126:127], v17 offset:9216
    v_mfma_f32_16x16x32_bf16 v[208:211], v[80:83], v[128:131], v[208:211]
    buffer_load_dwordx4 v[184:187], v2, s[4:7], s31 offen offset:3072
    v_mfma_f32_16x16x32_bf16 v[240:243], v[80:83], v[132:135], v[240:243]
    buffer_load_dwordx4 v[188:191], v3, s[4:7], s31 offen offset:3072
    s_add_u32 s31, s31, 4096
    v_mfma_f32_16x16x32_bf16 v[212:215], v[84:87], v[128:131], v[212:215]
    s_cmp_lt_u32 s35, 3
    s_cselect_b32 s6, 4194304, 0
    s_cselect_b32 s10, 8388608, 0
    s_cselect_b32 s34, s33, 0x30000
    v_mfma_f32_16x16x32_bf16 v[244:247], v[84:87], v[132:135], v[244:247]
    v_mfma_f32_16x16x32_bf16 v[216:219], v[88:91], v[128:131], v[216:219]
    v_mfma_f32_16x16x32_bf16 v[248:251], v[88:91], v[132:135], v[248:251]
    v_mfma_f32_16x16x32_bf16 v[220:223], v[92:95], v[128:131], v[220:223]
    v_mfma_f32_16x16x32_bf16 v[252:255], v[92:95], v[132:135], v[252:255]
    s_waitcnt lgkmcnt(0)
    s_waitcnt vmcnt(16)
    v_mfma_f32_16x16x32_bf16 v[192:195], v[96:99], v[136:139], v[192:195]
    ds_read_b64_tr_b16 v[64:65], v10 offset:16384
    ds_read_b64_tr_b16 v[66:67], v10 offset:17408
    v_mfma_f32_16x16x32_bf16 v[224:227], v[96:99], v[140:143], v[224:227]
    ds_read_b64_tr_b16 v[68:69], v11 offset:16384
    ds_read_b64_tr_b16 v[70:71], v11 offset:17408
    v_mfma_f32_16x16x32_bf16 v[196:199], v[100:103], v[136:139], v[196:199]
    ds_read_b64_tr_b16 v[72:73], v12 offset:16384
    ds_read_b64_tr_b16 v[74:75], v12 offset:17408
    v_mfma_f32_16x16x32_bf16 v[228:231], v[100:103], v[140:143], v[228:231]
    ds_read_b64_tr_b16 v[76:77], v13 offset:16384
    ds_read_b64_tr_b16 v[78:79], v13 offset:17408
    v_mfma_f32_16x16x32_bf16 v[200:203], v[104:107], v[136:139], v[200:203]
    ds_read_b64_tr_b16 v[80:81], v14 offset:16384
    ds_read_b64_tr_b16 v[82:83], v14 offset:17408
    v_mfma_f32_16x16x32_bf16 v[232:235], v[104:107], v[140:143], v[232:235]
    ds_read_b64_tr_b16 v[84:85], v15 offset:16384
    ds_read_b64_tr_b16 v[86:87], v15 offset:17408
    v_mfma_f32_16x16x32_bf16 v[204:207], v[108:111], v[136:139], v[204:207]
    ds_read_b64_tr_b16 v[88:89], v16 offset:16384
    ds_read_b64_tr_b16 v[90:91], v16 offset:17408
    v_mfma_f32_16x16x32_bf16 v[236:239], v[108:111], v[140:143], v[236:239]
    ds_read_b64_tr_b16 v[92:93], v17 offset:16384
    ds_read_b64_tr_b16 v[94:95], v17 offset:17408
    v_mfma_f32_16x16x32_bf16 v[208:211], v[112:115], v[136:139], v[208:211]
    buffer_load_dwordx4 v[128:131], v2, s[4:7], s31 offen offset:0
    v_mfma_f32_16x16x32_bf16 v[240:243], v[112:115], v[140:143], v[240:243]
    buffer_load_dwordx4 v[132:135], v3, s[4:7], s31 offen offset:0
    v_mfma_f32_16x16x32_bf16 v[212:215], v[116:119], v[136:139], v[212:215]
    v_mfma_f32_16x16x32_bf16 v[244:247], v[116:119], v[140:143], v[244:247]
    v_mfma_f32_16x16x32_bf16 v[216:219], v[120:123], v[136:139], v[216:219]
    v_mfma_f32_16x16x32_bf16 v[248:251], v[120:123], v[140:143], v[248:251]
    v_mfma_f32_16x16x32_bf16 v[220:223], v[124:127], v[136:139], v[220:223]
    v_mfma_f32_16x16x32_bf16 v[252:255], v[124:127], v[140:143], v[252:255]
    s_waitcnt lgkmcnt(0)
    s_waitcnt vmcnt(16)
    v_mfma_f32_16x16x32_bf16 v[192:195], v[64:67], v[144:147], v[192:195]
    ds_read_b64_tr_b16 v[96:97], v10 offset:24576
    ds_read_b64_tr_b16 v[98:99], v10 offset:25600
    v_mfma_f32_16x16x32_bf16 v[224:227], v[64:67], v[148:151], v[224:227]
    ds_read_b64_tr_b16 v[100:101], v11 offset:24576
    ds_read_b64_tr_b16 v[102:103], v11 offset:25600
    v_mfma_f32_16x16x32_bf16 v[196:199], v[68:71], v[144:147], v[196:199]
    ds_read_b64_tr_b16 v[104:105], v12 offset:24576
    ds_read_b64_tr_b16 v[106:107], v12 offset:25600
    v_mfma_f32_16x16x32_bf16 v[228:231], v[68:71], v[148:151], v[228:231]
    ds_read_b64_tr_b16 v[108:109], v13 offset:24576
    ds_read_b64_tr_b16 v[110:111], v13 offset:25600
    v_mfma_f32_16x16x32_bf16 v[200:203], v[72:75], v[144:147], v[200:203]
    ds_read_b64_tr_b16 v[112:113], v14 offset:24576
    ds_read_b64_tr_b16 v[114:115], v14 offset:25600
    v_mfma_f32_16x16x32_bf16 v[232:235], v[72:75], v[148:151], v[232:235]
    ds_read_b64_tr_b16 v[116:117], v15 offset:24576
    ds_read_b64_tr_b16 v[118:119], v15 offset:25600
    v_mfma_f32_16x16x32_bf16 v[204:207], v[76:79], v[144:147], v[204:207]
    ds_read_b64_tr_b16 v[120:121], v16 offset:24576
    ds_read_b64_tr_b16 v[122:123], v16 offset:25600
    v_mfma_f32_16x16x32_bf16 v[236:239], v[76:79], v[148:151], v[236:239]
    ds_read_b64_tr_b16 v[124:125], v17 offset:24576
    ds_read_b64_tr_b16 v[126:127], v17 offset:25600
    v_mfma_f32_16x16x32_bf16 v[208:211], v[80:83], v[144:147], v[208:211]
    buffer_load_dwordx4 v[136:139], v2, s[4:7], s31 offen offset:1024
    v_mfma_f32_16x16x32_bf16 v[240:243], v[80:83], v[148:151], v[240:243]
    buffer_load_dwordx4 v[140:143], v3, s[4:7], s31 offen offset:1024
    v_mfma_f32_16x16x32_bf16 v[212:215], v[84:87], v[144:147], v[212:215]
    v_mfma_f32_16x16x32_bf16 v[244:247], v[84:87], v[148:151], v[244:247]
    v_mfma_f32_16x16x32_bf16 v[216:219], v[88:91], v[144:147], v[216:219]
    v_mfma_f32_16x16x32_bf16 v[248:251], v[88:91], v[148:151], v[248:251]
    v_mfma_f32_16x16x32_bf16 v[220:223], v[92:95], v[144:147], v[220:223]
    v_mfma_f32_16x16x32_bf16 v[252:255], v[92:95], v[148:151], v[252:255]
    s_waitcnt lgkmcnt(0)
    s_waitcnt vmcnt(6)
    s_barrier
    v_mfma_f32_16x16x32_bf16 v[192:195], v[96:99], v[152:155], v[192:195]
    ds_read_b64_tr_b16 v[64:65], v10 offset:32768
    ds_read_b64_tr_b16 v[66:67], v10 offset:33792
    v_mfma_f32_16x16x32_bf16 v[224:227], v[96:99], v[156:159], v[224:227]
    ds_read_b64_tr_b16 v[68:69], v11 offset:32768
    ds_read_b64_tr_b16 v[70:71], v11 offset:33792
    v_mfma_f32_16x16x32_bf16 v[196:199], v[100:103], v[152:155], v[196:199]
    ds_read_b64_tr_b16 v[72:73], v12 offset:32768
    ds_read_b64_tr_b16 v[74:75], v12 offset:33792
    v_mfma_f32_16x16x32_bf16 v[228:231], v[100:103], v[156:159], v[228:231]
    ds_read_b64_tr_b16 v[76:77], v13 offset:32768
    ds_read_b64_tr_b16 v[78:79], v13 offset:33792
    v_mfma_f32_16x16x32_bf16 v[200:203], v[104:107], v[152:155], v[200:203]
    ds_read_b64_tr_b16 v[80:81], v14 offset:32768
    ds_read_b64_tr_b16 v[82:83], v14 offset:33792
    v_mfma_f32_16x16x32_bf16 v[232:235], v[104:107], v[156:159], v[232:235]
    ds_read_b64_tr_b16 v[84:85], v15 offset:32768
    ds_read_b64_tr_b16 v[86:87], v15 offset:33792
    v_mfma_f32_16x16x32_bf16 v[204:207], v[108:111], v[152:155], v[204:207]
    ds_read_b64_tr_b16 v[88:89], v16 offset:32768
    ds_read_b64_tr_b16 v[90:91], v16 offset:33792
    v_mfma_f32_16x16x32_bf16 v[236:239], v[108:111], v[156:159], v[236:239]
    ds_read_b64_tr_b16 v[92:93], v17 offset:32768
    ds_read_b64_tr_b16 v[94:95], v17 offset:33792
    v_mfma_f32_16x16x32_bf16 v[208:211], v[112:115], v[152:155], v[208:211]
    buffer_load_dwordx4 v[144:147], v2, s[4:7], s31 offen offset:2048
    v_mfma_f32_16x16x32_bf16 v[240:243], v[112:115], v[156:159], v[240:243]
    buffer_load_dwordx4 v[148:151], v3, s[4:7], s31 offen offset:2048
    s_add_u32 m0, s34, 0
    v_mfma_f32_16x16x32_bf16 v[212:215], v[116:119], v[152:155], v[212:215]
    buffer_load_dwordx4 v6, s[8:11], s32 offen offset:0 lds
    v_mfma_f32_16x16x32_bf16 v[244:247], v[116:119], v[156:159], v[244:247]
    buffer_load_dwordx4 v7, s[8:11], s32 offen offset:1024 lds
    v_mfma_f32_16x16x32_bf16 v[216:219], v[120:123], v[152:155], v[216:219]
    buffer_load_dwordx4 v8, s[8:11], s32 offen offset:2048 lds
    v_mfma_f32_16x16x32_bf16 v[248:251], v[120:123], v[156:159], v[248:251]
    buffer_load_dwordx4 v9, s[8:11], s32 offen offset:3072 lds
    v_mfma_f32_16x16x32_bf16 v[220:223], v[124:127], v[152:155], v[220:223]
    s_add_u32 s32, s32, 1048576
    v_mfma_f32_16x16x32_bf16 v[252:255], v[124:127], v[156:159], v[252:255]
    s_waitcnt lgkmcnt(0)
    s_waitcnt vmcnt(16)
    v_mfma_f32_16x16x32_bf16 v[192:195], v[64:67], v[160:163], v[192:195]
    ds_read_b64_tr_b16 v[96:97], v10 offset:40960
    ds_read_b64_tr_b16 v[98:99], v10 offset:41984
    v_mfma_f32_16x16x32_bf16 v[224:227], v[64:67], v[164:167], v[224:227]
    ds_read_b64_tr_b16 v[100:101], v11 offset:40960
    ds_read_b64_tr_b16 v[102:103], v11 offset:41984
    v_mfma_f32_16x16x32_bf16 v[196:199], v[68:71], v[160:163], v[196:199]
    ds_read_b64_tr_b16 v[104:105], v12 offset:40960
    ds_read_b64_tr_b16 v[106:107], v12 offset:41984
    v_mfma_f32_16x16x32_bf16 v[228:231], v[68:71], v[164:167], v[228:231]
    ds_read_b64_tr_b16 v[108:109], v13 offset:40960
    ds_read_b64_tr_b16 v[110:111], v13 offset:41984
    v_mfma_f32_16x16x32_bf16 v[200:203], v[72:75], v[160:163], v[200:203]
    ds_read_b64_tr_b16 v[112:113], v14 offset:40960
    ds_read_b64_tr_b16 v[114:115], v14 offset:41984
    v_mfma_f32_16x16x32_bf16 v[232:235], v[72:75], v[164:167], v[232:235]
    ds_read_b64_tr_b16 v[116:117], v15 offset:40960
    ds_read_b64_tr_b16 v[118:119], v15 offset:41984
    v_mfma_f32_16x16x32_bf16 v[204:207], v[76:79], v[160:163], v[204:207]
    ds_read_b64_tr_b16 v[120:121], v16 offset:40960
    ds_read_b64_tr_b16 v[122:123], v16 offset:41984
    v_mfma_f32_16x16x32_bf16 v[236:239], v[76:79], v[164:167], v[236:239]
    ds_read_b64_tr_b16 v[124:125], v17 offset:40960
    ds_read_b64_tr_b16 v[126:127], v17 offset:41984
    v_mfma_f32_16x16x32_bf16 v[208:211], v[80:83], v[160:163], v[208:211]
    buffer_load_dwordx4 v[152:155], v2, s[4:7], s31 offen offset:3072
    v_mfma_f32_16x16x32_bf16 v[240:243], v[80:83], v[164:167], v[240:243]
    buffer_load_dwordx4 v[156:159], v3, s[4:7], s31 offen offset:3072
    s_add_u32 s31, s31, 4096
    v_mfma_f32_16x16x32_bf16 v[212:215], v[84:87], v[160:163], v[212:215]
    v_mfma_f32_16x16x32_bf16 v[244:247], v[84:87], v[164:167], v[244:247]
    v_mfma_f32_16x16x32_bf16 v[216:219], v[88:91], v[160:163], v[216:219]
    v_mfma_f32_16x16x32_bf16 v[248:251], v[88:91], v[164:167], v[248:251]
    v_mfma_f32_16x16x32_bf16 v[220:223], v[92:95], v[160:163], v[220:223]
    v_mfma_f32_16x16x32_bf16 v[252:255], v[92:95], v[164:167], v[252:255]
    s_waitcnt lgkmcnt(0)
    s_waitcnt vmcnt(16)
    v_mfma_f32_16x16x32_bf16 v[192:195], v[96:99], v[168:171], v[192:195]
    ds_read_b64_tr_b16 v[64:65], v10 offset:49152
    ds_read_b64_tr_b16 v[66:67], v10 offset:50176
    v_mfma_f32_16x16x32_bf16 v[224:227], v[96:99], v[172:175], v[224:227]
    ds_read_b64_tr_b16 v[68:69], v11 offset:49152
    ds_read_b64_tr_b16 v[70:71], v11 offset:50176
    v_mfma_f32_16x16x32_bf16 v[196:199], v[100:103], v[168:171], v[196:199]
    ds_read_b64_tr_b16 v[72:73], v12 offset:49152
    ds_read_b64_tr_b16 v[74:75], v12 offset:50176
    v_mfma_f32_16x16x32_bf16 v[228:231], v[100:103], v[172:175], v[228:231]
    ds_read_b64_tr_b16 v[76:77], v13 offset:49152
    ds_read_b64_tr_b16 v[78:79], v13 offset:50176
    v_mfma_f32_16x16x32_bf16 v[200:203], v[104:107], v[168:171], v[200:203]
    ds_read_b64_tr_b16 v[80:81], v14 offset:49152
    ds_read_b64_tr_b16 v[82:83], v14 offset:50176
    v_mfma_f32_16x16x32_bf16 v[232:235], v[104:107], v[172:175], v[232:235]
    ds_read_b64_tr_b16 v[84:85], v15 offset:49152
    ds_read_b64_tr_b16 v[86:87], v15 offset:50176
    v_mfma_f32_16x16x32_bf16 v[204:207], v[108:111], v[168:171], v[204:207]
    ds_read_b64_tr_b16 v[88:89], v16 offset:49152
    ds_read_b64_tr_b16 v[90:91], v16 offset:50176
    v_mfma_f32_16x16x32_bf16 v[236:239], v[108:111], v[172:175], v[236:239]
    ds_read_b64_tr_b16 v[92:93], v17 offset:49152
    ds_read_b64_tr_b16 v[94:95], v17 offset:50176
    v_mfma_f32_16x16x32_bf16 v[208:211], v[112:115], v[168:171], v[208:211]
    buffer_load_dwordx4 v[160:163], v2, s[4:7], s31 offen offset:0
    v_mfma_f32_16x16x32_bf16 v[240:243], v[112:115], v[172:175], v[240:243]
    buffer_load_dwordx4 v[164:167], v3, s[4:7], s31 offen offset:0
    v_mfma_f32_16x16x32_bf16 v[212:215], v[116:119], v[168:171], v[212:215]
    v_mfma_f32_16x16x32_bf16 v[244:247], v[116:119], v[172:175], v[244:247]
    v_mfma_f32_16x16x32_bf16 v[216:219], v[120:123], v[168:171], v[216:219]
    v_mfma_f32_16x16x32_bf16 v[248:251], v[120:123], v[172:175], v[248:251]
    v_mfma_f32_16x16x32_bf16 v[220:223], v[124:127], v[168:171], v[220:223]
    v_mfma_f32_16x16x32_bf16 v[252:255], v[124:127], v[172:175], v[252:255]
    s_waitcnt lgkmcnt(0)
    s_waitcnt vmcnt(16)
    v_mfma_f32_16x16x32_bf16 v[192:195], v[64:67], v[176:179], v[192:195]
    ds_read_b64_tr_b16 v[96:97], v10 offset:57344
    ds_read_b64_tr_b16 v[98:99], v10 offset:58368
    v_mfma_f32_16x16x32_bf16 v[224:227], v[64:67], v[180:183], v[224:227]
    ds_read_b64_tr_b16 v[100:101], v11 offset:57344
    ds_read_b64_tr_b16 v[102:103], v11 offset:58368
    v_mfma_f32_16x16x32_bf16 v[196:199], v[68:71], v[176:179], v[196:199]
    ds_read_b64_tr_b16 v[104:105], v12 offset:57344
    ds_read_b64_tr_b16 v[106:107], v12 offset:58368
    v_mfma_f32_16x16x32_bf16 v[228:231], v[68:71], v[180:183], v[228:231]
    ds_read_b64_tr_b16 v[108:109], v13 offset:57344
    ds_read_b64_tr_b16 v[110:111], v13 offset:58368
    v_mfma_f32_16x16x32_bf16 v[200:203], v[72:75], v[176:179], v[200:203]
    ds_read_b64_tr_b16 v[112:113], v14 offset:57344
    ds_read_b64_tr_b16 v[114:115], v14 offset:58368
    v_mfma_f32_16x16x32_bf16 v[232:235], v[72:75], v[180:183], v[232:235]
    ds_read_b64_tr_b16 v[116:117], v15 offset:57344
    ds_read_b64_tr_b16 v[118:119], v15 offset:58368
    v_mfma_f32_16x16x32_bf16 v[204:207], v[76:79], v[176:179], v[204:207]
    ds_read_b64_tr_b16 v[120:121], v16 offset:57344
    ds_read_b64_tr_b16 v[122:123], v16 offset:58368
    v_mfma_f32_16x16x32_bf16 v[236:239], v[76:79], v[180:183], v[236:239]
    ds_read_b64_tr_b16 v[124:125], v17 offset:57344
    ds_read_b64_tr_b16 v[126:127], v17 offset:58368
    v_mfma_f32_16x16x32_bf16 v[208:211], v[80:83], v[176:179], v[208:211]
    buffer_load_dwordx4 v[168:171], v2, s[4:7], s31 offen offset:1024
    v_mfma_f32_16x16x32_bf16 v[240:243], v[80:83], v[180:183], v[240:243]
    buffer_load_dwordx4 v[172:175], v3, s[4:7], s31 offen offset:1024
    v_mfma_f32_16x16x32_bf16 v[212:215], v[84:87], v[176:179], v[212:215]
    v_mfma_f32_16x16x32_bf16 v[244:247], v[84:87], v[180:183], v[244:247]
    v_mfma_f32_16x16x32_bf16 v[216:219], v[88:91], v[176:179], v[216:219]
    v_mfma_f32_16x16x32_bf16 v[248:251], v[88:91], v[180:183], v[248:251]
    v_mfma_f32_16x16x32_bf16 v[220:223], v[92:95], v[176:179], v[220:223]
    v_mfma_f32_16x16x32_bf16 v[252:255], v[92:95], v[180:183], v[252:255]
    s_waitcnt lgkmcnt(0)
    s_waitcnt vmcnt(6)
    s_barrier
    v_mfma_f32_16x16x32_bf16 v[192:195], v[96:99], v[184:187], v[192:195]
    ds_read_b64_tr_b16 v[64:65], v10 offset:0
    ds_read_b64_tr_b16 v[66:67], v10 offset:1024
    v_mfma_f32_16x16x32_bf16 v[224:227], v[96:99], v[188:191], v[224:227]
    ds_read_b64_tr_b16 v[68:69], v11 offset:0
    ds_read_b64_tr_b16 v[70:71], v11 offset:1024
    v_mfma_f32_16x16x32_bf16 v[196:199], v[100:103], v[184:187], v[196:199]
    ds_read_b64_tr_b16 v[72:73], v12 offset:0
    ds_read_b64_tr_b16 v[74:75], v12 offset:1024
    v_mfma_f32_16x16x32_bf16 v[228:231], v[100:103], v[188:191], v[228:231]
    ds_read_b64_tr_b16 v[76:77], v13 offset:0
    ds_read_b64_tr_b16 v[78:79], v13 offset:1024
    v_mfma_f32_16x16x32_bf16 v[200:203], v[104:107], v[184:187], v[200:203]
    ds_read_b64_tr_b16 v[80:81], v14 offset:0
    ds_read_b64_tr_b16 v[82:83], v14 offset:1024
    v_mfma_f32_16x16x32_bf16 v[232:235], v[104:107], v[188:191], v[232:235]
    ds_read_b64_tr_b16 v[84:85], v15 offset:0
    ds_read_b64_tr_b16 v[86:87], v15 offset:1024
    v_mfma_f32_16x16x32_bf16 v[204:207], v[108:111], v[184:187], v[204:207]
    ds_read_b64_tr_b16 v[88:89], v16 offset:0
    ds_read_b64_tr_b16 v[90:91], v16 offset:1024
    v_mfma_f32_16x16x32_bf16 v[236:239], v[108:111], v[188:191], v[236:239]
    ds_read_b64_tr_b16 v[92:93], v17 offset:0
    ds_read_b64_tr_b16 v[94:95], v17 offset:1024
    v_mfma_f32_16x16x32_bf16 v[208:211], v[112:115], v[184:187], v[208:211]
    buffer_load_dwordx4 v[176:179], v2, s[4:7], s31 offen offset:2048
    v_mfma_f32_16x16x32_bf16 v[240:243], v[112:115], v[188:191], v[240:243]
    buffer_load_dwordx4 v[180:183], v3, s[4:7], s31 offen offset:2048
    s_add_u32 m0, s34, 32768
    v_mfma_f32_16x16x32_bf16 v[212:215], v[116:119], v[184:187], v[212:215]
    buffer_load_dwordx4 v6, s[8:11], s32 offen offset:0 lds
    v_mfma_f32_16x16x32_bf16 v[244:247], v[116:119], v[188:191], v[244:247]
    buffer_load_dwordx4 v7, s[8:11], s32 offen offset:1024 lds
    v_mfma_f32_16x16x32_bf16 v[216:219], v[120:123], v[184:187], v[216:219]
    buffer_load_dwordx4 v8, s[8:11], s32 offen offset:2048 lds
    v_mfma_f32_16x16x32_bf16 v[248:251], v[120:123], v[188:191], v[248:251]
    buffer_load_dwordx4 v9, s[8:11], s32 offen offset:3072 lds
    v_mfma_f32_16x16x32_bf16 v[220:223], v[124:127], v[184:187], v[220:223]
    s_add_u32 s32, s32, 1048576
    v_mfma_f32_16x16x32_bf16 v[252:255], v[124:127], v[188:191], v[252:255]
    s_add_u32 s35, s35, 1
    s_cmp_lt_u32 s35, 4
    s_cbranch_scc1 L_p2_loop
    s_cmp_lt_u32 s28, 4
    s_cbranch_scc0 L_grp1
    s_mov_b32 s36, 1040356334
    s_and_b32 s37, s28, 3
    s_lshl_b32 s37, s37, 13
    v_lshlrev_b32 v7, 4, v1
    v_add_u32 v4, s37, v7
    v_add_u32 v6, 4096, v4
    v_add_u32 v19, 131072, v4
    s_mov_b32 s43, s37
    s_add_u32 s44, s37, 98304
    s_waitcnt vmcnt(0) lgkmcnt(0)
    v_mul_f32 v192, s36, v192
    v_mul_f32 v193, s36, v193
    v_mul_f32 v194, s36, v194
    v_mul_f32 v195, s36, v195
    v_mul_f32 v196, s36, v196
    v_mul_f32 v197, s36, v197
    v_mul_f32 v198, s36, v198
    v_mul_f32 v199, s36, v199
    v_cvt_pk_bf16_f32 v128, v192, v193
    v_cvt_pk_bf16_f32 v129, v194, v195
    v_cvt_pk_bf16_f32 v130, v196, v197
    v_cvt_pk_bf16_f32 v131, v198, v199
    ds_write_b128 v19, v[128:131] offset:0
    v_mul_f32 v200, s36, v200
    v_mul_f32 v201, s36, v201
    v_mul_f32 v202, s36, v202
    v_mul_f32 v203, s36, v203
    v_mul_f32 v204, s36, v204
    v_mul_f32 v205, s36, v205
    v_mul_f32 v206, s36, v206
    v_mul_f32 v207, s36, v207
    v_cvt_pk_bf16_f32 v132, v200, v201
    v_cvt_pk_bf16_f32 v133, v202, v203
    v_cvt_pk_bf16_f32 v134, v204, v205
    v_cvt_pk_bf16_f32 v135, v206, v207
    ds_write_b128 v19, v[132:135] offset:1024
    v_mul_f32 v208, s36, v208
    v_mul_f32 v209, s36, v209
    v_mul_f32 v210, s36, v210
    v_mul_f32 v211, s36, v211
    v_mul_f32 v212, s36, v212
    v_mul_f32 v213, s36, v213
    v_mul_f32 v214, s36, v214
    v_mul_f32 v215, s36, v215
    v_cvt_pk_bf16_f32 v136, v208, v209
    v_cvt_pk_bf16_f32 v137, v210, v211
    v_cvt_pk_bf16_f32 v138, v212, v213
    v_cvt_pk_bf16_f32 v139, v214, v215
    ds_write_b128 v19, v[136:139] offset:2048
    v_mul_f32 v216, s36, v216
    v_mul_f32 v217, s36, v217
    v_mul_f32 v218, s36, v218
    v_mul_f32 v219, s36, v219
    v_mul_f32 v220, s36, v220
    v_mul_f32 v221, s36, v221
    v_mul_f32 v222, s36, v222
    v_mul_f32 v223, s36, v223
    v_cvt_pk_bf16_f32 v140, v216, v217
    v_cvt_pk_bf16_f32 v141, v218, v219
    v_cvt_pk_bf16_f32 v142, v220, v221
    v_cvt_pk_bf16_f32 v143, v222, v223
    ds_write_b128 v19, v[140:143] offset:3072
    v_mul_f32 v224, s36, v224
    v_mul_f32 v225, s36, v225
    v_mul_f32 v226, s36, v226
    v_mul_f32 v227, s36, v227
    v_mul_f32 v228, s36, v228
    v_mul_f32 v229, s36, v229
    v_mul_f32 v230, s36, v230
    v_mul_f32 v231, s36, v231
    v_cvt_pk_bf16_f32 v144, v224, v225
    v_cvt_pk_bf16_f32 v145, v226, v227
    v_cvt_pk_bf16_f32 v146, v228, v229
    v_cvt_pk_bf16_f32 v147, v230, v231
    ds_write_b128 v19, v[144:147] offset:4096
    v_mul_f32 v232, s36, v232
    v_mul_f32 v233, s36, v233
    v_mul_f32 v234, s36, v234
    v_mul_f32 v235, s36, v235
    v_mul_f32 v236, s36, v236
    v_mul_f32 v237, s36, v237
    v_mul_f32 v238, s36, v238
    v_mul_f32 v239, s36, v239
    v_cvt_pk_bf16_f32 v148, v232, v233
    v_cvt_pk_bf16_f32 v149, v234, v235
    v_cvt_pk_bf16_f32 v150, v236, v237
    v_cvt_pk_bf16_f32 v151, v238, v239
    ds_write_b128 v19, v[148:151] offset:5120
    v_mul_f32 v240, s36, v240
    v_mul_f32 v241, s36, v241
    v_mul_f32 v242, s36, v242
    v_mul_f32 v243, s36, v243
    v_mul_f32 v244, s36, v244
    v_mul_f32 v245, s36, v245
    v_mul_f32 v246, s36, v246
    v_mul_f32 v247, s36, v247
    v_cvt_pk_bf16_f32 v152, v240, v241
    v_cvt_pk_bf16_f32 v153, v242, v243
    v_cvt_pk_bf16_f32 v154, v244, v245
    v_cvt_pk_bf16_f32 v155, v246, v247
    ds_write_b128 v19, v[152:155] offset:6144
    v_mul_f32 v248, s36, v248
    v_mul_f32 v249, s36, v249
    v_mul_f32 v250, s36, v250
    v_mul_f32 v251, s36, v251
    v_mul_f32 v252, s36, v252
    v_mul_f32 v253, s36, v253
    v_mul_f32 v254, s36, v254
    v_mul_f32 v255, s36, v255
    v_cvt_pk_bf16_f32 v156, v248, v249
    v_cvt_pk_bf16_f32 v157, v250, v251
    v_cvt_pk_bf16_f32 v158, v252, v253
    v_cvt_pk_bf16_f32 v159, v254, v255
    ds_write_b128 v19, v[156:159] offset:7168
    v_mov_b32 v2, v7
    v_and_b32 v21, 15, v1
    v_lshrrev_b32 v22, 4, v1
    v_lshlrev_b32 v22, 2, v22
    v_sub_u32 v18, v21, v22
    s_mov_b32 s40, 0
    s_mov_b32 s41, 0
    s_lshl_b32 s51, s30, 1
    s_add_u32 s51, s51, 1
    s_and_b32 s36, s28, 3
    s_lshl_b32 s36, s36, 5
    s_sub_u32 s37, 15, s30
    s_lshl_b32 s37, s37, 7
    s_add_u32 s36, s36, s37
    s_sub_u32 s50, 0, s36
    s_add_u32 s36, s51, 1
    s_lshl_b32 s36, -1, s36
    s_or_b32 s48, s36, 0xaaaaaaaa
    s_and_b32 s48, s48, 0x7ffe
    s_or_b32 s39, s36, 0x55555555
    s_and_b32 s39, s39, 0xffff
    s_add_u32 s46, s45, 131072
    s_add_u32 s47, s45, 98304
    s_mov_b64 s[52:53], 0
    s_waitcnt lgkmcnt(0)
    s_barrier
    ds_read_b128 v[64:67], v2 offset:0
    ds_read_b128 v[68:71], v2 offset:1024
    ds_read_b128 v[72:75], v2 offset:2048
    ds_read_b128 v[76:79], v2 offset:3072
    ds_read_b128 v[80:83], v2 offset:4096
    ds_read_b128 v[84:87], v2 offset:5120
    ds_read_b128 v[88:91], v2 offset:6144
    ds_read_b128 v[92:95], v2 offset:7168
    s_waitcnt lgkmcnt(7)
    v_mfma_f32_16x16x32_bf16 v[96:99], v[64:67], v[128:131], 0
    v_mov_b32 v192, 0
    v_mov_b32 v193, 0
    v_mfma_f32_16x16x32_bf16 v[104:107], v[64:67], v[144:147], 0
    ds_read_b128 v[64:67], v2 offset:8192
    v_mov_b32 v194, 0
    v_mov_b32 v195, 0
    s_waitcnt lgkmcnt(7)
    v_mfma_f32_16x16x32_bf16 v[96:99], v[68:71], v[132:135], v[96:99]
    v_mov_b32 v196, 0
    v_mov_b32 v197, 0
    v_mfma_f32_16x16x32_bf16 v[104:107], v[68:71], v[148:151], v[104:107]
    ds_read_b128 v[68:71], v2 offset:9216
    v_mov_b32 v198, 0
    v_mov_b32 v199, 0
    s_waitcnt lgkmcnt(7)
    v_mfma_f32_16x16x32_bf16 v[96:99], v[72:75], v[136:139], v[96:99]
    v_mov_b32 v200, 0
    v_mov_b32 v201, 0
    v_mfma_f32_16x16x32_bf16 v[104:107], v[72:75], v[152:155], v[104:107]
    ds_read_b128 v[72:75], v2 offset:10240
    v_mov_b32 v202, 0
    v_mov_b32 v203, 0
    s_waitcnt lgkmcnt(7)
    v_mfma_f32_16x16x32_bf16 v[96:99], v[76:79], v[140:143], v[96:99]
    v_mov_b32 v204, 0
    v_mov_b32 v205, 0
    v_mfma_f32_16x16x32_bf16 v[104:107], v[76:79], v[156:159], v[104:107]
    ds_read_b128 v[76:79], v2 offset:11264
    v_mov_b32 v206, 0
    v_mov_b32 v207, 0
    s_waitcnt lgkmcnt(7)
    v_mfma_f32_16x16x32_bf16 v[100:103], v[80:83], v[128:131], 0
    v_mov_b32 v208, 0
    v_mov_b32 v209, 0
    v_mfma_f32_16x16x32_bf16 v[108:111], v[80:83], v[144:147], 0
    ds_read_b128 v[80:83], v2 offset:12288
    v_mov_b32 v210, 0
    v_mov_b32 v211, 0
    s_waitcnt lgkmcnt(7)
    v_mfma_f32_16x16x32_bf16 v[100:103], v[84:87], v[132:135], v[100:103]
    v_mov_b32 v212, 0
    v_mov_b32 v213, 0
    v_mfma_f32_16x16x32_bf16 v[108:111], v[84:87], v[148:151], v[108:111]
    ds_read_b128 v[84:87], v2 offset:13312
    v_mov_b32 v214, 0
    v_mov_b32 v215, 0
    s_waitcnt lgkmcnt(7)
    v_mfma_f32_16x16x32_bf16 v[100:103], v[88:91], v[136:139], v[100:103]
    v_mov_b32 v216, 0
    v_mov_b32 v217, 0
    v_mfma_f32_16x16x32_bf16 v[108:111], v[88:91], v[152:155], v[108:111]
    ds_read_b128 v[88:91], v2 offset:14336
    v_mov_b32 v218, 0
    v_mov_b32 v219, 0
    s_waitcnt lgkmcnt(7)
    v_mfma_f32_16x16x32_bf16 v[100:103], v[92:95], v[140:143], v[100:103]
    v_mov_b32 v220, 0
    v_mov_b32 v221, 0
    v_mfma_f32_16x16x32_bf16 v[108:111], v[92:95], v[156:159], v[108:111]
    ds_read_b128 v[92:95], v2 offset:15360
    v_mov_b32 v222, 0
    v_mov_b32 v223, 0
    s_waitcnt lgkmcnt(7)
    v_mfma_f32_16x16x32_bf16 v[112:115], v[64:67], v[128:131], 0
    v_mov_b32 v224, 0
    v_mov_b32 v225, 0
    v_mfma_f32_16x16x32_bf16 v[120:123], v[64:67], v[144:147], 0
    v_mov_b32 v226, 0
    v_mov_b32 v227, 0
    s_waitcnt lgkmcnt(6)
    v_mfma_f32_16x16x32_bf16 v[112:115], v[68:71], v[132:135], v[112:115]
    v_mov_b32 v228, 0
    v_mov_b32 v229, 0
    v_mfma_f32_16x16x32_bf16 v[120:123], v[68:71], v[148:151], v[120:123]
    v_mov_b32 v230, 0
    v_mov_b32 v231, 0
    s_waitcnt lgkmcnt(5)
    v_mfma_f32_16x16x32_bf16 v[112:115], v[72:75], v[136:139], v[112:115]
    v_mov_b32 v232, 0
    v_mov_b32 v233, 0
    v_mfma_f32_16x16x32_bf16 v[120:123], v[72:75], v[152:155], v[120:123]
    v_mov_b32 v234, 0
    v_mov_b32 v235, 0
    s_waitcnt lgkmcnt(4)
    v_mfma_f32_16x16x32_bf16 v[112:115], v[76:79], v[140:143], v[112:115]
    v_mov_b32 v236, 0
    v_mov_b32 v237, 0
    v_mfma_f32_16x16x32_bf16 v[120:123], v[76:79], v[156:159], v[120:123]
    v_mov_b32 v238, 0
    v_mov_b32 v239, 0
    s_waitcnt lgkmcnt(3)
    v_mfma_f32_16x16x32_bf16 v[116:119], v[80:83], v[128:131], 0
    v_mov_b32 v240, 0
    v_mov_b32 v241, 0
    v_mfma_f32_16x16x32_bf16 v[124:127], v[80:83], v[144:147], 0
    v_mov_b32 v242, 0
    v_mov_b32 v243, 0
    s_waitcnt lgkmcnt(2)
    v_mfma_f32_16x16x32_bf16 v[116:119], v[84:87], v[132:135], v[116:119]
    v_mov_b32 v244, 0
    v_mov_b32 v245, 0
    v_mfma_f32_16x16x32_bf16 v[124:127], v[84:87], v[148:151], v[124:127]
    v_mov_b32 v246, 0
    v_mov_b32 v247, 0
    s_waitcnt lgkmcnt(1)
    v_mfma_f32_16x16x32_bf16 v[116:119], v[88:91], v[136:139], v[116:119]
    v_mov_b32 v248, 0
    v_mov_b32 v249, 0
    v_mfma_f32_16x16x32_bf16 v[124:127], v[88:91], v[152:155], v[124:127]
    v_mov_b32 v250, 0
    v_mov_b32 v251, 0
    s_waitcnt lgkmcnt(0)
    v_mfma_f32_16x16x32_bf16 v[116:119], v[92:95], v[140:143], v[116:119]
    v_mov_b32 v252, 0
    v_mov_b32 v253, 0
    v_mfma_f32_16x16x32_bf16 v[124:127], v[92:95], v[156:159], v[124:127]
    v_mov_b32 v254, 0
    v_mov_b32 v255, 0
    v_mov_b32 v38, 0
    v_mov_b32 v39, 0
    s_cmp_lt_i32 s50, 0
    s_cbranch_scc0 L_attn_kernel_rare_1
L_attn_kernel_back_2:
    s_add_u32 s49, s50, 32
    v_add_u32 v24, 65536, v2
    s_cmp_le_u32 s40, s51
    s_cselect_b32 s36, 64, 128
    s_add_u32 s41, s41, s36
    s_add_u32 s50, s50, s36
    s_and_b32 s36, s41, 0xff
    v_lshl_add_u32 v2, s36, 8, v7
    s_cmp_eq_u32 s40, 16
    s_cselect_b64 s[20:21], -1, 0
    v_cndmask_b32 v5, v2, v24, s[20:21]
    v_mov_b32 v3, v24
    s_barrier
    ds_read_b128 v[64:67], v5 offset:0
    ds_read_b128 v[68:71], v5 offset:1024
    ds_read_b128 v[72:75], v5 offset:2048
    ds_read_b128 v[76:79], v5 offset:3072
    ds_read_b128 v[80:83], v5 offset:4096
    ds_read_b128 v[84:87], v5 offset:5120
    ds_read_b128 v[88:91], v5 offset:6144
    v_max3_f32 v21, v96, v97, v98
    v_max3_f32 v21, v21, v99, v100
    v_max3_f32 v21, v21, v101, v102
    v_max_f32 v21, v21, v103
    v_max3_f32 v22, v104, v105, v106
    v_max3_f32 v22, v22, v107, v108
    v_max3_f32 v22, v22, v109, v110
    v_max_f32 v22, v22, v111
    v_mov_b32 v23, v21
    s_nop 1
    v_permlane16_swap_b32 v21, v23
    s_nop 1
    v_max_f32 v21, v21, v23
    v_mov_b32 v23, v21
    s_nop 1
    v_permlane32_swap_b32 v21, v23
    s_nop 1
    v_max_f32 v21, v21, v23
    v_mov_b32 v23, v22
    s_nop 1
    v_permlane16_swap_b32 v22, v23
    s_nop 1
    v_max_f32 v22, v22, v23
    v_mov_b32 v23, v22
    s_nop 1
    v_permlane32_swap_b32 v22, v23
    s_nop 1
    v_max_f32 v22, v22, v23
    v_sub_f32 v40, 0, v21
    v_sub_f32 v41, 0, v21
    v_sub_f32 v42, 0, v21
    v_sub_f32 v43, 0, v21
    v_sub_f32 v44, 0, v22
    v_sub_f32 v45, 0, v22
    v_sub_f32 v46, 0, v22
    v_sub_f32 v47, 0, v22
    ds_write_b128 v19, v[40:43]
    ds_write_b128 v19, v[44:47] offset:1024
    v_sub_f32 v96, v96, v21
    v_sub_f32 v97, v97, v21
    v_sub_f32 v98, v98, v21
    v_sub_f32 v99, v99, v21
    v_sub_f32 v100, v100, v21
    v_sub_f32 v101, v101, v21
    v_sub_f32 v102, v102, v21
    v_sub_f32 v103, v103, v21
    v_sub_f32 v104, v104, v22
    v_sub_f32 v105, v105, v22
    v_sub_f32 v106, v106, v22
    v_sub_f32 v107, v107, v22
    v_sub_f32 v108, v108, v22
    v_sub_f32 v109, v109, v22
    v_sub_f32 v110, v110, v22
    v_sub_f32 v111, v111, v22
    v_sub_f32 v112, v112, v21
    v_sub_f32 v113, v113, v21
    v_sub_f32 v114, v114, v21
    v_sub_f32 v115, v115, v21
    v_sub_f32 v116, v116, v21
    v_sub_f32 v117, v117, v21
    v_sub_f32 v118, v118, v21
    v_sub_f32 v119, v119, v21
    v_sub_f32 v120, v120, v22
    v_sub_f32 v121, v121, v22
    v_sub_f32 v122, v122, v22
    v_sub_f32 v123, v123, v22
    v_sub_f32 v124, v124, v22
    v_sub_f32 v125, v125, v22
    v_sub_f32 v126, v126, v22
    v_sub_f32 v127, v127, v22
    v_exp_f32 v96, v96
    v_exp_f32 v97, v97
    v_add_f32 v38, v38, v96
    v_exp_f32 v98, v98
    v_add_f32 v38, v38, v97
    v_cvt_pk_bf16_f32 v48, v96, v97
    v_exp_f32 v99, v99
    v_add_f32 v38, v38, v98
    v_exp_f32 v104, v104
    v_add_f32 v38, v38, v99
    v_cvt_pk_bf16_f32 v49, v98, v99
    v_exp_f32 v105, v105
    v_add_f32 v39, v39, v104
    v_exp_f32 v106, v106
    v_add_f32 v39, v39, v105
    v_cvt_pk_bf16_f32 v52, v104, v105
    v_exp_f32 v107, v107
    v_add_f32 v39, v39, v106
    v_exp_f32 v100, v100
    v_add_f32 v39, v39, v107
    v_cvt_pk_bf16_f32 v53, v106, v107
    v_exp_f32 v101, v101
    v_add_f32 v38, v38, v100
    v_exp_f32 v102, v102
    v_add_f32 v38, v38, v101
    v_cvt_pk_bf16_f32 v50, v100, v101
    v_exp_f32 v103, v103
    v_add_f32 v38, v38, v102
    v_exp_f32 v108, v108
    v_add_f32 v38, v38, v103
    v_cvt_pk_bf16_f32 v51, v102, v103
    v_exp_f32 v109, v109
    v_add_f32 v39, v39, v108
    v_exp_f32 v110, v110
    v_add_f32 v39, v39, v109
    v_cvt_pk_bf16_f32 v54, v108, v109
    v_exp_f32 v111, v111
    v_add_f32 v39, v39, v110
    s_nop 0
    v_add_f32 v39, v39, v111
    v_cvt_pk_bf16_f32 v55, v110, v111
    .p2align 6
L_body0:
    s_cmp_lt_i32 s49, 0
    s_cbranch_scc0 L_attn_kernel_rare_3
L_attn_kernel_back_4:
    s_waitcnt lgkmcnt(3)
    v_mfma_f32_16x16x32_bf16 v[96:99], v[64:67], v[128:131], v[40:43]
    v_exp_f32 v112, v112
    v_mfma_f32_16x16x32_bf16 v[104:107], v[64:67], v[144:147], v[44:47]
    ds_read_b128 v[92:95], v2 offset:7168
    s_bitcmp1_b32 s48, s40
    s_cbranch_scc0 L_attn_kernel_nodma_7
    s_add_u32 m0, s43, 0
    s_nop 0
    buffer_load_dwordx4 v4, s[12:15], s46 offen offset:0 lds
    buffer_load_dwordx4 v4, s[12:15], s46 offen offset:1024 lds
L_attn_kernel_nodma_7:
    v_mfma_f32_16x16x32_bf16 v[96:99], v[68:71], v[132:135], v[96:99]
    v_exp_f32 v113, v113
    v_mfma_f32_16x16x32_bf16 v[104:107], v[68:71], v[148:151], v[104:107]
    ds_read_b128 v[64:67], v3 offset:0
    v_add_f32 v38, v38, v112
    v_mfma_f32_16x16x32_bf16 v[96:99], v[72:75], v[136:139], v[96:99]
    v_exp_f32 v114, v114
    v_mfma_f32_16x16x32_bf16 v[104:107], v[72:75], v[152:155], v[104:107]
    ds_read_b128 v[68:71], v3 offset:1024
    v_add_f32 v38, v38, v113
    v_cvt_pk_bf16_f32 v56, v112, v113
    s_bitcmp1_b32 s48, s40
    s_cbranch_scc0 L_attn_kernel_nodma_8
    s_add_u32 m0, s43, 0
    s_nop 0
    buffer_load_dwordx4 v4, s[12:15], s46 offen offset:2048 lds
    buffer_load_dwordx4 v4, s[12:15], s46 offen offset:3072 lds
L_attn_kernel_nodma_8:
    v_mfma_f32_16x16x32_bf16 v[96:99], v[76:79], v[140:143], v[96:99]
    v_exp_f32 v115, v115
    v_mfma_f32_16x16x32_bf16 v[104:107], v[76:79], v[156:159], v[104:107]
    ds_read_b128 v[72:75], v3 offset:2048
    v_add_f32 v38, v38, v114
    s_waitcnt lgkmcnt(3)
    v_mfma_f32_16x16x32_bf16 v[100:103], v[80:83], v[128:131], v[40:43]
    v_exp_f32 v120, v120
    v_mfma_f32_16x16x32_bf16 v[108:111], v[80:83], v[144:147], v[44:47]
    ds_read_b128 v[76:79], v3 offset:3072
    v_add_f32 v38, v38, v115
    v_cvt_pk_bf16_f32 v57, v114, v115
    s_bitcmp1_b32 s48, s40
    s_cbranch_scc0 L_attn_kernel_nodma_9
    s_add_u32 m0, s43, 4096
    s_nop 0
    buffer_load_dwordx4 v6, s[12:15], s46 offen offset:0 lds
    buffer_load_dwordx4 v6, s[12:15], s46 offen offset:1024 lds
L_attn_kernel_nodma_9:
    v_mfma_f32_16x16x32_bf16 v[100:103], v[84:87], v[132:135], v[100:103]
    v_exp_f32 v121, v121
    v_mfma_f32_16x16x32_bf16 v[108:111], v[84:87], v[148:151], v[108:111]
    ds_read_b128 v[80:83], v3 offset:4096
    v_add_f32 v39, v39, v120
    v_mfma_f32_16x16x32_bf16 v[100:103], v[88:91], v[136:139], v[100:103]
    v_exp_f32 v122, v122
    v_mfma_f32_16x16x32_bf16 v[108:111], v[88:91], v[152:155], v[108:111]
    ds_read_b128 v[84:87], v3 offset:5120
    v_add_f32 v39, v39, v121
    v_cvt_pk_bf16_f32 v60, v120, v121
    s_bitcmp1_b32 s48, s40
    s_cbranch_scc0 L_attn_kernel_nodma_10
    s_add_u32 m0, s43, 4096
    s_nop 0
    buffer_load_dwordx4 v6, s[12:15], s46 offen offset:2048 lds
    buffer_load_dwordx4 v6, s[12:15], s46 offen offset:3072 lds
    s_add_u32 s46, s46, 65536
    s_xor_b32 s43, s43, 32768
L_attn_kernel_nodma_10:
    v_mfma_f32_16x16x32_bf16 v[100:103], v[92:95], v[140:143], v[100:103]
    v_exp_f32 v123, v123
    v_mfma_f32_16x16x32_bf16 v[108:111], v[92:95], v[156:159], v[108:111]
    ds_read_b128 v[88:91], v3 offset:6144
    v_add_f32 v39, v39, v122
    s_waitcnt lgkmcnt(3)
    v_mfma_f32_16x16x32_bf16 v[192:195], v[64:67], v[48:51], v[192:195]
    v_exp_f32 v116, v116
    v_mfma_f32_16x16x32_bf16 v[224:227], v[64:67], v[52:55], v[224:227]
    ds_read_b128 v[92:95], v3 offset:7168
    v_add_f32 v39, v39, v123
    v_cvt_pk_bf16_f32 v61, v122, v123
    s_bitcmp1_b32 s39, s40
    s_cbranch_scc0 L_attn_kernel_nodma_11
    s_add_u32 m0, s44, 0
    s_nop 0
    buffer_load_dwordx4 v4, s[12:15], s47 offen offset:0 lds
    buffer_load_dwordx4 v4, s[12:15], s47 offen offset:1024 lds
L_attn_kernel_nodma_11:
    v_mfma_f32_16x16x32_bf16 v[196:199], v[68:71], v[48:51], v[196:199]
    v_exp_f32 v117, v117
    v_mfma_f32_16x16x32_bf16 v[228:231], v[68:71], v[52:55], v[228:231]
    ds_read_b128 v[64:67], v2 offset:8192
    v_add_f32 v38, v38, v116
    v_mfma_f32_16x16x32_bf16 v[200:203], v[72:75], v[48:51], v[200:203]
    v_exp_f32 v118, v118
    v_mfma_f32_16x16x32_bf16 v[232:235], v[72:75], v[52:55], v[232:235]
    ds_read_b128 v[68:71], v2 offset:9216
    v_add_f32 v38, v38, v117
    v_cvt_pk_bf16_f32 v58, v116, v117
    s_bitcmp1_b32 s39, s40
    s_cbranch_scc0 L_attn_kernel_nodma_12
    s_add_u32 m0, s44, 0
    s_nop 0
    buffer_load_dwordx4 v4, s[12:15], s47 offen offset:2048 lds
    buffer_load_dwordx4 v4, s[12:15], s47 offen offset:3072 lds
L_attn_kernel_nodma_12:
    v_mfma_f32_16x16x32_bf16 v[204:207], v[76:79], v[48:51], v[204:207]
    v_exp_f32 v119, v119
    v_mfma_f32_16x16x32_bf16 v[236:239], v[76:79], v[52:55], v[236:239]
    ds_read_b128 v[72:75], v2 offset:10240
    v_add_f32 v38, v38, v118
    s_waitcnt lgkmcnt(3)
    v_mfma_f32_16x16x32_bf16 v[208:211], v[80:83], v[48:51], v[208:211]
    v_exp_f32 v124, v124
    v_mfma_f32_16x16x32_bf16 v[240:243], v[80:83], v[52:55], v[240:243]
    ds_read_b128 v[76:79], v2 offset:11264
    v_add_f32 v38, v38, v119
    v_cvt_pk_bf16_f32 v59, v118, v119
    s_bitcmp1_b32 s39, s40
    s_cbranch_scc0 L_attn_kernel_nodma_13
    s_add_u32 m0, s44, 4096
    s_nop 0
    buffer_load_dwordx4 v6, s[12:15], s47 offen offset:0 lds
    buffer_load_dwordx4 v6, s[12:15], s47 offen offset:1024 lds
L_attn_kernel_nodma_13:
    v_mfma_f32_16x16x32_bf16 v[212:215], v[84:87], v[48:51], v[212:215]
    v_exp_f32 v125, v125
    v_mfma_f32_16x16x32_bf16 v[244:247], v[84:87], v[52:55], v[244:247]
    ds_read_b128 v[80:83], v2 offset:12288
    v_add_f32 v39, v39, v124
    v_mfma_f32_16x16x32_bf16 v[216:219], v[88:91], v[48:51], v[216:219]
    v_exp_f32 v126, v126
    v_mfma_f32_16x16x32_bf16 v[248:251], v[88:91], v[52:55], v[248:251]
    ds_read_b128 v[84:87], v2 offset:13312
    v_add_f32 v39, v39, v125
    v_cvt_pk_bf16_f32 v62, v124, v125
    s_bitcmp1_b32 s39, s40
    s_cbranch_scc0 L_attn_kernel_nodma_14
    s_add_u32 m0, s44, 4096
    s_nop 0
    buffer_load_dwordx4 v6, s[12:15], s47 offen offset:2048 lds
    buffer_load_dwordx4 v6, s[12:15], s47 offen offset:3072 lds
    s_add_u32 s47, s47, 65536
    s_xor_b32 s44, s44, 32768
L_attn_kernel_nodma_14:
    v_mfma_f32_16x16x32_bf16 v[220:223], v[92:95], v[48:51], v[220:223]
    v_exp_f32 v127, v127
    v_mfma_f32_16x16x32_bf16 v[252:255], v[92:95], v[52:55], v[252:255]
    ds_read_b128 v[88:91], v2 offset:14336
    v_add_f32 v39, v39, v126
    v_add_f32 v39, v39, v127
    v_cvt_pk_bf16_f32 v63, v126, v127
    s_cmp_lt_i32 s50, 0
    s_cbranch_scc0 L_attn_kernel_rare_5
L_attn_kernel_back_6:
    s_waitcnt lgkmcnt(3)
    v_mfma_f32_16x16x32_bf16 v[112:115], v[64:67], v[128:131], v[40:43]
    v_exp_f32 v96, v96
    v_mfma_f32_16x16x32_bf16 v[120:123], v[64:67], v[144:147], v[44:47]
    ds_read_b128 v[92:95], v2 offset:15360
    v_mfma_f32_16x16x32_bf16 v[112:115], v[68:71], v[132:135], v[112:115]
    v_exp_f32 v97, v97
    s_add_u32 s40, s40, 1
    v_mfma_f32_16x16x32_bf16 v[120:123], v[68:71], v[148:151], v[120:123]
    ds_read_b128 v[64:67], v3 offset:8192
    v_add_f32 v38, v38, v96
    s_add_u32 s49, s50, 32
    v_add_u32 v24, 65536, v2
    v_mfma_f32_16x16x32_bf16 v[112:115], v[72:75], v[136:139], v[112:115]
    v_exp_f32 v98, v98
    v_mfma_f32_16x16x32_bf16 v[120:123], v[72:75], v[152:155], v[120:123]
    ds_read_b128 v[68:71], v3 offset:9216
    v_add_f32 v38, v38, v97
    v_cvt_pk_bf16_f32 v48, v96, v97
    s_cmp_le_u32 s40, s51
    s_cselect_b32 s36, 64, 128
    v_mfma_f32_16x16x32_bf16 v[112:115], v[76:79], v[140:143], v[112:115]
    v_exp_f32 v99, v99
    v_mfma_f32_16x16x32_bf16 v[120:123], v[76:79], v[156:159], v[120:123]
    ds_read_b128 v[72:75], v3 offset:10240
    v_add_f32 v38, v38, v98
    s_add_u32 s41, s41, s36
    s_add_u32 s50, s50, s36
    s_waitcnt lgkmcnt(3)
    v_mfma_f32_16x16x32_bf16 v[116:119], v[80:83], v[128:131], v[40:43]
    v_exp_f32 v104, v104
    v_mfma_f32_16x16x32_bf16 v[124:127], v[80:83], v[144:147], v[44:47]
    ds_read_b128 v[76:79], v3 offset:11264
    v_add_f32 v38, v38, v99
    v_cvt_pk_bf16_f32 v49, v98, v99
    s_and_b32 s36, s41, 0xff
    v_lshl_add_u32 v2, s36, 8, v7
    v_mfma_f32_16x16x32_bf16 v[116:119], v[84:87], v[132:135], v[116:119]
    v_exp_f32 v105, v105
    v_mfma_f32_16x16x32_bf16 v[124:127], v[84:87], v[148:151], v[124:127]
    ds_read_b128 v[80:83], v3 offset:12288
    v_add_f32 v39, v39, v104
    s_cmp_eq_u32 s40, 16
    s_cselect_b64 s[20:21], -1, 0
    v_mfma_f32_16x16x32_bf16 v[116:119], v[88:91], v[136:139], v[116:119]
    v_exp_f32 v106, v106
    v_mfma_f32_16x16x32_bf16 v[124:127], v[88:91], v[152:155], v[124:127]
    ds_read_b128 v[84:87], v3 offset:13312
    v_add_f32 v39, v39, v105
    v_cvt_pk_bf16_f32 v52, v104, v105
    v_cndmask_b32 v5, v2, v24, s[20:21]
    v_mfma_f32_16x16x32_bf16 v[116:119], v[92:95], v[140:143], v[116:119]
    v_exp_f32 v107, v107
    v_mfma_f32_16x16x32_bf16 v[124:127], v[92:95], v[156:159], v[124:127]
    ds_read_b128 v[88:91], v3 offset:14336
    v_add_f32 v39, v39, v106
    s_waitcnt lgkmcnt(3)
    v_mfma_f32_16x16x32_bf16 v[192:195], v[64:67], v[56:59], v[192:195]
    v_exp_f32 v100, v100
    v_mfma_f32_16x16x32_bf16 v[224:227], v[64:67], v[60:63], v[224:227]
    ds_read_b128 v[92:95], v3 offset:15360
    v_add_f32 v39, v39, v107
    v_cvt_pk_bf16_f32 v53, v106, v107
    v_mfma_f32_16x16x32_bf16 v[196:199], v[68:71], v[56:59], v[196:199]
    v_exp_f32 v101, v101
    v_mfma_f32_16x16x32_bf16 v[228:231], v[68:71], v[60:63], v[228:231]
    v_add_f32 v38, v38, v100
    v_mov_b32 v3, v24
    v_mfma_f32_16x16x32_bf16 v[200:203], v[72:75], v[56:59], v[200:203]
    v_exp_f32 v102, v102
    v_mfma_f32_16x16x32_bf16 v[232:235], v[72:75], v[60:63], v[232:235]
    v_add_f32 v38, v38, v101
    v_cvt_pk_bf16_f32 v50, v100, v101
    s_waitcnt vmcnt(0) lgkmcnt(0)
    s_barrier
    v_mfma_f32_16x16x32_bf16 v[204:207], v[76:79], v[56:59], v[204:207]
    v_exp_f32 v103, v103
    v_mfma_f32_16x16x32_bf16 v[236:239], v[76:79], v[60:63], v[236:239]
    ds_read_b128 v[68:71], v5 offset:1024
    ds_read_b128 v[64:67], v5 offset:0
    v_add_f32 v38, v38, v102
    v_mfma_f32_16x16x32_bf16 v[208:211], v[80:83], v[56:59], v[208:211]
    v_exp_f32 v108, v108
    v_mfma_f32_16x16x32_bf16 v[240:243], v[80:83], v[60:63], v[240:243]
    ds_read_b128 v[76:79], v5 offset:3072
    ds_read_b128 v[72:75], v5 offset:2048
    v_add_f32 v38, v38, v103
    v_cvt_pk_bf16_f32 v51, v102, v103
    v_mfma_f32_16x16x32_bf16 v[212:215], v[84:87], v[56:59], v[212:215]
    v_exp_f32 v109, v109
    v_mfma_f32_16x16x32_bf16 v[244:247], v[84:87], v[60:63], v[244:247]
    ds_read_b128 v[80:83], v5 offset:4096
    v_add_f32 v39, v39, v108
    v_mfma_f32_16x16x32_bf16 v[216:219], v[88:91], v[56:59], v[216:219]
    v_exp_f32 v110, v110
    v_mfma_f32_16x16x32_bf16 v[248:251], v[88:91], v[60:63], v[248:251]
    ds_read_b128 v[84:87], v5 offset:5120
    v_add_f32 v39, v39, v109
    v_cvt_pk_bf16_f32 v54, v108, v109
    v_mfma_f32_16x16x32_bf16 v[220:223], v[92:95], v[56:59], v[220:223]
    v_exp_f32 v111, v111
    v_mfma_f32_16x16x32_bf16 v[252:255], v[92:95], v[60:63], v[252:255]
    ds_read_b128 v[88:91], v5 offset:6144
    v_add_f32 v39, v39, v110
    v_add_f32 v39, v39, v111
    v_cvt_pk_bf16_f32 v55, v110, v111
    s_cmp_lg_u32 s40, 16
    s_cbranch_scc1 L_body0
    s_cmp_lt_i32 s49, 0
    s_cbranch_scc0 L_attn_kernel_rare_15
L_attn_kernel_back_16:
    s_waitcnt lgkmcnt(5)
    v_mfma_f32_16x16x32_bf16 v[192:195], v[64:67], v[48:51], v[192:195]
    v_exp_f32 v112, v112
    v_mfma_f32_16x16x32_bf16 v[224:227], v[64:67], v[52:55], v[224:227]
    ds_read_b128 v[92:95], v3 offset:7168
    v_add_f32 v38, v38, v112
    v_exp_f32 v113, v113
    v_mfma_f32_16x16x32_bf16 v[196:199], v[68:71], v[48:51], v[196:199]
    v_add_f32 v38, v38, v113
    v_cvt_pk_bf16_f32 v56, v112, v113
    v_exp_f32 v114, v114
    v_mfma_f32_16x16x32_bf16 v[228:231], v[68:71], v[52:55], v[228:231]
    ds_read_b128 v[64:67], v3 offset:8192
    v_add_f32 v38, v38, v114
    v_exp_f32 v115, v115
    s_waitcnt lgkmcnt(5)
    v_mfma_f32_16x16x32_bf16 v[200:203], v[72:75], v[48:51], v[200:203]
    v_add_f32 v38, v38, v115
    v_cvt_pk_bf16_f32 v57, v114, v115
    v_exp_f32 v120, v120
    v_mfma_f32_16x16x32_bf16 v[232:235], v[72:75], v[52:55], v[232:235]
    ds_read_b128 v[68:71], v3 offset:9216
    v_add_f32 v39, v39, v120
    v_exp_f32 v121, v121
    v_mfma_f32_16x16x32_bf16 v[204:207], v[76:79], v[48:51], v[204:207]
    v_add_f32 v39, v39, v121
    v_cvt_pk_bf16_f32 v60, v120, v121
    v_exp_f32 v122, v122
    v_mfma_f32_16x16x32_bf16 v[236:239], v[76:79], v[52:55], v[236:239]
    ds_read_b128 v[72:75], v3 offset:10240
    v_add_f32 v39, v39, v122
    v_exp_f32 v123, v123
    s_waitcnt lgkmcnt(6)
    v_mfma_f32_16x16x32_bf16 v[208:211], v[80:83], v[48:51], v[208:211]
    v_add_f32 v39, v39, v123
    v_cvt_pk_bf16_f32 v61, v122, v123
    v_exp_f32 v116, v116
    v_mfma_f32_16x16x32_bf16 v[240:243], v[80:83], v[52:55], v[240:243]
    ds_read_b128 v[76:79], v3 offset:11264
    v_add_f32 v38, v38, v116
    v_exp_f32 v117, v117
    s_waitcnt lgkmcnt(6)
    v_mfma_f32_16x16x32_bf16 v[212:215], v[84:87], v[48:51], v[212:215]
    v_add_f32 v38, v38, v117
    v_cvt_pk_bf16_f32 v58, v116, v117
    v_exp_f32 v118, v118
    v_mfma_f32_16x16x32_bf16 v[244:247], v[84:87], v[52:55], v[244:247]
    ds_read_b128 v[80:83], v3 offset:12288
    v_add_f32 v38, v38, v118
    v_exp_f32 v119, v119
    s_waitcnt lgkmcnt(6)
    v_mfma_f32_16x16x32_bf16 v[216:219], v[88:91], v[48:51], v[216:219]
    v_add_f32 v38, v38, v119
    v_cvt_pk_bf16_f32 v59, v118, v119
    v_exp_f32 v124, v124
    v_mfma_f32_16x16x32_bf16 v[248:251], v[88:91], v[52:55], v[248:251]
    ds_read_b128 v[84:87], v3 offset:13312
    v_add_f32 v39, v39, v124
    v_exp_f32 v125, v125
    s_waitcnt lgkmcnt(6)
    v_mfma_f32_16x16x32_bf16 v[220:223], v[92:95], v[48:51], v[220:223]
    v_add_f32 v39, v39, v125
    v_cvt_pk_bf16_f32 v62, v124, v125
    v_exp_f32 v126, v126
    v_mfma_f32_16x16x32_bf16 v[252:255], v[92:95], v[52:55], v[252:255]
    ds_read_b128 v[88:91], v3 offset:14336
    v_add_f32 v39, v39, v126
    v_exp_f32 v127, v127
    s_nop 0
    v_add_f32 v39, v39, v127
    v_cvt_pk_bf16_f32 v63, v126, v127
    s_nop 1
    s_waitcnt lgkmcnt(6)
    v_mfma_f32_16x16x32_bf16 v[192:195], v[64:67], v[56:59], v[192:195]
    v_mfma_f32_16x16x32_bf16 v[224:227], v[64:67], v[60:63], v[224:227]
    ds_read_b128 v[92:95], v3 offset:15360
    s_waitcnt lgkmcnt(6)
    v_mfma_f32_16x16x32_bf16 v[196:199], v[68:71], v[56:59], v[196:199]
    v_mfma_f32_16x16x32_bf16 v[228:231], v[68:71], v[60:63], v[228:231]
    s_waitcnt lgkmcnt(5)
    v_mfma_f32_16x16x32_bf16 v[200:203], v[72:75], v[56:59], v[200:203]
    v_mfma_f32_16x16x32_bf16 v[232:235], v[72:75], v[60:63], v[232:235]
    s_waitcnt lgkmcnt(4)
    v_mfma_f32_16x16x32_bf16 v[204:207], v[76:79], v[56:59], v[204:207]
    v_mfma_f32_16x16x32_bf16 v[236:239], v[76:79], v[60:63], v[236:239]
    s_waitcnt lgkmcnt(3)
    v_mfma_f32_16x16x32_bf16 v[208:211], v[80:83], v[56:59], v[208:211]
    v_mfma_f32_16x16x32_bf16 v[240:243], v[80:83], v[60:63], v[240:243]
    s_waitcnt lgkmcnt(2)
    v_mfma_f32_16x16x32_bf16 v[212:215], v[84:87], v[56:59], v[212:215]
    v_mfma_f32_16x16x32_bf16 v[244:247], v[84:87], v[60:63], v[244:247]
    s_waitcnt lgkmcnt(1)
    v_mfma_f32_16x16x32_bf16 v[216:219], v[88:91], v[56:59], v[216:219]
    v_mfma_f32_16x16x32_bf16 v[248:251], v[88:91], v[60:63], v[248:251]
    s_waitcnt lgkmcnt(0)
    v_mfma_f32_16x16x32_bf16 v[220:223], v[92:95], v[56:59], v[220:223]
    v_mfma_f32_16x16x32_bf16 v[252:255], v[92:95], v[60:63], v[252:255]
    s_lshl_b32 s37, s28, 13
    v_add_u32 v21, s37, v7
    v_xor_b32 v22, 32768, v21
    s_lshl_b32 s37, s28, 8
    s_add_u32 s37, s37, 131072
    v_lshl_add_u32 v23, v1, 2, s37
    v_xor_b32 v24, 1024, v23
    ds_write_b32 v23, v39
    s_mov_b32 s36, 0x5d800000
    v_cmp_nge_f32 vcc, s36, v38
    s_nop 0
    s_or_b64 s[52:53], s[52:53], vcc
    v_cmp_nge_f32 vcc, s36, v39
    s_nop 0
    s_or_b64 s[52:53], s[52:53], vcc
    s_or_b32 s36, s52, s53
    v_mov_b32 v26, s36
    s_lshl_b32 s37, s28, 2
    s_add_u32 s37, s37, 135168
    v_mov_b32 v27, s37
    ds_write_b32 v27, v26
    ds_write_b128 v21, v[224:227] offset:0
    ds_write_b128 v21, v[228:231] offset:1024
    ds_write_b128 v21, v[232:235] offset:2048
    ds_write_b128 v21, v[236:239] offset:3072
    ds_write_b128 v21, v[240:243] offset:4096
    ds_write_b128 v21, v[244:247] offset:5120
    ds_write_b128 v21, v[248:251] offset:6144
    ds_write_b128 v21, v[252:255] offset:7168
    v_and_b32 v27, 7, v1
    v_lshlrev_b32 v27, 2, v27
    v_add_u32 v27, 135168, v27
    s_sub_u32 s36, 15, s30
    s_lshl_b32 s38, s36, 3
    s_and_b32 s37, s28, 3
    s_lshl_b32 s37, s37, 1
    s_add_u32 s38, s38, s37
    s_lshl_b32 s38, s38, 17
    s_lshl_b32 s37, s29, 12
    s_add_u32 s38, s38, s37
    s_waitcnt lgkmcnt(0)
    s_barrier
    ds_read_b32 v26, v27
    ds_read_b32 v25, v24
    ds_read_b128 v[64:67], v22 offset:0
    ds_read_b128 v[68:71], v22 offset:1024
    ds_read_b128 v[72:75], v22 offset:2048
    ds_read_b128 v[76:79], v22 offset:3072
    ds_read_b128 v[80:83], v22 offset:4096
    ds_read_b128 v[84:87], v22 offset:5120
    ds_read_b128 v[88:91], v22 offset:6144
    ds_read_b128 v[92:95], v22 offset:7168
    s_waitcnt lgkmcnt(8)
    v_add_f32 v25, v25, v38
    v_mov_b32 v20, v25
    s_nop 1
    v_permlane16_swap_b32 v25, v20
    s_nop 1
    v_add_f32 v25, v25, v20
    v_mov_b32 v20, v25
    s_nop 1
    v_permlane32_swap_b32 v25, v20
    s_nop 1
    v_add_f32 v25, v25, v20
    v_cmp_ne_u32 s[52:53], 0, v26
    v_rcp_f32 v25, v25
    s_waitcnt lgkmcnt(6)
    v_add_f32 v192, v192, v64
    v_add_f32 v193, v193, v65
    v_add_f32 v194, v194, v66
    v_add_f32 v195, v195, v67
    v_add_f32 v196, v196, v68
    v_add_f32 v197, v197, v69
    v_add_f32 v198, v198, v70
    v_add_f32 v199, v199, v71
    v_mul_f32 v192, v25, v192
    v_mul_f32 v193, v25, v193
    v_mul_f32 v194, v25, v194
    v_mul_f32 v195, v25, v195
    v_mul_f32 v196, v25, v196
    v_mul_f32 v197, v25, v197
    v_mul_f32 v198, v25, v198
    v_mul_f32 v199, v25, v199
    v_cvt_pk_bf16_f32 v48, v192, v193
    v_cvt_pk_bf16_f32 v49, v194, v195
    v_cvt_pk_bf16_f32 v50, v196, v197
    v_cvt_pk_bf16_f32 v51, v198, v199
    buffer_store_dwordx4 v[48:51], v7, s[16:19], s38 offen offset:0
    s_waitcnt lgkmcnt(4)
    v_add_f32 v200, v200, v72
    v_add_f32 v201, v201, v73
    v_add_f32 v202, v202, v74
    v_add_f32 v203, v203, v75
    v_add_f32 v204, v204, v76
    v_add_f32 v205, v205, v77
    v_add_f32 v206, v206, v78
    v_add_f32 v207, v207, v79
    v_mul_f32 v200, v25, v200
    v_mul_f32 v201, v25, v201
    v_mul_f32 v202, v25, v202
    v_mul_f32 v203, v25, v203
    v_mul_f32 v204, v25, v204
    v_mul_f32 v205, v25, v205
    v_mul_f32 v206, v25, v206
    v_mul_f32 v207, v25, v207
    v_cvt_pk_bf16_f32 v52, v200, v201
    v_cvt_pk_bf16_f32 v53, v202, v203
    v_cvt_pk_bf16_f32 v54, v204, v205
    v_cvt_pk_bf16_f32 v55, v206, v207
    buffer_store_dwordx4 v[52:55], v7, s[16:19], s38 offen offset:1024
    s_waitcnt lgkmcnt(2)
    v_add_f32 v208, v208, v80
    v_add_f32 v209, v209, v81
    v_add_f32 v210, v210, v82
    v_add_f32 v211, v211, v83
    v_add_f32 v212, v212, v84
    v_add_f32 v213, v213, v85
    v_add_f32 v214, v214, v86
    v_add_f32 v215, v215, v87
    v_mul_f32 v208, v25, v208
    v_mul_f32 v209, v25, v209
    v_mul_f32 v210, v25, v210
    v_mul_f32 v211, v25, v211
    v_mul_f32 v212, v25, v212
    v_mul_f32 v213, v25, v213
    v_mul_f32 v214, v25, v214
    v_mul_f32 v215, v25, v215
    v_cvt_pk_bf16_f32 v56, v208, v209
    v_cvt_pk_bf16_f32 v57, v210, v211
    v_cvt_pk_bf16_f32 v58, v212, v213
    v_cvt_pk_bf16_f32 v59, v214, v215
    buffer_store_dwordx4 v[56:59], v7, s[16:19], s38 offen offset:2048
    s_waitcnt lgkmcnt(0)
    v_add_f32 v216, v216, v88
    v_add_f32 v217, v217, v89
    v_add_f32 v218, v218, v90
    v_add_f32 v219, v219, v91
    v_add_f32 v220, v220, v92
    v_add_f32 v221, v221, v93
    v_add_f32 v222, v222, v94
    v_add_f32 v223, v223, v95
    v_mul_f32 v216, v25, v216
    v_mul_f32 v217, v25, v217
    v_mul_f32 v218, v25, v218
    v_mul_f32 v219, v25, v219
    v_mul_f32 v220, v25, v220
    v_mul_f32 v221, v25, v221
    v_mul_f32 v222, v25, v222
    v_mul_f32 v223, v25, v223
    v_cvt_pk_bf16_f32 v60, v216, v217
    v_cvt_pk_bf16_f32 v61, v218, v219
    v_cvt_pk_bf16_f32 v62, v220, v221
    v_cvt_pk_bf16_f32 v63, v222, v223
    buffer_store_dwordx4 v[60:63], v7, s[16:19], s38 offen offset:3072
    s_cmp_eq_u64 s[52:53], 0
    s_cbranch_scc1 L_p3_done
    v_mov_b32 v192, 0
    v_mov_b32 v193, 0
    v_mov_b32 v194, 0
    v_mov_b32 v195, 0
    v_mov_b32 v196, 0
    v_mov_b32 v197, 0
    v_mov_b32 v198, 0
    v_mov_b32 v199, 0
    v_mov_b32 v200, 0
    v_mov_b32 v201, 0
    v_mov_b32 v202, 0
    v_mov_b32 v203, 0
    v_mov_b32 v204, 0
    v_mov_b32 v205, 0
    v_mov_b32 v206, 0
    v_mov_b32 v207, 0
    v_mov_b32 v208, 0
    v_mov_b32 v209, 0
    v_mov_b32 v210, 0
    v_mov_b32 v211, 0
    v_mov_b32 v212, 0
    v_mov_b32 v213, 0
    v_mov_b32 v214, 0
    v_mov_b32 v215, 0
    v_mov_b32 v216, 0
    v_mov_b32 v217, 0
    v_mov_b32 v218, 0
    v_mov_b32 v219, 0
    v_mov_b32 v220, 0
    v_mov_b32 v221, 0
    v_mov_b32 v222, 0
    v_mov_b32 v223, 0
    v_mov_b32 v224, 0
    v_mov_b32 v225, 0
    v_mov_b32 v226, 0
    v_mov_b32 v227, 0
    v_mov_b32 v228, 0
    v_mov_b32 v229, 0
    v_mov_b32 v230, 0
    v_mov_b32 v231, 0
    v_mov_b32 v232, 0
    v_mov_b32 v233, 0
    v_mov_b32 v234, 0
    v_mov_b32 v235, 0
    v_mov_b32 v236, 0
    v_mov_b32 v237, 0
    v_mov_b32 v238, 0
    v_mov_b32 v239, 0
    v_mov_b32 v240, 0
    v_mov_b32 v241, 0
    v_mov_b32 v242, 0
    v_mov_b32 v243, 0
    v_mov_b32 v244, 0
    v_mov_b32 v245, 0
    v_mov_b32 v246, 0
    v_mov_b32 v247, 0
    v_mov_b32 v248, 0
    v_mov_b32 v249, 0
    v_mov_b32 v250, 0
    v_mov_b32 v251, 0
    v_mov_b32 v252, 0
    v_mov_b32 v253, 0
    v_mov_b32 v254, 0
    v_mov_b32 v255, 0
    v_mov_b32 v38, 0
    v_mov_b32 v40, 4048155338
    v_mov_b32 v39, 0
    v_mov_b32 v41, 4048155338
    s_lshl_b32 s43, s28, 12
    v_add_u32 v4, s43, v7
    s_mov_b32 s46, s45
    s_sub_u32 s40, 16, s30
    s_sub_u32 s39, 15, s30
    s_lshl_b32 s37, s39, 7
    s_and_b32 s36, s28, 3
    s_lshl_b32 s36, s36, 5
    s_add_u32 s36, s36, s37
    s_sub_u32 s50, 0, s36
L_attn_kernel_stile_17:
    s_waitcnt vmcnt(0) lgkmcnt(0)
    s_barrier
    s_mov_b32 m0, s43
    s_add_u32 s47, s46, 32768
    buffer_load_dwordx4 v4, s[12:15], s46 offen offset:0 lds
    buffer_load_dwordx4 v4, s[12:15], s46 offen offset:1024 lds
    buffer_load_dwordx4 v4, s[12:15], s46 offen offset:2048 lds
    buffer_load_dwordx4 v4, s[12:15], s46 offen offset:3072 lds
    s_add_u32 m0, s43, 32768
    s_add_u32 s46, s46, 65536
    buffer_load_dwordx4 v4, s[12:15], s47 offen offset:0 lds
    buffer_load_dwordx4 v4, s[12:15], s47 offen offset:1024 lds
    buffer_load_dwordx4 v4, s[12:15], s47 offen offset:2048 lds
    buffer_load_dwordx4 v4, s[12:15], s47 offen offset:3072 lds
    v_mov_b32 v2, v7
    s_mov_b32 s41, 4
    s_waitcnt vmcnt(0)
    s_barrier
L_attn_kernel_sunit_18:
    s_cmp_gt_i32 s50, 0
    s_cbranch_scc1 L_attn_kernel_snext_19
    ds_read_b128 v[64:67], v2 offset:0
    ds_read_b128 v[68:71], v2 offset:1024
    ds_read_b128 v[72:75], v2 offset:2048
    ds_read_b128 v[76:79], v2 offset:3072
    ds_read_b128 v[80:83], v2 offset:4096
    ds_read_b128 v[84:87], v2 offset:5120
    ds_read_b128 v[88:91], v2 offset:6144
    ds_read_b128 v[92:95], v2 offset:7168
    s_waitcnt lgkmcnt(0)
    v_mfma_f32_16x16x32_bf16 v[96:99], v[64:67], v[128:131], 0
    v_mfma_f32_16x16x32_bf16 v[104:107], v[64:67], v[144:147], 0
    v_mfma_f32_16x16x32_bf16 v[96:99], v[68:71], v[132:135], v[96:99]
    v_mfma_f32_16x16x32_bf16 v[104:107], v[68:71], v[148:151], v[104:107]
    v_mfma_f32_16x16x32_bf16 v[96:99], v[72:75], v[136:139], v[96:99]
    v_mfma_f32_16x16x32_bf16 v[104:107], v[72:75], v[152:155], v[104:107]
    v_mfma_f32_16x16x32_bf16 v[96:99], v[76:79], v[140:143], v[96:99]
    v_mfma_f32_16x16x32_bf16 v[104:107], v[76:79], v[156:159], v[104:107]
    v_mfma_f32_16x16x32_bf16 v[100:103], v[80:83], v[128:131], 0
    v_mfma_f32_16x16x32_bf16 v[108:111], v[80:83], v[144:147], 0
    v_mfma_f32_16x16x32_bf16 v[100:103], v[84:87], v[132:135], v[100:103]
    v_mfma_f32_16x16x32_bf16 v[108:111], v[84:87], v[148:151], v[108:111]
    v_mfma_f32_16x16x32_bf16 v[100:103], v[88:91], v[136:139], v[100:103]
    v_mfma_f32_16x16x32_bf16 v[108:111], v[88:91], v[152:155], v[108:111]
    v_mfma_f32_16x16x32_bf16 v[100:103], v[92:95], v[140:143], v[100:103]
    v_mfma_f32_16x16x32_bf16 v[108:111], v[92:95], v[156:159], v[108:111]
    ds_read_b128 v[64:67], v2 offset:32768
    ds_read_b128 v[68:71], v2 offset:33792
    ds_read_b128 v[72:75], v2 offset:34816
    ds_read_b128 v[76:79], v2 offset:35840
    ds_read_b128 v[80:83], v2 offset:36864
    ds_read_b128 v[84:87], v2 offset:37888
    ds_read_b128 v[88:91], v2 offset:38912
    ds_read_b128 v[92:95], v2 offset:39936
    s_nop 1
    s_cmp_lt_i32 s50, 0
    s_cbranch_scc0 L_attn_kernel_rare_20
L_attn_kernel_back_21:
    v_max3_f32 v22, v96, v97, v98
    v_max3_f32 v22, v22, v99, v100
    v_max3_f32 v22, v22, v101, v102
    v_max3_f32 v22, v22, v103, v40
    v_mov_b32 v24, v22
    s_nop 1
    v_permlane16_swap_b32 v22, v24
    s_nop 1
    v_max_f32 v22, v22, v24
    v_mov_b32 v24, v22
    s_nop 1
    v_permlane32_swap_b32 v22, v24
    s_nop 1
    v_max_f32 v22, v22, v24
    v_sub_f32 v25, v40, v22
    v_exp_f32 v25, v25
    v_mov_b32 v40, v22
    v_mul_f32 v38, v38, v25
    v_mul_f32 v192, v192, v25
    v_mul_f32 v193, v193, v25
    v_mul_f32 v194, v194, v25
    v_mul_f32 v195, v195, v25
    v_mul_f32 v196, v196, v25
    v_mul_f32 v197, v197, v25
    v_mul_f32 v198, v198, v25
    v_mul_f32 v199, v199, v25
    v_mul_f32 v200, v200, v25
    v_mul_f32 v201, v201, v25
    v_mul_f32 v202, v202, v25
    v_mul_f32 v203, v203, v25
    v_mul_f32 v204, v204, v25
    v_mul_f32 v205, v205, v25
    v_mul_f32 v206, v206, v25
    v_mul_f32 v207, v207, v25
    v_mul_f32 v208, v208, v25
    v_mul_f32 v209, v209, v25
    v_mul_f32 v210, v210, v25
    v_mul_f32 v211, v211, v25
    v_mul_f32 v212, v212, v25
    v_mul_f32 v213, v213, v25
    v_mul_f32 v214, v214, v25
    v_mul_f32 v215, v215, v25
    v_mul_f32 v216, v216, v25
    v_mul_f32 v217, v217, v25
    v_mul_f32 v218, v218, v25
    v_mul_f32 v219, v219, v25
    v_mul_f32 v220, v220, v25
    v_mul_f32 v221, v221, v25
    v_mul_f32 v222, v222, v25
    v_mul_f32 v223, v223, v25
    v_sub_f32 v96, v96, v22
    v_sub_f32 v97, v97, v22
    v_sub_f32 v98, v98, v22
    v_sub_f32 v99, v99, v22
    v_sub_f32 v100, v100, v22
    v_sub_f32 v101, v101, v22
    v_sub_f32 v102, v102, v22
    v_sub_f32 v103, v103, v22
    v_max3_f32 v23, v104, v105, v106
    v_max3_f32 v23, v23, v107, v108
    v_max3_f32 v23, v23, v109, v110
    v_max3_f32 v23, v23, v111, v41
    v_mov_b32 v24, v23
    s_nop 1
    v_permlane16_swap_b32 v23, v24
    s_nop 1
    v_max_f32 v23, v23, v24
    v_mov_b32 v24, v23
    s_nop 1
    v_permlane32_swap_b32 v23, v24
    s_nop 1
    v_max_f32 v23, v23, v24
    v_sub_f32 v25, v41, v23
    v_exp_f32 v25, v25
    v_mov_b32 v41, v23
    v_mul_f32 v39, v39, v25
    v_mul_f32 v224, v224, v25
    v_mul_f32 v225, v225, v25
    v_mul_f32 v226, v226, v25
    v_mul_f32 v227, v227, v25
    v_mul_f32 v228, v228, v25
    v_mul_f32 v229, v229, v25
    v_mul_f32 v230, v230, v25
    v_mul_f32 v231, v231, v25
    v_mul_f32 v232, v232, v25
    v_mul_f32 v233, v233, v25
    v_mul_f32 v234, v234, v25
    v_mul_f32 v235, v235, v25
    v_mul_f32 v236, v236, v25
    v_mul_f32 v237, v237, v25
    v_mul_f32 v238, v238, v25
    v_mul_f32 v239, v239, v25
    v_mul_f32 v240, v240, v25
    v_mul_f32 v241, v241, v25
    v_mul_f32 v242, v242, v25
    v_mul_f32 v243, v243, v25
    v_mul_f32 v244, v244, v25
    v_mul_f32 v245, v245, v25
    v_mul_f32 v246, v246, v25
    v_mul_f32 v247, v247, v25
    v_mul_f32 v248, v248, v25
    v_mul_f32 v249, v249, v25
    v_mul_f32 v250, v250, v25
    v_mul_f32 v251, v251, v25
    v_mul_f32 v252, v252, v25
    v_mul_f32 v253, v253, v25
    v_mul_f32 v254, v254, v25
    v_mul_f32 v255, v255, v25
    v_sub_f32 v104, v104, v23
    v_sub_f32 v105, v105, v23
    v_sub_f32 v106, v106, v23
    v_sub_f32 v107, v107, v23
    v_sub_f32 v108, v108, v23
    v_sub_f32 v109, v109, v23
    v_sub_f32 v110, v110, v23
    v_sub_f32 v111, v111, v23
    v_exp_f32 v96, v96
    v_exp_f32 v97, v97
    v_exp_f32 v98, v98
    v_exp_f32 v99, v99
    v_exp_f32 v104, v104
    v_exp_f32 v105, v105
    v_exp_f32 v106, v106
    v_exp_f32 v107, v107
    v_exp_f32 v100, v100
    v_exp_f32 v101, v101
    v_exp_f32 v102, v102
    v_exp_f32 v103, v103
    v_exp_f32 v108, v108
    v_exp_f32 v109, v109
    v_exp_f32 v110, v110
    v_exp_f32 v111, v111
    v_add_f32 v38, v38, v96
    v_add_f32 v38, v38, v97
    v_cvt_pk_bf16_f32 v48, v96, v97
    v_add_f32 v38, v38, v98
    v_add_f32 v38, v38, v99
    v_cvt_pk_bf16_f32 v49, v98, v99
    v_add_f32 v39, v39, v104
    v_add_f32 v39, v39, v105
    v_cvt_pk_bf16_f32 v52, v104, v105
    v_add_f32 v39, v39, v106
    v_add_f32 v39, v39, v107
    v_cvt_pk_bf16_f32 v53, v106, v107
    v_add_f32 v38, v38, v100
    v_add_f32 v38, v38, v101
    v_cvt_pk_bf16_f32 v50, v100, v101
    v_add_f32 v38, v38, v102
    v_add_f32 v38, v38, v103
    v_cvt_pk_bf16_f32 v51, v102, v103
    v_add_f32 v39, v39, v108
    v_add_f32 v39, v39, v109
    v_cvt_pk_bf16_f32 v54, v108, v109
    v_add_f32 v39, v39, v110
    v_add_f32 v39, v39, v111
    v_cvt_pk_bf16_f32 v55, v110, v111
    s_waitcnt lgkmcnt(0)
    s_nop 0
    v_mfma_f32_16x16x32_bf16 v[192:195], v[64:67], v[48:51], v[192:195]
    v_mfma_f32_16x16x32_bf16 v[224:227], v[64:67], v[52:55], v[224:227]
    v_mfma_f32_16x16x32_bf16 v[196:199], v[68:71], v[48:51], v[196:199]
    v_mfma_f32_16x16x32_bf16 v[228:231], v[68:71], v[52:55], v[228:231]
    v_mfma_f32_16x16x32_bf16 v[200:203], v[72:75], v[48:51], v[200:203]
    v_mfma_f32_16x16x32_bf16 v[232:235], v[72:75], v[52:55], v[232:235]
    v_mfma_f32_16x16x32_bf16 v[204:207], v[76:79], v[48:51], v[204:207]
    v_mfma_f32_16x16x32_bf16 v[236:239], v[76:79], v[52:55], v[236:239]
    v_mfma_f32_16x16x32_bf16 v[208:211], v[80:83], v[48:51], v[208:211]
    v_mfma_f32_16x16x32_bf16 v[240:243], v[80:83], v[52:55], v[240:243]
    v_mfma_f32_16x16x32_bf16 v[212:215], v[84:87], v[48:51], v[212:215]
    v_mfma_f32_16x16x32_bf16 v[244:247], v[84:87], v[52:55], v[244:247]
    v_mfma_f32_16x16x32_bf16 v[216:219], v[88:91], v[48:51], v[216:219]
    v_mfma_f32_16x16x32_bf16 v[248:251], v[88:91], v[52:55], v[248:251]
    v_mfma_f32_16x16x32_bf16 v[220:223], v[92:95], v[48:51], v[220:223]
    v_mfma_f32_16x16x32_bf16 v[252:255], v[92:95], v[52:55], v[252:255]
L_attn_kernel_snext_19:
    v_add_u32 v2, 8192, v2
    s_add_u32 s50, s50, 32
    s_sub_u32 s41, s41, 1
    s_cmp_lg_u32 s41, 0
    s_cbranch_scc1 L_attn_kernel_sunit_18
    s_sub_u32 s40, s40, 1
    s_cmp_lg_u32 s40, 0
    s_cbranch_scc1 L_attn_kernel_stile_17
    v_mov_b32 v20, v38
    s_nop 1
    v_permlane16_swap_b32 v38, v20
    s_nop 1
    v_add_f32 v38, v38, v20
    v_mov_b32 v20, v38
    s_nop 1
    v_permlane32_swap_b32 v38, v20
    s_nop 1
    v_add_f32 v38, v38, v20
    v_mov_b32 v20, v39
    s_nop 1
    v_permlane16_swap_b32 v39, v20
    s_nop 1
    v_add_f32 v39, v39, v20
    v_mov_b32 v20, v39
    s_nop 1
    v_permlane32_swap_b32 v39, v20
    s_nop 1
    v_add_f32 v39, v39, v20
    s_mov_b32 s36, 0x5d800000
    v_cmp_nge_f32 vcc, s36, v38
    s_nop 0
    s_or_b64 s[52:53], s[52:53], vcc
    v_cmp_nge_f32 vcc, s36, v39
    s_nop 0
    s_or_b64 s[52:53], s[52:53], vcc
    v_rcp_f32 v38, v38
    v_rcp_f32 v39, v39
    s_lshl_b32 s38, s39, 3
    s_and_b32 s37, s28, 3
    s_lshl_b32 s37, s37, 1
    s_add_u32 s38, s38, s37
    s_lshl_b32 s38, s38, 17
    s_lshl_b32 s37, s29, 12
    s_add_u32 s38, s38, s37
    v_mul_f32 v192, v38, v192
    v_mul_f32 v193, v38, v193
    v_mul_f32 v194, v38, v194
    v_mul_f32 v195, v38, v195
    v_mul_f32 v196, v38, v196
    v_mul_f32 v197, v38, v197
    v_mul_f32 v198, v38, v198
    v_mul_f32 v199, v38, v199
    v_cvt_pk_bf16_f32 v22, v192, v193
    v_cvt_pk_bf16_f32 v23, v194, v195
    v_cvt_pk_bf16_f32 v24, v196, v197
    v_cvt_pk_bf16_f32 v25, v198, v199
    buffer_store_dwordx4 v[22:25], v7, s[16:19], s38 offen offset:0
    v_mul_f32 v200, v38, v200
    v_mul_f32 v201, v38, v201
    v_mul_f32 v202, v38, v202
    v_mul_f32 v203, v38, v203
    v_mul_f32 v204, v38, v204
    v_mul_f32 v205, v38, v205
    v_mul_f32 v206, v38, v206
    v_mul_f32 v207, v38, v207
    v_cvt_pk_bf16_f32 v26, v200, v201
    v_cvt_pk_bf16_f32 v27, v202, v203
    v_cvt_pk_bf16_f32 v28, v204, v205
    v_cvt_pk_bf16_f32 v29, v206, v207
    buffer_store_dwordx4 v[26:29], v7, s[16:19], s38 offen offset:1024
    v_mul_f32 v208, v38, v208
    v_mul_f32 v209, v38, v209
    v_mul_f32 v210, v38, v210
    v_mul_f32 v211, v38, v211
    v_mul_f32 v212, v38, v212
    v_mul_f32 v213, v38, v213
    v_mul_f32 v214, v38, v214
    v_mul_f32 v215, v38, v215
    v_cvt_pk_bf16_f32 v30, v208, v209
    v_cvt_pk_bf16_f32 v31, v210, v211
    v_cvt_pk_bf16_f32 v32, v212, v213
    v_cvt_pk_bf16_f32 v33, v214, v215
    buffer_store_dwordx4 v[30:33], v7, s[16:19], s38 offen offset:2048
    v_mul_f32 v216, v38, v216
    v_mul_f32 v217, v38, v217
    v_mul_f32 v218, v38, v218
    v_mul_f32 v219, v38, v219
    v_mul_f32 v220, v38, v220
    v_mul_f32 v221, v38, v221
    v_mul_f32 v222, v38, v222
    v_mul_f32 v223, v38, v223
    v_cvt_pk_bf16_f32 v34, v216, v217
    v_cvt_pk_bf16_f32 v35, v218, v219
    v_cvt_pk_bf16_f32 v36, v220, v221
    v_cvt_pk_bf16_f32 v37, v222, v223
    buffer_store_dwordx4 v[34:37], v7, s[16:19], s38 offen offset:3072
    s_add_u32 s38, s38, 131072
    v_mul_f32 v224, v39, v224
    v_mul_f32 v225, v39, v225
    v_mul_f32 v226, v39, v226
    v_mul_f32 v227, v39, v227
    v_mul_f32 v228, v39, v228
    v_mul_f32 v229, v39, v229
    v_mul_f32 v230, v39, v230
    v_mul_f32 v231, v39, v231
    v_cvt_pk_bf16_f32 v22, v224, v225
    v_cvt_pk_bf16_f32 v23, v226, v227
    v_cvt_pk_bf16_f32 v24, v228, v229
    v_cvt_pk_bf16_f32 v25, v230, v231
    buffer_store_dwordx4 v[22:25], v7, s[16:19], s38 offen offset:0
    v_mul_f32 v232, v39, v232
    v_mul_f32 v233, v39, v233
    v_mul_f32 v234, v39, v234
    v_mul_f32 v235, v39, v235
    v_mul_f32 v236, v39, v236
    v_mul_f32 v237, v39, v237
    v_mul_f32 v238, v39, v238
    v_mul_f32 v239, v39, v239
    v_cvt_pk_bf16_f32 v26, v232, v233
    v_cvt_pk_bf16_f32 v27, v234, v235
    v_cvt_pk_bf16_f32 v28, v236, v237
    v_cvt_pk_bf16_f32 v29, v238, v239
    buffer_store_dwordx4 v[26:29], v7, s[16:19], s38 offen offset:1024
    v_mul_f32 v240, v39, v240
    v_mul_f32 v241, v39, v241
    v_mul_f32 v242, v39, v242
    v_mul_f32 v243, v39, v243
    v_mul_f32 v244, v39, v244
    v_mul_f32 v245, v39, v245
    v_mul_f32 v246, v39, v246
    v_mul_f32 v247, v39, v247
    v_cvt_pk_bf16_f32 v30, v240, v241
    v_cvt_pk_bf16_f32 v31, v242, v243
    v_cvt_pk_bf16_f32 v32, v244, v245
    v_cvt_pk_bf16_f32 v33, v246, v247
    buffer_store_dwordx4 v[30:33], v7, s[16:19], s38 offen offset:2048
    v_mul_f32 v248, v39, v248
    v_mul_f32 v249, v39, v249
    v_mul_f32 v250, v39, v250
    v_mul_f32 v251, v39, v251
    v_mul_f32 v252, v39, v252
    v_mul_f32 v253, v39, v253
    v_mul_f32 v254, v39, v254
    v_mul_f32 v255, v39, v255
    v_cvt_pk_bf16_f32 v34, v248, v249
    v_cvt_pk_bf16_f32 v35, v250, v251
    v_cvt_pk_bf16_f32 v36, v252, v253
    v_cvt_pk_bf16_f32 v37, v254, v255
    buffer_store_dwordx4 v[34:37], v7, s[16:19], s38 offen offset:3072
    s_branch L_p3_done
L_attn_kernel_rare_1:
    v_mov_b32 v20, 4048155338
    v_subrev_u32 v21, s50, v18
    v_cmp_gt_i32 s[20:21], 0, v21
    v_cmp_gt_i32 s[22:23], 1, v21
    v_cmp_gt_i32 s[24:25], 2, v21
    v_cmp_gt_i32 s[26:27], 3, v21
    v_cndmask_b32 v96, v96, v20, s[20:21]
    v_cndmask_b32 v97, v97, v20, s[22:23]
    v_cndmask_b32 v98, v98, v20, s[24:25]
    v_cndmask_b32 v99, v99, v20, s[26:27]
    v_cmp_gt_i32 s[20:21], 16, v21
    v_cmp_gt_i32 s[22:23], 17, v21
    v_cmp_gt_i32 s[24:25], 18, v21
    v_cmp_gt_i32 s[26:27], 19, v21
    v_cndmask_b32 v100, v100, v20, s[20:21]
    v_cndmask_b32 v101, v101, v20, s[22:23]
    v_cndmask_b32 v102, v102, v20, s[24:25]
    v_cndmask_b32 v103, v103, v20, s[26:27]
    v_cmp_gt_i32 s[20:21], -16, v21
    v_cmp_gt_i32 s[22:23], -15, v21
    v_cmp_gt_i32 s[24:25], -14, v21
    v_cmp_gt_i32 s[26:27], -13, v21
    v_cndmask_b32 v104, v104, v20, s[20:21]
    v_cndmask_b32 v105, v105, v20, s[22:23]
    v_cndmask_b32 v106, v106, v20, s[24:25]
    v_cndmask_b32 v107, v107, v20, s[26:27]
    v_cmp_gt_i32 s[20:21], 0, v21
    v_cmp_gt_i32 s[22:23], 1, v21
    v_cmp_gt_i32 s[24:25], 2, v21
    v_cmp_gt_i32 s[26:27], 3, v21
    v_cndmask_b32 v108, v108, v20, s[20:21]
    v_cndmask_b32 v109, v109, v20, s[22:23]
    v_cndmask_b32 v110, v110, v20, s[24:25]
    v_cndmask_b32 v111, v111, v20, s[26:27]
    s_branch L_attn_kernel_back_2
L_attn_kernel_rare_3:
    v_mov_b32 v20, 4048155338
    v_subrev_u32 v21, s49, v18
    v_cmp_gt_i32 s[20:21], 0, v21
    v_cmp_gt_i32 s[22:23], 1, v21
    v_cmp_gt_i32 s[24:25], 2, v21
    v_cmp_gt_i32 s[26:27], 3, v21
    v_cndmask_b32 v112, v112, v20, s[20:21]
    v_cndmask_b32 v113, v113, v20, s[22:23]
    v_cndmask_b32 v114, v114, v20, s[24:25]
    v_cndmask_b32 v115, v115, v20, s[26:27]
    v_cmp_gt_i32 s[20:21], 16, v21
    v_cmp_gt_i32 s[22:23], 17, v21
    v_cmp_gt_i32 s[24:25], 18, v21
    v_cmp_gt_i32 s[26:27], 19, v21
    v_cndmask_b32 v116, v116, v20, s[20:21]
    v_cndmask_b32 v117, v117, v20, s[22:23]
    v_cndmask_b32 v118, v118, v20, s[24:25]
    v_cndmask_b32 v119, v119, v20, s[26:27]
    v_cmp_gt_i32 s[20:21], -16, v21
    v_cmp_gt_i32 s[22:23], -15, v21
    v_cmp_gt_i32 s[24:25], -14, v21
    v_cmp_gt_i32 s[26:27], -13, v21
    v_cndmask_b32 v120, v120, v20, s[20:21]
    v_cndmask_b32 v121, v121, v20, s[22:23]
    v_cndmask_b32 v122, v122, v20, s[24:25]
    v_cndmask_b32 v123, v123, v20, s[26:27]
    v_cmp_gt_i32 s[20:21], 0, v21
    v_cmp_gt_i32 s[22:23], 1, v21
    v_cmp_gt_i32 s[24:25], 2, v21
    v_cmp_gt_i32 s[26:27], 3, v21
    v_cndmask_b32 v124, v124, v20, s[20:21]
    v_cndmask_b32 v125, v125, v20, s[22:23]
    v_cndmask_b32 v126, v126, v20, s[24:25]
    v_cndmask_b32 v127, v127, v20, s[26:27]
    s_branch L_attn_kernel_back_4
L_attn_kernel_rare_5:
    v_mov_b32 v20, 4048155338
    v_subrev_u32 v21, s50, v18
    v_cmp_gt_i32 s[20:21], 0, v21
    v_cmp_gt_i32 s[22:23], 1, v21
    v_cmp_gt_i32 s[24:25], 2, v21
    v_cmp_gt_i32 s[26:27], 3, v21
    v_cndmask_b32 v96, v96, v20, s[20:21]
    v_cndmask_b32 v97, v97, v20, s[22:23]
    v_cndmask_b32 v98, v98, v20, s[24:25]
    v_cndmask_b32 v99, v99, v20, s[26:27]
    v_cmp_gt_i32 s[20:21], 16, v21
    v_cmp_gt_i32 s[22:23], 17, v21
    v_cmp_gt_i32 s[24:25], 18, v21
    v_cmp_gt_i32 s[26:27], 19, v21
    v_cndmask_b32 v100, v100, v20, s[20:21]
    v_cndmask_b32 v101, v101, v20, s[22:23]
    v_cndmask_b32 v102, v102, v20, s[24:25]
    v_cndmask_b32 v103, v103, v20, s[26:27]
    v_cmp_gt_i32 s[20:21], -16, v21
    v_cmp_gt_i32 s[22:23], -15, v21
    v_cmp_gt_i32 s[24:25], -14, v21
    v_cmp_gt_i32 s[26:27], -13, v21
    v_cndmask_b32 v104, v104, v20, s[20:21]
    v_cndmask_b32 v105, v105, v20, s[22:23]
    v_cndmask_b32 v106, v106, v20, s[24:25]
    v_cndmask_b32 v107, v107, v20, s[26:27]
    v_cmp_gt_i32 s[20:21], 0, v21
    v_cmp_gt_i32 s[22:23], 1, v21
    v_cmp_gt_i32 s[24:25], 2, v21
    v_cmp_gt_i32 s[26:27], 3, v21
    v_cndmask_b32 v108, v108, v20, s[20:21]
    v_cndmask_b32 v109, v109, v20, s[22:23]
    v_cndmask_b32 v110, v110, v20, s[24:25]
    v_cndmask_b32 v111, v111, v20, s[26:27]
    s_branch L_attn_kernel_back_6
L_attn_kernel_rare_15:
    v_mov_b32 v20, 4048155338
    v_subrev_u32 v21, s49, v18
    v_cmp_gt_i32 s[20:21], 0, v21
    v_cmp_gt_i32 s[22:23], 1, v21
    v_cmp_gt_i32 s[24:25], 2, v21
    v_cmp_gt_i32 s[26:27], 3, v21
    v_cndmask_b32 v112, v112, v20, s[20:21]
    v_cndmask_b32 v113, v113, v20, s[22:23]
    v_cndmask_b32 v114, v114, v20, s[24:25]
    v_cndmask_b32 v115, v115, v20, s[26:27]
    v_cmp_gt_i32 s[20:21], 16, v21
    v_cmp_gt_i32 s[22:23], 17, v21
    v_cmp_gt_i32 s[24:25], 18, v21
    v_cmp_gt_i32 s[26:27], 19, v21
    v_cndmask_b32 v116, v116, v20, s[20:21]
    v_cndmask_b32 v117, v117, v20, s[22:23]
    v_cndmask_b32 v118, v118, v20, s[24:25]
    v_cndmask_b32 v119, v119, v20, s[26:27]
    v_cmp_gt_i32 s[20:21], -16, v21
    v_cmp_gt_i32 s[22:23], -15, v21
    v_cmp_gt_i32 s[24:25], -14, v21
    v_cmp_gt_i32 s[26:27], -13, v21
    v_cndmask_b32 v120, v120, v20, s[20:21]
    v_cndmask_b32 v121, v121, v20, s[22:23]
    v_cndmask_b32 v122, v122, v20, s[24:25]
    v_cndmask_b32 v123, v123, v20, s[26:27]
    v_cmp_gt_i32 s[20:21], 0, v21
    v_cmp_gt_i32 s[22:23], 1, v21
    v_cmp_gt_i32 s[24:25], 2, v21
    v_cmp_gt_i32 s[26:27], 3, v21
    v_cndmask_b32 v124, v124, v20, s[20:21]
    v_cndmask_b32 v125, v125, v20, s[22:23]
    v_cndmask_b32 v126, v126, v20, s[24:25]
    v_cndmask_b32 v127, v127, v20, s[26:27]
    s_branch L_attn_kernel_back_16
L_attn_kernel_rare_20:
    v_mov_b32 v20, 4048155338
    v_subrev_u32 v21, s50, v18
    v_cmp_gt_i32 s[20:21], 0, v21
    v_cmp_gt_i32 s[22:23], 1, v21
    v_cmp_gt_i32 s[24:25], 2, v21
    v_cmp_gt_i32 s[26:27], 3, v21
    v_cndmask_b32 v96, v96, v20, s[20:21]
    v_cndmask_b32 v97, v97, v20, s[22:23]
    v_cndmask_b32 v98, v98, v20, s[24:25]
    v_cndmask_b32 v99, v99, v20, s[26:27]
    v_cmp_gt_i32 s[20:21], 16, v21
    v_cmp_gt_i32 s[22:23], 17, v21
    v_cmp_gt_i32 s[24:25], 18, v21
    v_cmp_gt_i32 s[26:27], 19, v21
    v_cndmask_b32 v100, v100, v20, s[20:21]
    v_cndmask_b32 v101, v101, v20, s[22:23]
    v_cndmask_b32 v102, v102, v20, s[24:25]
    v_cndmask_b32 v103, v103, v20, s[26:27]
    v_cmp_gt_i32 s[20:21], -16, v21
    v_cmp_gt_i32 s[22:23], -15, v21
    v_cmp_gt_i32 s[24:25], -14, v21
    v_cmp_gt_i32 s[26:27], -13, v21
    v_cndmask_b32 v104, v104, v20, s[20:21]
    v_cndmask_b32 v105, v105, v20, s[22:23]
    v_cndmask_b32 v106, v106, v20, s[24:25]
    v_cndmask_b32 v107, v107, v20, s[26:27]
    v_cmp_gt_i32 s[20:21], 0, v21
    v_cmp_gt_i32 s[22:23], 1, v21
    v_cmp_gt_i32 s[24:25], 2, v21
    v_cmp_gt_i32 s[26:27], 3, v21
    v_cndmask_b32 v108, v108, v20, s[20:21]
    v_cndmask_b32 v109, v109, v20, s[22:23]
    v_cndmask_b32 v110, v110, v20, s[24:25]
    v_cndmask_b32 v111, v111, v20, s[26:27]
    s_branch L_attn_kernel_back_21
L_grp1:
    s_mov_b32 s36, 1040356334
    s_and_b32 s37, s28, 3
    s_lshl_b32 s37, s37, 13
    v_lshlrev_b32 v7, 4, v1
    v_add_u32 v4, s37, v7
    v_add_u32 v6, 4096, v4
    v_add_u32 v19, 131072, v4
    s_mov_b32 s43, s37
    s_add_u32 s44, s37, 98304
    s_waitcnt vmcnt(0) lgkmcnt(0)
    v_mul_f32 v192, s36, v192
    v_mul_f32 v193, s36, v193
    v_mul_f32 v194, s36, v194
    v_mul_f32 v195, s36, v195
    v_mul_f32 v196, s36, v196
    v_mul_f32 v197, s36, v197
    v_mul_f32 v198, s36, v198
    v_mul_f32 v199, s36, v199
    v_cvt_pk_bf16_f32 v128, v192, v193
    v_cvt_pk_bf16_f32 v129, v194, v195
    v_cvt_pk_bf16_f32 v130, v196, v197
    v_cvt_pk_bf16_f32 v131, v198, v199
    v_mul_f32 v200, s36, v200
    v_mul_f32 v201, s36, v201
    v_mul_f32 v202, s36, v202
    v_mul_f32 v203, s36, v203
    v_mul_f32 v204, s36, v204
    v_mul_f32 v205, s36, v205
    v_mul_f32 v206, s36, v206
    v_mul_f32 v207, s36, v207
    v_cvt_pk_bf16_f32 v132, v200, v201
    v_cvt_pk_bf16_f32 v133, v202, v203
    v_cvt_pk_bf16_f32 v134, v204, v205
    v_cvt_pk_bf16_f32 v135, v206, v207
    v_mul_f32 v208, s36, v208
    v_mul_f32 v209, s36, v209
    v_mul_f32 v210, s36, v210
    v_mul_f32 v211, s36, v211
    v_mul_f32 v212, s36, v212
    v_mul_f32 v213, s36, v213
    v_mul_f32 v214, s36, v214
    v_mul_f32 v215, s36, v215
    v_cvt_pk_bf16_f32 v136, v208, v209
    v_cvt_pk_bf16_f32 v137, v210, v211
    v_cvt_pk_bf16_f32 v138, v212, v213
    v_cvt_pk_bf16_f32 v139, v214, v215
    v_mul_f32 v216, s36, v216
    v_mul_f32 v217, s36, v217
    v_mul_f32 v218, s36, v218
    v_mul_f32 v219, s36, v219
    v_mul_f32 v220, s36, v220
    v_mul_f32 v221, s36, v221
    v_mul_f32 v222, s36, v222
    v_mul_f32 v223, s36, v223
    v_cvt_pk_bf16_f32 v140, v216, v217
    v_cvt_pk_bf16_f32 v141, v218, v219
    v_cvt_pk_bf16_f32 v142, v220, v221
    v_cvt_pk_bf16_f32 v143, v222, v223
    v_mul_f32 v224, s36, v224
    v_mul_f32 v225, s36, v225
    v_mul_f32 v226, s36, v226
    v_mul_f32 v227, s36, v227
    v_mul_f32 v228, s36, v228
    v_mul_f32 v229, s36, v229
    v_mul_f32 v230, s36, v230
    v_mul_f32 v231, s36, v231
    v_cvt_pk_bf16_f32 v144, v224, v225
    v_cvt_pk_bf16_f32 v145, v226, v227
    v_cvt_pk_bf16_f32 v146, v228, v229
    v_cvt_pk_bf16_f32 v147, v230, v231
    v_mul_f32 v232, s36, v232
    v_mul_f32 v233, s36, v233
    v_mul_f32 v234, s36, v234
    v_mul_f32 v235, s36, v235
    v_mul_f32 v236, s36, v236
    v_mul_f32 v237, s36, v237
    v_mul_f32 v238, s36, v238
    v_mul_f32 v239, s36, v239
    v_cvt_pk_bf16_f32 v148, v232, v233
    v_cvt_pk_bf16_f32 v149, v234, v235
    v_cvt_pk_bf16_f32 v150, v236, v237
    v_cvt_pk_bf16_f32 v151, v238, v239
    v_mul_f32 v240, s36, v240
    v_mul_f32 v241, s36, v241
    v_mul_f32 v242, s36, v242
    v_mul_f32 v243, s36, v243
    v_mul_f32 v244, s36, v244
    v_mul_f32 v245, s36, v245
    v_mul_f32 v246, s36, v246
    v_mul_f32 v247, s36, v247
    v_cvt_pk_bf16_f32 v152, v240, v241
    v_cvt_pk_bf16_f32 v153, v242, v243
    v_cvt_pk_bf16_f32 v154, v244, v245
    v_cvt_pk_bf16_f32 v155, v246, v247
    v_mul_f32 v248, s36, v248
    v_mul_f32 v249, s36, v249
    v_mul_f32 v250, s36, v250
    v_mul_f32 v251, s36, v251
    v_mul_f32 v252, s36, v252
    v_mul_f32 v253, s36, v253
    v_mul_f32 v254, s36, v254
    v_mul_f32 v255, s36, v255
    v_cvt_pk_bf16_f32 v156, v248, v249
    v_cvt_pk_bf16_f32 v157, v250, v251
    v_cvt_pk_bf16_f32 v158, v252, v253
    v_cvt_pk_bf16_f32 v159, v254, v255
    v_mov_b32 v2, v7
    v_and_b32 v21, 15, v1
    v_lshrrev_b32 v22, 4, v1
    v_lshlrev_b32 v22, 2, v22
    v_sub_u32 v18, v21, v22
    s_mov_b32 s40, 0
    s_mov_b32 s41, 0
    s_lshl_b32 s51, s30, 1
    s_add_u32 s51, s51, 1
    s_and_b32 s36, s28, 3
    s_lshl_b32 s36, s36, 5
    s_lshl_b32 s37, s30, 7
    s_add_u32 s36, s36, s37
    s_sub_u32 s50, 0, s36
    s_lshl_b32 s42, s30, 8
    s_sub_u32 s42, s42, 1792
    s_mov_b64 s[52:53], 0
    s_waitcnt lgkmcnt(0)
    s_barrier
    ds_read_b128 v[160:163], v19 offset:0
    ds_read_b128 v[164:167], v19 offset:1024
    ds_read_b128 v[168:171], v19 offset:2048
    ds_read_b128 v[172:175], v19 offset:3072
    ds_read_b128 v[176:179], v19 offset:4096
    ds_read_b128 v[180:183], v19 offset:5120
    ds_read_b128 v[184:187], v19 offset:6144
    ds_read_b128 v[188:191], v19 offset:7168
    ds_read_b128 v[64:67], v2 offset:0
    ds_read_b128 v[68:71], v2 offset:1024
    ds_read_b128 v[72:75], v2 offset:2048
    ds_read_b128 v[76:79], v2 offset:3072
    ds_read_b128 v[80:83], v2 offset:4096
    ds_read_b128 v[84:87], v2 offset:5120
    ds_read_b128 v[88:91], v2 offset:6144
    ds_read_b128 v[92:95], v2 offset:7168
    s_waitcnt lgkmcnt(7)
    v_mfma_f32_16x16x32_bf16 v[96:99], v[64:67], v[128:131], 0
    v_mov_b32 v192, 0
    v_mov_b32 v193, 0
    v_mfma_f32_16x16x32_bf16 v[104:107], v[64:67], v[144:147], 0
    ds_read_b128 v[64:67], v2 offset:8192
    v_mov_b32 v194, 0
    v_mov_b32 v195, 0
    s_waitcnt lgkmcnt(7)
    v_mfma_f32_16x16x32_bf16 v[96:99], v[68:71], v[132:135], v[96:99]
    v_mov_b32 v196, 0
    v_mov_b32 v197, 0
    v_mfma_f32_16x16x32_bf16 v[104:107], v[68:71], v[148:151], v[104:107]
    ds_read_b128 v[68:71], v2 offset:9216
    v_mov_b32 v198, 0
    v_mov_b32 v199, 0
    s_waitcnt lgkmcnt(7)
    v_mfma_f32_16x16x32_bf16 v[96:99], v[72:75], v[136:139], v[96:99]
    v_mov_b32 v200, 0
    v_mov_b32 v201, 0
    v_mfma_f32_16x16x32_bf16 v[104:107], v[72:75], v[152:155], v[104:107]
    ds_read_b128 v[72:75], v2 offset:10240
    v_mov_b32 v202, 0
    v_mov_b32 v203, 0
    s_waitcnt lgkmcnt(7)
    v_mfma_f32_16x16x32_bf16 v[96:99], v[76:79], v[140:143], v[96:99]
    v_mov_b32 v204, 0
    v_mov_b32 v205, 0
    v_mfma_f32_16x16x32_bf16 v[104:107], v[76:79], v[156:159], v[104:107]
    ds_read_b128 v[76:79], v2 offset:11264
    v_mov_b32 v206, 0
    v_mov_b32 v207, 0
    s_waitcnt lgkmcnt(7)
    v_mfma_f32_16x16x32_bf16 v[100:103], v[80:83], v[128:131], 0
    v_mov_b32 v208, 0
    v_mov_b32 v209, 0
    v_mfma_f32_16x16x32_bf16 v[108:111], v[80:83], v[144:147], 0
    ds_read_b128 v[80:83], v2 offset:12288
    v_mov_b32 v210, 0
    v_mov_b32 v211, 0
    s_waitcnt lgkmcnt(7)
    v_mfma_f32_16x16x32_bf16 v[100:103], v[84:87], v[132:135], v[100:103]
    v_mov_b32 v212, 0
    v_mov_b32 v213, 0
    v_mfma_f32_16x16x32_bf16 v[108:111], v[84:87], v[148:151], v[108:111]
    ds_read_b128 v[84:87], v2 offset:13312
    v_mov_b32 v214, 0
    v_mov_b32 v215, 0
    s_waitcnt lgkmcnt(7)
    v_mfma_f32_16x16x32_bf16 v[100:103], v[88:91], v[136:139], v[100:103]
    v_mov_b32 v216, 0
    v_mov_b32 v217, 0
    v_mfma_f32_16x16x32_bf16 v[108:111], v[88:91], v[152:155], v[108:111]
    ds_read_b128 v[88:91], v2 offset:14336
    v_mov_b32 v218, 0
    v_mov_b32 v219, 0
    s_waitcnt lgkmcnt(7)
    v_mfma_f32_16x16x32_bf16 v[100:103], v[92:95], v[140:143], v[100:103]
    v_mov_b32 v220, 0
    v_mov_b32 v221, 0
    v_mfma_f32_16x16x32_bf16 v[108:111], v[92:95], v[156:159], v[108:111]
    ds_read_b128 v[92:95], v2 offset:15360
    v_mov_b32 v222, 0
    v_mov_b32 v223, 0
    s_waitcnt lgkmcnt(7)
    v_mfma_f32_16x16x32_bf16 v[112:115], v[64:67], v[128:131], 0
    v_mov_b32 v224, 0
    v_mov_b32 v225, 0
    v_mfma_f32_16x16x32_bf16 v[120:123], v[64:67], v[144:147], 0
    v_mov_b32 v226, 0
    v_mov_b32 v227, 0
    s_waitcnt lgkmcnt(6)
    v_mfma_f32_16x16x32_bf16 v[112:115], v[68:71], v[132:135], v[112:115]
    v_mov_b32 v228, 0
    v_mov_b32 v229, 0
    v_mfma_f32_16x16x32_bf16 v[120:123], v[68:71], v[148:151], v[120:123]
    v_mov_b32 v230, 0
    v_mov_b32 v231, 0
    s_waitcnt lgkmcnt(5)
    v_mfma_f32_16x16x32_bf16 v[112:115], v[72:75], v[136:139], v[112:115]
    v_mov_b32 v232, 0
    v_mov_b32 v233, 0
    v_mfma_f32_16x16x32_bf16 v[120:123], v[72:75], v[152:155], v[120:123]
    v_mov_b32 v234, 0
    v_mov_b32 v235, 0
    s_waitcnt lgkmcnt(4)
    v_mfma_f32_16x16x32_bf16 v[112:115], v[76:79], v[140:143], v[112:115]
    v_mov_b32 v236, 0
    v_mov_b32 v237, 0
    v_mfma_f32_16x16x32_bf16 v[120:123], v[76:79], v[156:159], v[120:123]
    v_mov_b32 v238, 0
    v_mov_b32 v239, 0
    s_waitcnt lgkmcnt(3)
    v_mfma_f32_16x16x32_bf16 v[116:119], v[80:83], v[128:131], 0
    v_mov_b32 v240, 0
    v_mov_b32 v241, 0
    v_mfma_f32_16x16x32_bf16 v[124:127], v[80:83], v[144:147], 0
    v_mov_b32 v242, 0
    v_mov_b32 v243, 0
    s_waitcnt lgkmcnt(2)
    v_mfma_f32_16x16x32_bf16 v[116:119], v[84:87], v[132:135], v[116:119]
    v_mov_b32 v244, 0
    v_mov_b32 v245, 0
    v_mfma_f32_16x16x32_bf16 v[124:127], v[84:87], v[148:151], v[124:127]
    v_mov_b32 v246, 0
    v_mov_b32 v247, 0
    s_waitcnt lgkmcnt(1)
    v_mfma_f32_16x16x32_bf16 v[116:119], v[88:91], v[136:139], v[116:119]
    v_mov_b32 v248, 0
    v_mov_b32 v249, 0
    v_mfma_f32_16x16x32_bf16 v[124:127], v[88:91], v[152:155], v[124:127]
    v_mov_b32 v250, 0
    v_mov_b32 v251, 0
    s_waitcnt lgkmcnt(0)
    v_mfma_f32_16x16x32_bf16 v[116:119], v[92:95], v[140:143], v[116:119]
    v_mov_b32 v252, 0
    v_mov_b32 v253, 0
    v_mfma_f32_16x16x32_bf16 v[124:127], v[92:95], v[156:159], v[124:127]
    v_mov_b32 v254, 0
    v_mov_b32 v255, 0
    v_mov_b32 v38, 0
    v_mov_b32 v39, 0
    s_cmp_lt_i32 s50, 0
    s_cbranch_scc0 L_attn_kernel_rare_22
L_attn_kernel_back_23:
    s_add_u32 s49, s50, 32
    v_add_u32 v24, 65536, v2
    s_cmp_lt_u32 s40, s51
    s_cselect_b32 s36, 64, 128
    s_add_u32 s41, s41, s36
    s_cmp_eq_u32 s40, s51
    s_cselect_b32 s36, s42, s36
    s_add_u32 s50, s50, s36
    s_and_b32 s36, s41, 0xff
    v_lshl_add_u32 v2, s36, 8, v7
    s_cmp_eq_u32 s40, 16
    s_cselect_b64 s[20:21], -1, 0
    v_cndmask_b32 v5, v2, v24, s[20:21]
    v_mov_b32 v3, v24
    s_barrier
    ds_read_b128 v[64:67], v5 offset:0
    ds_read_b128 v[68:71], v5 offset:1024
    ds_read_b128 v[72:75], v5 offset:2048
    ds_read_b128 v[76:79], v5 offset:3072
    ds_read_b128 v[80:83], v5 offset:4096
    ds_read_b128 v[84:87], v5 offset:5120
    ds_read_b128 v[88:91], v5 offset:6144
    v_max3_f32 v21, v96, v97, v98
    v_max3_f32 v21, v21, v99, v100
    v_max3_f32 v21, v21, v101, v102
    v_max_f32 v21, v21, v103
    v_max3_f32 v22, v104, v105, v106
    v_max3_f32 v22, v22, v107, v108
    v_max3_f32 v22, v22, v109, v110
    v_max_f32 v22, v22, v111
    v_mov_b32 v23, v21
    s_nop 1
    v_permlane16_swap_b32 v21, v23
    s_nop 1
    v_max_f32 v21, v21, v23
    v_mov_b32 v23, v21
    s_nop 1
    v_permlane32_swap_b32 v21, v23
    s_nop 1
    v_max_f32 v21, v21, v23
    v_mov_b32 v23, v22
    s_nop 1
    v_permlane16_swap_b32 v22, v23
    s_nop 1
    v_max_f32 v22, v22, v23
    v_mov_b32 v23, v22
    s_nop 1
    v_permlane32_swap_b32 v22, v23
    s_nop 1
    v_max_f32 v22, v22, v23
    v_sub_f32 v40, 0, v21
    v_sub_f32 v41, 0, v21
    v_sub_f32 v42, 0, v21
    v_sub_f32 v43, 0, v21
    v_sub_f32 v44, 0, v22
    v_sub_f32 v45, 0, v22
    v_sub_f32 v46, 0, v22
    v_sub_f32 v47, 0, v22
    v_sub_f32 v96, v96, v21
    v_sub_f32 v97, v97, v21
    v_sub_f32 v98, v98, v21
    v_sub_f32 v99, v99, v21
    v_sub_f32 v100, v100, v21
    v_sub_f32 v101, v101, v21
    v_sub_f32 v102, v102, v21
    v_sub_f32 v103, v103, v21
    v_sub_f32 v104, v104, v22
    v_sub_f32 v105, v105, v22
    v_sub_f32 v106, v106, v22
    v_sub_f32 v107, v107, v22
    v_sub_f32 v108, v108, v22
    v_sub_f32 v109, v109, v22
    v_sub_f32 v110, v110, v22
    v_sub_f32 v111, v111, v22
    v_sub_f32 v112, v112, v21
    v_sub_f32 v113, v113, v21
    v_sub_f32 v114, v114, v21
    v_sub_f32 v115, v115, v21
    v_sub_f32 v116, v116, v21
    v_sub_f32 v117, v117, v21
    v_sub_f32 v118, v118, v21
    v_sub_f32 v119, v119, v21
    v_sub_f32 v120, v120, v22
    v_sub_f32 v121, v121, v22
    v_sub_f32 v122, v122, v22
    v_sub_f32 v123, v123, v22
    v_sub_f32 v124, v124, v22
    v_sub_f32 v125, v125, v22
    v_sub_f32 v126, v126, v22
    v_sub_f32 v127, v127, v22
    v_exp_f32 v96, v96
    v_exp_f32 v97, v97
    v_add_f32 v38, v38, v96
    v_exp_f32 v98, v98
    v_add_f32 v38, v38, v97
    v_cvt_pk_bf16_f32 v48, v96, v97
    v_exp_f32 v99, v99
    v_add_f32 v38, v38, v98
    v_exp_f32 v104, v104
    v_add_f32 v38, v38, v99
    v_cvt_pk_bf16_f32 v49, v98, v99
    v_exp_f32 v105, v105
    v_add_f32 v39, v39, v104
    v_exp_f32 v106, v106
    v_add_f32 v39, v39, v105
    v_cvt_pk_bf16_f32 v52, v104, v105
    v_exp_f32 v107, v107
    v_add_f32 v39, v39, v106
    v_exp_f32 v100, v100
    v_add_f32 v39, v39, v107
    v_cvt_pk_bf16_f32 v53, v106, v107
    v_exp_f32 v101, v101
    v_add_f32 v38, v38, v100
    v_exp_f32 v102, v102
    v_add_f32 v38, v38, v101
    v_cvt_pk_bf16_f32 v50, v100, v101
    v_exp_f32 v103, v103
    v_add_f32 v38, v38, v102
    v_exp_f32 v108, v108
    v_add_f32 v38, v38, v103
    v_cvt_pk_bf16_f32 v51, v102, v103
    v_exp_f32 v109, v109
    v_add_f32 v39, v39, v108
    v_exp_f32 v110, v110
    v_add_f32 v39, v39, v109
    v_cvt_pk_bf16_f32 v54, v108, v109
    v_exp_f32 v111, v111
    v_add_f32 v39, v39, v110
    s_nop 0
    v_add_f32 v39, v39, v111
    v_cvt_pk_bf16_f32 v55, v110, v111
    .p2align 6
L_body1:
    s_cmp_lt_i32 s49, 0
    s_cbranch_scc0 L_attn_kernel_rare_24
L_attn_kernel_back_25:
    s_waitcnt lgkmcnt(3)
    v_mfma_f32_16x16x32_bf16 v[96:99], v[64:67], v[128:131], v[40:43]
    v_exp_f32 v112, v112
    v_mfma_f32_16x16x32_bf16 v[104:107], v[64:67], v[144:147], v[44:47]
    ds_read_b128 v[92:95], v2 offset:7168
    v_mfma_f32_16x16x32_bf16 v[96:99], v[68:71], v[132:135], v[96:99]
    v_exp_f32 v113, v113
    v_mfma_f32_16x16x32_bf16 v[104:107], v[68:71], v[148:151], v[104:107]
    ds_read_b128 v[64:67], v3 offset:0
    v_add_f32 v38, v38, v112
    v_mfma_f32_16x16x32_bf16 v[96:99], v[72:75], v[136:139], v[96:99]
    v_exp_f32 v114, v114
    v_mfma_f32_16x16x32_bf16 v[104:107], v[72:75], v[152:155], v[104:107]
    ds_read_b128 v[68:71], v3 offset:1024
    v_add_f32 v38, v38, v113
    v_cvt_pk_bf16_f32 v56, v112, v113
    v_mfma_f32_16x16x32_bf16 v[96:99], v[76:79], v[140:143], v[96:99]
    v_exp_f32 v115, v115
    v_mfma_f32_16x16x32_bf16 v[104:107], v[76:79], v[156:159], v[104:107]
    ds_read_b128 v[72:75], v3 offset:2048
    v_add_f32 v38, v38, v114
    s_waitcnt lgkmcnt(3)
    v_mfma_f32_16x16x32_bf16 v[100:103], v[80:83], v[128:131], v[40:43]
    v_exp_f32 v120, v120
    v_mfma_f32_16x16x32_bf16 v[108:111], v[80:83], v[144:147], v[44:47]
    ds_read_b128 v[76:79], v3 offset:3072
    v_add_f32 v38, v38, v115
    v_cvt_pk_bf16_f32 v57, v114, v115
    v_mfma_f32_16x16x32_bf16 v[100:103], v[84:87], v[132:135], v[100:103]
    v_exp_f32 v121, v121
    v_mfma_f32_16x16x32_bf16 v[108:111], v[84:87], v[148:151], v[108:111]
    ds_read_b128 v[80:83], v3 offset:4096
    v_add_f32 v39, v39, v120
    v_mfma_f32_16x16x32_bf16 v[100:103], v[88:91], v[136:139], v[100:103]
    v_exp_f32 v122, v122
    v_mfma_f32_16x16x32_bf16 v[108:111], v[88:91], v[152:155], v[108:111]
    ds_read_b128 v[84:87], v3 offset:5120
    v_add_f32 v39, v39, v121
    v_cvt_pk_bf16_f32 v60, v120, v121
    v_mfma_f32_16x16x32_bf16 v[100:103], v[92:95], v[140:143], v[100:103]
    v_exp_f32 v123, v123
    v_mfma_f32_16x16x32_bf16 v[108:111], v[92:95], v[156:159], v[108:111]
    ds_read_b128 v[88:91], v3 offset:6144
    v_add_f32 v39, v39, v122
    s_waitcnt lgkmcnt(3)
    v_mfma_f32_16x16x32_bf16 v[192:195], v[64:67], v[48:51], v[192:195]
    v_exp_f32 v116, v116
    v_mfma_f32_16x16x32_bf16 v[224:227], v[64:67], v[52:55], v[224:227]
    ds_read_b128 v[92:95], v3 offset:7168
    v_add_f32 v39, v39, v123
    v_cvt_pk_bf16_f32 v61, v122, v123
    v_mfma_f32_16x16x32_bf16 v[196:199], v[68:71], v[48:51], v[196:199]
    v_exp_f32 v117, v117
    v_mfma_f32_16x16x32_bf16 v[228:231], v[68:71], v[52:55], v[228:231]
    ds_read_b128 v[64:67], v2 offset:8192
    v_add_f32 v38, v38, v116
    v_mfma_f32_16x16x32_bf16 v[200:203], v[72:75], v[48:51], v[200:203]
    v_exp_f32 v118, v118
    v_mfma_f32_16x16x32_bf16 v[232:235], v[72:75], v[52:55], v[232:235]
    ds_read_b128 v[68:71], v2 offset:9216
    v_add_f32 v38, v38, v117
    v_cvt_pk_bf16_f32 v58, v116, v117
    v_mfma_f32_16x16x32_bf16 v[204:207], v[76:79], v[48:51], v[204:207]
    v_exp_f32 v119, v119
    v_mfma_f32_16x16x32_bf16 v[236:239], v[76:79], v[52:55], v[236:239]
    ds_read_b128 v[72:75], v2 offset:10240
    v_add_f32 v38, v38, v118
    s_waitcnt lgkmcnt(3)
    v_mfma_f32_16x16x32_bf16 v[208:211], v[80:83], v[48:51], v[208:211]
    v_exp_f32 v124, v124
    v_mfma_f32_16x16x32_bf16 v[240:243], v[80:83], v[52:55], v[240:243]
    ds_read_b128 v[76:79], v2 offset:11264
    v_add_f32 v38, v38, v119
    v_cvt_pk_bf16_f32 v59, v118, v119
    v_mfma_f32_16x16x32_bf16 v[212:215], v[84:87], v[48:51], v[212:215]
    v_exp_f32 v125, v125
    v_mfma_f32_16x16x32_bf16 v[244:247], v[84:87], v[52:55], v[244:247]
    ds_read_b128 v[80:83], v2 offset:12288
    v_add_f32 v39, v39, v124
    v_mfma_f32_16x16x32_bf16 v[216:219], v[88:91], v[48:51], v[216:219]
    v_exp_f32 v126, v126
    v_mfma_f32_16x16x32_bf16 v[248:251], v[88:91], v[52:55], v[248:251]
    ds_read_b128 v[84:87], v2 offset:13312
    v_add_f32 v39, v39, v125
    v_cvt_pk_bf16_f32 v62, v124, v125
    v_mfma_f32_16x16x32_bf16 v[220:223], v[92:95], v[48:51], v[220:223]
    v_exp_f32 v127, v127
    v_mfma_f32_16x16x32_bf16 v[252:255], v[92:95], v[52:55], v[252:255]
    ds_read_b128 v[88:91], v2 offset:14336
    v_add_f32 v39, v39, v126
    v_add_f32 v39, v39, v127
    v_cvt_pk_bf16_f32 v63, v126, v127
    s_cmp_eq_u32 s40, s51
    s_cbranch_scc1 L_attn_kernel_rare_26
L_attn_kernel_back_27:
    s_cmp_lt_i32 s50, 0
    s_cbranch_scc0 L_attn_kernel_rare_28
L_attn_kernel_back_29:
    s_waitcnt lgkmcnt(3)
    v_mfma_f32_16x16x32_bf16 v[112:115], v[64:67], v[128:131], v[40:43]
    v_exp_f32 v96, v96
    v_mfma_f32_16x16x32_bf16 v[120:123], v[64:67], v[144:147], v[44:47]
    ds_read_b128 v[92:95], v2 offset:15360
    v_mfma_f32_16x16x32_bf16 v[112:115], v[68:71], v[132:135], v[112:115]
    v_exp_f32 v97, v97
    s_add_u32 s40, s40, 1
    v_mfma_f32_16x16x32_bf16 v[120:123], v[68:71], v[148:151], v[120:123]
    ds_read_b128 v[64:67], v3 offset:8192
    v_add_f32 v38, v38, v96
    s_add_u32 s49, s50, 32
    v_add_u32 v24, 65536, v2
    v_mfma_f32_16x16x32_bf16 v[112:115], v[72:75], v[136:139], v[112:115]
    v_exp_f32 v98, v98
    v_mfma_f32_16x16x32_bf16 v[120:123], v[72:75], v[152:155], v[120:123]
    ds_read_b128 v[68:71], v3 offset:9216
    v_add_f32 v38, v38, v97
    v_cvt_pk_bf16_f32 v48, v96, v97
    s_cmp_lt_u32 s40, s51
    s_cselect_b32 s36, 64, 128
    v_mfma_f32_16x16x32_bf16 v[112:115], v[76:79], v[140:143], v[112:115]
    v_exp_f32 v99, v99
    v_mfma_f32_16x16x32_bf16 v[120:123], v[76:79], v[156:159], v[120:123]
    ds_read_b128 v[72:75], v3 offset:10240
    v_add_f32 v38, v38, v98
    s_add_u32 s41, s41, s36
    s_waitcnt lgkmcnt(3)
    v_mfma_f32_16x16x32_bf16 v[116:119], v[80:83], v[128:131], v[40:43]
    v_exp_f32 v104, v104
    v_mfma_f32_16x16x32_bf16 v[124:127], v[80:83], v[144:147], v[44:47]
    ds_read_b128 v[76:79], v3 offset:11264
    v_add_f32 v38, v38, v99
    v_cvt_pk_bf16_f32 v49, v98, v99
    s_cmp_eq_u32 s40, s51
    s_cselect_b32 s36, s42, s36
    v_mfma_f32_16x16x32_bf16 v[116:119], v[84:87], v[132:135], v[116:119]
    v_exp_f32 v105, v105
    v_mfma_f32_16x16x32_bf16 v[124:127], v[84:87], v[148:151], v[124:127]
    ds_read_b128 v[80:83], v3 offset:12288
    v_add_f32 v39, v39, v104
    s_add_u32 s50, s50, s36
    v_mfma_f32_16x16x32_bf16 v[116:119], v[88:91], v[136:139], v[116:119]
    v_exp_f32 v106, v106
    v_mfma_f32_16x16x32_bf16 v[124:127], v[88:91], v[152:155], v[124:127]
    ds_read_b128 v[84:87], v3 offset:13312
    v_add_f32 v39, v39, v105
    v_cvt_pk_bf16_f32 v52, v104, v105
    s_and_b32 s36, s41, 0xff
    v_lshl_add_u32 v2, s36, 8, v7
    v_mfma_f32_16x16x32_bf16 v[116:119], v[92:95], v[140:143], v[116:119]
    v_exp_f32 v107, v107
    v_mfma_f32_16x16x32_bf16 v[124:127], v[92:95], v[156:159], v[124:127]
    ds_read_b128 v[88:91], v3 offset:14336
    v_add_f32 v39, v39, v106
    s_cmp_eq_u32 s40, 16
    s_cselect_b64 s[20:21], -1, 0
    s_waitcnt lgkmcnt(3)
    v_mfma_f32_16x16x32_bf16 v[192:195], v[64:67], v[56:59], v[192:195]
    v_exp_f32 v100, v100
    v_mfma_f32_16x16x32_bf16 v[224:227], v[64:67], v[60:63], v[224:227]
    ds_read_b128 v[92:95], v3 offset:15360
    v_add_f32 v39, v39, v107
    v_cvt_pk_bf16_f32 v53, v106, v107
    v_cndmask_b32 v5, v2, v24, s[20:21]
    v_mfma_f32_16x16x32_bf16 v[196:199], v[68:71], v[56:59], v[196:199]
    v_exp_f32 v101, v101
    v_mfma_f32_16x16x32_bf16 v[228:231], v[68:71], v[60:63], v[228:231]
    v_add_f32 v38, v38, v100
    v_mov_b32 v3, v24
    v_mfma_f32_16x16x32_bf16 v[200:203], v[72:75], v[56:59], v[200:203]
    v_exp_f32 v102, v102
    v_mfma_f32_16x16x32_bf16 v[232:235], v[72:75], v[60:63], v[232:235]
    v_add_f32 v38, v38, v101
    v_cvt_pk_bf16_f32 v50, v100, v101
    s_waitcnt lgkmcnt(0)
    s_barrier
    v_mfma_f32_16x16x32_bf16 v[204:207], v[76:79], v[56:59], v[204:207]
    v_exp_f32 v103, v103
    v_mfma_f32_16x16x32_bf16 v[236:239], v[76:79], v[60:63], v[236:239]
    ds_read_b128 v[68:71], v5 offset:1024
    ds_read_b128 v[64:67], v5 offset:0
    v_add_f32 v38, v38, v102
    v_mfma_f32_16x16x32_bf16 v[208:211], v[80:83], v[56:59], v[208:211]
    v_exp_f32 v108, v108
    v_mfma_f32_16x16x32_bf16 v[240:243], v[80:83], v[60:63], v[240:243]
    ds_read_b128 v[76:79], v5 offset:3072
    ds_read_b128 v[72:75], v5 offset:2048
    v_add_f32 v38, v38, v103
    v_cvt_pk_bf16_f32 v51, v102, v103
    v_mfma_f32_16x16x32_bf16 v[212:215], v[84:87], v[56:59], v[212:215]
    v_exp_f32 v109, v109
    v_mfma_f32_16x16x32_bf16 v[244:247], v[84:87], v[60:63], v[244:247]
    ds_read_b128 v[80:83], v5 offset:4096
    v_add_f32 v39, v39, v108
    v_mfma_f32_16x16x32_bf16 v[216:219], v[88:91], v[56:59], v[216:219]
    v_exp_f32 v110, v110
    v_mfma_f32_16x16x32_bf16 v[248:251], v[88:91], v[60:63], v[248:251]
    ds_read_b128 v[84:87], v5 offset:5120
    v_add_f32 v39, v39, v109
    v_cvt_pk_bf16_f32 v54, v108, v109
    v_mfma_f32_16x16x32_bf16 v[220:223], v[92:95], v[56:59], v[220:223]
    v_exp_f32 v111, v111
    v_mfma_f32_16x16x32_bf16 v[252:255], v[92:95], v[60:63], v[252:255]
    ds_read_b128 v[88:91], v5 offset:6144
    v_add_f32 v39, v39, v110
    v_add_f32 v39, v39, v111
    v_cvt_pk_bf16_f32 v55, v110, v111
    s_sub_u32 s36, s40, s51
    s_cmp_lt_u32 s36, 2
    s_cbranch_scc1 L_attn_kernel_rare_32
L_attn_kernel_back_33:
    s_cmp_lg_u32 s40, 16
    s_cbranch_scc1 L_body1
    s_cmp_lt_i32 s49, 0
    s_cbranch_scc0 L_attn_kernel_rare_30
L_attn_kernel_back_31:
    s_waitcnt lgkmcnt(5)
    v_mfma_f32_16x16x32_bf16 v[192:195], v[64:67], v[48:51], v[192:195]
    v_exp_f32 v112, v112
    v_mfma_f32_16x16x32_bf16 v[224:227], v[64:67], v[52:55], v[224:227]
    ds_read_b128 v[92:95], v3 offset:7168
    v_add_f32 v38, v38, v112
    v_exp_f32 v113, v113
    v_mfma_f32_16x16x32_bf16 v[196:199], v[68:71], v[48:51], v[196:199]
    v_add_f32 v38, v38, v113
    v_cvt_pk_bf16_f32 v56, v112, v113
    v_exp_f32 v114, v114
    v_mfma_f32_16x16x32_bf16 v[228:231], v[68:71], v[52:55], v[228:231]
    ds_read_b128 v[64:67], v3 offset:8192
    v_add_f32 v38, v38, v114
    v_exp_f32 v115, v115
    s_waitcnt lgkmcnt(5)
    v_mfma_f32_16x16x32_bf16 v[200:203], v[72:75], v[48:51], v[200:203]
    v_add_f32 v38, v38, v115
    v_cvt_pk_bf16_f32 v57, v114, v115
    v_exp_f32 v120, v120
    v_mfma_f32_16x16x32_bf16 v[232:235], v[72:75], v[52:55], v[232:235]
    ds_read_b128 v[68:71], v3 offset:9216
    v_add_f32 v39, v39, v120
    v_exp_f32 v121, v121
    v_mfma_f32_16x16x32_bf16 v[204:207], v[76:79], v[48:51], v[204:207]
    v_add_f32 v39, v39, v121
    v_cvt_pk_bf16_f32 v60, v120, v121
    v_exp_f32 v122, v122
    v_mfma_f32_16x16x32_bf16 v[236:239], v[76:79], v[52:55], v[236:239]
    ds_read_b128 v[72:75], v3 offset:10240
    v_add_f32 v39, v39, v122
    v_exp_f32 v123, v123
    s_waitcnt lgkmcnt(6)
    v_mfma_f32_16x16x32_bf16 v[208:211], v[80:83], v[48:51], v[208:211]
    v_add_f32 v39, v39, v123
    v_cvt_pk_bf16_f32 v61, v122, v123
    v_exp_f32 v116, v116
    v_mfma_f32_16x16x32_bf16 v[240:243], v[80:83], v[52:55], v[240:243]
    ds_read_b128 v[76:79], v3 offset:11264
    v_add_f32 v38, v38, v116
    v_exp_f32 v117, v117
    s_waitcnt lgkmcnt(6)
    v_mfma_f32_16x16x32_bf16 v[212:215], v[84:87], v[48:51], v[212:215]
    v_add_f32 v38, v38, v117
    v_cvt_pk_bf16_f32 v58, v116, v117
    v_exp_f32 v118, v118
    v_mfma_f32_16x16x32_bf16 v[244:247], v[84:87], v[52:55], v[244:247]
    ds_read_b128 v[80:83], v3 offset:12288
    v_add_f32 v38, v38, v118
    v_exp_f32 v119, v119
    s_waitcnt lgkmcnt(6)
    v_mfma_f32_16x16x32_bf16 v[216:219], v[88:91], v[48:51], v[216:219]
    v_add_f32 v38, v38, v119
    v_cvt_pk_bf16_f32 v59, v118, v119
    v_exp_f32 v124, v124
    v_mfma_f32_16x16x32_bf16 v[248:251], v[88:91], v[52:55], v[248:251]
    ds_read_b128 v[84:87], v3 offset:13312
    v_add_f32 v39, v39, v124
    v_exp_f32 v125, v125
    s_waitcnt lgkmcnt(6)
    v_mfma_f32_16x16x32_bf16 v[220:223], v[92:95], v[48:51], v[220:223]
    v_add_f32 v39, v39, v125
    v_cvt_pk_bf16_f32 v62, v124, v125
    v_exp_f32 v126, v126
    v_mfma_f32_16x16x32_bf16 v[252:255], v[92:95], v[52:55], v[252:255]
    ds_read_b128 v[88:91], v3 offset:14336
    v_add_f32 v39, v39, v126
    v_exp_f32 v127, v127
    s_nop 0
    v_add_f32 v39, v39, v127
    v_cvt_pk_bf16_f32 v63, v126, v127
    s_nop 1
    s_waitcnt lgkmcnt(6)
    v_mfma_f32_16x16x32_bf16 v[192:195], v[64:67], v[56:59], v[192:195]
    v_mfma_f32_16x16x32_bf16 v[224:227], v[64:67], v[60:63], v[224:227]
    ds_read_b128 v[92:95], v3 offset:15360
    s_waitcnt lgkmcnt(6)
    v_mfma_f32_16x16x32_bf16 v[196:199], v[68:71], v[56:59], v[196:199]
    v_mfma_f32_16x16x32_bf16 v[228:231], v[68:71], v[60:63], v[228:231]
    s_waitcnt lgkmcnt(5)
    v_mfma_f32_16x16x32_bf16 v[200:203], v[72:75], v[56:59], v[200:203]
    v_mfma_f32_16x16x32_bf16 v[232:235], v[72:75], v[60:63], v[232:235]
    s_waitcnt lgkmcnt(4)
    v_mfma_f32_16x16x32_bf16 v[204:207], v[76:79], v[56:59], v[204:207]
    v_mfma_f32_16x16x32_bf16 v[236:239], v[76:79], v[60:63], v[236:239]
    s_waitcnt lgkmcnt(3)
    v_mfma_f32_16x16x32_bf16 v[208:211], v[80:83], v[56:59], v[208:211]
    v_mfma_f32_16x16x32_bf16 v[240:243], v[80:83], v[60:63], v[240:243]
    s_waitcnt lgkmcnt(2)
    v_mfma_f32_16x16x32_bf16 v[212:215], v[84:87], v[56:59], v[212:215]
    v_mfma_f32_16x16x32_bf16 v[244:247], v[84:87], v[60:63], v[244:247]
    s_waitcnt lgkmcnt(1)
    v_mfma_f32_16x16x32_bf16 v[216:219], v[88:91], v[56:59], v[216:219]
    v_mfma_f32_16x16x32_bf16 v[248:251], v[88:91], v[60:63], v[248:251]
    s_waitcnt lgkmcnt(0)
    v_mfma_f32_16x16x32_bf16 v[220:223], v[92:95], v[56:59], v[220:223]
    v_mfma_f32_16x16x32_bf16 v[252:255], v[92:95], v[60:63], v[252:255]
    s_lshl_b32 s37, s28, 13
    v_add_u32 v21, s37, v7
    v_xor_b32 v22, 32768, v21
    s_lshl_b32 s37, s28, 8
    s_add_u32 s37, s37, 131072
    v_lshl_add_u32 v23, v1, 2, s37
    v_xor_b32 v24, 1024, v23
    ds_write_b32 v23, v38
    s_mov_b32 s36, 0x5d800000
    v_cmp_nge_f32 vcc, s36, v38
    s_nop 0
    s_or_b64 s[52:53], s[52:53], vcc
    v_cmp_nge_f32 vcc, s36, v39
    s_nop 0
    s_or_b64 s[52:53], s[52:53], vcc
    s_or_b32 s36, s52, s53
    v_mov_b32 v26, s36
    s_lshl_b32 s37, s28, 2
    s_add_u32 s37, s37, 135168
    v_mov_b32 v27, s37
    ds_write_b32 v27, v26
    ds_write_b128 v21, v[192:195] offset:0
    ds_write_b128 v21, v[196:199] offset:1024
    ds_write_b128 v21, v[200:203] offset:2048
    ds_write_b128 v21, v[204:207] offset:3072
    ds_write_b128 v21, v[208:211] offset:4096
    ds_write_b128 v21, v[212:215] offset:5120
    ds_write_b128 v21, v[216:219] offset:6144
    ds_write_b128 v21, v[220:223] offset:7168
    v_and_b32 v27, 7, v1
    v_lshlrev_b32 v27, 2, v27
    v_add_u32 v27, 135168, v27
    s_sub_u32 s36, 15, s30
    s_lshl_b32 s38, s36, 3
    s_and_b32 s37, s28, 3
    s_lshl_b32 s37, s37, 1
    s_add_u32 s38, s38, s37
    s_add_u32 s38, s38, 1
    s_lshl_b32 s38, s38, 17
    s_lshl_b32 s37, s29, 12
    s_add_u32 s38, s38, s37
    s_waitcnt lgkmcnt(0)
    s_barrier
    ds_read_b32 v26, v27
    ds_read_b32 v25, v24
    ds_read_b128 v[64:67], v22 offset:0
    ds_read_b128 v[68:71], v22 offset:1024
    ds_read_b128 v[72:75], v22 offset:2048
    ds_read_b128 v[76:79], v22 offset:3072
    ds_read_b128 v[80:83], v22 offset:4096
    ds_read_b128 v[84:87], v22 offset:5120
    ds_read_b128 v[88:91], v22 offset:6144
    ds_read_b128 v[92:95], v22 offset:7168
    s_waitcnt lgkmcnt(8)
    v_add_f32 v25, v25, v39
    v_mov_b32 v20, v25
    s_nop 1
    v_permlane16_swap_b32 v25, v20
    s_nop 1
    v_add_f32 v25, v25, v20
    v_mov_b32 v20, v25
    s_nop 1
    v_permlane32_swap_b32 v25, v20
    s_nop 1
    v_add_f32 v25, v25, v20
    v_cmp_ne_u32 s[52:53], 0, v26
    v_rcp_f32 v25, v25
    s_waitcnt lgkmcnt(6)
    v_add_f32 v224, v224, v64
    v_add_f32 v225, v225, v65
    v_add_f32 v226, v226, v66
    v_add_f32 v227, v227, v67
    v_add_f32 v228, v228, v68
    v_add_f32 v229, v229, v69
    v_add_f32 v230, v230, v70
    v_add_f32 v231, v231, v71
    v_mul_f32 v224, v25, v224
    v_mul_f32 v225, v25, v225
    v_mul_f32 v226, v25, v226
    v_mul_f32 v227, v25, v227
    v_mul_f32 v228, v25, v228
    v_mul_f32 v229, v25, v229
    v_mul_f32 v230, v25, v230
    v_mul_f32 v231, v25, v231
    v_cvt_pk_bf16_f32 v48, v224, v225
    v_cvt_pk_bf16_f32 v49, v226, v227
    v_cvt_pk_bf16_f32 v50, v228, v229
    v_cvt_pk_bf16_f32 v51, v230, v231
    buffer_store_dwordx4 v[48:51], v7, s[16:19], s38 offen offset:0
    s_waitcnt lgkmcnt(4)
    v_add_f32 v232, v232, v72
    v_add_f32 v233, v233, v73
    v_add_f32 v234, v234, v74
    v_add_f32 v235, v235, v75
    v_add_f32 v236, v236, v76
    v_add_f32 v237, v237, v77
    v_add_f32 v238, v238, v78
    v_add_f32 v239, v239, v79
    v_mul_f32 v232, v25, v232
    v_mul_f32 v233, v25, v233
    v_mul_f32 v234, v25, v234
    v_mul_f32 v235, v25, v235
    v_mul_f32 v236, v25, v236
    v_mul_f32 v237, v25, v237
    v_mul_f32 v238, v25, v238
    v_mul_f32 v239, v25, v239
    v_cvt_pk_bf16_f32 v52, v232, v233
    v_cvt_pk_bf16_f32 v53, v234, v235
    v_cvt_pk_bf16_f32 v54, v236, v237
    v_cvt_pk_bf16_f32 v55, v238, v239
    buffer_store_dwordx4 v[52:55], v7, s[16:19], s38 offen offset:1024
    s_waitcnt lgkmcnt(2)
    v_add_f32 v240, v240, v80
    v_add_f32 v241, v241, v81
    v_add_f32 v242, v242, v82
    v_add_f32 v243, v243, v83
    v_add_f32 v244, v244, v84
    v_add_f32 v245, v245, v85
    v_add_f32 v246, v246, v86
    v_add_f32 v247, v247, v87
    v_mul_f32 v240, v25, v240
    v_mul_f32 v241, v25, v241
    v_mul_f32 v242, v25, v242
    v_mul_f32 v243, v25, v243
    v_mul_f32 v244, v25, v244
    v_mul_f32 v245, v25, v245
    v_mul_f32 v246, v25, v246
    v_mul_f32 v247, v25, v247
    v_cvt_pk_bf16_f32 v56, v240, v241
    v_cvt_pk_bf16_f32 v57, v242, v243
    v_cvt_pk_bf16_f32 v58, v244, v245
    v_cvt_pk_bf16_f32 v59, v246, v247
    buffer_store_dwordx4 v[56:59], v7, s[16:19], s38 offen offset:2048
    s_waitcnt lgkmcnt(0)
    v_add_f32 v248, v248, v88
    v_add_f32 v249, v249, v89
    v_add_f32 v250, v250, v90
    v_add_f32 v251, v251, v91
    v_add_f32 v252, v252, v92
    v_add_f32 v253, v253, v93
    v_add_f32 v254, v254, v94
    v_add_f32 v255, v255, v95
    v_mul_f32 v248, v25, v248
    v_mul_f32 v249, v25, v249
    v_mul_f32 v250, v25, v250
    v_mul_f32 v251, v25, v251
    v_mul_f32 v252, v25, v252
    v_mul_f32 v253, v25, v253
    v_mul_f32 v254, v25, v254
    v_mul_f32 v255, v25, v255
    v_cvt_pk_bf16_f32 v60, v248, v249
    v_cvt_pk_bf16_f32 v61, v250, v251
    v_cvt_pk_bf16_f32 v62, v252, v253
    v_cvt_pk_bf16_f32 v63, v254, v255
    buffer_store_dwordx4 v[60:63], v7, s[16:19], s38 offen offset:3072
    s_cmp_eq_u64 s[52:53], 0
    s_cbranch_scc1 L_p3_done
    v_swap_b32 v128, v160
    v_swap_b32 v129, v161
    v_swap_b32 v130, v162
    v_swap_b32 v131, v163
    v_swap_b32 v132, v164
    v_swap_b32 v133, v165
    v_swap_b32 v134, v166
    v_swap_b32 v135, v167
    v_swap_b32 v136, v168
    v_swap_b32 v137, v169
    v_swap_b32 v138, v170
    v_swap_b32 v139, v171
    v_swap_b32 v140, v172
    v_swap_b32 v141, v173
    v_swap_b32 v142, v174
    v_swap_b32 v143, v175
    v_swap_b32 v144, v176
    v_swap_b32 v145, v177
    v_swap_b32 v146, v178
    v_swap_b32 v147, v179
    v_swap_b32 v148, v180
    v_swap_b32 v149, v181
    v_swap_b32 v150, v182
    v_swap_b32 v151, v183
    v_swap_b32 v152, v184
    v_swap_b32 v153, v185
    v_swap_b32 v154, v186
    v_swap_b32 v155, v187
    v_swap_b32 v156, v188
    v_swap_b32 v157, v189
    v_swap_b32 v158, v190
    v_swap_b32 v159, v191
    v_mov_b32 v192, 0
    v_mov_b32 v193, 0
    v_mov_b32 v194, 0
    v_mov_b32 v195, 0
    v_mov_b32 v196, 0
    v_mov_b32 v197, 0
    v_mov_b32 v198, 0
    v_mov_b32 v199, 0
    v_mov_b32 v200, 0
    v_mov_b32 v201, 0
    v_mov_b32 v202, 0
    v_mov_b32 v203, 0
    v_mov_b32 v204, 0
    v_mov_b32 v205, 0
    v_mov_b32 v206, 0
    v_mov_b32 v207, 0
    v_mov_b32 v208, 0
    v_mov_b32 v209, 0
    v_mov_b32 v210, 0
    v_mov_b32 v211, 0
    v_mov_b32 v212, 0
    v_mov_b32 v213, 0
    v_mov_b32 v214, 0
    v_mov_b32 v215, 0
    v_mov_b32 v216, 0
    v_mov_b32 v217, 0
    v_mov_b32 v218, 0
    v_mov_b32 v219, 0
    v_mov_b32 v220, 0
    v_mov_b32 v221, 0
    v_mov_b32 v222, 0
    v_mov_b32 v223, 0
    v_mov_b32 v224, 0
    v_mov_b32 v225, 0
    v_mov_b32 v226, 0
    v_mov_b32 v227, 0
    v_mov_b32 v228, 0
    v_mov_b32 v229, 0
    v_mov_b32 v230, 0
    v_mov_b32 v231, 0
    v_mov_b32 v232, 0
    v_mov_b32 v233, 0
    v_mov_b32 v234, 0
    v_mov_b32 v235, 0
    v_mov_b32 v236, 0
    v_mov_b32 v237, 0
    v_mov_b32 v238, 0
    v_mov_b32 v239, 0
    v_mov_b32 v240, 0
    v_mov_b32 v241, 0
    v_mov_b32 v242, 0
    v_mov_b32 v243, 0
    v_mov_b32 v244, 0
    v_mov_b32 v245, 0
    v_mov_b32 v246, 0
    v_mov_b32 v247, 0
    v_mov_b32 v248, 0
    v_mov_b32 v249, 0
    v_mov_b32 v250, 0
    v_mov_b32 v251, 0
    v_mov_b32 v252, 0
    v_mov_b32 v253, 0
    v_mov_b32 v254, 0
    v_mov_b32 v255, 0
    v_mov_b32 v38, 0
    v_mov_b32 v40, 4048155338
    v_mov_b32 v39, 0
    v_mov_b32 v41, 4048155338
    s_lshl_b32 s43, s28, 12
    v_add_u32 v4, s43, v7
    s_mov_b32 s46, s45
    s_sub_u32 s40, 16, s30
    s_mov_b32 s39, s30
    s_lshl_b32 s37, s39, 7
    s_and_b32 s36, s28, 3
    s_lshl_b32 s36, s36, 5
    s_add_u32 s36, s36, s37
    s_sub_u32 s50, 0, s36
L_attn_kernel_stile_35:
    s_waitcnt vmcnt(0) lgkmcnt(0)
    s_barrier
    s_mov_b32 m0, s43
    s_add_u32 s47, s46, 32768
    buffer_load_dwordx4 v4, s[12:15], s46 offen offset:0 lds
    buffer_load_dwordx4 v4, s[12:15], s46 offen offset:1024 lds
    buffer_load_dwordx4 v4, s[12:15], s46 offen offset:2048 lds
    buffer_load_dwordx4 v4, s[12:15], s46 offen offset:3072 lds
    s_add_u32 m0, s43, 32768
    s_add_u32 s46, s46, 65536
    buffer_load_dwordx4 v4, s[12:15], s47 offen offset:0 lds
    buffer_load_dwordx4 v4, s[12:15], s47 offen offset:1024 lds
    buffer_load_dwordx4 v4, s[12:15], s47 offen offset:2048 lds
    buffer_load_dwordx4 v4, s[12:15], s47 offen offset:3072 lds
    v_mov_b32 v2, v7
    s_mov_b32 s41, 4
    s_waitcnt vmcnt(0)
    s_barrier
L_attn_kernel_sunit_36:
    s_cmp_gt_i32 s50, 0
    s_cbranch_scc1 L_attn_kernel_snext_37
    ds_read_b128 v[64:67], v2 offset:0
    ds_read_b128 v[68:71], v2 offset:1024
    ds_read_b128 v[72:75], v2 offset:2048
    ds_read_b128 v[76:79], v2 offset:3072
    ds_read_b128 v[80:83], v2 offset:4096
    ds_read_b128 v[84:87], v2 offset:5120
    ds_read_b128 v[88:91], v2 offset:6144
    ds_read_b128 v[92:95], v2 offset:7168
    s_waitcnt lgkmcnt(0)
    v_mfma_f32_16x16x32_bf16 v[96:99], v[64:67], v[128:131], 0
    v_mfma_f32_16x16x32_bf16 v[104:107], v[64:67], v[144:147], 0
    v_mfma_f32_16x16x32_bf16 v[96:99], v[68:71], v[132:135], v[96:99]
    v_mfma_f32_16x16x32_bf16 v[104:107], v[68:71], v[148:151], v[104:107]
    v_mfma_f32_16x16x32_bf16 v[96:99], v[72:75], v[136:139], v[96:99]
    v_mfma_f32_16x16x32_bf16 v[104:107], v[72:75], v[152:155], v[104:107]
    v_mfma_f32_16x16x32_bf16 v[96:99], v[76:79], v[140:143], v[96:99]
    v_mfma_f32_16x16x32_bf16 v[104:107], v[76:79], v[156:159], v[104:107]
    v_mfma_f32_16x16x32_bf16 v[100:103], v[80:83], v[128:131], 0
    v_mfma_f32_16x16x32_bf16 v[108:111], v[80:83], v[144:147], 0
    v_mfma_f32_16x16x32_bf16 v[100:103], v[84:87], v[132:135], v[100:103]
    v_mfma_f32_16x16x32_bf16 v[108:111], v[84:87], v[148:151], v[108:111]
    v_mfma_f32_16x16x32_bf16 v[100:103], v[88:91], v[136:139], v[100:103]
    v_mfma_f32_16x16x32_bf16 v[108:111], v[88:91], v[152:155], v[108:111]
    v_mfma_f32_16x16x32_bf16 v[100:103], v[92:95], v[140:143], v[100:103]
    v_mfma_f32_16x16x32_bf16 v[108:111], v[92:95], v[156:159], v[108:111]
    ds_read_b128 v[64:67], v2 offset:32768
    ds_read_b128 v[68:71], v2 offset:33792
    ds_read_b128 v[72:75], v2 offset:34816
    ds_read_b128 v[76:79], v2 offset:35840
    ds_read_b128 v[80:83], v2 offset:36864
    ds_read_b128 v[84:87], v2 offset:37888
    ds_read_b128 v[88:91], v2 offset:38912
    ds_read_b128 v[92:95], v2 offset:39936
    s_nop 1
    s_cmp_lt_i32 s50, 0
    s_cbranch_scc0 L_attn_kernel_rare_38
L_attn_kernel_back_39:
    v_max3_f32 v22, v96, v97, v98
    v_max3_f32 v22, v22, v99, v100
    v_max3_f32 v22, v22, v101, v102
    v_max3_f32 v22, v22, v103, v40
    v_mov_b32 v24, v22
    s_nop 1
    v_permlane16_swap_b32 v22, v24
    s_nop 1
    v_max_f32 v22, v22, v24
    v_mov_b32 v24, v22
    s_nop 1
    v_permlane32_swap_b32 v22, v24
    s_nop 1
    v_max_f32 v22, v22, v24
    v_sub_f32 v25, v40, v22
    v_exp_f32 v25, v25
    v_mov_b32 v40, v22
    v_mul_f32 v38, v38, v25
    v_mul_f32 v192, v192, v25
    v_mul_f32 v193, v193, v25
    v_mul_f32 v194, v194, v25
    v_mul_f32 v195, v195, v25
    v_mul_f32 v196, v196, v25
    v_mul_f32 v197, v197, v25
    v_mul_f32 v198, v198, v25
    v_mul_f32 v199, v199, v25
    v_mul_f32 v200, v200, v25
    v_mul_f32 v201, v201, v25
    v_mul_f32 v202, v202, v25
    v_mul_f32 v203, v203, v25
    v_mul_f32 v204, v204, v25
    v_mul_f32 v205, v205, v25
    v_mul_f32 v206, v206, v25
    v_mul_f32 v207, v207, v25
    v_mul_f32 v208, v208, v25
    v_mul_f32 v209, v209, v25
    v_mul_f32 v210, v210, v25
    v_mul_f32 v211, v211, v25
    v_mul_f32 v212, v212, v25
    v_mul_f32 v213, v213, v25
    v_mul_f32 v214, v214, v25
    v_mul_f32 v215, v215, v25
    v_mul_f32 v216, v216, v25
    v_mul_f32 v217, v217, v25
    v_mul_f32 v218, v218, v25
    v_mul_f32 v219, v219, v25
    v_mul_f32 v220, v220, v25
    v_mul_f32 v221, v221, v25
    v_mul_f32 v222, v222, v25
    v_mul_f32 v223, v223, v25
    v_sub_f32 v96, v96, v22
    v_sub_f32 v97, v97, v22
    v_sub_f32 v98, v98, v22
    v_sub_f32 v99, v99, v22
    v_sub_f32 v100, v100, v22
    v_sub_f32 v101, v101, v22
    v_sub_f32 v102, v102, v22
    v_sub_f32 v103, v103, v22
    v_max3_f32 v23, v104, v105, v106
    v_max3_f32 v23, v23, v107, v108
    v_max3_f32 v23, v23, v109, v110
    v_max3_f32 v23, v23, v111, v41
    v_mov_b32 v24, v23
    s_nop 1
    v_permlane16_swap_b32 v23, v24
    s_nop 1
    v_max_f32 v23, v23, v24
    v_mov_b32 v24, v23
    s_nop 1
    v_permlane32_swap_b32 v23, v24
    s_nop 1
    v_max_f32 v23, v23, v24
    v_sub_f32 v25, v41, v23
    v_exp_f32 v25, v25
    v_mov_b32 v41, v23
    v_mul_f32 v39, v39, v25
    v_mul_f32 v224, v224, v25
    v_mul_f32 v225, v225, v25
    v_mul_f32 v226, v226, v25
    v_mul_f32 v227, v227, v25
    v_mul_f32 v228, v228, v25
    v_mul_f32 v229, v229, v25
    v_mul_f32 v230, v230, v25
    v_mul_f32 v231, v231, v25
    v_mul_f32 v232, v232, v25
    v_mul_f32 v233, v233, v25
    v_mul_f32 v234, v234, v25
    v_mul_f32 v235, v235, v25
    v_mul_f32 v236, v236, v25
    v_mul_f32 v237, v237, v25
    v_mul_f32 v238, v238, v25
    v_mul_f32 v239, v239, v25
    v_mul_f32 v240, v240, v25
    v_mul_f32 v241, v241, v25
    v_mul_f32 v242, v242, v25
    v_mul_f32 v243, v243, v25
    v_mul_f32 v244, v244, v25
    v_mul_f32 v245, v245, v25
    v_mul_f32 v246, v246, v25
    v_mul_f32 v247, v247, v25
    v_mul_f32 v248, v248, v25
    v_mul_f32 v249, v249, v25
    v_mul_f32 v250, v250, v25
    v_mul_f32 v251, v251, v25
    v_mul_f32 v252, v252, v25
    v_mul_f32 v253, v253, v25
    v_mul_f32 v254, v254, v25
    v_mul_f32 v255, v255, v25
    v_sub_f32 v104, v104, v23
    v_sub_f32 v105, v105, v23
    v_sub_f32 v106, v106, v23
    v_sub_f32 v107, v107, v23
    v_sub_f32 v108, v108, v23
    v_sub_f32 v109, v109, v23
    v_sub_f32 v110, v110, v23
    v_sub_f32 v111, v111, v23
    v_exp_f32 v96, v96
    v_exp_f32 v97, v97
    v_exp_f32 v98, v98
    v_exp_f32 v99, v99
    v_exp_f32 v104, v104
    v_exp_f32 v105, v105
    v_exp_f32 v106, v106
    v_exp_f32 v107, v107
    v_exp_f32 v100, v100
    v_exp_f32 v101, v101
    v_exp_f32 v102, v102
    v_exp_f32 v103, v103
    v_exp_f32 v108, v108
    v_exp_f32 v109, v109
    v_exp_f32 v110, v110
    v_exp_f32 v111, v111
    v_add_f32 v38, v38, v96
    v_add_f32 v38, v38, v97
    v_cvt_pk_bf16_f32 v48, v96, v97
    v_add_f32 v38, v38, v98
    v_add_f32 v38, v38, v99
    v_cvt_pk_bf16_f32 v49, v98, v99
    v_add_f32 v39, v39, v104
    v_add_f32 v39, v39, v105
    v_cvt_pk_bf16_f32 v52, v104, v105
    v_add_f32 v39, v39, v106
    v_add_f32 v39, v39, v107
    v_cvt_pk_bf16_f32 v53, v106, v107
    v_add_f32 v38, v38, v100
    v_add_f32 v38, v38, v101
    v_cvt_pk_bf16_f32 v50, v100, v101
    v_add_f32 v38, v38, v102
    v_add_f32 v38, v38, v103
    v_cvt_pk_bf16_f32 v51, v102, v103
    v_add_f32 v39, v39, v108
    v_add_f32 v39, v39, v109
    v_cvt_pk_bf16_f32 v54, v108, v109
    v_add_f32 v39, v39, v110
    v_add_f32 v39, v39, v111
    v_cvt_pk_bf16_f32 v55, v110, v111
    s_waitcnt lgkmcnt(0)
    s_nop 0
    v_mfma_f32_16x16x32_bf16 v[192:195], v[64:67], v[48:51], v[192:195]
    v_mfma_f32_16x16x32_bf16 v[224:227], v[64:67], v[52:55], v[224:227]
    v_mfma_f32_16x16x32_bf16 v[196:199], v[68:71], v[48:51], v[196:199]
    v_mfma_f32_16x16x32_bf16 v[228:231], v[68:71], v[52:55], v[228:231]
    v_mfma_f32_16x16x32_bf16 v[200:203], v[72:75], v[48:51], v[200:203]
    v_mfma_f32_16x16x32_bf16 v[232:235], v[72:75], v[52:55], v[232:235]
    v_mfma_f32_16x16x32_bf16 v[204:207], v[76:79], v[48:51], v[204:207]
    v_mfma_f32_16x16x32_bf16 v[236:239], v[76:79], v[52:55], v[236:239]
    v_mfma_f32_16x16x32_bf16 v[208:211], v[80:83], v[48:51], v[208:211]
    v_mfma_f32_16x16x32_bf16 v[240:243], v[80:83], v[52:55], v[240:243]
    v_mfma_f32_16x16x32_bf16 v[212:215], v[84:87], v[48:51], v[212:215]
    v_mfma_f32_16x16x32_bf16 v[244:247], v[84:87], v[52:55], v[244:247]
    v_mfma_f32_16x16x32_bf16 v[216:219], v[88:91], v[48:51], v[216:219]
    v_mfma_f32_16x16x32_bf16 v[248:251], v[88:91], v[52:55], v[248:251]
    v_mfma_f32_16x16x32_bf16 v[220:223], v[92:95], v[48:51], v[220:223]
    v_mfma_f32_16x16x32_bf16 v[252:255], v[92:95], v[52:55], v[252:255]
L_attn_kernel_snext_37:
    v_add_u32 v2, 8192, v2
    s_add_u32 s50, s50, 32
    s_sub_u32 s41, s41, 1
    s_cmp_lg_u32 s41, 0
    s_cbranch_scc1 L_attn_kernel_sunit_36
    s_sub_u32 s40, s40, 1
    s_cmp_lg_u32 s40, 0
    s_cbranch_scc1 L_attn_kernel_stile_35
    v_mov_b32 v20, v38
    s_nop 1
    v_permlane16_swap_b32 v38, v20
    s_nop 1
    v_add_f32 v38, v38, v20
    v_mov_b32 v20, v38
    s_nop 1
    v_permlane32_swap_b32 v38, v20
    s_nop 1
    v_add_f32 v38, v38, v20
    v_mov_b32 v20, v39
    s_nop 1
    v_permlane16_swap_b32 v39, v20
    s_nop 1
    v_add_f32 v39, v39, v20
    v_mov_b32 v20, v39
    s_nop 1
    v_permlane32_swap_b32 v39, v20
    s_nop 1
    v_add_f32 v39, v39, v20
    s_mov_b32 s36, 0x5d800000
    v_cmp_nge_f32 vcc, s36, v38
    s_nop 0
    s_or_b64 s[52:53], s[52:53], vcc
    v_cmp_nge_f32 vcc, s36, v39
    s_nop 0
    s_or_b64 s[52:53], s[52:53], vcc
    v_rcp_f32 v38, v38
    v_rcp_f32 v39, v39
    s_lshl_b32 s38, s39, 3
    s_and_b32 s37, s28, 3
    s_lshl_b32 s37, s37, 1
    s_add_u32 s38, s38, s37
    s_lshl_b32 s38, s38, 17
    s_lshl_b32 s37, s29, 12
    s_add_u32 s38, s38, s37
    v_mul_f32 v192, v38, v192
    v_mul_f32 v193, v38, v193
    v_mul_f32 v194, v38, v194
    v_mul_f32 v195, v38, v195
    v_mul_f32 v196, v38, v196
    v_mul_f32 v197, v38, v197
    v_mul_f32 v198, v38, v198
    v_mul_f32 v199, v38, v199
    v_cvt_pk_bf16_f32 v22, v192, v193
    v_cvt_pk_bf16_f32 v23, v194, v195
    v_cvt_pk_bf16_f32 v24, v196, v197
    v_cvt_pk_bf16_f32 v25, v198, v199
    buffer_store_dwordx4 v[22:25], v7, s[16:19], s38 offen offset:0
    v_mul_f32 v200, v38, v200
    v_mul_f32 v201, v38, v201
    v_mul_f32 v202, v38, v202
    v_mul_f32 v203, v38, v203
    v_mul_f32 v204, v38, v204
    v_mul_f32 v205, v38, v205
    v_mul_f32 v206, v38, v206
    v_mul_f32 v207, v38, v207
    v_cvt_pk_bf16_f32 v26, v200, v201
    v_cvt_pk_bf16_f32 v27, v202, v203
    v_cvt_pk_bf16_f32 v28, v204, v205
    v_cvt_pk_bf16_f32 v29, v206, v207
    buffer_store_dwordx4 v[26:29], v7, s[16:19], s38 offen offset:1024
    v_mul_f32 v208, v38, v208
    v_mul_f32 v209, v38, v209
    v_mul_f32 v210, v38, v210
    v_mul_f32 v211, v38, v211
    v_mul_f32 v212, v38, v212
    v_mul_f32 v213, v38, v213
    v_mul_f32 v214, v38, v214
    v_mul_f32 v215, v38, v215
    v_cvt_pk_bf16_f32 v30, v208, v209
    v_cvt_pk_bf16_f32 v31, v210, v211
    v_cvt_pk_bf16_f32 v32, v212, v213
    v_cvt_pk_bf16_f32 v33, v214, v215
    buffer_store_dwordx4 v[30:33], v7, s[16:19], s38 offen offset:2048
    v_mul_f32 v216, v38, v216
    v_mul_f32 v217, v38, v217
    v_mul_f32 v218, v38, v218
    v_mul_f32 v219, v38, v219
    v_mul_f32 v220, v38, v220
    v_mul_f32 v221, v38, v221
    v_mul_f32 v222, v38, v222
    v_mul_f32 v223, v38, v223
    v_cvt_pk_bf16_f32 v34, v216, v217
    v_cvt_pk_bf16_f32 v35, v218, v219
    v_cvt_pk_bf16_f32 v36, v220, v221
    v_cvt_pk_bf16_f32 v37, v222, v223
    buffer_store_dwordx4 v[34:37], v7, s[16:19], s38 offen offset:3072
    s_add_u32 s38, s38, 131072
    v_mul_f32 v224, v39, v224
    v_mul_f32 v225, v39, v225
    v_mul_f32 v226, v39, v226
    v_mul_f32 v227, v39, v227
    v_mul_f32 v228, v39, v228
    v_mul_f32 v229, v39, v229
    v_mul_f32 v230, v39, v230
    v_mul_f32 v231, v39, v231
    v_cvt_pk_bf16_f32 v22, v224, v225
    v_cvt_pk_bf16_f32 v23, v226, v227
    v_cvt_pk_bf16_f32 v24, v228, v229
    v_cvt_pk_bf16_f32 v25, v230, v231
    buffer_store_dwordx4 v[22:25], v7, s[16:19], s38 offen offset:0
    v_mul_f32 v232, v39, v232
    v_mul_f32 v233, v39, v233
    v_mul_f32 v234, v39, v234
    v_mul_f32 v235, v39, v235
    v_mul_f32 v236, v39, v236
    v_mul_f32 v237, v39, v237
    v_mul_f32 v238, v39, v238
    v_mul_f32 v239, v39, v239
    v_cvt_pk_bf16_f32 v26, v232, v233
    v_cvt_pk_bf16_f32 v27, v234, v235
    v_cvt_pk_bf16_f32 v28, v236, v237
    v_cvt_pk_bf16_f32 v29, v238, v239
    buffer_store_dwordx4 v[26:29], v7, s[16:19], s38 offen offset:1024
    v_mul_f32 v240, v39, v240
    v_mul_f32 v241, v39, v241
    v_mul_f32 v242, v39, v242
    v_mul_f32 v243, v39, v243
    v_mul_f32 v244, v39, v244
    v_mul_f32 v245, v39, v245
    v_mul_f32 v246, v39, v246
    v_mul_f32 v247, v39, v247
    v_cvt_pk_bf16_f32 v30, v240, v241
    v_cvt_pk_bf16_f32 v31, v242, v243
    v_cvt_pk_bf16_f32 v32, v244, v245
    v_cvt_pk_bf16_f32 v33, v246, v247
    buffer_store_dwordx4 v[30:33], v7, s[16:19], s38 offen offset:2048
    v_mul_f32 v248, v39, v248
    v_mul_f32 v249, v39, v249
    v_mul_f32 v250, v39, v250
    v_mul_f32 v251, v39, v251
    v_mul_f32 v252, v39, v252
    v_mul_f32 v253, v39, v253
    v_mul_f32 v254, v39, v254
    v_mul_f32 v255, v39, v255
    v_cvt_pk_bf16_f32 v34, v248, v249
    v_cvt_pk_bf16_f32 v35, v250, v251
    v_cvt_pk_bf16_f32 v36, v252, v253
    v_cvt_pk_bf16_f32 v37, v254, v255
    buffer_store_dwordx4 v[34:37], v7, s[16:19], s38 offen offset:3072
    s_branch L_p3_done
L_attn_kernel_rare_22:
    v_mov_b32 v20, 4048155338
    v_subrev_u32 v21, s50, v18
    v_cmp_gt_i32 s[20:21], 0, v21
    v_cmp_gt_i32 s[22:23], 1, v21
    v_cmp_gt_i32 s[24:25], 2, v21
    v_cmp_gt_i32 s[26:27], 3, v21
    v_cndmask_b32 v96, v96, v20, s[20:21]
    v_cndmask_b32 v97, v97, v20, s[22:23]
    v_cndmask_b32 v98, v98, v20, s[24:25]
    v_cndmask_b32 v99, v99, v20, s[26:27]
    v_cmp_gt_i32 s[20:21], 16, v21
    v_cmp_gt_i32 s[22:23], 17, v21
    v_cmp_gt_i32 s[24:25], 18, v21
    v_cmp_gt_i32 s[26:27], 19, v21
    v_cndmask_b32 v100, v100, v20, s[20:21]
    v_cndmask_b32 v101, v101, v20, s[22:23]
    v_cndmask_b32 v102, v102, v20, s[24:25]
    v_cndmask_b32 v103, v103, v20, s[26:27]
    v_cmp_gt_i32 s[20:21], -16, v21
    v_cmp_gt_i32 s[22:23], -15, v21
    v_cmp_gt_i32 s[24:25], -14, v21
    v_cmp_gt_i32 s[26:27], -13, v21
    v_cndmask_b32 v104, v104, v20, s[20:21]
    v_cndmask_b32 v105, v105, v20, s[22:23]
    v_cndmask_b32 v106, v106, v20, s[24:25]
    v_cndmask_b32 v107, v107, v20, s[26:27]
    v_cmp_gt_i32 s[20:21], 0, v21
    v_cmp_gt_i32 s[22:23], 1, v21
    v_cmp_gt_i32 s[24:25], 2, v21
    v_cmp_gt_i32 s[26:27], 3, v21
    v_cndmask_b32 v108, v108, v20, s[20:21]
    v_cndmask_b32 v109, v109, v20, s[22:23]
    v_cndmask_b32 v110, v110, v20, s[24:25]
    v_cndmask_b32 v111, v111, v20, s[26:27]
    s_branch L_attn_kernel_back_23
L_attn_kernel_rare_24:
    v_mov_b32 v20, 4048155338
    v_subrev_u32 v21, s49, v18
    v_cmp_gt_i32 s[20:21], 0, v21
    v_cmp_gt_i32 s[22:23], 1, v21
    v_cmp_gt_i32 s[24:25], 2, v21
    v_cmp_gt_i32 s[26:27], 3, v21
    v_cndmask_b32 v112, v112, v20, s[20:21]
    v_cndmask_b32 v113, v113, v20, s[22:23]
    v_cndmask_b32 v114, v114, v20, s[24:25]
    v_cndmask_b32 v115, v115, v20, s[26:27]
    v_cmp_gt_i32 s[20:21], 16, v21
    v_cmp_gt_i32 s[22:23], 17, v21
    v_cmp_gt_i32 s[24:25], 18, v21
    v_cmp_gt_i32 s[26:27], 19, v21
    v_cndmask_b32 v116, v116, v20, s[20:21]
    v_cndmask_b32 v117, v117, v20, s[22:23]
    v_cndmask_b32 v118, v118, v20, s[24:25]
    v_cndmask_b32 v119, v119, v20, s[26:27]
    v_cmp_gt_i32 s[20:21], -16, v21
    v_cmp_gt_i32 s[22:23], -15, v21
    v_cmp_gt_i32 s[24:25], -14, v21
    v_cmp_gt_i32 s[26:27], -13, v21
    v_cndmask_b32 v120, v120, v20, s[20:21]
    v_cndmask_b32 v121, v121, v20, s[22:23]
    v_cndmask_b32 v122, v122, v20, s[24:25]
    v_cndmask_b32 v123, v123, v20, s[26:27]
    v_cmp_gt_i32 s[20:21], 0, v21
    v_cmp_gt_i32 s[22:23], 1, v21
    v_cmp_gt_i32 s[24:25], 2, v21
    v_cmp_gt_i32 s[26:27], 3, v21
    v_cndmask_b32 v124, v124, v20, s[20:21]
    v_cndmask_b32 v125, v125, v20, s[22:23]
    v_cndmask_b32 v126, v126, v20, s[24:25]
    v_cndmask_b32 v127, v127, v20, s[26:27]
    s_branch L_attn_kernel_back_25
L_attn_kernel_rare_26:
    v_mov_b32 v8, v38
    v_mov_b32 v9, v39
    v_mov_b32 v38, 0
    v_mov_b32 v39, 0
    s_branch L_attn_kernel_back_27
L_attn_kernel_rare_28:
    v_mov_b32 v20, 4048155338
    v_subrev_u32 v21, s50, v18
    v_cmp_gt_i32 s[20:21], 0, v21
    v_cmp_gt_i32 s[22:23], 1, v21
    v_cmp_gt_i32 s[24:25], 2, v21
    v_cmp_gt_i32 s[26:27], 3, v21
    v_cndmask_b32 v96, v96, v20, s[20:21]
    v_cndmask_b32 v97, v97, v20, s[22:23]
    v_cndmask_b32 v98, v98, v20, s[24:25]
    v_cndmask_b32 v99, v99, v20, s[26:27]
    v_cmp_gt_i32 s[20:21], 16, v21
    v_cmp_gt_i32 s[22:23], 17, v21
    v_cmp_gt_i32 s[24:25], 18, v21
    v_cmp_gt_i32 s[26:27], 19, v21
    v_cndmask_b32 v100, v100, v20, s[20:21]
    v_cndmask_b32 v101, v101, v20, s[22:23]
    v_cndmask_b32 v102, v102, v20, s[24:25]
    v_cndmask_b32 v103, v103, v20, s[26:27]
    v_cmp_gt_i32 s[20:21], -16, v21
    v_cmp_gt_i32 s[22:23], -15, v21
    v_cmp_gt_i32 s[24:25], -14, v21
    v_cmp_gt_i32 s[26:27], -13, v21
    v_cndmask_b32 v104, v104, v20, s[20:21]
    v_cndmask_b32 v105, v105, v20, s[22:23]
    v_cndmask_b32 v106, v106, v20, s[24:25]
    v_cndmask_b32 v107, v107, v20, s[26:27]
    v_cmp_gt_i32 s[20:21], 0, v21
    v_cmp_gt_i32 s[22:23], 1, v21
    v_cmp_gt_i32 s[24:25], 2, v21
    v_cmp_gt_i32 s[26:27], 3, v21
    v_cndmask_b32 v108, v108, v20, s[20:21]
    v_cndmask_b32 v109, v109, v20, s[22:23]
    v_cndmask_b32 v110, v110, v20, s[24:25]
    v_cndmask_b32 v111, v111, v20, s[26:27]
    s_branch L_attn_kernel_back_29
L_attn_kernel_rare_30:
    v_mov_b32 v20, 4048155338
    v_subrev_u32 v21, s49, v18
    v_cmp_gt_i32 s[20:21], 0, v21
    v_cmp_gt_i32 s[22:23], 1, v21
    v_cmp_gt_i32 s[24:25], 2, v21
    v_cmp_gt_i32 s[26:27], 3, v21
    v_cndmask_b32 v112, v112, v20, s[20:21]
    v_cndmask_b32 v113, v113, v20, s[22:23]
    v_cndmask_b32 v114, v114, v20, s[24:25]
    v_cndmask_b32 v115, v115, v20, s[26:27]
    v_cmp_gt_i32 s[20:21], 16, v21
    v_cmp_gt_i32 s[22:23], 17, v21
    v_cmp_gt_i32 s[24:25], 18, v21
    v_cmp_gt_i32 s[26:27], 19, v21
    v_cndmask_b32 v116, v116, v20, s[20:21]
    v_cndmask_b32 v117, v117, v20, s[22:23]
    v_cndmask_b32 v118, v118, v20, s[24:25]
    v_cndmask_b32 v119, v119, v20, s[26:27]
    v_cmp_gt_i32 s[20:21], -16, v21
    v_cmp_gt_i32 s[22:23], -15, v21
    v_cmp_gt_i32 s[24:25], -14, v21
    v_cmp_gt_i32 s[26:27], -13, v21
    v_cndmask_b32 v120, v120, v20, s[20:21]
    v_cndmask_b32 v121, v121, v20, s[22:23]
    v_cndmask_b32 v122, v122, v20, s[24:25]
    v_cndmask_b32 v123, v123, v20, s[26:27]
    v_cmp_gt_i32 s[20:21], 0, v21
    v_cmp_gt_i32 s[22:23], 1, v21
    v_cmp_gt_i32 s[24:25], 2, v21
    v_cmp_gt_i32 s[26:27], 3, v21
    v_cndmask_b32 v124, v124, v20, s[20:21]
    v_cndmask_b32 v125, v125, v20, s[22:23]
    v_cndmask_b32 v126, v126, v20, s[24:25]
    v_cndmask_b32 v127, v127, v20, s[26:27]
    s_branch L_attn_kernel_back_31
L_attn_kernel_rare_32:
    s_cmp_lg_u32 s40, s51
    s_cbranch_scc1 L_attn_kernel_epi_34
    ds_read_b128 v[40:43], v19
    ds_read_b128 v[44:47], v19 offset:1024
    v_swap_b32 v128, v160
    v_swap_b32 v129, v161
    v_swap_b32 v130, v162
    v_swap_b32 v131, v163
    v_swap_b32 v132, v164
    v_swap_b32 v133, v165
    v_swap_b32 v134, v166
    v_swap_b32 v135, v167
    v_swap_b32 v136, v168
    v_swap_b32 v137, v169
    v_swap_b32 v138, v170
    v_swap_b32 v139, v171
    v_swap_b32 v140, v172
    v_swap_b32 v141, v173
    v_swap_b32 v142, v174
    v_swap_b32 v143, v175
    v_swap_b32 v144, v176
    v_swap_b32 v145, v177
    v_swap_b32 v146, v178
    v_swap_b32 v147, v179
    v_swap_b32 v148, v180
    v_swap_b32 v149, v181
    v_swap_b32 v150, v182
    v_swap_b32 v151, v183
    v_swap_b32 v152, v184
    v_swap_b32 v153, v185
    v_swap_b32 v154, v186
    v_swap_b32 v155, v187
    v_swap_b32 v156, v188
    v_swap_b32 v157, v189
    v_swap_b32 v158, v190
    v_swap_b32 v159, v191
    s_waitcnt lgkmcnt(0)
    s_branch L_attn_kernel_back_33
L_attn_kernel_epi_34:
    v_mov_b32 v20, v8
    s_nop 1
    v_permlane16_swap_b32 v8, v20
    s_nop 1
    v_add_f32 v8, v8, v20
    v_mov_b32 v20, v8
    s_nop 1
    v_permlane32_swap_b32 v8, v20
    s_nop 1
    v_add_f32 v8, v8, v20
    v_mov_b32 v20, v9
    s_nop 1
    v_permlane16_swap_b32 v9, v20
    s_nop 1
    v_add_f32 v9, v9, v20
    v_mov_b32 v20, v9
    s_nop 1
    v_permlane32_swap_b32 v9, v20
    s_nop 1
    v_add_f32 v9, v9, v20
    s_mov_b32 s36, 0x5d800000
    v_cmp_nge_f32 vcc, s36, v8
    s_nop 0
    s_or_b64 s[52:53], s[52:53], vcc
    v_cmp_nge_f32 vcc, s36, v9
    s_nop 0
    s_or_b64 s[52:53], s[52:53], vcc
    v_rcp_f32 v8, v8
    v_rcp_f32 v9, v9
    s_lshl_b32 s38, s30, 3
    s_and_b32 s37, s28, 3
    s_lshl_b32 s37, s37, 1
    s_add_u32 s38, s38, s37
    s_lshl_b32 s38, s38, 17
    s_lshl_b32 s37, s29, 12
    s_add_u32 s38, s38, s37
    v_mul_f32 v192, v8, v192
    v_mul_f32 v193, v8, v193
    v_mul_f32 v194, v8, v194
    v_mul_f32 v195, v8, v195
    v_mul_f32 v196, v8, v196
    v_mul_f32 v197, v8, v197
    v_mul_f32 v198, v8, v198
    v_mul_f32 v199, v8, v199
    v_cvt_pk_bf16_f32 v22, v192, v193
    v_cvt_pk_bf16_f32 v23, v194, v195
    v_cvt_pk_bf16_f32 v24, v196, v197
    v_cvt_pk_bf16_f32 v25, v198, v199
    buffer_store_dwordx4 v[22:25], v7, s[16:19], s38 offen offset:0
    v_mov_b32 v192, 0
    v_mov_b32 v193, 0
    v_mov_b32 v194, 0
    v_mov_b32 v195, 0
    v_mov_b32 v196, 0
    v_mov_b32 v197, 0
    v_mov_b32 v198, 0
    v_mov_b32 v199, 0
    v_mul_f32 v200, v8, v200
    v_mul_f32 v201, v8, v201
    v_mul_f32 v202, v8, v202
    v_mul_f32 v203, v8, v203
    v_mul_f32 v204, v8, v204
    v_mul_f32 v205, v8, v205
    v_mul_f32 v206, v8, v206
    v_mul_f32 v207, v8, v207
    v_cvt_pk_bf16_f32 v26, v200, v201
    v_cvt_pk_bf16_f32 v27, v202, v203
    v_cvt_pk_bf16_f32 v28, v204, v205
    v_cvt_pk_bf16_f32 v29, v206, v207
    buffer_store_dwordx4 v[26:29], v7, s[16:19], s38 offen offset:1024
    v_mov_b32 v200, 0
    v_mov_b32 v201, 0
    v_mov_b32 v202, 0
    v_mov_b32 v203, 0
    v_mov_b32 v204, 0
    v_mov_b32 v205, 0
    v_mov_b32 v206, 0
    v_mov_b32 v207, 0
    v_mul_f32 v208, v8, v208
    v_mul_f32 v209, v8, v209
    v_mul_f32 v210, v8, v210
    v_mul_f32 v211, v8, v211
    v_mul_f32 v212, v8, v212
    v_mul_f32 v213, v8, v213
    v_mul_f32 v214, v8, v214
    v_mul_f32 v215, v8, v215
    v_cvt_pk_bf16_f32 v30, v208, v209
    v_cvt_pk_bf16_f32 v31, v210, v211
    v_cvt_pk_bf16_f32 v32, v212, v213
    v_cvt_pk_bf16_f32 v33, v214, v215
    buffer_store_dwordx4 v[30:33], v7, s[16:19], s38 offen offset:2048
    v_mov_b32 v208, 0
    v_mov_b32 v209, 0
    v_mov_b32 v210, 0
    v_mov_b32 v211, 0
    v_mov_b32 v212, 0
    v_mov_b32 v213, 0
    v_mov_b32 v214, 0
    v_mov_b32 v215, 0
    v_mul_f32 v216, v8, v216
    v_mul_f32 v217, v8, v217
    v_mul_f32 v218, v8, v218
    v_mul_f32 v219, v8, v219
    v_mul_f32 v220, v8, v220
    v_mul_f32 v221, v8, v221
    v_mul_f32 v222, v8, v222
    v_mul_f32 v223, v8, v223
    v_cvt_pk_bf16_f32 v34, v216, v217
    v_cvt_pk_bf16_f32 v35, v218, v219
    v_cvt_pk_bf16_f32 v36, v220, v221
    v_cvt_pk_bf16_f32 v37, v222, v223
    buffer_store_dwordx4 v[34:37], v7, s[16:19], s38 offen offset:3072
    v_mov_b32 v216, 0
    v_mov_b32 v217, 0
    v_mov_b32 v218, 0
    v_mov_b32 v219, 0
    v_mov_b32 v220, 0
    v_mov_b32 v221, 0
    v_mov_b32 v222, 0
    v_mov_b32 v223, 0
    s_add_u32 s38, s38, 131072
    v_mul_f32 v224, v9, v224
    v_mul_f32 v225, v9, v225
    v_mul_f32 v226, v9, v226
    v_mul_f32 v227, v9, v227
    v_mul_f32 v228, v9, v228
    v_mul_f32 v229, v9, v229
    v_mul_f32 v230, v9, v230
    v_mul_f32 v231, v9, v231
    v_cvt_pk_bf16_f32 v22, v224, v225
    v_cvt_pk_bf16_f32 v23, v226, v227
    v_cvt_pk_bf16_f32 v24, v228, v229
    v_cvt_pk_bf16_f32 v25, v230, v231
    buffer_store_dwordx4 v[22:25], v7, s[16:19], s38 offen offset:0
    v_mov_b32 v224, 0
    v_mov_b32 v225, 0
    v_mov_b32 v226, 0
    v_mov_b32 v227, 0
    v_mov_b32 v228, 0
    v_mov_b32 v229, 0
    v_mov_b32 v230, 0
    v_mov_b32 v231, 0
    v_mul_f32 v232, v9, v232
    v_mul_f32 v233, v9, v233
    v_mul_f32 v234, v9, v234
    v_mul_f32 v235, v9, v235
    v_mul_f32 v236, v9, v236
    v_mul_f32 v237, v9, v237
    v_mul_f32 v238, v9, v238
    v_mul_f32 v239, v9, v239
    v_cvt_pk_bf16_f32 v26, v232, v233
    v_cvt_pk_bf16_f32 v27, v234, v235
    v_cvt_pk_bf16_f32 v28, v236, v237
    v_cvt_pk_bf16_f32 v29, v238, v239
    buffer_store_dwordx4 v[26:29], v7, s[16:19], s38 offen offset:1024
    v_mov_b32 v232, 0
    v_mov_b32 v233, 0
    v_mov_b32 v234, 0
    v_mov_b32 v235, 0
    v_mov_b32 v236, 0
    v_mov_b32 v237, 0
    v_mov_b32 v238, 0
    v_mov_b32 v239, 0
    v_mul_f32 v240, v9, v240
    v_mul_f32 v241, v9, v241
    v_mul_f32 v242, v9, v242
    v_mul_f32 v243, v9, v243
    v_mul_f32 v244, v9, v244
    v_mul_f32 v245, v9, v245
    v_mul_f32 v246, v9, v246
    v_mul_f32 v247, v9, v247
    v_cvt_pk_bf16_f32 v30, v240, v241
    v_cvt_pk_bf16_f32 v31, v242, v243
    v_cvt_pk_bf16_f32 v32, v244, v245
    v_cvt_pk_bf16_f32 v33, v246, v247
    buffer_store_dwordx4 v[30:33], v7, s[16:19], s38 offen offset:2048
    v_mov_b32 v240, 0
    v_mov_b32 v241, 0
    v_mov_b32 v242, 0
    v_mov_b32 v243, 0
    v_mov_b32 v244, 0
    v_mov_b32 v245, 0
    v_mov_b32 v246, 0
    v_mov_b32 v247, 0
    v_mul_f32 v248, v9, v248
    v_mul_f32 v249, v9, v249
    v_mul_f32 v250, v9, v250
    v_mul_f32 v251, v9, v251
    v_mul_f32 v252, v9, v252
    v_mul_f32 v253, v9, v253
    v_mul_f32 v254, v9, v254
    v_mul_f32 v255, v9, v255
    v_cvt_pk_bf16_f32 v34, v248, v249
    v_cvt_pk_bf16_f32 v35, v250, v251
    v_cvt_pk_bf16_f32 v36, v252, v253
    v_cvt_pk_bf16_f32 v37, v254, v255
    buffer_store_dwordx4 v[34:37], v7, s[16:19], s38 offen offset:3072
    v_mov_b32 v248, 0
    v_mov_b32 v249, 0
    v_mov_b32 v250, 0
    v_mov_b32 v251, 0
    v_mov_b32 v252, 0
    v_mov_b32 v253, 0
    v_mov_b32 v254, 0
    v_mov_b32 v255, 0
    s_branch L_attn_kernel_back_33
L_attn_kernel_rare_38:
    v_mov_b32 v20, 4048155338
    v_subrev_u32 v21, s50, v18
    v_cmp_gt_i32 s[20:21], 0, v21
    v_cmp_gt_i32 s[22:23], 1, v21
    v_cmp_gt_i32 s[24:25], 2, v21
    v_cmp_gt_i32 s[26:27], 3, v21
    v_cndmask_b32 v96, v96, v20, s[20:21]
    v_cndmask_b32 v97, v97, v20, s[22:23]
    v_cndmask_b32 v98, v98, v20, s[24:25]
    v_cndmask_b32 v99, v99, v20, s[26:27]
    v_cmp_gt_i32 s[20:21], 16, v21
    v_cmp_gt_i32 s[22:23], 17, v21
    v_cmp_gt_i32 s[24:25], 18, v21
    v_cmp_gt_i32 s[26:27], 19, v21
    v_cndmask_b32 v100, v100, v20, s[20:21]
    v_cndmask_b32 v101, v101, v20, s[22:23]
    v_cndmask_b32 v102, v102, v20, s[24:25]
    v_cndmask_b32 v103, v103, v20, s[26:27]
    v_cmp_gt_i32 s[20:21], -16, v21
    v_cmp_gt_i32 s[22:23], -15, v21
    v_cmp_gt_i32 s[24:25], -14, v21
    v_cmp_gt_i32 s[26:27], -13, v21
    v_cndmask_b32 v104, v104, v20, s[20:21]
    v_cndmask_b32 v105, v105, v20, s[22:23]
    v_cndmask_b32 v106, v106, v20, s[24:25]
    v_cndmask_b32 v107, v107, v20, s[26:27]
    v_cmp_gt_i32 s[20:21], 0, v21
    v_cmp_gt_i32 s[22:23], 1, v21
    v_cmp_gt_i32 s[24:25], 2, v21
    v_cmp_gt_i32 s[26:27], 3, v21
    v_cndmask_b32 v108, v108, v20, s[20:21]
    v_cndmask_b32 v109, v109, v20, s[22:23]
    v_cndmask_b32 v110, v110, v20, s[24:25]
    v_cndmask_b32 v111, v111, v20, s[26:27]
    s_branch L_attn_kernel_back_39
L_p3_done:
L_attn_end:
    s_endpgm
.globl oproj_kernel
.p2align 8
.type oproj_kernel,@function
oproj_kernel:
    s_cmp_ge_u32 s2, 256
    s_cbranch_scc1 L_op_end
    s_load_dwordx2 s[46:47], s[0:1], 0
    s_load_dwordx2 s[48:49], s[0:1], 40
    s_load_dwordx2 s[50:51], s[0:1], 88
    s_load_dwordx2 s[54:55], s[0:1], 104
    v_and_b32 v1, 63, v0
    v_lshrrev_b32 v16, 6, v0
    s_nop 0
    v_readfirstlane_b32 s28, v16
    s_nop 0
    s_and_b32 s36, s2, 3
    s_lshl_b32 s36, s36, 2
    s_bfe_u32 s37, s2, 0x20003
    s_add_u32 s29, s36, s37
    s_bfe_u32 s36, s2, 0x10002
    s_lshl_b32 s36, s36, 3
    s_lshr_b32 s37, s2, 5
    s_add_u32 s30, s36, s37
    s_and_b32 s36, s28, 3
    s_lshl_b32 s37, s29, 2
    s_add_u32 s36, s36, s37
    s_lshl_b32 s36, s36, 18
    s_lshr_b32 s37, s28, 2
    s_lshl_b32 s37, s37, 12
    s_add_u32 s36, s36, s37
    v_lshl_add_u32 v2, v1, 4, s36
    v_add_u32 v3, 131072, v2
    v_lshrrev_b32 v18, 3, v1
    s_lshl_b32 s36, s28, 5
    v_add_u32 v18, s36, v18
    v_lshlrev_b32 v18, 11, v18
    s_lshl_b32 s36, s30, 7
    v_add_u32 v18, s36, v18
    v_lshrrev_b32 v19, 4, v1
    v_lshlrev_b32 v20, 1, v19
    v_and_b32 v21, 7, v1
    v_xor_b32 v20, v20, v21
    v_lshl_add_u32 v6, v20, 4, v18
    v_add_u32 v7, 15360, v6
    v_add_u32 v8, 30720, v6
    v_add_u32 v9, 46080, v6
    s_lshl_b32 s33, s28, 12
    s_mov_b32 s31, 0
    s_mov_b32 s32, 0
    s_waitcnt lgkmcnt(0)
    s_add_u32 s4, s54, 41943040
    s_addc_u32 s5, s55, 0
    s_and_b32 s5, s5, 0xffff
    s_mov_b32 s6, 16777216
    s_mov_b32 s7, 0x20000
    s_mov_b32 s8, s48
    s_and_b32 s9, s49, 0xffff
    s_mov_b32 s10, 8388608
    s_mov_b32 s11, 0x20000
    s_mov_b32 s34, s33
    s_add_u32 m0, s34, 0
    s_nop 0
    buffer_load_dwordx4 v6, s[8:11], s32 offen offset:0 lds
    buffer_load_dwordx4 v7, s[8:11], s32 offen offset:1024 lds
    buffer_load_dwordx4 v8, s[8:11], s32 offen offset:2048 lds
    buffer_load_dwordx4 v9, s[8:11], s32 offen offset:3072 lds
    s_add_u32 s32, s32, 524288
    buffer_load_dwordx4 v[128:131], v2, s[4:7], s31 offen offset:0
    buffer_load_dwordx4 v[132:135], v3, s[4:7], s31 offen offset:0
    buffer_load_dwordx4 v[136:139], v2, s[4:7], s31 offen offset:1024
    buffer_load_dwordx4 v[140:143], v3, s[4:7], s31 offen offset:1024
    buffer_load_dwordx4 v[144:147], v2, s[4:7], s31 offen offset:2048
    buffer_load_dwordx4 v[148:151], v3, s[4:7], s31 offen offset:2048
    buffer_load_dwordx4 v[152:155], v2, s[4:7], s31 offen offset:3072
    buffer_load_dwordx4 v[156:159], v3, s[4:7], s31 offen offset:3072
    s_add_u32 s31, s31, 8192
    s_add_u32 m0, s34, 32768
    s_nop 0
    buffer_load_dwordx4 v6, s[8:11], s32 offen offset:0 lds
    buffer_load_dwordx4 v7, s[8:11], s32 offen offset:1024 lds
    buffer_load_dwordx4 v8, s[8:11], s32 offen offset:2048 lds
    buffer_load_dwordx4 v9, s[8:11], s32 offen offset:3072 lds
    s_add_u32 s32, s32, 524288
    buffer_load_dwordx4 v[160:163], v2, s[4:7], s31 offen offset:0
    buffer_load_dwordx4 v[164:167], v3, s[4:7], s31 offen offset:0
    buffer_load_dwordx4 v[168:171], v2, s[4:7], s31 offen offset:1024
    buffer_load_dwordx4 v[172:175], v3, s[4:7], s31 offen offset:1024
    buffer_load_dwordx4 v[176:179], v2, s[4:7], s31 offen offset:2048
    buffer_load_dwordx4 v[180:183], v3, s[4:7], s31 offen offset:2048
    s_mov_b32 s16, s46
    s_and_b32 s17, s47, 0xffff
    s_mov_b32 s18, 4194304
    s_mov_b32 s19, 0x20000
    s_mov_b32 s20, s50
    s_and_b32 s21, s51, 0xffff
    s_mov_b32 s22, 4194304
    s_mov_b32 s23, 0x20000
    s_mov_b32 s24, s54
    s_and_b32 s25, s55, 0xffff
    s_mov_b32 s26, 67108864
    s_mov_b32 s27, 0x20000
    s_add_u32 s52, s54, 60817408
    s_addc_u32 s53, s55, 0
    s_load_dwordx4 s[56:59], s[52:53], 0
    s_lshl_b32 s36, s29, 7
    s_and_b32 s37, s28, 3
    s_lshl_b32 s37, s37, 5
    s_add_u32 s36, s36, s37
    s_lshr_b32 s37, s28, 2
    s_lshl_b32 s37, s37, 4
    s_add_u32 s38, s36, s37
    v_and_b32 v14, 15, v1
    v_add_u32 v14, s38, v14
    v_lshlrev_b32 v15, 11, v14
    v_lshl_add_u32 v15, v19, 3, v15
    s_lshl_b32 s36, s30, 7
    v_add_u32 v15, s36, v15
    v_lshlrev_b32 v16, 3, v14
    buffer_load_dwordx2 v[40:41], v15, s[16:19], 0 offen offset:0
    buffer_load_dwordx2 v[42:43], v15, s[16:19], 0 offen offset:32
    buffer_load_dwordx2 v[44:45], v15, s[16:19], 0 offen offset:64
    buffer_load_dwordx2 v[46:47], v15, s[16:19], 0 offen offset:96
    s_mov_b32 s36, 4194304
    buffer_load_dwordx2 v[48:49], v16, s[24:27], s36 offen
    v_bfe_u32 v20, v1, 2, 2
    v_lshl_add_u32 v18, v19, 2, v20
    v_bfe_u32 v20, v18, 1, 2
    v_lshlrev_b32 v18, 7, v18
    s_lshr_b32 s36, s28, 2
    s_lshl_b32 s36, s36, 14
    v_add_u32 v18, s36, v18
    v_and_b32 v21, 3, v1
    v_lshl_add_u32 v18, v21, 3, v18
    v_xor_b32 v21, 0, v20
    v_lshl_add_u32 v10, v21, 5, v18
    v_xor_b32 v21, 1, v20
    v_lshl_add_u32 v11, v21, 5, v18
    v_xor_b32 v21, 2, v20
    v_lshl_add_u32 v12, v21, 5, v18
    v_xor_b32 v21, 3, v20
    v_lshl_add_u32 v13, v21, 5, v18
    v_mov_b32 v224, 0
    v_mov_b32 v225, 0
    v_mov_b32 v226, 0
    v_mov_b32 v227, 0
    v_mov_b32 v228, 0
    v_mov_b32 v229, 0
    v_mov_b32 v230, 0
    v_mov_b32 v231, 0
    v_mov_b32 v232, 0
    v_mov_b32 v233, 0
    v_mov_b32 v234, 0
    v_mov_b32 v235, 0
    v_mov_b32 v236, 0
    v_mov_b32 v237, 0
    v_mov_b32 v238, 0
    v_mov_b32 v239, 0
    v_mov_b32 v240, 0
    v_mov_b32 v241, 0
    v_mov_b32 v242, 0
    v_mov_b32 v243, 0
    v_mov_b32 v244, 0
    v_mov_b32 v245, 0
    v_mov_b32 v246, 0
    v_mov_b32 v247, 0
    v_mov_b32 v248, 0
    v_mov_b32 v249, 0
    v_mov_b32 v250, 0
    v_mov_b32 v251, 0
    v_mov_b32 v252, 0
    v_mov_b32 v253, 0
    v_mov_b32 v254, 0
    v_mov_b32 v255, 0
    s_waitcnt lgkmcnt(0)
    s_waitcnt vmcnt(23)
    s_barrier
    ds_read_b64_tr_b16 v[64:65], v10 offset:0
    ds_read_b64_tr_b16 v[66:67], v10 offset:2048
    ds_read_b64_tr_b16 v[68:69], v11 offset:0
    ds_read_b64_tr_b16 v[70:71], v11 offset:2048
    ds_read_b64_tr_b16 v[72:73], v12 offset:0
    ds_read_b64_tr_b16 v[74:75], v12 offset:2048
    ds_read_b64_tr_b16 v[76:77], v13 offset:0
    ds_read_b64_tr_b16 v[78:79], v13 offset:2048
    s_mov_b32 s35, 0
    .p2align 6
L_p4_loop:
    s_waitcnt lgkmcnt(0)
    s_waitcnt vmcnt(21)
    v_mfma_f32_16x16x32_bf16 v[224:227], v[64:67], v[128:131], v[224:227]
    ds_read_b64_tr_b16 v[80:81], v10 offset:4096
    ds_read_b64_tr_b16 v[82:83], v10 offset:6144
    v_mfma_f32_16x16x32_bf16 v[240:243], v[64:67], v[132:135], v[240:243]
    ds_read_b64_tr_b16 v[84:85], v11 offset:4096
    ds_read_b64_tr_b16 v[86:87], v11 offset:6144
    v_mfma_f32_16x16x32_bf16 v[228:231], v[68:71], v[128:131], v[228:231]
    ds_read_b64_tr_b16 v[88:89], v12 offset:4096
    ds_read_b64_tr_b16 v[90:91], v12 offset:6144
    v_mfma_f32_16x16x32_bf16 v[244:247], v[68:71], v[132:135], v[244:247]
    ds_read_b64_tr_b16 v[92:93], v13 offset:4096
    ds_read_b64_tr_b16 v[94:95], v13 offset:6144
    v_mfma_f32_16x16x32_bf16 v[232:235], v[72:75], v[128:131], v[232:235]
    buffer_load_dwordx4 v[184:187], v2, s[4:7], s31 offen offset:3072
    v_mfma_f32_16x16x32_bf16 v[248:251], v[72:75], v[132:135], v[248:251]
    buffer_load_dwordx4 v[188:191], v3, s[4:7], s31 offen offset:3072
    s_add_u32 s31, s31, 8192
    v_mfma_f32_16x16x32_bf16 v[236:239], v[76:79], v[128:131], v[236:239]
    s_cmp_lt_u32 s35, 7
    s_cselect_b32 s6, 16777216, 0
    s_cselect_b32 s10, 8388608, 0
    s_cselect_b32 s34, s33, 0x30000
    v_mfma_f32_16x16x32_bf16 v[252:255], v[76:79], v[132:135], v[252:255]
    s_waitcnt lgkmcnt(0)
    s_waitcnt vmcnt(21)
    v_mfma_f32_16x16x32_bf16 v[224:227], v[80:83], v[136:139], v[224:227]
    ds_read_b64_tr_b16 v[64:65], v10 offset:8192
    ds_read_b64_tr_b16 v[66:67], v10 offset:10240
    v_mfma_f32_16x16x32_bf16 v[240:243], v[80:83], v[140:143], v[240:243]
    ds_read_b64_tr_b16 v[68:69], v11 offset:8192
    ds_read_b64_tr_b16 v[70:71], v11 offset:10240
    v_mfma_f32_16x16x32_bf16 v[228:231], v[84:87], v[136:139], v[228:231]
    ds_read_b64_tr_b16 v[72:73], v12 offset:8192
    ds_read_b64_tr_b16 v[74:75], v12 offset:10240
    v_mfma_f32_16x16x32_bf16 v[244:247], v[84:87], v[140:143], v[244:247]
    ds_read_b64_tr_b16 v[76:77], v13 offset:8192
    ds_read_b64_tr_b16 v[78:79], v13 offset:10240
    v_mfma_f32_16x16x32_bf16 v[232:235], v[88:91], v[136:139], v[232:235]
    buffer_load_dwordx4 v[128:131], v2, s[4:7], s31 offen offset:0
    v_mfma_f32_16x16x32_bf16 v[248:251], v[88:91], v[140:143], v[248:251]
    buffer_load_dwordx4 v[132:135], v3, s[4:7], s31 offen offset:0
    v_mfma_f32_16x16x32_bf16 v[236:239], v[92:95], v[136:139], v[236:239]
    v_mfma_f32_16x16x32_bf16 v[252:255], v[92:95], v[140:143], v[252:255]
    s_waitcnt lgkmcnt(0)
    s_waitcnt vmcnt(16)
    v_mfma_f32_16x16x32_bf16 v[224:227], v[64:67], v[144:147], v[224:227]
    ds_read_b64_tr_b16 v[80:81], v10 offset:12288
    ds_read_b64_tr_b16 v[82:83], v10 offset:14336
    v_mfma_f32_16x16x32_bf16 v[240:243], v[64:67], v[148:151], v[240:243]
    ds_read_b64_tr_b16 v[84:85], v11 offset:12288
    ds_read_b64_tr_b16 v[86:87], v11 offset:14336
    v_mfma_f32_16x16x32_bf16 v[228:231], v[68:71], v[144:147], v[228:231]
    ds_read_b64_tr_b16 v[88:89], v12 offset:12288
    ds_read_b64_tr_b16 v[90:91], v12 offset:14336
    v_mfma_f32_16x16x32_bf16 v[244:247], v[68:71], v[148:151], v[244:247]
    ds_read_b64_tr_b16 v[92:93], v13 offset:12288
    ds_read_b64_tr_b16 v[94:95], v13 offset:14336
    v_mfma_f32_16x16x32_bf16 v[232:235], v[72:75], v[144:147], v[232:235]
    buffer_load_dwordx4 v[136:139], v2, s[4:7], s31 offen offset:1024
    v_mfma_f32_16x16x32_bf16 v[248:251], v[72:75], v[148:151], v[248:251]
    buffer_load_dwordx4 v[140:143], v3, s[4:7], s31 offen offset:1024
    v_mfma_f32_16x16x32_bf16 v[236:239], v[76:79], v[144:147], v[236:239]
    v_mfma_f32_16x16x32_bf16 v[252:255], v[76:79], v[148:151], v[252:255]
    s_waitcnt lgkmcnt(0)
    s_waitcnt vmcnt(7)
    s_barrier
    v_mfma_f32_16x16x32_bf16 v[224:227], v[80:83], v[152:155], v[224:227]
    ds_read_b64_tr_b16 v[64:65], v10 offset:32768
    ds_read_b64_tr_b16 v[66:67], v10 offset:34816
    v_mfma_f32_16x16x32_bf16 v[240:243], v[80:83], v[156:159], v[240:243]
    ds_read_b64_tr_b16 v[68:69], v11 offset:32768
    ds_read_b64_tr_b16 v[70:71], v11 offset:34816
    v_mfma_f32_16x16x32_bf16 v[228:231], v[84:87], v[152:155], v[228:231]
    ds_read_b64_tr_b16 v[72:73], v12 offset:32768
    ds_read_b64_tr_b16 v[74:75], v12 offset:34816
    v_mfma_f32_16x16x32_bf16 v[244:247], v[84:87], v[156:159], v[244:247]
    ds_read_b64_tr_b16 v[76:77], v13 offset:32768
    ds_read_b64_tr_b16 v[78:79], v13 offset:34816
    s_add_u32 m0, s34, 0
    v_mfma_f32_16x16x32_bf16 v[232:235], v[88:91], v[152:155], v[232:235]
    buffer_load_dwordx4 v6, s[8:11], s32 offen offset:0 lds
    buffer_load_dwordx4 v7, s[8:11], s32 offen offset:1024 lds
    buffer_load_dwordx4 v[144:147], v2, s[4:7], s31 offen offset:2048
    v_mfma_f32_16x16x32_bf16 v[248:251], v[88:91], v[156:159], v[248:251]
    buffer_load_dwordx4 v8, s[8:11], s32 offen offset:2048 lds
    buffer_load_dwordx4 v9, s[8:11], s32 offen offset:3072 lds
    buffer_load_dwordx4 v[148:151], v3, s[4:7], s31 offen offset:2048
    v_mfma_f32_16x16x32_bf16 v[236:239], v[92:95], v[152:155], v[236:239]
    v_mfma_f32_16x16x32_bf16 v[252:255], v[92:95], v[156:159], v[252:255]
    s_add_u32 s32, s32, 524288
    s_waitcnt lgkmcnt(0)
    s_waitcnt vmcnt(21)
    v_mfma_f32_16x16x32_bf16 v[224:227], v[64:67], v[160:163], v[224:227]
    ds_read_b64_tr_b16 v[80:81], v10 offset:36864
    ds_read_b64_tr_b16 v[82:83], v10 offset:38912
    v_mfma_f32_16x16x32_bf16 v[240:243], v[64:67], v[164:167], v[240:243]
    ds_read_b64_tr_b16 v[84:85], v11 offset:36864
    ds_read_b64_tr_b16 v[86:87], v11 offset:38912
    v_mfma_f32_16x16x32_bf16 v[228:231], v[68:71], v[160:163], v[228:231]
    ds_read_b64_tr_b16 v[88:89], v12 offset:36864
    ds_read_b64_tr_b16 v[90:91], v12 offset:38912
    v_mfma_f32_16x16x32_bf16 v[244:247], v[68:71], v[164:167], v[244:247]
    ds_read_b64_tr_b16 v[92:93], v13 offset:36864
    ds_read_b64_tr_b16 v[94:95], v13 offset:38912
    v_mfma_f32_16x16x32_bf16 v[232:235], v[72:75], v[160:163], v[232:235]
    buffer_load_dwordx4 v[152:155], v2, s[4:7], s31 offen offset:3072
    v_mfma_f32_16x16x32_bf16 v[248:251], v[72:75], v[164:167], v[248:251]
    buffer_load_dwordx4 v[156:159], v3, s[4:7], s31 offen offset:3072
    s_add_u32 s31, s31, 8192
    v_mfma_f32_16x16x32_bf16 v[236:239], v[76:79], v[160:163], v[236:239]
    v_mfma_f32_16x16x32_bf16 v[252:255], v[76:79], v[164:167], v[252:255]
    s_waitcnt lgkmcnt(0)
    s_waitcnt vmcnt(21)
    v_mfma_f32_16x16x32_bf16 v[224:227], v[80:83], v[168:171], v[224:227]
    ds_read_b64_tr_b16 v[64:65], v10 offset:40960
    ds_read_b64_tr_b16 v[66:67], v10 offset:43008
    v_mfma_f32_16x16x32_bf16 v[240:243], v[80:83], v[172:175], v[240:243]
    ds_read_b64_tr_b16 v[68:69], v11 offset:40960
    ds_read_b64_tr_b16 v[70:71], v11 offset:43008
    v_mfma_f32_16x16x32_bf16 v[228:231], v[84:87], v[168:171], v[228:231]
    ds_read_b64_tr_b16 v[72:73], v12 offset:40960
    ds_read_b64_tr_b16 v[74:75], v12 offset:43008
    v_mfma_f32_16x16x32_bf16 v[244:247], v[84:87], v[172:175], v[244:247]
    ds_read_b64_tr_b16 v[76:77], v13 offset:40960
    ds_read_b64_tr_b16 v[78:79], v13 offset:43008
    v_mfma_f32_16x16x32_bf16 v[232:235], v[88:91], v[168:171], v[232:235]
    buffer_load_dwordx4 v[160:163], v2, s[4:7], s31 offen offset:0
    v_mfma_f32_16x16x32_bf16 v[248:251], v[88:91], v[172:175], v[248:251]
    buffer_load_dwordx4 v[164:167], v3, s[4:7], s31 offen offset:0
    v_mfma_f32_16x16x32_bf16 v[236:239], v[92:95], v[168:171], v[236:239]
    v_mfma_f32_16x16x32_bf16 v[252:255], v[92:95], v[172:175], v[252:255]
    s_waitcnt lgkmcnt(0)
    s_waitcnt vmcnt(16)
    v_mfma_f32_16x16x32_bf16 v[224:227], v[64:67], v[176:179], v[224:227]
    ds_read_b64_tr_b16 v[80:81], v10 offset:45056
    ds_read_b64_tr_b16 v[82:83], v10 offset:47104
    v_mfma_f32_16x16x32_bf16 v[240:243], v[64:67], v[180:183], v[240:243]
    ds_read_b64_tr_b16 v[84:85], v11 offset:45056
    ds_read_b64_tr_b16 v[86:87], v11 offset:47104
    v_mfma_f32_16x16x32_bf16 v[228:231], v[68:71], v[176:179], v[228:231]
    ds_read_b64_tr_b16 v[88:89], v12 offset:45056
    ds_read_b64_tr_b16 v[90:91], v12 offset:47104
    v_mfma_f32_16x16x32_bf16 v[244:247], v[68:71], v[180:183], v[244:247]
    ds_read_b64_tr_b16 v[92:93], v13 offset:45056
    ds_read_b64_tr_b16 v[94:95], v13 offset:47104
    v_mfma_f32_16x16x32_bf16 v[232:235], v[72:75], v[176:179], v[232:235]
    buffer_load_dwordx4 v[168:171], v2, s[4:7], s31 offen offset:1024
    v_mfma_f32_16x16x32_bf16 v[248:251], v[72:75], v[180:183], v[248:251]
    buffer_load_dwordx4 v[172:175], v3, s[4:7], s31 offen offset:1024
    v_mfma_f32_16x16x32_bf16 v[236:239], v[76:79], v[176:179], v[236:239]
    v_mfma_f32_16x16x32_bf16 v[252:255], v[76:79], v[180:183], v[252:255]
    s_waitcnt lgkmcnt(0)
    s_waitcnt vmcnt(7)
    s_barrier
    v_mfma_f32_16x16x32_bf16 v[224:227], v[80:83], v[184:187], v[224:227]
    ds_read_b64_tr_b16 v[64:65], v10 offset:0
    ds_read_b64_tr_b16 v[66:67], v10 offset:2048
    v_mfma_f32_16x16x32_bf16 v[240:243], v[80:83], v[188:191], v[240:243]
    ds_read_b64_tr_b16 v[68:69], v11 offset:0
    ds_read_b64_tr_b16 v[70:71], v11 offset:2048
    v_mfma_f32_16x16x32_bf16 v[228:231], v[84:87], v[184:187], v[228:231]
    ds_read_b64_tr_b16 v[72:73], v12 offset:0
    ds_read_b64_tr_b16 v[74:75], v12 offset:2048
    v_mfma_f32_16x16x32_bf16 v[244:247], v[84:87], v[188:191], v[244:247]
    ds_read_b64_tr_b16 v[76:77], v13 offset:0
    ds_read_b64_tr_b16 v[78:79], v13 offset:2048
    s_add_u32 m0, s34, 32768
    v_mfma_f32_16x16x32_bf16 v[232:235], v[88:91], v[184:187], v[232:235]
    buffer_load_dwordx4 v6, s[8:11], s32 offen offset:0 lds
    buffer_load_dwordx4 v7, s[8:11], s32 offen offset:1024 lds
    buffer_load_dwordx4 v[176:179], v2, s[4:7], s31 offen offset:2048
    v_mfma_f32_16x16x32_bf16 v[248:251], v[88:91], v[188:191], v[248:251]
    buffer_load_dwordx4 v8, s[8:11], s32 offen offset:2048 lds
    buffer_load_dwordx4 v9, s[8:11], s32 offen offset:3072 lds
    buffer_load_dwordx4 v[180:183], v3, s[4:7], s31 offen offset:2048
    v_mfma_f32_16x16x32_bf16 v[236:239], v[92:95], v[184:187], v[236:239]
    v_mfma_f32_16x16x32_bf16 v[252:255], v[92:95], v[188:191], v[252:255]
    s_add_u32 s32, s32, 524288
    s_add_u32 s35, s35, 1
    s_cmp_lt_u32 s35, 8
    s_cbranch_scc1 L_p4_loop
    s_waitcnt vmcnt(0) lgkmcnt(0)
    s_cmp_lt_u32 s28, 4
    s_cbranch_scc0 L_p4_e1
    s_lshl_b32 s36, s28, 12
    s_add_u32 s36, s36, 65536
    v_lshl_add_u32 v20, v1, 4, s36
    v_xor_b32 v21, 16384, v20
    v_mov_b32 v100, 0
    v_mov_b32 v101, 0
    v_mov_b32 v102, 0
    v_mov_b32 v103, 0
    v_mov_b32 v104, 0
    v_mov_b32 v105, 0
    v_mov_b32 v106, 0
    v_mov_b32 v107, 0
    v_mov_b32 v108, 0
    v_mov_b32 v109, 0
    v_mov_b32 v110, 0
    v_mov_b32 v111, 0
    v_mov_b32 v112, 0
    v_mov_b32 v113, 0
    v_mov_b32 v114, 0
    v_mov_b32 v115, 0
    ds_write_b128 v20, v[240:243] offset:0
    ds_write_b128 v20, v[244:247] offset:1024
    ds_write_b128 v20, v[248:251] offset:2048
    ds_write_b128 v20, v[252:255] offset:3072
    s_sub_u32 s36, s56, s38
    s_cmp_lt_u32 s36, 16
    s_cbranch_scc0 L_oproj_kernel_noy_1
    s_lshl_b32 s37, s30, 8
    s_add_u32 s37, s37, 59768832
    v_lshlrev_b32 v22, 4, v19
    v_mov_b32 v64, 0
    v_mov_b32 v65, 0
    v_mov_b32 v66, 0
    v_mov_b32 v67, 0
    v_mov_b32 v68, 0
    v_mov_b32 v69, 0
    v_mov_b32 v70, 0
    v_mov_b32 v71, 0
    v_mov_b32 v72, 0
    v_mov_b32 v73, 0
    v_mov_b32 v74, 0
    v_mov_b32 v75, 0
    v_mov_b32 v76, 0
    v_mov_b32 v77, 0
    v_mov_b32 v78, 0
    v_mov_b32 v79, 0
    s_mov_b32 s39, 0
L_oproj_kernel_ysum_2:
    buffer_load_dwordx4 v[80:83], v22, s[24:27], s37 offen offset:0
    buffer_load_dwordx4 v[84:87], v22, s[24:27], s37 offen offset:64
    buffer_load_dwordx4 v[88:91], v22, s[24:27], s37 offen offset:128
    buffer_load_dwordx4 v[92:95], v22, s[24:27], s37 offen offset:192
    s_add_u32 s37, s37, 8192
    s_add_u32 s39, s39, 1
    s_waitcnt vmcnt(0)
    v_add_f32 v64, v64, v80
    v_add_f32 v65, v65, v81
    v_add_f32 v66, v66, v82
    v_add_f32 v67, v67, v83
    v_add_f32 v68, v68, v84
    v_add_f32 v69, v69, v85
    v_add_f32 v70, v70, v86
    v_add_f32 v71, v71, v87
    v_add_f32 v72, v72, v88
    v_add_f32 v73, v73, v89
    v_add_f32 v74, v74, v90
    v_add_f32 v75, v75, v91
    v_add_f32 v76, v76, v92
    v_add_f32 v77, v77, v93
    v_add_f32 v78, v78, v94
    v_add_f32 v79, v79, v95
    s_cmp_lt_u32 s39, 16
    s_cbranch_scc1 L_oproj_kernel_ysum_2
    v_cmp_eq_u32 vcc, s56, v14
    v_cvt_pk_bf16_f32 v64, v64, v64
    v_lshlrev_b32 v64, 16, v64
    v_mul_f32 v64, s58, v64
    v_cvt_pk_bf16_f32 v64, v64, v64
    v_lshlrev_b32 v64, 16, v64
    v_cndmask_b32 v100, v100, v64, vcc
    v_cvt_pk_bf16_f32 v65, v65, v65
    v_lshlrev_b32 v65, 16, v65
    v_mul_f32 v65, s58, v65
    v_cvt_pk_bf16_f32 v65, v65, v65
    v_lshlrev_b32 v65, 16, v65
    v_cndmask_b32 v101, v101, v65, vcc
    v_cvt_pk_bf16_f32 v66, v66, v66
    v_lshlrev_b32 v66, 16, v66
    v_mul_f32 v66, s58, v66
    v_cvt_pk_bf16_f32 v66, v66, v66
    v_lshlrev_b32 v66, 16, v66
    v_cndmask_b32 v102, v102, v66, vcc
    v_cvt_pk_bf16_f32 v67, v67, v67
    v_lshlrev_b32 v67, 16, v67
    v_mul_f32 v67, s58, v67
    v_cvt_pk_bf16_f32 v67, v67, v67
    v_lshlrev_b32 v67, 16, v67
    v_cndmask_b32 v103, v103, v67, vcc
    v_cvt_pk_bf16_f32 v68, v68, v68
    v_lshlrev_b32 v68, 16, v68
    v_mul_f32 v68, s58, v68
    v_cvt_pk_bf16_f32 v68, v68, v68
    v_lshlrev_b32 v68, 16, v68
    v_cndmask_b32 v104, v104, v68, vcc
    v_cvt_pk_bf16_f32 v69, v69, v69
    v_lshlrev_b32 v69, 16, v69
    v_mul_f32 v69, s58, v69
    v_cvt_pk_bf16_f32 v69, v69, v69
    v_lshlrev_b32 v69, 16, v69
    v_cndmask_b32 v105, v105, v69, vcc
    v_cvt_pk_bf16_f32 v70, v70, v70
    v_lshlrev_b32 v70, 16, v70
    v_mul_f32 v70, s58, v70
    v_cvt_pk_bf16_f32 v70, v70, v70
    v_lshlrev_b32 v70, 16, v70
    v_cndmask_b32 v106, v106, v70, vcc
    v_cvt_pk_bf16_f32 v71, v71, v71
    v_lshlrev_b32 v71, 16, v71
    v_mul_f32 v71, s58, v71
    v_cvt_pk_bf16_f32 v71, v71, v71
    v_lshlrev_b32 v71, 16, v71
    v_cndmask_b32 v107, v107, v71, vcc
    v_cvt_pk_bf16_f32 v72, v72, v72
    v_lshlrev_b32 v72, 16, v72
    v_mul_f32 v72, s58, v72
    v_cvt_pk_bf16_f32 v72, v72, v72
    v_lshlrev_b32 v72, 16, v72
    v_cndmask_b32 v108, v108, v72, vcc
    v_cvt_pk_bf16_f32 v73, v73, v73
    v_lshlrev_b32 v73, 16, v73
    v_mul_f32 v73, s58, v73
    v_cvt_pk_bf16_f32 v73, v73, v73
    v_lshlrev_b32 v73, 16, v73
    v_cndmask_b32 v109, v109, v73, vcc
    v_cvt_pk_bf16_f32 v74, v74, v74
    v_lshlrev_b32 v74, 16, v74
    v_mul_f32 v74, s58, v74
    v_cvt_pk_bf16_f32 v74, v74, v74
    v_lshlrev_b32 v74, 16, v74
    v_cndmask_b32 v110, v110, v74, vcc
    v_cvt_pk_bf16_f32 v75, v75, v75
    v_lshlrev_b32 v75, 16, v75
    v_mul_f32 v75, s58, v75
    v_cvt_pk_bf16_f32 v75, v75, v75
    v_lshlrev_b32 v75, 16, v75
    v_cndmask_b32 v111, v111, v75, vcc
    v_cvt_pk_bf16_f32 v76, v76, v76
    v_lshlrev_b32 v76, 16, v76
    v_mul_f32 v76, s58, v76
    v_cvt_pk_bf16_f32 v76, v76, v76
    v_lshlrev_b32 v76, 16, v76
    v_cndmask_b32 v112, v112, v76, vcc
    v_cvt_pk_bf16_f32 v77, v77, v77
    v_lshlrev_b32 v77, 16, v77
    v_mul_f32 v77, s58, v77
    v_cvt_pk_bf16_f32 v77, v77, v77
    v_lshlrev_b32 v77, 16, v77
    v_cndmask_b32 v113, v113, v77, vcc
    v_cvt_pk_bf16_f32 v78, v78, v78
    v_lshlrev_b32 v78, 16, v78
    v_mul_f32 v78, s58, v78
    v_cvt_pk_bf16_f32 v78, v78, v78
    v_lshlrev_b32 v78, 16, v78
    v_cndmask_b32 v114, v114, v78, vcc
    v_cvt_pk_bf16_f32 v79, v79, v79
    v_lshlrev_b32 v79, 16, v79
    v_mul_f32 v79, s58, v79
    v_cvt_pk_bf16_f32 v79, v79, v79
    v_lshlrev_b32 v79, 16, v79
    v_cndmask_b32 v115, v115, v79, vcc
L_oproj_kernel_noy_1:
    s_sub_u32 s36, s57, s38
    s_cmp_lt_u32 s36, 16
    s_cbranch_scc0 L_oproj_kernel_noy_3
    s_lshl_b32 s37, s30, 8
    s_add_u32 s37, s37, 59772928
    v_lshlrev_b32 v22, 4, v19
    v_mov_b32 v64, 0
    v_mov_b32 v65, 0
    v_mov_b32 v66, 0
    v_mov_b32 v67, 0
    v_mov_b32 v68, 0
    v_mov_b32 v69, 0
    v_mov_b32 v70, 0
    v_mov_b32 v71, 0
    v_mov_b32 v72, 0
    v_mov_b32 v73, 0
    v_mov_b32 v74, 0
    v_mov_b32 v75, 0
    v_mov_b32 v76, 0
    v_mov_b32 v77, 0
    v_mov_b32 v78, 0
    v_mov_b32 v79, 0
    s_mov_b32 s39, 0
L_oproj_kernel_ysum_4:
    buffer_load_dwordx4 v[80:83], v22, s[24:27], s37 offen offset:0
    buffer_load_dwordx4 v[84:87], v22, s[24:27], s37 offen offset:64
    buffer_load_dwordx4 v[88:91], v22, s[24:27], s37 offen offset:128
    buffer_load_dwordx4 v[92:95], v22, s[24:27], s37 offen offset:192
    s_add_u32 s37, s37, 8192
    s_add_u32 s39, s39, 1
    s_waitcnt vmcnt(0)
    v_add_f32 v64, v64, v80
    v_add_f32 v65, v65, v81
    v_add_f32 v66, v66, v82
    v_add_f32 v67, v67, v83
    v_add_f32 v68, v68, v84
    v_add_f32 v69, v69, v85
    v_add_f32 v70, v70, v86
    v_add_f32 v71, v71, v87
    v_add_f32 v72, v72, v88
    v_add_f32 v73, v73, v89
    v_add_f32 v74, v74, v90
    v_add_f32 v75, v75, v91
    v_add_f32 v76, v76, v92
    v_add_f32 v77, v77, v93
    v_add_f32 v78, v78, v94
    v_add_f32 v79, v79, v95
    s_cmp_lt_u32 s39, 16
    s_cbranch_scc1 L_oproj_kernel_ysum_4
    v_cmp_eq_u32 vcc, s57, v14
    v_cvt_pk_bf16_f32 v64, v64, v64
    v_lshlrev_b32 v64, 16, v64
    v_mul_f32 v64, s59, v64
    v_cvt_pk_bf16_f32 v64, v64, v64
    v_lshlrev_b32 v64, 16, v64
    v_cndmask_b32 v100, v100, v64, vcc
    v_cvt_pk_bf16_f32 v65, v65, v65
    v_lshlrev_b32 v65, 16, v65
    v_mul_f32 v65, s59, v65
    v_cvt_pk_bf16_f32 v65, v65, v65
    v_lshlrev_b32 v65, 16, v65
    v_cndmask_b32 v101, v101, v65, vcc
    v_cvt_pk_bf16_f32 v66, v66, v66
    v_lshlrev_b32 v66, 16, v66
    v_mul_f32 v66, s59, v66
    v_cvt_pk_bf16_f32 v66, v66, v66
    v_lshlrev_b32 v66, 16, v66
    v_cndmask_b32 v102, v102, v66, vcc
    v_cvt_pk_bf16_f32 v67, v67, v67
    v_lshlrev_b32 v67, 16, v67
    v_mul_f32 v67, s59, v67
    v_cvt_pk_bf16_f32 v67, v67, v67
    v_lshlrev_b32 v67, 16, v67
    v_cndmask_b32 v103, v103, v67, vcc
    v_cvt_pk_bf16_f32 v68, v68, v68
    v_lshlrev_b32 v68, 16, v68
    v_mul_f32 v68, s59, v68
    v_cvt_pk_bf16_f32 v68, v68, v68
    v_lshlrev_b32 v68, 16, v68
    v_cndmask_b32 v104, v104, v68, vcc
    v_cvt_pk_bf16_f32 v69, v69, v69
    v_lshlrev_b32 v69, 16, v69
    v_mul_f32 v69, s59, v69
    v_cvt_pk_bf16_f32 v69, v69, v69
    v_lshlrev_b32 v69, 16, v69
    v_cndmask_b32 v105, v105, v69, vcc
    v_cvt_pk_bf16_f32 v70, v70, v70
    v_lshlrev_b32 v70, 16, v70
    v_mul_f32 v70, s59, v70
    v_cvt_pk_bf16_f32 v70, v70, v70
    v_lshlrev_b32 v70, 16, v70
    v_cndmask_b32 v106, v106, v70, vcc
    v_cvt_pk_bf16_f32 v71, v71, v71
    v_lshlrev_b32 v71, 16, v71
    v_mul_f32 v71, s59, v71
    v_cvt_pk_bf16_f32 v71, v71, v71
    v_lshlrev_b32 v71, 16, v71
    v_cndmask_b32 v107, v107, v71, vcc
    v_cvt_pk_bf16_f32 v72, v72, v72
    v_lshlrev_b32 v72, 16, v72
    v_mul_f32 v72, s59, v72
    v_cvt_pk_bf16_f32 v72, v72, v72
    v_lshlrev_b32 v72, 16, v72
    v_cndmask_b32 v108, v108, v72, vcc
    v_cvt_pk_bf16_f32 v73, v73, v73
    v_lshlrev_b32 v73, 16, v73
    v_mul_f32 v73, s59, v73
    v_cvt_pk_bf16_f32 v73, v73, v73
    v_lshlrev_b32 v73, 16, v73
    v_cndmask_b32 v109, v109, v73, vcc
    v_cvt_pk_bf16_f32 v74, v74, v74
    v_lshlrev_b32 v74, 16, v74
    v_mul_f32 v74, s59, v74
    v_cvt_pk_bf16_f32 v74, v74, v74
    v_lshlrev_b32 v74, 16, v74
    v_cndmask_b32 v110, v110, v74, vcc
    v_cvt_pk_bf16_f32 v75, v75, v75
    v_lshlrev_b32 v75, 16, v75
    v_mul_f32 v75, s59, v75
    v_cvt_pk_bf16_f32 v75, v75, v75
    v_lshlrev_b32 v75, 16, v75
    v_cndmask_b32 v111, v111, v75, vcc
    v_cvt_pk_bf16_f32 v76, v76, v76
    v_lshlrev_b32 v76, 16, v76
    v_mul_f32 v76, s59, v76
    v_cvt_pk_bf16_f32 v76, v76, v76
    v_lshlrev_b32 v76, 16, v76
    v_cndmask_b32 v112, v112, v76, vcc
    v_cvt_pk_bf16_f32 v77, v77, v77
    v_lshlrev_b32 v77, 16, v77
    v_mul_f32 v77, s59, v77
    v_cvt_pk_bf16_f32 v77, v77, v77
    v_lshlrev_b32 v77, 16, v77
    v_cndmask_b32 v113, v113, v77, vcc
    v_cvt_pk_bf16_f32 v78, v78, v78
    v_lshlrev_b32 v78, 16, v78
    v_mul_f32 v78, s59, v78
    v_cvt_pk_bf16_f32 v78, v78, v78
    v_lshlrev_b32 v78, 16, v78
    v_cndmask_b32 v114, v114, v78, vcc
    v_cvt_pk_bf16_f32 v79, v79, v79
    v_lshlrev_b32 v79, 16, v79
    v_mul_f32 v79, s59, v79
    v_cvt_pk_bf16_f32 v79, v79, v79
    v_lshlrev_b32 v79, 16, v79
    v_cndmask_b32 v115, v115, v79, vcc
L_oproj_kernel_noy_3:
    s_waitcnt vmcnt(0)
    v_lshlrev_b32 v128, 16, v40
    v_and_b32 v129, 0xffff0000, v40
    v_sub_f32 v144, v128, v48
    v_sub_f32 v145, v129, v48
    v_cvt_pk_bf16_f32 v23, v144, v145
    v_lshlrev_b32 v144, 16, v23
    v_and_b32 v145, 0xffff0000, v23
    v_mul_f32 v144, v144, v49
    v_mul_f32 v145, v145, v49
    v_cvt_pk_bf16_f32 v23, v144, v145
    v_lshlrev_b32 v144, 16, v23
    v_and_b32 v145, 0xffff0000, v23
    v_add_f32 v144, v144, v100
    v_add_f32 v145, v145, v101
    v_cvt_pk_bf16_f32 v23, v144, v145
    v_lshlrev_b32 v144, 16, v23
    v_and_b32 v145, 0xffff0000, v23
    v_mul_f32 v24, 0xbfb8aa3b, v144
    v_mul_f32 v25, 0xbfb8aa3b, v145
    v_exp_f32 v24, v24
    v_exp_f32 v25, v25
    s_nop 0
    v_add_f32 v24, 1.0, v24
    v_add_f32 v25, 1.0, v25
    v_rcp_f32 v24, v24
    v_rcp_f32 v25, v25
    s_nop 0
    v_mul_f32 v144, v144, v24
    v_mul_f32 v145, v145, v25
    v_cvt_pk_bf16_f32 v23, v144, v145
    v_lshlrev_b32 v144, 16, v23
    v_and_b32 v145, 0xffff0000, v23
    v_lshlrev_b32 v130, 16, v41
    v_and_b32 v131, 0xffff0000, v41
    v_sub_f32 v146, v130, v48
    v_sub_f32 v147, v131, v48
    v_cvt_pk_bf16_f32 v23, v146, v147
    v_lshlrev_b32 v146, 16, v23
    v_and_b32 v147, 0xffff0000, v23
    v_mul_f32 v146, v146, v49
    v_mul_f32 v147, v147, v49
    v_cvt_pk_bf16_f32 v23, v146, v147
    v_lshlrev_b32 v146, 16, v23
    v_and_b32 v147, 0xffff0000, v23
    v_add_f32 v146, v146, v102
    v_add_f32 v147, v147, v103
    v_cvt_pk_bf16_f32 v23, v146, v147
    v_lshlrev_b32 v146, 16, v23
    v_and_b32 v147, 0xffff0000, v23
    v_mul_f32 v24, 0xbfb8aa3b, v146
    v_mul_f32 v25, 0xbfb8aa3b, v147
    v_exp_f32 v24, v24
    v_exp_f32 v25, v25
    s_nop 0
    v_add_f32 v24, 1.0, v24
    v_add_f32 v25, 1.0, v25
    v_rcp_f32 v24, v24
    v_rcp_f32 v25, v25
    s_nop 0
    v_mul_f32 v146, v146, v24
    v_mul_f32 v147, v147, v25
    v_cvt_pk_bf16_f32 v23, v146, v147
    v_lshlrev_b32 v146, 16, v23
    v_and_b32 v147, 0xffff0000, v23
    v_lshlrev_b32 v132, 16, v42
    v_and_b32 v133, 0xffff0000, v42
    v_sub_f32 v148, v132, v48
    v_sub_f32 v149, v133, v48
    v_cvt_pk_bf16_f32 v23, v148, v149
    v_lshlrev_b32 v148, 16, v23
    v_and_b32 v149, 0xffff0000, v23
    v_mul_f32 v148, v148, v49
    v_mul_f32 v149, v149, v49
    v_cvt_pk_bf16_f32 v23, v148, v149
    v_lshlrev_b32 v148, 16, v23
    v_and_b32 v149, 0xffff0000, v23
    v_add_f32 v148, v148, v104
    v_add_f32 v149, v149, v105
    v_cvt_pk_bf16_f32 v23, v148, v149
    v_lshlrev_b32 v148, 16, v23
    v_and_b32 v149, 0xffff0000, v23
    v_mul_f32 v24, 0xbfb8aa3b, v148
    v_mul_f32 v25, 0xbfb8aa3b, v149
    v_exp_f32 v24, v24
    v_exp_f32 v25, v25
    s_nop 0
    v_add_f32 v24, 1.0, v24
    v_add_f32 v25, 1.0, v25
    v_rcp_f32 v24, v24
    v_rcp_f32 v25, v25
    s_nop 0
    v_mul_f32 v148, v148, v24
    v_mul_f32 v149, v149, v25
    v_cvt_pk_bf16_f32 v23, v148, v149
    v_lshlrev_b32 v148, 16, v23
    v_and_b32 v149, 0xffff0000, v23
    v_lshlrev_b32 v134, 16, v43
    v_and_b32 v135, 0xffff0000, v43
    v_sub_f32 v150, v134, v48
    v_sub_f32 v151, v135, v48
    v_cvt_pk_bf16_f32 v23, v150, v151
    v_lshlrev_b32 v150, 16, v23
    v_and_b32 v151, 0xffff0000, v23
    v_mul_f32 v150, v150, v49
    v_mul_f32 v151, v151, v49
    v_cvt_pk_bf16_f32 v23, v150, v151
    v_lshlrev_b32 v150, 16, v23
    v_and_b32 v151, 0xffff0000, v23
    v_add_f32 v150, v150, v106
    v_add_f32 v151, v151, v107
    v_cvt_pk_bf16_f32 v23, v150, v151
    v_lshlrev_b32 v150, 16, v23
    v_and_b32 v151, 0xffff0000, v23
    v_mul_f32 v24, 0xbfb8aa3b, v150
    v_mul_f32 v25, 0xbfb8aa3b, v151
    v_exp_f32 v24, v24
    v_exp_f32 v25, v25
    s_nop 0
    v_add_f32 v24, 1.0, v24
    v_add_f32 v25, 1.0, v25
    v_rcp_f32 v24, v24
    v_rcp_f32 v25, v25
    s_nop 0
    v_mul_f32 v150, v150, v24
    v_mul_f32 v151, v151, v25
    v_cvt_pk_bf16_f32 v23, v150, v151
    v_lshlrev_b32 v150, 16, v23
    v_and_b32 v151, 0xffff0000, v23
    v_lshlrev_b32 v136, 16, v44
    v_and_b32 v137, 0xffff0000, v44
    v_sub_f32 v152, v136, v48
    v_sub_f32 v153, v137, v48
    v_cvt_pk_bf16_f32 v23, v152, v153
    v_lshlrev_b32 v152, 16, v23
    v_and_b32 v153, 0xffff0000, v23
    v_mul_f32 v152, v152, v49
    v_mul_f32 v153, v153, v49
    v_cvt_pk_bf16_f32 v23, v152, v153
    v_lshlrev_b32 v152, 16, v23
    v_and_b32 v153, 0xffff0000, v23
    v_add_f32 v152, v152, v108
    v_add_f32 v153, v153, v109
    v_cvt_pk_bf16_f32 v23, v152, v153
    v_lshlrev_b32 v152, 16, v23
    v_and_b32 v153, 0xffff0000, v23
    v_mul_f32 v24, 0xbfb8aa3b, v152
    v_mul_f32 v25, 0xbfb8aa3b, v153
    v_exp_f32 v24, v24
    v_exp_f32 v25, v25
    s_nop 0
    v_add_f32 v24, 1.0, v24
    v_add_f32 v25, 1.0, v25
    v_rcp_f32 v24, v24
    v_rcp_f32 v25, v25
    s_nop 0
    v_mul_f32 v152, v152, v24
    v_mul_f32 v153, v153, v25
    v_cvt_pk_bf16_f32 v23, v152, v153
    v_lshlrev_b32 v152, 16, v23
    v_and_b32 v153, 0xffff0000, v23
    v_lshlrev_b32 v138, 16, v45
    v_and_b32 v139, 0xffff0000, v45
    v_sub_f32 v154, v138, v48
    v_sub_f32 v155, v139, v48
    v_cvt_pk_bf16_f32 v23, v154, v155
    v_lshlrev_b32 v154, 16, v23
    v_and_b32 v155, 0xffff0000, v23
    v_mul_f32 v154, v154, v49
    v_mul_f32 v155, v155, v49
    v_cvt_pk_bf16_f32 v23, v154, v155
    v_lshlrev_b32 v154, 16, v23
    v_and_b32 v155, 0xffff0000, v23
    v_add_f32 v154, v154, v110
    v_add_f32 v155, v155, v111
    v_cvt_pk_bf16_f32 v23, v154, v155
    v_lshlrev_b32 v154, 16, v23
    v_and_b32 v155, 0xffff0000, v23
    v_mul_f32 v24, 0xbfb8aa3b, v154
    v_mul_f32 v25, 0xbfb8aa3b, v155
    v_exp_f32 v24, v24
    v_exp_f32 v25, v25
    s_nop 0
    v_add_f32 v24, 1.0, v24
    v_add_f32 v25, 1.0, v25
    v_rcp_f32 v24, v24
    v_rcp_f32 v25, v25
    s_nop 0
    v_mul_f32 v154, v154, v24
    v_mul_f32 v155, v155, v25
    v_cvt_pk_bf16_f32 v23, v154, v155
    v_lshlrev_b32 v154, 16, v23
    v_and_b32 v155, 0xffff0000, v23
    v_lshlrev_b32 v140, 16, v46
    v_and_b32 v141, 0xffff0000, v46
    v_sub_f32 v156, v140, v48
    v_sub_f32 v157, v141, v48
    v_cvt_pk_bf16_f32 v23, v156, v157
    v_lshlrev_b32 v156, 16, v23
    v_and_b32 v157, 0xffff0000, v23
    v_mul_f32 v156, v156, v49
    v_mul_f32 v157, v157, v49
    v_cvt_pk_bf16_f32 v23, v156, v157
    v_lshlrev_b32 v156, 16, v23
    v_and_b32 v157, 0xffff0000, v23
    v_add_f32 v156, v156, v112
    v_add_f32 v157, v157, v113
    v_cvt_pk_bf16_f32 v23, v156, v157
    v_lshlrev_b32 v156, 16, v23
    v_and_b32 v157, 0xffff0000, v23
    v_mul_f32 v24, 0xbfb8aa3b, v156
    v_mul_f32 v25, 0xbfb8aa3b, v157
    v_exp_f32 v24, v24
    v_exp_f32 v25, v25
    s_nop 0
    v_add_f32 v24, 1.0, v24
    v_add_f32 v25, 1.0, v25
    v_rcp_f32 v24, v24
    v_rcp_f32 v25, v25
    s_nop 0
    v_mul_f32 v156, v156, v24
    v_mul_f32 v157, v157, v25
    v_cvt_pk_bf16_f32 v23, v156, v157
    v_lshlrev_b32 v156, 16, v23
    v_and_b32 v157, 0xffff0000, v23
    v_lshlrev_b32 v142, 16, v47
    v_and_b32 v143, 0xffff0000, v47
    v_sub_f32 v158, v142, v48
    v_sub_f32 v159, v143, v48
    v_cvt_pk_bf16_f32 v23, v158, v159
    v_lshlrev_b32 v158, 16, v23
    v_and_b32 v159, 0xffff0000, v23
    v_mul_f32 v158, v158, v49
    v_mul_f32 v159, v159, v49
    v_cvt_pk_bf16_f32 v23, v158, v159
    v_lshlrev_b32 v158, 16, v23
    v_and_b32 v159, 0xffff0000, v23
    v_add_f32 v158, v158, v114
    v_add_f32 v159, v159, v115
    v_cvt_pk_bf16_f32 v23, v158, v159
    v_lshlrev_b32 v158, 16, v23
    v_and_b32 v159, 0xffff0000, v23
    v_mul_f32 v24, 0xbfb8aa3b, v158
    v_mul_f32 v25, 0xbfb8aa3b, v159
    v_exp_f32 v24, v24
    v_exp_f32 v25, v25
    s_nop 0
    v_add_f32 v24, 1.0, v24
    v_add_f32 v25, 1.0, v25
    v_rcp_f32 v24, v24
    v_rcp_f32 v25, v25
    s_nop 0
    v_mul_f32 v158, v158, v24
    v_mul_f32 v159, v159, v25
    v_cvt_pk_bf16_f32 v23, v158, v159
    v_lshlrev_b32 v158, 16, v23
    v_and_b32 v159, 0xffff0000, v23
    s_waitcnt lgkmcnt(0)
    s_barrier
    ds_read_b128 v[64:67], v21 offset:0
    ds_read_b128 v[68:71], v21 offset:1024
    ds_read_b128 v[72:75], v21 offset:2048
    ds_read_b128 v[76:79], v21 offset:3072
    s_waitcnt lgkmcnt(3)
    v_add_f32 v224, v224, v64
    v_add_f32 v225, v225, v65
    v_cvt_pk_bf16_f32 v23, v224, v225
    v_lshlrev_b32 v224, 16, v23
    v_and_b32 v225, 0xffff0000, v23
    v_mul_f32 v224, v224, v144
    v_mul_f32 v225, v225, v145
    v_cvt_pk_bf16_f32 v23, v224, v225
    v_lshlrev_b32 v224, 16, v23
    v_and_b32 v225, 0xffff0000, v23
    v_add_f32 v224, v224, v128
    v_add_f32 v225, v225, v129
    v_cvt_pk_bf16_f32 v80, v224, v225
    v_add_f32 v226, v226, v66
    v_add_f32 v227, v227, v67
    v_cvt_pk_bf16_f32 v23, v226, v227
    v_lshlrev_b32 v226, 16, v23
    v_and_b32 v227, 0xffff0000, v23
    v_mul_f32 v226, v226, v146
    v_mul_f32 v227, v227, v147
    v_cvt_pk_bf16_f32 v23, v226, v227
    v_lshlrev_b32 v226, 16, v23
    v_and_b32 v227, 0xffff0000, v23
    v_add_f32 v226, v226, v130
    v_add_f32 v227, v227, v131
    v_cvt_pk_bf16_f32 v81, v226, v227
    buffer_store_dwordx2 v[80:81], v15, s[20:23], 0 offen offset:0
    s_waitcnt lgkmcnt(2)
    v_add_f32 v228, v228, v68
    v_add_f32 v229, v229, v69
    v_cvt_pk_bf16_f32 v23, v228, v229
    v_lshlrev_b32 v228, 16, v23
    v_and_b32 v229, 0xffff0000, v23
    v_mul_f32 v228, v228, v148
    v_mul_f32 v229, v229, v149
    v_cvt_pk_bf16_f32 v23, v228, v229
    v_lshlrev_b32 v228, 16, v23
    v_and_b32 v229, 0xffff0000, v23
    v_add_f32 v228, v228, v132
    v_add_f32 v229, v229, v133
    v_cvt_pk_bf16_f32 v82, v228, v229
    v_add_f32 v230, v230, v70
    v_add_f32 v231, v231, v71
    v_cvt_pk_bf16_f32 v23, v230, v231
    v_lshlrev_b32 v230, 16, v23
    v_and_b32 v231, 0xffff0000, v23
    v_mul_f32 v230, v230, v150
    v_mul_f32 v231, v231, v151
    v_cvt_pk_bf16_f32 v23, v230, v231
    v_lshlrev_b32 v230, 16, v23
    v_and_b32 v231, 0xffff0000, v23
    v_add_f32 v230, v230, v134
    v_add_f32 v231, v231, v135
    v_cvt_pk_bf16_f32 v83, v230, v231
    buffer_store_dwordx2 v[82:83], v15, s[20:23], 0 offen offset:32
    s_waitcnt lgkmcnt(1)
    v_add_f32 v232, v232, v72
    v_add_f32 v233, v233, v73
    v_cvt_pk_bf16_f32 v23, v232, v233
    v_lshlrev_b32 v232, 16, v23
    v_and_b32 v233, 0xffff0000, v23
    v_mul_f32 v232, v232, v152
    v_mul_f32 v233, v233, v153
    v_cvt_pk_bf16_f32 v23, v232, v233
    v_lshlrev_b32 v232, 16, v23
    v_and_b32 v233, 0xffff0000, v23
    v_add_f32 v232, v232, v136
    v_add_f32 v233, v233, v137
    v_cvt_pk_bf16_f32 v84, v232, v233
    v_add_f32 v234, v234, v74
    v_add_f32 v235, v235, v75
    v_cvt_pk_bf16_f32 v23, v234, v235
    v_lshlrev_b32 v234, 16, v23
    v_and_b32 v235, 0xffff0000, v23
    v_mul_f32 v234, v234, v154
    v_mul_f32 v235, v235, v155
    v_cvt_pk_bf16_f32 v23, v234, v235
    v_lshlrev_b32 v234, 16, v23
    v_and_b32 v235, 0xffff0000, v23
    v_add_f32 v234, v234, v138
    v_add_f32 v235, v235, v139
    v_cvt_pk_bf16_f32 v85, v234, v235
    buffer_store_dwordx2 v[84:85], v15, s[20:23], 0 offen offset:64
    s_waitcnt lgkmcnt(0)
    v_add_f32 v236, v236, v76
    v_add_f32 v237, v237, v77
    v_cvt_pk_bf16_f32 v23, v236, v237
    v_lshlrev_b32 v236, 16, v23
    v_and_b32 v237, 0xffff0000, v23
    v_mul_f32 v236, v236, v156
    v_mul_f32 v237, v237, v157
    v_cvt_pk_bf16_f32 v23, v236, v237
    v_lshlrev_b32 v236, 16, v23
    v_and_b32 v237, 0xffff0000, v23
    v_add_f32 v236, v236, v140
    v_add_f32 v237, v237, v141
    v_cvt_pk_bf16_f32 v86, v236, v237
    v_add_f32 v238, v238, v78
    v_add_f32 v239, v239, v79
    v_cvt_pk_bf16_f32 v23, v238, v239
    v_lshlrev_b32 v238, 16, v23
    v_and_b32 v239, 0xffff0000, v23
    v_mul_f32 v238, v238, v158
    v_mul_f32 v239, v239, v159
    v_cvt_pk_bf16_f32 v23, v238, v239
    v_lshlrev_b32 v238, 16, v23
    v_and_b32 v239, 0xffff0000, v23
    v_add_f32 v238, v238, v142
    v_add_f32 v239, v239, v143
    v_cvt_pk_bf16_f32 v87, v238, v239
    buffer_store_dwordx2 v[86:87], v15, s[20:23], 0 offen offset:96
    s_branch L_p4_done
L_p4_e1:
    s_lshl_b32 s36, s28, 12
    s_add_u32 s36, s36, 65536
    v_lshl_add_u32 v20, v1, 4, s36
    v_xor_b32 v21, 16384, v20
    v_mov_b32 v100, 0
    v_mov_b32 v101, 0
    v_mov_b32 v102, 0
    v_mov_b32 v103, 0
    v_mov_b32 v104, 0
    v_mov_b32 v105, 0
    v_mov_b32 v106, 0
    v_mov_b32 v107, 0
    v_mov_b32 v108, 0
    v_mov_b32 v109, 0
    v_mov_b32 v110, 0
    v_mov_b32 v111, 0
    v_mov_b32 v112, 0
    v_mov_b32 v113, 0
    v_mov_b32 v114, 0
    v_mov_b32 v115, 0
    ds_write_b128 v20, v[224:227] offset:0
    ds_write_b128 v20, v[228:231] offset:1024
    ds_write_b128 v20, v[232:235] offset:2048
    ds_write_b128 v20, v[236:239] offset:3072
    s_sub_u32 s36, s56, s38
    s_cmp_lt_u32 s36, 16
    s_cbranch_scc0 L_oproj_kernel_noy_5
    s_lshl_b32 s37, s30, 8
    s_add_u32 s37, s37, 59768832
    v_lshlrev_b32 v22, 4, v19
    v_mov_b32 v64, 0
    v_mov_b32 v65, 0
    v_mov_b32 v66, 0
    v_mov_b32 v67, 0
    v_mov_b32 v68, 0
    v_mov_b32 v69, 0
    v_mov_b32 v70, 0
    v_mov_b32 v71, 0
    v_mov_b32 v72, 0
    v_mov_b32 v73, 0
    v_mov_b32 v74, 0
    v_mov_b32 v75, 0
    v_mov_b32 v76, 0
    v_mov_b32 v77, 0
    v_mov_b32 v78, 0
    v_mov_b32 v79, 0
    s_mov_b32 s39, 0
L_oproj_kernel_ysum_6:
    buffer_load_dwordx4 v[80:83], v22, s[24:27], s37 offen offset:0
    buffer_load_dwordx4 v[84:87], v22, s[24:27], s37 offen offset:64
    buffer_load_dwordx4 v[88:91], v22, s[24:27], s37 offen offset:128
    buffer_load_dwordx4 v[92:95], v22, s[24:27], s37 offen offset:192
    s_add_u32 s37, s37, 8192
    s_add_u32 s39, s39, 1
    s_waitcnt vmcnt(0)
    v_add_f32 v64, v64, v80
    v_add_f32 v65, v65, v81
    v_add_f32 v66, v66, v82
    v_add_f32 v67, v67, v83
    v_add_f32 v68, v68, v84
    v_add_f32 v69, v69, v85
    v_add_f32 v70, v70, v86
    v_add_f32 v71, v71, v87
    v_add_f32 v72, v72, v88
    v_add_f32 v73, v73, v89
    v_add_f32 v74, v74, v90
    v_add_f32 v75, v75, v91
    v_add_f32 v76, v76, v92
    v_add_f32 v77, v77, v93
    v_add_f32 v78, v78, v94
    v_add_f32 v79, v79, v95
    s_cmp_lt_u32 s39, 16
    s_cbranch_scc1 L_oproj_kernel_ysum_6
    v_cmp_eq_u32 vcc, s56, v14
    v_cvt_pk_bf16_f32 v64, v64, v64
    v_lshlrev_b32 v64, 16, v64
    v_mul_f32 v64, s58, v64
    v_cvt_pk_bf16_f32 v64, v64, v64
    v_lshlrev_b32 v64, 16, v64
    v_cndmask_b32 v100, v100, v64, vcc
    v_cvt_pk_bf16_f32 v65, v65, v65
    v_lshlrev_b32 v65, 16, v65
    v_mul_f32 v65, s58, v65
    v_cvt_pk_bf16_f32 v65, v65, v65
    v_lshlrev_b32 v65, 16, v65
    v_cndmask_b32 v101, v101, v65, vcc
    v_cvt_pk_bf16_f32 v66, v66, v66
    v_lshlrev_b32 v66, 16, v66
    v_mul_f32 v66, s58, v66
    v_cvt_pk_bf16_f32 v66, v66, v66
    v_lshlrev_b32 v66, 16, v66
    v_cndmask_b32 v102, v102, v66, vcc
    v_cvt_pk_bf16_f32 v67, v67, v67
    v_lshlrev_b32 v67, 16, v67
    v_mul_f32 v67, s58, v67
    v_cvt_pk_bf16_f32 v67, v67, v67
    v_lshlrev_b32 v67, 16, v67
    v_cndmask_b32 v103, v103, v67, vcc
    v_cvt_pk_bf16_f32 v68, v68, v68
    v_lshlrev_b32 v68, 16, v68
    v_mul_f32 v68, s58, v68
    v_cvt_pk_bf16_f32 v68, v68, v68
    v_lshlrev_b32 v68, 16, v68
    v_cndmask_b32 v104, v104, v68, vcc
    v_cvt_pk_bf16_f32 v69, v69, v69
    v_lshlrev_b32 v69, 16, v69
    v_mul_f32 v69, s58, v69
    v_cvt_pk_bf16_f32 v69, v69, v69
    v_lshlrev_b32 v69, 16, v69
    v_cndmask_b32 v105, v105, v69, vcc
    v_cvt_pk_bf16_f32 v70, v70, v70
    v_lshlrev_b32 v70, 16, v70
    v_mul_f32 v70, s58, v70
    v_cvt_pk_bf16_f32 v70, v70, v70
    v_lshlrev_b32 v70, 16, v70
    v_cndmask_b32 v106, v106, v70, vcc
    v_cvt_pk_bf16_f32 v71, v71, v71
    v_lshlrev_b32 v71, 16, v71
    v_mul_f32 v71, s58, v71
    v_cvt_pk_bf16_f32 v71, v71, v71
    v_lshlrev_b32 v71, 16, v71
    v_cndmask_b32 v107, v107, v71, vcc
    v_cvt_pk_bf16_f32 v72, v72, v72
    v_lshlrev_b32 v72, 16, v72
    v_mul_f32 v72, s58, v72
    v_cvt_pk_bf16_f32 v72, v72, v72
    v_lshlrev_b32 v72, 16, v72
    v_cndmask_b32 v108, v108, v72, vcc
    v_cvt_pk_bf16_f32 v73, v73, v73
    v_lshlrev_b32 v73, 16, v73
    v_mul_f32 v73, s58, v73
    v_cvt_pk_bf16_f32 v73, v73, v73
    v_lshlrev_b32 v73, 16, v73
    v_cndmask_b32 v109, v109, v73, vcc
    v_cvt_pk_bf16_f32 v74, v74, v74
    v_lshlrev_b32 v74, 16, v74
    v_mul_f32 v74, s58, v74
    v_cvt_pk_bf16_f32 v74, v74, v74
    v_lshlrev_b32 v74, 16, v74
    v_cndmask_b32 v110, v110, v74, vcc
    v_cvt_pk_bf16_f32 v75, v75, v75
    v_lshlrev_b32 v75, 16, v75
    v_mul_f32 v75, s58, v75
    v_cvt_pk_bf16_f32 v75, v75, v75
    v_lshlrev_b32 v75, 16, v75
    v_cndmask_b32 v111, v111, v75, vcc
    v_cvt_pk_bf16_f32 v76, v76, v76
    v_lshlrev_b32 v76, 16, v76
    v_mul_f32 v76, s58, v76
    v_cvt_pk_bf16_f32 v76, v76, v76
    v_lshlrev_b32 v76, 16, v76
    v_cndmask_b32 v112, v112, v76, vcc
    v_cvt_pk_bf16_f32 v77, v77, v77
    v_lshlrev_b32 v77, 16, v77
    v_mul_f32 v77, s58, v77
    v_cvt_pk_bf16_f32 v77, v77, v77
    v_lshlrev_b32 v77, 16, v77
    v_cndmask_b32 v113, v113, v77, vcc
    v_cvt_pk_bf16_f32 v78, v78, v78
    v_lshlrev_b32 v78, 16, v78
    v_mul_f32 v78, s58, v78
    v_cvt_pk_bf16_f32 v78, v78, v78
    v_lshlrev_b32 v78, 16, v78
    v_cndmask_b32 v114, v114, v78, vcc
    v_cvt_pk_bf16_f32 v79, v79, v79
    v_lshlrev_b32 v79, 16, v79
    v_mul_f32 v79, s58, v79
    v_cvt_pk_bf16_f32 v79, v79, v79
    v_lshlrev_b32 v79, 16, v79
    v_cndmask_b32 v115, v115, v79, vcc
L_oproj_kernel_noy_5:
    s_sub_u32 s36, s57, s38
    s_cmp_lt_u32 s36, 16
    s_cbranch_scc0 L_oproj_kernel_noy_7
    s_lshl_b32 s37, s30, 8
    s_add_u32 s37, s37, 59772928
    v_lshlrev_b32 v22, 4, v19
    v_mov_b32 v64, 0
    v_mov_b32 v65, 0
    v_mov_b32 v66, 0
    v_mov_b32 v67, 0
    v_mov_b32 v68, 0
    v_mov_b32 v69, 0
    v_mov_b32 v70, 0
    v_mov_b32 v71, 0
    v_mov_b32 v72, 0
    v_mov_b32 v73, 0
    v_mov_b32 v74, 0
    v_mov_b32 v75, 0
    v_mov_b32 v76, 0
    v_mov_b32 v77, 0
    v_mov_b32 v78, 0
    v_mov_b32 v79, 0
    s_mov_b32 s39, 0
L_oproj_kernel_ysum_8:
    buffer_load_dwordx4 v[80:83], v22, s[24:27], s37 offen offset:0
    buffer_load_dwordx4 v[84:87], v22, s[24:27], s37 offen offset:64
    buffer_load_dwordx4 v[88:91], v22, s[24:27], s37 offen offset:128
    buffer_load_dwordx4 v[92:95], v22, s[24:27], s37 offen offset:192
    s_add_u32 s37, s37, 8192
    s_add_u32 s39, s39, 1
    s_waitcnt vmcnt(0)
    v_add_f32 v64, v64, v80
    v_add_f32 v65, v65, v81
    v_add_f32 v66, v66, v82
    v_add_f32 v67, v67, v83
    v_add_f32 v68, v68, v84
    v_add_f32 v69, v69, v85
    v_add_f32 v70, v70, v86
    v_add_f32 v71, v71, v87
    v_add_f32 v72, v72, v88
    v_add_f32 v73, v73, v89
    v_add_f32 v74, v74, v90
    v_add_f32 v75, v75, v91
    v_add_f32 v76, v76, v92
    v_add_f32 v77, v77, v93
    v_add_f32 v78, v78, v94
    v_add_f32 v79, v79, v95
    s_cmp_lt_u32 s39, 16
    s_cbranch_scc1 L_oproj_kernel_ysum_8
    v_cmp_eq_u32 vcc, s57, v14
    v_cvt_pk_bf16_f32 v64, v64, v64
    v_lshlrev_b32 v64, 16, v64
    v_mul_f32 v64, s59, v64
    v_cvt_pk_bf16_f32 v64, v64, v64
    v_lshlrev_b32 v64, 16, v64
    v_cndmask_b32 v100, v100, v64, vcc
    v_cvt_pk_bf16_f32 v65, v65, v65
    v_lshlrev_b32 v65, 16, v65
    v_mul_f32 v65, s59, v65
    v_cvt_pk_bf16_f32 v65, v65, v65
    v_lshlrev_b32 v65, 16, v65
    v_cndmask_b32 v101, v101, v65, vcc
    v_cvt_pk_bf16_f32 v66, v66, v66
    v_lshlrev_b32 v66, 16, v66
    v_mul_f32 v66, s59, v66
    v_cvt_pk_bf16_f32 v66, v66, v66
    v_lshlrev_b32 v66, 16, v66
    v_cndmask_b32 v102, v102, v66, vcc
    v_cvt_pk_bf16_f32 v67, v67, v67
    v_lshlrev_b32 v67, 16, v67
    v_mul_f32 v67, s59, v67
    v_cvt_pk_bf16_f32 v67, v67, v67
    v_lshlrev_b32 v67, 16, v67
    v_cndmask_b32 v103, v103, v67, vcc
    v_cvt_pk_bf16_f32 v68, v68, v68
    v_lshlrev_b32 v68, 16, v68
    v_mul_f32 v68, s59, v68
    v_cvt_pk_bf16_f32 v68, v68, v68
    v_lshlrev_b32 v68, 16, v68
    v_cndmask_b32 v104, v104, v68, vcc
    v_cvt_pk_bf16_f32 v69, v69, v69
    v_lshlrev_b32 v69, 16, v69
    v_mul_f32 v69, s59, v69
    v_cvt_pk_bf16_f32 v69, v69, v69
    v_lshlrev_b32 v69, 16, v69
    v_cndmask_b32 v105, v105, v69, vcc
    v_cvt_pk_bf16_f32 v70, v70, v70
    v_lshlrev_b32 v70, 16, v70
    v_mul_f32 v70, s59, v70
    v_cvt_pk_bf16_f32 v70, v70, v70
    v_lshlrev_b32 v70, 16, v70
    v_cndmask_b32 v106, v106, v70, vcc
    v_cvt_pk_bf16_f32 v71, v71, v71
    v_lshlrev_b32 v71, 16, v71
    v_mul_f32 v71, s59, v71
    v_cvt_pk_bf16_f32 v71, v71, v71
    v_lshlrev_b32 v71, 16, v71
    v_cndmask_b32 v107, v107, v71, vcc
    v_cvt_pk_bf16_f32 v72, v72, v72
    v_lshlrev_b32 v72, 16, v72
    v_mul_f32 v72, s59, v72
    v_cvt_pk_bf16_f32 v72, v72, v72
    v_lshlrev_b32 v72, 16, v72
    v_cndmask_b32 v108, v108, v72, vcc
    v_cvt_pk_bf16_f32 v73, v73, v73
    v_lshlrev_b32 v73, 16, v73
    v_mul_f32 v73, s59, v73
    v_cvt_pk_bf16_f32 v73, v73, v73
    v_lshlrev_b32 v73, 16, v73
    v_cndmask_b32 v109, v109, v73, vcc
    v_cvt_pk_bf16_f32 v74, v74, v74
    v_lshlrev_b32 v74, 16, v74
    v_mul_f32 v74, s59, v74
    v_cvt_pk_bf16_f32 v74, v74, v74
    v_lshlrev_b32 v74, 16, v74
    v_cndmask_b32 v110, v110, v74, vcc
    v_cvt_pk_bf16_f32 v75, v75, v75
    v_lshlrev_b32 v75, 16, v75
    v_mul_f32 v75, s59, v75
    v_cvt_pk_bf16_f32 v75, v75, v75
    v_lshlrev_b32 v75, 16, v75
    v_cndmask_b32 v111, v111, v75, vcc
    v_cvt_pk_bf16_f32 v76, v76, v76
    v_lshlrev_b32 v76, 16, v76
    v_mul_f32 v76, s59, v76
    v_cvt_pk_bf16_f32 v76, v76, v76
    v_lshlrev_b32 v76, 16, v76
    v_cndmask_b32 v112, v112, v76, vcc
    v_cvt_pk_bf16_f32 v77, v77, v77
    v_lshlrev_b32 v77, 16, v77
    v_mul_f32 v77, s59, v77
    v_cvt_pk_bf16_f32 v77, v77, v77
    v_lshlrev_b32 v77, 16, v77
    v_cndmask_b32 v113, v113, v77, vcc
    v_cvt_pk_bf16_f32 v78, v78, v78
    v_lshlrev_b32 v78, 16, v78
    v_mul_f32 v78, s59, v78
    v_cvt_pk_bf16_f32 v78, v78, v78
    v_lshlrev_b32 v78, 16, v78
    v_cndmask_b32 v114, v114, v78, vcc
    v_cvt_pk_bf16_f32 v79, v79, v79
    v_lshlrev_b32 v79, 16, v79
    v_mul_f32 v79, s59, v79
    v_cvt_pk_bf16_f32 v79, v79, v79
    v_lshlrev_b32 v79, 16, v79
    v_cndmask_b32 v115, v115, v79, vcc
L_oproj_kernel_noy_7:
    s_waitcnt vmcnt(0)
    v_lshlrev_b32 v128, 16, v40
    v_and_b32 v129, 0xffff0000, v40
    v_sub_f32 v144, v128, v48
    v_sub_f32 v145, v129, v48
    v_cvt_pk_bf16_f32 v23, v144, v145
    v_lshlrev_b32 v144, 16, v23
    v_and_b32 v145, 0xffff0000, v23
    v_mul_f32 v144, v144, v49
    v_mul_f32 v145, v145, v49
    v_cvt_pk_bf16_f32 v23, v144, v145
    v_lshlrev_b32 v144, 16, v23
    v_and_b32 v145, 0xffff0000, v23
    v_add_f32 v144, v144, v100
    v_add_f32 v145, v145, v101
    v_cvt_pk_bf16_f32 v23, v144, v145
    v_lshlrev_b32 v144, 16, v23
    v_and_b32 v145, 0xffff0000, v23
    v_mul_f32 v24, 0xbfb8aa3b, v144
    v_mul_f32 v25, 0xbfb8aa3b, v145
    v_exp_f32 v24, v24
    v_exp_f32 v25, v25
    s_nop 0
    v_add_f32 v24, 1.0, v24
    v_add_f32 v25, 1.0, v25
    v_rcp_f32 v24, v24
    v_rcp_f32 v25, v25
    s_nop 0
    v_mul_f32 v144, v144, v24
    v_mul_f32 v145, v145, v25
    v_cvt_pk_bf16_f32 v23, v144, v145
    v_lshlrev_b32 v144, 16, v23
    v_and_b32 v145, 0xffff0000, v23
    v_lshlrev_b32 v130, 16, v41
    v_and_b32 v131, 0xffff0000, v41
    v_sub_f32 v146, v130, v48
    v_sub_f32 v147, v131, v48
    v_cvt_pk_bf16_f32 v23, v146, v147
    v_lshlrev_b32 v146, 16, v23
    v_and_b32 v147, 0xffff0000, v23
    v_mul_f32 v146, v146, v49
    v_mul_f32 v147, v147, v49
    v_cvt_pk_bf16_f32 v23, v146, v147
    v_lshlrev_b32 v146, 16, v23
    v_and_b32 v147, 0xffff0000, v23
    v_add_f32 v146, v146, v102
    v_add_f32 v147, v147, v103
    v_cvt_pk_bf16_f32 v23, v146, v147
    v_lshlrev_b32 v146, 16, v23
    v_and_b32 v147, 0xffff0000, v23
    v_mul_f32 v24, 0xbfb8aa3b, v146
    v_mul_f32 v25, 0xbfb8aa3b, v147
    v_exp_f32 v24, v24
    v_exp_f32 v25, v25
    s_nop 0
    v_add_f32 v24, 1.0, v24
    v_add_f32 v25, 1.0, v25
    v_rcp_f32 v24, v24
    v_rcp_f32 v25, v25
    s_nop 0
    v_mul_f32 v146, v146, v24
    v_mul_f32 v147, v147, v25
    v_cvt_pk_bf16_f32 v23, v146, v147
    v_lshlrev_b32 v146, 16, v23
    v_and_b32 v147, 0xffff0000, v23
    v_lshlrev_b32 v132, 16, v42
    v_and_b32 v133, 0xffff0000, v42
    v_sub_f32 v148, v132, v48
    v_sub_f32 v149, v133, v48
    v_cvt_pk_bf16_f32 v23, v148, v149
    v_lshlrev_b32 v148, 16, v23
    v_and_b32 v149, 0xffff0000, v23
    v_mul_f32 v148, v148, v49
    v_mul_f32 v149, v149, v49
    v_cvt_pk_bf16_f32 v23, v148, v149
    v_lshlrev_b32 v148, 16, v23
    v_and_b32 v149, 0xffff0000, v23
    v_add_f32 v148, v148, v104
    v_add_f32 v149, v149, v105
    v_cvt_pk_bf16_f32 v23, v148, v149
    v_lshlrev_b32 v148, 16, v23
    v_and_b32 v149, 0xffff0000, v23
    v_mul_f32 v24, 0xbfb8aa3b, v148
    v_mul_f32 v25, 0xbfb8aa3b, v149
    v_exp_f32 v24, v24
    v_exp_f32 v25, v25
    s_nop 0
    v_add_f32 v24, 1.0, v24
    v_add_f32 v25, 1.0, v25
    v_rcp_f32 v24, v24
    v_rcp_f32 v25, v25
    s_nop 0
    v_mul_f32 v148, v148, v24
    v_mul_f32 v149, v149, v25
    v_cvt_pk_bf16_f32 v23, v148, v149
    v_lshlrev_b32 v148, 16, v23
    v_and_b32 v149, 0xffff0000, v23
    v_lshlrev_b32 v134, 16, v43
    v_and_b32 v135, 0xffff0000, v43
    v_sub_f32 v150, v134, v48
    v_sub_f32 v151, v135, v48
    v_cvt_pk_bf16_f32 v23, v150, v151
    v_lshlrev_b32 v150, 16, v23
    v_and_b32 v151, 0xffff0000, v23
    v_mul_f32 v150, v150, v49
    v_mul_f32 v151, v151, v49
    v_cvt_pk_bf16_f32 v23, v150, v151
    v_lshlrev_b32 v150, 16, v23
    v_and_b32 v151, 0xffff0000, v23
    v_add_f32 v150, v150, v106
    v_add_f32 v151, v151, v107
    v_cvt_pk_bf16_f32 v23, v150, v151
    v_lshlrev_b32 v150, 16, v23
    v_and_b32 v151, 0xffff0000, v23
    v_mul_f32 v24, 0xbfb8aa3b, v150
    v_mul_f32 v25, 0xbfb8aa3b, v151
    v_exp_f32 v24, v24
    v_exp_f32 v25, v25
    s_nop 0
    v_add_f32 v24, 1.0, v24
    v_add_f32 v25, 1.0, v25
    v_rcp_f32 v24, v24
    v_rcp_f32 v25, v25
    s_nop 0
    v_mul_f32 v150, v150, v24
    v_mul_f32 v151, v151, v25
    v_cvt_pk_bf16_f32 v23, v150, v151
    v_lshlrev_b32 v150, 16, v23
    v_and_b32 v151, 0xffff0000, v23
    v_lshlrev_b32 v136, 16, v44
    v_and_b32 v137, 0xffff0000, v44
    v_sub_f32 v152, v136, v48
    v_sub_f32 v153, v137, v48
    v_cvt_pk_bf16_f32 v23, v152, v153
    v_lshlrev_b32 v152, 16, v23
    v_and_b32 v153, 0xffff0000, v23
    v_mul_f32 v152, v152, v49
    v_mul_f32 v153, v153, v49
    v_cvt_pk_bf16_f32 v23, v152, v153
    v_lshlrev_b32 v152, 16, v23
    v_and_b32 v153, 0xffff0000, v23
    v_add_f32 v152, v152, v108
    v_add_f32 v153, v153, v109
    v_cvt_pk_bf16_f32 v23, v152, v153
    v_lshlrev_b32 v152, 16, v23
    v_and_b32 v153, 0xffff0000, v23
    v_mul_f32 v24, 0xbfb8aa3b, v152
    v_mul_f32 v25, 0xbfb8aa3b, v153
    v_exp_f32 v24, v24
    v_exp_f32 v25, v25
    s_nop 0
    v_add_f32 v24, 1.0, v24
    v_add_f32 v25, 1.0, v25
    v_rcp_f32 v24, v24
    v_rcp_f32 v25, v25
    s_nop 0
    v_mul_f32 v152, v152, v24
    v_mul_f32 v153, v153, v25
    v_cvt_pk_bf16_f32 v23, v152, v153
    v_lshlrev_b32 v152, 16, v23
    v_and_b32 v153, 0xffff0000, v23
    v_lshlrev_b32 v138, 16, v45
    v_and_b32 v139, 0xffff0000, v45
    v_sub_f32 v154, v138, v48
    v_sub_f32 v155, v139, v48
    v_cvt_pk_bf16_f32 v23, v154, v155
    v_lshlrev_b32 v154, 16, v23
    v_and_b32 v155, 0xffff0000, v23
    v_mul_f32 v154, v154, v49
    v_mul_f32 v155, v155, v49
    v_cvt_pk_bf16_f32 v23, v154, v155
    v_lshlrev_b32 v154, 16, v23
    v_and_b32 v155, 0xffff0000, v23
    v_add_f32 v154, v154, v110
    v_add_f32 v155, v155, v111
    v_cvt_pk_bf16_f32 v23, v154, v155
    v_lshlrev_b32 v154, 16, v23
    v_and_b32 v155, 0xffff0000, v23
    v_mul_f32 v24, 0xbfb8aa3b, v154
    v_mul_f32 v25, 0xbfb8aa3b, v155
    v_exp_f32 v24, v24
    v_exp_f32 v25, v25
    s_nop 0
    v_add_f32 v24, 1.0, v24
    v_add_f32 v25, 1.0, v25
    v_rcp_f32 v24, v24
    v_rcp_f32 v25, v25
    s_nop 0
    v_mul_f32 v154, v154, v24
    v_mul_f32 v155, v155, v25
    v_cvt_pk_bf16_f32 v23, v154, v155
    v_lshlrev_b32 v154, 16, v23
    v_and_b32 v155, 0xffff0000, v23
    v_lshlrev_b32 v140, 16, v46
    v_and_b32 v141, 0xffff0000, v46
    v_sub_f32 v156, v140, v48
    v_sub_f32 v157, v141, v48
    v_cvt_pk_bf16_f32 v23, v156, v157
    v_lshlrev_b32 v156, 16, v23
    v_and_b32 v157, 0xffff0000, v23
    v_mul_f32 v156, v156, v49
    v_mul_f32 v157, v157, v49
    v_cvt_pk_bf16_f32 v23, v156, v157
    v_lshlrev_b32 v156, 16, v23
    v_and_b32 v157, 0xffff0000, v23
    v_add_f32 v156, v156, v112
    v_add_f32 v157, v157, v113
    v_cvt_pk_bf16_f32 v23, v156, v157
    v_lshlrev_b32 v156, 16, v23
    v_and_b32 v157, 0xffff0000, v23
    v_mul_f32 v24, 0xbfb8aa3b, v156
    v_mul_f32 v25, 0xbfb8aa3b, v157
    v_exp_f32 v24, v24
    v_exp_f32 v25, v25
    s_nop 0
    v_add_f32 v24, 1.0, v24
    v_add_f32 v25, 1.0, v25
    v_rcp_f32 v24, v24
    v_rcp_f32 v25, v25
    s_nop 0
    v_mul_f32 v156, v156, v24
    v_mul_f32 v157, v157, v25
    v_cvt_pk_bf16_f32 v23, v156, v157
    v_lshlrev_b32 v156, 16, v23
    v_and_b32 v157, 0xffff0000, v23
    v_lshlrev_b32 v142, 16, v47
    v_and_b32 v143, 0xffff0000, v47
    v_sub_f32 v158, v142, v48
    v_sub_f32 v159, v143, v48
    v_cvt_pk_bf16_f32 v23, v158, v159
    v_lshlrev_b32 v158, 16, v23
    v_and_b32 v159, 0xffff0000, v23
    v_mul_f32 v158, v158, v49
    v_mul_f32 v159, v159, v49
    v_cvt_pk_bf16_f32 v23, v158, v159
    v_lshlrev_b32 v158, 16, v23
    v_and_b32 v159, 0xffff0000, v23
    v_add_f32 v158, v158, v114
    v_add_f32 v159, v159, v115
    v_cvt_pk_bf16_f32 v23, v158, v159
    v_lshlrev_b32 v158, 16, v23
    v_and_b32 v159, 0xffff0000, v23
    v_mul_f32 v24, 0xbfb8aa3b, v158
    v_mul_f32 v25, 0xbfb8aa3b, v159
    v_exp_f32 v24, v24
    v_exp_f32 v25, v25
    s_nop 0
    v_add_f32 v24, 1.0, v24
    v_add_f32 v25, 1.0, v25
    v_rcp_f32 v24, v24
    v_rcp_f32 v25, v25
    s_nop 0
    v_mul_f32 v158, v158, v24
    v_mul_f32 v159, v159, v25
    v_cvt_pk_bf16_f32 v23, v158, v159
    v_lshlrev_b32 v158, 16, v23
    v_and_b32 v159, 0xffff0000, v23
    s_waitcnt lgkmcnt(0)
    s_barrier
    ds_read_b128 v[64:67], v21 offset:0
    ds_read_b128 v[68:71], v21 offset:1024
    ds_read_b128 v[72:75], v21 offset:2048
    ds_read_b128 v[76:79], v21 offset:3072
    s_waitcnt lgkmcnt(3)
    v_add_f32 v240, v240, v64
    v_add_f32 v241, v241, v65
    v_cvt_pk_bf16_f32 v23, v240, v241
    v_lshlrev_b32 v240, 16, v23
    v_and_b32 v241, 0xffff0000, v23
    v_mul_f32 v240, v240, v144
    v_mul_f32 v241, v241, v145
    v_cvt_pk_bf16_f32 v23, v240, v241
    v_lshlrev_b32 v240, 16, v23
    v_and_b32 v241, 0xffff0000, v23
    v_add_f32 v240, v240, v128
    v_add_f32 v241, v241, v129
    v_cvt_pk_bf16_f32 v80, v240, v241
    v_add_f32 v242, v242, v66
    v_add_f32 v243, v243, v67
    v_cvt_pk_bf16_f32 v23, v242, v243
    v_lshlrev_b32 v242, 16, v23
    v_and_b32 v243, 0xffff0000, v23
    v_mul_f32 v242, v242, v146
    v_mul_f32 v243, v243, v147
    v_cvt_pk_bf16_f32 v23, v242, v243
    v_lshlrev_b32 v242, 16, v23
    v_and_b32 v243, 0xffff0000, v23
    v_add_f32 v242, v242, v130
    v_add_f32 v243, v243, v131
    v_cvt_pk_bf16_f32 v81, v242, v243
    buffer_store_dwordx2 v[80:81], v15, s[20:23], 0 offen offset:0
    s_waitcnt lgkmcnt(2)
    v_add_f32 v244, v244, v68
    v_add_f32 v245, v245, v69
    v_cvt_pk_bf16_f32 v23, v244, v245
    v_lshlrev_b32 v244, 16, v23
    v_and_b32 v245, 0xffff0000, v23
    v_mul_f32 v244, v244, v148
    v_mul_f32 v245, v245, v149
    v_cvt_pk_bf16_f32 v23, v244, v245
    v_lshlrev_b32 v244, 16, v23
    v_and_b32 v245, 0xffff0000, v23
    v_add_f32 v244, v244, v132
    v_add_f32 v245, v245, v133
    v_cvt_pk_bf16_f32 v82, v244, v245
    v_add_f32 v246, v246, v70
    v_add_f32 v247, v247, v71
    v_cvt_pk_bf16_f32 v23, v246, v247
    v_lshlrev_b32 v246, 16, v23
    v_and_b32 v247, 0xffff0000, v23
    v_mul_f32 v246, v246, v150
    v_mul_f32 v247, v247, v151
    v_cvt_pk_bf16_f32 v23, v246, v247
    v_lshlrev_b32 v246, 16, v23
    v_and_b32 v247, 0xffff0000, v23
    v_add_f32 v246, v246, v134
    v_add_f32 v247, v247, v135
    v_cvt_pk_bf16_f32 v83, v246, v247
    buffer_store_dwordx2 v[82:83], v15, s[20:23], 0 offen offset:32
    s_waitcnt lgkmcnt(1)
    v_add_f32 v248, v248, v72
    v_add_f32 v249, v249, v73
    v_cvt_pk_bf16_f32 v23, v248, v249
    v_lshlrev_b32 v248, 16, v23
    v_and_b32 v249, 0xffff0000, v23
    v_mul_f32 v248, v248, v152
    v_mul_f32 v249, v249, v153
    v_cvt_pk_bf16_f32 v23, v248, v249
    v_lshlrev_b32 v248, 16, v23
    v_and_b32 v249, 0xffff0000, v23
    v_add_f32 v248, v248, v136
    v_add_f32 v249, v249, v137
    v_cvt_pk_bf16_f32 v84, v248, v249
    v_add_f32 v250, v250, v74
    v_add_f32 v251, v251, v75
    v_cvt_pk_bf16_f32 v23, v250, v251
    v_lshlrev_b32 v250, 16, v23
    v_and_b32 v251, 0xffff0000, v23
    v_mul_f32 v250, v250, v154
    v_mul_f32 v251, v251, v155
    v_cvt_pk_bf16_f32 v23, v250, v251
    v_lshlrev_b32 v250, 16, v23
    v_and_b32 v251, 0xffff0000, v23
    v_add_f32 v250, v250, v138
    v_add_f32 v251, v251, v139
    v_cvt_pk_bf16_f32 v85, v250, v251
    buffer_store_dwordx2 v[84:85], v15, s[20:23], 0 offen offset:64
    s_waitcnt lgkmcnt(0)
    v_add_f32 v252, v252, v76
    v_add_f32 v253, v253, v77
    v_cvt_pk_bf16_f32 v23, v252, v253
    v_lshlrev_b32 v252, 16, v23
    v_and_b32 v253, 0xffff0000, v23
    v_mul_f32 v252, v252, v156
    v_mul_f32 v253, v253, v157
    v_cvt_pk_bf16_f32 v23, v252, v253
    v_lshlrev_b32 v252, 16, v23
    v_and_b32 v253, 0xffff0000, v23
    v_add_f32 v252, v252, v140
    v_add_f32 v253, v253, v141
    v_cvt_pk_bf16_f32 v86, v252, v253
    v_add_f32 v254, v254, v78
    v_add_f32 v255, v255, v79
    v_cvt_pk_bf16_f32 v23, v254, v255
    v_lshlrev_b32 v254, 16, v23
    v_and_b32 v255, 0xffff0000, v23
    v_mul_f32 v254, v254, v158
    v_mul_f32 v255, v255, v159
    v_cvt_pk_bf16_f32 v23, v254, v255
    v_lshlrev_b32 v254, 16, v23
    v_and_b32 v255, 0xffff0000, v23
    v_add_f32 v254, v254, v142
    v_add_f32 v255, v255, v143
    v_cvt_pk_bf16_f32 v87, v254, v255
    buffer_store_dwordx2 v[86:87], v15, s[20:23], 0 offen offset:96
L_p4_done:
L_op_end:
    s_endpgm
.section .rodata,"a"
.p2align 6
.amdhsa_kernel kv_kernel
  .amdhsa_next_free_vgpr 256
  .amdhsa_next_free_sgpr 102
  .amdhsa_accum_offset 256
  .amdhsa_group_segment_fixed_size 0
  .amdhsa_kernarg_size 112
  .amdhsa_user_sgpr_count 2
  .amdhsa_user_sgpr_kernarg_segment_ptr 1
  .amdhsa_system_sgpr_workgroup_id_x 1
.end_amdhsa_kernel
.p2align 6
.amdhsa_kernel ffn1_kernel
  .amdhsa_next_free_vgpr 136
  .amdhsa_next_free_sgpr 102
  .amdhsa_accum_offset 136
  .amdhsa_group_segment_fixed_size 0
  .amdhsa_kernarg_size 112
  .amdhsa_user_sgpr_count 2
  .amdhsa_user_sgpr_kernarg_segment_ptr 1
  .amdhsa_system_sgpr_workgroup_id_x 1
.end_amdhsa_kernel
.p2align 6
.amdhsa_kernel ffn2_kernel
  .amdhsa_next_free_vgpr 136
  .amdhsa_next_free_sgpr 102
  .amdhsa_accum_offset 136
  .amdhsa_group_segment_fixed_size 0
  .amdhsa_kernarg_size 112
  .amdhsa_user_sgpr_count 2
  .amdhsa_user_sgpr_kernarg_segment_ptr 1
  .amdhsa_system_sgpr_workgroup_id_x 1
.end_amdhsa_kernel
.p2align 6
.amdhsa_kernel attn_kernel
  .amdhsa_next_free_vgpr 256
  .amdhsa_next_free_sgpr 102
  .amdhsa_accum_offset 256
  .amdhsa_group_segment_fixed_size 0
  .amdhsa_kernarg_size 112
  .amdhsa_user_sgpr_count 2
  .amdhsa_user_sgpr_kernarg_segment_ptr 1
  .amdhsa_system_sgpr_workgroup_id_x 1
.end_amdhsa_kernel
.p2align 6
.amdhsa_kernel oproj_kernel
  .amdhsa_next_free_vgpr 256
  .amdhsa_next_free_sgpr 102
  .amdhsa_accum_offset 256
  .amdhsa_group_segment_fixed_size 0
  .amdhsa_kernarg_size 112
  .amdhsa_user_sgpr_count 2
  .amdhsa_user_sgpr_kernarg_segment_ptr 1
  .amdhsa_system_sgpr_workgroup_id_x 1
.end_amdhsa_kernel
```

```asm
; @launch kernel=recurrent_scan__compressed_kv_cla__moe_arch_mod__prompt_kernel grid=(256,1,1) block=(512,1,1) lds=163840
.amdgcn_target "amdgcn-amd-amdhsa--gfx950"
.text
.globl recurrent_scan__compressed_kv_cla__moe_arch_mod__prompt_kernel
.p2align 8
.type recurrent_scan__compressed_kv_cla__moe_arch_mod__prompt_kernel,@function
recurrent_scan__compressed_kv_cla__moe_arch_mod__prompt_kernel:
    s_cmp_ge_u32 s2, 256
    s_cbranch_scc1 L_end
    s_load_dwordx4 s[44:47], s[0:1], 0
    s_load_dwordx4 s[48:51], s[0:1], 24
    s_load_dwordx2 s[52:53], s[0:1], 56
    s_load_dwordx4 s[88:91], s[0:1], 96
    s_load_dwordx4 s[92:95], s[0:1], 64
    s_load_dwordx2 s[96:97], s[0:1], 16
    v_and_b32 v1, 63, v0
    v_lshrrev_b32 v16, 6, v0
    s_and_b32 s29, s2, 7
    v_readfirstlane_b32 s28, v16
    s_lshl_b32 s29, s29, 2
    s_bfe_u32 s36, s2, 0x20003
    s_add_u32 s29, s29, s36
    s_lshr_b32 s30, s2, 5
    s_lshl_b32 s42, s2, 3
    s_add_u32 s42, s42, s28
    v_lshlrev_b32 v116, 4, v1
    s_lshl_b32 s36, s42, 11
    v_add_u32 v117, s36, v116
    v_lshrrev_b32 v16, 3, v1
    s_lshl_b32 s36, s30, 8
    s_lshl_b32 s37, s28, 5
    s_add_u32 s36, s36, s37
    v_add_u32 v16, s36, v16
    v_lshlrev_b32 v16, 10, v16
    v_lshrrev_b32 v18, 4, v1
    v_and_b32 v19, 7, v1
    v_xor_b32 v19, v19, v18
    v_lshl_add_u32 v2, v19, 4, v16
    v_xor_b32 v19, 4, v19
    v_lshl_add_u32 v3, v19, 4, v16
    v_add_u32 v3, 7168, v3
    v_add_u32 v4, 14336, v2
    v_add_u32 v5, 14336, v3
    s_and_b32 s36, s28, 3
    s_lshl_b32 s37, s36, 4
    v_add_u32 v16, s37, v18
    v_lshlrev_b32 v16, 13, v16
    s_lshl_b32 s37, s29, 8
    v_add_u32 v16, s37, v16
    v_and_b32 v19, 15, v1
    v_lshlrev_b32 v18, 1, v18
    v_xor_b32 v19, v19, v18
    v_lshl_add_u32 v6, v19, 4, v16
    v_add_u32 v7, 31744, v6
    v_xor_b32 v19, 8, v19
    v_lshl_add_u32 v8, v19, 4, v16
    v_add_u32 v8, 63488, v8
    v_add_u32 v9, 31744, v8
    s_lshl_b32 s33, s28, 12
    s_add_u32 s34, s33, 65536
    s_mov_b32 s31, 0
    s_mov_b32 s32, 0
    s_waitcnt lgkmcnt(0)
    s_add_u32 s54, s90, 0
    s_addc_u32 s55, s91, 0
    s_mov_b32 s16, s44
    s_and_b32 s17, s45, 0xffff
    s_mov_b32 s18, 4194304
    s_mov_b32 s19, 0x20000
    s_mov_b32 s20, s52
    s_and_b32 s21, s53, 0xffff
    s_mov_b32 s22, 2048
    s_mov_b32 s23, 0x20000
    buffer_load_dwordx4 v[68:71], v117, s[16:19], 0 offen
    buffer_load_dwordx4 v[72:75], v117, s[16:19], 0 offen offset:1024
    buffer_load_dwordx4 v[76:79], v116, s[20:23], 0 offen
    buffer_load_dwordx4 v[80:83], v116, s[20:23], 0 offen offset:1024
    s_mov_b32 s4, s46
    s_and_b32 s5, s47, 0xffff
    s_mov_b32 s6, 2097152
    s_mov_b32 s7, 0x20000
    s_cmp_lt_u32 s28, 4
    s_cselect_b32 s8, s48, s50
    s_cselect_b32 s9, s49, s51
    s_and_b32 s9, s9, 0xffff
    s_mov_b32 s10, 4194304
    s_mov_b32 s11, 0x20000
    s_barrier
    s_mov_b32 s40, 128
    s_mov_b32 s41, 524288
    s_and_b32 s95, s95, 0xffff
    s_add_u32 m0, s33, 0
    s_nop 0
    buffer_load_dwordx4 v2, s[4:7], s31 offen offset:0 lds
    buffer_load_dwordx4 v3, s[4:7], s31 offen offset:1024 lds
    buffer_load_dwordx4 v4, s[4:7], s31 offen offset:2048 lds
    buffer_load_dwordx4 v5, s[4:7], s31 offen offset:3072 lds
    s_add_u32 m0, s34, 0
    s_nop 0
    buffer_load_dwordx4 v6, s[8:11], s32 offen offset:0 lds
    buffer_load_dwordx4 v7, s[8:11], s32 offen offset:1024 lds
    buffer_load_dwordx4 v8, s[8:11], s32 offen offset:2048 lds
    buffer_load_dwordx4 v9, s[8:11], s32 offen offset:3072 lds
    s_add_u32 s31, s31, s40
    s_add_u32 s32, s32, s41
    s_add_u32 s12, s54, 8388608
    s_addc_u32 s13, s55, 0
    s_and_b32 s13, s13, 0xffff
    s_mov_b32 s14, 33554432
    s_mov_b32 s15, 0x20000
    s_mov_b32 s24, s54
    s_and_b32 s25, s55, 0xffff
    s_mov_b32 s26, 67108864
    s_mov_b32 s27, 0x20000
    s_add_u32 s90, s54, 61865984
    s_addc_u32 s91, s55, 0
    v_and_b32 v16, 15, v1
    v_lshrrev_b32 v17, 4, v1
    s_bfe_u32 s36, s28, 0x10001
    s_lshl_b32 s36, s36, 14
    v_lshl_add_u32 v18, v16, 7, s36
    v_lshrrev_b32 v19, 1, v16
    v_xor_b32 v19, v19, v17
    v_lshl_add_u32 v10, v19, 4, v18
    v_xor_b32 v19, 4, v19
    v_lshl_add_u32 v11, v19, 4, v18
    v_lshrrev_b32 v16, 2, v16
    v_lshl_add_u32 v18, v17, 3, v16
    v_lshlrev_b32 v18, 8, v18
    s_lshr_b32 s36, s28, 2
    s_lshl_b32 s36, s36, 14
    s_add_u32 s36, s36, 65536
    v_add_u32 v18, s36, v18
    v_and_b32 v19, 3, v1
    v_lshl_add_u32 v18, v19, 3, v18
    v_and_b32 v17, 1, v17
    v_lshl_add_u32 v16, v17, 2, v16
    s_and_b32 s36, s28, 1
    s_lshl_b32 s36, s36, 2
    s_add_u32 s37, s36, 0
    v_xor_b32 v19, s37, v16
    v_lshl_add_u32 v12, v19, 5, v18
    s_add_u32 s37, s36, 1
    v_xor_b32 v19, s37, v16
    v_lshl_add_u32 v13, v19, 5, v18
    s_add_u32 s37, s36, 2
    v_xor_b32 v19, s37, v16
    v_lshl_add_u32 v14, v19, 5, v18
    s_add_u32 s37, s36, 3
    v_xor_b32 v19, s37, v16
    v_lshl_add_u32 v15, v19, 5, v18
    v_mov_b32 v128, 0
    v_mov_b32 v129, 0
    v_mov_b32 v130, 0
    v_mov_b32 v131, 0
    v_mov_b32 v132, 0
    v_mov_b32 v133, 0
    v_mov_b32 v134, 0
    v_mov_b32 v135, 0
    v_mov_b32 v136, 0
    v_mov_b32 v137, 0
    v_mov_b32 v138, 0
    v_mov_b32 v139, 0
    v_mov_b32 v140, 0
    v_mov_b32 v141, 0
    v_mov_b32 v142, 0
    v_mov_b32 v143, 0
    v_mov_b32 v144, 0
    v_mov_b32 v145, 0
    v_mov_b32 v146, 0
    v_mov_b32 v147, 0
    v_mov_b32 v148, 0
    v_mov_b32 v149, 0
    v_mov_b32 v150, 0
    v_mov_b32 v151, 0
    v_mov_b32 v152, 0
    v_mov_b32 v153, 0
    v_mov_b32 v154, 0
    v_mov_b32 v155, 0
    v_mov_b32 v156, 0
    v_mov_b32 v157, 0
    v_mov_b32 v158, 0
    v_mov_b32 v159, 0
    v_mov_b32 v160, 0
    v_mov_b32 v161, 0
    v_mov_b32 v162, 0
    v_mov_b32 v163, 0
    v_mov_b32 v164, 0
    v_mov_b32 v165, 0
    v_mov_b32 v166, 0
    v_mov_b32 v167, 0
    v_mov_b32 v168, 0
    v_mov_b32 v169, 0
    v_mov_b32 v170, 0
    v_mov_b32 v171, 0
    v_mov_b32 v172, 0
    v_mov_b32 v173, 0
    v_mov_b32 v174, 0
    v_mov_b32 v175, 0
    v_mov_b32 v176, 0
    v_mov_b32 v177, 0
    v_mov_b32 v178, 0
    v_mov_b32 v179, 0
    v_mov_b32 v180, 0
    v_mov_b32 v181, 0
    v_mov_b32 v182, 0
    v_mov_b32 v183, 0
    v_mov_b32 v184, 0
    v_mov_b32 v185, 0
    v_mov_b32 v186, 0
    v_mov_b32 v187, 0
    v_mov_b32 v188, 0
    v_mov_b32 v189, 0
    v_mov_b32 v190, 0
    v_mov_b32 v191, 0
    v_mov_b32 v192, 0
    v_mov_b32 v193, 0
    v_mov_b32 v194, 0
    v_mov_b32 v195, 0
    v_mov_b32 v196, 0
    v_mov_b32 v197, 0
    v_mov_b32 v198, 0
    v_mov_b32 v199, 0
    v_mov_b32 v200, 0
    v_mov_b32 v201, 0
    v_mov_b32 v202, 0
    v_mov_b32 v203, 0
    v_mov_b32 v204, 0
    v_mov_b32 v205, 0
    v_mov_b32 v206, 0
    v_mov_b32 v207, 0
    v_mov_b32 v208, 0
    v_mov_b32 v209, 0
    v_mov_b32 v210, 0
    v_mov_b32 v211, 0
    v_mov_b32 v212, 0
    v_mov_b32 v213, 0
    v_mov_b32 v214, 0
    v_mov_b32 v215, 0
    v_mov_b32 v216, 0
    v_mov_b32 v217, 0
    v_mov_b32 v218, 0
    v_mov_b32 v219, 0
    v_mov_b32 v220, 0
    v_mov_b32 v221, 0
    v_mov_b32 v222, 0
    v_mov_b32 v223, 0
    v_mov_b32 v224, 0
    v_mov_b32 v225, 0
    v_mov_b32 v226, 0
    v_mov_b32 v227, 0
    v_mov_b32 v228, 0
    v_mov_b32 v229, 0
    v_mov_b32 v230, 0
    v_mov_b32 v231, 0
    v_mov_b32 v232, 0
    v_mov_b32 v233, 0
    v_mov_b32 v234, 0
    v_mov_b32 v235, 0
    v_mov_b32 v236, 0
    v_mov_b32 v237, 0
    v_mov_b32 v238, 0
    v_mov_b32 v239, 0
    v_mov_b32 v240, 0
    v_mov_b32 v241, 0
    v_mov_b32 v242, 0
    v_mov_b32 v243, 0
    v_mov_b32 v244, 0
    v_mov_b32 v245, 0
    v_mov_b32 v246, 0
    v_mov_b32 v247, 0
    v_mov_b32 v248, 0
    v_mov_b32 v249, 0
    v_mov_b32 v250, 0
    v_mov_b32 v251, 0
    v_mov_b32 v252, 0
    v_mov_b32 v253, 0
    v_mov_b32 v254, 0
    v_mov_b32 v255, 0
    v_mov_b32 v118, 0
    s_waitcnt vmcnt(8)
    s_add_u32 m0, s33, 32768
    s_nop 0
    buffer_load_dwordx4 v2, s[4:7], s31 offen offset:0 lds
    buffer_load_dwordx4 v3, s[4:7], s31 offen offset:1024 lds
    buffer_load_dwordx4 v4, s[4:7], s31 offen offset:2048 lds
    buffer_load_dwordx4 v5, s[4:7], s31 offen offset:3072 lds
    s_add_u32 m0, s34, 32768
    s_nop 0
    buffer_load_dwordx4 v6, s[8:11], s32 offen offset:0 lds
    buffer_load_dwordx4 v7, s[8:11], s32 offen offset:1024 lds
    buffer_load_dwordx4 v8, s[8:11], s32 offen offset:2048 lds
    buffer_load_dwordx4 v9, s[8:11], s32 offen offset:3072 lds
    s_add_u32 s31, s31, s40
    s_add_u32 s32, s32, s41
    s_lshl_b32 s36, s30, 8
    s_lshl_b32 s37, s28, 5
    s_add_u32 s36, s36, s37
    v_lshrrev_b32 v16, 1, v1
    v_add_u32 v16, s36, v16
    v_lshlrev_b32 v16, 10, v16
    v_and_b32 v17, 1, v1
    v_lshl_add_u32 v16, v17, 7, v16
    s_and_b32 s36, s29, 3
    s_lshl_b32 s36, s36, 8
    v_add_u32 v16, s36, v16
    global_load_dword v117, v16, s[46:47]
    v_and_b32 v19, 31, v1
    s_lshl_b32 s36, s30, 6
    s_lshl_b32 s37, s28, 3
    s_add_u32 s36, s36, s37
    v_bfe_u32 v16, v1, 1, 3
    v_add_u32 v16, s36, v16
    v_lshlrev_b32 v16, 13, v16
    v_and_b32 v17, 1, v1
    v_lshl_add_u32 v16, v17, 7, v16
    s_lshl_b32 s36, s29, 8
    v_add_u32 v16, s36, v16
    v_mov_b32 v17, v16
    v_cmp_lt_u32 vcc, 31, v1
    v_mov_b32 v18, s48
    v_mov_b32 v19, s50
    v_cndmask_b32 v16, v16, v17, vcc
    v_cndmask_b32 v18, v18, v19, vcc
    v_mov_b32 v17, s49
    v_mov_b32 v19, s51
    v_cndmask_b32 v17, v17, v19, vcc
    v_add_co_u32 v16, vcc, v18, v16
    s_nop 1
    v_addc_co_u32 v17, vcc, 0, v17, vcc
    global_load_dword v119, v[16:17], off
    s_add_u32 s36, s2, s28
    s_cmp_eq_u32 s36, 0
    s_cbranch_scc1 L_recurrent_scan__compressed_kv_cla__moe_arch_mod__prompt_kernel_rare_1
L_recurrent_scan__compressed_kv_cla__moe_arch_mod__prompt_kernel_back_2:
    v_lshlrev_b32 v84, 16, v68
    v_and_b32 v85, 0xffff0000, v68
    v_lshlrev_b32 v86, 16, v69
    v_and_b32 v87, 0xffff0000, v69
    v_lshlrev_b32 v88, 16, v70
    v_and_b32 v89, 0xffff0000, v70
    v_lshlrev_b32 v90, 16, v71
    v_and_b32 v91, 0xffff0000, v71
    v_lshlrev_b32 v92, 16, v72
    v_and_b32 v93, 0xffff0000, v72
    v_lshlrev_b32 v94, 16, v73
    v_and_b32 v95, 0xffff0000, v73
    v_lshlrev_b32 v96, 16, v74
    v_and_b32 v97, 0xffff0000, v74
    v_lshlrev_b32 v98, 16, v75
    v_and_b32 v99, 0xffff0000, v75
    v_add_f32 v100, v84, v85
    v_add_f32 v100, v100, v86
    v_add_f32 v100, v100, v87
    v_add_f32 v100, v100, v88
    v_add_f32 v100, v100, v89
    v_add_f32 v100, v100, v90
    v_add_f32 v100, v100, v91
    v_add_f32 v100, v100, v92
    v_add_f32 v100, v100, v93
    v_add_f32 v100, v100, v94
    v_add_f32 v100, v100, v95
    v_add_f32 v100, v100, v96
    v_add_f32 v100, v100, v97
    v_add_f32 v100, v100, v98
    v_add_f32 v100, v100, v99
    s_nop 1
    v_add_f32_dpp v100, v100, v100 quad_perm:[1,0,3,2] row_mask:0xf bank_mask:0xf
    s_nop 1
    v_add_f32_dpp v100, v100, v100 quad_perm:[2,3,0,1] row_mask:0xf bank_mask:0xf
    s_nop 1
    v_add_f32_dpp v100, v100, v100 row_half_mirror row_mask:0xf bank_mask:0xf
    s_nop 1
    v_add_f32_dpp v100, v100, v100 row_mirror row_mask:0xf bank_mask:0xf
    s_nop 0
    v_readlane_b32 s36, v100, 0
    v_readlane_b32 s37, v100, 16
    v_readlane_b32 s38, v100, 32
    v_readlane_b32 s39, v100, 48
    v_mov_b32 v101, s36
    v_add_f32 v101, s37, v101
    v_add_f32 v101, s38, v101
    v_add_f32 v101, s39, v101
    v_mul_f32 v101, 0x3a800000, v101
    v_sub_f32 v102, v84, v101
    v_mul_f32 v100, v102, v102
    v_sub_f32 v102, v85, v101
    v_fmac_f32 v100, v102, v102
    v_sub_f32 v102, v86, v101
    v_fmac_f32 v100, v102, v102
    v_sub_f32 v102, v87, v101
    v_fmac_f32 v100, v102, v102
    v_sub_f32 v102, v88, v101
    v_fmac_f32 v100, v102, v102
    v_sub_f32 v102, v89, v101
    v_fmac_f32 v100, v102, v102
    v_sub_f32 v102, v90, v101
    v_fmac_f32 v100, v102, v102
    v_sub_f32 v102, v91, v101
    v_fmac_f32 v100, v102, v102
    v_sub_f32 v102, v92, v101
    v_fmac_f32 v100, v102, v102
    v_sub_f32 v102, v93, v101
    v_fmac_f32 v100, v102, v102
    v_sub_f32 v102, v94, v101
    v_fmac_f32 v100, v102, v102
    v_sub_f32 v102, v95, v101
    v_fmac_f32 v100, v102, v102
    v_sub_f32 v102, v96, v101
    v_fmac_f32 v100, v102, v102
    v_sub_f32 v102, v97, v101
    v_fmac_f32 v100, v102, v102
    v_sub_f32 v102, v98, v101
    v_fmac_f32 v100, v102, v102
    v_sub_f32 v102, v99, v101
    v_fmac_f32 v100, v102, v102
    s_nop 1
    v_add_f32_dpp v100, v100, v100 quad_perm:[1,0,3,2] row_mask:0xf bank_mask:0xf
    s_nop 1
    v_add_f32_dpp v100, v100, v100 quad_perm:[2,3,0,1] row_mask:0xf bank_mask:0xf
    s_nop 1
    v_add_f32_dpp v100, v100, v100 row_half_mirror row_mask:0xf bank_mask:0xf
    s_nop 1
    v_add_f32_dpp v100, v100, v100 row_mirror row_mask:0xf bank_mask:0xf
    s_nop 0
    v_readlane_b32 s36, v100, 0
    v_readlane_b32 s37, v100, 16
    v_readlane_b32 s38, v100, 32
    v_readlane_b32 s39, v100, 48
    v_mov_b32 v102, s36
    v_add_f32 v102, s37, v102
    v_add_f32 v102, s38, v102
    v_add_f32 v102, s39, v102
    v_mul_f32 v102, 0x3a800000, v102
    v_cvt_pk_bf16_f32 v103, v101, v102
    v_lshlrev_b32 v106, 16, v103
    v_and_b32 v102, 0xffff0000, v103
    v_add_f32 v102, 0x3727c5ac, v102
    v_cvt_pk_bf16_f32 v102, v102, v102
    v_lshlrev_b32 v102, 16, v102
    v_sqrt_f32 v102, v102
    s_nop 0
    v_cvt_pk_bf16_f32 v102, v102, v102
    v_lshlrev_b32 v102, 16, v102
    v_rcp_f32 v107, v102
    s_nop 0
    v_fma_f32 v104, -v102, v107, 1.0
    v_fma_f32 v107, v104, v107, v107
    v_sub_f32 v84, v84, v106
    v_sub_f32 v85, v85, v106
    v_cvt_pk_bf16_f32 v104, v84, v85
    v_lshlrev_b32 v84, 16, v104
    v_and_b32 v85, 0xffff0000, v104
    v_mul_f32 v84, v84, v107
    v_mul_f32 v85, v85, v107
    v_cvt_pk_bf16_f32 v68, v84, v85
    v_lshlrev_b32 v84, 16, v68
    v_and_b32 v85, 0xffff0000, v68
    v_sub_f32 v86, v86, v106
    v_sub_f32 v87, v87, v106
    v_cvt_pk_bf16_f32 v104, v86, v87
    v_lshlrev_b32 v86, 16, v104
    v_and_b32 v87, 0xffff0000, v104
    v_mul_f32 v86, v86, v107
    v_mul_f32 v87, v87, v107
    v_cvt_pk_bf16_f32 v69, v86, v87
    v_lshlrev_b32 v86, 16, v69
    v_and_b32 v87, 0xffff0000, v69
    v_sub_f32 v88, v88, v106
    v_sub_f32 v89, v89, v106
    v_cvt_pk_bf16_f32 v104, v88, v89
    v_lshlrev_b32 v88, 16, v104
    v_and_b32 v89, 0xffff0000, v104
    v_mul_f32 v88, v88, v107
    v_mul_f32 v89, v89, v107
    v_cvt_pk_bf16_f32 v70, v88, v89
    v_lshlrev_b32 v88, 16, v70
    v_and_b32 v89, 0xffff0000, v70
    v_sub_f32 v90, v90, v106
    v_sub_f32 v91, v91, v106
    v_cvt_pk_bf16_f32 v104, v90, v91
    v_lshlrev_b32 v90, 16, v104
    v_and_b32 v91, 0xffff0000, v104
    v_mul_f32 v90, v90, v107
    v_mul_f32 v91, v91, v107
    v_cvt_pk_bf16_f32 v71, v90, v91
    v_lshlrev_b32 v90, 16, v71
    v_and_b32 v91, 0xffff0000, v71
    v_sub_f32 v92, v92, v106
    v_sub_f32 v93, v93, v106
    v_cvt_pk_bf16_f32 v104, v92, v93
    v_lshlrev_b32 v92, 16, v104
    v_and_b32 v93, 0xffff0000, v104
    v_mul_f32 v92, v92, v107
    v_mul_f32 v93, v93, v107
    v_cvt_pk_bf16_f32 v72, v92, v93
    v_lshlrev_b32 v92, 16, v72
    v_and_b32 v93, 0xffff0000, v72
    v_sub_f32 v94, v94, v106
    v_sub_f32 v95, v95, v106
    v_cvt_pk_bf16_f32 v104, v94, v95
    v_lshlrev_b32 v94, 16, v104
    v_and_b32 v95, 0xffff0000, v104
    v_mul_f32 v94, v94, v107
    v_mul_f32 v95, v95, v107
    v_cvt_pk_bf16_f32 v73, v94, v95
    v_lshlrev_b32 v94, 16, v73
    v_and_b32 v95, 0xffff0000, v73
    v_sub_f32 v96, v96, v106
    v_sub_f32 v97, v97, v106
    v_cvt_pk_bf16_f32 v104, v96, v97
    v_lshlrev_b32 v96, 16, v104
    v_and_b32 v97, 0xffff0000, v104
    v_mul_f32 v96, v96, v107
    v_mul_f32 v97, v97, v107
    v_cvt_pk_bf16_f32 v74, v96, v97
    v_lshlrev_b32 v96, 16, v74
    v_and_b32 v97, 0xffff0000, v74
    v_sub_f32 v98, v98, v106
    v_sub_f32 v99, v99, v106
    v_cvt_pk_bf16_f32 v104, v98, v99
    v_lshlrev_b32 v98, 16, v104
    v_and_b32 v99, 0xffff0000, v104
    v_mul_f32 v98, v98, v107
    v_mul_f32 v99, v99, v107
    v_cvt_pk_bf16_f32 v75, v98, v99
    v_lshlrev_b32 v98, 16, v75
    v_and_b32 v99, 0xffff0000, v75
    s_mul_i32 s36, s28, 2064
    s_add_u32 s36, s36, 131072
    v_lshl_add_u32 v103, v1, 4, s36
    ds_write_b128 v103, v[68:71]
    ds_write_b128 v103, v[72:75] offset:1024
    v_lshlrev_b32 v104, 16, v76
    v_and_b32 v105, 0xffff0000, v76
    v_mul_f32 v100, v84, v104
    v_fmac_f32 v100, v85, v105
    v_lshlrev_b32 v104, 16, v77
    v_and_b32 v105, 0xffff0000, v77
    v_fmac_f32 v100, v86, v104
    v_fmac_f32 v100, v87, v105
    v_lshlrev_b32 v104, 16, v78
    v_and_b32 v105, 0xffff0000, v78
    v_fmac_f32 v100, v88, v104
    v_fmac_f32 v100, v89, v105
    v_lshlrev_b32 v104, 16, v79
    v_and_b32 v105, 0xffff0000, v79
    v_fmac_f32 v100, v90, v104
    v_fmac_f32 v100, v91, v105
    v_lshlrev_b32 v104, 16, v80
    v_and_b32 v105, 0xffff0000, v80
    v_fmac_f32 v100, v92, v104
    v_fmac_f32 v100, v93, v105
    v_lshlrev_b32 v104, 16, v81
    v_and_b32 v105, 0xffff0000, v81
    v_fmac_f32 v100, v94, v104
    v_fmac_f32 v100, v95, v105
    v_lshlrev_b32 v104, 16, v82
    v_and_b32 v105, 0xffff0000, v82
    v_fmac_f32 v100, v96, v104
    v_fmac_f32 v100, v97, v105
    v_lshlrev_b32 v104, 16, v83
    v_and_b32 v105, 0xffff0000, v83
    v_fmac_f32 v100, v98, v104
    v_fmac_f32 v100, v99, v105
    s_nop 1
    v_add_f32_dpp v100, v100, v100 quad_perm:[1,0,3,2] row_mask:0xf bank_mask:0xf
    s_nop 1
    v_add_f32_dpp v100, v100, v100 quad_perm:[2,3,0,1] row_mask:0xf bank_mask:0xf
    s_nop 1
    v_add_f32_dpp v100, v100, v100 row_half_mirror row_mask:0xf bank_mask:0xf
    s_nop 1
    v_add_f32_dpp v100, v100, v100 row_mirror row_mask:0xf bank_mask:0xf
    s_nop 0
    v_readlane_b32 s36, v100, 0
    v_readlane_b32 s37, v100, 16
    v_readlane_b32 s38, v100, 32
    v_readlane_b32 s39, v100, 48
    v_mov_b32 v101, s36
    v_add_f32 v101, s37, v101
    v_add_f32 v101, s38, v101
    v_add_f32 v101, s39, v101
    v_cvt_pk_bf16_f32 v101, v101, v101
    v_lshlrev_b32 v101, 16, v101
    v_ashrrev_i32 v103, 31, v101
    v_or_b32 v103, 0x80000000, v103
    v_xor_b32 v103, v101, v103
    v_and_b32 v103, 0xffff0000, v103
    s_sub_u32 s36, 0xffff, s42
    v_or_b32 v103, s36, v103
    s_lshl_b32 s36, s28, 3
    s_add_u32 s36, s36, 147712
    v_mov_b32 v102, s36
    ds_write_b64 v102, v[106:107]
    ds_write_b32 v102, v103 offset:64
    s_waitcnt vmcnt(10) lgkmcnt(0)
    s_barrier
    ds_read_b128 v[20:23], v10 offset:0
    ds_read_b64_tr_b16 v[52:53], v12 offset:0
    ds_read_b64_tr_b16 v[54:55], v12 offset:1024
    ds_read_b64_tr_b16 v[56:57], v13 offset:0
    ds_read_b64_tr_b16 v[58:59], v13 offset:1024
    ds_read_b64_tr_b16 v[60:61], v14 offset:0
    ds_read_b64_tr_b16 v[62:63], v14 offset:1024
    ds_read_b64_tr_b16 v[64:65], v15 offset:0
    ds_read_b64_tr_b16 v[66:67], v15 offset:1024
    ds_read_b128 v[24:27], v10 offset:2048
    ds_read_b128 v[28:31], v10 offset:4096
    ds_read_b128 v[32:35], v10 offset:6144
    ds_read_b128 v[36:39], v10 offset:8192
    ds_read_b128 v[40:43], v10 offset:10240
    ds_read_b128 v[44:47], v10 offset:12288
    ds_read_b128 v[48:51], v10 offset:14336
    v_and_b32 v100, 7, v1
    v_lshrrev_b32 v101, 3, v1
    v_mul_u32_u24 v102, 2064, v100
    v_lshl_add_u32 v102, v101, 4, v102
    s_lshl_b32 s36, s28, 8
    s_add_u32 s36, s36, 131072
    v_add_u32 v102, s36, v102
    ds_read_b128 v[120:123], v102
    ds_read_b128 v[124:127], v102 offset:128
    v_lshlrev_b32 v100, 4, v100
    v_lshl_add_u32 v100, v101, 8, v100
    s_lshr_b32 s36, s2, 1
    s_lshl_b32 s36, s36, 15
    s_and_b32 s37, s2, 1
    s_lshl_b32 s37, s37, 7
    s_add_u32 s36, s36, s37
    s_lshl_b32 s37, s28, 12
    s_add_u32 s36, s36, s37
    s_waitcnt lgkmcnt(0)
    buffer_store_dwordx4 v[120:123], v100, s[24:27], s36 offen sc1
    buffer_store_dwordx4 v[124:127], v100, s[24:27], s36 offen offset:2048 sc1
    s_cmp_eq_u32 s28, 7
    s_cbranch_scc1 L_recurrent_scan__compressed_kv_cla__moe_arch_mod__prompt_kernel_rare_3
L_recurrent_scan__compressed_kv_cla__moe_arch_mod__prompt_kernel_back_4:
    s_mov_b32 s35, 0
    s_cmp_eq_u32 s28, 0
    s_cselect_b32 s43, 3, 63
    s_cselect_b32 s44, 2, 1
    s_cmp_lt_u32 s28, 4
    s_cbranch_scc0 L_kv_vloop
    .p2align 6
L_kv_kloop:
    s_cmp_eq_u32 s35, 3
    s_cbranch_scc1 L_recurrent_scan__compressed_kv_cla__moe_arch_mod__prompt_kernel_rare_5
L_recurrent_scan__compressed_kv_cla__moe_arch_mod__prompt_kernel_back_6:
    s_waitcnt lgkmcnt(0)
    v_mfma_f32_16x16x32_bf16 v[128:131], v[52:55], v[20:23], v[128:131]
    ds_read_b128 v[68:71], v11 offset:0
    v_mfma_f32_16x16x32_bf16 v[132:135], v[56:59], v[20:23], v[132:135]
    ds_read_b64_tr_b16 v[100:101], v12 offset:8192
    v_mfma_f32_16x16x32_bf16 v[136:139], v[60:63], v[20:23], v[136:139]
    ds_read_b64_tr_b16 v[102:103], v12 offset:9216
    v_mfma_f32_16x16x32_bf16 v[140:143], v[64:67], v[20:23], v[140:143]
    ds_read_b64_tr_b16 v[104:105], v13 offset:8192
    v_mfma_f32_16x16x32_bf16 v[144:147], v[52:55], v[24:27], v[144:147]
    ds_read_b64_tr_b16 v[106:107], v13 offset:9216
    v_mfma_f32_16x16x32_bf16 v[148:151], v[56:59], v[24:27], v[148:151]
    ds_read_b64_tr_b16 v[108:109], v14 offset:8192
    v_mfma_f32_16x16x32_bf16 v[152:155], v[60:63], v[24:27], v[152:155]
    ds_read_b64_tr_b16 v[110:111], v14 offset:9216
    v_mfma_f32_16x16x32_bf16 v[156:159], v[64:67], v[24:27], v[156:159]
    ds_read_b64_tr_b16 v[112:113], v15 offset:8192
    v_mfma_f32_16x16x32_bf16 v[160:163], v[52:55], v[28:31], v[160:163]
    ds_read_b64_tr_b16 v[114:115], v15 offset:9216
    v_mfma_f32_16x16x32_bf16 v[164:167], v[56:59], v[28:31], v[164:167]
    ds_read_b128 v[72:75], v11 offset:2048
    v_mfma_f32_16x16x32_bf16 v[168:171], v[60:63], v[28:31], v[168:171]
    ds_read_b128 v[76:79], v11 offset:4096
    v_mfma_f32_16x16x32_bf16 v[172:175], v[64:67], v[28:31], v[172:175]
    ds_read_b128 v[80:83], v11 offset:6144
    v_mfma_f32_16x16x32_bf16 v[176:179], v[52:55], v[32:35], v[176:179]
    ds_read_b128 v[84:87], v11 offset:8192
    v_mfma_f32_16x16x32_bf16 v[180:183], v[56:59], v[32:35], v[180:183]
    ds_read_b128 v[88:91], v11 offset:10240
    v_mfma_f32_16x16x32_bf16 v[184:187], v[60:63], v[32:35], v[184:187]
    ds_read_b128 v[92:95], v11 offset:12288
    v_mfma_f32_16x16x32_bf16 v[188:191], v[64:67], v[32:35], v[188:191]
    ds_read_b128 v[96:99], v11 offset:14336
    v_mfma_f32_16x16x32_bf16 v[192:195], v[52:55], v[36:39], v[192:195]
    v_mfma_f32_16x16x32_bf16 v[196:199], v[56:59], v[36:39], v[196:199]
    v_mfma_f32_16x16x32_bf16 v[200:203], v[60:63], v[36:39], v[200:203]
    v_mfma_f32_16x16x32_bf16 v[204:207], v[64:67], v[36:39], v[204:207]
    v_mfma_f32_16x16x32_bf16 v[208:211], v[52:55], v[40:43], v[208:211]
    v_mfma_f32_16x16x32_bf16 v[212:215], v[56:59], v[40:43], v[212:215]
    v_mfma_f32_16x16x32_bf16 v[216:219], v[60:63], v[40:43], v[216:219]
    v_mfma_f32_16x16x32_bf16 v[220:223], v[64:67], v[40:43], v[220:223]
    v_mfma_f32_16x16x32_bf16 v[224:227], v[52:55], v[44:47], v[224:227]
    v_mfma_f32_16x16x32_bf16 v[228:231], v[56:59], v[44:47], v[228:231]
    v_mfma_f32_16x16x32_bf16 v[232:235], v[60:63], v[44:47], v[232:235]
    v_mfma_f32_16x16x32_bf16 v[236:239], v[64:67], v[44:47], v[236:239]
    v_mfma_f32_16x16x32_bf16 v[240:243], v[52:55], v[48:51], v[240:243]
    v_mfma_f32_16x16x32_bf16 v[244:247], v[56:59], v[48:51], v[244:247]
    v_mfma_f32_16x16x32_bf16 v[248:251], v[60:63], v[48:51], v[248:251]
    v_mfma_f32_16x16x32_bf16 v[252:255], v[64:67], v[48:51], v[252:255]
    s_cmp_lt_u32 s35, s44
    s_cbranch_scc1 L_recurrent_scan__compressed_kv_cla__moe_arch_mod__prompt_kernel_w0_7
    s_waitcnt vmcnt(0)
L_recurrent_scan__compressed_kv_cla__moe_arch_mod__prompt_kernel_w0b_8:
    s_waitcnt lgkmcnt(0)
    s_barrier
    v_mfma_f32_16x16x32_bf16 v[128:131], v[100:103], v[68:71], v[128:131]
    ds_read_b128 v[20:23], v10 offset:32768
    s_add_u32 m0, s33, 0
    v_mfma_f32_16x16x32_bf16 v[132:135], v[104:107], v[68:71], v[132:135]
    ds_read_b64_tr_b16 v[52:53], v12 offset:32768
    buffer_load_dwordx4 v2, s[4:7], s31 offen offset:0 lds
    v_mfma_f32_16x16x32_bf16 v[136:139], v[108:111], v[68:71], v[136:139]
    ds_read_b64_tr_b16 v[54:55], v12 offset:33792
    v_mfma_f32_16x16x32_bf16 v[140:143], v[112:115], v[68:71], v[140:143]
    ds_read_b64_tr_b16 v[56:57], v13 offset:32768
    v_mfma_f32_16x16x32_bf16 v[144:147], v[100:103], v[72:75], v[144:147]
    ds_read_b64_tr_b16 v[58:59], v13 offset:33792
    buffer_load_dwordx4 v3, s[4:7], s31 offen offset:1024 lds
    v_mfma_f32_16x16x32_bf16 v[148:151], v[104:107], v[72:75], v[148:151]
    ds_read_b64_tr_b16 v[60:61], v14 offset:32768
    v_mfma_f32_16x16x32_bf16 v[152:155], v[108:111], v[72:75], v[152:155]
    ds_read_b64_tr_b16 v[62:63], v14 offset:33792
    v_mfma_f32_16x16x32_bf16 v[156:159], v[112:115], v[72:75], v[156:159]
    ds_read_b64_tr_b16 v[64:65], v15 offset:32768
    buffer_load_dwordx4 v4, s[4:7], s31 offen offset:2048 lds
    v_mfma_f32_16x16x32_bf16 v[160:163], v[100:103], v[76:79], v[160:163]
    ds_read_b64_tr_b16 v[66:67], v15 offset:33792
    v_mfma_f32_16x16x32_bf16 v[164:167], v[104:107], v[76:79], v[164:167]
    ds_read_b128 v[24:27], v10 offset:34816
    v_mfma_f32_16x16x32_bf16 v[168:171], v[108:111], v[76:79], v[168:171]
    ds_read_b128 v[28:31], v10 offset:36864
    buffer_load_dwordx4 v5, s[4:7], s31 offen offset:3072 lds
    v_mfma_f32_16x16x32_bf16 v[172:175], v[112:115], v[76:79], v[172:175]
    ds_read_b128 v[32:35], v10 offset:38912
    v_mfma_f32_16x16x32_bf16 v[176:179], v[100:103], v[80:83], v[176:179]
    ds_read_b128 v[36:39], v10 offset:40960
    s_add_u32 m0, s34, 0
    v_mfma_f32_16x16x32_bf16 v[180:183], v[104:107], v[80:83], v[180:183]
    ds_read_b128 v[40:43], v10 offset:43008
    buffer_load_dwordx4 v6, s[8:11], s32 offen offset:0 lds
    v_mfma_f32_16x16x32_bf16 v[184:187], v[108:111], v[80:83], v[184:187]
    ds_read_b128 v[44:47], v10 offset:45056
    v_mfma_f32_16x16x32_bf16 v[188:191], v[112:115], v[80:83], v[188:191]
    ds_read_b128 v[48:51], v10 offset:47104
    v_mfma_f32_16x16x32_bf16 v[192:195], v[100:103], v[84:87], v[192:195]
    buffer_load_dwordx4 v7, s[8:11], s32 offen offset:1024 lds
    v_mfma_f32_16x16x32_bf16 v[196:199], v[104:107], v[84:87], v[196:199]
    v_mfma_f32_16x16x32_bf16 v[200:203], v[108:111], v[84:87], v[200:203]
    v_mfma_f32_16x16x32_bf16 v[204:207], v[112:115], v[84:87], v[204:207]
    buffer_load_dwordx4 v8, s[8:11], s32 offen offset:2048 lds
    v_mfma_f32_16x16x32_bf16 v[208:211], v[100:103], v[88:91], v[208:211]
    v_mfma_f32_16x16x32_bf16 v[212:215], v[104:107], v[88:91], v[212:215]
    v_mfma_f32_16x16x32_bf16 v[216:219], v[108:111], v[88:91], v[216:219]
    buffer_load_dwordx4 v9, s[8:11], s32 offen offset:3072 lds
    v_mfma_f32_16x16x32_bf16 v[220:223], v[112:115], v[88:91], v[220:223]
    v_mfma_f32_16x16x32_bf16 v[224:227], v[100:103], v[92:95], v[224:227]
    v_mfma_f32_16x16x32_bf16 v[228:231], v[104:107], v[92:95], v[228:231]
    v_mfma_f32_16x16x32_bf16 v[232:235], v[108:111], v[92:95], v[232:235]
    s_branch L_recurrent_scan__compressed_kv_cla__moe_arch_mod__prompt_kernel_tch_11
L_recurrent_scan__compressed_kv_cla__moe_arch_mod__prompt_kernel_tchb_12:
    v_mfma_f32_16x16x32_bf16 v[236:239], v[112:115], v[92:95], v[236:239]
    v_mfma_f32_16x16x32_bf16 v[240:243], v[100:103], v[96:99], v[240:243]
    v_mfma_f32_16x16x32_bf16 v[244:247], v[104:107], v[96:99], v[244:247]
    v_mfma_f32_16x16x32_bf16 v[248:251], v[108:111], v[96:99], v[248:251]
    v_mfma_f32_16x16x32_bf16 v[252:255], v[112:115], v[96:99], v[252:255]
    s_add_u32 s31, s31, s40
    s_add_u32 s32, s32, s41
    s_cmp_eq_u32 s35, 3
    s_cselect_b32 s8, s94, s8
    s_cselect_b32 s9, s95, s9
    s_waitcnt lgkmcnt(0)
    v_mfma_f32_16x16x32_bf16 v[128:131], v[52:55], v[20:23], v[128:131]
    ds_read_b128 v[68:71], v11 offset:32768
    v_mfma_f32_16x16x32_bf16 v[132:135], v[56:59], v[20:23], v[132:135]
    ds_read_b64_tr_b16 v[100:101], v12 offset:40960
    v_mfma_f32_16x16x32_bf16 v[136:139], v[60:63], v[20:23], v[136:139]
    ds_read_b64_tr_b16 v[102:103], v12 offset:41984
    v_mfma_f32_16x16x32_bf16 v[140:143], v[64:67], v[20:23], v[140:143]
    ds_read_b64_tr_b16 v[104:105], v13 offset:40960
    v_mfma_f32_16x16x32_bf16 v[144:147], v[52:55], v[24:27], v[144:147]
    ds_read_b64_tr_b16 v[106:107], v13 offset:41984
    v_mfma_f32_16x16x32_bf16 v[148:151], v[56:59], v[24:27], v[148:151]
    ds_read_b64_tr_b16 v[108:109], v14 offset:40960
    v_mfma_f32_16x16x32_bf16 v[152:155], v[60:63], v[24:27], v[152:155]
    ds_read_b64_tr_b16 v[110:111], v14 offset:41984
    v_mfma_f32_16x16x32_bf16 v[156:159], v[64:67], v[24:27], v[156:159]
    ds_read_b64_tr_b16 v[112:113], v15 offset:40960
    v_mfma_f32_16x16x32_bf16 v[160:163], v[52:55], v[28:31], v[160:163]
    ds_read_b64_tr_b16 v[114:115], v15 offset:41984
    v_mfma_f32_16x16x32_bf16 v[164:167], v[56:59], v[28:31], v[164:167]
    ds_read_b128 v[72:75], v11 offset:34816
    v_mfma_f32_16x16x32_bf16 v[168:171], v[60:63], v[28:31], v[168:171]
    ds_read_b128 v[76:79], v11 offset:36864
    v_mfma_f32_16x16x32_bf16 v[172:175], v[64:67], v[28:31], v[172:175]
    ds_read_b128 v[80:83], v11 offset:38912
    v_mfma_f32_16x16x32_bf16 v[176:179], v[52:55], v[32:35], v[176:179]
    ds_read_b128 v[84:87], v11 offset:40960
    v_mfma_f32_16x16x32_bf16 v[180:183], v[56:59], v[32:35], v[180:183]
    ds_read_b128 v[88:91], v11 offset:43008
    v_mfma_f32_16x16x32_bf16 v[184:187], v[60:63], v[32:35], v[184:187]
    ds_read_b128 v[92:95], v11 offset:45056
    v_mfma_f32_16x16x32_bf16 v[188:191], v[64:67], v[32:35], v[188:191]
    ds_read_b128 v[96:99], v11 offset:47104
    v_mfma_f32_16x16x32_bf16 v[192:195], v[52:55], v[36:39], v[192:195]
    v_mfma_f32_16x16x32_bf16 v[196:199], v[56:59], v[36:39], v[196:199]
    v_mfma_f32_16x16x32_bf16 v[200:203], v[60:63], v[36:39], v[200:203]
    v_mfma_f32_16x16x32_bf16 v[204:207], v[64:67], v[36:39], v[204:207]
    v_mfma_f32_16x16x32_bf16 v[208:211], v[52:55], v[40:43], v[208:211]
    s_cmp_eq_u32 s35, s43
    s_cbranch_scc1 L_recurrent_scan__compressed_kv_cla__moe_arch_mod__prompt_kernel_rare_16
L_recurrent_scan__compressed_kv_cla__moe_arch_mod__prompt_kernel_back_17:
    v_mfma_f32_16x16x32_bf16 v[212:215], v[56:59], v[40:43], v[212:215]
    v_mfma_f32_16x16x32_bf16 v[216:219], v[60:63], v[40:43], v[216:219]
    v_mfma_f32_16x16x32_bf16 v[220:223], v[64:67], v[40:43], v[220:223]
    v_mfma_f32_16x16x32_bf16 v[224:227], v[52:55], v[44:47], v[224:227]
    v_mfma_f32_16x16x32_bf16 v[228:231], v[56:59], v[44:47], v[228:231]
    v_mfma_f32_16x16x32_bf16 v[232:235], v[60:63], v[44:47], v[232:235]
    v_mfma_f32_16x16x32_bf16 v[236:239], v[64:67], v[44:47], v[236:239]
    v_mfma_f32_16x16x32_bf16 v[240:243], v[52:55], v[48:51], v[240:243]
    v_mfma_f32_16x16x32_bf16 v[244:247], v[56:59], v[48:51], v[244:247]
    v_mfma_f32_16x16x32_bf16 v[248:251], v[60:63], v[48:51], v[248:251]
    v_mfma_f32_16x16x32_bf16 v[252:255], v[64:67], v[48:51], v[252:255]
    s_cmp_eq_u32 s35, s43
    s_cbranch_scc1 L_recurrent_scan__compressed_kv_cla__moe_arch_mod__prompt_kernel_w0_18
    s_waitcnt vmcnt(1)
L_recurrent_scan__compressed_kv_cla__moe_arch_mod__prompt_kernel_w0b_19:
    s_waitcnt lgkmcnt(0)
    s_barrier
    v_mfma_f32_16x16x32_bf16 v[128:131], v[100:103], v[68:71], v[128:131]
    ds_read_b128 v[20:23], v10 offset:0
    s_add_u32 m0, s33, 32768
    v_mfma_f32_16x16x32_bf16 v[132:135], v[104:107], v[68:71], v[132:135]
    ds_read_b64_tr_b16 v[52:53], v12 offset:0
    buffer_load_dwordx4 v2, s[4:7], s31 offen offset:0 lds
    v_mfma_f32_16x16x32_bf16 v[136:139], v[108:111], v[68:71], v[136:139]
    ds_read_b64_tr_b16 v[54:55], v12 offset:1024
    v_mfma_f32_16x16x32_bf16 v[140:143], v[112:115], v[68:71], v[140:143]
    ds_read_b64_tr_b16 v[56:57], v13 offset:0
    v_mfma_f32_16x16x32_bf16 v[144:147], v[100:103], v[72:75], v[144:147]
    ds_read_b64_tr_b16 v[58:59], v13 offset:1024
    buffer_load_dwordx4 v3, s[4:7], s31 offen offset:1024 lds
    v_mfma_f32_16x16x32_bf16 v[148:151], v[104:107], v[72:75], v[148:151]
    ds_read_b64_tr_b16 v[60:61], v14 offset:0
    v_mfma_f32_16x16x32_bf16 v[152:155], v[108:111], v[72:75], v[152:155]
    ds_read_b64_tr_b16 v[62:63], v14 offset:1024
    v_mfma_f32_16x16x32_bf16 v[156:159], v[112:115], v[72:75], v[156:159]
    ds_read_b64_tr_b16 v[64:65], v15 offset:0
    buffer_load_dwordx4 v4, s[4:7], s31 offen offset:2048 lds
    v_mfma_f32_16x16x32_bf16 v[160:163], v[100:103], v[76:79], v[160:163]
    ds_read_b64_tr_b16 v[66:67], v15 offset:1024
    v_mfma_f32_16x16x32_bf16 v[164:167], v[104:107], v[76:79], v[164:167]
    ds_read_b128 v[24:27], v10 offset:2048
    v_mfma_f32_16x16x32_bf16 v[168:171], v[108:111], v[76:79], v[168:171]
    ds_read_b128 v[28:31], v10 offset:4096
    buffer_load_dwordx4 v5, s[4:7], s31 offen offset:3072 lds
    v_mfma_f32_16x16x32_bf16 v[172:175], v[112:115], v[76:79], v[172:175]
    ds_read_b128 v[32:35], v10 offset:6144
    v_mfma_f32_16x16x32_bf16 v[176:179], v[100:103], v[80:83], v[176:179]
    ds_read_b128 v[36:39], v10 offset:8192
    s_add_u32 m0, s34, 32768
    v_mfma_f32_16x16x32_bf16 v[180:183], v[104:107], v[80:83], v[180:183]
    ds_read_b128 v[40:43], v10 offset:10240
    buffer_load_dwordx4 v6, s[8:11], s32 offen offset:0 lds
    v_mfma_f32_16x16x32_bf16 v[184:187], v[108:111], v[80:83], v[184:187]
    ds_read_b128 v[44:47], v10 offset:12288
    v_mfma_f32_16x16x32_bf16 v[188:191], v[112:115], v[80:83], v[188:191]
    ds_read_b128 v[48:51], v10 offset:14336
    v_mfma_f32_16x16x32_bf16 v[192:195], v[100:103], v[84:87], v[192:195]
    buffer_load_dwordx4 v7, s[8:11], s32 offen offset:1024 lds
    v_mfma_f32_16x16x32_bf16 v[196:199], v[104:107], v[84:87], v[196:199]
    v_mfma_f32_16x16x32_bf16 v[200:203], v[108:111], v[84:87], v[200:203]
    v_mfma_f32_16x16x32_bf16 v[204:207], v[112:115], v[84:87], v[204:207]
    buffer_load_dwordx4 v8, s[8:11], s32 offen offset:2048 lds
    v_mfma_f32_16x16x32_bf16 v[208:211], v[100:103], v[88:91], v[208:211]
    v_mfma_f32_16x16x32_bf16 v[212:215], v[104:107], v[88:91], v[212:215]
    v_mfma_f32_16x16x32_bf16 v[216:219], v[108:111], v[88:91], v[216:219]
    buffer_load_dwordx4 v9, s[8:11], s32 offen offset:3072 lds
    v_mfma_f32_16x16x32_bf16 v[220:223], v[112:115], v[88:91], v[220:223]
    v_mfma_f32_16x16x32_bf16 v[224:227], v[100:103], v[92:95], v[224:227]
    v_mfma_f32_16x16x32_bf16 v[228:231], v[104:107], v[92:95], v[228:231]
    v_mfma_f32_16x16x32_bf16 v[232:235], v[108:111], v[92:95], v[232:235]
    v_mfma_f32_16x16x32_bf16 v[236:239], v[112:115], v[92:95], v[236:239]
    v_mfma_f32_16x16x32_bf16 v[240:243], v[100:103], v[96:99], v[240:243]
    v_mfma_f32_16x16x32_bf16 v[244:247], v[104:107], v[96:99], v[244:247]
    v_mfma_f32_16x16x32_bf16 v[248:251], v[108:111], v[96:99], v[248:251]
    s_add_u32 s36, s35, s28
    s_cmp_eq_u32 s36, 0
    s_cbranch_scc1 L_recurrent_scan__compressed_kv_cla__moe_arch_mod__prompt_kernel_rare_24
L_recurrent_scan__compressed_kv_cla__moe_arch_mod__prompt_kernel_back_25:
    v_mfma_f32_16x16x32_bf16 v[252:255], v[112:115], v[96:99], v[252:255]
    s_add_u32 s31, s31, s40
    s_add_u32 s32, s32, s41
    s_add_u32 s35, s35, 1
    s_cmp_lt_u32 s35, 4
    s_cbranch_scc1 L_kv_kloop
    s_branch L_p1_done
    .p2align 6
L_kv_vloop:
    s_cmp_eq_u32 s35, 3
    s_cbranch_scc1 L_recurrent_scan__compressed_kv_cla__moe_arch_mod__prompt_kernel_rare_26
L_recurrent_scan__compressed_kv_cla__moe_arch_mod__prompt_kernel_back_27:
    s_waitcnt lgkmcnt(0)
    v_mfma_f32_16x16x32_bf16 v[128:131], v[20:23], v[52:55], v[128:131]
    ds_read_b128 v[68:71], v11 offset:0
    v_mfma_f32_16x16x32_bf16 v[160:163], v[20:23], v[56:59], v[160:163]
    ds_read_b64_tr_b16 v[100:101], v12 offset:8192
    v_mfma_f32_16x16x32_bf16 v[192:195], v[20:23], v[60:63], v[192:195]
    ds_read_b64_tr_b16 v[102:103], v12 offset:9216
    v_mfma_f32_16x16x32_bf16 v[224:227], v[20:23], v[64:67], v[224:227]
    ds_read_b64_tr_b16 v[104:105], v13 offset:8192
    v_mfma_f32_16x16x32_bf16 v[132:135], v[24:27], v[52:55], v[132:135]
    ds_read_b64_tr_b16 v[106:107], v13 offset:9216
    v_mfma_f32_16x16x32_bf16 v[164:167], v[24:27], v[56:59], v[164:167]
    ds_read_b64_tr_b16 v[108:109], v14 offset:8192
    v_mfma_f32_16x16x32_bf16 v[196:199], v[24:27], v[60:63], v[196:199]
    ds_read_b64_tr_b16 v[110:111], v14 offset:9216
    v_mfma_f32_16x16x32_bf16 v[228:231], v[24:27], v[64:67], v[228:231]
    ds_read_b64_tr_b16 v[112:113], v15 offset:8192
    v_mfma_f32_16x16x32_bf16 v[136:139], v[28:31], v[52:55], v[136:139]
    ds_read_b64_tr_b16 v[114:115], v15 offset:9216
    v_mfma_f32_16x16x32_bf16 v[168:171], v[28:31], v[56:59], v[168:171]
    ds_read_b128 v[72:75], v11 offset:2048
    v_mfma_f32_16x16x32_bf16 v[200:203], v[28:31], v[60:63], v[200:203]
    ds_read_b128 v[76:79], v11 offset:4096
    v_mfma_f32_16x16x32_bf16 v[232:235], v[28:31], v[64:67], v[232:235]
    ds_read_b128 v[80:83], v11 offset:6144
    v_mfma_f32_16x16x32_bf16 v[140:143], v[32:35], v[52:55], v[140:143]
    ds_read_b128 v[84:87], v11 offset:8192
    v_mfma_f32_16x16x32_bf16 v[172:175], v[32:35], v[56:59], v[172:175]
    ds_read_b128 v[88:91], v11 offset:10240
    v_mfma_f32_16x16x32_bf16 v[204:207], v[32:35], v[60:63], v[204:207]
    ds_read_b128 v[92:95], v11 offset:12288
    v_mfma_f32_16x16x32_bf16 v[236:239], v[32:35], v[64:67], v[236:239]
    ds_read_b128 v[96:99], v11 offset:14336
    v_mfma_f32_16x16x32_bf16 v[144:147], v[36:39], v[52:55], v[144:147]
    v_mfma_f32_16x16x32_bf16 v[176:179], v[36:39], v[56:59], v[176:179]
    v_mfma_f32_16x16x32_bf16 v[208:211], v[36:39], v[60:63], v[208:211]
    v_mfma_f32_16x16x32_bf16 v[240:243], v[36:39], v[64:67], v[240:243]
    v_mfma_f32_16x16x32_bf16 v[148:151], v[40:43], v[52:55], v[148:151]
    v_mfma_f32_16x16x32_bf16 v[180:183], v[40:43], v[56:59], v[180:183]
    v_mfma_f32_16x16x32_bf16 v[212:215], v[40:43], v[60:63], v[212:215]
    v_mfma_f32_16x16x32_bf16 v[244:247], v[40:43], v[64:67], v[244:247]
    v_mfma_f32_16x16x32_bf16 v[152:155], v[44:47], v[52:55], v[152:155]
    v_mfma_f32_16x16x32_bf16 v[184:187], v[44:47], v[56:59], v[184:187]
    v_mfma_f32_16x16x32_bf16 v[216:219], v[44:47], v[60:63], v[216:219]
    v_mfma_f32_16x16x32_bf16 v[248:251], v[44:47], v[64:67], v[248:251]
    v_mfma_f32_16x16x32_bf16 v[156:159], v[48:51], v[52:55], v[156:159]
    v_mfma_f32_16x16x32_bf16 v[188:191], v[48:51], v[56:59], v[188:191]
    v_mfma_f32_16x16x32_bf16 v[220:223], v[48:51], v[60:63], v[220:223]
    v_mfma_f32_16x16x32_bf16 v[252:255], v[48:51], v[64:67], v[252:255]
    s_cmp_lt_u32 s35, s44
    s_cbranch_scc1 L_recurrent_scan__compressed_kv_cla__moe_arch_mod__prompt_kernel_w0_28
    s_waitcnt vmcnt(0)
L_recurrent_scan__compressed_kv_cla__moe_arch_mod__prompt_kernel_w0b_29:
    s_waitcnt lgkmcnt(0)
    s_barrier
    s_add_u32 m0, s33, 0
    s_nop 0
    buffer_load_dwordx4 v2, s[4:7], s31 offen offset:0 lds
    buffer_load_dwordx4 v3, s[4:7], s31 offen offset:1024 lds
    buffer_load_dwordx4 v4, s[4:7], s31 offen offset:2048 lds
    buffer_load_dwordx4 v5, s[4:7], s31 offen offset:3072 lds
    s_add_u32 m0, s34, 0
    s_nop 0
    buffer_load_dwordx4 v6, s[8:11], s32 offen offset:0 lds
    buffer_load_dwordx4 v7, s[8:11], s32 offen offset:1024 lds
    buffer_load_dwordx4 v8, s[8:11], s32 offen offset:2048 lds
    buffer_load_dwordx4 v9, s[8:11], s32 offen offset:3072 lds
    s_add_u32 s31, s31, s40
    s_add_u32 s32, s32, s41
    s_cmp_eq_u32 s35, 3
    s_cselect_b32 s8, s94, s8
    s_cselect_b32 s9, s95, s9
    v_mfma_f32_16x16x32_bf16 v[128:131], v[68:71], v[100:103], v[128:131]
    ds_read_b128 v[20:23], v10 offset:32768
    v_mfma_f32_16x16x32_bf16 v[160:163], v[68:71], v[104:107], v[160:163]
    ds_read_b64_tr_b16 v[52:53], v12 offset:32768
    v_mfma_f32_16x16x32_bf16 v[192:195], v[68:71], v[108:111], v[192:195]
    ds_read_b64_tr_b16 v[54:55], v12 offset:33792
    v_mfma_f32_16x16x32_bf16 v[224:227], v[68:71], v[112:115], v[224:227]
    ds_read_b64_tr_b16 v[56:57], v13 offset:32768
    v_mfma_f32_16x16x32_bf16 v[132:135], v[72:75], v[100:103], v[132:135]
    ds_read_b64_tr_b16 v[58:59], v13 offset:33792
    v_mfma_f32_16x16x32_bf16 v[164:167], v[72:75], v[104:107], v[164:167]
    ds_read_b64_tr_b16 v[60:61], v14 offset:32768
    v_mfma_f32_16x16x32_bf16 v[196:199], v[72:75], v[108:111], v[196:199]
    ds_read_b64_tr_b16 v[62:63], v14 offset:33792
    v_mfma_f32_16x16x32_bf16 v[228:231], v[72:75], v[112:115], v[228:231]
    ds_read_b64_tr_b16 v[64:65], v15 offset:32768
    v_mfma_f32_16x16x32_bf16 v[136:139], v[76:79], v[100:103], v[136:139]
    ds_read_b64_tr_b16 v[66:67], v15 offset:33792
    v_mfma_f32_16x16x32_bf16 v[168:171], v[76:79], v[104:107], v[168:171]
    ds_read_b128 v[24:27], v10 offset:34816
    v_mfma_f32_16x16x32_bf16 v[200:203], v[76:79], v[108:111], v[200:203]
    ds_read_b128 v[28:31], v10 offset:36864
    v_mfma_f32_16x16x32_bf16 v[232:235], v[76:79], v[112:115], v[232:235]
    ds_read_b128 v[32:35], v10 offset:38912
    v_mfma_f32_16x16x32_bf16 v[140:143], v[80:83], v[100:103], v[140:143]
    ds_read_b128 v[36:39], v10 offset:40960
    v_mfma_f32_16x16x32_bf16 v[172:175], v[80:83], v[104:107], v[172:175]
    ds_read_b128 v[40:43], v10 offset:43008
    v_mfma_f32_16x16x32_bf16 v[204:207], v[80:83], v[108:111], v[204:207]
    ds_read_b128 v[44:47], v10 offset:45056
    v_mfma_f32_16x16x32_bf16 v[236:239], v[80:83], v[112:115], v[236:239]
    ds_read_b128 v[48:51], v10 offset:47104
    v_mfma_f32_16x16x32_bf16 v[144:147], v[84:87], v[100:103], v[144:147]
    v_mfma_f32_16x16x32_bf16 v[176:179], v[84:87], v[104:107], v[176:179]
    v_mfma_f32_16x16x32_bf16 v[208:211], v[84:87], v[108:111], v[208:211]
    v_mfma_f32_16x16x32_bf16 v[240:243], v[84:87], v[112:115], v[240:243]
    v_mfma_f32_16x16x32_bf16 v[148:151], v[88:91], v[100:103], v[148:151]
    v_mfma_f32_16x16x32_bf16 v[180:183], v[88:91], v[104:107], v[180:183]
    v_mfma_f32_16x16x32_bf16 v[212:215], v[88:91], v[108:111], v[212:215]
    v_mfma_f32_16x16x32_bf16 v[244:247], v[88:91], v[112:115], v[244:247]
    v_mfma_f32_16x16x32_bf16 v[152:155], v[92:95], v[100:103], v[152:155]
    v_mfma_f32_16x16x32_bf16 v[184:187], v[92:95], v[104:107], v[184:187]
    v_mfma_f32_16x16x32_bf16 v[216:219], v[92:95], v[108:111], v[216:219]
    s_branch L_recurrent_scan__compressed_kv_cla__moe_arch_mod__prompt_kernel_tch_32
L_recurrent_scan__compressed_kv_cla__moe_arch_mod__prompt_kernel_tchb_33:
    v_mfma_f32_16x16x32_bf16 v[248:251], v[92:95], v[112:115], v[248:251]
    v_mfma_f32_16x16x32_bf16 v[156:159], v[96:99], v[100:103], v[156:159]
    v_mfma_f32_16x16x32_bf16 v[188:191], v[96:99], v[104:107], v[188:191]
    v_mfma_f32_16x16x32_bf16 v[220:223], v[96:99], v[108:111], v[220:223]
    v_mfma_f32_16x16x32_bf16 v[252:255], v[96:99], v[112:115], v[252:255]
    s_waitcnt lgkmcnt(0)
    v_mfma_f32_16x16x32_bf16 v[128:131], v[20:23], v[52:55], v[128:131]
    ds_read_b128 v[68:71], v11 offset:32768
    v_mfma_f32_16x16x32_bf16 v[160:163], v[20:23], v[56:59], v[160:163]
    ds_read_b64_tr_b16 v[100:101], v12 offset:40960
    v_mfma_f32_16x16x32_bf16 v[192:195], v[20:23], v[60:63], v[192:195]
    ds_read_b64_tr_b16 v[102:103], v12 offset:41984
    v_mfma_f32_16x16x32_bf16 v[224:227], v[20:23], v[64:67], v[224:227]
    ds_read_b64_tr_b16 v[104:105], v13 offset:40960
    v_mfma_f32_16x16x32_bf16 v[132:135], v[24:27], v[52:55], v[132:135]
    ds_read_b64_tr_b16 v[106:107], v13 offset:41984
    v_mfma_f32_16x16x32_bf16 v[164:167], v[24:27], v[56:59], v[164:167]
    ds_read_b64_tr_b16 v[108:109], v14 offset:40960
    v_mfma_f32_16x16x32_bf16 v[196:199], v[24:27], v[60:63], v[196:199]
    ds_read_b64_tr_b16 v[110:111], v14 offset:41984
    v_mfma_f32_16x16x32_bf16 v[228:231], v[24:27], v[64:67], v[228:231]
    ds_read_b64_tr_b16 v[112:113], v15 offset:40960
    v_mfma_f32_16x16x32_bf16 v[136:139], v[28:31], v[52:55], v[136:139]
    ds_read_b64_tr_b16 v[114:115], v15 offset:41984
    v_mfma_f32_16x16x32_bf16 v[168:171], v[28:31], v[56:59], v[168:171]
    ds_read_b128 v[72:75], v11 offset:34816
    v_mfma_f32_16x16x32_bf16 v[200:203], v[28:31], v[60:63], v[200:203]
    ds_read_b128 v[76:79], v11 offset:36864
    v_mfma_f32_16x16x32_bf16 v[232:235], v[28:31], v[64:67], v[232:235]
    ds_read_b128 v[80:83], v11 offset:38912
    v_mfma_f32_16x16x32_bf16 v[140:143], v[32:35], v[52:55], v[140:143]
    ds_read_b128 v[84:87], v11 offset:40960
    v_mfma_f32_16x16x32_bf16 v[172:175], v[32:35], v[56:59], v[172:175]
    ds_read_b128 v[88:91], v11 offset:43008
    v_mfma_f32_16x16x32_bf16 v[204:207], v[32:35], v[60:63], v[204:207]
    ds_read_b128 v[92:95], v11 offset:45056
    v_mfma_f32_16x16x32_bf16 v[236:239], v[32:35], v[64:67], v[236:239]
    ds_read_b128 v[96:99], v11 offset:47104
    v_mfma_f32_16x16x32_bf16 v[144:147], v[36:39], v[52:55], v[144:147]
    v_mfma_f32_16x16x32_bf16 v[176:179], v[36:39], v[56:59], v[176:179]
    v_mfma_f32_16x16x32_bf16 v[208:211], v[36:39], v[60:63], v[208:211]
    v_mfma_f32_16x16x32_bf16 v[240:243], v[36:39], v[64:67], v[240:243]
    v_mfma_f32_16x16x32_bf16 v[148:151], v[40:43], v[52:55], v[148:151]
    v_mfma_f32_16x16x32_bf16 v[180:183], v[40:43], v[56:59], v[180:183]
    v_mfma_f32_16x16x32_bf16 v[212:215], v[40:43], v[60:63], v[212:215]
    v_mfma_f32_16x16x32_bf16 v[244:247], v[40:43], v[64:67], v[244:247]
    v_mfma_f32_16x16x32_bf16 v[152:155], v[44:47], v[52:55], v[152:155]
    v_mfma_f32_16x16x32_bf16 v[184:187], v[44:47], v[56:59], v[184:187]
    v_mfma_f32_16x16x32_bf16 v[216:219], v[44:47], v[60:63], v[216:219]
    v_mfma_f32_16x16x32_bf16 v[248:251], v[44:47], v[64:67], v[248:251]
    v_mfma_f32_16x16x32_bf16 v[156:159], v[48:51], v[52:55], v[156:159]
    v_mfma_f32_16x16x32_bf16 v[188:191], v[48:51], v[56:59], v[188:191]
    v_mfma_f32_16x16x32_bf16 v[220:223], v[48:51], v[60:63], v[220:223]
    v_mfma_f32_16x16x32_bf16 v[252:255], v[48:51], v[64:67], v[252:255]
    s_waitcnt vmcnt(1) lgkmcnt(0)
    s_barrier
    s_add_u32 m0, s33, 32768
    s_nop 0
    buffer_load_dwordx4 v2, s[4:7], s31 offen offset:0 lds
    buffer_load_dwordx4 v3, s[4:7], s31 offen offset:1024 lds
    buffer_load_dwordx4 v4, s[4:7], s31 offen offset:2048 lds
    buffer_load_dwordx4 v5, s[4:7], s31 offen offset:3072 lds
    s_add_u32 m0, s34, 32768
    s_nop 0
    buffer_load_dwordx4 v6, s[8:11], s32 offen offset:0 lds
    buffer_load_dwordx4 v7, s[8:11], s32 offen offset:1024 lds
    buffer_load_dwordx4 v8, s[8:11], s32 offen offset:2048 lds
    buffer_load_dwordx4 v9, s[8:11], s32 offen offset:3072 lds
    s_add_u32 s31, s31, s40
    s_add_u32 s32, s32, s41
    v_mfma_f32_16x16x32_bf16 v[128:131], v[68:71], v[100:103], v[128:131]
    ds_read_b128 v[20:23], v10 offset:0
    v_mfma_f32_16x16x32_bf16 v[160:163], v[68:71], v[104:107], v[160:163]
    ds_read_b64_tr_b16 v[52:53], v12 offset:0
    v_mfma_f32_16x16x32_bf16 v[192:195], v[68:71], v[108:111], v[192:195]
    ds_read_b64_tr_b16 v[54:55], v12 offset:1024
    v_mfma_f32_16x16x32_bf16 v[224:227], v[68:71], v[112:115], v[224:227]
    ds_read_b64_tr_b16 v[56:57], v13 offset:0
    v_mfma_f32_16x16x32_bf16 v[132:135], v[72:75], v[100:103], v[132:135]
    ds_read_b64_tr_b16 v[58:59], v13 offset:1024
    v_mfma_f32_16x16x32_bf16 v[164:167], v[72:75], v[104:107], v[164:167]
    ds_read_b64_tr_b16 v[60:61], v14 offset:0
    v_mfma_f32_16x16x32_bf16 v[196:199], v[72:75], v[108:111], v[196:199]
    ds_read_b64_tr_b16 v[62:63], v14 offset:1024
    v_mfma_f32_16x16x32_bf16 v[228:231], v[72:75], v[112:115], v[228:231]
    ds_read_b64_tr_b16 v[64:65], v15 offset:0
    v_mfma_f32_16x16x32_bf16 v[136:139], v[76:79], v[100:103], v[136:139]
    ds_read_b64_tr_b16 v[66:67], v15 offset:1024
    v_mfma_f32_16x16x32_bf16 v[168:171], v[76:79], v[104:107], v[168:171]
    ds_read_b128 v[24:27], v10 offset:2048
    v_mfma_f32_16x16x32_bf16 v[200:203], v[76:79], v[108:111], v[200:203]
    ds_read_b128 v[28:31], v10 offset:4096
    v_mfma_f32_16x16x32_bf16 v[232:235], v[76:79], v[112:115], v[232:235]
    ds_read_b128 v[32:35], v10 offset:6144
    v_mfma_f32_16x16x32_bf16 v[140:143], v[80:83], v[100:103], v[140:143]
    ds_read_b128 v[36:39], v10 offset:8192
    v_mfma_f32_16x16x32_bf16 v[172:175], v[80:83], v[104:107], v[172:175]
    ds_read_b128 v[40:43], v10 offset:10240
    v_mfma_f32_16x16x32_bf16 v[204:207], v[80:83], v[108:111], v[204:207]
    ds_read_b128 v[44:47], v10 offset:12288
    v_mfma_f32_16x16x32_bf16 v[236:239], v[80:83], v[112:115], v[236:239]
    ds_read_b128 v[48:51], v10 offset:14336
    v_mfma_f32_16x16x32_bf16 v[144:147], v[84:87], v[100:103], v[144:147]
    v_mfma_f32_16x16x32_bf16 v[176:179], v[84:87], v[104:107], v[176:179]
    v_mfma_f32_16x16x32_bf16 v[208:211], v[84:87], v[108:111], v[208:211]
    v_mfma_f32_16x16x32_bf16 v[240:243], v[84:87], v[112:115], v[240:243]
    v_mfma_f32_16x16x32_bf16 v[148:151], v[88:91], v[100:103], v[148:151]
    v_mfma_f32_16x16x32_bf16 v[180:183], v[88:91], v[104:107], v[180:183]
    v_mfma_f32_16x16x32_bf16 v[212:215], v[88:91], v[108:111], v[212:215]
    v_mfma_f32_16x16x32_bf16 v[244:247], v[88:91], v[112:115], v[244:247]
    v_mfma_f32_16x16x32_bf16 v[152:155], v[92:95], v[100:103], v[152:155]
    v_mfma_f32_16x16x32_bf16 v[184:187], v[92:95], v[104:107], v[184:187]
    v_mfma_f32_16x16x32_bf16 v[216:219], v[92:95], v[108:111], v[216:219]
    v_mfma_f32_16x16x32_bf16 v[248:251], v[92:95], v[112:115], v[248:251]
    v_mfma_f32_16x16x32_bf16 v[156:159], v[96:99], v[100:103], v[156:159]
    v_mfma_f32_16x16x32_bf16 v[188:191], v[96:99], v[104:107], v[188:191]
    v_mfma_f32_16x16x32_bf16 v[220:223], v[96:99], v[108:111], v[220:223]
    v_mfma_f32_16x16x32_bf16 v[252:255], v[96:99], v[112:115], v[252:255]
    s_add_u32 s35, s35, 1
    s_cmp_lt_u32 s35, 4
    s_cbranch_scc1 L_kv_vloop
L_p1_done:
    s_waitcnt vmcnt(8) lgkmcnt(0)
    s_and_b32 s36, s28, 3
    s_sub_u32 s37, 15, s30
    s_cmp_lt_u32 s28, 4
    s_cselect_b32 s37, s37, s30
    s_lshl_b32 s37, s37, 2
    s_add_u32 s37, s37, s36
    s_lshl_b32 s37, s37, 16
    v_lshl_add_u32 v6, v1, 4, s37
    v_add_u32 v7, 32768, v6
    s_mov_b32 s32, 0
    s_mov_b32 s8, s54
    s_and_b32 s9, s55, 0xffff
    s_mov_b32 s10, 4194304
    s_mov_b32 s11, 0x20000
    buffer_load_dwordx4 v[64:67], v6, s[8:11], s32 offen offset:0 sc1
    buffer_load_dwordx4 v[68:71], v7, s[8:11], s32 offen offset:0 sc1
    buffer_load_dwordx4 v[72:75], v6, s[8:11], s32 offen offset:1024 sc1
    buffer_load_dwordx4 v[76:79], v7, s[8:11], s32 offen offset:1024 sc1
    buffer_load_dwordx4 v[80:83], v6, s[8:11], s32 offen offset:2048 sc1
    buffer_load_dwordx4 v[84:87], v7, s[8:11], s32 offen offset:2048 sc1
    buffer_load_dwordx4 v[88:91], v6, s[8:11], s32 offen offset:3072 sc1
    buffer_load_dwordx4 v[92:95], v7, s[8:11], s32 offen offset:3072 sc1
    s_add_u32 s32, s32, 4096
    buffer_load_dwordx4 v[96:99], v6, s[8:11], s32 offen offset:0 sc1
    buffer_load_dwordx4 v[100:103], v7, s[8:11], s32 offen offset:0 sc1
    buffer_load_dwordx4 v[104:107], v6, s[8:11], s32 offen offset:1024 sc1
    buffer_load_dwordx4 v[108:111], v7, s[8:11], s32 offen offset:1024 sc1
    buffer_load_dwordx4 v[112:115], v6, s[8:11], s32 offen offset:2048 sc1
    buffer_load_dwordx4 v[116:119], v7, s[8:11], s32 offen offset:2048 sc1
    v_lshrrev_b32 v18, 4, v1
    v_bfe_u32 v20, v1, 2, 2
    v_lshl_add_u32 v19, v18, 3, v20
    v_lshlrev_b32 v19, 8, v19
    v_and_b32 v21, 3, v1
    v_lshl_add_u32 v19, v21, 3, v19
    v_and_b32 v21, 1, v18
    v_lshl_add_u32 v20, v21, 2, v20
    v_xor_b32 v21, 0, v20
    v_lshl_add_u32 v10, v21, 5, v19
    v_xor_b32 v21, 1, v20
    v_lshl_add_u32 v11, v21, 5, v19
    v_xor_b32 v21, 2, v20
    v_lshl_add_u32 v12, v21, 5, v19
    v_xor_b32 v21, 3, v20
    v_lshl_add_u32 v13, v21, 5, v19
    v_xor_b32 v21, 4, v20
    v_lshl_add_u32 v14, v21, 5, v19
    v_xor_b32 v21, 5, v20
    v_lshl_add_u32 v15, v21, 5, v19
    v_xor_b32 v21, 6, v20
    v_lshl_add_u32 v16, v21, 5, v19
    v_xor_b32 v21, 7, v20
    v_lshl_add_u32 v17, v21, 5, v19
    s_lshl_b32 s45, s29, 20
    ds_read_b64_tr_b16 v[24:25], v10 offset:0
    ds_read_b64_tr_b16 v[26:27], v10 offset:1024
    ds_read_b64_tr_b16 v[28:29], v11 offset:0
    ds_read_b64_tr_b16 v[30:31], v11 offset:1024
    ds_read_b64_tr_b16 v[32:33], v12 offset:0
    ds_read_b64_tr_b16 v[34:35], v12 offset:1024
    ds_read_b64_tr_b16 v[36:37], v13 offset:0
    ds_read_b64_tr_b16 v[38:39], v13 offset:1024
    ds_read_b64_tr_b16 v[40:41], v14 offset:0
    ds_read_b64_tr_b16 v[42:43], v14 offset:1024
    ds_read_b64_tr_b16 v[44:45], v15 offset:0
    ds_read_b64_tr_b16 v[46:47], v15 offset:1024
    v_cvt_pk_bf16_f32 v128, v128, v129
    v_cvt_pk_bf16_f32 v129, v130, v131
    v_cvt_pk_bf16_f32 v130, v132, v133
    v_cvt_pk_bf16_f32 v131, v134, v135
    v_cvt_pk_bf16_f32 v132, v136, v137
    v_cvt_pk_bf16_f32 v133, v138, v139
    v_cvt_pk_bf16_f32 v134, v140, v141
    v_cvt_pk_bf16_f32 v135, v142, v143
    v_cvt_pk_bf16_f32 v136, v144, v145
    v_cvt_pk_bf16_f32 v137, v146, v147
    v_cvt_pk_bf16_f32 v138, v148, v149
    v_cvt_pk_bf16_f32 v139, v150, v151
    v_cvt_pk_bf16_f32 v140, v152, v153
    v_cvt_pk_bf16_f32 v141, v154, v155
    v_cvt_pk_bf16_f32 v142, v156, v157
    v_cvt_pk_bf16_f32 v143, v158, v159
    v_cvt_pk_bf16_f32 v144, v160, v161
    v_cvt_pk_bf16_f32 v145, v162, v163
    v_cvt_pk_bf16_f32 v146, v164, v165
    v_cvt_pk_bf16_f32 v147, v166, v167
    v_cvt_pk_bf16_f32 v148, v168, v169
    v_cvt_pk_bf16_f32 v149, v170, v171
    v_cvt_pk_bf16_f32 v150, v172, v173
    v_cvt_pk_bf16_f32 v151, v174, v175
    v_cvt_pk_bf16_f32 v152, v176, v177
    v_cvt_pk_bf16_f32 v153, v178, v179
    v_cvt_pk_bf16_f32 v154, v180, v181
    v_cvt_pk_bf16_f32 v155, v182, v183
    v_cvt_pk_bf16_f32 v156, v184, v185
    v_cvt_pk_bf16_f32 v157, v186, v187
    v_cvt_pk_bf16_f32 v158, v188, v189
    v_cvt_pk_bf16_f32 v159, v190, v191
    v_cvt_pk_bf16_f32 v160, v192, v193
    v_cvt_pk_bf16_f32 v161, v194, v195
    v_cvt_pk_bf16_f32 v162, v196, v197
    v_cvt_pk_bf16_f32 v163, v198, v199
    v_cvt_pk_bf16_f32 v164, v200, v201
    v_cvt_pk_bf16_f32 v165, v202, v203
    v_cvt_pk_bf16_f32 v166, v204, v205
    v_cvt_pk_bf16_f32 v167, v206, v207
    v_cvt_pk_bf16_f32 v168, v208, v209
    v_cvt_pk_bf16_f32 v169, v210, v211
    v_cvt_pk_bf16_f32 v170, v212, v213
    v_cvt_pk_bf16_f32 v171, v214, v215
    v_cvt_pk_bf16_f32 v172, v216, v217
    v_cvt_pk_bf16_f32 v173, v218, v219
    v_cvt_pk_bf16_f32 v174, v220, v221
    v_cvt_pk_bf16_f32 v175, v222, v223
    v_cvt_pk_bf16_f32 v176, v224, v225
    v_cvt_pk_bf16_f32 v177, v226, v227
    v_cvt_pk_bf16_f32 v178, v228, v229
    v_cvt_pk_bf16_f32 v179, v230, v231
    v_cvt_pk_bf16_f32 v180, v232, v233
    v_cvt_pk_bf16_f32 v181, v234, v235
    v_cvt_pk_bf16_f32 v182, v236, v237
    v_cvt_pk_bf16_f32 v183, v238, v239
    v_cvt_pk_bf16_f32 v184, v240, v241
    v_cvt_pk_bf16_f32 v185, v242, v243
    v_cvt_pk_bf16_f32 v186, v244, v245
    v_cvt_pk_bf16_f32 v187, v246, v247
    v_cvt_pk_bf16_f32 v188, v248, v249
    v_cvt_pk_bf16_f32 v189, v250, v251
    v_cvt_pk_bf16_f32 v190, v252, v253
    v_cvt_pk_bf16_f32 v191, v254, v255
    s_mov_b32 s51, 0x55555555
    s_lshl_b32 s38, s29, 20
    s_lshl_b32 s37, s30, 17
    s_add_u32 s38, s38, s37
    s_bfe_u32 s37, s28, 0x10001
    s_lshl_b32 s37, s37, 16
    s_add_u32 s38, s38, s37
    s_lshr_b32 s36, s28, 2
    s_lshl_b32 s37, s36, 15
    s_add_u32 s38, s38, s37
    s_and_b32 s37, s28, 1
    s_add_u32 s36, s36, 11
    s_lshl_b32 s37, s37, s36
    s_add_u32 s38, s38, s37
    s_cmp_lt_u32 s28, 4
    s_cselect_b32 s36, 4, 32
    s_cselect_b32 s37, 16, 64
    s_cselect_b32 s39, 32, 4
    s_lshl_b32 s36, s36, 8
    s_lshl_b32 s37, s37, 8
    s_lshl_b32 s39, s39, 8
    s_mov_b32 s46, s38
    s_add_u32 s47, s46, s39
    s_add_u32 s48, s47, s39
    s_add_u32 s49, s48, s39
    s_cmp_eq_u32 s30, 0
    s_cselect_b32 s50, 0xffff, s51
    s_cselect_b32 s52, 4, 0
    v_lshlrev_b32 v58, 4, v1
    v_add_u32 v59, s36, v58
    v_add_u32 v60, s37, v58
    v_add_u32 v61, s36, v60
    v_mov_b32 v192, 0
    v_mov_b32 v193, 0
    v_mov_b32 v194, 0
    v_mov_b32 v195, 0
    v_mov_b32 v196, 0
    v_mov_b32 v197, 0
    v_mov_b32 v198, 0
    v_mov_b32 v199, 0
    v_mov_b32 v200, 0
    v_mov_b32 v201, 0
    v_mov_b32 v202, 0
    v_mov_b32 v203, 0
    v_mov_b32 v204, 0
    v_mov_b32 v205, 0
    v_mov_b32 v206, 0
    v_mov_b32 v207, 0
    v_mov_b32 v208, 0
    v_mov_b32 v209, 0
    v_mov_b32 v210, 0
    v_mov_b32 v211, 0
    v_mov_b32 v212, 0
    v_mov_b32 v213, 0
    v_mov_b32 v214, 0
    v_mov_b32 v215, 0
    v_mov_b32 v216, 0
    v_mov_b32 v217, 0
    v_mov_b32 v218, 0
    v_mov_b32 v219, 0
    v_mov_b32 v220, 0
    v_mov_b32 v221, 0
    v_mov_b32 v222, 0
    v_mov_b32 v223, 0
    v_mov_b32 v224, 0
    v_mov_b32 v225, 0
    v_mov_b32 v226, 0
    v_mov_b32 v227, 0
    v_mov_b32 v228, 0
    v_mov_b32 v229, 0
    v_mov_b32 v230, 0
    v_mov_b32 v231, 0
    v_mov_b32 v232, 0
    v_mov_b32 v233, 0
    v_mov_b32 v234, 0
    v_mov_b32 v235, 0
    v_mov_b32 v236, 0
    v_mov_b32 v237, 0
    v_mov_b32 v238, 0
    v_mov_b32 v239, 0
    v_mov_b32 v240, 0
    v_mov_b32 v241, 0
    v_mov_b32 v242, 0
    v_mov_b32 v243, 0
    v_mov_b32 v244, 0
    v_mov_b32 v245, 0
    v_mov_b32 v246, 0
    v_mov_b32 v247, 0
    v_mov_b32 v248, 0
    v_mov_b32 v249, 0
    v_mov_b32 v250, 0
    v_mov_b32 v251, 0
    v_mov_b32 v252, 0
    v_mov_b32 v253, 0
    v_mov_b32 v254, 0
    v_mov_b32 v255, 0
    s_mov_b32 s35, 0
    s_waitcnt vmcnt(6)
    .p2align 6
L_p2_loop:
    s_cmp_ge_u32 s35, 2
    s_cbranch_scc1 L_recurrent_scan__compressed_kv_cla__moe_arch_mod__prompt_kernel_rare_61
L_recurrent_scan__compressed_kv_cla__moe_arch_mod__prompt_kernel_back_62:
    s_waitcnt lgkmcnt(8)
    v_mfma_f32_16x16x32_bf16 v[192:195], v[24:27], v[64:67], v[192:195]
    ds_read_b64_tr_b16 v[48:49], v16 offset:0
    v_mfma_f32_16x16x32_bf16 v[224:227], v[24:27], v[68:71], v[224:227]
    ds_read_b64_tr_b16 v[50:51], v16 offset:1024
    v_mfma_f32_16x16x32_bf16 v[196:199], v[28:31], v[64:67], v[196:199]
    ds_read_b64_tr_b16 v[52:53], v17 offset:0
    buffer_load_dwordx4 v[120:123], v6, s[8:11], s32 offen offset:3072 sc1
    v_mfma_f32_16x16x32_bf16 v[228:231], v[28:31], v[68:71], v[228:231]
    ds_read_b64_tr_b16 v[54:55], v17 offset:1024
    s_waitcnt lgkmcnt(8)
    v_mfma_f32_16x16x32_bf16 v[200:203], v[32:35], v[64:67], v[200:203]
    ds_read_b64_tr_b16 v[24:25], v10 offset:8192
    v_mfma_f32_16x16x32_bf16 v[232:235], v[32:35], v[68:71], v[232:235]
    ds_read_b64_tr_b16 v[26:27], v10 offset:9216
    v_mfma_f32_16x16x32_bf16 v[204:207], v[36:39], v[64:67], v[204:207]
    ds_read_b64_tr_b16 v[28:29], v11 offset:8192
    buffer_load_dwordx4 v[124:127], v7, s[8:11], s32 offen offset:3072 sc1
    v_mfma_f32_16x16x32_bf16 v[236:239], v[36:39], v[68:71], v[236:239]
    ds_read_b64_tr_b16 v[30:31], v11 offset:9216
    s_add_u32 s32, s32, 4096
    s_waitcnt lgkmcnt(8)
    v_mfma_f32_16x16x32_bf16 v[208:211], v[40:43], v[64:67], v[208:211]
    ds_read_b64_tr_b16 v[32:33], v12 offset:8192
    s_cmp_lt_u32 s35, 3
    s_cselect_b32 s10, 4194304, 0
    v_mfma_f32_16x16x32_bf16 v[240:243], v[40:43], v[68:71], v[240:243]
    ds_read_b64_tr_b16 v[34:35], v12 offset:9216
    s_bitcmp1_b32 s50, 0
    s_cbranch_scc1 L_recurrent_scan__compressed_kv_cla__moe_arch_mod__prompt_kernel_rare_75
L_recurrent_scan__compressed_kv_cla__moe_arch_mod__prompt_kernel_back_76:
    v_mfma_f32_16x16x32_bf16 v[212:215], v[44:47], v[64:67], v[212:215]
    ds_read_b64_tr_b16 v[36:37], v13 offset:8192
    v_mfma_f32_16x16x32_bf16 v[244:247], v[44:47], v[68:71], v[244:247]
    ds_read_b64_tr_b16 v[38:39], v13 offset:9216
    s_waitcnt lgkmcnt(8)
    v_mfma_f32_16x16x32_bf16 v[216:219], v[48:51], v[64:67], v[216:219]
    ds_read_b64_tr_b16 v[40:41], v14 offset:8192
    v_mfma_f32_16x16x32_bf16 v[248:251], v[48:51], v[68:71], v[248:251]
    ds_read_b64_tr_b16 v[42:43], v14 offset:9216
    s_bitcmp1_b32 s50, 2
    s_cbranch_scc1 L_recurrent_scan__compressed_kv_cla__moe_arch_mod__prompt_kernel_rare_87
L_recurrent_scan__compressed_kv_cla__moe_arch_mod__prompt_kernel_back_88:
    v_mfma_f32_16x16x32_bf16 v[220:223], v[52:55], v[64:67], v[220:223]
    ds_read_b64_tr_b16 v[44:45], v15 offset:8192
    v_mfma_f32_16x16x32_bf16 v[252:255], v[52:55], v[68:71], v[252:255]
    ds_read_b64_tr_b16 v[46:47], v15 offset:9216
    s_waitcnt lgkmcnt(8)
    v_mfma_f32_16x16x32_bf16 v[192:195], v[24:27], v[72:75], v[192:195]
    ds_read_b64_tr_b16 v[48:49], v16 offset:8192
    v_mfma_f32_16x16x32_bf16 v[224:227], v[24:27], v[76:79], v[224:227]
    ds_read_b64_tr_b16 v[50:51], v16 offset:9216
    v_mfma_f32_16x16x32_bf16 v[196:199], v[28:31], v[72:75], v[196:199]
    ds_read_b64_tr_b16 v[52:53], v17 offset:8192
    buffer_load_dwordx4 v[64:67], v6, s[8:11], s32 offen offset:0 sc1
    v_mfma_f32_16x16x32_bf16 v[228:231], v[28:31], v[76:79], v[228:231]
    ds_read_b64_tr_b16 v[54:55], v17 offset:9216
    s_waitcnt lgkmcnt(8)
    v_mfma_f32_16x16x32_bf16 v[200:203], v[32:35], v[72:75], v[200:203]
    ds_read_b64_tr_b16 v[24:25], v10 offset:16384
    v_mfma_f32_16x16x32_bf16 v[232:235], v[32:35], v[76:79], v[232:235]
    ds_read_b64_tr_b16 v[26:27], v10 offset:17408
    v_mfma_f32_16x16x32_bf16 v[204:207], v[36:39], v[72:75], v[204:207]
    ds_read_b64_tr_b16 v[28:29], v11 offset:16384
    buffer_load_dwordx4 v[68:71], v7, s[8:11], s32 offen offset:0 sc1
    v_mfma_f32_16x16x32_bf16 v[236:239], v[36:39], v[76:79], v[236:239]
    ds_read_b64_tr_b16 v[30:31], v11 offset:17408
    s_waitcnt lgkmcnt(8)
    v_mfma_f32_16x16x32_bf16 v[208:211], v[40:43], v[72:75], v[208:211]
    ds_read_b64_tr_b16 v[32:33], v12 offset:16384
    v_mfma_f32_16x16x32_bf16 v[240:243], v[40:43], v[76:79], v[240:243]
    ds_read_b64_tr_b16 v[34:35], v12 offset:17408
    v_mfma_f32_16x16x32_bf16 v[212:215], v[44:47], v[72:75], v[212:215]
    ds_read_b64_tr_b16 v[36:37], v13 offset:16384
    v_mfma_f32_16x16x32_bf16 v[244:247], v[44:47], v[76:79], v[244:247]
    ds_read_b64_tr_b16 v[38:39], v13 offset:17408
    s_bitcmp1_b32 s50, 1
    s_cbranch_scc1 L_recurrent_scan__compressed_kv_cla__moe_arch_mod__prompt_kernel_rare_79
L_recurrent_scan__compressed_kv_cla__moe_arch_mod__prompt_kernel_back_80:
    s_waitcnt lgkmcnt(8)
    v_mfma_f32_16x16x32_bf16 v[216:219], v[48:51], v[72:75], v[216:219]
    ds_read_b64_tr_b16 v[40:41], v14 offset:16384
    v_mfma_f32_16x16x32_bf16 v[248:251], v[48:51], v[76:79], v[248:251]
    ds_read_b64_tr_b16 v[42:43], v14 offset:17408
    v_mfma_f32_16x16x32_bf16 v[220:223], v[52:55], v[72:75], v[220:223]
    ds_read_b64_tr_b16 v[44:45], v15 offset:16384
    v_mfma_f32_16x16x32_bf16 v[252:255], v[52:55], v[76:79], v[252:255]
    ds_read_b64_tr_b16 v[46:47], v15 offset:17408
    s_bitcmp1_b32 s50, 3
    s_cbranch_scc1 L_recurrent_scan__compressed_kv_cla__moe_arch_mod__prompt_kernel_rare_91
L_recurrent_scan__compressed_kv_cla__moe_arch_mod__prompt_kernel_back_92:
    s_waitcnt lgkmcnt(8)
    v_mfma_f32_16x16x32_bf16 v[192:195], v[24:27], v[80:83], v[192:195]
    ds_read_b64_tr_b16 v[48:49], v16 offset:16384
    v_mfma_f32_16x16x32_bf16 v[224:227], v[24:27], v[84:87], v[224:227]
    ds_read_b64_tr_b16 v[50:51], v16 offset:17408
    v_mfma_f32_16x16x32_bf16 v[196:199], v[28:31], v[80:83], v[196:199]
    ds_read_b64_tr_b16 v[52:53], v17 offset:16384
    buffer_load_dwordx4 v[72:75], v6, s[8:11], s32 offen offset:1024 sc1
    v_mfma_f32_16x16x32_bf16 v[228:231], v[28:31], v[84:87], v[228:231]
    ds_read_b64_tr_b16 v[54:55], v17 offset:17408
    s_waitcnt lgkmcnt(8)
    v_mfma_f32_16x16x32_bf16 v[200:203], v[32:35], v[80:83], v[200:203]
    ds_read_b64_tr_b16 v[24:25], v10 offset:24576
    v_mfma_f32_16x16x32_bf16 v[232:235], v[32:35], v[84:87], v[232:235]
    ds_read_b64_tr_b16 v[26:27], v10 offset:25600
    v_mfma_f32_16x16x32_bf16 v[204:207], v[36:39], v[80:83], v[204:207]
    ds_read_b64_tr_b16 v[28:29], v11 offset:24576
    buffer_load_dwordx4 v[76:79], v7, s[8:11], s32 offen offset:1024 sc1
    v_mfma_f32_16x16x32_bf16 v[236:239], v[36:39], v[84:87], v[236:239]
    ds_read_b64_tr_b16 v[30:31], v11 offset:25600
    s_waitcnt lgkmcnt(8)
    v_mfma_f32_16x16x32_bf16 v[208:211], v[40:43], v[80:83], v[208:211]
    ds_read_b64_tr_b16 v[32:33], v12 offset:24576
    v_mfma_f32_16x16x32_bf16 v[240:243], v[40:43], v[84:87], v[240:243]
    ds_read_b64_tr_b16 v[34:35], v12 offset:25600
    v_mfma_f32_16x16x32_bf16 v[212:215], v[44:47], v[80:83], v[212:215]
    ds_read_b64_tr_b16 v[36:37], v13 offset:24576
    v_mfma_f32_16x16x32_bf16 v[244:247], v[44:47], v[84:87], v[244:247]
    ds_read_b64_tr_b16 v[38:39], v13 offset:25600
    s_waitcnt lgkmcnt(8)
    v_mfma_f32_16x16x32_bf16 v[216:219], v[48:51], v[80:83], v[216:219]
    ds_read_b64_tr_b16 v[40:41], v14 offset:24576
    v_mfma_f32_16x16x32_bf16 v[248:251], v[48:51], v[84:87], v[248:251]
    ds_read_b64_tr_b16 v[42:43], v14 offset:25600
    v_mfma_f32_16x16x32_bf16 v[220:223], v[52:55], v[80:83], v[220:223]
    ds_read_b64_tr_b16 v[44:45], v15 offset:24576
    v_mfma_f32_16x16x32_bf16 v[252:255], v[52:55], v[84:87], v[252:255]
    ds_read_b64_tr_b16 v[46:47], v15 offset:25600
    s_waitcnt lgkmcnt(8)
    s_waitcnt vmcnt(16)
    v_mfma_f32_16x16x32_bf16 v[192:195], v[24:27], v[88:91], v[192:195]
    ds_read_b64_tr_b16 v[48:49], v16 offset:24576
    v_mfma_f32_16x16x32_bf16 v[224:227], v[24:27], v[92:95], v[224:227]
    ds_read_b64_tr_b16 v[50:51], v16 offset:25600
    v_mfma_f32_16x16x32_bf16 v[196:199], v[28:31], v[88:91], v[196:199]
    ds_read_b64_tr_b16 v[52:53], v17 offset:24576
    buffer_load_dwordx4 v[80:83], v6, s[8:11], s32 offen offset:2048 sc1
    v_mfma_f32_16x16x32_bf16 v[228:231], v[28:31], v[92:95], v[228:231]
    ds_read_b64_tr_b16 v[54:55], v17 offset:25600
    s_waitcnt lgkmcnt(8)
    v_mfma_f32_16x16x32_bf16 v[200:203], v[32:35], v[88:91], v[200:203]
    v_mfma_f32_16x16x32_bf16 v[232:235], v[32:35], v[92:95], v[232:235]
    v_mfma_f32_16x16x32_bf16 v[204:207], v[36:39], v[88:91], v[204:207]
    buffer_load_dwordx4 v[84:87], v7, s[8:11], s32 offen offset:2048 sc1
    v_mfma_f32_16x16x32_bf16 v[236:239], v[36:39], v[92:95], v[236:239]
    s_cmp_ge_u32 s35, 2
    s_cbranch_scc1 L_recurrent_scan__compressed_kv_cla__moe_arch_mod__prompt_kernel_rare_51
L_recurrent_scan__compressed_kv_cla__moe_arch_mod__prompt_kernel_back_52:
    s_waitcnt lgkmcnt(0)
    s_waitcnt vmcnt(8)
    s_barrier
    v_mfma_f32_16x16x32_bf16 v[208:211], v[40:43], v[88:91], v[208:211]
    ds_read_b64_tr_b16 v[24:25], v10 offset:32768
    ds_read_b64_tr_b16 v[26:27], v10 offset:33792
    v_mfma_f32_16x16x32_bf16 v[240:243], v[40:43], v[92:95], v[240:243]
    ds_read_b64_tr_b16 v[28:29], v11 offset:32768
    ds_read_b64_tr_b16 v[30:31], v11 offset:33792
    v_mfma_f32_16x16x32_bf16 v[212:215], v[44:47], v[88:91], v[212:215]
    ds_read_b64_tr_b16 v[32:33], v12 offset:32768
    ds_read_b64_tr_b16 v[34:35], v12 offset:33792
    v_mfma_f32_16x16x32_bf16 v[244:247], v[44:47], v[92:95], v[244:247]
    ds_read_b64_tr_b16 v[36:37], v13 offset:32768
    ds_read_b64_tr_b16 v[38:39], v13 offset:33792
    s_add_u32 m0, s33, 0
    v_mfma_f32_16x16x32_bf16 v[216:219], v[48:51], v[88:91], v[216:219]
    ds_read_b64_tr_b16 v[40:41], v14 offset:32768
    ds_read_b64_tr_b16 v[42:43], v14 offset:33792
    buffer_load_dwordx4 v2, s[4:7], s31 offen offset:0 sc1 lds
    v_mfma_f32_16x16x32_bf16 v[248:251], v[48:51], v[92:95], v[248:251]
    buffer_load_dwordx4 v3, s[4:7], s31 offen offset:1024 sc1 lds
    v_mfma_f32_16x16x32_bf16 v[220:223], v[52:55], v[88:91], v[220:223]
    ds_read_b64_tr_b16 v[44:45], v15 offset:32768
    ds_read_b64_tr_b16 v[46:47], v15 offset:33792
    buffer_load_dwordx4 v4, s[4:7], s31 offen offset:2048 sc1 lds
    v_mfma_f32_16x16x32_bf16 v[252:255], v[52:55], v[92:95], v[252:255]
    buffer_load_dwordx4 v5, s[4:7], s31 offen offset:3072 sc1 lds
    s_add_u32 s31, s31, s40
    s_cmp_ge_u32 s35, 2
    s_cbranch_scc1 L_recurrent_scan__compressed_kv_cla__moe_arch_mod__prompt_kernel_rare_67
L_recurrent_scan__compressed_kv_cla__moe_arch_mod__prompt_kernel_back_68:
    s_waitcnt lgkmcnt(8)
    s_waitcnt vmcnt(18)
    v_mfma_f32_16x16x32_bf16 v[192:195], v[24:27], v[96:99], v[192:195]
    ds_read_b64_tr_b16 v[48:49], v16 offset:32768
    v_mfma_f32_16x16x32_bf16 v[224:227], v[24:27], v[100:103], v[224:227]
    ds_read_b64_tr_b16 v[50:51], v16 offset:33792
    v_mfma_f32_16x16x32_bf16 v[196:199], v[28:31], v[96:99], v[196:199]
    ds_read_b64_tr_b16 v[52:53], v17 offset:32768
    buffer_load_dwordx4 v[88:91], v6, s[8:11], s32 offen offset:3072 sc1
    v_mfma_f32_16x16x32_bf16 v[228:231], v[28:31], v[100:103], v[228:231]
    ds_read_b64_tr_b16 v[54:55], v17 offset:33792
    s_waitcnt lgkmcnt(8)
    v_mfma_f32_16x16x32_bf16 v[200:203], v[32:35], v[96:99], v[200:203]
    ds_read_b64_tr_b16 v[24:25], v10 offset:40960
    v_mfma_f32_16x16x32_bf16 v[232:235], v[32:35], v[100:103], v[232:235]
    ds_read_b64_tr_b16 v[26:27], v10 offset:41984
    v_mfma_f32_16x16x32_bf16 v[204:207], v[36:39], v[96:99], v[204:207]
    ds_read_b64_tr_b16 v[28:29], v11 offset:40960
    buffer_load_dwordx4 v[92:95], v7, s[8:11], s32 offen offset:3072 sc1
    v_mfma_f32_16x16x32_bf16 v[236:239], v[36:39], v[100:103], v[236:239]
    ds_read_b64_tr_b16 v[30:31], v11 offset:41984
    s_add_u32 s32, s32, 4096
    s_waitcnt lgkmcnt(8)
    v_mfma_f32_16x16x32_bf16 v[208:211], v[40:43], v[96:99], v[208:211]
    ds_read_b64_tr_b16 v[32:33], v12 offset:40960
    v_mfma_f32_16x16x32_bf16 v[240:243], v[40:43], v[100:103], v[240:243]
    ds_read_b64_tr_b16 v[34:35], v12 offset:41984
    s_bitcmp1_b32 s50, 4
    s_cbranch_scc1 L_recurrent_scan__compressed_kv_cla__moe_arch_mod__prompt_kernel_rare_99
L_recurrent_scan__compressed_kv_cla__moe_arch_mod__prompt_kernel_back_100:
    v_mfma_f32_16x16x32_bf16 v[212:215], v[44:47], v[96:99], v[212:215]
    ds_read_b64_tr_b16 v[36:37], v13 offset:40960
    v_mfma_f32_16x16x32_bf16 v[244:247], v[44:47], v[100:103], v[244:247]
    ds_read_b64_tr_b16 v[38:39], v13 offset:41984
    s_waitcnt lgkmcnt(8)
    v_mfma_f32_16x16x32_bf16 v[216:219], v[48:51], v[96:99], v[216:219]
    ds_read_b64_tr_b16 v[40:41], v14 offset:40960
    v_mfma_f32_16x16x32_bf16 v[248:251], v[48:51], v[100:103], v[248:251]
    ds_read_b64_tr_b16 v[42:43], v14 offset:41984
    s_bitcmp1_b32 s50, 6
    s_cbranch_scc1 L_recurrent_scan__compressed_kv_cla__moe_arch_mod__prompt_kernel_rare_111
L_recurrent_scan__compressed_kv_cla__moe_arch_mod__prompt_kernel_back_112:
    v_mfma_f32_16x16x32_bf16 v[220:223], v[52:55], v[96:99], v[220:223]
    ds_read_b64_tr_b16 v[44:45], v15 offset:40960
    v_mfma_f32_16x16x32_bf16 v[252:255], v[52:55], v[100:103], v[252:255]
    ds_read_b64_tr_b16 v[46:47], v15 offset:41984
    s_waitcnt lgkmcnt(8)
    s_waitcnt vmcnt(20)
    v_mfma_f32_16x16x32_bf16 v[192:195], v[24:27], v[104:107], v[192:195]
    ds_read_b64_tr_b16 v[48:49], v16 offset:40960
    v_mfma_f32_16x16x32_bf16 v[224:227], v[24:27], v[108:111], v[224:227]
    ds_read_b64_tr_b16 v[50:51], v16 offset:41984
    v_mfma_f32_16x16x32_bf16 v[196:199], v[28:31], v[104:107], v[196:199]
    ds_read_b64_tr_b16 v[52:53], v17 offset:40960
    buffer_load_dwordx4 v[96:99], v6, s[8:11], s32 offen offset:0 sc1
    v_mfma_f32_16x16x32_bf16 v[228:231], v[28:31], v[108:111], v[228:231]
    ds_read_b64_tr_b16 v[54:55], v17 offset:41984
    s_waitcnt lgkmcnt(8)
    v_mfma_f32_16x16x32_bf16 v[200:203], v[32:35], v[104:107], v[200:203]
    ds_read_b64_tr_b16 v[24:25], v10 offset:49152
    v_mfma_f32_16x16x32_bf16 v[232:235], v[32:35], v[108:111], v[232:235]
    ds_read_b64_tr_b16 v[26:27], v10 offset:50176
    v_mfma_f32_16x16x32_bf16 v[204:207], v[36:39], v[104:107], v[204:207]
    ds_read_b64_tr_b16 v[28:29], v11 offset:49152
    buffer_load_dwordx4 v[100:103], v7, s[8:11], s32 offen offset:0 sc1
    v_mfma_f32_16x16x32_bf16 v[236:239], v[36:39], v[108:111], v[236:239]
    ds_read_b64_tr_b16 v[30:31], v11 offset:50176
    s_waitcnt lgkmcnt(8)
    v_mfma_f32_16x16x32_bf16 v[208:211], v[40:43], v[104:107], v[208:211]
    ds_read_b64_tr_b16 v[32:33], v12 offset:49152
    v_mfma_f32_16x16x32_bf16 v[240:243], v[40:43], v[108:111], v[240:243]
    ds_read_b64_tr_b16 v[34:35], v12 offset:50176
    v_mfma_f32_16x16x32_bf16 v[212:215], v[44:47], v[104:107], v[212:215]
    ds_read_b64_tr_b16 v[36:37], v13 offset:49152
    v_mfma_f32_16x16x32_bf16 v[244:247], v[44:47], v[108:111], v[244:247]
    ds_read_b64_tr_b16 v[38:39], v13 offset:50176
    s_bitcmp1_b32 s50, 5
    s_cbranch_scc1 L_recurrent_scan__compressed_kv_cla__moe_arch_mod__prompt_kernel_rare_103
L_recurrent_scan__compressed_kv_cla__moe_arch_mod__prompt_kernel_back_104:
    s_waitcnt lgkmcnt(8)
    v_mfma_f32_16x16x32_bf16 v[216:219], v[48:51], v[104:107], v[216:219]
    ds_read_b64_tr_b16 v[40:41], v14 offset:49152
    v_mfma_f32_16x16x32_bf16 v[248:251], v[48:51], v[108:111], v[248:251]
    ds_read_b64_tr_b16 v[42:43], v14 offset:50176
    v_mfma_f32_16x16x32_bf16 v[220:223], v[52:55], v[104:107], v[220:223]
    ds_read_b64_tr_b16 v[44:45], v15 offset:49152
    v_mfma_f32_16x16x32_bf16 v[252:255], v[52:55], v[108:111], v[252:255]
    ds_read_b64_tr_b16 v[46:47], v15 offset:50176
    s_bitcmp1_b32 s50, 7
    s_cbranch_scc1 L_recurrent_scan__compressed_kv_cla__moe_arch_mod__prompt_kernel_rare_115
L_recurrent_scan__compressed_kv_cla__moe_arch_mod__prompt_kernel_back_116:
    s_waitcnt lgkmcnt(8)
    s_waitcnt vmcnt(20)
    v_mfma_f32_16x16x32_bf16 v[192:195], v[24:27], v[112:115], v[192:195]
    ds_read_b64_tr_b16 v[48:49], v16 offset:49152
    v_mfma_f32_16x16x32_bf16 v[224:227], v[24:27], v[116:119], v[224:227]
    ds_read_b64_tr_b16 v[50:51], v16 offset:50176
    v_mfma_f32_16x16x32_bf16 v[196:199], v[28:31], v[112:115], v[196:199]
    ds_read_b64_tr_b16 v[52:53], v17 offset:49152
    buffer_load_dwordx4 v[104:107], v6, s[8:11], s32 offen offset:1024 sc1
    v_mfma_f32_16x16x32_bf16 v[228:231], v[28:31], v[116:119], v[228:231]
    ds_read_b64_tr_b16 v[54:55], v17 offset:50176
    s_waitcnt lgkmcnt(8)
    v_mfma_f32_16x16x32_bf16 v[200:203], v[32:35], v[112:115], v[200:203]
    ds_read_b64_tr_b16 v[24:25], v10 offset:57344
    v_mfma_f32_16x16x32_bf16 v[232:235], v[32:35], v[116:119], v[232:235]
    ds_read_b64_tr_b16 v[26:27], v10 offset:58368
    v_mfma_f32_16x16x32_bf16 v[204:207], v[36:39], v[112:115], v[204:207]
    ds_read_b64_tr_b16 v[28:29], v11 offset:57344
    buffer_load_dwordx4 v[108:111], v7, s[8:11], s32 offen offset:1024 sc1
    v_mfma_f32_16x16x32_bf16 v[236:239], v[36:39], v[116:119], v[236:239]
    ds_read_b64_tr_b16 v[30:31], v11 offset:58368
    s_waitcnt lgkmcnt(8)
    v_mfma_f32_16x16x32_bf16 v[208:211], v[40:43], v[112:115], v[208:211]
    ds_read_b64_tr_b16 v[32:33], v12 offset:57344
    v_mfma_f32_16x16x32_bf16 v[240:243], v[40:43], v[116:119], v[240:243]
    ds_read_b64_tr_b16 v[34:35], v12 offset:58368
    v_mfma_f32_16x16x32_bf16 v[212:215], v[44:47], v[112:115], v[212:215]
    ds_read_b64_tr_b16 v[36:37], v13 offset:57344
    v_mfma_f32_16x16x32_bf16 v[244:247], v[44:47], v[116:119], v[244:247]
    ds_read_b64_tr_b16 v[38:39], v13 offset:58368
    s_waitcnt lgkmcnt(8)
    v_mfma_f32_16x16x32_bf16 v[216:219], v[48:51], v[112:115], v[216:219]
    ds_read_b64_tr_b16 v[40:41], v14 offset:57344
    v_mfma_f32_16x16x32_bf16 v[248:251], v[48:51], v[116:119], v[248:251]
    ds_read_b64_tr_b16 v[42:43], v14 offset:58368
    v_mfma_f32_16x16x32_bf16 v[220:223], v[52:55], v[112:115], v[220:223]
    ds_read_b64_tr_b16 v[44:45], v15 offset:57344
    v_mfma_f32_16x16x32_bf16 v[252:255], v[52:55], v[116:119], v[252:255]
    ds_read_b64_tr_b16 v[46:47], v15 offset:58368
    s_waitcnt lgkmcnt(8)
    s_waitcnt vmcnt(18)
    v_mfma_f32_16x16x32_bf16 v[192:195], v[24:27], v[120:123], v[192:195]
    ds_read_b64_tr_b16 v[48:49], v16 offset:57344
    v_mfma_f32_16x16x32_bf16 v[224:227], v[24:27], v[124:127], v[224:227]
    ds_read_b64_tr_b16 v[50:51], v16 offset:58368
    v_mfma_f32_16x16x32_bf16 v[196:199], v[28:31], v[120:123], v[196:199]
    ds_read_b64_tr_b16 v[52:53], v17 offset:57344
    buffer_load_dwordx4 v[112:115], v6, s[8:11], s32 offen offset:2048 sc1
    v_mfma_f32_16x16x32_bf16 v[228:231], v[28:31], v[124:127], v[228:231]
    ds_read_b64_tr_b16 v[54:55], v17 offset:58368
    s_waitcnt lgkmcnt(8)
    v_mfma_f32_16x16x32_bf16 v[200:203], v[32:35], v[120:123], v[200:203]
    v_mfma_f32_16x16x32_bf16 v[232:235], v[32:35], v[124:127], v[232:235]
    v_mfma_f32_16x16x32_bf16 v[204:207], v[36:39], v[120:123], v[204:207]
    buffer_load_dwordx4 v[116:119], v7, s[8:11], s32 offen offset:2048 sc1
    v_mfma_f32_16x16x32_bf16 v[236:239], v[36:39], v[124:127], v[236:239]
    s_cmp_ge_u32 s35, 2
    s_cbranch_scc1 L_recurrent_scan__compressed_kv_cla__moe_arch_mod__prompt_kernel_rare_56
L_recurrent_scan__compressed_kv_cla__moe_arch_mod__prompt_kernel_back_57:
    s_waitcnt lgkmcnt(0)
    s_waitcnt vmcnt(10)
    s_barrier
    v_mfma_f32_16x16x32_bf16 v[208:211], v[40:43], v[120:123], v[208:211]
    ds_read_b64_tr_b16 v[24:25], v10 offset:0
    ds_read_b64_tr_b16 v[26:27], v10 offset:1024
    v_mfma_f32_16x16x32_bf16 v[240:243], v[40:43], v[124:127], v[240:243]
    ds_read_b64_tr_b16 v[28:29], v11 offset:0
    ds_read_b64_tr_b16 v[30:31], v11 offset:1024
    v_mfma_f32_16x16x32_bf16 v[212:215], v[44:47], v[120:123], v[212:215]
    ds_read_b64_tr_b16 v[32:33], v12 offset:0
    ds_read_b64_tr_b16 v[34:35], v12 offset:1024
    v_mfma_f32_16x16x32_bf16 v[244:247], v[44:47], v[124:127], v[244:247]
    ds_read_b64_tr_b16 v[36:37], v13 offset:0
    ds_read_b64_tr_b16 v[38:39], v13 offset:1024
    s_add_u32 m0, s33, 32768
    v_mfma_f32_16x16x32_bf16 v[216:219], v[48:51], v[120:123], v[216:219]
    ds_read_b64_tr_b16 v[40:41], v14 offset:0
    ds_read_b64_tr_b16 v[42:43], v14 offset:1024
    buffer_load_dwordx4 v2, s[4:7], s31 offen offset:0 sc1 lds
    v_mfma_f32_16x16x32_bf16 v[248:251], v[48:51], v[124:127], v[248:251]
    buffer_load_dwordx4 v3, s[4:7], s31 offen offset:1024 sc1 lds
    v_mfma_f32_16x16x32_bf16 v[220:223], v[52:55], v[120:123], v[220:223]
    ds_read_b64_tr_b16 v[44:45], v15 offset:0
    ds_read_b64_tr_b16 v[46:47], v15 offset:1024
    buffer_load_dwordx4 v4, s[4:7], s31 offen offset:2048 sc1 lds
    v_mfma_f32_16x16x32_bf16 v[252:255], v[52:55], v[124:127], v[252:255]
    buffer_load_dwordx4 v5, s[4:7], s31 offen offset:3072 sc1 lds
    s_add_u32 s31, s31, s40
    s_lshr_b32 s50, s50, 8
    s_add_u32 s35, s35, 1
    s_cmp_lt_u32 s35, 4
    s_cbranch_scc1 L_p2_loop
    s_load_dwordx2 s[92:93], s[0:1], 40
    s_load_dwordx2 s[94:95], s[0:1], 80
    s_load_dwordx2 s[96:97], s[0:1], 0
    s_load_dwordx2 s[98:99], s[0:1], 88
    s_cmp_lt_u32 s28, 4
    s_cbranch_scc0 L_grp1
    s_mov_b32 s36, 1040356334
    s_and_b32 s37, s28, 3
    s_lshl_b32 s37, s37, 13
    v_lshlrev_b32 v7, 4, v1
    v_add_u32 v4, s37, v7
    v_add_u32 v6, 4096, v4
    v_add_u32 v19, 131072, v4
    s_mov_b32 s43, s37
    s_add_u32 s44, s37, 98304
    s_waitcnt vmcnt(4) lgkmcnt(0)
    v_mul_f32 v192, s36, v192
    v_mul_f32 v193, s36, v193
    v_mul_f32 v194, s36, v194
    v_mul_f32 v195, s36, v195
    v_mul_f32 v196, s36, v196
    v_mul_f32 v197, s36, v197
    v_mul_f32 v198, s36, v198
    v_mul_f32 v199, s36, v199
    v_cvt_pk_bf16_f32 v128, v192, v193
    v_cvt_pk_bf16_f32 v129, v194, v195
    v_cvt_pk_bf16_f32 v130, v196, v197
    v_cvt_pk_bf16_f32 v131, v198, v199
    ds_write_b128 v19, v[128:131] offset:0
    v_mul_f32 v200, s36, v200
    v_mul_f32 v201, s36, v201
    v_mul_f32 v202, s36, v202
    v_mul_f32 v203, s36, v203
    v_mul_f32 v204, s36, v204
    v_mul_f32 v205, s36, v205
    v_mul_f32 v206, s36, v206
    v_mul_f32 v207, s36, v207
    v_cvt_pk_bf16_f32 v132, v200, v201
    v_cvt_pk_bf16_f32 v133, v202, v203
    v_cvt_pk_bf16_f32 v134, v204, v205
    v_cvt_pk_bf16_f32 v135, v206, v207
    ds_write_b128 v19, v[132:135] offset:1024
    v_mul_f32 v208, s36, v208
    v_mul_f32 v209, s36, v209
    v_mul_f32 v210, s36, v210
    v_mul_f32 v211, s36, v211
    v_mul_f32 v212, s36, v212
    v_mul_f32 v213, s36, v213
    v_mul_f32 v214, s36, v214
    v_mul_f32 v215, s36, v215
    v_cvt_pk_bf16_f32 v136, v208, v209
    v_cvt_pk_bf16_f32 v137, v210, v211
    v_cvt_pk_bf16_f32 v138, v212, v213
    v_cvt_pk_bf16_f32 v139, v214, v215
    ds_write_b128 v19, v[136:139] offset:2048
    v_mul_f32 v216, s36, v216
    v_mul_f32 v217, s36, v217
    v_mul_f32 v218, s36, v218
    v_mul_f32 v219, s36, v219
    v_mul_f32 v220, s36, v220
    v_mul_f32 v221, s36, v221
    v_mul_f32 v222, s36, v222
    v_mul_f32 v223, s36, v223
    v_cvt_pk_bf16_f32 v140, v216, v217
    v_cvt_pk_bf16_f32 v141, v218, v219
    v_cvt_pk_bf16_f32 v142, v220, v221
    v_cvt_pk_bf16_f32 v143, v222, v223
    ds_write_b128 v19, v[140:143] offset:3072
    v_mul_f32 v224, s36, v224
    v_mul_f32 v225, s36, v225
    v_mul_f32 v226, s36, v226
    v_mul_f32 v227, s36, v227
    v_mul_f32 v228, s36, v228
    v_mul_f32 v229, s36, v229
    v_mul_f32 v230, s36, v230
    v_mul_f32 v231, s36, v231
    v_cvt_pk_bf16_f32 v144, v224, v225
    v_cvt_pk_bf16_f32 v145, v226, v227
    v_cvt_pk_bf16_f32 v146, v228, v229
    v_cvt_pk_bf16_f32 v147, v230, v231
    ds_write_b128 v19, v[144:147] offset:4096
    v_mul_f32 v232, s36, v232
    v_mul_f32 v233, s36, v233
    v_mul_f32 v234, s36, v234
    v_mul_f32 v235, s36, v235
    v_mul_f32 v236, s36, v236
    v_mul_f32 v237, s36, v237
    v_mul_f32 v238, s36, v238
    v_mul_f32 v239, s36, v239
    v_cvt_pk_bf16_f32 v148, v232, v233
    v_cvt_pk_bf16_f32 v149, v234, v235
    v_cvt_pk_bf16_f32 v150, v236, v237
    v_cvt_pk_bf16_f32 v151, v238, v239
    ds_write_b128 v19, v[148:151] offset:5120
    v_mul_f32 v240, s36, v240
    v_mul_f32 v241, s36, v241
    v_mul_f32 v242, s36, v242
    v_mul_f32 v243, s36, v243
    v_mul_f32 v244, s36, v244
    v_mul_f32 v245, s36, v245
    v_mul_f32 v246, s36, v246
    v_mul_f32 v247, s36, v247
    v_cvt_pk_bf16_f32 v152, v240, v241
    v_cvt_pk_bf16_f32 v153, v242, v243
    v_cvt_pk_bf16_f32 v154, v244, v245
    v_cvt_pk_bf16_f32 v155, v246, v247
    ds_write_b128 v19, v[152:155] offset:6144
    v_mul_f32 v248, s36, v248
    v_mul_f32 v249, s36, v249
    v_mul_f32 v250, s36, v250
    v_mul_f32 v251, s36, v251
    v_mul_f32 v252, s36, v252
    v_mul_f32 v253, s36, v253
    v_mul_f32 v254, s36, v254
    v_mul_f32 v255, s36, v255
    v_cvt_pk_bf16_f32 v156, v248, v249
    v_cvt_pk_bf16_f32 v157, v250, v251
    v_cvt_pk_bf16_f32 v158, v252, v253
    v_cvt_pk_bf16_f32 v159, v254, v255
    ds_write_b128 v19, v[156:159] offset:7168
    v_mov_b32 v2, v7
    v_and_b32 v21, 15, v1
    v_lshrrev_b32 v22, 4, v1
    v_lshlrev_b32 v22, 2, v22
    v_sub_u32 v18, v21, v22
    s_mov_b32 s40, 0
    s_mov_b32 s41, 0
    s_lshl_b32 s51, s30, 1
    s_add_u32 s51, s51, 1
    s_and_b32 s36, s28, 3
    s_lshl_b32 s36, s36, 5
    s_sub_u32 s37, 15, s30
    s_lshl_b32 s37, s37, 7
    s_add_u32 s36, s36, s37
    s_sub_u32 s50, 0, s36
    s_add_u32 s36, s51, 1
    s_lshl_b32 s36, -1, s36
    s_or_b32 s48, s36, 0xaaaaaaaa
    s_and_b32 s48, s48, 0x7ffe
    s_or_b32 s39, s36, 0x55555555
    s_and_b32 s39, s39, 0xffff
    s_add_u32 s46, s45, 131072
    s_add_u32 s47, s45, 98304
    s_mov_b64 s[52:53], 0
    s_waitcnt lgkmcnt(0)
    s_barrier
    s_add_u32 s16, s54, 41943040
    s_addc_u32 s17, s55, 0
    s_and_b32 s17, s17, 0xffff
    s_mov_b32 s18, 16777216
    s_mov_b32 s19, 0x20000
    s_mov_b32 s4, s94
    s_and_b32 s5, s95, 0xffff
    s_mov_b32 s6, 7340032
    s_mov_b32 s7, 0x20000
    s_mov_b32 s8, s92
    s_and_b32 s9, s93, 0xffff
    s_mov_b32 s10, 8388608
    s_mov_b32 s11, 0x20000
    s_cmp_eq_u32 s28, 0
    s_cselect_b32 s42, 1, 63
    ds_read_b128 v[64:67], v2 offset:0
    ds_read_b128 v[68:71], v2 offset:1024
    ds_read_b128 v[72:75], v2 offset:2048
    ds_read_b128 v[76:79], v2 offset:3072
    ds_read_b128 v[80:83], v2 offset:4096
    ds_read_b128 v[84:87], v2 offset:5120
    ds_read_b128 v[88:91], v2 offset:6144
    ds_read_b128 v[92:95], v2 offset:7168
    s_waitcnt lgkmcnt(7)
    v_mfma_f32_16x16x32_bf16 v[96:99], v[64:67], v[128:131], 0
    v_mov_b32 v192, 0
    v_mov_b32 v193, 0
    v_mfma_f32_16x16x32_bf16 v[104:107], v[64:67], v[144:147], 0
    ds_read_b128 v[64:67], v2 offset:8192
    v_mov_b32 v194, 0
    v_mov_b32 v195, 0
    s_waitcnt lgkmcnt(7)
    v_mfma_f32_16x16x32_bf16 v[96:99], v[68:71], v[132:135], v[96:99]
    v_mov_b32 v196, 0
    v_mov_b32 v197, 0
    v_mfma_f32_16x16x32_bf16 v[104:107], v[68:71], v[148:151], v[104:107]
    ds_read_b128 v[68:71], v2 offset:9216
    v_mov_b32 v198, 0
    v_mov_b32 v199, 0
    s_waitcnt lgkmcnt(7)
    v_mfma_f32_16x16x32_bf16 v[96:99], v[72:75], v[136:139], v[96:99]
    v_mov_b32 v200, 0
    v_mov_b32 v201, 0
    v_mfma_f32_16x16x32_bf16 v[104:107], v[72:75], v[152:155], v[104:107]
    ds_read_b128 v[72:75], v2 offset:10240
    v_mov_b32 v202, 0
    v_mov_b32 v203, 0
    s_waitcnt lgkmcnt(7)
    v_mfma_f32_16x16x32_bf16 v[96:99], v[76:79], v[140:143], v[96:99]
    v_mov_b32 v204, 0
    v_mov_b32 v205, 0
    v_mfma_f32_16x16x32_bf16 v[104:107], v[76:79], v[156:159], v[104:107]
    ds_read_b128 v[76:79], v2 offset:11264
    v_mov_b32 v206, 0
    v_mov_b32 v207, 0
    s_waitcnt lgkmcnt(7)
    v_mfma_f32_16x16x32_bf16 v[100:103], v[80:83], v[128:131], 0
    v_mov_b32 v208, 0
    v_mov_b32 v209, 0
    v_mfma_f32_16x16x32_bf16 v[108:111], v[80:83], v[144:147], 0
    ds_read_b128 v[80:83], v2 offset:12288
    v_mov_b32 v210, 0
    v_mov_b32 v211, 0
    s_waitcnt lgkmcnt(7)
    v_mfma_f32_16x16x32_bf16 v[100:103], v[84:87], v[132:135], v[100:103]
    v_mov_b32 v212, 0
    v_mov_b32 v213, 0
    v_mfma_f32_16x16x32_bf16 v[108:111], v[84:87], v[148:151], v[108:111]
    ds_read_b128 v[84:87], v2 offset:13312
    v_mov_b32 v214, 0
    v_mov_b32 v215, 0
    s_waitcnt lgkmcnt(7)
    v_mfma_f32_16x16x32_bf16 v[100:103], v[88:91], v[136:139], v[100:103]
    v_mov_b32 v216, 0
    v_mov_b32 v217, 0
    v_mfma_f32_16x16x32_bf16 v[108:111], v[88:91], v[152:155], v[108:111]
    ds_read_b128 v[88:91], v2 offset:14336
    v_mov_b32 v218, 0
    v_mov_b32 v219, 0
    s_waitcnt lgkmcnt(7)
    v_mfma_f32_16x16x32_bf16 v[100:103], v[92:95], v[140:143], v[100:103]
    v_mov_b32 v220, 0
    v_mov_b32 v221, 0
    v_mfma_f32_16x16x32_bf16 v[108:111], v[92:95], v[156:159], v[108:111]
    ds_read_b128 v[92:95], v2 offset:15360
    v_mov_b32 v222, 0
    v_mov_b32 v223, 0
    s_waitcnt lgkmcnt(7)
    v_mfma_f32_16x16x32_bf16 v[112:115], v[64:67], v[128:131], 0
    v_mov_b32 v224, 0
    v_mov_b32 v225, 0
    v_mfma_f32_16x16x32_bf16 v[120:123], v[64:67], v[144:147], 0
    v_mov_b32 v226, 0
    v_mov_b32 v227, 0
    s_waitcnt lgkmcnt(6)
    v_mfma_f32_16x16x32_bf16 v[112:115], v[68:71], v[132:135], v[112:115]
    v_mov_b32 v228, 0
    v_mov_b32 v229, 0
    v_mfma_f32_16x16x32_bf16 v[120:123], v[68:71], v[148:151], v[120:123]
    v_mov_b32 v230, 0
    v_mov_b32 v231, 0
    s_waitcnt lgkmcnt(5)
    v_mfma_f32_16x16x32_bf16 v[112:115], v[72:75], v[136:139], v[112:115]
    v_mov_b32 v232, 0
    v_mov_b32 v233, 0
    v_mfma_f32_16x16x32_bf16 v[120:123], v[72:75], v[152:155], v[120:123]
    v_mov_b32 v234, 0
    v_mov_b32 v235, 0
    s_waitcnt lgkmcnt(4)
    v_mfma_f32_16x16x32_bf16 v[112:115], v[76:79], v[140:143], v[112:115]
    v_mov_b32 v236, 0
    v_mov_b32 v237, 0
    v_mfma_f32_16x16x32_bf16 v[120:123], v[76:79], v[156:159], v[120:123]
    v_mov_b32 v238, 0
    v_mov_b32 v239, 0
    s_waitcnt lgkmcnt(3)
    v_mfma_f32_16x16x32_bf16 v[116:119], v[80:83], v[128:131], 0
    v_mov_b32 v240, 0
    v_mov_b32 v241, 0
    v_mfma_f32_16x16x32_bf16 v[124:127], v[80:83], v[144:147], 0
    v_mov_b32 v242, 0
    v_mov_b32 v243, 0
    s_waitcnt lgkmcnt(2)
    v_mfma_f32_16x16x32_bf16 v[116:119], v[84:87], v[132:135], v[116:119]
    v_mov_b32 v244, 0
    v_mov_b32 v245, 0
    v_mfma_f32_16x16x32_bf16 v[124:127], v[84:87], v[148:151], v[124:127]
    v_mov_b32 v246, 0
    v_mov_b32 v247, 0
    s_waitcnt lgkmcnt(1)
    v_mfma_f32_16x16x32_bf16 v[116:119], v[88:91], v[136:139], v[116:119]
    v_mov_b32 v248, 0
    v_mov_b32 v249, 0
    v_mfma_f32_16x16x32_bf16 v[124:127], v[88:91], v[152:155], v[124:127]
    v_mov_b32 v250, 0
    v_mov_b32 v251, 0
    s_waitcnt lgkmcnt(0)
    v_mfma_f32_16x16x32_bf16 v[116:119], v[92:95], v[140:143], v[116:119]
    v_mov_b32 v252, 0
    v_mov_b32 v253, 0
    v_mfma_f32_16x16x32_bf16 v[124:127], v[92:95], v[156:159], v[124:127]
    v_mov_b32 v254, 0
    v_mov_b32 v255, 0
    v_mov_b32 v38, 0
    v_mov_b32 v39, 0
    s_cmp_lt_i32 s50, 0
    s_cbranch_scc0 L_recurrent_scan__compressed_kv_cla__moe_arch_mod__prompt_kernel_rare_117
L_recurrent_scan__compressed_kv_cla__moe_arch_mod__prompt_kernel_back_118:
    s_add_u32 s49, s50, 32
    v_add_u32 v24, 65536, v2
    s_cmp_le_u32 s40, s51
    s_cselect_b32 s36, 64, 128
    s_add_u32 s41, s41, s36
    s_add_u32 s50, s50, s36
    s_and_b32 s36, s41, 0xff
    v_lshl_add_u32 v2, s36, 8, v7
    s_cmp_eq_u32 s40, 16
    s_cselect_b64 s[20:21], -1, 0
    v_cndmask_b32 v5, v2, v24, s[20:21]
    v_mov_b32 v3, v24
    s_waitcnt vmcnt(0)
    s_barrier
    v_and_b32 v29, 31, v1
    s_lshr_b32 s36, s2, 4
    s_mul_i32 s36, s36, 224
    s_min_u32 s37, s28, 6
    s_lshl_b32 s37, s37, 5
    s_add_u32 s36, s36, s37
    v_add_u32 v26, s36, v29
    v_lshlrev_b32 v26, 11, v26
    s_and_b32 s37, s2, 15
    s_lshl_b32 s37, s37, 7
    v_add_u32 v26, s37, v26
    s_lshl_b32 s36, s2, 15
    s_lshl_b32 s37, s28, 12
    s_add_u32 s36, s36, s37
    v_lshl_add_u32 v27, v29, 7, s36
    v_cmp_lt_u32 vcc, 31, v1
    v_mov_b32 v28, s94
    v_mov_b32 v29, s92
    v_cndmask_b32 v26, v26, v27, vcc
    v_cndmask_b32 v28, v28, v29, vcc
    v_mov_b32 v27, s95
    v_mov_b32 v29, s93
    v_cndmask_b32 v27, v27, v29, vcc
    v_add_co_u32 v26, vcc, v28, v26
    s_nop 1
    v_addc_co_u32 v27, vcc, 0, v27, vcc
    global_load_dword v10, v[26:27], off
    s_cmp_eq_u32 s28, 0
    s_cbranch_scc1 L_recurrent_scan__compressed_kv_cla__moe_arch_mod__prompt_kernel_rare_119
L_recurrent_scan__compressed_kv_cla__moe_arch_mod__prompt_kernel_back_120:
    ds_read_b128 v[64:67], v5 offset:0
    ds_read_b128 v[68:71], v5 offset:1024
    ds_read_b128 v[72:75], v5 offset:2048
    ds_read_b128 v[76:79], v5 offset:3072
    ds_read_b128 v[80:83], v5 offset:4096
    ds_read_b128 v[84:87], v5 offset:5120
    ds_read_b128 v[88:91], v5 offset:6144
    v_max3_f32 v21, v96, v97, v98
    v_max3_f32 v21, v21, v99, v100
    v_max3_f32 v21, v21, v101, v102
    v_max_f32 v21, v21, v103
    v_max3_f32 v22, v104, v105, v106
    v_max3_f32 v22, v22, v107, v108
    v_max3_f32 v22, v22, v109, v110
    v_max_f32 v22, v22, v111
    v_mov_b32 v23, v21
    s_nop 1
    v_permlane16_swap_b32 v21, v23
    s_nop 1
    v_max_f32 v21, v21, v23
    v_mov_b32 v23, v21
    s_nop 1
    v_permlane32_swap_b32 v21, v23
    s_nop 1
    v_max_f32 v21, v21, v23
    v_mov_b32 v23, v22
    s_nop 1
    v_permlane16_swap_b32 v22, v23
    s_nop 1
    v_max_f32 v22, v22, v23
    v_mov_b32 v23, v22
    s_nop 1
    v_permlane32_swap_b32 v22, v23
    s_nop 1
    v_max_f32 v22, v22, v23
    v_sub_f32 v40, 0, v21
    v_sub_f32 v41, 0, v21
    v_sub_f32 v42, 0, v21
    v_sub_f32 v43, 0, v21
    v_sub_f32 v44, 0, v22
    v_sub_f32 v45, 0, v22
    v_sub_f32 v46, 0, v22
    v_sub_f32 v47, 0, v22
    ds_write_b128 v19, v[40:43]
    ds_write_b128 v19, v[44:47] offset:1024
    v_sub_f32 v96, v96, v21
    v_sub_f32 v97, v97, v21
    v_sub_f32 v98, v98, v21
    v_sub_f32 v99, v99, v21
    v_sub_f32 v100, v100, v21
    v_sub_f32 v101, v101, v21
    v_sub_f32 v102, v102, v21
    v_sub_f32 v103, v103, v21
    v_sub_f32 v104, v104, v22
    v_sub_f32 v105, v105, v22
    v_sub_f32 v106, v106, v22
    v_sub_f32 v107, v107, v22
    v_sub_f32 v108, v108, v22
    v_sub_f32 v109, v109, v22
    v_sub_f32 v110, v110, v22
    v_sub_f32 v111, v111, v22
    v_sub_f32 v112, v112, v21
    v_sub_f32 v113, v113, v21
    v_sub_f32 v114, v114, v21
    v_sub_f32 v115, v115, v21
    v_sub_f32 v116, v116, v21
    v_sub_f32 v117, v117, v21
    v_sub_f32 v118, v118, v21
    v_sub_f32 v119, v119, v21
    v_sub_f32 v120, v120, v22
    v_sub_f32 v121, v121, v22
    v_sub_f32 v122, v122, v22
    v_sub_f32 v123, v123, v22
    v_sub_f32 v124, v124, v22
    v_sub_f32 v125, v125, v22
    v_sub_f32 v126, v126, v22
    v_sub_f32 v127, v127, v22
    v_exp_f32 v96, v96
    v_exp_f32 v97, v97
    v_add_f32 v38, v38, v96
    v_exp_f32 v98, v98
    v_add_f32 v38, v38, v97
    v_cvt_pk_bf16_f32 v48, v96, v97
    v_exp_f32 v99, v99
    v_add_f32 v38, v38, v98
    v_exp_f32 v104, v104
    v_add_f32 v38, v38, v99
    v_cvt_pk_bf16_f32 v49, v98, v99
    v_exp_f32 v105, v105
    v_add_f32 v39, v39, v104
    v_exp_f32 v106, v106
    v_add_f32 v39, v39, v105
    v_cvt_pk_bf16_f32 v52, v104, v105
    v_exp_f32 v107, v107
    v_add_f32 v39, v39, v106
    v_exp_f32 v100, v100
    v_add_f32 v39, v39, v107
    v_cvt_pk_bf16_f32 v53, v106, v107
    v_exp_f32 v101, v101
    v_add_f32 v38, v38, v100
    v_exp_f32 v102, v102
    v_add_f32 v38, v38, v101
    v_cvt_pk_bf16_f32 v50, v100, v101
    v_exp_f32 v103, v103
    v_add_f32 v38, v38, v102
    v_exp_f32 v108, v108
    v_add_f32 v38, v38, v103
    v_cvt_pk_bf16_f32 v51, v102, v103
    v_exp_f32 v109, v109
    v_add_f32 v39, v39, v108
    v_exp_f32 v110, v110
    v_add_f32 v39, v39, v109
    v_cvt_pk_bf16_f32 v54, v108, v109
    v_exp_f32 v111, v111
    v_add_f32 v39, v39, v110
    s_nop 0
    v_add_f32 v39, v39, v111
    v_cvt_pk_bf16_f32 v55, v110, v111
    .p2align 6
L_body0:
    s_cmp_lt_i32 s49, 0
    s_cbranch_scc0 L_recurrent_scan__compressed_kv_cla__moe_arch_mod__prompt_kernel_rare_121
L_recurrent_scan__compressed_kv_cla__moe_arch_mod__prompt_kernel_back_122:
    s_waitcnt lgkmcnt(3)
    v_mfma_f32_16x16x32_bf16 v[96:99], v[64:67], v[128:131], v[40:43]
    v_exp_f32 v112, v112
    v_mfma_f32_16x16x32_bf16 v[104:107], v[64:67], v[144:147], v[44:47]
    ds_read_b128 v[92:95], v2 offset:7168
    s_bitcmp1_b32 s48, s40
    s_cbranch_scc0 L_recurrent_scan__compressed_kv_cla__moe_arch_mod__prompt_kernel_nodma_131
    s_add_u32 m0, s43, 0
    s_nop 0
    buffer_load_dwordx4 v4, s[12:15], s46 offen offset:0 sc1 lds
    buffer_load_dwordx4 v4, s[12:15], s46 offen offset:1024 sc1 lds
L_recurrent_scan__compressed_kv_cla__moe_arch_mod__prompt_kernel_nodma_131:
    v_mfma_f32_16x16x32_bf16 v[96:99], v[68:71], v[132:135], v[96:99]
    v_exp_f32 v113, v113
    v_mfma_f32_16x16x32_bf16 v[104:107], v[68:71], v[148:151], v[104:107]
    ds_read_b128 v[64:67], v3 offset:0
    v_add_f32 v38, v38, v112
    v_mfma_f32_16x16x32_bf16 v[96:99], v[72:75], v[136:139], v[96:99]
    v_exp_f32 v114, v114
    v_mfma_f32_16x16x32_bf16 v[104:107], v[72:75], v[152:155], v[104:107]
    ds_read_b128 v[68:71], v3 offset:1024
    v_add_f32 v38, v38, v113
    v_cvt_pk_bf16_f32 v56, v112, v113
    s_bitcmp1_b32 s48, s40
    s_cbranch_scc0 L_recurrent_scan__compressed_kv_cla__moe_arch_mod__prompt_kernel_nodma_132
    s_add_u32 m0, s43, 0
    s_nop 0
    buffer_load_dwordx4 v4, s[12:15], s46 offen offset:2048 sc1 lds
    buffer_load_dwordx4 v4, s[12:15], s46 offen offset:3072 sc1 lds
L_recurrent_scan__compressed_kv_cla__moe_arch_mod__prompt_kernel_nodma_132:
    v_mfma_f32_16x16x32_bf16 v[96:99], v[76:79], v[140:143], v[96:99]
    v_exp_f32 v115, v115
    v_mfma_f32_16x16x32_bf16 v[104:107], v[76:79], v[156:159], v[104:107]
    ds_read_b128 v[72:75], v3 offset:2048
    v_add_f32 v38, v38, v114
    s_waitcnt lgkmcnt(3)
    v_mfma_f32_16x16x32_bf16 v[100:103], v[80:83], v[128:131], v[40:43]
    v_exp_f32 v120, v120
    v_mfma_f32_16x16x32_bf16 v[108:111], v[80:83], v[144:147], v[44:47]
    ds_read_b128 v[76:79], v3 offset:3072
    v_add_f32 v38, v38, v115
    v_cvt_pk_bf16_f32 v57, v114, v115
    s_bitcmp1_b32 s48, s40
    s_cbranch_scc0 L_recurrent_scan__compressed_kv_cla__moe_arch_mod__prompt_kernel_nodma_133
    s_add_u32 m0, s43, 4096
    s_nop 0
    buffer_load_dwordx4 v6, s[12:15], s46 offen offset:0 sc1 lds
    buffer_load_dwordx4 v6, s[12:15], s46 offen offset:1024 sc1 lds
L_recurrent_scan__compressed_kv_cla__moe_arch_mod__prompt_kernel_nodma_133:
    v_mfma_f32_16x16x32_bf16 v[100:103], v[84:87], v[132:135], v[100:103]
    v_exp_f32 v121, v121
    v_mfma_f32_16x16x32_bf16 v[108:111], v[84:87], v[148:151], v[108:111]
    ds_read_b128 v[80:83], v3 offset:4096
    v_add_f32 v39, v39, v120
    v_mfma_f32_16x16x32_bf16 v[100:103], v[88:91], v[136:139], v[100:103]
    v_exp_f32 v122, v122
    v_mfma_f32_16x16x32_bf16 v[108:111], v[88:91], v[152:155], v[108:111]
    ds_read_b128 v[84:87], v3 offset:5120
    v_add_f32 v39, v39, v121
    v_cvt_pk_bf16_f32 v60, v120, v121
    s_bitcmp1_b32 s48, s40
    s_cbranch_scc0 L_recurrent_scan__compressed_kv_cla__moe_arch_mod__prompt_kernel_nodma_134
    s_add_u32 m0, s43, 4096
    s_nop 0
    buffer_load_dwordx4 v6, s[12:15], s46 offen offset:2048 sc1 lds
    buffer_load_dwordx4 v6, s[12:15], s46 offen offset:3072 sc1 lds
    s_add_u32 s46, s46, 65536
    s_xor_b32 s43, s43, 32768
L_recurrent_scan__compressed_kv_cla__moe_arch_mod__prompt_kernel_nodma_134:
    v_mfma_f32_16x16x32_bf16 v[100:103], v[92:95], v[140:143], v[100:103]
    v_exp_f32 v123, v123
    v_mfma_f32_16x16x32_bf16 v[108:111], v[92:95], v[156:159], v[108:111]
    ds_read_b128 v[88:91], v3 offset:6144
    v_add_f32 v39, v39, v122
    s_waitcnt lgkmcnt(3)
    v_mfma_f32_16x16x32_bf16 v[192:195], v[64:67], v[48:51], v[192:195]
    v_exp_f32 v116, v116
    v_mfma_f32_16x16x32_bf16 v[224:227], v[64:67], v[52:55], v[224:227]
    ds_read_b128 v[92:95], v3 offset:7168
    v_add_f32 v39, v39, v123
    v_cvt_pk_bf16_f32 v61, v122, v123
    s_bitcmp1_b32 s39, s40
    s_cbranch_scc0 L_recurrent_scan__compressed_kv_cla__moe_arch_mod__prompt_kernel_nodma_135
    s_add_u32 m0, s44, 0
    s_nop 0
    buffer_load_dwordx4 v4, s[12:15], s47 offen offset:0 sc1 lds
    buffer_load_dwordx4 v4, s[12:15], s47 offen offset:1024 sc1 lds
L_recurrent_scan__compressed_kv_cla__moe_arch_mod__prompt_kernel_nodma_135:
    v_mfma_f32_16x16x32_bf16 v[196:199], v[68:71], v[48:51], v[196:199]
    v_exp_f32 v117, v117
    v_mfma_f32_16x16x32_bf16 v[228:231], v[68:71], v[52:55], v[228:231]
    ds_read_b128 v[64:67], v2 offset:8192
    v_add_f32 v38, v38, v116
    v_mfma_f32_16x16x32_bf16 v[200:203], v[72:75], v[48:51], v[200:203]
    v_exp_f32 v118, v118
    v_mfma_f32_16x16x32_bf16 v[232:235], v[72:75], v[52:55], v[232:235]
    ds_read_b128 v[68:71], v2 offset:9216
    v_add_f32 v38, v38, v117
    v_cvt_pk_bf16_f32 v58, v116, v117
    s_bitcmp1_b32 s39, s40
    s_cbranch_scc0 L_recurrent_scan__compressed_kv_cla__moe_arch_mod__prompt_kernel_nodma_136
    s_add_u32 m0, s44, 0
    s_nop 0
    buffer_load_dwordx4 v4, s[12:15], s47 offen offset:2048 sc1 lds
    buffer_load_dwordx4 v4, s[12:15], s47 offen offset:3072 sc1 lds
L_recurrent_scan__compressed_kv_cla__moe_arch_mod__prompt_kernel_nodma_136:
    v_mfma_f32_16x16x32_bf16 v[204:207], v[76:79], v[48:51], v[204:207]
    v_exp_f32 v119, v119
    v_mfma_f32_16x16x32_bf16 v[236:239], v[76:79], v[52:55], v[236:239]
    ds_read_b128 v[72:75], v2 offset:10240
    v_add_f32 v38, v38, v118
    s_waitcnt lgkmcnt(3)
    v_mfma_f32_16x16x32_bf16 v[208:211], v[80:83], v[48:51], v[208:211]
    v_exp_f32 v124, v124
    v_mfma_f32_16x16x32_bf16 v[240:243], v[80:83], v[52:55], v[240:243]
    ds_read_b128 v[76:79], v2 offset:11264
    v_add_f32 v38, v38, v119
    v_cvt_pk_bf16_f32 v59, v118, v119
    s_bitcmp1_b32 s39, s40
    s_cbranch_scc0 L_recurrent_scan__compressed_kv_cla__moe_arch_mod__prompt_kernel_nodma_137
    s_add_u32 m0, s44, 4096
    s_nop 0
    buffer_load_dwordx4 v6, s[12:15], s47 offen offset:0 sc1 lds
    buffer_load_dwordx4 v6, s[12:15], s47 offen offset:1024 sc1 lds
L_recurrent_scan__compressed_kv_cla__moe_arch_mod__prompt_kernel_nodma_137:
    v_mfma_f32_16x16x32_bf16 v[212:215], v[84:87], v[48:51], v[212:215]
    v_exp_f32 v125, v125
    v_mfma_f32_16x16x32_bf16 v[244:247], v[84:87], v[52:55], v[244:247]
    ds_read_b128 v[80:83], v2 offset:12288
    v_add_f32 v39, v39, v124
    v_mfma_f32_16x16x32_bf16 v[216:219], v[88:91], v[48:51], v[216:219]
    v_exp_f32 v126, v126
    v_mfma_f32_16x16x32_bf16 v[248:251], v[88:91], v[52:55], v[248:251]
    ds_read_b128 v[84:87], v2 offset:13312
    v_add_f32 v39, v39, v125
    v_cvt_pk_bf16_f32 v62, v124, v125
    s_bitcmp1_b32 s39, s40
    s_cbranch_scc0 L_recurrent_scan__compressed_kv_cla__moe_arch_mod__prompt_kernel_nodma_138
    s_add_u32 m0, s44, 4096
    s_nop 0
    buffer_load_dwordx4 v6, s[12:15], s47 offen offset:2048 sc1 lds
    buffer_load_dwordx4 v6, s[12:15], s47 offen offset:3072 sc1 lds
    s_add_u32 s47, s47, 65536
    s_xor_b32 s44, s44, 32768
L_recurrent_scan__compressed_kv_cla__moe_arch_mod__prompt_kernel_nodma_138:
    v_mfma_f32_16x16x32_bf16 v[220:223], v[92:95], v[48:51], v[220:223]
    v_exp_f32 v127, v127
    v_mfma_f32_16x16x32_bf16 v[252:255], v[92:95], v[52:55], v[252:255]
    ds_read_b128 v[88:91], v2 offset:14336
    v_add_f32 v39, v39, v126
    v_add_f32 v39, v39, v127
    v_cvt_pk_bf16_f32 v63, v126, v127
    s_cmp_lt_i32 s50, 0
    s_cbranch_scc0 L_recurrent_scan__compressed_kv_cla__moe_arch_mod__prompt_kernel_rare_123
L_recurrent_scan__compressed_kv_cla__moe_arch_mod__prompt_kernel_back_124:
    s_waitcnt lgkmcnt(3)
    v_mfma_f32_16x16x32_bf16 v[112:115], v[64:67], v[128:131], v[40:43]
    v_exp_f32 v96, v96
    v_mfma_f32_16x16x32_bf16 v[120:123], v[64:67], v[144:147], v[44:47]
    ds_read_b128 v[92:95], v2 offset:15360
    v_mfma_f32_16x16x32_bf16 v[112:115], v[68:71], v[132:135], v[112:115]
    v_exp_f32 v97, v97
    s_add_u32 s40, s40, 1
    v_mfma_f32_16x16x32_bf16 v[120:123], v[68:71], v[148:151], v[120:123]
    ds_read_b128 v[64:67], v3 offset:8192
    v_add_f32 v38, v38, v96
    s_add_u32 s49, s50, 32
    v_add_u32 v24, 65536, v2
    v_mfma_f32_16x16x32_bf16 v[112:115], v[72:75], v[136:139], v[112:115]
    v_exp_f32 v98, v98
    v_mfma_f32_16x16x32_bf16 v[120:123], v[72:75], v[152:155], v[120:123]
    ds_read_b128 v[68:71], v3 offset:9216
    v_add_f32 v38, v38, v97
    v_cvt_pk_bf16_f32 v48, v96, v97
    s_cmp_le_u32 s40, s51
    s_cselect_b32 s36, 64, 128
    v_mfma_f32_16x16x32_bf16 v[112:115], v[76:79], v[140:143], v[112:115]
    v_exp_f32 v99, v99
    v_mfma_f32_16x16x32_bf16 v[120:123], v[76:79], v[156:159], v[120:123]
    ds_read_b128 v[72:75], v3 offset:10240
    v_add_f32 v38, v38, v98
    s_add_u32 s41, s41, s36
    s_add_u32 s50, s50, s36
    s_waitcnt lgkmcnt(3)
    v_mfma_f32_16x16x32_bf16 v[116:119], v[80:83], v[128:131], v[40:43]
    v_exp_f32 v104, v104
    v_mfma_f32_16x16x32_bf16 v[124:127], v[80:83], v[144:147], v[44:47]
    ds_read_b128 v[76:79], v3 offset:11264
    v_add_f32 v38, v38, v99
    v_cvt_pk_bf16_f32 v49, v98, v99
    s_and_b32 s36, s41, 0xff
    v_lshl_add_u32 v2, s36, 8, v7
    v_mfma_f32_16x16x32_bf16 v[116:119], v[84:87], v[132:135], v[116:119]
    v_exp_f32 v105, v105
    v_mfma_f32_16x16x32_bf16 v[124:127], v[84:87], v[148:151], v[124:127]
    ds_read_b128 v[80:83], v3 offset:12288
    v_add_f32 v39, v39, v104
    s_cmp_eq_u32 s40, 16
    s_cselect_b64 s[20:21], -1, 0
    v_mfma_f32_16x16x32_bf16 v[116:119], v[88:91], v[136:139], v[116:119]
    v_exp_f32 v106, v106
    v_mfma_f32_16x16x32_bf16 v[124:127], v[88:91], v[152:155], v[124:127]
    ds_read_b128 v[84:87], v3 offset:13312
    v_add_f32 v39, v39, v105
    v_cvt_pk_bf16_f32 v52, v104, v105
    v_cndmask_b32 v5, v2, v24, s[20:21]
    v_mfma_f32_16x16x32_bf16 v[116:119], v[92:95], v[140:143], v[116:119]
    v_exp_f32 v107, v107
    v_mfma_f32_16x16x32_bf16 v[124:127], v[92:95], v[156:159], v[124:127]
    ds_read_b128 v[88:91], v3 offset:14336
    v_add_f32 v39, v39, v106
    s_waitcnt lgkmcnt(3)
    v_mfma_f32_16x16x32_bf16 v[192:195], v[64:67], v[56:59], v[192:195]
    v_exp_f32 v100, v100
    v_mfma_f32_16x16x32_bf16 v[224:227], v[64:67], v[60:63], v[224:227]
    ds_read_b128 v[92:95], v3 offset:15360
    v_add_f32 v39, v39, v107
    v_cvt_pk_bf16_f32 v53, v106, v107
    v_mfma_f32_16x16x32_bf16 v[196:199], v[68:71], v[56:59], v[196:199]
    v_exp_f32 v101, v101
    v_mfma_f32_16x16x32_bf16 v[228:231], v[68:71], v[60:63], v[228:231]
    v_add_f32 v38, v38, v100
    v_mov_b32 v3, v24
    v_mfma_f32_16x16x32_bf16 v[200:203], v[72:75], v[56:59], v[200:203]
    v_exp_f32 v102, v102
    v_mfma_f32_16x16x32_bf16 v[232:235], v[72:75], v[60:63], v[232:235]
    v_add_f32 v38, v38, v101
    v_cvt_pk_bf16_f32 v50, v100, v101
    s_waitcnt vmcnt(0) lgkmcnt(0)
    s_cmp_eq_u32 s40, s42
    s_cbranch_scc1 L_recurrent_scan__compressed_kv_cla__moe_arch_mod__prompt_kernel_rare_129
L_recurrent_scan__compressed_kv_cla__moe_arch_mod__prompt_kernel_back_130:
    s_barrier
    v_mfma_f32_16x16x32_bf16 v[204:207], v[76:79], v[56:59], v[204:207]
    v_exp_f32 v103, v103
    v_mfma_f32_16x16x32_bf16 v[236:239], v[76:79], v[60:63], v[236:239]
    ds_read_b128 v[68:71], v5 offset:1024
    ds_read_b128 v[64:67], v5 offset:0
    v_add_f32 v38, v38, v102
    v_mfma_f32_16x16x32_bf16 v[208:211], v[80:83], v[56:59], v[208:211]
    v_exp_f32 v108, v108
    v_mfma_f32_16x16x32_bf16 v[240:243], v[80:83], v[60:63], v[240:243]
    ds_read_b128 v[76:79], v5 offset:3072
    ds_read_b128 v[72:75], v5 offset:2048
    v_add_f32 v38, v38, v103
    v_cvt_pk_bf16_f32 v51, v102, v103
    v_mfma_f32_16x16x32_bf16 v[212:215], v[84:87], v[56:59], v[212:215]
    v_exp_f32 v109, v109
    v_mfma_f32_16x16x32_bf16 v[244:247], v[84:87], v[60:63], v[244:247]
    ds_read_b128 v[80:83], v5 offset:4096
    v_add_f32 v39, v39, v108
    v_mfma_f32_16x16x32_bf16 v[216:219], v[88:91], v[56:59], v[216:219]
    v_exp_f32 v110, v110
    v_mfma_f32_16x16x32_bf16 v[248:251], v[88:91], v[60:63], v[248:251]
    ds_read_b128 v[84:87], v5 offset:5120
    v_add_f32 v39, v39, v109
    v_cvt_pk_bf16_f32 v54, v108, v109
    v_mfma_f32_16x16x32_bf16 v[220:223], v[92:95], v[56:59], v[220:223]
    v_exp_f32 v111, v111
    v_mfma_f32_16x16x32_bf16 v[252:255], v[92:95], v[60:63], v[252:255]
    ds_read_b128 v[88:91], v5 offset:6144
    v_add_f32 v39, v39, v110
    v_add_f32 v39, v39, v111
    v_cvt_pk_bf16_f32 v55, v110, v111
    s_cmp_lg_u32 s40, 16
    s_cbranch_scc1 L_body0
    s_lshr_b32 s38, s2, 4
    s_mul_i32 s38, s38, 224
    s_and_b32 s39, s2, 15
    s_lshl_b32 s39, s39, 7
    v_lshrrev_b32 v27, 3, v1
    s_lshl_b32 s36, s28, 5
    s_add_u32 s36, s36, s38
    v_add_u32 v27, s36, v27
    v_mul_u32_u24 v27, 2048, v27
    v_add_u32 v27, s39, v27
    v_bfe_u32 v28, v1, 4, 1
    v_lshlrev_b32 v28, 1, v28
    v_and_b32 v29, 7, v1
    v_xor_b32 v28, v28, v29
    v_lshl_add_u32 v26, v28, 4, v27
    v_xor_b32 v28, 4, v28
    v_lshl_add_u32 v27, v28, 4, v27
    v_add_u32 v27, 15360, v27
    v_add_u32 v28, 30720, v26
    v_add_u32 v29, 30720, v27
    s_lshl_b32 s36, s28, 12
    s_add_u32 s36, s36, 131072
    s_cmp_lt_u32 s28, 7
    s_cselect_b32 m0, s36, 0x30000
    s_cselect_b32 s6, 7340032, 0
    buffer_load_dwordx4 v26, s[4:7], 0 offen offset:0 lds
    buffer_load_dwordx4 v27, s[4:7], 0 offen offset:1024 lds
    buffer_load_dwordx4 v28, s[4:7], 0 offen offset:2048 lds
    buffer_load_dwordx4 v29, s[4:7], 0 offen offset:3072 lds
    s_lshr_b32 s36, s2, 5
    s_add_u32 s36, s36, 48
    s_lshl_b32 s36, s36, 7
    v_mov_b32 v12, s36
    global_load_dword v11, v12, s[90:91] sc1
    s_cmp_lt_i32 s49, 0
    s_cbranch_scc0 L_recurrent_scan__compressed_kv_cla__moe_arch_mod__prompt_kernel_rare_139
L_recurrent_scan__compressed_kv_cla__moe_arch_mod__prompt_kernel_back_140:
    s_waitcnt lgkmcnt(5)
    v_mfma_f32_16x16x32_bf16 v[192:195], v[64:67], v[48:51], v[192:195]
    v_exp_f32 v112, v112
    v_mfma_f32_16x16x32_bf16 v[224:227], v[64:67], v[52:55], v[224:227]
    ds_read_b128 v[92:95], v3 offset:7168
    v_add_f32 v38, v38, v112
    v_exp_f32 v113, v113
    v_mfma_f32_16x16x32_bf16 v[196:199], v[68:71], v[48:51], v[196:199]
    v_add_f32 v38, v38, v113
    v_cvt_pk_bf16_f32 v56, v112, v113
    v_exp_f32 v114, v114
    v_mfma_f32_16x16x32_bf16 v[228:231], v[68:71], v[52:55], v[228:231]
    ds_read_b128 v[64:67], v3 offset:8192
    v_add_f32 v38, v38, v114
    v_exp_f32 v115, v115
    s_waitcnt lgkmcnt(5)
    v_mfma_f32_16x16x32_bf16 v[200:203], v[72:75], v[48:51], v[200:203]
    v_add_f32 v38, v38, v115
    v_cvt_pk_bf16_f32 v57, v114, v115
    v_exp_f32 v120, v120
    v_mfma_f32_16x16x32_bf16 v[232:235], v[72:75], v[52:55], v[232:235]
    ds_read_b128 v[68:71], v3 offset:9216
    v_add_f32 v39, v39, v120
    v_exp_f32 v121, v121
    v_mfma_f32_16x16x32_bf16 v[204:207], v[76:79], v[48:51], v[204:207]
    v_add_f32 v39, v39, v121
    v_cvt_pk_bf16_f32 v60, v120, v121
    v_exp_f32 v122, v122
    v_mfma_f32_16x16x32_bf16 v[236:239], v[76:79], v[52:55], v[236:239]
    ds_read_b128 v[72:75], v3 offset:10240
    v_add_f32 v39, v39, v122
    v_exp_f32 v123, v123
    s_waitcnt lgkmcnt(6)
    v_mfma_f32_16x16x32_bf16 v[208:211], v[80:83], v[48:51], v[208:211]
    v_add_f32 v39, v39, v123
    v_cvt_pk_bf16_f32 v61, v122, v123
    v_exp_f32 v116, v116
    v_mfma_f32_16x16x32_bf16 v[240:243], v[80:83], v[52:55], v[240:243]
    ds_read_b128 v[76:79], v3 offset:11264
    v_add_f32 v38, v38, v116
    v_exp_f32 v117, v117
    s_waitcnt lgkmcnt(6)
    v_mfma_f32_16x16x32_bf16 v[212:215], v[84:87], v[48:51], v[212:215]
    v_add_f32 v38, v38, v117
    v_cvt_pk_bf16_f32 v58, v116, v117
    v_exp_f32 v118, v118
    v_mfma_f32_16x16x32_bf16 v[244:247], v[84:87], v[52:55], v[244:247]
    ds_read_b128 v[80:83], v3 offset:12288
    v_add_f32 v38, v38, v118
    v_exp_f32 v119, v119
    s_waitcnt lgkmcnt(6)
    v_mfma_f32_16x16x32_bf16 v[216:219], v[88:91], v[48:51], v[216:219]
    v_add_f32 v38, v38, v119
    v_cvt_pk_bf16_f32 v59, v118, v119
    v_exp_f32 v124, v124
    v_mfma_f32_16x16x32_bf16 v[248:251], v[88:91], v[52:55], v[248:251]
    ds_read_b128 v[84:87], v3 offset:13312
    v_add_f32 v39, v39, v124
    v_exp_f32 v125, v125
    s_waitcnt lgkmcnt(6)
    v_mfma_f32_16x16x32_bf16 v[220:223], v[92:95], v[48:51], v[220:223]
    v_add_f32 v39, v39, v125
    v_cvt_pk_bf16_f32 v62, v124, v125
    v_exp_f32 v126, v126
    v_mfma_f32_16x16x32_bf16 v[252:255], v[92:95], v[52:55], v[252:255]
    ds_read_b128 v[88:91], v3 offset:14336
    v_add_f32 v39, v39, v126
    v_exp_f32 v127, v127
    s_nop 0
    v_add_f32 v39, v39, v127
    v_cvt_pk_bf16_f32 v63, v126, v127
    s_nop 1
    s_waitcnt lgkmcnt(6)
    v_mfma_f32_16x16x32_bf16 v[192:195], v[64:67], v[56:59], v[192:195]
    v_mfma_f32_16x16x32_bf16 v[224:227], v[64:67], v[60:63], v[224:227]
    ds_read_b128 v[92:95], v3 offset:15360
    s_waitcnt lgkmcnt(6)
    v_mfma_f32_16x16x32_bf16 v[196:199], v[68:71], v[56:59], v[196:199]
    v_mfma_f32_16x16x32_bf16 v[228:231], v[68:71], v[60:63], v[228:231]
    s_waitcnt lgkmcnt(5)
    v_mfma_f32_16x16x32_bf16 v[200:203], v[72:75], v[56:59], v[200:203]
    v_mfma_f32_16x16x32_bf16 v[232:235], v[72:75], v[60:63], v[232:235]
    s_waitcnt lgkmcnt(4)
    v_mfma_f32_16x16x32_bf16 v[204:207], v[76:79], v[56:59], v[204:207]
    v_mfma_f32_16x16x32_bf16 v[236:239], v[76:79], v[60:63], v[236:239]
    s_waitcnt lgkmcnt(3)
    v_mfma_f32_16x16x32_bf16 v[208:211], v[80:83], v[56:59], v[208:211]
    v_mfma_f32_16x16x32_bf16 v[240:243], v[80:83], v[60:63], v[240:243]
    s_waitcnt lgkmcnt(2)
    v_mfma_f32_16x16x32_bf16 v[212:215], v[84:87], v[56:59], v[212:215]
    v_mfma_f32_16x16x32_bf16 v[244:247], v[84:87], v[60:63], v[244:247]
    s_waitcnt lgkmcnt(1)
    v_mfma_f32_16x16x32_bf16 v[216:219], v[88:91], v[56:59], v[216:219]
    v_mfma_f32_16x16x32_bf16 v[248:251], v[88:91], v[60:63], v[248:251]
    s_waitcnt lgkmcnt(0)
    v_mfma_f32_16x16x32_bf16 v[220:223], v[92:95], v[56:59], v[220:223]
    v_mfma_f32_16x16x32_bf16 v[252:255], v[92:95], v[60:63], v[252:255]
    s_lshl_b32 s37, s28, 13
    v_add_u32 v21, s37, v7
    v_xor_b32 v22, 32768, v21
    s_lshl_b32 s37, s28, 8
    s_add_u32 s37, s37, 159744
    v_lshl_add_u32 v23, v1, 2, s37
    v_xor_b32 v24, 1024, v23
    ds_write_b32 v23, v39
    s_mov_b32 s36, 0x5d800000
    v_cmp_nge_f32 vcc, s36, v38
    s_nop 0
    s_or_b64 s[52:53], s[52:53], vcc
    v_cmp_nge_f32 vcc, s36, v39
    s_nop 0
    s_or_b64 s[52:53], s[52:53], vcc
    s_or_b32 s36, s52, s53
    v_mov_b32 v26, s36
    s_lshl_b32 s37, s28, 2
    s_add_u32 s37, s37, 161792
    v_mov_b32 v27, s37
    ds_write_b32 v27, v26
    ds_write_b128 v21, v[224:227] offset:0
    ds_write_b128 v21, v[228:231] offset:1024
    ds_write_b128 v21, v[232:235] offset:2048
    ds_write_b128 v21, v[236:239] offset:3072
    ds_write_b128 v21, v[240:243] offset:4096
    ds_write_b128 v21, v[244:247] offset:5120
    ds_write_b128 v21, v[248:251] offset:6144
    ds_write_b128 v21, v[252:255] offset:7168
    v_and_b32 v27, 7, v1
    v_lshlrev_b32 v27, 2, v27
    v_add_u32 v27, 161792, v27
    s_sub_u32 s36, 15, s30
    s_lshl_b32 s38, s36, 3
    s_and_b32 s37, s28, 3
    s_lshl_b32 s37, s37, 1
    s_add_u32 s38, s38, s37
    s_lshl_b32 s38, s38, 17
    s_lshl_b32 s37, s29, 12
    s_add_u32 s38, s38, s37
    s_waitcnt lgkmcnt(0)
    s_barrier
    ds_read_b32 v26, v27
    ds_read_b32 v25, v24
    ds_read_b128 v[64:67], v22 offset:0
    ds_read_b128 v[68:71], v22 offset:1024
    ds_read_b128 v[72:75], v22 offset:2048
    ds_read_b128 v[76:79], v22 offset:3072
    ds_read_b128 v[80:83], v22 offset:4096
    ds_read_b128 v[84:87], v22 offset:5120
    ds_read_b128 v[88:91], v22 offset:6144
    ds_read_b128 v[92:95], v22 offset:7168
    s_waitcnt lgkmcnt(8)
    v_add_f32 v25, v25, v38
    v_mov_b32 v20, v25
    s_nop 1
    v_permlane16_swap_b32 v25, v20
    s_nop 1
    v_add_f32 v25, v25, v20
    v_mov_b32 v20, v25
    s_nop 1
    v_permlane32_swap_b32 v25, v20
    s_nop 1
    v_add_f32 v25, v25, v20
    v_cmp_ne_u32 s[52:53], 0, v26
    v_rcp_f32 v25, v25
    s_waitcnt lgkmcnt(6)
    v_add_f32 v192, v192, v64
    v_add_f32 v193, v193, v65
    v_add_f32 v194, v194, v66
    v_add_f32 v195, v195, v67
    v_add_f32 v196, v196, v68
    v_add_f32 v197, v197, v69
    v_add_f32 v198, v198, v70
    v_add_f32 v199, v199, v71
    v_mul_f32 v192, v25, v192
    v_mul_f32 v193, v25, v193
    v_mul_f32 v194, v25, v194
    v_mul_f32 v195, v25, v195
    v_mul_f32 v196, v25, v196
    v_mul_f32 v197, v25, v197
    v_mul_f32 v198, v25, v198
    v_mul_f32 v199, v25, v199
    v_cvt_pk_bf16_f32 v48, v192, v193
    v_cvt_pk_bf16_f32 v49, v194, v195
    v_cvt_pk_bf16_f32 v50, v196, v197
    v_cvt_pk_bf16_f32 v51, v198, v199
    buffer_store_dwordx4 v[48:51], v7, s[16:19], s38 offen offset:0 sc1
    s_waitcnt lgkmcnt(4)
    v_add_f32 v200, v200, v72
    v_add_f32 v201, v201, v73
    v_add_f32 v202, v202, v74
    v_add_f32 v203, v203, v75
    v_add_f32 v204, v204, v76
    v_add_f32 v205, v205, v77
    v_add_f32 v206, v206, v78
    v_add_f32 v207, v207, v79
    v_mul_f32 v200, v25, v200
    v_mul_f32 v201, v25, v201
    v_mul_f32 v202, v25, v202
    v_mul_f32 v203, v25, v203
    v_mul_f32 v204, v25, v204
    v_mul_f32 v205, v25, v205
    v_mul_f32 v206, v25, v206
    v_mul_f32 v207, v25, v207
    v_cvt_pk_bf16_f32 v52, v200, v201
    v_cvt_pk_bf16_f32 v53, v202, v203
    v_cvt_pk_bf16_f32 v54, v204, v205
    v_cvt_pk_bf16_f32 v55, v206, v207
    buffer_store_dwordx4 v[52:55], v7, s[16:19], s38 offen offset:1024 sc1
    s_waitcnt lgkmcnt(2)
    v_add_f32 v208, v208, v80
    v_add_f32 v209, v209, v81
    v_add_f32 v210, v210, v82
    v_add_f32 v211, v211, v83
    v_add_f32 v212, v212, v84
    v_add_f32 v213, v213, v85
    v_add_f32 v214, v214, v86
    v_add_f32 v215, v215, v87
    v_mul_f32 v208, v25, v208
    v_mul_f32 v209, v25, v209
    v_mul_f32 v210, v25, v210
    v_mul_f32 v211, v25, v211
    v_mul_f32 v212, v25, v212
    v_mul_f32 v213, v25, v213
    v_mul_f32 v214, v25, v214
    v_mul_f32 v215, v25, v215
    v_cvt_pk_bf16_f32 v56, v208, v209
    v_cvt_pk_bf16_f32 v57, v210, v211
    v_cvt_pk_bf16_f32 v58, v212, v213
    v_cvt_pk_bf16_f32 v59, v214, v215
    buffer_store_dwordx4 v[56:59], v7, s[16:19], s38 offen offset:2048 sc1
    s_waitcnt lgkmcnt(0)
    v_add_f32 v216, v216, v88
    v_add_f32 v217, v217, v89
    v_add_f32 v218, v218, v90
    v_add_f32 v219, v219, v91
    v_add_f32 v220, v220, v92
    v_add_f32 v221, v221, v93
    v_add_f32 v222, v222, v94
    v_add_f32 v223, v223, v95
    v_mul_f32 v216, v25, v216
    v_mul_f32 v217, v25, v217
    v_mul_f32 v218, v25, v218
    v_mul_f32 v219, v25, v219
    v_mul_f32 v220, v25, v220
    v_mul_f32 v221, v25, v221
    v_mul_f32 v222, v25, v222
    v_mul_f32 v223, v25, v223
    v_cvt_pk_bf16_f32 v60, v216, v217
    v_cvt_pk_bf16_f32 v61, v218, v219
    v_cvt_pk_bf16_f32 v62, v220, v221
    v_cvt_pk_bf16_f32 v63, v222, v223
    buffer_store_dwordx4 v[60:63], v7, s[16:19], s38 offen offset:3072 sc1
    s_cmp_eq_u64 s[52:53], 0
    s_cbranch_scc1 L_p3_done
    v_mov_b32 v192, 0
    v_mov_b32 v193, 0
    v_mov_b32 v194, 0
    v_mov_b32 v195, 0
    v_mov_b32 v196, 0
    v_mov_b32 v197, 0
    v_mov_b32 v198, 0
    v_mov_b32 v199, 0
    v_mov_b32 v200, 0
    v_mov_b32 v201, 0
    v_mov_b32 v202, 0
    v_mov_b32 v203, 0
    v_mov_b32 v204, 0
    v_mov_b32 v205, 0
    v_mov_b32 v206, 0
    v_mov_b32 v207, 0
    v_mov_b32 v208, 0
    v_mov_b32 v209, 0
    v_mov_b32 v210, 0
    v_mov_b32 v211, 0
    v_mov_b32 v212, 0
    v_mov_b32 v213, 0
    v_mov_b32 v214, 0
    v_mov_b32 v215, 0
    v_mov_b32 v216, 0
    v_mov_b32 v217, 0
    v_mov_b32 v218, 0
    v_mov_b32 v219, 0
    v_mov_b32 v220, 0
    v_mov_b32 v221, 0
    v_mov_b32 v222, 0
    v_mov_b32 v223, 0
    v_mov_b32 v224, 0
    v_mov_b32 v225, 0
    v_mov_b32 v226, 0
    v_mov_b32 v227, 0
    v_mov_b32 v228, 0
    v_mov_b32 v229, 0
    v_mov_b32 v230, 0
    v_mov_b32 v231, 0
    v_mov_b32 v232, 0
    v_mov_b32 v233, 0
    v_mov_b32 v234, 0
    v_mov_b32 v235, 0
    v_mov_b32 v236, 0
    v_mov_b32 v237, 0
    v_mov_b32 v238, 0
    v_mov_b32 v239, 0
    v_mov_b32 v240, 0
    v_mov_b32 v241, 0
    v_mov_b32 v242, 0
    v_mov_b32 v243, 0
    v_mov_b32 v244, 0
    v_mov_b32 v245, 0
    v_mov_b32 v246, 0
    v_mov_b32 v247, 0
    v_mov_b32 v248, 0
    v_mov_b32 v249, 0
    v_mov_b32 v250, 0
    v_mov_b32 v251, 0
    v_mov_b32 v252, 0
    v_mov_b32 v253, 0
    v_mov_b32 v254, 0
    v_mov_b32 v255, 0
    v_mov_b32 v38, 0
    v_mov_b32 v40, 4048155338
    v_mov_b32 v39, 0
    v_mov_b32 v41, 4048155338
    s_lshl_b32 s43, s28, 12
    v_add_u32 v4, s43, v7
    s_mov_b32 s46, s45
    s_sub_u32 s40, 16, s30
    s_sub_u32 s39, 15, s30
    s_lshl_b32 s37, s39, 7
    s_and_b32 s36, s28, 3
    s_lshl_b32 s36, s36, 5
    s_add_u32 s36, s36, s37
    s_sub_u32 s50, 0, s36
L_recurrent_scan__compressed_kv_cla__moe_arch_mod__prompt_kernel_stile_141:
    s_waitcnt vmcnt(0) lgkmcnt(0)
    s_barrier
    s_mov_b32 m0, s43
    s_add_u32 s47, s46, 32768
    buffer_load_dwordx4 v4, s[12:15], s46 offen offset:0 sc1 lds
    buffer_load_dwordx4 v4, s[12:15], s46 offen offset:1024 sc1 lds
    buffer_load_dwordx4 v4, s[12:15], s46 offen offset:2048 sc1 lds
    buffer_load_dwordx4 v4, s[12:15], s46 offen offset:3072 sc1 lds
    s_add_u32 m0, s43, 32768
    s_add_u32 s46, s46, 65536
    buffer_load_dwordx4 v4, s[12:15], s47 offen offset:0 sc1 lds
    buffer_load_dwordx4 v4, s[12:15], s47 offen offset:1024 sc1 lds
    buffer_load_dwordx4 v4, s[12:15], s47 offen offset:2048 sc1 lds
    buffer_load_dwordx4 v4, s[12:15], s47 offen offset:3072 sc1 lds
    v_mov_b32 v2, v7
    s_mov_b32 s41, 4
    s_waitcnt vmcnt(0)
    s_barrier
L_recurrent_scan__compressed_kv_cla__moe_arch_mod__prompt_kernel_sunit_142:
    s_cmp_gt_i32 s50, 0
    s_cbranch_scc1 L_recurrent_scan__compressed_kv_cla__moe_arch_mod__prompt_kernel_snext_143
    ds_read_b128 v[64:67], v2 offset:0
    ds_read_b128 v[68:71], v2 offset:1024
    ds_read_b128 v[72:75], v2 offset:2048
    ds_read_b128 v[76:79], v2 offset:3072
    ds_read_b128 v[80:83], v2 offset:4096
    ds_read_b128 v[84:87], v2 offset:5120
    ds_read_b128 v[88:91], v2 offset:6144
    ds_read_b128 v[92:95], v2 offset:7168
    s_waitcnt lgkmcnt(0)
    v_mfma_f32_16x16x32_bf16 v[96:99], v[64:67], v[128:131], 0
    v_mfma_f32_16x16x32_bf16 v[104:107], v[64:67], v[144:147], 0
    v_mfma_f32_16x16x32_bf16 v[96:99], v[68:71], v[132:135], v[96:99]
    v_mfma_f32_16x16x32_bf16 v[104:107], v[68:71], v[148:151], v[104:107]
    v_mfma_f32_16x16x32_bf16 v[96:99], v[72:75], v[136:139], v[96:99]
    v_mfma_f32_16x16x32_bf16 v[104:107], v[72:75], v[152:155], v[104:107]
    v_mfma_f32_16x16x32_bf16 v[96:99], v[76:79], v[140:143], v[96:99]
    v_mfma_f32_16x16x32_bf16 v[104:107], v[76:79], v[156:159], v[104:107]
    v_mfma_f32_16x16x32_bf16 v[100:103], v[80:83], v[128:131], 0
    v_mfma_f32_16x16x32_bf16 v[108:111], v[80:83], v[144:147], 0
    v_mfma_f32_16x16x32_bf16 v[100:103], v[84:87], v[132:135], v[100:103]
    v_mfma_f32_16x16x32_bf16 v[108:111], v[84:87], v[148:151], v[108:111]
    v_mfma_f32_16x16x32_bf16 v[100:103], v[88:91], v[136:139], v[100:103]
    v_mfma_f32_16x16x32_bf16 v[108:111], v[88:91], v[152:155], v[108:111]
    v_mfma_f32_16x16x32_bf16 v[100:103], v[92:95], v[140:143], v[100:103]
    v_mfma_f32_16x16x32_bf16 v[108:111], v[92:95], v[156:159], v[108:111]
    ds_read_b128 v[64:67], v2 offset:32768
    ds_read_b128 v[68:71], v2 offset:33792
    ds_read_b128 v[72:75], v2 offset:34816
    ds_read_b128 v[76:79], v2 offset:35840
    ds_read_b128 v[80:83], v2 offset:36864
    ds_read_b128 v[84:87], v2 offset:37888
    ds_read_b128 v[88:91], v2 offset:38912
    ds_read_b128 v[92:95], v2 offset:39936
    s_nop 1
    s_cmp_lt_i32 s50, 0
    s_cbranch_scc0 L_recurrent_scan__compressed_kv_cla__moe_arch_mod__prompt_kernel_rare_144
L_recurrent_scan__compressed_kv_cla__moe_arch_mod__prompt_kernel_back_145:
    v_max3_f32 v22, v96, v97, v98
    v_max3_f32 v22, v22, v99, v100
    v_max3_f32 v22, v22, v101, v102
    v_max3_f32 v22, v22, v103, v40
    v_mov_b32 v24, v22
    s_nop 1
    v_permlane16_swap_b32 v22, v24
    s_nop 1
    v_max_f32 v22, v22, v24
    v_mov_b32 v24, v22
    s_nop 1
    v_permlane32_swap_b32 v22, v24
    s_nop 1
    v_max_f32 v22, v22, v24
    v_sub_f32 v25, v40, v22
    v_exp_f32 v25, v25
    v_mov_b32 v40, v22
    v_mul_f32 v38, v38, v25
    v_mul_f32 v192, v192, v25
    v_mul_f32 v193, v193, v25
    v_mul_f32 v194, v194, v25
    v_mul_f32 v195, v195, v25
    v_mul_f32 v196, v196, v25
    v_mul_f32 v197, v197, v25
    v_mul_f32 v198, v198, v25
    v_mul_f32 v199, v199, v25
    v_mul_f32 v200, v200, v25
    v_mul_f32 v201, v201, v25
    v_mul_f32 v202, v202, v25
    v_mul_f32 v203, v203, v25
    v_mul_f32 v204, v204, v25
    v_mul_f32 v205, v205, v25
    v_mul_f32 v206, v206, v25
    v_mul_f32 v207, v207, v25
    v_mul_f32 v208, v208, v25
    v_mul_f32 v209, v209, v25
    v_mul_f32 v210, v210, v25
    v_mul_f32 v211, v211, v25
    v_mul_f32 v212, v212, v25
    v_mul_f32 v213, v213, v25
    v_mul_f32 v214, v214, v25
    v_mul_f32 v215, v215, v25
    v_mul_f32 v216, v216, v25
    v_mul_f32 v217, v217, v25
    v_mul_f32 v218, v218, v25
    v_mul_f32 v219, v219, v25
    v_mul_f32 v220, v220, v25
    v_mul_f32 v221, v221, v25
    v_mul_f32 v222, v222, v25
    v_mul_f32 v223, v223, v25
    v_sub_f32 v96, v96, v22
    v_sub_f32 v97, v97, v22
    v_sub_f32 v98, v98, v22
    v_sub_f32 v99, v99, v22
    v_sub_f32 v100, v100, v22
    v_sub_f32 v101, v101, v22
    v_sub_f32 v102, v102, v22
    v_sub_f32 v103, v103, v22
    v_max3_f32 v23, v104, v105, v106
    v_max3_f32 v23, v23, v107, v108
    v_max3_f32 v23, v23, v109, v110
    v_max3_f32 v23, v23, v111, v41
    v_mov_b32 v24, v23
    s_nop 1
    v_permlane16_swap_b32 v23, v24
    s_nop 1
    v_max_f32 v23, v23, v24
    v_mov_b32 v24, v23
    s_nop 1
    v_permlane32_swap_b32 v23, v24
    s_nop 1
    v_max_f32 v23, v23, v24
    v_sub_f32 v25, v41, v23
    v_exp_f32 v25, v25
    v_mov_b32 v41, v23
    v_mul_f32 v39, v39, v25
    v_mul_f32 v224, v224, v25
    v_mul_f32 v225, v225, v25
    v_mul_f32 v226, v226, v25
    v_mul_f32 v227, v227, v25
    v_mul_f32 v228, v228, v25
    v_mul_f32 v229, v229, v25
    v_mul_f32 v230, v230, v25
    v_mul_f32 v231, v231, v25
    v_mul_f32 v232, v232, v25
    v_mul_f32 v233, v233, v25
    v_mul_f32 v234, v234, v25
    v_mul_f32 v235, v235, v25
    v_mul_f32 v236, v236, v25
    v_mul_f32 v237, v237, v25
    v_mul_f32 v238, v238, v25
    v_mul_f32 v239, v239, v25
    v_mul_f32 v240, v240, v25
    v_mul_f32 v241, v241, v25
    v_mul_f32 v242, v242, v25
    v_mul_f32 v243, v243, v25
    v_mul_f32 v244, v244, v25
    v_mul_f32 v245, v245, v25
    v_mul_f32 v246, v246, v25
    v_mul_f32 v247, v247, v25
    v_mul_f32 v248, v248, v25
    v_mul_f32 v249, v249, v25
    v_mul_f32 v250, v250, v25
    v_mul_f32 v251, v251, v25
    v_mul_f32 v252, v252, v25
    v_mul_f32 v253, v253, v25
    v_mul_f32 v254, v254, v25
    v_mul_f32 v255, v255, v25
    v_sub_f32 v104, v104, v23
    v_sub_f32 v105, v105, v23
    v_sub_f32 v106, v106, v23
    v_sub_f32 v107, v107, v23
    v_sub_f32 v108, v108, v23
    v_sub_f32 v109, v109, v23
    v_sub_f32 v110, v110, v23
    v_sub_f32 v111, v111, v23
    v_exp_f32 v96, v96
    v_exp_f32 v97, v97
    v_exp_f32 v98, v98
    v_exp_f32 v99, v99
    v_exp_f32 v104, v104
    v_exp_f32 v105, v105
    v_exp_f32 v106, v106
    v_exp_f32 v107, v107
    v_exp_f32 v100, v100
    v_exp_f32 v101, v101
    v_exp_f32 v102, v102
    v_exp_f32 v103, v103
    v_exp_f32 v108, v108
    v_exp_f32 v109, v109
    v_exp_f32 v110, v110
    v_exp_f32 v111, v111
    v_add_f32 v38, v38, v96
    v_add_f32 v38, v38, v97
    v_cvt_pk_bf16_f32 v48, v96, v97
    v_add_f32 v38, v38, v98
    v_add_f32 v38, v38, v99
    v_cvt_pk_bf16_f32 v49, v98, v99
    v_add_f32 v39, v39, v104
    v_add_f32 v39, v39, v105
    v_cvt_pk_bf16_f32 v52, v104, v105
    v_add_f32 v39, v39, v106
    v_add_f32 v39, v39, v107
    v_cvt_pk_bf16_f32 v53, v106, v107
    v_add_f32 v38, v38, v100
    v_add_f32 v38, v38, v101
    v_cvt_pk_bf16_f32 v50, v100, v101
    v_add_f32 v38, v38, v102
    v_add_f32 v38, v38, v103
    v_cvt_pk_bf16_f32 v51, v102, v103
    v_add_f32 v39, v39, v108
    v_add_f32 v39, v39, v109
    v_cvt_pk_bf16_f32 v54, v108, v109
    v_add_f32 v39, v39, v110
    v_add_f32 v39, v39, v111
    v_cvt_pk_bf16_f32 v55, v110, v111
    s_waitcnt lgkmcnt(0)
    s_nop 0
    v_mfma_f32_16x16x32_bf16 v[192:195], v[64:67], v[48:51], v[192:195]
    v_mfma_f32_16x16x32_bf16 v[224:227], v[64:67], v[52:55], v[224:227]
    v_mfma_f32_16x16x32_bf16 v[196:199], v[68:71], v[48:51], v[196:199]
    v_mfma_f32_16x16x32_bf16 v[228:231], v[68:71], v[52:55], v[228:231]
    v_mfma_f32_16x16x32_bf16 v[200:203], v[72:75], v[48:51], v[200:203]
    v_mfma_f32_16x16x32_bf16 v[232:235], v[72:75], v[52:55], v[232:235]
    v_mfma_f32_16x16x32_bf16 v[204:207], v[76:79], v[48:51], v[204:207]
    v_mfma_f32_16x16x32_bf16 v[236:239], v[76:79], v[52:55], v[236:239]
    v_mfma_f32_16x16x32_bf16 v[208:211], v[80:83], v[48:51], v[208:211]
    v_mfma_f32_16x16x32_bf16 v[240:243], v[80:83], v[52:55], v[240:243]
    v_mfma_f32_16x16x32_bf16 v[212:215], v[84:87], v[48:51], v[212:215]
    v_mfma_f32_16x16x32_bf16 v[244:247], v[84:87], v[52:55], v[244:247]
    v_mfma_f32_16x16x32_bf16 v[216:219], v[88:91], v[48:51], v[216:219]
    v_mfma_f32_16x16x32_bf16 v[248:251], v[88:91], v[52:55], v[248:251]
    v_mfma_f32_16x16x32_bf16 v[220:223], v[92:95], v[48:51], v[220:223]
    v_mfma_f32_16x16x32_bf16 v[252:255], v[92:95], v[52:55], v[252:255]
L_recurrent_scan__compressed_kv_cla__moe_arch_mod__prompt_kernel_snext_143:
    v_add_u32 v2, 8192, v2
    s_add_u32 s50, s50, 32
    s_sub_u32 s41, s41, 1
    s_cmp_lg_u32 s41, 0
    s_cbranch_scc1 L_recurrent_scan__compressed_kv_cla__moe_arch_mod__prompt_kernel_sunit_142
    s_sub_u32 s40, s40, 1
    s_cmp_lg_u32 s40, 0
    s_cbranch_scc1 L_recurrent_scan__compressed_kv_cla__moe_arch_mod__prompt_kernel_stile_141
    v_mov_b32 v20, v38
    s_nop 1
    v_permlane16_swap_b32 v38, v20
    s_nop 1
    v_add_f32 v38, v38, v20
    v_mov_b32 v20, v38
    s_nop 1
    v_permlane32_swap_b32 v38, v20
    s_nop 1
    v_add_f32 v38, v38, v20
    v_mov_b32 v20, v39
    s_nop 1
    v_permlane16_swap_b32 v39, v20
    s_nop 1
    v_add_f32 v39, v39, v20
    v_mov_b32 v20, v39
    s_nop 1
    v_permlane32_swap_b32 v39, v20
    s_nop 1
    v_add_f32 v39, v39, v20
    s_mov_b32 s36, 0x5d800000
    v_cmp_nge_f32 vcc, s36, v38
    s_nop 0
    s_or_b64 s[52:53], s[52:53], vcc
    v_cmp_nge_f32 vcc, s36, v39
    s_nop 0
    s_or_b64 s[52:53], s[52:53], vcc
    v_rcp_f32 v38, v38
    v_rcp_f32 v39, v39
    s_lshl_b32 s38, s39, 3
    s_and_b32 s37, s28, 3
    s_lshl_b32 s37, s37, 1
    s_add_u32 s38, s38, s37
    s_lshl_b32 s38, s38, 17
    s_lshl_b32 s37, s29, 12
    s_add_u32 s38, s38, s37
    v_mul_f32 v192, v38, v192
    v_mul_f32 v193, v38, v193
    v_mul_f32 v194, v38, v194
    v_mul_f32 v195, v38, v195
    v_mul_f32 v196, v38, v196
    v_mul_f32 v197, v38, v197
    v_mul_f32 v198, v38, v198
    v_mul_f32 v199, v38, v199
    v_cvt_pk_bf16_f32 v22, v192, v193
    v_cvt_pk_bf16_f32 v23, v194, v195
    v_cvt_pk_bf16_f32 v24, v196, v197
    v_cvt_pk_bf16_f32 v25, v198, v199
    buffer_store_dwordx4 v[22:25], v7, s[16:19], s38 offen offset:0 sc1
    v_mul_f32 v200, v38, v200
    v_mul_f32 v201, v38, v201
    v_mul_f32 v202, v38, v202
    v_mul_f32 v203, v38, v203
    v_mul_f32 v204, v38, v204
    v_mul_f32 v205, v38, v205
    v_mul_f32 v206, v38, v206
    v_mul_f32 v207, v38, v207
    v_cvt_pk_bf16_f32 v26, v200, v201
    v_cvt_pk_bf16_f32 v27, v202, v203
    v_cvt_pk_bf16_f32 v28, v204, v205
    v_cvt_pk_bf16_f32 v29, v206, v207
    buffer_store_dwordx4 v[26:29], v7, s[16:19], s38 offen offset:1024 sc1
    v_mul_f32 v208, v38, v208
    v_mul_f32 v209, v38, v209
    v_mul_f32 v210, v38, v210
    v_mul_f32 v211, v38, v211
    v_mul_f32 v212, v38, v212
    v_mul_f32 v213, v38, v213
    v_mul_f32 v214, v38, v214
    v_mul_f32 v215, v38, v215
    v_cvt_pk_bf16_f32 v30, v208, v209
    v_cvt_pk_bf16_f32 v31, v210, v211
    v_cvt_pk_bf16_f32 v32, v212, v213
    v_cvt_pk_bf16_f32 v33, v214, v215
    buffer_store_dwordx4 v[30:33], v7, s[16:19], s38 offen offset:2048 sc1
    v_mul_f32 v216, v38, v216
    v_mul_f32 v217, v38, v217
    v_mul_f32 v218, v38, v218
    v_mul_f32 v219, v38, v219
    v_mul_f32 v220, v38, v220
    v_mul_f32 v221, v38, v221
    v_mul_f32 v222, v38, v222
    v_mul_f32 v223, v38, v223
    v_cvt_pk_bf16_f32 v34, v216, v217
    v_cvt_pk_bf16_f32 v35, v218, v219
    v_cvt_pk_bf16_f32 v36, v220, v221
    v_cvt_pk_bf16_f32 v37, v222, v223
    buffer_store_dwordx4 v[34:37], v7, s[16:19], s38 offen offset:3072 sc1
    s_add_u32 s38, s38, 131072
    v_mul_f32 v224, v39, v224
    v_mul_f32 v225, v39, v225
    v_mul_f32 v226, v39, v226
    v_mul_f32 v227, v39, v227
    v_mul_f32 v228, v39, v228
    v_mul_f32 v229, v39, v229
    v_mul_f32 v230, v39, v230
    v_mul_f32 v231, v39, v231
    v_cvt_pk_bf16_f32 v22, v224, v225
    v_cvt_pk_bf16_f32 v23, v226, v227
    v_cvt_pk_bf16_f32 v24, v228, v229
    v_cvt_pk_bf16_f32 v25, v230, v231
    buffer_store_dwordx4 v[22:25], v7, s[16:19], s38 offen offset:0 sc1
    v_mul_f32 v232, v39, v232
    v_mul_f32 v233, v39, v233
    v_mul_f32 v234, v39, v234
    v_mul_f32 v235, v39, v235
    v_mul_f32 v236, v39, v236
    v_mul_f32 v237, v39, v237
    v_mul_f32 v238, v39, v238
    v_mul_f32 v239, v39, v239
    v_cvt_pk_bf16_f32 v26, v232, v233
    v_cvt_pk_bf16_f32 v27, v234, v235
    v_cvt_pk_bf16_f32 v28, v236, v237
    v_cvt_pk_bf16_f32 v29, v238, v239
    buffer_store_dwordx4 v[26:29], v7, s[16:19], s38 offen offset:1024 sc1
    v_mul_f32 v240, v39, v240
    v_mul_f32 v241, v39, v241
    v_mul_f32 v242, v39, v242
    v_mul_f32 v243, v39, v243
    v_mul_f32 v244, v39, v244
    v_mul_f32 v245, v39, v245
    v_mul_f32 v246, v39, v246
    v_mul_f32 v247, v39, v247
    v_cvt_pk_bf16_f32 v30, v240, v241
    v_cvt_pk_bf16_f32 v31, v242, v243
    v_cvt_pk_bf16_f32 v32, v244, v245
    v_cvt_pk_bf16_f32 v33, v246, v247
    buffer_store_dwordx4 v[30:33], v7, s[16:19], s38 offen offset:2048 sc1
    v_mul_f32 v248, v39, v248
    v_mul_f32 v249, v39, v249
    v_mul_f32 v250, v39, v250
    v_mul_f32 v251, v39, v251
    v_mul_f32 v252, v39, v252
    v_mul_f32 v253, v39, v253
    v_mul_f32 v254, v39, v254
    v_mul_f32 v255, v39, v255
    v_cvt_pk_bf16_f32 v34, v248, v249
    v_cvt_pk_bf16_f32 v35, v250, v251
    v_cvt_pk_bf16_f32 v36, v252, v253
    v_cvt_pk_bf16_f32 v37, v254, v255
    buffer_store_dwordx4 v[34:37], v7, s[16:19], s38 offen offset:3072 sc1
    s_branch L_p3_done
L_recurrent_scan__compressed_kv_cla__moe_arch_mod__prompt_kernel_rare_1:
    v_lshlrev_b32 v16, 7, v1
    global_store_dword v16, v118, s[90:91] sc1
    v_add_u32 v16, 8192, v16
    global_store_dword v16, v118, s[90:91] sc1
    s_waitcnt vmcnt(0)
    s_branch L_recurrent_scan__compressed_kv_cla__moe_arch_mod__prompt_kernel_back_2
L_recurrent_scan__compressed_kv_cla__moe_arch_mod__prompt_kernel_rare_3:
    v_and_b32 v108, 7, v1
    v_lshlrev_b32 v108, 3, v108
    v_add_u32 v109, 147712, v108
    ds_read_b64 v[110:111], v109
    ds_read_b32 v112, v109 offset:64
    s_lshl_b32 s36, s2, 6
    s_add_u32 s36, s36, 4194304
    s_lshl_b32 s37, s2, 3
    s_add_u32 s37, s37, 4276224
    s_waitcnt lgkmcnt(0)
    v_mov_b32 v114, v112
    s_nop 1
    v_max_u32_dpp v114, v114, v114 quad_perm:[1,0,3,2] row_mask:0xf bank_mask:0xf
    s_nop 1
    v_max_u32_dpp v114, v114, v114 quad_perm:[2,3,0,1] row_mask:0xf bank_mask:0xf
    s_nop 1
    v_max_u32_dpp v114, v114, v114 row_half_mirror row_mask:0xf bank_mask:0xf
    v_cmp_eq_u32 vcc, v114, v112
    s_nop 1
    v_cndmask_b32 v115, v112, v118, vcc
    s_nop 1
    v_max_u32_dpp v115, v115, v115 quad_perm:[1,0,3,2] row_mask:0xf bank_mask:0xf
    s_nop 1
    v_max_u32_dpp v115, v115, v115 quad_perm:[2,3,0,1] row_mask:0xf bank_mask:0xf
    s_nop 1
    v_max_u32_dpp v115, v115, v115 row_half_mirror row_mask:0xf bank_mask:0xf
    s_mov_b64 exec, 0xff
    buffer_store_dwordx2 v[110:111], v108, s[24:27], s36 offen sc1
    s_mov_b64 exec, 1
    buffer_store_dwordx2 v[114:115], v108, s[24:27], s37 offen sc1
    s_mov_b64 exec, -1
    s_nop 3
    s_branch L_recurrent_scan__compressed_kv_cla__moe_arch_mod__prompt_kernel_back_4
L_recurrent_scan__compressed_kv_cla__moe_arch_mod__prompt_kernel_rare_5:
    v_lshrrev_b32 v18, 4, v1
    s_lshl_b32 s37, s28, 4
    v_add_u32 v19, s37, v18
    v_lshlrev_b32 v19, 13, v19
    s_lshl_b32 s37, s29, 8
    v_add_u32 v19, s37, v19
    v_and_b32 v16, 15, v1
    v_lshlrev_b32 v17, 1, v18
    v_xor_b32 v17, v16, v17
    v_lshl_add_u32 v2, v17, 4, v19
    v_add_u32 v3, 31744, v2
    v_xor_b32 v17, 8, v17
    v_lshl_add_u32 v4, v17, 4, v19
    v_add_u32 v4, 63488, v4
    v_add_u32 v5, 31744, v4
    s_mov_b32 s4, s96
    s_and_b32 s5, s97, 0xffff
    s_mov_b32 s6, 8388608
    s_mov_b32 s7, 0x20000
    s_mov_b32 s31, 0
    s_mov_b32 s40, 1048576
    s_mov_b32 s32, 0
    s_mov_b32 s41, 0
    s_and_b32 s38, s2, 3
    s_lshl_b32 s38, s38, 8
    s_lshr_b32 s39, s2, 2
    s_lshl_b32 s39, s39, 7
    v_lshrrev_b32 v7, 3, v1
    s_lshl_b32 s36, s28, 5
    s_add_u32 s36, s36, s38
    v_add_u32 v7, s36, v7
    v_mul_u32_u24 v7, 7168, v7
    v_add_u32 v7, s39, v7
    v_bfe_u32 v8, v1, 4, 1
    v_lshlrev_b32 v8, 1, v8
    v_and_b32 v9, 7, v1
    v_xor_b32 v8, v8, v9
    v_lshl_add_u32 v6, v8, 4, v7
    v_xor_b32 v8, 4, v8
    v_lshl_add_u32 v7, v8, 4, v7
    v_add_u32 v7, 56320, v7
    v_add_u32 v8, 112640, v6
    v_add_u32 v9, 112640, v7
    s_mov_b32 s8, s92
    s_and_b32 s9, s93, 0xffff
    s_mov_b32 s10, 7340032
    s_mov_b32 s11, 0x20000
    s_cmp_lt_u32 s2, 224
    s_cselect_b32 s10, s10, 0
    s_branch L_recurrent_scan__compressed_kv_cla__moe_arch_mod__prompt_kernel_back_6
L_recurrent_scan__compressed_kv_cla__moe_arch_mod__prompt_kernel_w0_7:
    s_cmp_eq_u32 s35, 0
    s_cbranch_scc0 L_recurrent_scan__compressed_kv_cla__moe_arch_mod__prompt_kernel_swn_10
    s_waitcnt vmcnt(4)
    s_branch L_recurrent_scan__compressed_kv_cla__moe_arch_mod__prompt_kernel_swend_9
L_recurrent_scan__compressed_kv_cla__moe_arch_mod__prompt_kernel_swn_10:
    s_waitcnt vmcnt(1)
L_recurrent_scan__compressed_kv_cla__moe_arch_mod__prompt_kernel_swend_9:
    s_branch L_recurrent_scan__compressed_kv_cla__moe_arch_mod__prompt_kernel_w0b_8
L_recurrent_scan__compressed_kv_cla__moe_arch_mod__prompt_kernel_tch_11:
    s_cmp_eq_u32 s35, 0
    s_cbranch_scc0 L_recurrent_scan__compressed_kv_cla__moe_arch_mod__prompt_kernel_swn_14
    v_and_b32 v19, 31, v1
    s_lshl_b32 s36, s30, 7
    s_lshl_b32 s37, s28, 4
    s_add_u32 s36, s36, s37
    v_lshrrev_b32 v16, 1, v19
    v_add_u32 v16, s36, v16
    v_lshlrev_b32 v16, 13, v16
    v_and_b32 v17, 1, v1
    v_lshl_add_u32 v16, v17, 7, v16
    s_lshl_b32 s36, s29, 8
    v_add_u32 v16, s36, v16
    v_mov_b32 v17, v16
    v_cmp_lt_u32 vcc, 31, v1
    v_mov_b32 v18, s96
    v_mov_b32 v19, s96
    v_cndmask_b32 v16, v16, v17, vcc
    v_cndmask_b32 v18, v18, v19, vcc
    v_mov_b32 v17, s97
    v_mov_b32 v19, s97
    v_cndmask_b32 v17, v17, v19, vcc
    v_add_co_u32 v16, vcc, v18, v16
    s_nop 1
    v_addc_co_u32 v17, vcc, 0, v17, vcc
    global_load_dword v116, v[16:17], off
    s_branch L_recurrent_scan__compressed_kv_cla__moe_arch_mod__prompt_kernel_swend_13
L_recurrent_scan__compressed_kv_cla__moe_arch_mod__prompt_kernel_swn_14:
    s_cmp_eq_u32 s35, 1
    s_cbranch_scc0 L_recurrent_scan__compressed_kv_cla__moe_arch_mod__prompt_kernel_swn_15
    v_and_b32 v19, 31, v1
    s_min_u32 s37, s2, 223
    s_and_b32 s36, s37, 3
    s_lshl_b32 s36, s36, 8
    s_lshr_b32 s37, s37, 2
    s_lshl_b32 s37, s37, 7
    s_lshl_b32 s38, s28, 5
    s_add_u32 s36, s36, s38
    v_add_u32 v16, s36, v19
    v_mul_u32_u24 v16, 7168, v16
    v_add_u32 v16, s37, v16
    v_mov_b32 v17, v16
    v_cmp_lt_u32 vcc, 31, v1
    v_mov_b32 v18, s92
    v_mov_b32 v19, s94
    v_cndmask_b32 v16, v16, v17, vcc
    v_cndmask_b32 v18, v18, v19, vcc
    v_mov_b32 v17, s93
    v_mov_b32 v19, s95
    v_cndmask_b32 v17, v17, v19, vcc
    v_add_co_u32 v16, vcc, v18, v16
    s_nop 1
    v_addc_co_u32 v17, vcc, 0, v17, vcc
    global_load_dword v116, v[16:17], off
    s_branch L_recurrent_scan__compressed_kv_cla__moe_arch_mod__prompt_kernel_swend_13
L_recurrent_scan__compressed_kv_cla__moe_arch_mod__prompt_kernel_swn_15:
    global_load_dword v116, v118, s[96:97]
L_recurrent_scan__compressed_kv_cla__moe_arch_mod__prompt_kernel_swend_13:
    s_branch L_recurrent_scan__compressed_kv_cla__moe_arch_mod__prompt_kernel_tchb_12
L_recurrent_scan__compressed_kv_cla__moe_arch_mod__prompt_kernel_rare_16:
    global_load_dword v119, v118, s[88:89] sc1
    s_branch L_recurrent_scan__compressed_kv_cla__moe_arch_mod__prompt_kernel_back_17
L_recurrent_scan__compressed_kv_cla__moe_arch_mod__prompt_kernel_rare_22:
    s_mov_b32 s61, 0x40000
L_recurrent_scan__compressed_kv_cla__moe_arch_mod__prompt_kernel_spin_20:
    s_sub_u32 s61, s61, 1
    s_cbranch_scc1 L_recurrent_scan__compressed_kv_cla__moe_arch_mod__prompt_kernel_spinx_21
    s_sleep 8
    global_load_dword v119, v118, s[88:89] sc1
    s_waitcnt vmcnt(0)
    v_readfirstlane_b32 s36, v119
    s_nop 0
    s_cmp_lt_u32 s36, 256
    s_cbranch_scc1 L_recurrent_scan__compressed_kv_cla__moe_arch_mod__prompt_kernel_spin_20
L_recurrent_scan__compressed_kv_cla__moe_arch_mod__prompt_kernel_spinx_21:
    s_branch L_recurrent_scan__compressed_kv_cla__moe_arch_mod__prompt_kernel_back_23
L_recurrent_scan__compressed_kv_cla__moe_arch_mod__prompt_kernel_w0_18:
    s_waitcnt vmcnt(0)
    v_readfirstlane_b32 s36, v119
    s_nop 0
    s_cmp_lt_u32 s36, 256
    s_cbranch_scc1 L_recurrent_scan__compressed_kv_cla__moe_arch_mod__prompt_kernel_rare_22
L_recurrent_scan__compressed_kv_cla__moe_arch_mod__prompt_kernel_back_23:
    s_branch L_recurrent_scan__compressed_kv_cla__moe_arch_mod__prompt_kernel_w0b_19
L_recurrent_scan__compressed_kv_cla__moe_arch_mod__prompt_kernel_rare_24:
    v_mov_b32 v16, 0
    v_mov_b32 v17, 1
    s_mov_b64 exec, 1
    global_atomic_add v16, v17, s[88:89]
    s_mov_b64 exec, -1
    s_nop 3
    s_branch L_recurrent_scan__compressed_kv_cla__moe_arch_mod__prompt_kernel_back_25
L_recurrent_scan__compressed_kv_cla__moe_arch_mod__prompt_kernel_rare_26:
    v_lshrrev_b32 v18, 4, v1
    s_lshl_b32 s37, s28, 4
    v_add_u32 v19, s37, v18
    v_lshlrev_b32 v19, 13, v19
    s_lshl_b32 s37, s29, 8
    v_add_u32 v19, s37, v19
    v_and_b32 v16, 15, v1
    v_lshlrev_b32 v17, 1, v18
    v_xor_b32 v17, v16, v17
    v_lshl_add_u32 v2, v17, 4, v19
    v_add_u32 v3, 31744, v2
    v_xor_b32 v17, 8, v17
    v_lshl_add_u32 v4, v17, 4, v19
    v_add_u32 v4, 63488, v4
    v_add_u32 v5, 31744, v4
    s_mov_b32 s4, s96
    s_and_b32 s5, s97, 0xffff
    s_mov_b32 s6, 8388608
    s_mov_b32 s7, 0x20000
    s_mov_b32 s31, 0
    s_mov_b32 s40, 1048576
    s_mov_b32 s32, 0
    s_mov_b32 s41, 0
    s_and_b32 s38, s2, 3
    s_lshl_b32 s38, s38, 8
    s_lshr_b32 s39, s2, 2
    s_lshl_b32 s39, s39, 7
    v_lshrrev_b32 v7, 3, v1
    s_lshl_b32 s36, s28, 5
    s_add_u32 s36, s36, s38
    v_add_u32 v7, s36, v7
    v_mul_u32_u24 v7, 7168, v7
    v_add_u32 v7, s39, v7
    v_bfe_u32 v8, v1, 4, 1
    v_lshlrev_b32 v8, 1, v8
    v_and_b32 v9, 7, v1
    v_xor_b32 v8, v8, v9
    v_lshl_add_u32 v6, v8, 4, v7
    v_xor_b32 v8, 4, v8
    v_lshl_add_u32 v7, v8, 4, v7
    v_add_u32 v7, 56320, v7
    v_add_u32 v8, 112640, v6
    v_add_u32 v9, 112640, v7
    s_mov_b32 s8, s92
    s_and_b32 s9, s93, 0xffff
    s_mov_b32 s10, 7340032
    s_mov_b32 s11, 0x20000
    s_cmp_lt_u32 s2, 224
    s_cselect_b32 s10, s10, 0
    s_branch L_recurrent_scan__compressed_kv_cla__moe_arch_mod__prompt_kernel_back_27
L_recurrent_scan__compressed_kv_cla__moe_arch_mod__prompt_kernel_w0_28:
    s_cmp_eq_u32 s35, 0
    s_cbranch_scc0 L_recurrent_scan__compressed_kv_cla__moe_arch_mod__prompt_kernel_swn_31
    s_waitcnt vmcnt(4)
    s_branch L_recurrent_scan__compressed_kv_cla__moe_arch_mod__prompt_kernel_swend_30
L_recurrent_scan__compressed_kv_cla__moe_arch_mod__prompt_kernel_swn_31:
    s_waitcnt vmcnt(1)
L_recurrent_scan__compressed_kv_cla__moe_arch_mod__prompt_kernel_swend_30:
    s_branch L_recurrent_scan__compressed_kv_cla__moe_arch_mod__prompt_kernel_w0b_29
L_recurrent_scan__compressed_kv_cla__moe_arch_mod__prompt_kernel_tch_32:
    s_cmp_eq_u32 s35, 0
    s_cbranch_scc0 L_recurrent_scan__compressed_kv_cla__moe_arch_mod__prompt_kernel_swn_35
    v_and_b32 v19, 31, v1
    s_lshl_b32 s36, s30, 7
    s_lshl_b32 s37, s28, 4
    s_add_u32 s36, s36, s37
    v_lshrrev_b32 v16, 1, v19
    v_add_u32 v16, s36, v16
    v_lshlrev_b32 v16, 13, v16
    v_and_b32 v17, 1, v1
    v_lshl_add_u32 v16, v17, 7, v16
    s_lshl_b32 s36, s29, 8
    v_add_u32 v16, s36, v16
    v_mov_b32 v17, v16
    v_cmp_lt_u32 vcc, 31, v1
    v_mov_b32 v18, s96
    v_mov_b32 v19, s96
    v_cndmask_b32 v16, v16, v17, vcc
    v_cndmask_b32 v18, v18, v19, vcc
    v_mov_b32 v17, s97
    v_mov_b32 v19, s97
    v_cndmask_b32 v17, v17, v19, vcc
    v_add_co_u32 v16, vcc, v18, v16
    s_nop 1
    v_addc_co_u32 v17, vcc, 0, v17, vcc
    global_load_dword v116, v[16:17], off
    s_branch L_recurrent_scan__compressed_kv_cla__moe_arch_mod__prompt_kernel_swend_34
L_recurrent_scan__compressed_kv_cla__moe_arch_mod__prompt_kernel_swn_35:
    s_cmp_eq_u32 s35, 1
    s_cbranch_scc0 L_recurrent_scan__compressed_kv_cla__moe_arch_mod__prompt_kernel_swn_36
    v_and_b32 v19, 31, v1
    s_min_u32 s37, s2, 223
    s_and_b32 s36, s37, 3
    s_lshl_b32 s36, s36, 8
    s_lshr_b32 s37, s37, 2
    s_lshl_b32 s37, s37, 7
    s_lshl_b32 s38, s28, 5
    s_add_u32 s36, s36, s38
    v_add_u32 v16, s36, v19
    v_mul_u32_u24 v16, 7168, v16
    v_add_u32 v16, s37, v16
    v_mov_b32 v17, v16
    v_cmp_lt_u32 vcc, 31, v1
    v_mov_b32 v18, s92
    v_mov_b32 v19, s94
    v_cndmask_b32 v16, v16, v17, vcc
    v_cndmask_b32 v18, v18, v19, vcc
    v_mov_b32 v17, s93
    v_mov_b32 v19, s95
    v_cndmask_b32 v17, v17, v19, vcc
    v_add_co_u32 v16, vcc, v18, v16
    s_nop 1
    v_addc_co_u32 v17, vcc, 0, v17, vcc
    global_load_dword v116, v[16:17], off
    s_branch L_recurrent_scan__compressed_kv_cla__moe_arch_mod__prompt_kernel_swend_34
L_recurrent_scan__compressed_kv_cla__moe_arch_mod__prompt_kernel_swn_36:
    global_load_dword v116, v118, s[96:97]
L_recurrent_scan__compressed_kv_cla__moe_arch_mod__prompt_kernel_swend_34:
    s_branch L_recurrent_scan__compressed_kv_cla__moe_arch_mod__prompt_kernel_tchb_33
L_recurrent_scan__compressed_kv_cla__moe_arch_mod__prompt_kernel_rare_43:
    s_mov_b32 s61, 0x40000
L_recurrent_scan__compressed_kv_cla__moe_arch_mod__prompt_kernel_spin_41:
    s_sub_u32 s61, s61, 1
    s_cbranch_scc1 L_recurrent_scan__compressed_kv_cla__moe_arch_mod__prompt_kernel_spinx_42
    s_sleep 8
    global_load_dword v56, v57, s[90:91] sc1
    s_waitcnt vmcnt(0)
    v_readfirstlane_b32 s36, v56
    s_nop 0
    s_cmp_lt_u32 s36, 1
    s_cbranch_scc1 L_recurrent_scan__compressed_kv_cla__moe_arch_mod__prompt_kernel_spin_41
L_recurrent_scan__compressed_kv_cla__moe_arch_mod__prompt_kernel_spinx_42:
    s_branch L_recurrent_scan__compressed_kv_cla__moe_arch_mod__prompt_kernel_back_44
L_recurrent_scan__compressed_kv_cla__moe_arch_mod__prompt_kernel_rare_51:
    s_cmp_lt_u32 s28, 4
    s_cbranch_scc0 L_recurrent_scan__compressed_kv_cla__moe_arch_mod__prompt_kernel_ng_48
    s_cmp_eq_u32 s35, 2
    s_cbranch_scc0 L_recurrent_scan__compressed_kv_cla__moe_arch_mod__prompt_kernel_swn_50
    s_mov_b32 s36, 4276224
    buffer_load_dwordx4 v[128:131], v58, s[24:27], s36 offen offset:0 sc1
    buffer_load_dwordx4 v[132:135], v58, s[24:27], s36 offen offset:1024 sc1
    s_branch L_recurrent_scan__compressed_kv_cla__moe_arch_mod__prompt_kernel_swend_49
L_recurrent_scan__compressed_kv_cla__moe_arch_mod__prompt_kernel_swn_50:
    s_cmp_lt_u32 s2, 224
    s_cbranch_scc0 L_recurrent_scan__compressed_kv_cla__moe_arch_mod__prompt_kernel_g_46
    v_lshrrev_b32 v62, 4, v1
    v_bfe_u32 v22, v1, 2, 2
    v_lshl_add_u32 v22, v62, 3, v22
    v_lshlrev_b32 v22, 7, v22
    v_and_b32 v23, 3, v1
    v_lshl_add_u32 v22, v23, 3, v22
    v_bfe_u32 v23, v1, 3, 2
    s_and_b32 s36, s28, 3
    v_xor_b32 v23, s36, v23
    v_lshl_add_u32 v63, v23, 5, v22
    s_lshr_b32 s36, s28, 2
    s_lshl_b32 s36, s36, 15
    s_add_u32 s36, s36, 65536
    v_add_u32 v63, s36, v63
    ds_read_b64_tr_b16 v[160:161], v63 offset:0
    ds_read_b64_tr_b16 v[162:163], v63 offset:512
    ds_read_b64_tr_b16 v[164:165], v63 offset:4096
    ds_read_b64_tr_b16 v[166:167], v63 offset:4608
    ds_read_b64_tr_b16 v[168:169], v63 offset:8192
    ds_read_b64_tr_b16 v[170:171], v63 offset:8704
    ds_read_b64_tr_b16 v[172:173], v63 offset:12288
    ds_read_b64_tr_b16 v[174:175], v63 offset:12800
    s_and_b32 s36, s2, 3
    s_lshl_b32 s36, s36, 1
    s_lshr_b32 s37, s28, 2
    s_add_u32 s36, s36, s37
    s_mul_i32 s36, s36, 28672
    s_lshr_b32 s37, s2, 2
    s_lshl_b32 s37, s37, 8
    s_add_u32 s36, s36, s37
    s_and_b32 s37, s28, 3
    s_lshl_b32 s37, s37, 6
    s_add_u32 s36, s36, s37
    s_add_u32 s36, s36, 58720256
    v_mul_u32_u24 v62, 14336, v18
    v_lshl_add_u32 v62, v21, 4, v62
    s_waitcnt lgkmcnt(0)
    s_waitcnt vmcnt(12)
    v_mfma_f32_16x16x32_bf16 v[20:23], v[160:163], v[128:131], 0
    v_mfma_f32_16x16x32_bf16 v[20:23], v[164:167], v[132:135], v[20:23]
    v_mfma_f32_16x16x32_bf16 v[20:23], v[168:171], v[136:139], v[20:23]
    v_mfma_f32_16x16x32_bf16 v[20:23], v[172:175], v[140:143], v[20:23]
    ds_read_b64_tr_b16 v[160:161], v63 offset:16384
    ds_read_b64_tr_b16 v[162:163], v63 offset:16896
    ds_read_b64_tr_b16 v[164:165], v63 offset:20480
    ds_read_b64_tr_b16 v[166:167], v63 offset:20992
    ds_read_b64_tr_b16 v[168:169], v63 offset:24576
    ds_read_b64_tr_b16 v[170:171], v63 offset:25088
    ds_read_b64_tr_b16 v[172:173], v63 offset:28672
    ds_read_b64_tr_b16 v[174:175], v63 offset:29184
    s_waitcnt lgkmcnt(0)
    v_mfma_f32_16x16x32_bf16 v[20:23], v[160:163], v[144:147], v[20:23]
    v_mfma_f32_16x16x32_bf16 v[20:23], v[164:167], v[148:151], v[20:23]
    v_mfma_f32_16x16x32_bf16 v[20:23], v[168:171], v[152:155], v[20:23]
    v_mfma_f32_16x16x32_bf16 v[20:23], v[172:175], v[156:159], v[20:23]
    s_nop 5
    s_mov_b32 exec_lo, 0x00030003
    s_mov_b32 exec_hi, 0x00030003
    buffer_store_dwordx4 v[20:23], v62, s[24:27], s36 offen sc1
    s_mov_b64 exec, -1
    s_nop 3
L_recurrent_scan__compressed_kv_cla__moe_arch_mod__prompt_kernel_g_46:
    s_mov_b64 s[4:5], s[12:13]
    s_mov_b32 s6, s14
    s_mov_b32 s31, s45
    s_mov_b32 s40, 65536
    v_add_u32 v2, s33, v58
    v_mov_b32 v3, v2
    v_mov_b32 v4, v2
    v_mov_b32 v5, v2
    s_cmp_eq_u32 s28, 0
    s_cbranch_scc0 L_recurrent_scan__compressed_kv_cla__moe_arch_mod__prompt_kernel_g_45
    s_waitcnt vmcnt(12)
    v_readfirstlane_b32 s36, v56
    s_nop 0
    s_cmp_lt_u32 s36, 1
    s_cbranch_scc1 L_recurrent_scan__compressed_kv_cla__moe_arch_mod__prompt_kernel_rare_43
L_recurrent_scan__compressed_kv_cla__moe_arch_mod__prompt_kernel_back_44:
L_recurrent_scan__compressed_kv_cla__moe_arch_mod__prompt_kernel_g_45:
L_recurrent_scan__compressed_kv_cla__moe_arch_mod__prompt_kernel_swend_49:
L_recurrent_scan__compressed_kv_cla__moe_arch_mod__prompt_kernel_ng_48:
    s_branch L_recurrent_scan__compressed_kv_cla__moe_arch_mod__prompt_kernel_back_52
L_recurrent_scan__compressed_kv_cla__moe_arch_mod__prompt_kernel_rare_56:
    s_cmp_lt_u32 s28, 4
    s_cbranch_scc0 L_recurrent_scan__compressed_kv_cla__moe_arch_mod__prompt_kernel_ng_53
    s_cmp_eq_u32 s35, 2
    s_cbranch_scc0 L_recurrent_scan__compressed_kv_cla__moe_arch_mod__prompt_kernel_swn_55
    s_waitcnt vmcnt(12)
    v_max_u32 v18, v128, v129
    v_min_u32 v19, v128, v129
    v_med3_u32 v19, v18, v19, v130
    v_max_u32 v18, v18, v130
    v_med3_u32 v19, v18, v19, v131
    v_max_u32 v18, v18, v131
    v_med3_u32 v19, v18, v19, v132
    v_max_u32 v18, v18, v132
    v_med3_u32 v19, v18, v19, v133
    v_max_u32 v18, v18, v133
    v_med3_u32 v19, v18, v19, v134
    v_max_u32 v18, v18, v134
    v_med3_u32 v19, v18, v19, v135
    v_max_u32 v18, v18, v135
    v_mov_b32 v20, v18
    s_nop 1
    v_max_u32_dpp v20, v20, v20 quad_perm:[1,0,3,2] row_mask:0xf bank_mask:0xf
    s_nop 1
    v_max_u32_dpp v20, v20, v20 quad_perm:[2,3,0,1] row_mask:0xf bank_mask:0xf
    s_nop 1
    v_max_u32_dpp v20, v20, v20 row_half_mirror row_mask:0xf bank_mask:0xf
    s_nop 1
    v_max_u32_dpp v20, v20, v20 row_mirror row_mask:0xf bank_mask:0xf
    s_nop 0
    v_readlane_b32 s36, v20, 0
    v_readlane_b32 s37, v20, 16
    v_readlane_b32 s38, v20, 32
    v_readlane_b32 s39, v20, 48
    s_max_u32 s36, s36, s37
    s_max_u32 s38, s38, s39
    s_max_u32 s36, s36, s38
    s_mov_b32 s58, s36
    v_cmp_eq_u32 vcc, s58, v18
    s_nop 1
    v_cndmask_b32 v20, v18, v19, vcc
    s_nop 1
    v_max_u32_dpp v20, v20, v20 quad_perm:[1,0,3,2] row_mask:0xf bank_mask:0xf
    s_nop 1
    v_max_u32_dpp v20, v20, v20 quad_perm:[2,3,0,1] row_mask:0xf bank_mask:0xf
    s_nop 1
    v_max_u32_dpp v20, v20, v20 row_half_mirror row_mask:0xf bank_mask:0xf
    s_nop 1
    v_max_u32_dpp v20, v20, v20 row_mirror row_mask:0xf bank_mask:0xf
    s_nop 0
    v_readlane_b32 s36, v20, 0
    v_readlane_b32 s37, v20, 16
    v_readlane_b32 s38, v20, 32
    v_readlane_b32 s39, v20, 48
    s_max_u32 s36, s36, s37
    s_max_u32 s38, s38, s39
    s_max_u32 s36, s36, s38
    s_mov_b32 s59, s36
    s_and_b32 s36, s58, 0xffff
    s_sub_u32 s56, 0xffff, s36
    s_and_b32 s36, s59, 0xffff
    s_sub_u32 s57, 0xffff, s36
    v_and_b32 v18, 1, v1
    v_mov_b32 v19, s56
    v_mov_b32 v20, s57
    v_cmp_eq_u32 vcc, 1, v18
    s_nop 1
    v_cndmask_b32 v19, v19, v20, vcc
    v_lshrrev_b32 v20, 4, v19
    v_lshlrev_b32 v20, 15, v20
    v_and_b32 v19, 15, v19
    v_lshl_add_u32 v20, v19, 4, v20
    v_lshrrev_b32 v21, 4, v1
    v_lshl_add_u32 v20, v21, 8, v20
    s_and_b32 s36, s2, 3
    s_lshl_b32 s36, s36, 13
    s_add_u32 s37, s36, 4096
    s_mov_b32 exec_lo, 0x00030003
    s_mov_b32 exec_hi, 0x00030003
    buffer_load_dwordx4 v[128:131], v20, s[24:27], s36 offen offset:0 sc1
    buffer_load_dwordx4 v[132:135], v20, s[24:27], s36 offen offset:1024 sc1
    buffer_load_dwordx4 v[136:139], v20, s[24:27], s36 offen offset:2048 sc1
    buffer_load_dwordx4 v[140:143], v20, s[24:27], s36 offen offset:3072 sc1
    buffer_load_dwordx4 v[144:147], v20, s[24:27], s37 offen offset:0 sc1
    buffer_load_dwordx4 v[148:151], v20, s[24:27], s37 offen offset:1024 sc1
    buffer_load_dwordx4 v[152:155], v20, s[24:27], s37 offen offset:2048 sc1
    buffer_load_dwordx4 v[156:159], v20, s[24:27], s37 offen offset:3072 sc1
    s_mov_b64 exec, -1
    s_nop 3
    s_cmp_eq_u32 s28, 0
    s_cbranch_scc0 L_recurrent_scan__compressed_kv_cla__moe_arch_mod__prompt_kernel_g_40
    s_add_u32 s36, s29, 64
    s_lshl_b32 s36, s36, 7
    v_mov_b32 v57, s36
    global_load_dword v56, v57, s[90:91] sc1
L_recurrent_scan__compressed_kv_cla__moe_arch_mod__prompt_kernel_g_40:
    s_branch L_recurrent_scan__compressed_kv_cla__moe_arch_mod__prompt_kernel_swend_54
L_recurrent_scan__compressed_kv_cla__moe_arch_mod__prompt_kernel_swn_55:
L_recurrent_scan__compressed_kv_cla__moe_arch_mod__prompt_kernel_swend_54:
L_recurrent_scan__compressed_kv_cla__moe_arch_mod__prompt_kernel_ng_53:
    s_branch L_recurrent_scan__compressed_kv_cla__moe_arch_mod__prompt_kernel_back_57
L_recurrent_scan__compressed_kv_cla__moe_arch_mod__prompt_kernel_rare_61:
    s_cmp_ge_u32 s28, 4
    s_cbranch_scc0 L_recurrent_scan__compressed_kv_cla__moe_arch_mod__prompt_kernel_ng_58
    s_cmp_eq_u32 s35, 2
    s_cbranch_scc0 L_recurrent_scan__compressed_kv_cla__moe_arch_mod__prompt_kernel_swn_60
    s_mov_b32 s36, 4276224
    buffer_load_dwordx4 v[128:131], v58, s[24:27], s36 offen offset:0 sc1
    buffer_load_dwordx4 v[132:135], v58, s[24:27], s36 offen offset:1024 sc1
    s_branch L_recurrent_scan__compressed_kv_cla__moe_arch_mod__prompt_kernel_swend_59
L_recurrent_scan__compressed_kv_cla__moe_arch_mod__prompt_kernel_swn_60:
    s_cmp_lt_u32 s2, 224
    s_cbranch_scc0 L_recurrent_scan__compressed_kv_cla__moe_arch_mod__prompt_kernel_g_47
    v_lshrrev_b32 v62, 4, v1
    v_bfe_u32 v22, v1, 2, 2
    v_lshl_add_u32 v22, v62, 3, v22
    v_lshlrev_b32 v22, 7, v22
    v_and_b32 v23, 3, v1
    v_lshl_add_u32 v22, v23, 3, v22
    v_bfe_u32 v23, v1, 3, 2
    s_and_b32 s36, s28, 3
    v_xor_b32 v23, s36, v23
    v_lshl_add_u32 v63, v23, 5, v22
    s_lshr_b32 s36, s28, 2
    s_lshl_b32 s36, s36, 15
    s_add_u32 s36, s36, 65536
    v_add_u32 v63, s36, v63
    ds_read_b64_tr_b16 v[160:161], v63 offset:0
    ds_read_b64_tr_b16 v[162:163], v63 offset:512
    ds_read_b64_tr_b16 v[164:165], v63 offset:4096
    ds_read_b64_tr_b16 v[166:167], v63 offset:4608
    ds_read_b64_tr_b16 v[168:169], v63 offset:8192
    ds_read_b64_tr_b16 v[170:171], v63 offset:8704
    ds_read_b64_tr_b16 v[172:173], v63 offset:12288
    ds_read_b64_tr_b16 v[174:175], v63 offset:12800
    s_and_b32 s36, s2, 3
    s_lshl_b32 s36, s36, 1
    s_lshr_b32 s37, s28, 2
    s_add_u32 s36, s36, s37
    s_mul_i32 s36, s36, 28672
    s_lshr_b32 s37, s2, 2
    s_lshl_b32 s37, s37, 8
    s_add_u32 s36, s36, s37
    s_and_b32 s37, s28, 3
    s_lshl_b32 s37, s37, 6
    s_add_u32 s36, s36, s37
    s_add_u32 s36, s36, 58720256
    v_mul_u32_u24 v62, 14336, v18
    v_lshl_add_u32 v62, v21, 4, v62
    s_waitcnt lgkmcnt(0)
    s_waitcnt vmcnt(12)
    v_mfma_f32_16x16x32_bf16 v[20:23], v[160:163], v[128:131], 0
    v_mfma_f32_16x16x32_bf16 v[20:23], v[164:167], v[132:135], v[20:23]
    v_mfma_f32_16x16x32_bf16 v[20:23], v[168:171], v[136:139], v[20:23]
    v_mfma_f32_16x16x32_bf16 v[20:23], v[172:175], v[140:143], v[20:23]
    ds_read_b64_tr_b16 v[160:161], v63 offset:16384
    ds_read_b64_tr_b16 v[162:163], v63 offset:16896
    ds_read_b64_tr_b16 v[164:165], v63 offset:20480
    ds_read_b64_tr_b16 v[166:167], v63 offset:20992
    ds_read_b64_tr_b16 v[168:169], v63 offset:24576
    ds_read_b64_tr_b16 v[170:171], v63 offset:25088
    ds_read_b64_tr_b16 v[172:173], v63 offset:28672
    ds_read_b64_tr_b16 v[174:175], v63 offset:29184
    s_waitcnt lgkmcnt(0)
    v_mfma_f32_16x16x32_bf16 v[20:23], v[160:163], v[144:147], v[20:23]
    v_mfma_f32_16x16x32_bf16 v[20:23], v[164:167], v[148:151], v[20:23]
    v_mfma_f32_16x16x32_bf16 v[20:23], v[168:171], v[152:155], v[20:23]
    v_mfma_f32_16x16x32_bf16 v[20:23], v[172:175], v[156:159], v[20:23]
    s_nop 5
    s_mov_b32 exec_lo, 0x00030003
    s_mov_b32 exec_hi, 0x00030003
    buffer_store_dwordx4 v[20:23], v62, s[24:27], s36 offen sc1
    s_mov_b64 exec, -1
    s_nop 3
L_recurrent_scan__compressed_kv_cla__moe_arch_mod__prompt_kernel_g_47:
    s_mov_b64 s[4:5], s[12:13]
    s_mov_b32 s6, s14
    s_mov_b32 s31, s45
    s_mov_b32 s40, 65536
    v_add_u32 v2, s33, v58
    v_mov_b32 v3, v2
    v_mov_b32 v4, v2
    v_mov_b32 v5, v2
L_recurrent_scan__compressed_kv_cla__moe_arch_mod__prompt_kernel_swend_59:
L_recurrent_scan__compressed_kv_cla__moe_arch_mod__prompt_kernel_ng_58:
    s_branch L_recurrent_scan__compressed_kv_cla__moe_arch_mod__prompt_kernel_back_62
L_recurrent_scan__compressed_kv_cla__moe_arch_mod__prompt_kernel_rare_67:
    s_cmp_eq_u32 s35, 3
    s_cbranch_scc0 L_recurrent_scan__compressed_kv_cla__moe_arch_mod__prompt_kernel_nv0_63
    s_add_u32 m0, s33, 65536
    s_add_u32 s36, s45, 32768
    buffer_load_dwordx4 v2, s[12:15], s36 offen offset:0 sc1 lds
    buffer_load_dwordx4 v2, s[12:15], s36 offen offset:1024 sc1 lds
    buffer_load_dwordx4 v2, s[12:15], s36 offen offset:2048 sc1 lds
    buffer_load_dwordx4 v2, s[12:15], s36 offen offset:3072 sc1 lds
L_recurrent_scan__compressed_kv_cla__moe_arch_mod__prompt_kernel_nv0_63:
    s_cmp_ge_u32 s28, 4
    s_cbranch_scc0 L_recurrent_scan__compressed_kv_cla__moe_arch_mod__prompt_kernel_ng_64
    s_cmp_eq_u32 s35, 2
    s_cbranch_scc0 L_recurrent_scan__compressed_kv_cla__moe_arch_mod__prompt_kernel_swn_66
    s_add_u32 s36, s28, s30
    s_cmp_eq_u32 s36, 4
    s_cbranch_scc0 L_recurrent_scan__compressed_kv_cla__moe_arch_mod__prompt_kernel_g_39
    s_add_u32 s36, s29, 64
    s_lshl_b32 s36, s36, 7
    v_mov_b32 v62, s36
    v_mov_b32 v63, 1
    s_mov_b64 exec, 1
    global_atomic_add v62, v63, s[90:91]
    s_mov_b64 exec, -1
    s_nop 3
L_recurrent_scan__compressed_kv_cla__moe_arch_mod__prompt_kernel_g_39:
    v_max_u32 v18, v128, v129
    v_min_u32 v19, v128, v129
    v_med3_u32 v19, v18, v19, v130
    v_max_u32 v18, v18, v130
    v_med3_u32 v19, v18, v19, v131
    v_max_u32 v18, v18, v131
    v_med3_u32 v19, v18, v19, v132
    v_max_u32 v18, v18, v132
    v_med3_u32 v19, v18, v19, v133
    v_max_u32 v18, v18, v133
    v_med3_u32 v19, v18, v19, v134
    v_max_u32 v18, v18, v134
    v_med3_u32 v19, v18, v19, v135
    v_max_u32 v18, v18, v135
    v_mov_b32 v20, v18
    s_nop 1
    v_max_u32_dpp v20, v20, v20 quad_perm:[1,0,3,2] row_mask:0xf bank_mask:0xf
    s_nop 1
    v_max_u32_dpp v20, v20, v20 quad_perm:[2,3,0,1] row_mask:0xf bank_mask:0xf
    s_nop 1
    v_max_u32_dpp v20, v20, v20 row_half_mirror row_mask:0xf bank_mask:0xf
    s_nop 1
    v_max_u32_dpp v20, v20, v20 row_mirror row_mask:0xf bank_mask:0xf
    s_nop 0
    v_readlane_b32 s36, v20, 0
    v_readlane_b32 s37, v20, 16
    v_readlane_b32 s38, v20, 32
    v_readlane_b32 s39, v20, 48
    s_max_u32 s36, s36, s37
    s_max_u32 s38, s38, s39
    s_max_u32 s36, s36, s38
    s_mov_b32 s58, s36
    v_cmp_eq_u32 vcc, s58, v18
    s_nop 1
    v_cndmask_b32 v20, v18, v19, vcc
    s_nop 1
    v_max_u32_dpp v20, v20, v20 quad_perm:[1,0,3,2] row_mask:0xf bank_mask:0xf
    s_nop 1
    v_max_u32_dpp v20, v20, v20 quad_perm:[2,3,0,1] row_mask:0xf bank_mask:0xf
    s_nop 1
    v_max_u32_dpp v20, v20, v20 row_half_mirror row_mask:0xf bank_mask:0xf
    s_nop 1
    v_max_u32_dpp v20, v20, v20 row_mirror row_mask:0xf bank_mask:0xf
    s_nop 0
    v_readlane_b32 s36, v20, 0
    v_readlane_b32 s37, v20, 16
    v_readlane_b32 s38, v20, 32
    v_readlane_b32 s39, v20, 48
    s_max_u32 s36, s36, s37
    s_max_u32 s38, s38, s39
    s_max_u32 s36, s36, s38
    s_mov_b32 s59, s36
    s_and_b32 s36, s58, 0xffff
    s_sub_u32 s56, 0xffff, s36
    s_and_b32 s36, s59, 0xffff
    s_sub_u32 s57, 0xffff, s36
    v_and_b32 v18, 1, v1
    v_mov_b32 v19, s56
    v_mov_b32 v20, s57
    v_cmp_eq_u32 vcc, 1, v18
    s_nop 1
    v_cndmask_b32 v19, v19, v20, vcc
    v_lshrrev_b32 v20, 4, v19
    v_lshlrev_b32 v20, 15, v20
    v_and_b32 v19, 15, v19
    v_lshl_add_u32 v20, v19, 4, v20
    v_lshrrev_b32 v21, 4, v1
    v_lshl_add_u32 v20, v21, 8, v20
    s_and_b32 s36, s2, 3
    s_lshl_b32 s36, s36, 13
    s_add_u32 s37, s36, 4096
    s_mov_b32 exec_lo, 0x00030003
    s_mov_b32 exec_hi, 0x00030003
    buffer_load_dwordx4 v[128:131], v20, s[24:27], s36 offen offset:0 sc1
    buffer_load_dwordx4 v[132:135], v20, s[24:27], s36 offen offset:1024 sc1
    buffer_load_dwordx4 v[136:139], v20, s[24:27], s36 offen offset:2048 sc1
    buffer_load_dwordx4 v[140:143], v20, s[24:27], s36 offen offset:3072 sc1
    buffer_load_dwordx4 v[144:147], v20, s[24:27], s37 offen offset:0 sc1
    buffer_load_dwordx4 v[148:151], v20, s[24:27], s37 offen offset:1024 sc1
    buffer_load_dwordx4 v[152:155], v20, s[24:27], s37 offen offset:2048 sc1
    buffer_load_dwordx4 v[156:159], v20, s[24:27], s37 offen offset:3072 sc1
    s_mov_b64 exec, -1
    s_nop 3
    s_branch L_recurrent_scan__compressed_kv_cla__moe_arch_mod__prompt_kernel_swend_65
L_recurrent_scan__compressed_kv_cla__moe_arch_mod__prompt_kernel_swn_66:
L_recurrent_scan__compressed_kv_cla__moe_arch_mod__prompt_kernel_swend_65:
L_recurrent_scan__compressed_kv_cla__moe_arch_mod__prompt_kernel_ng_64:
    s_branch L_recurrent_scan__compressed_kv_cla__moe_arch_mod__prompt_kernel_back_68
L_recurrent_scan__compressed_kv_cla__moe_arch_mod__prompt_kernel_rare_75:
    s_add_u32 s36, s35, s52
    s_cmp_eq_u32 s36, 0
    s_cbranch_scc0 L_recurrent_scan__compressed_kv_cla__moe_arch_mod__prompt_kernel_swn_70
    buffer_store_dwordx4 v[128:131], v58, s[12:15], s46 offen sc1
    s_branch L_recurrent_scan__compressed_kv_cla__moe_arch_mod__prompt_kernel_swend_69
L_recurrent_scan__compressed_kv_cla__moe_arch_mod__prompt_kernel_swn_70:
    s_cmp_eq_u32 s36, 1
    s_cbranch_scc0 L_recurrent_scan__compressed_kv_cla__moe_arch_mod__prompt_kernel_swn_71
    buffer_store_dwordx4 v[144:147], v58, s[12:15], s47 offen sc1
    s_branch L_recurrent_scan__compressed_kv_cla__moe_arch_mod__prompt_kernel_swend_69
L_recurrent_scan__compressed_kv_cla__moe_arch_mod__prompt_kernel_swn_71:
    s_cmp_eq_u32 s36, 2
    s_cbranch_scc0 L_recurrent_scan__compressed_kv_cla__moe_arch_mod__prompt_kernel_swn_72
    buffer_store_dwordx4 v[160:163], v58, s[12:15], s48 offen sc1
    s_branch L_recurrent_scan__compressed_kv_cla__moe_arch_mod__prompt_kernel_swend_69
L_recurrent_scan__compressed_kv_cla__moe_arch_mod__prompt_kernel_swn_72:
    s_cmp_eq_u32 s36, 3
    s_cbranch_scc0 L_recurrent_scan__compressed_kv_cla__moe_arch_mod__prompt_kernel_swn_73
    buffer_store_dwordx4 v[176:179], v58, s[12:15], s49 offen sc1
    s_branch L_recurrent_scan__compressed_kv_cla__moe_arch_mod__prompt_kernel_swend_69
L_recurrent_scan__compressed_kv_cla__moe_arch_mod__prompt_kernel_swn_73:
    s_cmp_eq_u32 s36, 4
    s_cbranch_scc0 L_recurrent_scan__compressed_kv_cla__moe_arch_mod__prompt_kernel_swn_74
    buffer_store_dwordx4 v[128:131], v58, s[12:15], s46 offen sc1
    s_branch L_recurrent_scan__compressed_kv_cla__moe_arch_mod__prompt_kernel_swend_69
L_recurrent_scan__compressed_kv_cla__moe_arch_mod__prompt_kernel_swn_74:
    buffer_store_dwordx4 v[160:163], v58, s[12:15], s48 offen sc1
L_recurrent_scan__compressed_kv_cla__moe_arch_mod__prompt_kernel_swend_69:
    s_branch L_recurrent_scan__compressed_kv_cla__moe_arch_mod__prompt_kernel_back_76
L_recurrent_scan__compressed_kv_cla__moe_arch_mod__prompt_kernel_rare_79:
    s_add_u32 s36, s35, s52
    s_cmp_eq_u32 s36, 4
    s_cbranch_scc0 L_recurrent_scan__compressed_kv_cla__moe_arch_mod__prompt_kernel_swn_78
    buffer_store_dwordx4 v[132:135], v59, s[12:15], s46 offen sc1
    s_branch L_recurrent_scan__compressed_kv_cla__moe_arch_mod__prompt_kernel_swend_77
L_recurrent_scan__compressed_kv_cla__moe_arch_mod__prompt_kernel_swn_78:
    buffer_store_dwordx4 v[164:167], v59, s[12:15], s48 offen sc1
L_recurrent_scan__compressed_kv_cla__moe_arch_mod__prompt_kernel_swend_77:
    s_branch L_recurrent_scan__compressed_kv_cla__moe_arch_mod__prompt_kernel_back_80
L_recurrent_scan__compressed_kv_cla__moe_arch_mod__prompt_kernel_rare_87:
    s_add_u32 s36, s35, s52
    s_cmp_eq_u32 s36, 0
    s_cbranch_scc0 L_recurrent_scan__compressed_kv_cla__moe_arch_mod__prompt_kernel_swn_82
    buffer_store_dwordx4 v[132:135], v59, s[12:15], s46 offen sc1
    s_branch L_recurrent_scan__compressed_kv_cla__moe_arch_mod__prompt_kernel_swend_81
L_recurrent_scan__compressed_kv_cla__moe_arch_mod__prompt_kernel_swn_82:
    s_cmp_eq_u32 s36, 1
    s_cbranch_scc0 L_recurrent_scan__compressed_kv_cla__moe_arch_mod__prompt_kernel_swn_83
    buffer_store_dwordx4 v[148:151], v59, s[12:15], s47 offen sc1
    s_branch L_recurrent_scan__compressed_kv_cla__moe_arch_mod__prompt_kernel_swend_81
L_recurrent_scan__compressed_kv_cla__moe_arch_mod__prompt_kernel_swn_83:
    s_cmp_eq_u32 s36, 2
    s_cbranch_scc0 L_recurrent_scan__compressed_kv_cla__moe_arch_mod__prompt_kernel_swn_84
    buffer_store_dwordx4 v[164:167], v59, s[12:15], s48 offen sc1
    s_branch L_recurrent_scan__compressed_kv_cla__moe_arch_mod__prompt_kernel_swend_81
L_recurrent_scan__compressed_kv_cla__moe_arch_mod__prompt_kernel_swn_84:
    s_cmp_eq_u32 s36, 3
    s_cbranch_scc0 L_recurrent_scan__compressed_kv_cla__moe_arch_mod__prompt_kernel_swn_85
    buffer_store_dwordx4 v[180:183], v59, s[12:15], s49 offen sc1
    s_branch L_recurrent_scan__compressed_kv_cla__moe_arch_mod__prompt_kernel_swend_81
L_recurrent_scan__compressed_kv_cla__moe_arch_mod__prompt_kernel_swn_85:
    s_cmp_eq_u32 s36, 4
    s_cbranch_scc0 L_recurrent_scan__compressed_kv_cla__moe_arch_mod__prompt_kernel_swn_86
    buffer_store_dwordx4 v[136:139], v60, s[12:15], s46 offen sc1
    s_branch L_recurrent_scan__compressed_kv_cla__moe_arch_mod__prompt_kernel_swend_81
L_recurrent_scan__compressed_kv_cla__moe_arch_mod__prompt_kernel_swn_86:
    buffer_store_dwordx4 v[168:171], v60, s[12:15], s48 offen sc1
L_recurrent_scan__compressed_kv_cla__moe_arch_mod__prompt_kernel_swend_81:
    s_branch L_recurrent_scan__compressed_kv_cla__moe_arch_mod__prompt_kernel_back_88
L_recurrent_scan__compressed_kv_cla__moe_arch_mod__prompt_kernel_rare_91:
    s_add_u32 s36, s35, s52
    s_cmp_eq_u32 s36, 4
    s_cbranch_scc0 L_recurrent_scan__compressed_kv_cla__moe_arch_mod__prompt_kernel_swn_90
    buffer_store_dwordx4 v[140:143], v61, s[12:15], s46 offen sc1
    s_branch L_recurrent_scan__compressed_kv_cla__moe_arch_mod__prompt_kernel_swend_89
L_recurrent_scan__compressed_kv_cla__moe_arch_mod__prompt_kernel_swn_90:
    buffer_store_dwordx4 v[172:175], v61, s[12:15], s48 offen sc1
L_recurrent_scan__compressed_kv_cla__moe_arch_mod__prompt_kernel_swend_89:
    s_branch L_recurrent_scan__compressed_kv_cla__moe_arch_mod__prompt_kernel_back_92
L_recurrent_scan__compressed_kv_cla__moe_arch_mod__prompt_kernel_rare_99:
    s_add_u32 s36, s35, s52
    s_cmp_eq_u32 s36, 0
    s_cbranch_scc0 L_recurrent_scan__compressed_kv_cla__moe_arch_mod__prompt_kernel_swn_94
    buffer_store_dwordx4 v[136:139], v60, s[12:15], s46 offen sc1
    s_branch L_recurrent_scan__compressed_kv_cla__moe_arch_mod__prompt_kernel_swend_93
L_recurrent_scan__compressed_kv_cla__moe_arch_mod__prompt_kernel_swn_94:
    s_cmp_eq_u32 s36, 1
    s_cbranch_scc0 L_recurrent_scan__compressed_kv_cla__moe_arch_mod__prompt_kernel_swn_95
    buffer_store_dwordx4 v[152:155], v60, s[12:15], s47 offen sc1
    s_branch L_recurrent_scan__compressed_kv_cla__moe_arch_mod__prompt_kernel_swend_93
L_recurrent_scan__compressed_kv_cla__moe_arch_mod__prompt_kernel_swn_95:
    s_cmp_eq_u32 s36, 2
    s_cbranch_scc0 L_recurrent_scan__compressed_kv_cla__moe_arch_mod__prompt_kernel_swn_96
    buffer_store_dwordx4 v[168:171], v60, s[12:15], s48 offen sc1
    s_branch L_recurrent_scan__compressed_kv_cla__moe_arch_mod__prompt_kernel_swend_93
L_recurrent_scan__compressed_kv_cla__moe_arch_mod__prompt_kernel_swn_96:
    s_cmp_eq_u32 s36, 3
    s_cbranch_scc0 L_recurrent_scan__compressed_kv_cla__moe_arch_mod__prompt_kernel_swn_97
    buffer_store_dwordx4 v[184:187], v60, s[12:15], s49 offen sc1
    s_branch L_recurrent_scan__compressed_kv_cla__moe_arch_mod__prompt_kernel_swend_93
L_recurrent_scan__compressed_kv_cla__moe_arch_mod__prompt_kernel_swn_97:
    s_cmp_eq_u32 s36, 4
    s_cbranch_scc0 L_recurrent_scan__compressed_kv_cla__moe_arch_mod__prompt_kernel_swn_98
    buffer_store_dwordx4 v[144:147], v58, s[12:15], s47 offen sc1
    s_branch L_recurrent_scan__compressed_kv_cla__moe_arch_mod__prompt_kernel_swend_93
L_recurrent_scan__compressed_kv_cla__moe_arch_mod__prompt_kernel_swn_98:
    buffer_store_dwordx4 v[176:179], v58, s[12:15], s49 offen sc1
L_recurrent_scan__compressed_kv_cla__moe_arch_mod__prompt_kernel_swend_93:
    s_branch L_recurrent_scan__compressed_kv_cla__moe_arch_mod__prompt_kernel_back_100
L_recurrent_scan__compressed_kv_cla__moe_arch_mod__prompt_kernel_rare_103:
    s_add_u32 s36, s35, s52
    s_cmp_eq_u32 s36, 4
    s_cbranch_scc0 L_recurrent_scan__compressed_kv_cla__moe_arch_mod__prompt_kernel_swn_102
    buffer_store_dwordx4 v[148:151], v59, s[12:15], s47 offen sc1
    s_branch L_recurrent_scan__compressed_kv_cla__moe_arch_mod__prompt_kernel_swend_101
L_recurrent_scan__compressed_kv_cla__moe_arch_mod__prompt_kernel_swn_102:
    buffer_store_dwordx4 v[180:183], v59, s[12:15], s49 offen sc1
L_recurrent_scan__compressed_kv_cla__moe_arch_mod__prompt_kernel_swend_101:
    s_branch L_recurrent_scan__compressed_kv_cla__moe_arch_mod__prompt_kernel_back_104
L_recurrent_scan__compressed_kv_cla__moe_arch_mod__prompt_kernel_rare_111:
    s_add_u32 s36, s35, s52
    s_cmp_eq_u32 s36, 0
    s_cbranch_scc0 L_recurrent_scan__compressed_kv_cla__moe_arch_mod__prompt_kernel_swn_106
    buffer_store_dwordx4 v[140:143], v61, s[12:15], s46 offen sc1
    s_branch L_recurrent_scan__compressed_kv_cla__moe_arch_mod__prompt_kernel_swend_105
L_recurrent_scan__compressed_kv_cla__moe_arch_mod__prompt_kernel_swn_106:
    s_cmp_eq_u32 s36, 1
    s_cbranch_scc0 L_recurrent_scan__compressed_kv_cla__moe_arch_mod__prompt_kernel_swn_107
    buffer_store_dwordx4 v[156:159], v61, s[12:15], s47 offen sc1
    s_branch L_recurrent_scan__compressed_kv_cla__moe_arch_mod__prompt_kernel_swend_105
L_recurrent_scan__compressed_kv_cla__moe_arch_mod__prompt_kernel_swn_107:
    s_cmp_eq_u32 s36, 2
    s_cbranch_scc0 L_recurrent_scan__compressed_kv_cla__moe_arch_mod__prompt_kernel_swn_108
    buffer_store_dwordx4 v[172:175], v61, s[12:15], s48 offen sc1
    s_branch L_recurrent_scan__compressed_kv_cla__moe_arch_mod__prompt_kernel_swend_105
L_recurrent_scan__compressed_kv_cla__moe_arch_mod__prompt_kernel_swn_108:
    s_cmp_eq_u32 s36, 3
    s_cbranch_scc0 L_recurrent_scan__compressed_kv_cla__moe_arch_mod__prompt_kernel_swn_109
    buffer_store_dwordx4 v[188:191], v61, s[12:15], s49 offen sc1
    s_branch L_recurrent_scan__compressed_kv_cla__moe_arch_mod__prompt_kernel_swend_105
L_recurrent_scan__compressed_kv_cla__moe_arch_mod__prompt_kernel_swn_109:
    s_cmp_eq_u32 s36, 4
    s_cbranch_scc0 L_recurrent_scan__compressed_kv_cla__moe_arch_mod__prompt_kernel_swn_110
    buffer_store_dwordx4 v[152:155], v60, s[12:15], s47 offen sc1
    s_branch L_recurrent_scan__compressed_kv_cla__moe_arch_mod__prompt_kernel_swend_105
L_recurrent_scan__compressed_kv_cla__moe_arch_mod__prompt_kernel_swn_110:
    buffer_store_dwordx4 v[184:187], v60, s[12:15], s49 offen sc1
L_recurrent_scan__compressed_kv_cla__moe_arch_mod__prompt_kernel_swend_105:
    s_branch L_recurrent_scan__compressed_kv_cla__moe_arch_mod__prompt_kernel_back_112
L_recurrent_scan__compressed_kv_cla__moe_arch_mod__prompt_kernel_rare_115:
    s_add_u32 s36, s35, s52
    s_cmp_eq_u32 s36, 4
    s_cbranch_scc0 L_recurrent_scan__compressed_kv_cla__moe_arch_mod__prompt_kernel_swn_114
    buffer_store_dwordx4 v[156:159], v61, s[12:15], s47 offen sc1
    s_branch L_recurrent_scan__compressed_kv_cla__moe_arch_mod__prompt_kernel_swend_113
L_recurrent_scan__compressed_kv_cla__moe_arch_mod__prompt_kernel_swn_114:
    buffer_store_dwordx4 v[188:191], v61, s[12:15], s49 offen sc1
L_recurrent_scan__compressed_kv_cla__moe_arch_mod__prompt_kernel_swend_113:
    s_branch L_recurrent_scan__compressed_kv_cla__moe_arch_mod__prompt_kernel_back_116
L_recurrent_scan__compressed_kv_cla__moe_arch_mod__prompt_kernel_rare_117:
    v_mov_b32 v20, 4048155338
    v_subrev_u32 v21, s50, v18
    v_cmp_gt_i32 s[20:21], 0, v21
    v_cmp_gt_i32 s[22:23], 1, v21
    v_cmp_gt_i32 s[62:63], 2, v21
    v_cmp_gt_i32 vcc, 3, v21
    v_cndmask_b32 v96, v96, v20, s[20:21]
    v_cndmask_b32 v97, v97, v20, s[22:23]
    v_cndmask_b32 v98, v98, v20, s[62:63]
    v_cndmask_b32 v99, v99, v20, vcc
    v_cmp_gt_i32 s[20:21], 16, v21
    v_cmp_gt_i32 s[22:23], 17, v21
    v_cmp_gt_i32 s[62:63], 18, v21
    v_cmp_gt_i32 vcc, 19, v21
    v_cndmask_b32 v100, v100, v20, s[20:21]
    v_cndmask_b32 v101, v101, v20, s[22:23]
    v_cndmask_b32 v102, v102, v20, s[62:63]
    v_cndmask_b32 v103, v103, v20, vcc
    v_cmp_gt_i32 s[20:21], -16, v21
    v_cmp_gt_i32 s[22:23], -15, v21
    v_cmp_gt_i32 s[62:63], -14, v21
    v_cmp_gt_i32 vcc, -13, v21
    v_cndmask_b32 v104, v104, v20, s[20:21]
    v_cndmask_b32 v105, v105, v20, s[22:23]
    v_cndmask_b32 v106, v106, v20, s[62:63]
    v_cndmask_b32 v107, v107, v20, vcc
    v_cmp_gt_i32 s[20:21], 0, v21
    v_cmp_gt_i32 s[22:23], 1, v21
    v_cmp_gt_i32 s[62:63], 2, v21
    v_cmp_gt_i32 vcc, 3, v21
    v_cndmask_b32 v108, v108, v20, s[20:21]
    v_cndmask_b32 v109, v109, v20, s[22:23]
    v_cndmask_b32 v110, v110, v20, s[62:63]
    v_cndmask_b32 v111, v111, v20, vcc
    s_branch L_recurrent_scan__compressed_kv_cla__moe_arch_mod__prompt_kernel_back_118
L_recurrent_scan__compressed_kv_cla__moe_arch_mod__prompt_kernel_rare_119:
    s_lshl_b32 s36, s29, 7
    v_mov_b32 v13, s36
    global_load_dword v14, v13, s[90:91] sc1
    s_branch L_recurrent_scan__compressed_kv_cla__moe_arch_mod__prompt_kernel_back_120
L_recurrent_scan__compressed_kv_cla__moe_arch_mod__prompt_kernel_rare_121:
    v_mov_b32 v20, 4048155338
    v_subrev_u32 v21, s49, v18
    v_cmp_gt_i32 s[20:21], 0, v21
    v_cmp_gt_i32 s[22:23], 1, v21
    v_cmp_gt_i32 s[62:63], 2, v21
    v_cmp_gt_i32 vcc, 3, v21
    v_cndmask_b32 v112, v112, v20, s[20:21]
    v_cndmask_b32 v113, v113, v20, s[22:23]
    v_cndmask_b32 v114, v114, v20, s[62:63]
    v_cndmask_b32 v115, v115, v20, vcc
    v_cmp_gt_i32 s[20:21], 16, v21
    v_cmp_gt_i32 s[22:23], 17, v21
    v_cmp_gt_i32 s[62:63], 18, v21
    v_cmp_gt_i32 vcc, 19, v21
    v_cndmask_b32 v116, v116, v20, s[20:21]
    v_cndmask_b32 v117, v117, v20, s[22:23]
    v_cndmask_b32 v118, v118, v20, s[62:63]
    v_cndmask_b32 v119, v119, v20, vcc
    v_cmp_gt_i32 s[20:21], -16, v21
    v_cmp_gt_i32 s[22:23], -15, v21
    v_cmp_gt_i32 s[62:63], -14, v21
    v_cmp_gt_i32 vcc, -13, v21
    v_cndmask_b32 v120, v120, v20, s[20:21]
    v_cndmask_b32 v121, v121, v20, s[22:23]
    v_cndmask_b32 v122, v122, v20, s[62:63]
    v_cndmask_b32 v123, v123, v20, vcc
    v_cmp_gt_i32 s[20:21], 0, v21
    v_cmp_gt_i32 s[22:23], 1, v21
    v_cmp_gt_i32 s[62:63], 2, v21
    v_cmp_gt_i32 vcc, 3, v21
    v_cndmask_b32 v124, v124, v20, s[20:21]
    v_cndmask_b32 v125, v125, v20, s[22:23]
    v_cndmask_b32 v126, v126, v20, s[62:63]
    v_cndmask_b32 v127, v127, v20, vcc
    s_branch L_recurrent_scan__compressed_kv_cla__moe_arch_mod__prompt_kernel_back_122
L_recurrent_scan__compressed_kv_cla__moe_arch_mod__prompt_kernel_rare_123:
    v_mov_b32 v20, 4048155338
    v_subrev_u32 v21, s50, v18
    v_cmp_gt_i32 s[20:21], 0, v21
    v_cmp_gt_i32 s[22:23], 1, v21
    v_cmp_gt_i32 s[62:63], 2, v21
    v_cmp_gt_i32 vcc, 3, v21
    v_cndmask_b32 v96, v96, v20, s[20:21]
    v_cndmask_b32 v97, v97, v20, s[22:23]
    v_cndmask_b32 v98, v98, v20, s[62:63]
    v_cndmask_b32 v99, v99, v20, vcc
    v_cmp_gt_i32 s[20:21], 16, v21
    v_cmp_gt_i32 s[22:23], 17, v21
    v_cmp_gt_i32 s[62:63], 18, v21
    v_cmp_gt_i32 vcc, 19, v21
    v_cndmask_b32 v100, v100, v20, s[20:21]
    v_cndmask_b32 v101, v101, v20, s[22:23]
    v_cndmask_b32 v102, v102, v20, s[62:63]
    v_cndmask_b32 v103, v103, v20, vcc
    v_cmp_gt_i32 s[20:21], -16, v21
    v_cmp_gt_i32 s[22:23], -15, v21
    v_cmp_gt_i32 s[62:63], -14, v21
    v_cmp_gt_i32 vcc, -13, v21
    v_cndmask_b32 v104, v104, v20, s[20:21]
    v_cndmask_b32 v105, v105, v20, s[22:23]
    v_cndmask_b32 v106, v106, v20, s[62:63]
    v_cndmask_b32 v107, v107, v20, vcc
    v_cmp_gt_i32 s[20:21], 0, v21
    v_cmp_gt_i32 s[22:23], 1, v21
    v_cmp_gt_i32 s[62:63], 2, v21
    v_cmp_gt_i32 vcc, 3, v21
    v_cndmask_b32 v108, v108, v20, s[20:21]
    v_cndmask_b32 v109, v109, v20, s[22:23]
    v_cndmask_b32 v110, v110, v20, s[62:63]
    v_cndmask_b32 v111, v111, v20, vcc
    s_branch L_recurrent_scan__compressed_kv_cla__moe_arch_mod__prompt_kernel_back_124
L_recurrent_scan__compressed_kv_cla__moe_arch_mod__prompt_kernel_rare_127:
    s_mov_b32 s61, 0x40000
L_recurrent_scan__compressed_kv_cla__moe_arch_mod__prompt_kernel_spin_125:
    s_sub_u32 s61, s61, 1
    s_cbranch_scc1 L_recurrent_scan__compressed_kv_cla__moe_arch_mod__prompt_kernel_spinx_126
    s_sleep 8
    global_load_dword v14, v13, s[90:91] sc1
    s_waitcnt vmcnt(0)
    v_readfirstlane_b32 s36, v14
    s_nop 0
    s_cmp_lt_u32 s36, 8
    s_cbranch_scc1 L_recurrent_scan__compressed_kv_cla__moe_arch_mod__prompt_kernel_spin_125
L_recurrent_scan__compressed_kv_cla__moe_arch_mod__prompt_kernel_spinx_126:
    s_branch L_recurrent_scan__compressed_kv_cla__moe_arch_mod__prompt_kernel_back_128
L_recurrent_scan__compressed_kv_cla__moe_arch_mod__prompt_kernel_rare_129:
    v_readfirstlane_b32 s36, v14
    s_nop 0
    s_cmp_lt_u32 s36, 8
    s_cbranch_scc1 L_recurrent_scan__compressed_kv_cla__moe_arch_mod__prompt_kernel_rare_127
L_recurrent_scan__compressed_kv_cla__moe_arch_mod__prompt_kernel_back_128:
    s_branch L_recurrent_scan__compressed_kv_cla__moe_arch_mod__prompt_kernel_back_130
L_recurrent_scan__compressed_kv_cla__moe_arch_mod__prompt_kernel_rare_139:
    v_mov_b32 v20, 4048155338
    v_subrev_u32 v21, s49, v18
    v_cmp_gt_i32 s[20:21], 0, v21
    v_cmp_gt_i32 s[22:23], 1, v21
    v_cmp_gt_i32 s[62:63], 2, v21
    v_cmp_gt_i32 vcc, 3, v21
    v_cndmask_b32 v112, v112, v20, s[20:21]
    v_cndmask_b32 v113, v113, v20, s[22:23]
    v_cndmask_b32 v114, v114, v20, s[62:63]
    v_cndmask_b32 v115, v115, v20, vcc
    v_cmp_gt_i32 s[20:21], 16, v21
    v_cmp_gt_i32 s[22:23], 17, v21
    v_cmp_gt_i32 s[62:63], 18, v21
    v_cmp_gt_i32 vcc, 19, v21
    v_cndmask_b32 v116, v116, v20, s[20:21]
    v_cndmask_b32 v117, v117, v20, s[22:23]
    v_cndmask_b32 v118, v118, v20, s[62:63]
    v_cndmask_b32 v119, v119, v20, vcc
    v_cmp_gt_i32 s[20:21], -16, v21
    v_cmp_gt_i32 s[22:23], -15, v21
    v_cmp_gt_i32 s[62:63], -14, v21
    v_cmp_gt_i32 vcc, -13, v21
    v_cndmask_b32 v120, v120, v20, s[20:21]
    v_cndmask_b32 v121, v121, v20, s[22:23]
    v_cndmask_b32 v122, v122, v20, s[62:63]
    v_cndmask_b32 v123, v123, v20, vcc
    v_cmp_gt_i32 s[20:21], 0, v21
    v_cmp_gt_i32 s[22:23], 1, v21
    v_cmp_gt_i32 s[62:63], 2, v21
    v_cmp_gt_i32 vcc, 3, v21
    v_cndmask_b32 v124, v124, v20, s[20:21]
    v_cndmask_b32 v125, v125, v20, s[22:23]
    v_cndmask_b32 v126, v126, v20, s[62:63]
    v_cndmask_b32 v127, v127, v20, vcc
    s_branch L_recurrent_scan__compressed_kv_cla__moe_arch_mod__prompt_kernel_back_140
L_recurrent_scan__compressed_kv_cla__moe_arch_mod__prompt_kernel_rare_144:
    v_mov_b32 v20, 4048155338
    v_subrev_u32 v21, s50, v18
    v_cmp_gt_i32 s[20:21], 0, v21
    v_cmp_gt_i32 s[22:23], 1, v21
    v_cmp_gt_i32 s[62:63], 2, v21
    v_cmp_gt_i32 vcc, 3, v21
    v_cndmask_b32 v96, v96, v20, s[20:21]
    v_cndmask_b32 v97, v97, v20, s[22:23]
    v_cndmask_b32 v98, v98, v20, s[62:63]
    v_cndmask_b32 v99, v99, v20, vcc
    v_cmp_gt_i32 s[20:21], 16, v21
    v_cmp_gt_i32 s[22:23], 17, v21
    v_cmp_gt_i32 s[62:63], 18, v21
    v_cmp_gt_i32 vcc, 19, v21
    v_cndmask_b32 v100, v100, v20, s[20:21]
    v_cndmask_b32 v101, v101, v20, s[22:23]
    v_cndmask_b32 v102, v102, v20, s[62:63]
    v_cndmask_b32 v103, v103, v20, vcc
    v_cmp_gt_i32 s[20:21], -16, v21
    v_cmp_gt_i32 s[22:23], -15, v21
    v_cmp_gt_i32 s[62:63], -14, v21
    v_cmp_gt_i32 vcc, -13, v21
    v_cndmask_b32 v104, v104, v20, s[20:21]
    v_cndmask_b32 v105, v105, v20, s[22:23]
    v_cndmask_b32 v106, v106, v20, s[62:63]
    v_cndmask_b32 v107, v107, v20, vcc
    v_cmp_gt_i32 s[20:21], 0, v21
    v_cmp_gt_i32 s[22:23], 1, v21
    v_cmp_gt_i32 s[62:63], 2, v21
    v_cmp_gt_i32 vcc, 3, v21
    v_cndmask_b32 v108, v108, v20, s[20:21]
    v_cndmask_b32 v109, v109, v20, s[22:23]
    v_cndmask_b32 v110, v110, v20, s[62:63]
    v_cndmask_b32 v111, v111, v20, vcc
    s_branch L_recurrent_scan__compressed_kv_cla__moe_arch_mod__prompt_kernel_back_145
L_grp1:
    s_mov_b32 s36, 1040356334
    s_and_b32 s37, s28, 3
    s_lshl_b32 s37, s37, 13
    v_lshlrev_b32 v7, 4, v1
    v_add_u32 v4, s37, v7
    v_add_u32 v6, 4096, v4
    v_add_u32 v19, 131072, v4
    s_mov_b32 s43, s37
    s_add_u32 s44, s37, 98304
    s_waitcnt vmcnt(4) lgkmcnt(0)
    v_mul_f32 v192, s36, v192
    v_mul_f32 v193, s36, v193
    v_mul_f32 v194, s36, v194
    v_mul_f32 v195, s36, v195
    v_mul_f32 v196, s36, v196
    v_mul_f32 v197, s36, v197
    v_mul_f32 v198, s36, v198
    v_mul_f32 v199, s36, v199
    v_cvt_pk_bf16_f32 v128, v192, v193
    v_cvt_pk_bf16_f32 v129, v194, v195
    v_cvt_pk_bf16_f32 v130, v196, v197
    v_cvt_pk_bf16_f32 v131, v198, v199
    v_mul_f32 v200, s36, v200
    v_mul_f32 v201, s36, v201
    v_mul_f32 v202, s36, v202
    v_mul_f32 v203, s36, v203
    v_mul_f32 v204, s36, v204
    v_mul_f32 v205, s36, v205
    v_mul_f32 v206, s36, v206
    v_mul_f32 v207, s36, v207
    v_cvt_pk_bf16_f32 v132, v200, v201
    v_cvt_pk_bf16_f32 v133, v202, v203
    v_cvt_pk_bf16_f32 v134, v204, v205
    v_cvt_pk_bf16_f32 v135, v206, v207
    v_mul_f32 v208, s36, v208
    v_mul_f32 v209, s36, v209
    v_mul_f32 v210, s36, v210
    v_mul_f32 v211, s36, v211
    v_mul_f32 v212, s36, v212
    v_mul_f32 v213, s36, v213
    v_mul_f32 v214, s36, v214
    v_mul_f32 v215, s36, v215
    v_cvt_pk_bf16_f32 v136, v208, v209
    v_cvt_pk_bf16_f32 v137, v210, v211
    v_cvt_pk_bf16_f32 v138, v212, v213
    v_cvt_pk_bf16_f32 v139, v214, v215
    v_mul_f32 v216, s36, v216
    v_mul_f32 v217, s36, v217
    v_mul_f32 v218, s36, v218
    v_mul_f32 v219, s36, v219
    v_mul_f32 v220, s36, v220
    v_mul_f32 v221, s36, v221
    v_mul_f32 v222, s36, v222
    v_mul_f32 v223, s36, v223
    v_cvt_pk_bf16_f32 v140, v216, v217
    v_cvt_pk_bf16_f32 v141, v218, v219
    v_cvt_pk_bf16_f32 v142, v220, v221
    v_cvt_pk_bf16_f32 v143, v222, v223
    v_mul_f32 v224, s36, v224
    v_mul_f32 v225, s36, v225
    v_mul_f32 v226, s36, v226
    v_mul_f32 v227, s36, v227
    v_mul_f32 v228, s36, v228
    v_mul_f32 v229, s36, v229
    v_mul_f32 v230, s36, v230
    v_mul_f32 v231, s36, v231
    v_cvt_pk_bf16_f32 v144, v224, v225
    v_cvt_pk_bf16_f32 v145, v226, v227
    v_cvt_pk_bf16_f32 v146, v228, v229
    v_cvt_pk_bf16_f32 v147, v230, v231
    v_mul_f32 v232, s36, v232
    v_mul_f32 v233, s36, v233
    v_mul_f32 v234, s36, v234
    v_mul_f32 v235, s36, v235
    v_mul_f32 v236, s36, v236
    v_mul_f32 v237, s36, v237
    v_mul_f32 v238, s36, v238
    v_mul_f32 v239, s36, v239
    v_cvt_pk_bf16_f32 v148, v232, v233
    v_cvt_pk_bf16_f32 v149, v234, v235
    v_cvt_pk_bf16_f32 v150, v236, v237
    v_cvt_pk_bf16_f32 v151, v238, v239
    v_mul_f32 v240, s36, v240
    v_mul_f32 v241, s36, v241
    v_mul_f32 v242, s36, v242
    v_mul_f32 v243, s36, v243
    v_mul_f32 v244, s36, v244
    v_mul_f32 v245, s36, v245
    v_mul_f32 v246, s36, v246
    v_mul_f32 v247, s36, v247
    v_cvt_pk_bf16_f32 v152, v240, v241
    v_cvt_pk_bf16_f32 v153, v242, v243
    v_cvt_pk_bf16_f32 v154, v244, v245
    v_cvt_pk_bf16_f32 v155, v246, v247
    v_mul_f32 v248, s36, v248
    v_mul_f32 v249, s36, v249
    v_mul_f32 v250, s36, v250
    v_mul_f32 v251, s36, v251
    v_mul_f32 v252, s36, v252
    v_mul_f32 v253, s36, v253
    v_mul_f32 v254, s36, v254
    v_mul_f32 v255, s36, v255
    v_cvt_pk_bf16_f32 v156, v248, v249
    v_cvt_pk_bf16_f32 v157, v250, v251
    v_cvt_pk_bf16_f32 v158, v252, v253
    v_cvt_pk_bf16_f32 v159, v254, v255
    v_mov_b32 v2, v7
    v_and_b32 v21, 15, v1
    v_lshrrev_b32 v22, 4, v1
    v_lshlrev_b32 v22, 2, v22
    v_sub_u32 v18, v21, v22
    s_mov_b32 s40, 0
    s_mov_b32 s41, 0
    s_lshl_b32 s51, s30, 1
    s_add_u32 s51, s51, 1
    s_and_b32 s36, s28, 3
    s_lshl_b32 s36, s36, 5
    s_lshl_b32 s37, s30, 7
    s_add_u32 s36, s36, s37
    s_sub_u32 s50, 0, s36
    s_lshl_b32 s42, s30, 8
    s_sub_u32 s42, s42, 1792
    s_mov_b64 s[52:53], 0
    s_waitcnt lgkmcnt(0)
    s_barrier
    ds_read_b128 v[160:163], v19 offset:0
    ds_read_b128 v[164:167], v19 offset:1024
    ds_read_b128 v[168:171], v19 offset:2048
    ds_read_b128 v[172:175], v19 offset:3072
    ds_read_b128 v[176:179], v19 offset:4096
    ds_read_b128 v[180:183], v19 offset:5120
    ds_read_b128 v[184:187], v19 offset:6144
    ds_read_b128 v[188:191], v19 offset:7168
    s_add_u32 s16, s54, 41943040
    s_addc_u32 s17, s55, 0
    s_and_b32 s17, s17, 0xffff
    s_mov_b32 s18, 16777216
    s_mov_b32 s19, 0x20000
    s_mov_b32 s4, s94
    s_and_b32 s5, s95, 0xffff
    s_mov_b32 s6, 7340032
    s_mov_b32 s7, 0x20000
    s_mov_b32 s8, s92
    s_and_b32 s9, s93, 0xffff
    s_mov_b32 s10, 8388608
    s_mov_b32 s11, 0x20000
    s_cmp_eq_u32 s28, 4
    s_cbranch_scc1 L_recurrent_scan__compressed_kv_cla__moe_arch_mod__prompt_kernel_rare_146
L_recurrent_scan__compressed_kv_cla__moe_arch_mod__prompt_kernel_back_147:
    ds_read_b128 v[64:67], v2 offset:0
    ds_read_b128 v[68:71], v2 offset:1024
    ds_read_b128 v[72:75], v2 offset:2048
    ds_read_b128 v[76:79], v2 offset:3072
    ds_read_b128 v[80:83], v2 offset:4096
    ds_read_b128 v[84:87], v2 offset:5120
    ds_read_b128 v[88:91], v2 offset:6144
    ds_read_b128 v[92:95], v2 offset:7168
    s_waitcnt lgkmcnt(7)
    v_mfma_f32_16x16x32_bf16 v[96:99], v[64:67], v[128:131], 0
    v_mov_b32 v192, 0
    v_mov_b32 v193, 0
    v_mfma_f32_16x16x32_bf16 v[104:107], v[64:67], v[144:147], 0
    ds_read_b128 v[64:67], v2 offset:8192
    v_mov_b32 v194, 0
    v_mov_b32 v195, 0
    s_waitcnt lgkmcnt(7)
    v_mfma_f32_16x16x32_bf16 v[96:99], v[68:71], v[132:135], v[96:99]
    v_mov_b32 v196, 0
    v_mov_b32 v197, 0
    v_mfma_f32_16x16x32_bf16 v[104:107], v[68:71], v[148:151], v[104:107]
    ds_read_b128 v[68:71], v2 offset:9216
    v_mov_b32 v198, 0
    v_mov_b32 v199, 0
    s_waitcnt lgkmcnt(7)
    v_mfma_f32_16x16x32_bf16 v[96:99], v[72:75], v[136:139], v[96:99]
    v_mov_b32 v200, 0
    v_mov_b32 v201, 0
    v_mfma_f32_16x16x32_bf16 v[104:107], v[72:75], v[152:155], v[104:107]
    ds_read_b128 v[72:75], v2 offset:10240
    v_mov_b32 v202, 0
    v_mov_b32 v203, 0
    s_waitcnt lgkmcnt(7)
    v_mfma_f32_16x16x32_bf16 v[96:99], v[76:79], v[140:143], v[96:99]
    v_mov_b32 v204, 0
    v_mov_b32 v205, 0
    v_mfma_f32_16x16x32_bf16 v[104:107], v[76:79], v[156:159], v[104:107]
    ds_read_b128 v[76:79], v2 offset:11264
    v_mov_b32 v206, 0
    v_mov_b32 v207, 0
    s_waitcnt lgkmcnt(7)
    v_mfma_f32_16x16x32_bf16 v[100:103], v[80:83], v[128:131], 0
    v_mov_b32 v208, 0
    v_mov_b32 v209, 0
    v_mfma_f32_16x16x32_bf16 v[108:111], v[80:83], v[144:147], 0
    ds_read_b128 v[80:83], v2 offset:12288
    v_mov_b32 v210, 0
    v_mov_b32 v211, 0
    s_waitcnt lgkmcnt(7)
    v_mfma_f32_16x16x32_bf16 v[100:103], v[84:87], v[132:135], v[100:103]
    v_mov_b32 v212, 0
    v_mov_b32 v213, 0
    v_mfma_f32_16x16x32_bf16 v[108:111], v[84:87], v[148:151], v[108:111]
    ds_read_b128 v[84:87], v2 offset:13312
    v_mov_b32 v214, 0
    v_mov_b32 v215, 0
    s_waitcnt lgkmcnt(7)
    v_mfma_f32_16x16x32_bf16 v[100:103], v[88:91], v[136:139], v[100:103]
    v_mov_b32 v216, 0
    v_mov_b32 v217, 0
    v_mfma_f32_16x16x32_bf16 v[108:111], v[88:91], v[152:155], v[108:111]
    ds_read_b128 v[88:91], v2 offset:14336
    v_mov_b32 v218, 0
    v_mov_b32 v219, 0
    s_waitcnt lgkmcnt(7)
    v_mfma_f32_16x16x32_bf16 v[100:103], v[92:95], v[140:143], v[100:103]
    v_mov_b32 v220, 0
    v_mov_b32 v221, 0
    v_mfma_f32_16x16x32_bf16 v[108:111], v[92:95], v[156:159], v[108:111]
    ds_read_b128 v[92:95], v2 offset:15360
    v_mov_b32 v222, 0
    v_mov_b32 v223, 0
    s_waitcnt lgkmcnt(7)
    v_mfma_f32_16x16x32_bf16 v[112:115], v[64:67], v[128:131], 0
    v_mov_b32 v224, 0
    v_mov_b32 v225, 0
    v_mfma_f32_16x16x32_bf16 v[120:123], v[64:67], v[144:147], 0
    v_mov_b32 v226, 0
    v_mov_b32 v227, 0
    s_waitcnt lgkmcnt(6)
    v_mfma_f32_16x16x32_bf16 v[112:115], v[68:71], v[132:135], v[112:115]
    v_mov_b32 v228, 0
    v_mov_b32 v229, 0
    v_mfma_f32_16x16x32_bf16 v[120:123], v[68:71], v[148:151], v[120:123]
    v_mov_b32 v230, 0
    v_mov_b32 v231, 0
    s_waitcnt lgkmcnt(5)
    v_mfma_f32_16x16x32_bf16 v[112:115], v[72:75], v[136:139], v[112:115]
    v_mov_b32 v232, 0
    v_mov_b32 v233, 0
    v_mfma_f32_16x16x32_bf16 v[120:123], v[72:75], v[152:155], v[120:123]
    v_mov_b32 v234, 0
    v_mov_b32 v235, 0
    s_waitcnt lgkmcnt(4)
    v_mfma_f32_16x16x32_bf16 v[112:115], v[76:79], v[140:143], v[112:115]
    v_mov_b32 v236, 0
    v_mov_b32 v237, 0
    v_mfma_f32_16x16x32_bf16 v[120:123], v[76:79], v[156:159], v[120:123]
    v_mov_b32 v238, 0
    v_mov_b32 v239, 0
    s_waitcnt lgkmcnt(3)
    v_mfma_f32_16x16x32_bf16 v[116:119], v[80:83], v[128:131], 0
    v_mov_b32 v240, 0
    v_mov_b32 v241, 0
    v_mfma_f32_16x16x32_bf16 v[124:127], v[80:83], v[144:147], 0
    v_mov_b32 v242, 0
    v_mov_b32 v243, 0
    s_waitcnt lgkmcnt(2)
    v_mfma_f32_16x16x32_bf16 v[116:119], v[84:87], v[132:135], v[116:119]
    v_mov_b32 v244, 0
    v_mov_b32 v245, 0
    v_mfma_f32_16x16x32_bf16 v[124:127], v[84:87], v[148:151], v[124:127]
    v_mov_b32 v246, 0
    v_mov_b32 v247, 0
    s_waitcnt lgkmcnt(1)
    v_mfma_f32_16x16x32_bf16 v[116:119], v[88:91], v[136:139], v[116:119]
    v_mov_b32 v248, 0
    v_mov_b32 v249, 0
    v_mfma_f32_16x16x32_bf16 v[124:127], v[88:91], v[152:155], v[124:127]
    v_mov_b32 v250, 0
    v_mov_b32 v251, 0
    s_waitcnt lgkmcnt(0)
    v_mfma_f32_16x16x32_bf16 v[116:119], v[92:95], v[140:143], v[116:119]
    v_mov_b32 v252, 0
    v_mov_b32 v253, 0
    v_mfma_f32_16x16x32_bf16 v[124:127], v[92:95], v[156:159], v[124:127]
    v_mov_b32 v254, 0
    v_mov_b32 v255, 0
    v_mov_b32 v38, 0
    v_mov_b32 v39, 0
    s_cmp_lt_i32 s50, 0
    s_cbranch_scc0 L_recurrent_scan__compressed_kv_cla__moe_arch_mod__prompt_kernel_rare_148
L_recurrent_scan__compressed_kv_cla__moe_arch_mod__prompt_kernel_back_149:
    s_add_u32 s49, s50, 32
    v_add_u32 v24, 65536, v2
    s_cmp_lt_u32 s40, s51
    s_cselect_b32 s36, 64, 128
    s_add_u32 s41, s41, s36
    s_cmp_eq_u32 s40, s51
    s_cselect_b32 s36, s42, s36
    s_add_u32 s50, s50, s36
    s_and_b32 s36, s41, 0xff
    v_lshl_add_u32 v2, s36, 8, v7
    s_cmp_eq_u32 s40, 16
    s_cselect_b64 s[20:21], -1, 0
    v_cndmask_b32 v5, v2, v24, s[20:21]
    v_mov_b32 v3, v24
    s_waitcnt vmcnt(1)
    s_cmp_eq_u32 s28, 4
    s_cbranch_scc1 L_recurrent_scan__compressed_kv_cla__moe_arch_mod__prompt_kernel_pw_150
    s_waitcnt vmcnt(0)
L_recurrent_scan__compressed_kv_cla__moe_arch_mod__prompt_kernel_pw_150:
    s_barrier
    v_and_b32 v29, 31, v1
    s_lshr_b32 s36, s2, 4
    s_mul_i32 s36, s36, 224
    s_min_u32 s37, s28, 6
    s_lshl_b32 s37, s37, 5
    s_add_u32 s36, s36, s37
    v_add_u32 v26, s36, v29
    v_lshlrev_b32 v26, 11, v26
    s_and_b32 s37, s2, 15
    s_lshl_b32 s37, s37, 7
    v_add_u32 v26, s37, v26
    s_lshl_b32 s36, s2, 15
    s_lshl_b32 s37, s28, 12
    s_add_u32 s36, s36, s37
    v_lshl_add_u32 v27, v29, 7, s36
    v_cmp_lt_u32 vcc, 31, v1
    v_mov_b32 v28, s94
    v_mov_b32 v29, s92
    v_cndmask_b32 v26, v26, v27, vcc
    v_cndmask_b32 v28, v28, v29, vcc
    v_mov_b32 v27, s95
    v_mov_b32 v29, s93
    v_cndmask_b32 v27, v27, v29, vcc
    v_add_co_u32 v26, vcc, v28, v26
    s_nop 1
    v_addc_co_u32 v27, vcc, 0, v27, vcc
    global_load_dword v10, v[26:27], off
    ds_read_b128 v[64:67], v5 offset:0
    ds_read_b128 v[68:71], v5 offset:1024
    ds_read_b128 v[72:75], v5 offset:2048
    ds_read_b128 v[76:79], v5 offset:3072
    ds_read_b128 v[80:83], v5 offset:4096
    ds_read_b128 v[84:87], v5 offset:5120
    ds_read_b128 v[88:91], v5 offset:6144
    v_max3_f32 v21, v96, v97, v98
    v_max3_f32 v21, v21, v99, v100
    v_max3_f32 v21, v21, v101, v102
    v_max_f32 v21, v21, v103
    v_max3_f32 v22, v104, v105, v106
    v_max3_f32 v22, v22, v107, v108
    v_max3_f32 v22, v22, v109, v110
    v_max_f32 v22, v22, v111
    v_mov_b32 v23, v21
    s_nop 1
    v_permlane16_swap_b32 v21, v23
    s_nop 1
    v_max_f32 v21, v21, v23
    v_mov_b32 v23, v21
    s_nop 1
    v_permlane32_swap_b32 v21, v23
    s_nop 1
    v_max_f32 v21, v21, v23
    v_mov_b32 v23, v22
    s_nop 1
    v_permlane16_swap_b32 v22, v23
    s_nop 1
    v_max_f32 v22, v22, v23
    v_mov_b32 v23, v22
    s_nop 1
    v_permlane32_swap_b32 v22, v23
    s_nop 1
    v_max_f32 v22, v22, v23
    v_sub_f32 v40, 0, v21
    v_sub_f32 v41, 0, v21
    v_sub_f32 v42, 0, v21
    v_sub_f32 v43, 0, v21
    v_sub_f32 v44, 0, v22
    v_sub_f32 v45, 0, v22
    v_sub_f32 v46, 0, v22
    v_sub_f32 v47, 0, v22
    v_sub_f32 v96, v96, v21
    v_sub_f32 v97, v97, v21
    v_sub_f32 v98, v98, v21
    v_sub_f32 v99, v99, v21
    v_sub_f32 v100, v100, v21
    v_sub_f32 v101, v101, v21
    v_sub_f32 v102, v102, v21
    v_sub_f32 v103, v103, v21
    v_sub_f32 v104, v104, v22
    v_sub_f32 v105, v105, v22
    v_sub_f32 v106, v106, v22
    v_sub_f32 v107, v107, v22
    v_sub_f32 v108, v108, v22
    v_sub_f32 v109, v109, v22
    v_sub_f32 v110, v110, v22
    v_sub_f32 v111, v111, v22
    v_sub_f32 v112, v112, v21
    v_sub_f32 v113, v113, v21
    v_sub_f32 v114, v114, v21
    v_sub_f32 v115, v115, v21
    v_sub_f32 v116, v116, v21
    v_sub_f32 v117, v117, v21
    v_sub_f32 v118, v118, v21
    v_sub_f32 v119, v119, v21
    v_sub_f32 v120, v120, v22
    v_sub_f32 v121, v121, v22
    v_sub_f32 v122, v122, v22
    v_sub_f32 v123, v123, v22
    v_sub_f32 v124, v124, v22
    v_sub_f32 v125, v125, v22
    v_sub_f32 v126, v126, v22
    v_sub_f32 v127, v127, v22
    v_exp_f32 v96, v96
    v_exp_f32 v97, v97
    v_add_f32 v38, v38, v96
    v_exp_f32 v98, v98
    v_add_f32 v38, v38, v97
    v_cvt_pk_bf16_f32 v48, v96, v97
    v_exp_f32 v99, v99
    v_add_f32 v38, v38, v98
    v_exp_f32 v104, v104
    v_add_f32 v38, v38, v99
    v_cvt_pk_bf16_f32 v49, v98, v99
    v_exp_f32 v105, v105
    v_add_f32 v39, v39, v104
    v_exp_f32 v106, v106
    v_add_f32 v39, v39, v105
    v_cvt_pk_bf16_f32 v52, v104, v105
    v_exp_f32 v107, v107
    v_add_f32 v39, v39, v106
    v_exp_f32 v100, v100
    v_add_f32 v39, v39, v107
    v_cvt_pk_bf16_f32 v53, v106, v107
    v_exp_f32 v101, v101
    v_add_f32 v38, v38, v100
    v_exp_f32 v102, v102
    v_add_f32 v38, v38, v101
    v_cvt_pk_bf16_f32 v50, v100, v101
    v_exp_f32 v103, v103
    v_add_f32 v38, v38, v102
    v_exp_f32 v108, v108
    v_add_f32 v38, v38, v103
    v_cvt_pk_bf16_f32 v51, v102, v103
    v_exp_f32 v109, v109
    v_add_f32 v39, v39, v108
    v_exp_f32 v110, v110
    v_add_f32 v39, v39, v109
    v_cvt_pk_bf16_f32 v54, v108, v109
    v_exp_f32 v111, v111
    v_add_f32 v39, v39, v110
    s_nop 0
    v_add_f32 v39, v39, v111
    v_cvt_pk_bf16_f32 v55, v110, v111
    .p2align 6
L_body1:
    s_cmp_lt_i32 s49, 0
    s_cbranch_scc0 L_recurrent_scan__compressed_kv_cla__moe_arch_mod__prompt_kernel_rare_151
L_recurrent_scan__compressed_kv_cla__moe_arch_mod__prompt_kernel_back_152:
    s_waitcnt lgkmcnt(3)
    v_mfma_f32_16x16x32_bf16 v[96:99], v[64:67], v[128:131], v[40:43]
    v_exp_f32 v112, v112
    v_mfma_f32_16x16x32_bf16 v[104:107], v[64:67], v[144:147], v[44:47]
    ds_read_b128 v[92:95], v2 offset:7168
    v_mfma_f32_16x16x32_bf16 v[96:99], v[68:71], v[132:135], v[96:99]
    v_exp_f32 v113, v113
    v_mfma_f32_16x16x32_bf16 v[104:107], v[68:71], v[148:151], v[104:107]
    ds_read_b128 v[64:67], v3 offset:0
    v_add_f32 v38, v38, v112
    v_mfma_f32_16x16x32_bf16 v[96:99], v[72:75], v[136:139], v[96:99]
    v_exp_f32 v114, v114
    v_mfma_f32_16x16x32_bf16 v[104:107], v[72:75], v[152:155], v[104:107]
    ds_read_b128 v[68:71], v3 offset:1024
    v_add_f32 v38, v38, v113
    v_cvt_pk_bf16_f32 v56, v112, v113
    v_mfma_f32_16x16x32_bf16 v[96:99], v[76:79], v[140:143], v[96:99]
    v_exp_f32 v115, v115
    v_mfma_f32_16x16x32_bf16 v[104:107], v[76:79], v[156:159], v[104:107]
    ds_read_b128 v[72:75], v3 offset:2048
    v_add_f32 v38, v38, v114
    s_waitcnt lgkmcnt(3)
    v_mfma_f32_16x16x32_bf16 v[100:103], v[80:83], v[128:131], v[40:43]
    v_exp_f32 v120, v120
    v_mfma_f32_16x16x32_bf16 v[108:111], v[80:83], v[144:147], v[44:47]
    ds_read_b128 v[76:79], v3 offset:3072
    v_add_f32 v38, v38, v115
    v_cvt_pk_bf16_f32 v57, v114, v115
    v_mfma_f32_16x16x32_bf16 v[100:103], v[84:87], v[132:135], v[100:103]
    v_exp_f32 v121, v121
    v_mfma_f32_16x16x32_bf16 v[108:111], v[84:87], v[148:151], v[108:111]
    ds_read_b128 v[80:83], v3 offset:4096
    v_add_f32 v39, v39, v120
    v_mfma_f32_16x16x32_bf16 v[100:103], v[88:91], v[136:139], v[100:103]
    v_exp_f32 v122, v122
    v_mfma_f32_16x16x32_bf16 v[108:111], v[88:91], v[152:155], v[108:111]
    ds_read_b128 v[84:87], v3 offset:5120
    v_add_f32 v39, v39, v121
    v_cvt_pk_bf16_f32 v60, v120, v121
    v_mfma_f32_16x16x32_bf16 v[100:103], v[92:95], v[140:143], v[100:103]
    v_exp_f32 v123, v123
    v_mfma_f32_16x16x32_bf16 v[108:111], v[92:95], v[156:159], v[108:111]
    ds_read_b128 v[88:91], v3 offset:6144
    v_add_f32 v39, v39, v122
    s_waitcnt lgkmcnt(3)
    v_mfma_f32_16x16x32_bf16 v[192:195], v[64:67], v[48:51], v[192:195]
    v_exp_f32 v116, v116
    v_mfma_f32_16x16x32_bf16 v[224:227], v[64:67], v[52:55], v[224:227]
    ds_read_b128 v[92:95], v3 offset:7168
    v_add_f32 v39, v39, v123
    v_cvt_pk_bf16_f32 v61, v122, v123
    v_mfma_f32_16x16x32_bf16 v[196:199], v[68:71], v[48:51], v[196:199]
    v_exp_f32 v117, v117
    v_mfma_f32_16x16x32_bf16 v[228:231], v[68:71], v[52:55], v[228:231]
    ds_read_b128 v[64:67], v2 offset:8192
    v_add_f32 v38, v38, v116
    v_mfma_f32_16x16x32_bf16 v[200:203], v[72:75], v[48:51], v[200:203]
    v_exp_f32 v118, v118
    v_mfma_f32_16x16x32_bf16 v[232:235], v[72:75], v[52:55], v[232:235]
    ds_read_b128 v[68:71], v2 offset:9216
    v_add_f32 v38, v38, v117
    v_cvt_pk_bf16_f32 v58, v116, v117
    v_mfma_f32_16x16x32_bf16 v[204:207], v[76:79], v[48:51], v[204:207]
    v_exp_f32 v119, v119
    v_mfma_f32_16x16x32_bf16 v[236:239], v[76:79], v[52:55], v[236:239]
    ds_read_b128 v[72:75], v2 offset:10240
    v_add_f32 v38, v38, v118
    s_waitcnt lgkmcnt(3)
    v_mfma_f32_16x16x32_bf16 v[208:211], v[80:83], v[48:51], v[208:211]
    v_exp_f32 v124, v124
    v_mfma_f32_16x16x32_bf16 v[240:243], v[80:83], v[52:55], v[240:243]
    ds_read_b128 v[76:79], v2 offset:11264
    v_add_f32 v38, v38, v119
    v_cvt_pk_bf16_f32 v59, v118, v119
    v_mfma_f32_16x16x32_bf16 v[212:215], v[84:87], v[48:51], v[212:215]
    v_exp_f32 v125, v125
    v_mfma_f32_16x16x32_bf16 v[244:247], v[84:87], v[52:55], v[244:247]
    ds_read_b128 v[80:83], v2 offset:12288
    v_add_f32 v39, v39, v124
    v_mfma_f32_16x16x32_bf16 v[216:219], v[88:91], v[48:51], v[216:219]
    v_exp_f32 v126, v126
    v_mfma_f32_16x16x32_bf16 v[248:251], v[88:91], v[52:55], v[248:251]
    ds_read_b128 v[84:87], v2 offset:13312
    v_add_f32 v39, v39, v125
    v_cvt_pk_bf16_f32 v62, v124, v125
    v_mfma_f32_16x16x32_bf16 v[220:223], v[92:95], v[48:51], v[220:223]
    v_exp_f32 v127, v127
    v_mfma_f32_16x16x32_bf16 v[252:255], v[92:95], v[52:55], v[252:255]
    ds_read_b128 v[88:91], v2 offset:14336
    v_add_f32 v39, v39, v126
    v_add_f32 v39, v39, v127
    v_cvt_pk_bf16_f32 v63, v126, v127
    s_cmp_eq_u32 s40, s51
    s_cbranch_scc1 L_recurrent_scan__compressed_kv_cla__moe_arch_mod__prompt_kernel_rare_153
L_recurrent_scan__compressed_kv_cla__moe_arch_mod__prompt_kernel_back_154:
    s_cmp_lt_i32 s50, 0
    s_cbranch_scc0 L_recurrent_scan__compressed_kv_cla__moe_arch_mod__prompt_kernel_rare_155
L_recurrent_scan__compressed_kv_cla__moe_arch_mod__prompt_kernel_back_156:
    s_waitcnt lgkmcnt(3)
    v_mfma_f32_16x16x32_bf16 v[112:115], v[64:67], v[128:131], v[40:43]
    v_exp_f32 v96, v96
    v_mfma_f32_16x16x32_bf16 v[120:123], v[64:67], v[144:147], v[44:47]
    ds_read_b128 v[92:95], v2 offset:15360
    v_mfma_f32_16x16x32_bf16 v[112:115], v[68:71], v[132:135], v[112:115]
    v_exp_f32 v97, v97
    s_add_u32 s40, s40, 1
    v_mfma_f32_16x16x32_bf16 v[120:123], v[68:71], v[148:151], v[120:123]
    ds_read_b128 v[64:67], v3 offset:8192
    v_add_f32 v38, v38, v96
    s_add_u32 s49, s50, 32
    v_add_u32 v24, 65536, v2
    v_mfma_f32_16x16x32_bf16 v[112:115], v[72:75], v[136:139], v[112:115]
    v_exp_f32 v98, v98
    v_mfma_f32_16x16x32_bf16 v[120:123], v[72:75], v[152:155], v[120:123]
    ds_read_b128 v[68:71], v3 offset:9216
    v_add_f32 v38, v38, v97
    v_cvt_pk_bf16_f32 v48, v96, v97
    s_cmp_lt_u32 s40, s51
    s_cselect_b32 s36, 64, 128
    v_mfma_f32_16x16x32_bf16 v[112:115], v[76:79], v[140:143], v[112:115]
    v_exp_f32 v99, v99
    v_mfma_f32_16x16x32_bf16 v[120:123], v[76:79], v[156:159], v[120:123]
    ds_read_b128 v[72:75], v3 offset:10240
    v_add_f32 v38, v38, v98
    s_add_u32 s41, s41, s36
    s_waitcnt lgkmcnt(3)
    v_mfma_f32_16x16x32_bf16 v[116:119], v[80:83], v[128:131], v[40:43]
    v_exp_f32 v104, v104
    v_mfma_f32_16x16x32_bf16 v[124:127], v[80:83], v[144:147], v[44:47]
    ds_read_b128 v[76:79], v3 offset:11264
    v_add_f32 v38, v38, v99
    v_cvt_pk_bf16_f32 v49, v98, v99
    s_cmp_eq_u32 s40, s51
    s_cselect_b32 s36, s42, s36
    v_mfma_f32_16x16x32_bf16 v[116:119], v[84:87], v[132:135], v[116:119]
    v_exp_f32 v105, v105
    v_mfma_f32_16x16x32_bf16 v[124:127], v[84:87], v[148:151], v[124:127]
    ds_read_b128 v[80:83], v3 offset:12288
    v_add_f32 v39, v39, v104
    s_add_u32 s50, s50, s36
    v_mfma_f32_16x16x32_bf16 v[116:119], v[88:91], v[136:139], v[116:119]
    v_exp_f32 v106, v106
    v_mfma_f32_16x16x32_bf16 v[124:127], v[88:91], v[152:155], v[124:127]
    ds_read_b128 v[84:87], v3 offset:13312
    v_add_f32 v39, v39, v105
    v_cvt_pk_bf16_f32 v52, v104, v105
    s_and_b32 s36, s41, 0xff
    v_lshl_add_u32 v2, s36, 8, v7
    v_mfma_f32_16x16x32_bf16 v[116:119], v[92:95], v[140:143], v[116:119]
    v_exp_f32 v107, v107
    v_mfma_f32_16x16x32_bf16 v[124:127], v[92:95], v[156:159], v[124:127]
    ds_read_b128 v[88:91], v3 offset:14336
    v_add_f32 v39, v39, v106
    s_cmp_eq_u32 s40, 16
    s_cselect_b64 s[20:21], -1, 0
    s_waitcnt lgkmcnt(3)
    v_mfma_f32_16x16x32_bf16 v[192:195], v[64:67], v[56:59], v[192:195]
    v_exp_f32 v100, v100
    v_mfma_f32_16x16x32_bf16 v[224:227], v[64:67], v[60:63], v[224:227]
    ds_read_b128 v[92:95], v3 offset:15360
    v_add_f32 v39, v39, v107
    v_cvt_pk_bf16_f32 v53, v106, v107
    v_cndmask_b32 v5, v2, v24, s[20:21]
    v_mfma_f32_16x16x32_bf16 v[196:199], v[68:71], v[56:59], v[196:199]
    v_exp_f32 v101, v101
    v_mfma_f32_16x16x32_bf16 v[228:231], v[68:71], v[60:63], v[228:231]
    v_add_f32 v38, v38, v100
    v_mov_b32 v3, v24
    v_mfma_f32_16x16x32_bf16 v[200:203], v[72:75], v[56:59], v[200:203]
    v_exp_f32 v102, v102
    v_mfma_f32_16x16x32_bf16 v[232:235], v[72:75], v[60:63], v[232:235]
    v_add_f32 v38, v38, v101
    v_cvt_pk_bf16_f32 v50, v100, v101
    s_waitcnt lgkmcnt(0)
    s_barrier
    v_mfma_f32_16x16x32_bf16 v[204:207], v[76:79], v[56:59], v[204:207]
    v_exp_f32 v103, v103
    v_mfma_f32_16x16x32_bf16 v[236:239], v[76:79], v[60:63], v[236:239]
    ds_read_b128 v[68:71], v5 offset:1024
    ds_read_b128 v[64:67], v5 offset:0
    v_add_f32 v38, v38, v102
    v_mfma_f32_16x16x32_bf16 v[208:211], v[80:83], v[56:59], v[208:211]
    v_exp_f32 v108, v108
    v_mfma_f32_16x16x32_bf16 v[240:243], v[80:83], v[60:63], v[240:243]
    ds_read_b128 v[76:79], v5 offset:3072
    ds_read_b128 v[72:75], v5 offset:2048
    v_add_f32 v38, v38, v103
    v_cvt_pk_bf16_f32 v51, v102, v103
    v_mfma_f32_16x16x32_bf16 v[212:215], v[84:87], v[56:59], v[212:215]
    v_exp_f32 v109, v109
    v_mfma_f32_16x16x32_bf16 v[244:247], v[84:87], v[60:63], v[244:247]
    ds_read_b128 v[80:83], v5 offset:4096
    v_add_f32 v39, v39, v108
    v_mfma_f32_16x16x32_bf16 v[216:219], v[88:91], v[56:59], v[216:219]
    v_exp_f32 v110, v110
    v_mfma_f32_16x16x32_bf16 v[248:251], v[88:91], v[60:63], v[248:251]
    ds_read_b128 v[84:87], v5 offset:5120
    v_add_f32 v39, v39, v109
    v_cvt_pk_bf16_f32 v54, v108, v109
    v_mfma_f32_16x16x32_bf16 v[220:223], v[92:95], v[56:59], v[220:223]
    v_exp_f32 v111, v111
    v_mfma_f32_16x16x32_bf16 v[252:255], v[92:95], v[60:63], v[252:255]
    ds_read_b128 v[88:91], v5 offset:6144
    v_add_f32 v39, v39, v110
    v_add_f32 v39, v39, v111
    v_cvt_pk_bf16_f32 v55, v110, v111
    s_sub_u32 s36, s40, s51
    s_cmp_lt_u32 s36, 2
    s_cbranch_scc1 L_recurrent_scan__compressed_kv_cla__moe_arch_mod__prompt_kernel_rare_159
L_recurrent_scan__compressed_kv_cla__moe_arch_mod__prompt_kernel_back_160:
    s_cmp_lg_u32 s40, 16
    s_cbranch_scc1 L_body1
    s_lshr_b32 s38, s2, 4
    s_mul_i32 s38, s38, 224
    s_and_b32 s39, s2, 15
    s_lshl_b32 s39, s39, 7
    v_lshrrev_b32 v27, 3, v1
    s_lshl_b32 s36, s28, 5
    s_add_u32 s36, s36, s38
    v_add_u32 v27, s36, v27
    v_mul_u32_u24 v27, 2048, v27
    v_add_u32 v27, s39, v27
    v_bfe_u32 v28, v1, 4, 1
    v_lshlrev_b32 v28, 1, v28
    v_and_b32 v29, 7, v1
    v_xor_b32 v28, v28, v29
    v_lshl_add_u32 v26, v28, 4, v27
    v_xor_b32 v28, 4, v28
    v_lshl_add_u32 v27, v28, 4, v27
    v_add_u32 v27, 15360, v27
    v_add_u32 v28, 30720, v26
    v_add_u32 v29, 30720, v27
    s_lshl_b32 s36, s28, 12
    s_add_u32 s36, s36, 131072
    s_cmp_lt_u32 s28, 7
    s_cselect_b32 m0, s36, 0x30000
    s_cselect_b32 s6, 7340032, 0
    buffer_load_dwordx4 v26, s[4:7], 0 offen offset:0 lds
    buffer_load_dwordx4 v27, s[4:7], 0 offen offset:1024 lds
    buffer_load_dwordx4 v28, s[4:7], 0 offen offset:2048 lds
    buffer_load_dwordx4 v29, s[4:7], 0 offen offset:3072 lds
    s_lshr_b32 s36, s2, 5
    s_add_u32 s36, s36, 48
    s_lshl_b32 s36, s36, 7
    v_mov_b32 v12, s36
    global_load_dword v11, v12, s[90:91] sc1
    s_cmp_lt_i32 s49, 0
    s_cbranch_scc0 L_recurrent_scan__compressed_kv_cla__moe_arch_mod__prompt_kernel_rare_157
L_recurrent_scan__compressed_kv_cla__moe_arch_mod__prompt_kernel_back_158:
    s_waitcnt lgkmcnt(5)
    v_mfma_f32_16x16x32_bf16 v[192:195], v[64:67], v[48:51], v[192:195]
    v_exp_f32 v112, v112
    v_mfma_f32_16x16x32_bf16 v[224:227], v[64:67], v[52:55], v[224:227]
    ds_read_b128 v[92:95], v3 offset:7168
    v_add_f32 v38, v38, v112
    v_exp_f32 v113, v113
    v_mfma_f32_16x16x32_bf16 v[196:199], v[68:71], v[48:51], v[196:199]
    v_add_f32 v38, v38, v113
    v_cvt_pk_bf16_f32 v56, v112, v113
    v_exp_f32 v114, v114
    v_mfma_f32_16x16x32_bf16 v[228:231], v[68:71], v[52:55], v[228:231]
    ds_read_b128 v[64:67], v3 offset:8192
    v_add_f32 v38, v38, v114
    v_exp_f32 v115, v115
    s_waitcnt lgkmcnt(5)
    v_mfma_f32_16x16x32_bf16 v[200:203], v[72:75], v[48:51], v[200:203]
    v_add_f32 v38, v38, v115
    v_cvt_pk_bf16_f32 v57, v114, v115
    v_exp_f32 v120, v120
    v_mfma_f32_16x16x32_bf16 v[232:235], v[72:75], v[52:55], v[232:235]
    ds_read_b128 v[68:71], v3 offset:9216
    v_add_f32 v39, v39, v120
    v_exp_f32 v121, v121
    v_mfma_f32_16x16x32_bf16 v[204:207], v[76:79], v[48:51], v[204:207]
    v_add_f32 v39, v39, v121
    v_cvt_pk_bf16_f32 v60, v120, v121
    v_exp_f32 v122, v122
    v_mfma_f32_16x16x32_bf16 v[236:239], v[76:79], v[52:55], v[236:239]
    ds_read_b128 v[72:75], v3 offset:10240
    v_add_f32 v39, v39, v122
    v_exp_f32 v123, v123
    s_waitcnt lgkmcnt(6)
    v_mfma_f32_16x16x32_bf16 v[208:211], v[80:83], v[48:51], v[208:211]
    v_add_f32 v39, v39, v123
    v_cvt_pk_bf16_f32 v61, v122, v123
    v_exp_f32 v116, v116
    v_mfma_f32_16x16x32_bf16 v[240:243], v[80:83], v[52:55], v[240:243]
    ds_read_b128 v[76:79], v3 offset:11264
    v_add_f32 v38, v38, v116
    v_exp_f32 v117, v117
    s_waitcnt lgkmcnt(6)
    v_mfma_f32_16x16x32_bf16 v[212:215], v[84:87], v[48:51], v[212:215]
    v_add_f32 v38, v38, v117
    v_cvt_pk_bf16_f32 v58, v116, v117
    v_exp_f32 v118, v118
    v_mfma_f32_16x16x32_bf16 v[244:247], v[84:87], v[52:55], v[244:247]
    ds_read_b128 v[80:83], v3 offset:12288
    v_add_f32 v38, v38, v118
    v_exp_f32 v119, v119
    s_waitcnt lgkmcnt(6)
    v_mfma_f32_16x16x32_bf16 v[216:219], v[88:91], v[48:51], v[216:219]
    v_add_f32 v38, v38, v119
    v_cvt_pk_bf16_f32 v59, v118, v119
    v_exp_f32 v124, v124
    v_mfma_f32_16x16x32_bf16 v[248:251], v[88:91], v[52:55], v[248:251]
    ds_read_b128 v[84:87], v3 offset:13312
    v_add_f32 v39, v39, v124
    v_exp_f32 v125, v125
    s_waitcnt lgkmcnt(6)
    v_mfma_f32_16x16x32_bf16 v[220:223], v[92:95], v[48:51], v[220:223]
    v_add_f32 v39, v39, v125
    v_cvt_pk_bf16_f32 v62, v124, v125
    v_exp_f32 v126, v126
    v_mfma_f32_16x16x32_bf16 v[252:255], v[92:95], v[52:55], v[252:255]
    ds_read_b128 v[88:91], v3 offset:14336
    v_add_f32 v39, v39, v126
    v_exp_f32 v127, v127
    s_nop 0
    v_add_f32 v39, v39, v127
    v_cvt_pk_bf16_f32 v63, v126, v127
    s_nop 1
    s_waitcnt lgkmcnt(6)
    v_mfma_f32_16x16x32_bf16 v[192:195], v[64:67], v[56:59], v[192:195]
    v_mfma_f32_16x16x32_bf16 v[224:227], v[64:67], v[60:63], v[224:227]
    ds_read_b128 v[92:95], v3 offset:15360
    s_waitcnt lgkmcnt(6)
    v_mfma_f32_16x16x32_bf16 v[196:199], v[68:71], v[56:59], v[196:199]
    v_mfma_f32_16x16x32_bf16 v[228:231], v[68:71], v[60:63], v[228:231]
    s_waitcnt lgkmcnt(5)
    v_mfma_f32_16x16x32_bf16 v[200:203], v[72:75], v[56:59], v[200:203]
    v_mfma_f32_16x16x32_bf16 v[232:235], v[72:75], v[60:63], v[232:235]
    s_waitcnt lgkmcnt(4)
    v_mfma_f32_16x16x32_bf16 v[204:207], v[76:79], v[56:59], v[204:207]
    v_mfma_f32_16x16x32_bf16 v[236:239], v[76:79], v[60:63], v[236:239]
    s_waitcnt lgkmcnt(3)
    v_mfma_f32_16x16x32_bf16 v[208:211], v[80:83], v[56:59], v[208:211]
    v_mfma_f32_16x16x32_bf16 v[240:243], v[80:83], v[60:63], v[240:243]
    s_waitcnt lgkmcnt(2)
    v_mfma_f32_16x16x32_bf16 v[212:215], v[84:87], v[56:59], v[212:215]
    v_mfma_f32_16x16x32_bf16 v[244:247], v[84:87], v[60:63], v[244:247]
    s_waitcnt lgkmcnt(1)
    v_mfma_f32_16x16x32_bf16 v[216:219], v[88:91], v[56:59], v[216:219]
    v_mfma_f32_16x16x32_bf16 v[248:251], v[88:91], v[60:63], v[248:251]
    s_waitcnt lgkmcnt(0)
    v_mfma_f32_16x16x32_bf16 v[220:223], v[92:95], v[56:59], v[220:223]
    v_mfma_f32_16x16x32_bf16 v[252:255], v[92:95], v[60:63], v[252:255]
    s_lshl_b32 s37, s28, 13
    v_add_u32 v21, s37, v7
    v_xor_b32 v22, 32768, v21
    s_lshl_b32 s37, s28, 8
    s_add_u32 s37, s37, 159744
    v_lshl_add_u32 v23, v1, 2, s37
    v_xor_b32 v24, 1024, v23
    ds_write_b32 v23, v38
    s_mov_b32 s36, 0x5d800000
    v_cmp_nge_f32 vcc, s36, v38
    s_nop 0
    s_or_b64 s[52:53], s[52:53], vcc
    v_cmp_nge_f32 vcc, s36, v39
    s_nop 0
    s_or_b64 s[52:53], s[52:53], vcc
    s_or_b32 s36, s52, s53
    v_mov_b32 v26, s36
    s_lshl_b32 s37, s28, 2
    s_add_u32 s37, s37, 161792
    v_mov_b32 v27, s37
    ds_write_b32 v27, v26
    ds_write_b128 v21, v[192:195] offset:0
    ds_write_b128 v21, v[196:199] offset:1024
    ds_write_b128 v21, v[200:203] offset:2048
    ds_write_b128 v21, v[204:207] offset:3072
    ds_write_b128 v21, v[208:211] offset:4096
    ds_write_b128 v21, v[212:215] offset:5120
    ds_write_b128 v21, v[216:219] offset:6144
    ds_write_b128 v21, v[220:223] offset:7168
    v_and_b32 v27, 7, v1
    v_lshlrev_b32 v27, 2, v27
    v_add_u32 v27, 161792, v27
    s_sub_u32 s36, 15, s30
    s_lshl_b32 s38, s36, 3
    s_and_b32 s37, s28, 3
    s_lshl_b32 s37, s37, 1
    s_add_u32 s38, s38, s37
    s_add_u32 s38, s38, 1
    s_lshl_b32 s38, s38, 17
    s_lshl_b32 s37, s29, 12
    s_add_u32 s38, s38, s37
    s_waitcnt lgkmcnt(0)
    s_barrier
    ds_read_b32 v26, v27
    ds_read_b32 v25, v24
    ds_read_b128 v[64:67], v22 offset:0
    ds_read_b128 v[68:71], v22 offset:1024
    ds_read_b128 v[72:75], v22 offset:2048
    ds_read_b128 v[76:79], v22 offset:3072
    ds_read_b128 v[80:83], v22 offset:4096
    ds_read_b128 v[84:87], v22 offset:5120
    ds_read_b128 v[88:91], v22 offset:6144
    ds_read_b128 v[92:95], v22 offset:7168
    s_waitcnt lgkmcnt(8)
    v_add_f32 v25, v25, v39
    v_mov_b32 v20, v25
    s_nop 1
    v_permlane16_swap_b32 v25, v20
    s_nop 1
    v_add_f32 v25, v25, v20
    v_mov_b32 v20, v25
    s_nop 1
    v_permlane32_swap_b32 v25, v20
    s_nop 1
    v_add_f32 v25, v25, v20
    v_cmp_ne_u32 s[52:53], 0, v26
    v_rcp_f32 v25, v25
    s_waitcnt lgkmcnt(6)
    v_add_f32 v224, v224, v64
    v_add_f32 v225, v225, v65
    v_add_f32 v226, v226, v66
    v_add_f32 v227, v227, v67
    v_add_f32 v228, v228, v68
    v_add_f32 v229, v229, v69
    v_add_f32 v230, v230, v70
    v_add_f32 v231, v231, v71
    v_mul_f32 v224, v25, v224
    v_mul_f32 v225, v25, v225
    v_mul_f32 v226, v25, v226
    v_mul_f32 v227, v25, v227
    v_mul_f32 v228, v25, v228
    v_mul_f32 v229, v25, v229
    v_mul_f32 v230, v25, v230
    v_mul_f32 v231, v25, v231
    v_cvt_pk_bf16_f32 v48, v224, v225
    v_cvt_pk_bf16_f32 v49, v226, v227
    v_cvt_pk_bf16_f32 v50, v228, v229
    v_cvt_pk_bf16_f32 v51, v230, v231
    buffer_store_dwordx4 v[48:51], v7, s[16:19], s38 offen offset:0 sc1
    s_waitcnt lgkmcnt(4)
    v_add_f32 v232, v232, v72
    v_add_f32 v233, v233, v73
    v_add_f32 v234, v234, v74
    v_add_f32 v235, v235, v75
    v_add_f32 v236, v236, v76
    v_add_f32 v237, v237, v77
    v_add_f32 v238, v238, v78
    v_add_f32 v239, v239, v79
    v_mul_f32 v232, v25, v232
    v_mul_f32 v233, v25, v233
    v_mul_f32 v234, v25, v234
    v_mul_f32 v235, v25, v235
    v_mul_f32 v236, v25, v236
    v_mul_f32 v237, v25, v237
    v_mul_f32 v238, v25, v238
    v_mul_f32 v239, v25, v239
    v_cvt_pk_bf16_f32 v52, v232, v233
    v_cvt_pk_bf16_f32 v53, v234, v235
    v_cvt_pk_bf16_f32 v54, v236, v237
    v_cvt_pk_bf16_f32 v55, v238, v239
    buffer_store_dwordx4 v[52:55], v7, s[16:19], s38 offen offset:1024 sc1
    s_waitcnt lgkmcnt(2)
    v_add_f32 v240, v240, v80
    v_add_f32 v241, v241, v81
    v_add_f32 v242, v242, v82
    v_add_f32 v243, v243, v83
    v_add_f32 v244, v244, v84
    v_add_f32 v245, v245, v85
    v_add_f32 v246, v246, v86
    v_add_f32 v247, v247, v87
    v_mul_f32 v240, v25, v240
    v_mul_f32 v241, v25, v241
    v_mul_f32 v242, v25, v242
    v_mul_f32 v243, v25, v243
    v_mul_f32 v244, v25, v244
    v_mul_f32 v245, v25, v245
    v_mul_f32 v246, v25, v246
    v_mul_f32 v247, v25, v247
    v_cvt_pk_bf16_f32 v56, v240, v241
    v_cvt_pk_bf16_f32 v57, v242, v243
    v_cvt_pk_bf16_f32 v58, v244, v245
    v_cvt_pk_bf16_f32 v59, v246, v247
    buffer_store_dwordx4 v[56:59], v7, s[16:19], s38 offen offset:2048 sc1
    s_waitcnt lgkmcnt(0)
    v_add_f32 v248, v248, v88
    v_add_f32 v249, v249, v89
    v_add_f32 v250, v250, v90
    v_add_f32 v251, v251, v91
    v_add_f32 v252, v252, v92
    v_add_f32 v253, v253, v93
    v_add_f32 v254, v254, v94
    v_add_f32 v255, v255, v95
    v_mul_f32 v248, v25, v248
    v_mul_f32 v249, v25, v249
    v_mul_f32 v250, v25, v250
    v_mul_f32 v251, v25, v251
    v_mul_f32 v252, v25, v252
    v_mul_f32 v253, v25, v253
    v_mul_f32 v254, v25, v254
    v_mul_f32 v255, v25, v255
    v_cvt_pk_bf16_f32 v60, v248, v249
    v_cvt_pk_bf16_f32 v61, v250, v251
    v_cvt_pk_bf16_f32 v62, v252, v253
    v_cvt_pk_bf16_f32 v63, v254, v255
    buffer_store_dwordx4 v[60:63], v7, s[16:19], s38 offen offset:3072 sc1
    s_cmp_eq_u64 s[52:53], 0
    s_cbranch_scc1 L_p3_done
    v_swap_b32 v128, v160
    v_swap_b32 v129, v161
    v_swap_b32 v130, v162
    v_swap_b32 v131, v163
    v_swap_b32 v132, v164
    v_swap_b32 v133, v165
    v_swap_b32 v134, v166
    v_swap_b32 v135, v167
    v_swap_b32 v136, v168
    v_swap_b32 v137, v169
    v_swap_b32 v138, v170
    v_swap_b32 v139, v171
    v_swap_b32 v140, v172
    v_swap_b32 v141, v173
    v_swap_b32 v142, v174
    v_swap_b32 v143, v175
    v_swap_b32 v144, v176
    v_swap_b32 v145, v177
    v_swap_b32 v146, v178
    v_swap_b32 v147, v179
    v_swap_b32 v148, v180
    v_swap_b32 v149, v181
    v_swap_b32 v150, v182
    v_swap_b32 v151, v183
    v_swap_b32 v152, v184
    v_swap_b32 v153, v185
    v_swap_b32 v154, v186
    v_swap_b32 v155, v187
    v_swap_b32 v156, v188
    v_swap_b32 v157, v189
    v_swap_b32 v158, v190
    v_swap_b32 v159, v191
    v_mov_b32 v192, 0
    v_mov_b32 v193, 0
    v_mov_b32 v194, 0
    v_mov_b32 v195, 0
    v_mov_b32 v196, 0
    v_mov_b32 v197, 0
    v_mov_b32 v198, 0
    v_mov_b32 v199, 0
    v_mov_b32 v200, 0
    v_mov_b32 v201, 0
    v_mov_b32 v202, 0
    v_mov_b32 v203, 0
    v_mov_b32 v204, 0
    v_mov_b32 v205, 0
    v_mov_b32 v206, 0
    v_mov_b32 v207, 0
    v_mov_b32 v208, 0
    v_mov_b32 v209, 0
    v_mov_b32 v210, 0
    v_mov_b32 v211, 0
    v_mov_b32 v212, 0
    v_mov_b32 v213, 0
    v_mov_b32 v214, 0
    v_mov_b32 v215, 0
    v_mov_b32 v216, 0
    v_mov_b32 v217, 0
    v_mov_b32 v218, 0
    v_mov_b32 v219, 0
    v_mov_b32 v220, 0
    v_mov_b32 v221, 0
    v_mov_b32 v222, 0
    v_mov_b32 v223, 0
    v_mov_b32 v224, 0
    v_mov_b32 v225, 0
    v_mov_b32 v226, 0
    v_mov_b32 v227, 0
    v_mov_b32 v228, 0
    v_mov_b32 v229, 0
    v_mov_b32 v230, 0
    v_mov_b32 v231, 0
    v_mov_b32 v232, 0
    v_mov_b32 v233, 0
    v_mov_b32 v234, 0
    v_mov_b32 v235, 0
    v_mov_b32 v236, 0
    v_mov_b32 v237, 0
    v_mov_b32 v238, 0
    v_mov_b32 v239, 0
    v_mov_b32 v240, 0
    v_mov_b32 v241, 0
    v_mov_b32 v242, 0
    v_mov_b32 v243, 0
    v_mov_b32 v244, 0
    v_mov_b32 v245, 0
    v_mov_b32 v246, 0
    v_mov_b32 v247, 0
    v_mov_b32 v248, 0
    v_mov_b32 v249, 0
    v_mov_b32 v250, 0
    v_mov_b32 v251, 0
    v_mov_b32 v252, 0
    v_mov_b32 v253, 0
    v_mov_b32 v254, 0
    v_mov_b32 v255, 0
    v_mov_b32 v38, 0
    v_mov_b32 v40, 4048155338
    v_mov_b32 v39, 0
    v_mov_b32 v41, 4048155338
    s_lshl_b32 s43, s28, 12
    v_add_u32 v4, s43, v7
    s_mov_b32 s46, s45
    s_sub_u32 s40, 16, s30
    s_mov_b32 s39, s30
    s_lshl_b32 s37, s39, 7
    s_and_b32 s36, s28, 3
    s_lshl_b32 s36, s36, 5
    s_add_u32 s36, s36, s37
    s_sub_u32 s50, 0, s36
L_recurrent_scan__compressed_kv_cla__moe_arch_mod__prompt_kernel_stile_162:
    s_waitcnt vmcnt(0) lgkmcnt(0)
    s_barrier
    s_mov_b32 m0, s43
    s_add_u32 s47, s46, 32768
    buffer_load_dwordx4 v4, s[12:15], s46 offen offset:0 sc1 lds
    buffer_load_dwordx4 v4, s[12:15], s46 offen offset:1024 sc1 lds
    buffer_load_dwordx4 v4, s[12:15], s46 offen offset:2048 sc1 lds
    buffer_load_dwordx4 v4, s[12:15], s46 offen offset:3072 sc1 lds
    s_add_u32 m0, s43, 32768
    s_add_u32 s46, s46, 65536
    buffer_load_dwordx4 v4, s[12:15], s47 offen offset:0 sc1 lds
    buffer_load_dwordx4 v4, s[12:15], s47 offen offset:1024 sc1 lds
    buffer_load_dwordx4 v4, s[12:15], s47 offen offset:2048 sc1 lds
    buffer_load_dwordx4 v4, s[12:15], s47 offen offset:3072 sc1 lds
    v_mov_b32 v2, v7
    s_mov_b32 s41, 4
    s_waitcnt vmcnt(0)
    s_barrier
L_recurrent_scan__compressed_kv_cla__moe_arch_mod__prompt_kernel_sunit_163:
    s_cmp_gt_i32 s50, 0
    s_cbranch_scc1 L_recurrent_scan__compressed_kv_cla__moe_arch_mod__prompt_kernel_snext_164
    ds_read_b128 v[64:67], v2 offset:0
    ds_read_b128 v[68:71], v2 offset:1024
    ds_read_b128 v[72:75], v2 offset:2048
    ds_read_b128 v[76:79], v2 offset:3072
    ds_read_b128 v[80:83], v2 offset:4096
    ds_read_b128 v[84:87], v2 offset:5120
    ds_read_b128 v[88:91], v2 offset:6144
    ds_read_b128 v[92:95], v2 offset:7168
    s_waitcnt lgkmcnt(0)
    v_mfma_f32_16x16x32_bf16 v[96:99], v[64:67], v[128:131], 0
    v_mfma_f32_16x16x32_bf16 v[104:107], v[64:67], v[144:147], 0
    v_mfma_f32_16x16x32_bf16 v[96:99], v[68:71], v[132:135], v[96:99]
    v_mfma_f32_16x16x32_bf16 v[104:107], v[68:71], v[148:151], v[104:107]
    v_mfma_f32_16x16x32_bf16 v[96:99], v[72:75], v[136:139], v[96:99]
    v_mfma_f32_16x16x32_bf16 v[104:107], v[72:75], v[152:155], v[104:107]
    v_mfma_f32_16x16x32_bf16 v[96:99], v[76:79], v[140:143], v[96:99]
    v_mfma_f32_16x16x32_bf16 v[104:107], v[76:79], v[156:159], v[104:107]
    v_mfma_f32_16x16x32_bf16 v[100:103], v[80:83], v[128:131], 0
    v_mfma_f32_16x16x32_bf16 v[108:111], v[80:83], v[144:147], 0
    v_mfma_f32_16x16x32_bf16 v[100:103], v[84:87], v[132:135], v[100:103]
    v_mfma_f32_16x16x32_bf16 v[108:111], v[84:87], v[148:151], v[108:111]
    v_mfma_f32_16x16x32_bf16 v[100:103], v[88:91], v[136:139], v[100:103]
    v_mfma_f32_16x16x32_bf16 v[108:111], v[88:91], v[152:155], v[108:111]
    v_mfma_f32_16x16x32_bf16 v[100:103], v[92:95], v[140:143], v[100:103]
    v_mfma_f32_16x16x32_bf16 v[108:111], v[92:95], v[156:159], v[108:111]
    ds_read_b128 v[64:67], v2 offset:32768
    ds_read_b128 v[68:71], v2 offset:33792
    ds_read_b128 v[72:75], v2 offset:34816
    ds_read_b128 v[76:79], v2 offset:35840
    ds_read_b128 v[80:83], v2 offset:36864
    ds_read_b128 v[84:87], v2 offset:37888
    ds_read_b128 v[88:91], v2 offset:38912
    ds_read_b128 v[92:95], v2 offset:39936
    s_nop 1
    s_cmp_lt_i32 s50, 0
    s_cbranch_scc0 L_recurrent_scan__compressed_kv_cla__moe_arch_mod__prompt_kernel_rare_165
L_recurrent_scan__compressed_kv_cla__moe_arch_mod__prompt_kernel_back_166:
    v_max3_f32 v22, v96, v97, v98
    v_max3_f32 v22, v22, v99, v100
    v_max3_f32 v22, v22, v101, v102
    v_max3_f32 v22, v22, v103, v40
    v_mov_b32 v24, v22
    s_nop 1
    v_permlane16_swap_b32 v22, v24
    s_nop 1
    v_max_f32 v22, v22, v24
    v_mov_b32 v24, v22
    s_nop 1
    v_permlane32_swap_b32 v22, v24
    s_nop 1
    v_max_f32 v22, v22, v24
    v_sub_f32 v25, v40, v22
    v_exp_f32 v25, v25
    v_mov_b32 v40, v22
    v_mul_f32 v38, v38, v25
    v_mul_f32 v192, v192, v25
    v_mul_f32 v193, v193, v25
    v_mul_f32 v194, v194, v25
    v_mul_f32 v195, v195, v25
    v_mul_f32 v196, v196, v25
    v_mul_f32 v197, v197, v25
    v_mul_f32 v198, v198, v25
    v_mul_f32 v199, v199, v25
    v_mul_f32 v200, v200, v25
    v_mul_f32 v201, v201, v25
    v_mul_f32 v202, v202, v25
    v_mul_f32 v203, v203, v25
    v_mul_f32 v204, v204, v25
    v_mul_f32 v205, v205, v25
    v_mul_f32 v206, v206, v25
    v_mul_f32 v207, v207, v25
    v_mul_f32 v208, v208, v25
    v_mul_f32 v209, v209, v25
    v_mul_f32 v210, v210, v25
    v_mul_f32 v211, v211, v25
    v_mul_f32 v212, v212, v25
    v_mul_f32 v213, v213, v25
    v_mul_f32 v214, v214, v25
    v_mul_f32 v215, v215, v25
    v_mul_f32 v216, v216, v25
    v_mul_f32 v217, v217, v25
    v_mul_f32 v218, v218, v25
    v_mul_f32 v219, v219, v25
    v_mul_f32 v220, v220, v25
    v_mul_f32 v221, v221, v25
    v_mul_f32 v222, v222, v25
    v_mul_f32 v223, v223, v25
    v_sub_f32 v96, v96, v22
    v_sub_f32 v97, v97, v22
    v_sub_f32 v98, v98, v22
    v_sub_f32 v99, v99, v22
    v_sub_f32 v100, v100, v22
    v_sub_f32 v101, v101, v22
    v_sub_f32 v102, v102, v22
    v_sub_f32 v103, v103, v22
    v_max3_f32 v23, v104, v105, v106
    v_max3_f32 v23, v23, v107, v108
    v_max3_f32 v23, v23, v109, v110
    v_max3_f32 v23, v23, v111, v41
    v_mov_b32 v24, v23
    s_nop 1
    v_permlane16_swap_b32 v23, v24
    s_nop 1
    v_max_f32 v23, v23, v24
    v_mov_b32 v24, v23
    s_nop 1
    v_permlane32_swap_b32 v23, v24
    s_nop 1
    v_max_f32 v23, v23, v24
    v_sub_f32 v25, v41, v23
    v_exp_f32 v25, v25
    v_mov_b32 v41, v23
    v_mul_f32 v39, v39, v25
    v_mul_f32 v224, v224, v25
    v_mul_f32 v225, v225, v25
    v_mul_f32 v226, v226, v25
    v_mul_f32 v227, v227, v25
    v_mul_f32 v228, v228, v25
    v_mul_f32 v229, v229, v25
    v_mul_f32 v230, v230, v25
    v_mul_f32 v231, v231, v25
    v_mul_f32 v232, v232, v25
    v_mul_f32 v233, v233, v25
    v_mul_f32 v234, v234, v25
    v_mul_f32 v235, v235, v25
    v_mul_f32 v236, v236, v25
    v_mul_f32 v237, v237, v25
    v_mul_f32 v238, v238, v25
    v_mul_f32 v239, v239, v25
    v_mul_f32 v240, v240, v25
    v_mul_f32 v241, v241, v25
    v_mul_f32 v242, v242, v25
    v_mul_f32 v243, v243, v25
    v_mul_f32 v244, v244, v25
    v_mul_f32 v245, v245, v25
    v_mul_f32 v246, v246, v25
    v_mul_f32 v247, v247, v25
    v_mul_f32 v248, v248, v25
    v_mul_f32 v249, v249, v25
    v_mul_f32 v250, v250, v25
    v_mul_f32 v251, v251, v25
    v_mul_f32 v252, v252, v25
    v_mul_f32 v253, v253, v25
    v_mul_f32 v254, v254, v25
    v_mul_f32 v255, v255, v25
    v_sub_f32 v104, v104, v23
    v_sub_f32 v105, v105, v23
    v_sub_f32 v106, v106, v23
    v_sub_f32 v107, v107, v23
    v_sub_f32 v108, v108, v23
    v_sub_f32 v109, v109, v23
    v_sub_f32 v110, v110, v23
    v_sub_f32 v111, v111, v23
    v_exp_f32 v96, v96
    v_exp_f32 v97, v97
    v_exp_f32 v98, v98
    v_exp_f32 v99, v99
    v_exp_f32 v104, v104
    v_exp_f32 v105, v105
    v_exp_f32 v106, v106
    v_exp_f32 v107, v107
    v_exp_f32 v100, v100
    v_exp_f32 v101, v101
    v_exp_f32 v102, v102
    v_exp_f32 v103, v103
    v_exp_f32 v108, v108
    v_exp_f32 v109, v109
    v_exp_f32 v110, v110
    v_exp_f32 v111, v111
    v_add_f32 v38, v38, v96
    v_add_f32 v38, v38, v97
    v_cvt_pk_bf16_f32 v48, v96, v97
    v_add_f32 v38, v38, v98
    v_add_f32 v38, v38, v99
    v_cvt_pk_bf16_f32 v49, v98, v99
    v_add_f32 v39, v39, v104
    v_add_f32 v39, v39, v105
    v_cvt_pk_bf16_f32 v52, v104, v105
    v_add_f32 v39, v39, v106
    v_add_f32 v39, v39, v107
    v_cvt_pk_bf16_f32 v53, v106, v107
    v_add_f32 v38, v38, v100
    v_add_f32 v38, v38, v101
    v_cvt_pk_bf16_f32 v50, v100, v101
    v_add_f32 v38, v38, v102
    v_add_f32 v38, v38, v103
    v_cvt_pk_bf16_f32 v51, v102, v103
    v_add_f32 v39, v39, v108
    v_add_f32 v39, v39, v109
    v_cvt_pk_bf16_f32 v54, v108, v109
    v_add_f32 v39, v39, v110
    v_add_f32 v39, v39, v111
    v_cvt_pk_bf16_f32 v55, v110, v111
    s_waitcnt lgkmcnt(0)
    s_nop 0
    v_mfma_f32_16x16x32_bf16 v[192:195], v[64:67], v[48:51], v[192:195]
    v_mfma_f32_16x16x32_bf16 v[224:227], v[64:67], v[52:55], v[224:227]
    v_mfma_f32_16x16x32_bf16 v[196:199], v[68:71], v[48:51], v[196:199]
    v_mfma_f32_16x16x32_bf16 v[228:231], v[68:71], v[52:55], v[228:231]
    v_mfma_f32_16x16x32_bf16 v[200:203], v[72:75], v[48:51], v[200:203]
    v_mfma_f32_16x16x32_bf16 v[232:235], v[72:75], v[52:55], v[232:235]
    v_mfma_f32_16x16x32_bf16 v[204:207], v[76:79], v[48:51], v[204:207]
    v_mfma_f32_16x16x32_bf16 v[236:239], v[76:79], v[52:55], v[236:239]
    v_mfma_f32_16x16x32_bf16 v[208:211], v[80:83], v[48:51], v[208:211]
    v_mfma_f32_16x16x32_bf16 v[240:243], v[80:83], v[52:55], v[240:243]
    v_mfma_f32_16x16x32_bf16 v[212:215], v[84:87], v[48:51], v[212:215]
    v_mfma_f32_16x16x32_bf16 v[244:247], v[84:87], v[52:55], v[244:247]
    v_mfma_f32_16x16x32_bf16 v[216:219], v[88:91], v[48:51], v[216:219]
    v_mfma_f32_16x16x32_bf16 v[248:251], v[88:91], v[52:55], v[248:251]
    v_mfma_f32_16x16x32_bf16 v[220:223], v[92:95], v[48:51], v[220:223]
    v_mfma_f32_16x16x32_bf16 v[252:255], v[92:95], v[52:55], v[252:255]
L_recurrent_scan__compressed_kv_cla__moe_arch_mod__prompt_kernel_snext_164:
    v_add_u32 v2, 8192, v2
    s_add_u32 s50, s50, 32
    s_sub_u32 s41, s41, 1
    s_cmp_lg_u32 s41, 0
    s_cbranch_scc1 L_recurrent_scan__compressed_kv_cla__moe_arch_mod__prompt_kernel_sunit_163
    s_sub_u32 s40, s40, 1
    s_cmp_lg_u32 s40, 0
    s_cbranch_scc1 L_recurrent_scan__compressed_kv_cla__moe_arch_mod__prompt_kernel_stile_162
    v_mov_b32 v20, v38
    s_nop 1
    v_permlane16_swap_b32 v38, v20
    s_nop 1
    v_add_f32 v38, v38, v20
    v_mov_b32 v20, v38
    s_nop 1
    v_permlane32_swap_b32 v38, v20
    s_nop 1
    v_add_f32 v38, v38, v20
    v_mov_b32 v20, v39
    s_nop 1
    v_permlane16_swap_b32 v39, v20
    s_nop 1
    v_add_f32 v39, v39, v20
    v_mov_b32 v20, v39
    s_nop 1
    v_permlane32_swap_b32 v39, v20
    s_nop 1
    v_add_f32 v39, v39, v20
    s_mov_b32 s36, 0x5d800000
    v_cmp_nge_f32 vcc, s36, v38
    s_nop 0
    s_or_b64 s[52:53], s[52:53], vcc
    v_cmp_nge_f32 vcc, s36, v39
    s_nop 0
    s_or_b64 s[52:53], s[52:53], vcc
    v_rcp_f32 v38, v38
    v_rcp_f32 v39, v39
    s_lshl_b32 s38, s39, 3
    s_and_b32 s37, s28, 3
    s_lshl_b32 s37, s37, 1
    s_add_u32 s38, s38, s37
    s_lshl_b32 s38, s38, 17
    s_lshl_b32 s37, s29, 12
    s_add_u32 s38, s38, s37
    v_mul_f32 v192, v38, v192
    v_mul_f32 v193, v38, v193
    v_mul_f32 v194, v38, v194
    v_mul_f32 v195, v38, v195
    v_mul_f32 v196, v38, v196
    v_mul_f32 v197, v38, v197
    v_mul_f32 v198, v38, v198
    v_mul_f32 v199, v38, v199
    v_cvt_pk_bf16_f32 v22, v192, v193
    v_cvt_pk_bf16_f32 v23, v194, v195
    v_cvt_pk_bf16_f32 v24, v196, v197
    v_cvt_pk_bf16_f32 v25, v198, v199
    buffer_store_dwordx4 v[22:25], v7, s[16:19], s38 offen offset:0 sc1
    v_mul_f32 v200, v38, v200
    v_mul_f32 v201, v38, v201
    v_mul_f32 v202, v38, v202
    v_mul_f32 v203, v38, v203
    v_mul_f32 v204, v38, v204
    v_mul_f32 v205, v38, v205
    v_mul_f32 v206, v38, v206
    v_mul_f32 v207, v38, v207
    v_cvt_pk_bf16_f32 v26, v200, v201
    v_cvt_pk_bf16_f32 v27, v202, v203
    v_cvt_pk_bf16_f32 v28, v204, v205
    v_cvt_pk_bf16_f32 v29, v206, v207
    buffer_store_dwordx4 v[26:29], v7, s[16:19], s38 offen offset:1024 sc1
    v_mul_f32 v208, v38, v208
    v_mul_f32 v209, v38, v209
    v_mul_f32 v210, v38, v210
    v_mul_f32 v211, v38, v211
    v_mul_f32 v212, v38, v212
    v_mul_f32 v213, v38, v213
    v_mul_f32 v214, v38, v214
    v_mul_f32 v215, v38, v215
    v_cvt_pk_bf16_f32 v30, v208, v209
    v_cvt_pk_bf16_f32 v31, v210, v211
    v_cvt_pk_bf16_f32 v32, v212, v213
    v_cvt_pk_bf16_f32 v33, v214, v215
    buffer_store_dwordx4 v[30:33], v7, s[16:19], s38 offen offset:2048 sc1
    v_mul_f32 v216, v38, v216
    v_mul_f32 v217, v38, v217
    v_mul_f32 v218, v38, v218
    v_mul_f32 v219, v38, v219
    v_mul_f32 v220, v38, v220
    v_mul_f32 v221, v38, v221
    v_mul_f32 v222, v38, v222
    v_mul_f32 v223, v38, v223
    v_cvt_pk_bf16_f32 v34, v216, v217
    v_cvt_pk_bf16_f32 v35, v218, v219
    v_cvt_pk_bf16_f32 v36, v220, v221
    v_cvt_pk_bf16_f32 v37, v222, v223
    buffer_store_dwordx4 v[34:37], v7, s[16:19], s38 offen offset:3072 sc1
    s_add_u32 s38, s38, 131072
    v_mul_f32 v224, v39, v224
    v_mul_f32 v225, v39, v225
    v_mul_f32 v226, v39, v226
    v_mul_f32 v227, v39, v227
    v_mul_f32 v228, v39, v228
    v_mul_f32 v229, v39, v229
    v_mul_f32 v230, v39, v230
    v_mul_f32 v231, v39, v231
    v_cvt_pk_bf16_f32 v22, v224, v225
    v_cvt_pk_bf16_f32 v23, v226, v227
    v_cvt_pk_bf16_f32 v24, v228, v229
    v_cvt_pk_bf16_f32 v25, v230, v231
    buffer_store_dwordx4 v[22:25], v7, s[16:19], s38 offen offset:0 sc1
    v_mul_f32 v232, v39, v232
    v_mul_f32 v233, v39, v233
    v_mul_f32 v234, v39, v234
    v_mul_f32 v235, v39, v235
    v_mul_f32 v236, v39, v236
    v_mul_f32 v237, v39, v237
    v_mul_f32 v238, v39, v238
    v_mul_f32 v239, v39, v239
    v_cvt_pk_bf16_f32 v26, v232, v233
    v_cvt_pk_bf16_f32 v27, v234, v235
    v_cvt_pk_bf16_f32 v28, v236, v237
    v_cvt_pk_bf16_f32 v29, v238, v239
    buffer_store_dwordx4 v[26:29], v7, s[16:19], s38 offen offset:1024 sc1
    v_mul_f32 v240, v39, v240
    v_mul_f32 v241, v39, v241
    v_mul_f32 v242, v39, v242
    v_mul_f32 v243, v39, v243
    v_mul_f32 v244, v39, v244
    v_mul_f32 v245, v39, v245
    v_mul_f32 v246, v39, v246
    v_mul_f32 v247, v39, v247
    v_cvt_pk_bf16_f32 v30, v240, v241
    v_cvt_pk_bf16_f32 v31, v242, v243
    v_cvt_pk_bf16_f32 v32, v244, v245
    v_cvt_pk_bf16_f32 v33, v246, v247
    buffer_store_dwordx4 v[30:33], v7, s[16:19], s38 offen offset:2048 sc1
    v_mul_f32 v248, v39, v248
    v_mul_f32 v249, v39, v249
    v_mul_f32 v250, v39, v250
    v_mul_f32 v251, v39, v251
    v_mul_f32 v252, v39, v252
    v_mul_f32 v253, v39, v253
    v_mul_f32 v254, v39, v254
    v_mul_f32 v255, v39, v255
    v_cvt_pk_bf16_f32 v34, v248, v249
    v_cvt_pk_bf16_f32 v35, v250, v251
    v_cvt_pk_bf16_f32 v36, v252, v253
    v_cvt_pk_bf16_f32 v37, v254, v255
    buffer_store_dwordx4 v[34:37], v7, s[16:19], s38 offen offset:3072 sc1
    s_branch L_p3_done
L_recurrent_scan__compressed_kv_cla__moe_arch_mod__prompt_kernel_rare_146:
    s_lshl_b32 s36, s29, 7
    v_mov_b32 v20, s36
    s_mul_i32 s36, s2, 2341
    s_lshr_b32 s36, s36, 16
    s_add_u32 s36, s36, 48
    s_lshl_b32 s36, s36, 7
    v_mov_b32 v21, s36
    v_cmp_eq_u32 vcc, 1, v1
    v_mov_b32 v22, 1
    s_nop 0
    v_cndmask_b32 v20, v20, v21, vcc
    s_mov_b64 exec, 3
    global_atomic_add v20, v22, s[90:91]
    s_mov_b64 exec, -1
    s_branch L_recurrent_scan__compressed_kv_cla__moe_arch_mod__prompt_kernel_back_147
L_recurrent_scan__compressed_kv_cla__moe_arch_mod__prompt_kernel_rare_148:
    v_mov_b32 v20, 4048155338
    v_subrev_u32 v21, s50, v18
    v_cmp_gt_i32 s[20:21], 0, v21
    v_cmp_gt_i32 s[22:23], 1, v21
    v_cmp_gt_i32 s[62:63], 2, v21
    v_cmp_gt_i32 vcc, 3, v21
    v_cndmask_b32 v96, v96, v20, s[20:21]
    v_cndmask_b32 v97, v97, v20, s[22:23]
    v_cndmask_b32 v98, v98, v20, s[62:63]
    v_cndmask_b32 v99, v99, v20, vcc
    v_cmp_gt_i32 s[20:21], 16, v21
    v_cmp_gt_i32 s[22:23], 17, v21
    v_cmp_gt_i32 s[62:63], 18, v21
    v_cmp_gt_i32 vcc, 19, v21
    v_cndmask_b32 v100, v100, v20, s[20:21]
    v_cndmask_b32 v101, v101, v20, s[22:23]
    v_cndmask_b32 v102, v102, v20, s[62:63]
    v_cndmask_b32 v103, v103, v20, vcc
    v_cmp_gt_i32 s[20:21], -16, v21
    v_cmp_gt_i32 s[22:23], -15, v21
    v_cmp_gt_i32 s[62:63], -14, v21
    v_cmp_gt_i32 vcc, -13, v21
    v_cndmask_b32 v104, v104, v20, s[20:21]
    v_cndmask_b32 v105, v105, v20, s[22:23]
    v_cndmask_b32 v106, v106, v20, s[62:63]
    v_cndmask_b32 v107, v107, v20, vcc
    v_cmp_gt_i32 s[20:21], 0, v21
    v_cmp_gt_i32 s[22:23], 1, v21
    v_cmp_gt_i32 s[62:63], 2, v21
    v_cmp_gt_i32 vcc, 3, v21
    v_cndmask_b32 v108, v108, v20, s[20:21]
    v_cndmask_b32 v109, v109, v20, s[22:23]
    v_cndmask_b32 v110, v110, v20, s[62:63]
    v_cndmask_b32 v111, v111, v20, vcc
    s_branch L_recurrent_scan__compressed_kv_cla__moe_arch_mod__prompt_kernel_back_149
L_recurrent_scan__compressed_kv_cla__moe_arch_mod__prompt_kernel_rare_151:
    v_mov_b32 v20, 4048155338
    v_subrev_u32 v21, s49, v18
    v_cmp_gt_i32 s[20:21], 0, v21
    v_cmp_gt_i32 s[22:23], 1, v21
    v_cmp_gt_i32 s[62:63], 2, v21
    v_cmp_gt_i32 vcc, 3, v21
    v_cndmask_b32 v112, v112, v20, s[20:21]
    v_cndmask_b32 v113, v113, v20, s[22:23]
    v_cndmask_b32 v114, v114, v20, s[62:63]
    v_cndmask_b32 v115, v115, v20, vcc
    v_cmp_gt_i32 s[20:21], 16, v21
    v_cmp_gt_i32 s[22:23], 17, v21
    v_cmp_gt_i32 s[62:63], 18, v21
    v_cmp_gt_i32 vcc, 19, v21
    v_cndmask_b32 v116, v116, v20, s[20:21]
    v_cndmask_b32 v117, v117, v20, s[22:23]
    v_cndmask_b32 v118, v118, v20, s[62:63]
    v_cndmask_b32 v119, v119, v20, vcc
    v_cmp_gt_i32 s[20:21], -16, v21
    v_cmp_gt_i32 s[22:23], -15, v21
    v_cmp_gt_i32 s[62:63], -14, v21
    v_cmp_gt_i32 vcc, -13, v21
    v_cndmask_b32 v120, v120, v20, s[20:21]
    v_cndmask_b32 v121, v121, v20, s[22:23]
    v_cndmask_b32 v122, v122, v20, s[62:63]
    v_cndmask_b32 v123, v123, v20, vcc
    v_cmp_gt_i32 s[20:21], 0, v21
    v_cmp_gt_i32 s[22:23], 1, v21
    v_cmp_gt_i32 s[62:63], 2, v21
    v_cmp_gt_i32 vcc, 3, v21
    v_cndmask_b32 v124, v124, v20, s[20:21]
    v_cndmask_b32 v125, v125, v20, s[22:23]
    v_cndmask_b32 v126, v126, v20, s[62:63]
    v_cndmask_b32 v127, v127, v20, vcc
    s_branch L_recurrent_scan__compressed_kv_cla__moe_arch_mod__prompt_kernel_back_152
L_recurrent_scan__compressed_kv_cla__moe_arch_mod__prompt_kernel_rare_153:
    v_mov_b32 v8, v38
    v_mov_b32 v9, v39
    v_mov_b32 v38, 0
    v_mov_b32 v39, 0
    s_branch L_recurrent_scan__compressed_kv_cla__moe_arch_mod__prompt_kernel_back_154
L_recurrent_scan__compressed_kv_cla__moe_arch_mod__prompt_kernel_rare_155:
    v_mov_b32 v20, 4048155338
    v_subrev_u32 v21, s50, v18
    v_cmp_gt_i32 s[20:21], 0, v21
    v_cmp_gt_i32 s[22:23], 1, v21
    v_cmp_gt_i32 s[62:63], 2, v21
    v_cmp_gt_i32 vcc, 3, v21
    v_cndmask_b32 v96, v96, v20, s[20:21]
    v_cndmask_b32 v97, v97, v20, s[22:23]
    v_cndmask_b32 v98, v98, v20, s[62:63]
    v_cndmask_b32 v99, v99, v20, vcc
    v_cmp_gt_i32 s[20:21], 16, v21
    v_cmp_gt_i32 s[22:23], 17, v21
    v_cmp_gt_i32 s[62:63], 18, v21
    v_cmp_gt_i32 vcc, 19, v21
    v_cndmask_b32 v100, v100, v20, s[20:21]
    v_cndmask_b32 v101, v101, v20, s[22:23]
    v_cndmask_b32 v102, v102, v20, s[62:63]
    v_cndmask_b32 v103, v103, v20, vcc
    v_cmp_gt_i32 s[20:21], -16, v21
    v_cmp_gt_i32 s[22:23], -15, v21
    v_cmp_gt_i32 s[62:63], -14, v21
    v_cmp_gt_i32 vcc, -13, v21
    v_cndmask_b32 v104, v104, v20, s[20:21]
    v_cndmask_b32 v105, v105, v20, s[22:23]
    v_cndmask_b32 v106, v106, v20, s[62:63]
    v_cndmask_b32 v107, v107, v20, vcc
    v_cmp_gt_i32 s[20:21], 0, v21
    v_cmp_gt_i32 s[22:23], 1, v21
    v_cmp_gt_i32 s[62:63], 2, v21
    v_cmp_gt_i32 vcc, 3, v21
    v_cndmask_b32 v108, v108, v20, s[20:21]
    v_cndmask_b32 v109, v109, v20, s[22:23]
    v_cndmask_b32 v110, v110, v20, s[62:63]
    v_cndmask_b32 v111, v111, v20, vcc
    s_branch L_recurrent_scan__compressed_kv_cla__moe_arch_mod__prompt_kernel_back_156
L_recurrent_scan__compressed_kv_cla__moe_arch_mod__prompt_kernel_rare_157:
    v_mov_b32 v20, 4048155338
    v_subrev_u32 v21, s49, v18
    v_cmp_gt_i32 s[20:21], 0, v21
    v_cmp_gt_i32 s[22:23], 1, v21
    v_cmp_gt_i32 s[62:63], 2, v21
    v_cmp_gt_i32 vcc, 3, v21
    v_cndmask_b32 v112, v112, v20, s[20:21]
    v_cndmask_b32 v113, v113, v20, s[22:23]
    v_cndmask_b32 v114, v114, v20, s[62:63]
    v_cndmask_b32 v115, v115, v20, vcc
    v_cmp_gt_i32 s[20:21], 16, v21
    v_cmp_gt_i32 s[22:23], 17, v21
    v_cmp_gt_i32 s[62:63], 18, v21
    v_cmp_gt_i32 vcc, 19, v21
    v_cndmask_b32 v116, v116, v20, s[20:21]
    v_cndmask_b32 v117, v117, v20, s[22:23]
    v_cndmask_b32 v118, v118, v20, s[62:63]
    v_cndmask_b32 v119, v119, v20, vcc
    v_cmp_gt_i32 s[20:21], -16, v21
    v_cmp_gt_i32 s[22:23], -15, v21
    v_cmp_gt_i32 s[62:63], -14, v21
    v_cmp_gt_i32 vcc, -13, v21
    v_cndmask_b32 v120, v120, v20, s[20:21]
    v_cndmask_b32 v121, v121, v20, s[22:23]
    v_cndmask_b32 v122, v122, v20, s[62:63]
    v_cndmask_b32 v123, v123, v20, vcc
    v_cmp_gt_i32 s[20:21], 0, v21
    v_cmp_gt_i32 s[22:23], 1, v21
    v_cmp_gt_i32 s[62:63], 2, v21
    v_cmp_gt_i32 vcc, 3, v21
    v_cndmask_b32 v124, v124, v20, s[20:21]
    v_cndmask_b32 v125, v125, v20, s[22:23]
    v_cndmask_b32 v126, v126, v20, s[62:63]
    v_cndmask_b32 v127, v127, v20, vcc
    s_branch L_recurrent_scan__compressed_kv_cla__moe_arch_mod__prompt_kernel_back_158
L_recurrent_scan__compressed_kv_cla__moe_arch_mod__prompt_kernel_rare_159:
    s_cmp_lg_u32 s40, s51
    s_cbranch_scc1 L_recurrent_scan__compressed_kv_cla__moe_arch_mod__prompt_kernel_epi_161
    ds_read_b128 v[40:43], v19
    ds_read_b128 v[44:47], v19 offset:1024
    v_swap_b32 v128, v160
    v_swap_b32 v129, v161
    v_swap_b32 v130, v162
    v_swap_b32 v131, v163
    v_swap_b32 v132, v164
    v_swap_b32 v133, v165
    v_swap_b32 v134, v166
    v_swap_b32 v135, v167
    v_swap_b32 v136, v168
    v_swap_b32 v137, v169
    v_swap_b32 v138, v170
    v_swap_b32 v139, v171
    v_swap_b32 v140, v172
    v_swap_b32 v141, v173
    v_swap_b32 v142, v174
    v_swap_b32 v143, v175
    v_swap_b32 v144, v176
    v_swap_b32 v145, v177
    v_swap_b32 v146, v178
    v_swap_b32 v147, v179
    v_swap_b32 v148, v180
    v_swap_b32 v149, v181
    v_swap_b32 v150, v182
    v_swap_b32 v151, v183
    v_swap_b32 v152, v184
    v_swap_b32 v153, v185
    v_swap_b32 v154, v186
    v_swap_b32 v155, v187
    v_swap_b32 v156, v188
    v_swap_b32 v157, v189
    v_swap_b32 v158, v190
    v_swap_b32 v159, v191
    s_waitcnt lgkmcnt(0)
    s_branch L_recurrent_scan__compressed_kv_cla__moe_arch_mod__prompt_kernel_back_160
L_recurrent_scan__compressed_kv_cla__moe_arch_mod__prompt_kernel_epi_161:
    v_mov_b32 v20, v8
    s_nop 1
    v_permlane16_swap_b32 v8, v20
    s_nop 1
    v_add_f32 v8, v8, v20
    v_mov_b32 v20, v8
    s_nop 1
    v_permlane32_swap_b32 v8, v20
    s_nop 1
    v_add_f32 v8, v8, v20
    v_mov_b32 v20, v9
    s_nop 1
    v_permlane16_swap_b32 v9, v20
    s_nop 1
    v_add_f32 v9, v9, v20
    v_mov_b32 v20, v9
    s_nop 1
    v_permlane32_swap_b32 v9, v20
    s_nop 1
    v_add_f32 v9, v9, v20
    s_mov_b32 s36, 0x5d800000
    v_cmp_nge_f32 vcc, s36, v8
    s_nop 0
    s_or_b64 s[52:53], s[52:53], vcc
    v_cmp_nge_f32 vcc, s36, v9
    s_nop 0
    s_or_b64 s[52:53], s[52:53], vcc
    v_rcp_f32 v8, v8
    v_rcp_f32 v9, v9
    s_lshl_b32 s38, s30, 3
    s_and_b32 s37, s28, 3
    s_lshl_b32 s37, s37, 1
    s_add_u32 s38, s38, s37
    s_lshl_b32 s38, s38, 17
    s_lshl_b32 s37, s29, 12
    s_add_u32 s38, s38, s37
    v_mul_f32 v192, v8, v192
    v_mul_f32 v193, v8, v193
    v_mul_f32 v194, v8, v194
    v_mul_f32 v195, v8, v195
    v_mul_f32 v196, v8, v196
    v_mul_f32 v197, v8, v197
    v_mul_f32 v198, v8, v198
    v_mul_f32 v199, v8, v199
    v_cvt_pk_bf16_f32 v22, v192, v193
    v_cvt_pk_bf16_f32 v23, v194, v195
    v_cvt_pk_bf16_f32 v24, v196, v197
    v_cvt_pk_bf16_f32 v25, v198, v199
    buffer_store_dwordx4 v[22:25], v7, s[16:19], s38 offen offset:0 sc1
    v_mov_b32 v192, 0
    v_mov_b32 v193, 0
    v_mov_b32 v194, 0
    v_mov_b32 v195, 0
    v_mov_b32 v196, 0
    v_mov_b32 v197, 0
    v_mov_b32 v198, 0
    v_mov_b32 v199, 0
    v_mul_f32 v200, v8, v200
    v_mul_f32 v201, v8, v201
    v_mul_f32 v202, v8, v202
    v_mul_f32 v203, v8, v203
    v_mul_f32 v204, v8, v204
    v_mul_f32 v205, v8, v205
    v_mul_f32 v206, v8, v206
    v_mul_f32 v207, v8, v207
    v_cvt_pk_bf16_f32 v26, v200, v201
    v_cvt_pk_bf16_f32 v27, v202, v203
    v_cvt_pk_bf16_f32 v28, v204, v205
    v_cvt_pk_bf16_f32 v29, v206, v207
    buffer_store_dwordx4 v[26:29], v7, s[16:19], s38 offen offset:1024 sc1
    v_mov_b32 v200, 0
    v_mov_b32 v201, 0
    v_mov_b32 v202, 0
    v_mov_b32 v203, 0
    v_mov_b32 v204, 0
    v_mov_b32 v205, 0
    v_mov_b32 v206, 0
    v_mov_b32 v207, 0
    v_mul_f32 v208, v8, v208
    v_mul_f32 v209, v8, v209
    v_mul_f32 v210, v8, v210
    v_mul_f32 v211, v8, v211
    v_mul_f32 v212, v8, v212
    v_mul_f32 v213, v8, v213
    v_mul_f32 v214, v8, v214
    v_mul_f32 v215, v8, v215
    v_cvt_pk_bf16_f32 v30, v208, v209
    v_cvt_pk_bf16_f32 v31, v210, v211
    v_cvt_pk_bf16_f32 v32, v212, v213
    v_cvt_pk_bf16_f32 v33, v214, v215
    buffer_store_dwordx4 v[30:33], v7, s[16:19], s38 offen offset:2048 sc1
    v_mov_b32 v208, 0
    v_mov_b32 v209, 0
    v_mov_b32 v210, 0
    v_mov_b32 v211, 0
    v_mov_b32 v212, 0
    v_mov_b32 v213, 0
    v_mov_b32 v214, 0
    v_mov_b32 v215, 0
    v_mul_f32 v216, v8, v216
    v_mul_f32 v217, v8, v217
    v_mul_f32 v218, v8, v218
    v_mul_f32 v219, v8, v219
    v_mul_f32 v220, v8, v220
    v_mul_f32 v221, v8, v221
    v_mul_f32 v222, v8, v222
    v_mul_f32 v223, v8, v223
    v_cvt_pk_bf16_f32 v34, v216, v217
    v_cvt_pk_bf16_f32 v35, v218, v219
    v_cvt_pk_bf16_f32 v36, v220, v221
    v_cvt_pk_bf16_f32 v37, v222, v223
    buffer_store_dwordx4 v[34:37], v7, s[16:19], s38 offen offset:3072 sc1
    v_mov_b32 v216, 0
    v_mov_b32 v217, 0
    v_mov_b32 v218, 0
    v_mov_b32 v219, 0
    v_mov_b32 v220, 0
    v_mov_b32 v221, 0
    v_mov_b32 v222, 0
    v_mov_b32 v223, 0
    s_add_u32 s38, s38, 131072
    v_mul_f32 v224, v9, v224
    v_mul_f32 v225, v9, v225
    v_mul_f32 v226, v9, v226
    v_mul_f32 v227, v9, v227
    v_mul_f32 v228, v9, v228
    v_mul_f32 v229, v9, v229
    v_mul_f32 v230, v9, v230
    v_mul_f32 v231, v9, v231
    v_cvt_pk_bf16_f32 v22, v224, v225
    v_cvt_pk_bf16_f32 v23, v226, v227
    v_cvt_pk_bf16_f32 v24, v228, v229
    v_cvt_pk_bf16_f32 v25, v230, v231
    buffer_store_dwordx4 v[22:25], v7, s[16:19], s38 offen offset:0 sc1
    v_mov_b32 v224, 0
    v_mov_b32 v225, 0
    v_mov_b32 v226, 0
    v_mov_b32 v227, 0
    v_mov_b32 v228, 0
    v_mov_b32 v229, 0
    v_mov_b32 v230, 0
    v_mov_b32 v231, 0
    v_mul_f32 v232, v9, v232
    v_mul_f32 v233, v9, v233
    v_mul_f32 v234, v9, v234
    v_mul_f32 v235, v9, v235
    v_mul_f32 v236, v9, v236
    v_mul_f32 v237, v9, v237
    v_mul_f32 v238, v9, v238
    v_mul_f32 v239, v9, v239
    v_cvt_pk_bf16_f32 v26, v232, v233
    v_cvt_pk_bf16_f32 v27, v234, v235
    v_cvt_pk_bf16_f32 v28, v236, v237
    v_cvt_pk_bf16_f32 v29, v238, v239
    buffer_store_dwordx4 v[26:29], v7, s[16:19], s38 offen offset:1024 sc1
    v_mov_b32 v232, 0
    v_mov_b32 v233, 0
    v_mov_b32 v234, 0
    v_mov_b32 v235, 0
    v_mov_b32 v236, 0
    v_mov_b32 v237, 0
    v_mov_b32 v238, 0
    v_mov_b32 v239, 0
    v_mul_f32 v240, v9, v240
    v_mul_f32 v241, v9, v241
    v_mul_f32 v242, v9, v242
    v_mul_f32 v243, v9, v243
    v_mul_f32 v244, v9, v244
    v_mul_f32 v245, v9, v245
    v_mul_f32 v246, v9, v246
    v_mul_f32 v247, v9, v247
    v_cvt_pk_bf16_f32 v30, v240, v241
    v_cvt_pk_bf16_f32 v31, v242, v243
    v_cvt_pk_bf16_f32 v32, v244, v245
    v_cvt_pk_bf16_f32 v33, v246, v247
    buffer_store_dwordx4 v[30:33], v7, s[16:19], s38 offen offset:2048 sc1
    v_mov_b32 v240, 0
    v_mov_b32 v241, 0
    v_mov_b32 v242, 0
    v_mov_b32 v243, 0
    v_mov_b32 v244, 0
    v_mov_b32 v245, 0
    v_mov_b32 v246, 0
    v_mov_b32 v247, 0
    v_mul_f32 v248, v9, v248
    v_mul_f32 v249, v9, v249
    v_mul_f32 v250, v9, v250
    v_mul_f32 v251, v9, v251
    v_mul_f32 v252, v9, v252
    v_mul_f32 v253, v9, v253
    v_mul_f32 v254, v9, v254
    v_mul_f32 v255, v9, v255
    v_cvt_pk_bf16_f32 v34, v248, v249
    v_cvt_pk_bf16_f32 v35, v250, v251
    v_cvt_pk_bf16_f32 v36, v252, v253
    v_cvt_pk_bf16_f32 v37, v254, v255
    buffer_store_dwordx4 v[34:37], v7, s[16:19], s38 offen offset:3072 sc1
    v_mov_b32 v248, 0
    v_mov_b32 v249, 0
    v_mov_b32 v250, 0
    v_mov_b32 v251, 0
    v_mov_b32 v252, 0
    v_mov_b32 v253, 0
    v_mov_b32 v254, 0
    v_mov_b32 v255, 0
    s_branch L_recurrent_scan__compressed_kv_cla__moe_arch_mod__prompt_kernel_back_160
L_recurrent_scan__compressed_kv_cla__moe_arch_mod__prompt_kernel_rare_165:
    v_mov_b32 v20, 4048155338
    v_subrev_u32 v21, s50, v18
    v_cmp_gt_i32 s[20:21], 0, v21
    v_cmp_gt_i32 s[22:23], 1, v21
    v_cmp_gt_i32 s[62:63], 2, v21
    v_cmp_gt_i32 vcc, 3, v21
    v_cndmask_b32 v96, v96, v20, s[20:21]
    v_cndmask_b32 v97, v97, v20, s[22:23]
    v_cndmask_b32 v98, v98, v20, s[62:63]
    v_cndmask_b32 v99, v99, v20, vcc
    v_cmp_gt_i32 s[20:21], 16, v21
    v_cmp_gt_i32 s[22:23], 17, v21
    v_cmp_gt_i32 s[62:63], 18, v21
    v_cmp_gt_i32 vcc, 19, v21
    v_cndmask_b32 v100, v100, v20, s[20:21]
    v_cndmask_b32 v101, v101, v20, s[22:23]
    v_cndmask_b32 v102, v102, v20, s[62:63]
    v_cndmask_b32 v103, v103, v20, vcc
    v_cmp_gt_i32 s[20:21], -16, v21
    v_cmp_gt_i32 s[22:23], -15, v21
    v_cmp_gt_i32 s[62:63], -14, v21
    v_cmp_gt_i32 vcc, -13, v21
    v_cndmask_b32 v104, v104, v20, s[20:21]
    v_cndmask_b32 v105, v105, v20, s[22:23]
    v_cndmask_b32 v106, v106, v20, s[62:63]
    v_cndmask_b32 v107, v107, v20, vcc
    v_cmp_gt_i32 s[20:21], 0, v21
    v_cmp_gt_i32 s[22:23], 1, v21
    v_cmp_gt_i32 s[62:63], 2, v21
    v_cmp_gt_i32 vcc, 3, v21
    v_cndmask_b32 v108, v108, v20, s[20:21]
    v_cndmask_b32 v109, v109, v20, s[22:23]
    v_cndmask_b32 v110, v110, v20, s[62:63]
    v_cndmask_b32 v111, v111, v20, vcc
    s_branch L_recurrent_scan__compressed_kv_cla__moe_arch_mod__prompt_kernel_back_166
L_p3_done:
    s_waitcnt vmcnt(4)
    s_sub_u32 s40, 47, s30
    s_lshl_b32 s40, s40, 7
    s_add_u32 s41, s30, 32
    s_lshl_b32 s41, s41, 7
    v_mov_b32 v30, v11
    v_mov_b32 v31, v12
    s_and_b32 s36, s2, 3
    s_lshl_b32 s36, s36, 2
    s_bfe_u32 s37, s2, 0x20003
    s_add_u32 s29, s36, s37
    s_bfe_u32 s36, s2, 0x10002
    s_lshl_b32 s36, s36, 3
    s_lshr_b32 s37, s2, 5
    s_add_u32 s30, s36, s37
    s_and_b32 s36, s28, 3
    s_lshl_b32 s37, s29, 2
    s_add_u32 s36, s36, s37
    s_lshl_b32 s36, s36, 18
    s_lshr_b32 s37, s28, 2
    s_lshl_b32 s37, s37, 12
    s_add_u32 s36, s36, s37
    v_lshl_add_u32 v2, v1, 4, s36
    v_add_u32 v3, 131072, v2
    v_lshrrev_b32 v18, 3, v1
    s_lshl_b32 s36, s28, 5
    v_add_u32 v18, s36, v18
    v_lshlrev_b32 v18, 11, v18
    s_lshl_b32 s36, s30, 7
    v_add_u32 v18, s36, v18
    v_lshrrev_b32 v19, 4, v1
    v_lshlrev_b32 v20, 1, v19
    v_and_b32 v21, 7, v1
    v_xor_b32 v20, v20, v21
    v_lshl_add_u32 v6, v20, 4, v18
    v_add_u32 v7, 15360, v6
    v_add_u32 v8, 30720, v6
    v_add_u32 v9, 46080, v6
    s_lshl_b32 s33, s28, 12
    s_mov_b32 s31, 0
    s_mov_b32 s32, 0
    v_readfirstlane_b32 s36, v30
    s_nop 0
    s_cmp_lt_u32 s36, 28
    s_cbranch_scc1 L_recurrent_scan__compressed_kv_cla__moe_arch_mod__prompt_kernel_rare_174
L_recurrent_scan__compressed_kv_cla__moe_arch_mod__prompt_kernel_back_175:
    s_lshr_b32 s36, s2, 4
    s_mul_i32 s36, s36, 224
    s_min_u32 s37, s28, 6
    s_lshl_b32 s37, s37, 5
    s_add_u32 s36, s36, s37
    s_lshl_b32 s36, s36, 2
    s_add_u32 s36, s36, 58720256
    v_and_b32 v26, 15, v1
    v_mul_u32_u24 v26, 14336, v26
    v_lshl_add_u32 v26, v19, 5, v26
    buffer_load_dwordx4 v[96:99], v26, s[24:27], s36 offen offset:0 sc1
    buffer_load_dwordx4 v[100:103], v26, s[24:27], s36 offen offset:16 sc1
    s_add_u32 s4, s54, 41943040
    s_addc_u32 s5, s55, 0
    s_and_b32 s5, s5, 0xffff
    s_mov_b32 s6, 16777216
    s_mov_b32 s7, 0x20000
    s_mov_b32 s16, s96
    s_and_b32 s17, s97, 0xffff
    s_mov_b32 s18, 4194304
    s_mov_b32 s19, 0x20000
    s_mov_b32 s20, s98
    s_and_b32 s21, s99, 0xffff
    s_mov_b32 s22, 4194304
    s_mov_b32 s23, 0x20000
    s_lshl_b32 s36, s29, 7
    s_and_b32 s37, s28, 3
    s_lshl_b32 s37, s37, 5
    s_add_u32 s36, s36, s37
    s_lshr_b32 s37, s28, 2
    s_lshl_b32 s37, s37, 4
    s_add_u32 s38, s36, s37
    v_and_b32 v14, 15, v1
    v_add_u32 v14, s38, v14
    v_lshlrev_b32 v15, 11, v14
    v_lshl_add_u32 v15, v19, 3, v15
    s_lshl_b32 s36, s30, 7
    v_add_u32 v15, s36, v15
    v_lshlrev_b32 v16, 3, v14
    v_bfe_u32 v20, v1, 2, 2
    v_lshl_add_u32 v18, v19, 2, v20
    v_bfe_u32 v20, v18, 1, 2
    v_lshlrev_b32 v18, 7, v18
    s_lshr_b32 s36, s28, 2
    s_lshl_b32 s36, s36, 14
    v_add_u32 v18, s36, v18
    v_and_b32 v21, 3, v1
    v_lshl_add_u32 v18, v21, 3, v18
    v_xor_b32 v21, 0, v20
    v_lshl_add_u32 v10, v21, 5, v18
    v_xor_b32 v21, 1, v20
    v_lshl_add_u32 v11, v21, 5, v18
    v_xor_b32 v21, 2, v20
    v_lshl_add_u32 v12, v21, 5, v18
    v_xor_b32 v21, 3, v20
    v_lshl_add_u32 v13, v21, 5, v18
    v_mov_b32 v224, 0
    v_mov_b32 v225, 0
    v_mov_b32 v226, 0
    v_mov_b32 v227, 0
    v_mov_b32 v228, 0
    v_mov_b32 v229, 0
    v_mov_b32 v230, 0
    v_mov_b32 v231, 0
    v_mov_b32 v232, 0
    v_mov_b32 v233, 0
    v_mov_b32 v234, 0
    v_mov_b32 v235, 0
    v_mov_b32 v236, 0
    v_mov_b32 v237, 0
    v_mov_b32 v238, 0
    v_mov_b32 v239, 0
    v_mov_b32 v240, 0
    v_mov_b32 v241, 0
    v_mov_b32 v242, 0
    v_mov_b32 v243, 0
    v_mov_b32 v244, 0
    v_mov_b32 v245, 0
    v_mov_b32 v246, 0
    v_mov_b32 v247, 0
    v_mov_b32 v248, 0
    v_mov_b32 v249, 0
    v_mov_b32 v250, 0
    v_mov_b32 v251, 0
    v_mov_b32 v252, 0
    v_mov_b32 v253, 0
    v_mov_b32 v254, 0
    v_mov_b32 v255, 0
    v_add_u32 v10, 65536, v10
    v_add_u32 v11, 65536, v11
    v_add_u32 v12, 65536, v12
    v_add_u32 v13, 65536, v13
    s_waitcnt vmcnt(2)
    s_barrier
    s_cmp_eq_u32 s28, 0
    s_cbranch_scc1 L_recurrent_scan__compressed_kv_cla__moe_arch_mod__prompt_kernel_rare_167
L_recurrent_scan__compressed_kv_cla__moe_arch_mod__prompt_kernel_back_168:
    s_add_u32 s33, s33, 65536
    s_mov_b32 s34, s33
    s_add_u32 m0, s34, 0
    s_nop 0
    buffer_load_dwordx4 v6, s[8:11], s32 offen offset:0 lds
    buffer_load_dwordx4 v7, s[8:11], s32 offen offset:1024 lds
    buffer_load_dwordx4 v8, s[8:11], s32 offen offset:2048 lds
    buffer_load_dwordx4 v9, s[8:11], s32 offen offset:3072 lds
    s_add_u32 s32, s32, 524288
    s_add_u32 m0, s34, 32768
    s_nop 0
    buffer_load_dwordx4 v6, s[8:11], s32 offen offset:0 lds
    buffer_load_dwordx4 v7, s[8:11], s32 offen offset:1024 lds
    buffer_load_dwordx4 v8, s[8:11], s32 offen offset:2048 lds
    buffer_load_dwordx4 v9, s[8:11], s32 offen offset:3072 lds
    s_add_u32 s32, s32, 524288
    buffer_load_dwordx2 v[40:41], v15, s[16:19], 0 offen offset:0
    buffer_load_dwordx2 v[42:43], v15, s[16:19], 0 offen offset:32
    buffer_load_dwordx2 v[44:45], v15, s[16:19], 0 offen offset:64
    buffer_load_dwordx2 v[46:47], v15, s[16:19], 0 offen offset:96
    s_mov_b32 s36, 4194304
    buffer_load_dwordx2 v[48:49], v16, s[24:27], s36 offen sc1
    s_cmp_eq_u32 s28, 7
    s_cbranch_scc1 L_recurrent_scan__compressed_kv_cla__moe_arch_mod__prompt_kernel_w7_176
    s_waitcnt vmcnt(13)
    v_lshrrev_b32 v28, 4, v1
    v_bfe_u32 v26, v1, 2, 2
    v_lshl_add_u32 v26, v28, 3, v26
    v_lshlrev_b32 v26, 7, v26
    v_and_b32 v27, 3, v1
    v_lshl_add_u32 v26, v27, 3, v26
    v_bfe_u32 v27, v1, 3, 2
    s_lshl_b32 s36, s28, 12
    s_add_u32 s36, s36, 131072
    v_add_u32 v26, s36, v26
    v_xor_b32 v28, 0, v27
    v_lshl_add_u32 v28, v28, 5, v26
    ds_read_b64_tr_b16 v[64:65], v28 offset:0
    ds_read_b64_tr_b16 v[66:67], v28 offset:512
    v_xor_b32 v28, 1, v27
    v_lshl_add_u32 v28, v28, 5, v26
    ds_read_b64_tr_b16 v[68:69], v28 offset:0
    ds_read_b64_tr_b16 v[70:71], v28 offset:512
    v_xor_b32 v28, 2, v27
    v_lshl_add_u32 v28, v28, 5, v26
    ds_read_b64_tr_b16 v[72:73], v28 offset:0
    ds_read_b64_tr_b16 v[74:75], v28 offset:512
    v_xor_b32 v28, 3, v27
    v_lshl_add_u32 v28, v28, 5, v26
    ds_read_b64_tr_b16 v[76:77], v28 offset:0
    ds_read_b64_tr_b16 v[78:79], v28 offset:512
    v_add_f32_dpp v96, v96, v96 row_ror:4 row_mask:0xf bank_mask:0xf
    v_add_f32_dpp v97, v97, v97 row_ror:4 row_mask:0xf bank_mask:0xf
    v_add_f32_dpp v98, v98, v98 row_ror:4 row_mask:0xf bank_mask:0xf
    v_add_f32_dpp v99, v99, v99 row_ror:4 row_mask:0xf bank_mask:0xf
    v_add_f32_dpp v100, v100, v100 row_ror:4 row_mask:0xf bank_mask:0xf
    v_add_f32_dpp v101, v101, v101 row_ror:4 row_mask:0xf bank_mask:0xf
    v_add_f32_dpp v102, v102, v102 row_ror:4 row_mask:0xf bank_mask:0xf
    v_add_f32_dpp v103, v103, v103 row_ror:4 row_mask:0xf bank_mask:0xf
    v_add_f32_dpp v96, v96, v96 row_ror:8 row_mask:0xf bank_mask:0xf
    v_add_f32_dpp v97, v97, v97 row_ror:8 row_mask:0xf bank_mask:0xf
    v_add_f32_dpp v98, v98, v98 row_ror:8 row_mask:0xf bank_mask:0xf
    v_add_f32_dpp v99, v99, v99 row_ror:8 row_mask:0xf bank_mask:0xf
    v_add_f32_dpp v100, v100, v100 row_ror:8 row_mask:0xf bank_mask:0xf
    v_add_f32_dpp v101, v101, v101 row_ror:8 row_mask:0xf bank_mask:0xf
    v_add_f32_dpp v102, v102, v102 row_ror:8 row_mask:0xf bank_mask:0xf
    v_add_f32_dpp v103, v103, v103 row_ror:8 row_mask:0xf bank_mask:0xf
    v_cvt_pk_bf16_f32 v29, v96, v97
    v_lshlrev_b32 v96, 16, v29
    v_and_b32 v97, 0xffff0000, v29
    v_cvt_pk_bf16_f32 v29, v98, v99
    v_lshlrev_b32 v98, 16, v29
    v_and_b32 v99, 0xffff0000, v29
    v_cvt_pk_bf16_f32 v29, v100, v101
    v_lshlrev_b32 v100, 16, v29
    v_and_b32 v101, 0xffff0000, v29
    v_cvt_pk_bf16_f32 v29, v102, v103
    v_lshlrev_b32 v102, 16, v29
    v_and_b32 v103, 0xffff0000, v29
    v_mul_f32 v104, 0xbfb8aa3b, v96
    v_mul_f32 v105, 0xbfb8aa3b, v97
    v_mul_f32 v106, 0xbfb8aa3b, v98
    v_mul_f32 v107, 0xbfb8aa3b, v99
    v_mul_f32 v108, 0xbfb8aa3b, v100
    v_mul_f32 v109, 0xbfb8aa3b, v101
    v_mul_f32 v110, 0xbfb8aa3b, v102
    v_mul_f32 v111, 0xbfb8aa3b, v103
    v_exp_f32 v104, v104
    v_exp_f32 v105, v105
    v_exp_f32 v106, v106
    v_exp_f32 v107, v107
    v_exp_f32 v108, v108
    v_exp_f32 v109, v109
    v_exp_f32 v110, v110
    v_exp_f32 v111, v111
    v_add_f32 v104, 1.0, v104
    v_add_f32 v105, 1.0, v105
    v_add_f32 v106, 1.0, v106
    v_add_f32 v107, 1.0, v107
    v_add_f32 v108, 1.0, v108
    v_add_f32 v109, 1.0, v109
    v_add_f32 v110, 1.0, v110
    v_add_f32 v111, 1.0, v111
    v_rcp_f32 v104, v104
    v_rcp_f32 v105, v105
    v_rcp_f32 v106, v106
    v_rcp_f32 v107, v107
    v_rcp_f32 v108, v108
    v_rcp_f32 v109, v109
    v_rcp_f32 v110, v110
    v_rcp_f32 v111, v111
    v_mul_f32 v104, v96, v104
    v_mul_f32 v105, v97, v105
    v_mul_f32 v106, v98, v106
    v_mul_f32 v107, v99, v107
    v_mul_f32 v108, v100, v108
    v_mul_f32 v109, v101, v109
    v_mul_f32 v110, v102, v110
    v_mul_f32 v111, v103, v111
    v_cvt_pk_bf16_f32 v29, v104, v105
    v_lshlrev_b32 v104, 16, v29
    v_and_b32 v105, 0xffff0000, v29
    v_cvt_pk_bf16_f32 v29, v106, v107
    v_lshlrev_b32 v106, 16, v29
    v_and_b32 v107, 0xffff0000, v29
    v_cvt_pk_bf16_f32 v29, v108, v109
    v_lshlrev_b32 v108, 16, v29
    v_and_b32 v109, 0xffff0000, v29
    v_cvt_pk_bf16_f32 v29, v110, v111
    v_lshlrev_b32 v110, 16, v29
    v_and_b32 v111, 0xffff0000, v29
    v_mul_f32_dpp v96, v96, v104 quad_perm:[2,3,0,1] row_mask:0xf bank_mask:0xf
    v_mul_f32_dpp v97, v97, v105 quad_perm:[2,3,0,1] row_mask:0xf bank_mask:0xf
    v_mul_f32_dpp v98, v98, v106 quad_perm:[2,3,0,1] row_mask:0xf bank_mask:0xf
    v_mul_f32_dpp v99, v99, v107 quad_perm:[2,3,0,1] row_mask:0xf bank_mask:0xf
    v_mul_f32_dpp v100, v100, v108 quad_perm:[2,3,0,1] row_mask:0xf bank_mask:0xf
    v_mul_f32_dpp v101, v101, v109 quad_perm:[2,3,0,1] row_mask:0xf bank_mask:0xf
    v_mul_f32_dpp v102, v102, v110 quad_perm:[2,3,0,1] row_mask:0xf bank_mask:0xf
    v_mul_f32_dpp v103, v103, v111 quad_perm:[2,3,0,1] row_mask:0xf bank_mask:0xf
    v_cvt_pk_bf16_f32 v124, v96, v97
    v_cvt_pk_bf16_f32 v125, v98, v99
    v_cvt_pk_bf16_f32 v126, v100, v101
    v_cvt_pk_bf16_f32 v127, v102, v103
    s_waitcnt lgkmcnt(0)
    v_lshl_add_u32 v28, v1, 4, s36
    v_mfma_f32_16x16x32_bf16 v[80:83], v[64:67], v[124:127], 0
    v_mfma_f32_16x16x32_bf16 v[84:87], v[68:71], v[124:127], 0
    v_mfma_f32_16x16x32_bf16 v[88:91], v[72:75], v[124:127], 0
    v_mfma_f32_16x16x32_bf16 v[92:95], v[76:79], v[124:127], 0
    s_nop 7
    ds_write_b128 v28, v[80:83] offset:0
    ds_write_b128 v28, v[84:87] offset:1024
    ds_write_b128 v28, v[88:91] offset:2048
    ds_write_b128 v28, v[92:95] offset:3072
    s_branch L_recurrent_scan__compressed_kv_cla__moe_arch_mod__prompt_kernel_w7j_177
L_recurrent_scan__compressed_kv_cla__moe_arch_mod__prompt_kernel_w7_176:
    s_add_u32 s36, s29, 32
    s_lshl_b32 s36, s36, 7
    v_mov_b32 v30, s36
    s_mov_b32 s61, 0x40000
L_recurrent_scan__compressed_kv_cla__moe_arch_mod__prompt_kernel_spin_178:
    s_sub_u32 s61, s61, 1
    s_cbranch_scc1 L_recurrent_scan__compressed_kv_cla__moe_arch_mod__prompt_kernel_spinx_179
    s_sleep 8
    global_load_dword v31, v30, s[90:91] sc1
    s_waitcnt vmcnt(0)
    v_readfirstlane_b32 s36, v31
    s_nop 0
    s_cmp_lt_u32 s36, 32
    s_cbranch_scc1 L_recurrent_scan__compressed_kv_cla__moe_arch_mod__prompt_kernel_spin_178
L_recurrent_scan__compressed_kv_cla__moe_arch_mod__prompt_kernel_spinx_179:
L_recurrent_scan__compressed_kv_cla__moe_arch_mod__prompt_kernel_w7j_177:
    s_waitcnt vmcnt(9)
    s_waitcnt lgkmcnt(0)
    s_barrier
    buffer_load_dwordx4 v[128:131], v2, s[4:7], s31 offen offset:0 sc1
    buffer_load_dwordx4 v[132:135], v3, s[4:7], s31 offen offset:0 sc1
    buffer_load_dwordx4 v[136:139], v2, s[4:7], s31 offen offset:1024 sc1
    buffer_load_dwordx4 v[140:143], v3, s[4:7], s31 offen offset:1024 sc1
    buffer_load_dwordx4 v[144:147], v2, s[4:7], s31 offen offset:2048 sc1
    buffer_load_dwordx4 v[148:151], v3, s[4:7], s31 offen offset:2048 sc1
    buffer_load_dwordx4 v[152:155], v2, s[4:7], s31 offen offset:3072 sc1
    buffer_load_dwordx4 v[156:159], v3, s[4:7], s31 offen offset:3072 sc1
    s_add_u32 s31, s31, 8192
    buffer_load_dwordx4 v[160:163], v2, s[4:7], s31 offen offset:0 sc1
    buffer_load_dwordx4 v[164:167], v3, s[4:7], s31 offen offset:0 sc1
    buffer_load_dwordx4 v[168:171], v2, s[4:7], s31 offen offset:1024 sc1
    buffer_load_dwordx4 v[172:175], v3, s[4:7], s31 offen offset:1024 sc1
    buffer_load_dwordx4 v[176:179], v2, s[4:7], s31 offen offset:2048 sc1
    buffer_load_dwordx4 v[180:183], v3, s[4:7], s31 offen offset:2048 sc1
    s_cmp_lt_u32 s28, 4
    s_cbranch_scc0 L_recurrent_scan__compressed_kv_cla__moe_arch_mod__prompt_kernel_g_169
    s_lshl_b32 s36, s28, 10
    s_add_u32 s36, s36, 131072
    v_lshl_add_u32 v28, v1, 4, s36
    ds_read_b128 v[96:99], v28 offset:0
    ds_read_b128 v[100:103], v28 offset:4096
    ds_read_b128 v[104:107], v28 offset:8192
    ds_read_b128 v[108:111], v28 offset:12288
    ds_read_b128 v[112:115], v28 offset:16384
    ds_read_b128 v[116:119], v28 offset:20480
    ds_read_b128 v[120:123], v28 offset:24576
    s_lshr_b32 s36, s2, 4
    s_lshl_b32 s36, s36, 13
    s_and_b32 s37, s2, 15
    s_lshl_b32 s37, s37, 8
    s_add_u32 s36, s36, s37
    s_lshl_b32 s37, s28, 6
    s_add_u32 s36, s36, s37
    s_add_u32 s36, s36, 59768832
    v_and_b32 v28, 1, v1
    v_lshlrev_b32 v28, 12, v28
    v_lshl_add_u32 v28, v19, 4, v28
    s_waitcnt lgkmcnt(0)
    v_add_f32 v96, v96, v100
    v_add_f32 v97, v97, v101
    v_add_f32 v98, v98, v102
    v_add_f32 v99, v99, v103
    v_add_f32 v96, v96, v104
    v_add_f32 v97, v97, v105
    v_add_f32 v98, v98, v106
    v_add_f32 v99, v99, v107
    v_add_f32 v96, v96, v108
    v_add_f32 v97, v97, v109
    v_add_f32 v98, v98, v110
    v_add_f32 v99, v99, v111
    v_add_f32 v96, v96, v112
    v_add_f32 v97, v97, v113
    v_add_f32 v98, v98, v114
    v_add_f32 v99, v99, v115
    v_add_f32 v96, v96, v116
    v_add_f32 v97, v97, v117
    v_add_f32 v98, v98, v118
    v_add_f32 v99, v99, v119
    v_add_f32 v80, v96, v120
    v_add_f32 v81, v97, v121
    v_add_f32 v82, v98, v122
    v_add_f32 v83, v99, v123
    s_mov_b32 exec_lo, 0x00030003
    s_mov_b32 exec_hi, 0x00030003
    buffer_store_dwordx4 v[80:83], v28, s[24:27], s36 offen sc1
    s_mov_b64 exec, -1
L_recurrent_scan__compressed_kv_cla__moe_arch_mod__prompt_kernel_g_169:
    s_waitcnt vmcnt(14)
    v_lshlrev_b32 v192, 16, v40
    v_and_b32 v193, 0xffff0000, v40
    v_sub_f32 v208, v192, v48
    v_sub_f32 v209, v193, v48
    v_cvt_pk_bf16_f32 v23, v208, v209
    v_lshlrev_b32 v208, 16, v23
    v_and_b32 v209, 0xffff0000, v23
    v_mul_f32 v208, v208, v49
    v_mul_f32 v209, v209, v49
    v_cvt_pk_bf16_f32 v23, v208, v209
    v_lshlrev_b32 v208, 16, v23
    v_and_b32 v209, 0xffff0000, v23
    v_mul_f32 v24, 0xbfb8aa3b, v208
    v_mul_f32 v25, 0xbfb8aa3b, v209
    v_exp_f32 v24, v24
    v_exp_f32 v25, v25
    s_nop 0
    v_add_f32 v24, 1.0, v24
    v_add_f32 v25, 1.0, v25
    v_rcp_f32 v24, v24
    v_rcp_f32 v25, v25
    s_nop 0
    v_mul_f32 v208, v208, v24
    v_mul_f32 v209, v209, v25
    v_cvt_pk_bf16_f32 v23, v208, v209
    v_lshlrev_b32 v208, 16, v23
    v_and_b32 v209, 0xffff0000, v23
    v_lshlrev_b32 v194, 16, v41
    v_and_b32 v195, 0xffff0000, v41
    v_sub_f32 v210, v194, v48
    v_sub_f32 v211, v195, v48
    v_cvt_pk_bf16_f32 v23, v210, v211
    v_lshlrev_b32 v210, 16, v23
    v_and_b32 v211, 0xffff0000, v23
    v_mul_f32 v210, v210, v49
    v_mul_f32 v211, v211, v49
    v_cvt_pk_bf16_f32 v23, v210, v211
    v_lshlrev_b32 v210, 16, v23
    v_and_b32 v211, 0xffff0000, v23
    v_mul_f32 v24, 0xbfb8aa3b, v210
    v_mul_f32 v25, 0xbfb8aa3b, v211
    v_exp_f32 v24, v24
    v_exp_f32 v25, v25
    s_nop 0
    v_add_f32 v24, 1.0, v24
    v_add_f32 v25, 1.0, v25
    v_rcp_f32 v24, v24
    v_rcp_f32 v25, v25
    s_nop 0
    v_mul_f32 v210, v210, v24
    v_mul_f32 v211, v211, v25
    v_cvt_pk_bf16_f32 v23, v210, v211
    v_lshlrev_b32 v210, 16, v23
    v_and_b32 v211, 0xffff0000, v23
    v_lshlrev_b32 v196, 16, v42
    v_and_b32 v197, 0xffff0000, v42
    v_sub_f32 v212, v196, v48
    v_sub_f32 v213, v197, v48
    v_cvt_pk_bf16_f32 v23, v212, v213
    v_lshlrev_b32 v212, 16, v23
    v_and_b32 v213, 0xffff0000, v23
    v_mul_f32 v212, v212, v49
    v_mul_f32 v213, v213, v49
    v_cvt_pk_bf16_f32 v23, v212, v213
    v_lshlrev_b32 v212, 16, v23
    v_and_b32 v213, 0xffff0000, v23
    v_mul_f32 v24, 0xbfb8aa3b, v212
    v_mul_f32 v25, 0xbfb8aa3b, v213
    v_exp_f32 v24, v24
    v_exp_f32 v25, v25
    s_nop 0
    v_add_f32 v24, 1.0, v24
    v_add_f32 v25, 1.0, v25
    v_rcp_f32 v24, v24
    v_rcp_f32 v25, v25
    s_nop 0
    v_mul_f32 v212, v212, v24
    v_mul_f32 v213, v213, v25
    v_cvt_pk_bf16_f32 v23, v212, v213
    v_lshlrev_b32 v212, 16, v23
    v_and_b32 v213, 0xffff0000, v23
    v_lshlrev_b32 v198, 16, v43
    v_and_b32 v199, 0xffff0000, v43
    v_sub_f32 v214, v198, v48
    v_sub_f32 v215, v199, v48
    v_cvt_pk_bf16_f32 v23, v214, v215
    v_lshlrev_b32 v214, 16, v23
    v_and_b32 v215, 0xffff0000, v23
    v_mul_f32 v214, v214, v49
    v_mul_f32 v215, v215, v49
    v_cvt_pk_bf16_f32 v23, v214, v215
    v_lshlrev_b32 v214, 16, v23
    v_and_b32 v215, 0xffff0000, v23
    v_mul_f32 v24, 0xbfb8aa3b, v214
    v_mul_f32 v25, 0xbfb8aa3b, v215
    v_exp_f32 v24, v24
    v_exp_f32 v25, v25
    s_nop 0
    v_add_f32 v24, 1.0, v24
    v_add_f32 v25, 1.0, v25
    v_rcp_f32 v24, v24
    v_rcp_f32 v25, v25
    s_nop 0
    v_mul_f32 v214, v214, v24
    v_mul_f32 v215, v215, v25
    v_cvt_pk_bf16_f32 v23, v214, v215
    v_lshlrev_b32 v214, 16, v23
    v_and_b32 v215, 0xffff0000, v23
    v_lshlrev_b32 v200, 16, v44
    v_and_b32 v201, 0xffff0000, v44
    v_sub_f32 v216, v200, v48
    v_sub_f32 v217, v201, v48
    v_cvt_pk_bf16_f32 v23, v216, v217
    v_lshlrev_b32 v216, 16, v23
    v_and_b32 v217, 0xffff0000, v23
    v_mul_f32 v216, v216, v49
    v_mul_f32 v217, v217, v49
    v_cvt_pk_bf16_f32 v23, v216, v217
    v_lshlrev_b32 v216, 16, v23
    v_and_b32 v217, 0xffff0000, v23
    v_mul_f32 v24, 0xbfb8aa3b, v216
    v_mul_f32 v25, 0xbfb8aa3b, v217
    v_exp_f32 v24, v24
    v_exp_f32 v25, v25
    s_nop 0
    v_add_f32 v24, 1.0, v24
    v_add_f32 v25, 1.0, v25
    v_rcp_f32 v24, v24
    v_rcp_f32 v25, v25
    s_nop 0
    v_mul_f32 v216, v216, v24
    v_mul_f32 v217, v217, v25
    v_cvt_pk_bf16_f32 v23, v216, v217
    v_lshlrev_b32 v216, 16, v23
    v_and_b32 v217, 0xffff0000, v23
    v_lshlrev_b32 v202, 16, v45
    v_and_b32 v203, 0xffff0000, v45
    v_sub_f32 v218, v202, v48
    v_sub_f32 v219, v203, v48
    v_cvt_pk_bf16_f32 v23, v218, v219
    v_lshlrev_b32 v218, 16, v23
    v_and_b32 v219, 0xffff0000, v23
    v_mul_f32 v218, v218, v49
    v_mul_f32 v219, v219, v49
    v_cvt_pk_bf16_f32 v23, v218, v219
    v_lshlrev_b32 v218, 16, v23
    v_and_b32 v219, 0xffff0000, v23
    v_mul_f32 v24, 0xbfb8aa3b, v218
    v_mul_f32 v25, 0xbfb8aa3b, v219
    v_exp_f32 v24, v24
    v_exp_f32 v25, v25
    s_nop 0
    v_add_f32 v24, 1.0, v24
    v_add_f32 v25, 1.0, v25
    v_rcp_f32 v24, v24
    v_rcp_f32 v25, v25
    s_nop 0
    v_mul_f32 v218, v218, v24
    v_mul_f32 v219, v219, v25
    v_cvt_pk_bf16_f32 v23, v218, v219
    v_lshlrev_b32 v218, 16, v23
    v_and_b32 v219, 0xffff0000, v23
    v_lshlrev_b32 v204, 16, v46
    v_and_b32 v205, 0xffff0000, v46
    v_sub_f32 v220, v204, v48
    v_sub_f32 v221, v205, v48
    v_cvt_pk_bf16_f32 v23, v220, v221
    v_lshlrev_b32 v220, 16, v23
    v_and_b32 v221, 0xffff0000, v23
    v_mul_f32 v220, v220, v49
    v_mul_f32 v221, v221, v49
    v_cvt_pk_bf16_f32 v23, v220, v221
    v_lshlrev_b32 v220, 16, v23
    v_and_b32 v221, 0xffff0000, v23
    v_mul_f32 v24, 0xbfb8aa3b, v220
    v_mul_f32 v25, 0xbfb8aa3b, v221
    v_exp_f32 v24, v24
    v_exp_f32 v25, v25
    s_nop 0
    v_add_f32 v24, 1.0, v24
    v_add_f32 v25, 1.0, v25
    v_rcp_f32 v24, v24
    v_rcp_f32 v25, v25
    s_nop 0
    v_mul_f32 v220, v220, v24
    v_mul_f32 v221, v221, v25
    v_cvt_pk_bf16_f32 v23, v220, v221
    v_lshlrev_b32 v220, 16, v23
    v_and_b32 v221, 0xffff0000, v23
    v_lshlrev_b32 v206, 16, v47
    v_and_b32 v207, 0xffff0000, v47
    v_sub_f32 v222, v206, v48
    v_sub_f32 v223, v207, v48
    v_cvt_pk_bf16_f32 v23, v222, v223
    v_lshlrev_b32 v222, 16, v23
    v_and_b32 v223, 0xffff0000, v23
    v_mul_f32 v222, v222, v49
    v_mul_f32 v223, v223, v49
    v_cvt_pk_bf16_f32 v23, v222, v223
    v_lshlrev_b32 v222, 16, v23
    v_and_b32 v223, 0xffff0000, v23
    v_mul_f32 v24, 0xbfb8aa3b, v222
    v_mul_f32 v25, 0xbfb8aa3b, v223
    v_exp_f32 v24, v24
    v_exp_f32 v25, v25
    s_nop 0
    v_add_f32 v24, 1.0, v24
    v_add_f32 v25, 1.0, v25
    v_rcp_f32 v24, v24
    v_rcp_f32 v25, v25
    s_nop 0
    v_mul_f32 v222, v222, v24
    v_mul_f32 v223, v223, v25
    v_cvt_pk_bf16_f32 v23, v222, v223
    v_lshlrev_b32 v222, 16, v23
    v_and_b32 v223, 0xffff0000, v23
    s_lshl_b32 s36, s28, 12
    v_lshl_add_u32 v20, v1, 4, s36
    v_xor_b32 v21, 16384, v20
    ds_read_b64_tr_b16 v[64:65], v10 offset:0
    ds_read_b64_tr_b16 v[66:67], v10 offset:2048
    ds_read_b64_tr_b16 v[68:69], v11 offset:0
    ds_read_b64_tr_b16 v[70:71], v11 offset:2048
    ds_read_b64_tr_b16 v[72:73], v12 offset:0
    ds_read_b64_tr_b16 v[74:75], v12 offset:2048
    ds_read_b64_tr_b16 v[76:77], v13 offset:0
    ds_read_b64_tr_b16 v[78:79], v13 offset:2048
    s_mov_b32 s35, 0
    .p2align 6
L_p4_loop:
    s_lshl_b32 s36, s28, 3
    s_add_u32 s36, s36, s35
    s_cmp_eq_u32 s36, 1
    s_cbranch_scc1 L_recurrent_scan__compressed_kv_cla__moe_arch_mod__prompt_kernel_rare_170
L_recurrent_scan__compressed_kv_cla__moe_arch_mod__prompt_kernel_back_171:
    s_waitcnt lgkmcnt(0)
    s_waitcnt vmcnt(12)
    v_mfma_f32_16x16x32_bf16 v[224:227], v[64:67], v[128:131], v[224:227]
    ds_read_b64_tr_b16 v[80:81], v10 offset:4096
    ds_read_b64_tr_b16 v[82:83], v10 offset:6144
    v_mfma_f32_16x16x32_bf16 v[240:243], v[64:67], v[132:135], v[240:243]
    ds_read_b64_tr_b16 v[84:85], v11 offset:4096
    ds_read_b64_tr_b16 v[86:87], v11 offset:6144
    v_mfma_f32_16x16x32_bf16 v[228:231], v[68:71], v[128:131], v[228:231]
    ds_read_b64_tr_b16 v[88:89], v12 offset:4096
    ds_read_b64_tr_b16 v[90:91], v12 offset:6144
    v_mfma_f32_16x16x32_bf16 v[244:247], v[68:71], v[132:135], v[244:247]
    ds_read_b64_tr_b16 v[92:93], v13 offset:4096
    ds_read_b64_tr_b16 v[94:95], v13 offset:6144
    v_mfma_f32_16x16x32_bf16 v[232:235], v[72:75], v[128:131], v[232:235]
    buffer_load_dwordx4 v[184:187], v2, s[4:7], s31 offen offset:3072 sc1
    v_mfma_f32_16x16x32_bf16 v[248:251], v[72:75], v[132:135], v[248:251]
    buffer_load_dwordx4 v[188:191], v3, s[4:7], s31 offen offset:3072 sc1
    s_add_u32 s31, s31, 8192
    v_mfma_f32_16x16x32_bf16 v[236:239], v[76:79], v[128:131], v[236:239]
    s_cmp_lt_u32 s35, 7
    s_cselect_b32 s6, 16777216, 0
    s_cselect_b32 s10, 8388608, 0
    s_cselect_b32 s34, s33, 0x30000
    v_mfma_f32_16x16x32_bf16 v[252:255], v[76:79], v[132:135], v[252:255]
    s_waitcnt lgkmcnt(0)
    s_waitcnt vmcnt(12)
    v_mfma_f32_16x16x32_bf16 v[224:227], v[80:83], v[136:139], v[224:227]
    ds_read_b64_tr_b16 v[64:65], v10 offset:8192
    ds_read_b64_tr_b16 v[66:67], v10 offset:10240
    v_mfma_f32_16x16x32_bf16 v[240:243], v[80:83], v[140:143], v[240:243]
    ds_read_b64_tr_b16 v[68:69], v11 offset:8192
    ds_read_b64_tr_b16 v[70:71], v11 offset:10240
    v_mfma_f32_16x16x32_bf16 v[228:231], v[84:87], v[136:139], v[228:231]
    ds_read_b64_tr_b16 v[72:73], v12 offset:8192
    ds_read_b64_tr_b16 v[74:75], v12 offset:10240
    v_mfma_f32_16x16x32_bf16 v[244:247], v[84:87], v[140:143], v[244:247]
    ds_read_b64_tr_b16 v[76:77], v13 offset:8192
    ds_read_b64_tr_b16 v[78:79], v13 offset:10240
    v_mfma_f32_16x16x32_bf16 v[232:235], v[88:91], v[136:139], v[232:235]
    buffer_load_dwordx4 v[128:131], v2, s[4:7], s31 offen offset:0 sc1
    v_mfma_f32_16x16x32_bf16 v[248:251], v[88:91], v[140:143], v[248:251]
    buffer_load_dwordx4 v[132:135], v3, s[4:7], s31 offen offset:0 sc1
    v_mfma_f32_16x16x32_bf16 v[236:239], v[92:95], v[136:139], v[236:239]
    v_mfma_f32_16x16x32_bf16 v[252:255], v[92:95], v[140:143], v[252:255]
    s_waitcnt lgkmcnt(0)
    s_waitcnt vmcnt(12)
    v_mfma_f32_16x16x32_bf16 v[224:227], v[64:67], v[144:147], v[224:227]
    ds_read_b64_tr_b16 v[80:81], v10 offset:12288
    ds_read_b64_tr_b16 v[82:83], v10 offset:14336
    v_mfma_f32_16x16x32_bf16 v[240:243], v[64:67], v[148:151], v[240:243]
    ds_read_b64_tr_b16 v[84:85], v11 offset:12288
    ds_read_b64_tr_b16 v[86:87], v11 offset:14336
    v_mfma_f32_16x16x32_bf16 v[228:231], v[68:71], v[144:147], v[228:231]
    ds_read_b64_tr_b16 v[88:89], v12 offset:12288
    ds_read_b64_tr_b16 v[90:91], v12 offset:14336
    v_mfma_f32_16x16x32_bf16 v[244:247], v[68:71], v[148:151], v[244:247]
    ds_read_b64_tr_b16 v[92:93], v13 offset:12288
    ds_read_b64_tr_b16 v[94:95], v13 offset:14336
    v_mfma_f32_16x16x32_bf16 v[232:235], v[72:75], v[144:147], v[232:235]
    buffer_load_dwordx4 v[136:139], v2, s[4:7], s31 offen offset:1024 sc1
    v_mfma_f32_16x16x32_bf16 v[248:251], v[72:75], v[148:151], v[248:251]
    buffer_load_dwordx4 v[140:143], v3, s[4:7], s31 offen offset:1024 sc1
    v_mfma_f32_16x16x32_bf16 v[236:239], v[76:79], v[144:147], v[236:239]
    v_mfma_f32_16x16x32_bf16 v[252:255], v[76:79], v[148:151], v[252:255]
    s_waitcnt lgkmcnt(0)
    s_waitcnt vmcnt(7)
    s_barrier
    s_waitcnt vmcnt(13)
    v_mfma_f32_16x16x32_bf16 v[224:227], v[80:83], v[152:155], v[224:227]
    ds_read_b64_tr_b16 v[64:65], v10 offset:32768
    ds_read_b64_tr_b16 v[66:67], v10 offset:34816
    v_mfma_f32_16x16x32_bf16 v[240:243], v[80:83], v[156:159], v[240:243]
    ds_read_b64_tr_b16 v[68:69], v11 offset:32768
    ds_read_b64_tr_b16 v[70:71], v11 offset:34816
    v_mfma_f32_16x16x32_bf16 v[228:231], v[84:87], v[152:155], v[228:231]
    ds_read_b64_tr_b16 v[72:73], v12 offset:32768
    ds_read_b64_tr_b16 v[74:75], v12 offset:34816
    v_mfma_f32_16x16x32_bf16 v[244:247], v[84:87], v[156:159], v[244:247]
    ds_read_b64_tr_b16 v[76:77], v13 offset:32768
    ds_read_b64_tr_b16 v[78:79], v13 offset:34816
    s_add_u32 m0, s34, 0
    v_mfma_f32_16x16x32_bf16 v[232:235], v[88:91], v[152:155], v[232:235]
    buffer_load_dwordx4 v6, s[8:11], s32 offen offset:0 lds
    buffer_load_dwordx4 v7, s[8:11], s32 offen offset:1024 lds
    buffer_load_dwordx4 v[144:147], v2, s[4:7], s31 offen offset:2048 sc1
    v_mfma_f32_16x16x32_bf16 v[248:251], v[88:91], v[156:159], v[248:251]
    buffer_load_dwordx4 v8, s[8:11], s32 offen offset:2048 lds
    buffer_load_dwordx4 v9, s[8:11], s32 offen offset:3072 lds
    buffer_load_dwordx4 v[148:151], v3, s[4:7], s31 offen offset:2048 sc1
    v_mfma_f32_16x16x32_bf16 v[236:239], v[92:95], v[152:155], v[236:239]
    v_mfma_f32_16x16x32_bf16 v[252:255], v[92:95], v[156:159], v[252:255]
    s_add_u32 s32, s32, 524288
    s_waitcnt lgkmcnt(0)
    s_waitcnt vmcnt(17)
    v_mfma_f32_16x16x32_bf16 v[224:227], v[64:67], v[160:163], v[224:227]
    ds_read_b64_tr_b16 v[80:81], v10 offset:36864
    ds_read_b64_tr_b16 v[82:83], v10 offset:38912
    v_mfma_f32_16x16x32_bf16 v[240:243], v[64:67], v[164:167], v[240:243]
    ds_read_b64_tr_b16 v[84:85], v11 offset:36864
    ds_read_b64_tr_b16 v[86:87], v11 offset:38912
    v_mfma_f32_16x16x32_bf16 v[228:231], v[68:71], v[160:163], v[228:231]
    ds_read_b64_tr_b16 v[88:89], v12 offset:36864
    ds_read_b64_tr_b16 v[90:91], v12 offset:38912
    v_mfma_f32_16x16x32_bf16 v[244:247], v[68:71], v[164:167], v[244:247]
    ds_read_b64_tr_b16 v[92:93], v13 offset:36864
    ds_read_b64_tr_b16 v[94:95], v13 offset:38912
    v_mfma_f32_16x16x32_bf16 v[232:235], v[72:75], v[160:163], v[232:235]
    buffer_load_dwordx4 v[152:155], v2, s[4:7], s31 offen offset:3072 sc1
    v_mfma_f32_16x16x32_bf16 v[248:251], v[72:75], v[164:167], v[248:251]
    buffer_load_dwordx4 v[156:159], v3, s[4:7], s31 offen offset:3072 sc1
    s_add_u32 s31, s31, 8192
    v_mfma_f32_16x16x32_bf16 v[236:239], v[76:79], v[160:163], v[236:239]
    v_mfma_f32_16x16x32_bf16 v[252:255], v[76:79], v[164:167], v[252:255]
    s_waitcnt lgkmcnt(0)
    s_waitcnt vmcnt(17)
    v_mfma_f32_16x16x32_bf16 v[224:227], v[80:83], v[168:171], v[224:227]
    ds_read_b64_tr_b16 v[64:65], v10 offset:40960
    ds_read_b64_tr_b16 v[66:67], v10 offset:43008
    v_mfma_f32_16x16x32_bf16 v[240:243], v[80:83], v[172:175], v[240:243]
    ds_read_b64_tr_b16 v[68:69], v11 offset:40960
    ds_read_b64_tr_b16 v[70:71], v11 offset:43008
    v_mfma_f32_16x16x32_bf16 v[228:231], v[84:87], v[168:171], v[228:231]
    ds_read_b64_tr_b16 v[72:73], v12 offset:40960
    ds_read_b64_tr_b16 v[74:75], v12 offset:43008
    v_mfma_f32_16x16x32_bf16 v[244:247], v[84:87], v[172:175], v[244:247]
    ds_read_b64_tr_b16 v[76:77], v13 offset:40960
    ds_read_b64_tr_b16 v[78:79], v13 offset:43008
    v_mfma_f32_16x16x32_bf16 v[232:235], v[88:91], v[168:171], v[232:235]
    buffer_load_dwordx4 v[160:163], v2, s[4:7], s31 offen offset:0 sc1
    v_mfma_f32_16x16x32_bf16 v[248:251], v[88:91], v[172:175], v[248:251]
    buffer_load_dwordx4 v[164:167], v3, s[4:7], s31 offen offset:0 sc1
    v_mfma_f32_16x16x32_bf16 v[236:239], v[92:95], v[168:171], v[236:239]
    v_mfma_f32_16x16x32_bf16 v[252:255], v[92:95], v[172:175], v[252:255]
    s_waitcnt lgkmcnt(0)
    s_waitcnt vmcnt(16)
    v_mfma_f32_16x16x32_bf16 v[224:227], v[64:67], v[176:179], v[224:227]
    ds_read_b64_tr_b16 v[80:81], v10 offset:45056
    ds_read_b64_tr_b16 v[82:83], v10 offset:47104
    v_mfma_f32_16x16x32_bf16 v[240:243], v[64:67], v[180:183], v[240:243]
    ds_read_b64_tr_b16 v[84:85], v11 offset:45056
    ds_read_b64_tr_b16 v[86:87], v11 offset:47104
    v_mfma_f32_16x16x32_bf16 v[228:231], v[68:71], v[176:179], v[228:231]
    ds_read_b64_tr_b16 v[88:89], v12 offset:45056
    ds_read_b64_tr_b16 v[90:91], v12 offset:47104
    v_mfma_f32_16x16x32_bf16 v[244:247], v[68:71], v[180:183], v[244:247]
    ds_read_b64_tr_b16 v[92:93], v13 offset:45056
    ds_read_b64_tr_b16 v[94:95], v13 offset:47104
    v_mfma_f32_16x16x32_bf16 v[232:235], v[72:75], v[176:179], v[232:235]
    buffer_load_dwordx4 v[168:171], v2, s[4:7], s31 offen offset:1024 sc1
    v_mfma_f32_16x16x32_bf16 v[248:251], v[72:75], v[180:183], v[248:251]
    buffer_load_dwordx4 v[172:175], v3, s[4:7], s31 offen offset:1024 sc1
    v_mfma_f32_16x16x32_bf16 v[236:239], v[76:79], v[176:179], v[236:239]
    v_mfma_f32_16x16x32_bf16 v[252:255], v[76:79], v[180:183], v[252:255]
    s_waitcnt lgkmcnt(0)
    s_waitcnt vmcnt(7)
    s_barrier
    v_mfma_f32_16x16x32_bf16 v[224:227], v[80:83], v[184:187], v[224:227]
    ds_read_b64_tr_b16 v[64:65], v10 offset:0
    ds_read_b64_tr_b16 v[66:67], v10 offset:2048
    v_mfma_f32_16x16x32_bf16 v[240:243], v[80:83], v[188:191], v[240:243]
    ds_read_b64_tr_b16 v[68:69], v11 offset:0
    ds_read_b64_tr_b16 v[70:71], v11 offset:2048
    v_mfma_f32_16x16x32_bf16 v[228:231], v[84:87], v[184:187], v[228:231]
    ds_read_b64_tr_b16 v[72:73], v12 offset:0
    ds_read_b64_tr_b16 v[74:75], v12 offset:2048
    v_mfma_f32_16x16x32_bf16 v[244:247], v[84:87], v[188:191], v[244:247]
    ds_read_b64_tr_b16 v[76:77], v13 offset:0
    ds_read_b64_tr_b16 v[78:79], v13 offset:2048
    s_add_u32 m0, s34, 32768
    v_mfma_f32_16x16x32_bf16 v[232:235], v[88:91], v[184:187], v[232:235]
    buffer_load_dwordx4 v6, s[8:11], s32 offen offset:0 lds
    buffer_load_dwordx4 v7, s[8:11], s32 offen offset:1024 lds
    buffer_load_dwordx4 v[176:179], v2, s[4:7], s31 offen offset:2048 sc1
    v_mfma_f32_16x16x32_bf16 v[248:251], v[88:91], v[188:191], v[248:251]
    buffer_load_dwordx4 v8, s[8:11], s32 offen offset:2048 lds
    buffer_load_dwordx4 v9, s[8:11], s32 offen offset:3072 lds
    buffer_load_dwordx4 v[180:183], v3, s[4:7], s31 offen offset:2048 sc1
    v_mfma_f32_16x16x32_bf16 v[236:239], v[92:95], v[184:187], v[236:239]
    v_mfma_f32_16x16x32_bf16 v[252:255], v[92:95], v[188:191], v[252:255]
    s_add_u32 s32, s32, 524288
    s_add_u32 s35, s35, 1
    s_cmp_lt_u32 s35, 8
    s_cbranch_scc1 L_p4_loop
    s_waitcnt vmcnt(0) lgkmcnt(0)
    s_sub_u32 s36, s56, s38
    s_sub_u32 s37, s57, s38
    s_min_u32 s36, s36, s37
    s_cmp_lt_u32 s36, 16
    s_cbranch_scc1 L_recurrent_scan__compressed_kv_cla__moe_arch_mod__prompt_kernel_rare_180
L_recurrent_scan__compressed_kv_cla__moe_arch_mod__prompt_kernel_back_181:
    s_cmp_lt_u32 s28, 4
    s_cbranch_scc0 L_p4_e1
    ds_write_b128 v20, v[240:243] offset:0
    ds_write_b128 v20, v[244:247] offset:1024
    ds_write_b128 v20, v[248:251] offset:2048
    ds_write_b128 v20, v[252:255] offset:3072
    s_waitcnt lgkmcnt(0)
    s_barrier
    ds_read_b128 v[64:67], v21 offset:0
    ds_read_b128 v[68:71], v21 offset:1024
    ds_read_b128 v[72:75], v21 offset:2048
    ds_read_b128 v[76:79], v21 offset:3072
    s_waitcnt lgkmcnt(3)
    v_add_f32 v224, v224, v64
    v_add_f32 v225, v225, v65
    v_cvt_pk_bf16_f32 v23, v224, v225
    v_lshlrev_b32 v224, 16, v23
    v_and_b32 v225, 0xffff0000, v23
    v_mul_f32 v224, v224, v208
    v_mul_f32 v225, v225, v209
    v_cvt_pk_bf16_f32 v23, v224, v225
    v_lshlrev_b32 v224, 16, v23
    v_and_b32 v225, 0xffff0000, v23
    v_add_f32 v224, v224, v192
    v_add_f32 v225, v225, v193
    v_cvt_pk_bf16_f32 v80, v224, v225
    v_add_f32 v226, v226, v66
    v_add_f32 v227, v227, v67
    v_cvt_pk_bf16_f32 v23, v226, v227
    v_lshlrev_b32 v226, 16, v23
    v_and_b32 v227, 0xffff0000, v23
    v_mul_f32 v226, v226, v210
    v_mul_f32 v227, v227, v211
    v_cvt_pk_bf16_f32 v23, v226, v227
    v_lshlrev_b32 v226, 16, v23
    v_and_b32 v227, 0xffff0000, v23
    v_add_f32 v226, v226, v194
    v_add_f32 v227, v227, v195
    v_cvt_pk_bf16_f32 v81, v226, v227
    buffer_store_dwordx2 v[80:81], v15, s[20:23], 0 offen offset:0
    s_waitcnt lgkmcnt(2)
    v_add_f32 v228, v228, v68
    v_add_f32 v229, v229, v69
    v_cvt_pk_bf16_f32 v23, v228, v229
    v_lshlrev_b32 v228, 16, v23
    v_and_b32 v229, 0xffff0000, v23
    v_mul_f32 v228, v228, v212
    v_mul_f32 v229, v229, v213
    v_cvt_pk_bf16_f32 v23, v228, v229
    v_lshlrev_b32 v228, 16, v23
    v_and_b32 v229, 0xffff0000, v23
    v_add_f32 v228, v228, v196
    v_add_f32 v229, v229, v197
    v_cvt_pk_bf16_f32 v82, v228, v229
    v_add_f32 v230, v230, v70
    v_add_f32 v231, v231, v71
    v_cvt_pk_bf16_f32 v23, v230, v231
    v_lshlrev_b32 v230, 16, v23
    v_and_b32 v231, 0xffff0000, v23
    v_mul_f32 v230, v230, v214
    v_mul_f32 v231, v231, v215
    v_cvt_pk_bf16_f32 v23, v230, v231
    v_lshlrev_b32 v230, 16, v23
    v_and_b32 v231, 0xffff0000, v23
    v_add_f32 v230, v230, v198
    v_add_f32 v231, v231, v199
    v_cvt_pk_bf16_f32 v83, v230, v231
    buffer_store_dwordx2 v[82:83], v15, s[20:23], 0 offen offset:32
    s_waitcnt lgkmcnt(1)
    v_add_f32 v232, v232, v72
    v_add_f32 v233, v233, v73
    v_cvt_pk_bf16_f32 v23, v232, v233
    v_lshlrev_b32 v232, 16, v23
    v_and_b32 v233, 0xffff0000, v23
    v_mul_f32 v232, v232, v216
    v_mul_f32 v233, v233, v217
    v_cvt_pk_bf16_f32 v23, v232, v233
    v_lshlrev_b32 v232, 16, v23
    v_and_b32 v233, 0xffff0000, v23
    v_add_f32 v232, v232, v200
    v_add_f32 v233, v233, v201
    v_cvt_pk_bf16_f32 v84, v232, v233
    v_add_f32 v234, v234, v74
    v_add_f32 v235, v235, v75
    v_cvt_pk_bf16_f32 v23, v234, v235
    v_lshlrev_b32 v234, 16, v23
    v_and_b32 v235, 0xffff0000, v23
    v_mul_f32 v234, v234, v218
    v_mul_f32 v235, v235, v219
    v_cvt_pk_bf16_f32 v23, v234, v235
    v_lshlrev_b32 v234, 16, v23
    v_and_b32 v235, 0xffff0000, v23
    v_add_f32 v234, v234, v202
    v_add_f32 v235, v235, v203
    v_cvt_pk_bf16_f32 v85, v234, v235
    buffer_store_dwordx2 v[84:85], v15, s[20:23], 0 offen offset:64
    s_waitcnt lgkmcnt(0)
    v_add_f32 v236, v236, v76
    v_add_f32 v237, v237, v77
    v_cvt_pk_bf16_f32 v23, v236, v237
    v_lshlrev_b32 v236, 16, v23
    v_and_b32 v237, 0xffff0000, v23
    v_mul_f32 v236, v236, v220
    v_mul_f32 v237, v237, v221
    v_cvt_pk_bf16_f32 v23, v236, v237
    v_lshlrev_b32 v236, 16, v23
    v_and_b32 v237, 0xffff0000, v23
    v_add_f32 v236, v236, v204
    v_add_f32 v237, v237, v205
    v_cvt_pk_bf16_f32 v86, v236, v237
    v_add_f32 v238, v238, v78
    v_add_f32 v239, v239, v79
    v_cvt_pk_bf16_f32 v23, v238, v239
    v_lshlrev_b32 v238, 16, v23
    v_and_b32 v239, 0xffff0000, v23
    v_mul_f32 v238, v238, v222
    v_mul_f32 v239, v239, v223
    v_cvt_pk_bf16_f32 v23, v238, v239
    v_lshlrev_b32 v238, 16, v23
    v_and_b32 v239, 0xffff0000, v23
    v_add_f32 v238, v238, v206
    v_add_f32 v239, v239, v207
    v_cvt_pk_bf16_f32 v87, v238, v239
    buffer_store_dwordx2 v[86:87], v15, s[20:23], 0 offen offset:96
    s_branch L_p4_done
L_p4_e1:
    ds_write_b128 v20, v[224:227] offset:0
    ds_write_b128 v20, v[228:231] offset:1024
    ds_write_b128 v20, v[232:235] offset:2048
    ds_write_b128 v20, v[236:239] offset:3072
    s_waitcnt lgkmcnt(0)
    s_barrier
    ds_read_b128 v[64:67], v21 offset:0
    ds_read_b128 v[68:71], v21 offset:1024
    ds_read_b128 v[72:75], v21 offset:2048
    ds_read_b128 v[76:79], v21 offset:3072
    s_waitcnt lgkmcnt(3)
    v_add_f32 v240, v240, v64
    v_add_f32 v241, v241, v65
    v_cvt_pk_bf16_f32 v23, v240, v241
    v_lshlrev_b32 v240, 16, v23
    v_and_b32 v241, 0xffff0000, v23
    v_mul_f32 v240, v240, v208
    v_mul_f32 v241, v241, v209
    v_cvt_pk_bf16_f32 v23, v240, v241
    v_lshlrev_b32 v240, 16, v23
    v_and_b32 v241, 0xffff0000, v23
    v_add_f32 v240, v240, v192
    v_add_f32 v241, v241, v193
    v_cvt_pk_bf16_f32 v80, v240, v241
    v_add_f32 v242, v242, v66
    v_add_f32 v243, v243, v67
    v_cvt_pk_bf16_f32 v23, v242, v243
    v_lshlrev_b32 v242, 16, v23
    v_and_b32 v243, 0xffff0000, v23
    v_mul_f32 v242, v242, v210
    v_mul_f32 v243, v243, v211
    v_cvt_pk_bf16_f32 v23, v242, v243
    v_lshlrev_b32 v242, 16, v23
    v_and_b32 v243, 0xffff0000, v23
    v_add_f32 v242, v242, v194
    v_add_f32 v243, v243, v195
    v_cvt_pk_bf16_f32 v81, v242, v243
    buffer_store_dwordx2 v[80:81], v15, s[20:23], 0 offen offset:0
    s_waitcnt lgkmcnt(2)
    v_add_f32 v244, v244, v68
    v_add_f32 v245, v245, v69
    v_cvt_pk_bf16_f32 v23, v244, v245
    v_lshlrev_b32 v244, 16, v23
    v_and_b32 v245, 0xffff0000, v23
    v_mul_f32 v244, v244, v212
    v_mul_f32 v245, v245, v213
    v_cvt_pk_bf16_f32 v23, v244, v245
    v_lshlrev_b32 v244, 16, v23
    v_and_b32 v245, 0xffff0000, v23
    v_add_f32 v244, v244, v196
    v_add_f32 v245, v245, v197
    v_cvt_pk_bf16_f32 v82, v244, v245
    v_add_f32 v246, v246, v70
    v_add_f32 v247, v247, v71
    v_cvt_pk_bf16_f32 v23, v246, v247
    v_lshlrev_b32 v246, 16, v23
    v_and_b32 v247, 0xffff0000, v23
    v_mul_f32 v246, v246, v214
    v_mul_f32 v247, v247, v215
    v_cvt_pk_bf16_f32 v23, v246, v247
    v_lshlrev_b32 v246, 16, v23
    v_and_b32 v247, 0xffff0000, v23
    v_add_f32 v246, v246, v198
    v_add_f32 v247, v247, v199
    v_cvt_pk_bf16_f32 v83, v246, v247
    buffer_store_dwordx2 v[82:83], v15, s[20:23], 0 offen offset:32
    s_waitcnt lgkmcnt(1)
    v_add_f32 v248, v248, v72
    v_add_f32 v249, v249, v73
    v_cvt_pk_bf16_f32 v23, v248, v249
    v_lshlrev_b32 v248, 16, v23
    v_and_b32 v249, 0xffff0000, v23
    v_mul_f32 v248, v248, v216
    v_mul_f32 v249, v249, v217
    v_cvt_pk_bf16_f32 v23, v248, v249
    v_lshlrev_b32 v248, 16, v23
    v_and_b32 v249, 0xffff0000, v23
    v_add_f32 v248, v248, v200
    v_add_f32 v249, v249, v201
    v_cvt_pk_bf16_f32 v84, v248, v249
    v_add_f32 v250, v250, v74
    v_add_f32 v251, v251, v75
    v_cvt_pk_bf16_f32 v23, v250, v251
    v_lshlrev_b32 v250, 16, v23
    v_and_b32 v251, 0xffff0000, v23
    v_mul_f32 v250, v250, v218
    v_mul_f32 v251, v251, v219
    v_cvt_pk_bf16_f32 v23, v250, v251
    v_lshlrev_b32 v250, 16, v23
    v_and_b32 v251, 0xffff0000, v23
    v_add_f32 v250, v250, v202
    v_add_f32 v251, v251, v203
    v_cvt_pk_bf16_f32 v85, v250, v251
    buffer_store_dwordx2 v[84:85], v15, s[20:23], 0 offen offset:64
    s_waitcnt lgkmcnt(0)
    v_add_f32 v252, v252, v76
    v_add_f32 v253, v253, v77
    v_cvt_pk_bf16_f32 v23, v252, v253
    v_lshlrev_b32 v252, 16, v23
    v_and_b32 v253, 0xffff0000, v23
    v_mul_f32 v252, v252, v220
    v_mul_f32 v253, v253, v221
    v_cvt_pk_bf16_f32 v23, v252, v253
    v_lshlrev_b32 v252, 16, v23
    v_and_b32 v253, 0xffff0000, v23
    v_add_f32 v252, v252, v204
    v_add_f32 v253, v253, v205
    v_cvt_pk_bf16_f32 v86, v252, v253
    v_add_f32 v254, v254, v78
    v_add_f32 v255, v255, v79
    v_cvt_pk_bf16_f32 v23, v254, v255
    v_lshlrev_b32 v254, 16, v23
    v_and_b32 v255, 0xffff0000, v23
    v_mul_f32 v254, v254, v222
    v_mul_f32 v255, v255, v223
    v_cvt_pk_bf16_f32 v23, v254, v255
    v_lshlrev_b32 v254, 16, v23
    v_and_b32 v255, 0xffff0000, v23
    v_add_f32 v254, v254, v206
    v_add_f32 v255, v255, v207
    v_cvt_pk_bf16_f32 v87, v254, v255
    buffer_store_dwordx2 v[86:87], v15, s[20:23], 0 offen offset:96
L_p4_done:
    s_endpgm
L_recurrent_scan__compressed_kv_cla__moe_arch_mod__prompt_kernel_rare_167:
    v_mov_b32 v26, s40
    v_mov_b32 v27, s41
    v_cmp_eq_u32 vcc, 1, v1
    v_mov_b32 v28, 1
    s_nop 0
    v_cndmask_b32 v26, v26, v27, vcc
    s_mov_b64 exec, 3
    global_atomic_add v26, v28, s[90:91]
    s_mov_b64 exec, -1
    s_branch L_recurrent_scan__compressed_kv_cla__moe_arch_mod__prompt_kernel_back_168
L_recurrent_scan__compressed_kv_cla__moe_arch_mod__prompt_kernel_rare_170:
    s_and_b32 s36, s2, 15
    s_add_u32 s36, s36, 96
    s_lshl_b32 s36, s36, 7
    v_mov_b32 v26, s36
    v_mov_b32 v27, 1
    s_mov_b64 exec, 1
    global_atomic_add v26, v27, s[90:91]
    s_mov_b64 exec, -1
    s_nop 3
    s_branch L_recurrent_scan__compressed_kv_cla__moe_arch_mod__prompt_kernel_back_171
L_recurrent_scan__compressed_kv_cla__moe_arch_mod__prompt_kernel_rare_174:
    s_mov_b32 s61, 0x40000
L_recurrent_scan__compressed_kv_cla__moe_arch_mod__prompt_kernel_spin_172:
    s_sub_u32 s61, s61, 1
    s_cbranch_scc1 L_recurrent_scan__compressed_kv_cla__moe_arch_mod__prompt_kernel_spinx_173
    s_sleep 8
    global_load_dword v30, v31, s[90:91] sc1
    s_waitcnt vmcnt(0)
    v_readfirstlane_b32 s36, v30
    s_nop 0
    s_cmp_lt_u32 s36, 28
    s_cbranch_scc1 L_recurrent_scan__compressed_kv_cla__moe_arch_mod__prompt_kernel_spin_172
L_recurrent_scan__compressed_kv_cla__moe_arch_mod__prompt_kernel_spinx_173:
    s_branch L_recurrent_scan__compressed_kv_cla__moe_arch_mod__prompt_kernel_back_175
L_recurrent_scan__compressed_kv_cla__moe_arch_mod__prompt_kernel_rare_180:
    v_mov_b32 v100, 0
    v_mov_b32 v101, 0
    v_mov_b32 v102, 0
    v_mov_b32 v103, 0
    v_mov_b32 v104, 0
    v_mov_b32 v105, 0
    v_mov_b32 v106, 0
    v_mov_b32 v107, 0
    v_mov_b32 v108, 0
    v_mov_b32 v109, 0
    v_mov_b32 v110, 0
    v_mov_b32 v111, 0
    v_mov_b32 v112, 0
    v_mov_b32 v113, 0
    v_mov_b32 v114, 0
    v_mov_b32 v115, 0
    s_add_u32 s36, s30, 96
    s_lshl_b32 s36, s36, 7
    v_mov_b32 v22, s36
    s_mov_b32 s61, 0x40000
L_recurrent_scan__compressed_kv_cla__moe_arch_mod__prompt_kernel_rt_spin_1:
    s_sub_u32 s61, s61, 1
    s_cbranch_scc1 L_recurrent_scan__compressed_kv_cla__moe_arch_mod__prompt_kernel_rt_spinx_2
    s_sleep 1
    global_load_dword v23, v22, s[90:91] sc1
    s_waitcnt vmcnt(0)
    v_readfirstlane_b32 s36, v23
    s_nop 0
    s_cmp_lt_u32 s36, 16
    s_cbranch_scc1 L_recurrent_scan__compressed_kv_cla__moe_arch_mod__prompt_kernel_rt_spin_1
L_recurrent_scan__compressed_kv_cla__moe_arch_mod__prompt_kernel_rt_spinx_2:
    s_sub_u32 s36, s56, s38
    s_cmp_lt_u32 s36, 16
    s_cbranch_scc0 L_recurrent_scan__compressed_kv_cla__moe_arch_mod__prompt_kernel_rt_noy_3
    s_lshl_b32 s37, s30, 8
    s_add_u32 s37, s37, 59768832
    v_and_b32 v22, 15, v1
    v_lshlrev_b32 v22, 13, v22
    v_lshl_add_u32 v22, v19, 4, v22
    buffer_load_dwordx4 v[64:67], v22, s[24:27], s37 offen offset:0 sc1
    buffer_load_dwordx4 v[68:71], v22, s[24:27], s37 offen offset:64 sc1
    buffer_load_dwordx4 v[72:75], v22, s[24:27], s37 offen offset:128 sc1
    buffer_load_dwordx4 v[76:79], v22, s[24:27], s37 offen offset:192 sc1
    s_and_b32 s36, s58, 0xffff0000
    s_cmp_lt_i32 s36, 0
    s_cselect_b32 s37, 0x80000000, -1
    s_xor_b32 s36, s36, s37
    s_and_b32 s36, s36, 0xffff0000
    v_mov_b32 v24, s36
    v_mul_f32 v24, 0xbfb8aa3b, v24
    v_exp_f32 v24, v24
    s_nop 0
    v_add_f32 v24, 1.0, v24
    v_rcp_f32 v24, v24
    s_nop 0
    v_cvt_pk_bf16_f32 v24, v24, v24
    v_lshlrev_b32 v24, 16, v24
    s_waitcnt vmcnt(0)
    v_add_f32_dpp v64, v64, v64 quad_perm:[1,0,3,2] row_mask:0xf bank_mask:0xf
    v_add_f32_dpp v65, v65, v65 quad_perm:[1,0,3,2] row_mask:0xf bank_mask:0xf
    v_add_f32_dpp v66, v66, v66 quad_perm:[1,0,3,2] row_mask:0xf bank_mask:0xf
    v_add_f32_dpp v67, v67, v67 quad_perm:[1,0,3,2] row_mask:0xf bank_mask:0xf
    v_add_f32_dpp v68, v68, v68 quad_perm:[1,0,3,2] row_mask:0xf bank_mask:0xf
    v_add_f32_dpp v69, v69, v69 quad_perm:[1,0,3,2] row_mask:0xf bank_mask:0xf
    v_add_f32_dpp v70, v70, v70 quad_perm:[1,0,3,2] row_mask:0xf bank_mask:0xf
    v_add_f32_dpp v71, v71, v71 quad_perm:[1,0,3,2] row_mask:0xf bank_mask:0xf
    v_add_f32_dpp v72, v72, v72 quad_perm:[1,0,3,2] row_mask:0xf bank_mask:0xf
    v_add_f32_dpp v73, v73, v73 quad_perm:[1,0,3,2] row_mask:0xf bank_mask:0xf
    v_add_f32_dpp v74, v74, v74 quad_perm:[1,0,3,2] row_mask:0xf bank_mask:0xf
    v_add_f32_dpp v75, v75, v75 quad_perm:[1,0,3,2] row_mask:0xf bank_mask:0xf
    v_add_f32_dpp v76, v76, v76 quad_perm:[1,0,3,2] row_mask:0xf bank_mask:0xf
    v_add_f32_dpp v77, v77, v77 quad_perm:[1,0,3,2] row_mask:0xf bank_mask:0xf
    v_add_f32_dpp v78, v78, v78 quad_perm:[1,0,3,2] row_mask:0xf bank_mask:0xf
    v_add_f32_dpp v79, v79, v79 quad_perm:[1,0,3,2] row_mask:0xf bank_mask:0xf
    v_add_f32_dpp v64, v64, v64 quad_perm:[2,3,0,1] row_mask:0xf bank_mask:0xf
    v_add_f32_dpp v65, v65, v65 quad_perm:[2,3,0,1] row_mask:0xf bank_mask:0xf
    v_add_f32_dpp v66, v66, v66 quad_perm:[2,3,0,1] row_mask:0xf bank_mask:0xf
    v_add_f32_dpp v67, v67, v67 quad_perm:[2,3,0,1] row_mask:0xf bank_mask:0xf
    v_add_f32_dpp v68, v68, v68 quad_perm:[2,3,0,1] row_mask:0xf bank_mask:0xf
    v_add_f32_dpp v69, v69, v69 quad_perm:[2,3,0,1] row_mask:0xf bank_mask:0xf
    v_add_f32_dpp v70, v70, v70 quad_perm:[2,3,0,1] row_mask:0xf bank_mask:0xf
    v_add_f32_dpp v71, v71, v71 quad_perm:[2,3,0,1] row_mask:0xf bank_mask:0xf
    v_add_f32_dpp v72, v72, v72 quad_perm:[2,3,0,1] row_mask:0xf bank_mask:0xf
    v_add_f32_dpp v73, v73, v73 quad_perm:[2,3,0,1] row_mask:0xf bank_mask:0xf
    v_add_f32_dpp v74, v74, v74 quad_perm:[2,3,0,1] row_mask:0xf bank_mask:0xf
    v_add_f32_dpp v75, v75, v75 quad_perm:[2,3,0,1] row_mask:0xf bank_mask:0xf
    v_add_f32_dpp v76, v76, v76 quad_perm:[2,3,0,1] row_mask:0xf bank_mask:0xf
    v_add_f32_dpp v77, v77, v77 quad_perm:[2,3,0,1] row_mask:0xf bank_mask:0xf
    v_add_f32_dpp v78, v78, v78 quad_perm:[2,3,0,1] row_mask:0xf bank_mask:0xf
    v_add_f32_dpp v79, v79, v79 quad_perm:[2,3,0,1] row_mask:0xf bank_mask:0xf
    v_add_f32_dpp v64, v64, v64 row_half_mirror row_mask:0xf bank_mask:0xf
    v_add_f32_dpp v65, v65, v65 row_half_mirror row_mask:0xf bank_mask:0xf
    v_add_f32_dpp v66, v66, v66 row_half_mirror row_mask:0xf bank_mask:0xf
    v_add_f32_dpp v67, v67, v67 row_half_mirror row_mask:0xf bank_mask:0xf
    v_add_f32_dpp v68, v68, v68 row_half_mirror row_mask:0xf bank_mask:0xf
    v_add_f32_dpp v69, v69, v69 row_half_mirror row_mask:0xf bank_mask:0xf
    v_add_f32_dpp v70, v70, v70 row_half_mirror row_mask:0xf bank_mask:0xf
    v_add_f32_dpp v71, v71, v71 row_half_mirror row_mask:0xf bank_mask:0xf
    v_add_f32_dpp v72, v72, v72 row_half_mirror row_mask:0xf bank_mask:0xf
    v_add_f32_dpp v73, v73, v73 row_half_mirror row_mask:0xf bank_mask:0xf
    v_add_f32_dpp v74, v74, v74 row_half_mirror row_mask:0xf bank_mask:0xf
    v_add_f32_dpp v75, v75, v75 row_half_mirror row_mask:0xf bank_mask:0xf
    v_add_f32_dpp v76, v76, v76 row_half_mirror row_mask:0xf bank_mask:0xf
    v_add_f32_dpp v77, v77, v77 row_half_mirror row_mask:0xf bank_mask:0xf
    v_add_f32_dpp v78, v78, v78 row_half_mirror row_mask:0xf bank_mask:0xf
    v_add_f32_dpp v79, v79, v79 row_half_mirror row_mask:0xf bank_mask:0xf
    v_add_f32_dpp v64, v64, v64 row_mirror row_mask:0xf bank_mask:0xf
    v_add_f32_dpp v65, v65, v65 row_mirror row_mask:0xf bank_mask:0xf
    v_add_f32_dpp v66, v66, v66 row_mirror row_mask:0xf bank_mask:0xf
    v_add_f32_dpp v67, v67, v67 row_mirror row_mask:0xf bank_mask:0xf
    v_add_f32_dpp v68, v68, v68 row_mirror row_mask:0xf bank_mask:0xf
    v_add_f32_dpp v69, v69, v69 row_mirror row_mask:0xf bank_mask:0xf
    v_add_f32_dpp v70, v70, v70 row_mirror row_mask:0xf bank_mask:0xf
    v_add_f32_dpp v71, v71, v71 row_mirror row_mask:0xf bank_mask:0xf
    v_add_f32_dpp v72, v72, v72 row_mirror row_mask:0xf bank_mask:0xf
    v_add_f32_dpp v73, v73, v73 row_mirror row_mask:0xf bank_mask:0xf
    v_add_f32_dpp v74, v74, v74 row_mirror row_mask:0xf bank_mask:0xf
    v_add_f32_dpp v75, v75, v75 row_mirror row_mask:0xf bank_mask:0xf
    v_add_f32_dpp v76, v76, v76 row_mirror row_mask:0xf bank_mask:0xf
    v_add_f32_dpp v77, v77, v77 row_mirror row_mask:0xf bank_mask:0xf
    v_add_f32_dpp v78, v78, v78 row_mirror row_mask:0xf bank_mask:0xf
    v_add_f32_dpp v79, v79, v79 row_mirror row_mask:0xf bank_mask:0xf
    v_cmp_eq_u32 vcc, s56, v14
    v_cvt_pk_bf16_f32 v64, v64, v64
    v_lshlrev_b32 v64, 16, v64
    v_mul_f32 v64, v24, v64
    v_cvt_pk_bf16_f32 v64, v64, v64
    v_lshlrev_b32 v64, 16, v64
    v_cndmask_b32 v100, v100, v64, vcc
    v_cvt_pk_bf16_f32 v65, v65, v65
    v_lshlrev_b32 v65, 16, v65
    v_mul_f32 v65, v24, v65
    v_cvt_pk_bf16_f32 v65, v65, v65
    v_lshlrev_b32 v65, 16, v65
    v_cndmask_b32 v101, v101, v65, vcc
    v_cvt_pk_bf16_f32 v66, v66, v66
    v_lshlrev_b32 v66, 16, v66
    v_mul_f32 v66, v24, v66
    v_cvt_pk_bf16_f32 v66, v66, v66
    v_lshlrev_b32 v66, 16, v66
    v_cndmask_b32 v102, v102, v66, vcc
    v_cvt_pk_bf16_f32 v67, v67, v67
    v_lshlrev_b32 v67, 16, v67
    v_mul_f32 v67, v24, v67
    v_cvt_pk_bf16_f32 v67, v67, v67
    v_lshlrev_b32 v67, 16, v67
    v_cndmask_b32 v103, v103, v67, vcc
    v_cvt_pk_bf16_f32 v68, v68, v68
    v_lshlrev_b32 v68, 16, v68
    v_mul_f32 v68, v24, v68
    v_cvt_pk_bf16_f32 v68, v68, v68
    v_lshlrev_b32 v68, 16, v68
    v_cndmask_b32 v104, v104, v68, vcc
    v_cvt_pk_bf16_f32 v69, v69, v69
    v_lshlrev_b32 v69, 16, v69
    v_mul_f32 v69, v24, v69
    v_cvt_pk_bf16_f32 v69, v69, v69
    v_lshlrev_b32 v69, 16, v69
    v_cndmask_b32 v105, v105, v69, vcc
    v_cvt_pk_bf16_f32 v70, v70, v70
    v_lshlrev_b32 v70, 16, v70
    v_mul_f32 v70, v24, v70
    v_cvt_pk_bf16_f32 v70, v70, v70
    v_lshlrev_b32 v70, 16, v70
    v_cndmask_b32 v106, v106, v70, vcc
    v_cvt_pk_bf16_f32 v71, v71, v71
    v_lshlrev_b32 v71, 16, v71
    v_mul_f32 v71, v24, v71
    v_cvt_pk_bf16_f32 v71, v71, v71
    v_lshlrev_b32 v71, 16, v71
    v_cndmask_b32 v107, v107, v71, vcc
    v_cvt_pk_bf16_f32 v72, v72, v72
    v_lshlrev_b32 v72, 16, v72
    v_mul_f32 v72, v24, v72
    v_cvt_pk_bf16_f32 v72, v72, v72
    v_lshlrev_b32 v72, 16, v72
    v_cndmask_b32 v108, v108, v72, vcc
    v_cvt_pk_bf16_f32 v73, v73, v73
    v_lshlrev_b32 v73, 16, v73
    v_mul_f32 v73, v24, v73
    v_cvt_pk_bf16_f32 v73, v73, v73
    v_lshlrev_b32 v73, 16, v73
    v_cndmask_b32 v109, v109, v73, vcc
    v_cvt_pk_bf16_f32 v74, v74, v74
    v_lshlrev_b32 v74, 16, v74
    v_mul_f32 v74, v24, v74
    v_cvt_pk_bf16_f32 v74, v74, v74
    v_lshlrev_b32 v74, 16, v74
    v_cndmask_b32 v110, v110, v74, vcc
    v_cvt_pk_bf16_f32 v75, v75, v75
    v_lshlrev_b32 v75, 16, v75
    v_mul_f32 v75, v24, v75
    v_cvt_pk_bf16_f32 v75, v75, v75
    v_lshlrev_b32 v75, 16, v75
    v_cndmask_b32 v111, v111, v75, vcc
    v_cvt_pk_bf16_f32 v76, v76, v76
    v_lshlrev_b32 v76, 16, v76
    v_mul_f32 v76, v24, v76
    v_cvt_pk_bf16_f32 v76, v76, v76
    v_lshlrev_b32 v76, 16, v76
    v_cndmask_b32 v112, v112, v76, vcc
    v_cvt_pk_bf16_f32 v77, v77, v77
    v_lshlrev_b32 v77, 16, v77
    v_mul_f32 v77, v24, v77
    v_cvt_pk_bf16_f32 v77, v77, v77
    v_lshlrev_b32 v77, 16, v77
    v_cndmask_b32 v113, v113, v77, vcc
    v_cvt_pk_bf16_f32 v78, v78, v78
    v_lshlrev_b32 v78, 16, v78
    v_mul_f32 v78, v24, v78
    v_cvt_pk_bf16_f32 v78, v78, v78
    v_lshlrev_b32 v78, 16, v78
    v_cndmask_b32 v114, v114, v78, vcc
    v_cvt_pk_bf16_f32 v79, v79, v79
    v_lshlrev_b32 v79, 16, v79
    v_mul_f32 v79, v24, v79
    v_cvt_pk_bf16_f32 v79, v79, v79
    v_lshlrev_b32 v79, 16, v79
    v_cndmask_b32 v115, v115, v79, vcc
L_recurrent_scan__compressed_kv_cla__moe_arch_mod__prompt_kernel_rt_noy_3:
    s_sub_u32 s36, s57, s38
    s_cmp_lt_u32 s36, 16
    s_cbranch_scc0 L_recurrent_scan__compressed_kv_cla__moe_arch_mod__prompt_kernel_rt_noy_4
    s_lshl_b32 s37, s30, 8
    s_add_u32 s37, s37, 59772928
    v_and_b32 v22, 15, v1
    v_lshlrev_b32 v22, 13, v22
    v_lshl_add_u32 v22, v19, 4, v22
    buffer_load_dwordx4 v[64:67], v22, s[24:27], s37 offen offset:0 sc1
    buffer_load_dwordx4 v[68:71], v22, s[24:27], s37 offen offset:64 sc1
    buffer_load_dwordx4 v[72:75], v22, s[24:27], s37 offen offset:128 sc1
    buffer_load_dwordx4 v[76:79], v22, s[24:27], s37 offen offset:192 sc1
    s_and_b32 s36, s59, 0xffff0000
    s_cmp_lt_i32 s36, 0
    s_cselect_b32 s37, 0x80000000, -1
    s_xor_b32 s36, s36, s37
    s_and_b32 s36, s36, 0xffff0000
    v_mov_b32 v24, s36
    v_mul_f32 v24, 0xbfb8aa3b, v24
    v_exp_f32 v24, v24
    s_nop 0
    v_add_f32 v24, 1.0, v24
    v_rcp_f32 v24, v24
    s_nop 0
    v_cvt_pk_bf16_f32 v24, v24, v24
    v_lshlrev_b32 v24, 16, v24
    s_waitcnt vmcnt(0)
    v_add_f32_dpp v64, v64, v64 quad_perm:[1,0,3,2] row_mask:0xf bank_mask:0xf
    v_add_f32_dpp v65, v65, v65 quad_perm:[1,0,3,2] row_mask:0xf bank_mask:0xf
    v_add_f32_dpp v66, v66, v66 quad_perm:[1,0,3,2] row_mask:0xf bank_mask:0xf
    v_add_f32_dpp v67, v67, v67 quad_perm:[1,0,3,2] row_mask:0xf bank_mask:0xf
    v_add_f32_dpp v68, v68, v68 quad_perm:[1,0,3,2] row_mask:0xf bank_mask:0xf
    v_add_f32_dpp v69, v69, v69 quad_perm:[1,0,3,2] row_mask:0xf bank_mask:0xf
    v_add_f32_dpp v70, v70, v70 quad_perm:[1,0,3,2] row_mask:0xf bank_mask:0xf
    v_add_f32_dpp v71, v71, v71 quad_perm:[1,0,3,2] row_mask:0xf bank_mask:0xf
    v_add_f32_dpp v72, v72, v72 quad_perm:[1,0,3,2] row_mask:0xf bank_mask:0xf
    v_add_f32_dpp v73, v73, v73 quad_perm:[1,0,3,2] row_mask:0xf bank_mask:0xf
    v_add_f32_dpp v74, v74, v74 quad_perm:[1,0,3,2] row_mask:0xf bank_mask:0xf
    v_add_f32_dpp v75, v75, v75 quad_perm:[1,0,3,2] row_mask:0xf bank_mask:0xf
    v_add_f32_dpp v76, v76, v76 quad_perm:[1,0,3,2] row_mask:0xf bank_mask:0xf
    v_add_f32_dpp v77, v77, v77 quad_perm:[1,0,3,2] row_mask:0xf bank_mask:0xf
    v_add_f32_dpp v78, v78, v78 quad_perm:[1,0,3,2] row_mask:0xf bank_mask:0xf
    v_add_f32_dpp v79, v79, v79 quad_perm:[1,0,3,2] row_mask:0xf bank_mask:0xf
    v_add_f32_dpp v64, v64, v64 quad_perm:[2,3,0,1] row_mask:0xf bank_mask:0xf
    v_add_f32_dpp v65, v65, v65 quad_perm:[2,3,0,1] row_mask:0xf bank_mask:0xf
    v_add_f32_dpp v66, v66, v66 quad_perm:[2,3,0,1] row_mask:0xf bank_mask:0xf
    v_add_f32_dpp v67, v67, v67 quad_perm:[2,3,0,1] row_mask:0xf bank_mask:0xf
    v_add_f32_dpp v68, v68, v68 quad_perm:[2,3,0,1] row_mask:0xf bank_mask:0xf
    v_add_f32_dpp v69, v69, v69 quad_perm:[2,3,0,1] row_mask:0xf bank_mask:0xf
    v_add_f32_dpp v70, v70, v70 quad_perm:[2,3,0,1] row_mask:0xf bank_mask:0xf
    v_add_f32_dpp v71, v71, v71 quad_perm:[2,3,0,1] row_mask:0xf bank_mask:0xf
    v_add_f32_dpp v72, v72, v72 quad_perm:[2,3,0,1] row_mask:0xf bank_mask:0xf
    v_add_f32_dpp v73, v73, v73 quad_perm:[2,3,0,1] row_mask:0xf bank_mask:0xf
    v_add_f32_dpp v74, v74, v74 quad_perm:[2,3,0,1] row_mask:0xf bank_mask:0xf
    v_add_f32_dpp v75, v75, v75 quad_perm:[2,3,0,1] row_mask:0xf bank_mask:0xf
    v_add_f32_dpp v76, v76, v76 quad_perm:[2,3,0,1] row_mask:0xf bank_mask:0xf
    v_add_f32_dpp v77, v77, v77 quad_perm:[2,3,0,1] row_mask:0xf bank_mask:0xf
    v_add_f32_dpp v78, v78, v78 quad_perm:[2,3,0,1] row_mask:0xf bank_mask:0xf
    v_add_f32_dpp v79, v79, v79 quad_perm:[2,3,0,1] row_mask:0xf bank_mask:0xf
    v_add_f32_dpp v64, v64, v64 row_half_mirror row_mask:0xf bank_mask:0xf
    v_add_f32_dpp v65, v65, v65 row_half_mirror row_mask:0xf bank_mask:0xf
    v_add_f32_dpp v66, v66, v66 row_half_mirror row_mask:0xf bank_mask:0xf
    v_add_f32_dpp v67, v67, v67 row_half_mirror row_mask:0xf bank_mask:0xf
    v_add_f32_dpp v68, v68, v68 row_half_mirror row_mask:0xf bank_mask:0xf
    v_add_f32_dpp v69, v69, v69 row_half_mirror row_mask:0xf bank_mask:0xf
    v_add_f32_dpp v70, v70, v70 row_half_mirror row_mask:0xf bank_mask:0xf
    v_add_f32_dpp v71, v71, v71 row_half_mirror row_mask:0xf bank_mask:0xf
    v_add_f32_dpp v72, v72, v72 row_half_mirror row_mask:0xf bank_mask:0xf
    v_add_f32_dpp v73, v73, v73 row_half_mirror row_mask:0xf bank_mask:0xf
    v_add_f32_dpp v74, v74, v74 row_half_mirror row_mask:0xf bank_mask:0xf
    v_add_f32_dpp v75, v75, v75 row_half_mirror row_mask:0xf bank_mask:0xf
    v_add_f32_dpp v76, v76, v76 row_half_mirror row_mask:0xf bank_mask:0xf
    v_add_f32_dpp v77, v77, v77 row_half_mirror row_mask:0xf bank_mask:0xf
    v_add_f32_dpp v78, v78, v78 row_half_mirror row_mask:0xf bank_mask:0xf
    v_add_f32_dpp v79, v79, v79 row_half_mirror row_mask:0xf bank_mask:0xf
    v_add_f32_dpp v64, v64, v64 row_mirror row_mask:0xf bank_mask:0xf
    v_add_f32_dpp v65, v65, v65 row_mirror row_mask:0xf bank_mask:0xf
    v_add_f32_dpp v66, v66, v66 row_mirror row_mask:0xf bank_mask:0xf
    v_add_f32_dpp v67, v67, v67 row_mirror row_mask:0xf bank_mask:0xf
    v_add_f32_dpp v68, v68, v68 row_mirror row_mask:0xf bank_mask:0xf
    v_add_f32_dpp v69, v69, v69 row_mirror row_mask:0xf bank_mask:0xf
    v_add_f32_dpp v70, v70, v70 row_mirror row_mask:0xf bank_mask:0xf
    v_add_f32_dpp v71, v71, v71 row_mirror row_mask:0xf bank_mask:0xf
    v_add_f32_dpp v72, v72, v72 row_mirror row_mask:0xf bank_mask:0xf
    v_add_f32_dpp v73, v73, v73 row_mirror row_mask:0xf bank_mask:0xf
    v_add_f32_dpp v74, v74, v74 row_mirror row_mask:0xf bank_mask:0xf
    v_add_f32_dpp v75, v75, v75 row_mirror row_mask:0xf bank_mask:0xf
    v_add_f32_dpp v76, v76, v76 row_mirror row_mask:0xf bank_mask:0xf
    v_add_f32_dpp v77, v77, v77 row_mirror row_mask:0xf bank_mask:0xf
    v_add_f32_dpp v78, v78, v78 row_mirror row_mask:0xf bank_mask:0xf
    v_add_f32_dpp v79, v79, v79 row_mirror row_mask:0xf bank_mask:0xf
    v_cmp_eq_u32 vcc, s57, v14
    v_cvt_pk_bf16_f32 v64, v64, v64
    v_lshlrev_b32 v64, 16, v64
    v_mul_f32 v64, v24, v64
    v_cvt_pk_bf16_f32 v64, v64, v64
    v_lshlrev_b32 v64, 16, v64
    v_cndmask_b32 v100, v100, v64, vcc
    v_cvt_pk_bf16_f32 v65, v65, v65
    v_lshlrev_b32 v65, 16, v65
    v_mul_f32 v65, v24, v65
    v_cvt_pk_bf16_f32 v65, v65, v65
    v_lshlrev_b32 v65, 16, v65
    v_cndmask_b32 v101, v101, v65, vcc
    v_cvt_pk_bf16_f32 v66, v66, v66
    v_lshlrev_b32 v66, 16, v66
    v_mul_f32 v66, v24, v66
    v_cvt_pk_bf16_f32 v66, v66, v66
    v_lshlrev_b32 v66, 16, v66
    v_cndmask_b32 v102, v102, v66, vcc
    v_cvt_pk_bf16_f32 v67, v67, v67
    v_lshlrev_b32 v67, 16, v67
    v_mul_f32 v67, v24, v67
    v_cvt_pk_bf16_f32 v67, v67, v67
    v_lshlrev_b32 v67, 16, v67
    v_cndmask_b32 v103, v103, v67, vcc
    v_cvt_pk_bf16_f32 v68, v68, v68
    v_lshlrev_b32 v68, 16, v68
    v_mul_f32 v68, v24, v68
    v_cvt_pk_bf16_f32 v68, v68, v68
    v_lshlrev_b32 v68, 16, v68
    v_cndmask_b32 v104, v104, v68, vcc
    v_cvt_pk_bf16_f32 v69, v69, v69
    v_lshlrev_b32 v69, 16, v69
    v_mul_f32 v69, v24, v69
    v_cvt_pk_bf16_f32 v69, v69, v69
    v_lshlrev_b32 v69, 16, v69
    v_cndmask_b32 v105, v105, v69, vcc
    v_cvt_pk_bf16_f32 v70, v70, v70
    v_lshlrev_b32 v70, 16, v70
    v_mul_f32 v70, v24, v70
    v_cvt_pk_bf16_f32 v70, v70, v70
    v_lshlrev_b32 v70, 16, v70
    v_cndmask_b32 v106, v106, v70, vcc
    v_cvt_pk_bf16_f32 v71, v71, v71
    v_lshlrev_b32 v71, 16, v71
    v_mul_f32 v71, v24, v71
    v_cvt_pk_bf16_f32 v71, v71, v71
    v_lshlrev_b32 v71, 16, v71
    v_cndmask_b32 v107, v107, v71, vcc
    v_cvt_pk_bf16_f32 v72, v72, v72
    v_lshlrev_b32 v72, 16, v72
    v_mul_f32 v72, v24, v72
    v_cvt_pk_bf16_f32 v72, v72, v72
    v_lshlrev_b32 v72, 16, v72
    v_cndmask_b32 v108, v108, v72, vcc
    v_cvt_pk_bf16_f32 v73, v73, v73
    v_lshlrev_b32 v73, 16, v73
    v_mul_f32 v73, v24, v73
    v_cvt_pk_bf16_f32 v73, v73, v73
    v_lshlrev_b32 v73, 16, v73
    v_cndmask_b32 v109, v109, v73, vcc
    v_cvt_pk_bf16_f32 v74, v74, v74
    v_lshlrev_b32 v74, 16, v74
    v_mul_f32 v74, v24, v74
    v_cvt_pk_bf16_f32 v74, v74, v74
    v_lshlrev_b32 v74, 16, v74
    v_cndmask_b32 v110, v110, v74, vcc
    v_cvt_pk_bf16_f32 v75, v75, v75
    v_lshlrev_b32 v75, 16, v75
    v_mul_f32 v75, v24, v75
    v_cvt_pk_bf16_f32 v75, v75, v75
    v_lshlrev_b32 v75, 16, v75
    v_cndmask_b32 v111, v111, v75, vcc
    v_cvt_pk_bf16_f32 v76, v76, v76
    v_lshlrev_b32 v76, 16, v76
    v_mul_f32 v76, v24, v76
    v_cvt_pk_bf16_f32 v76, v76, v76
    v_lshlrev_b32 v76, 16, v76
    v_cndmask_b32 v112, v112, v76, vcc
    v_cvt_pk_bf16_f32 v77, v77, v77
    v_lshlrev_b32 v77, 16, v77
    v_mul_f32 v77, v24, v77
    v_cvt_pk_bf16_f32 v77, v77, v77
    v_lshlrev_b32 v77, 16, v77
    v_cndmask_b32 v113, v113, v77, vcc
    v_cvt_pk_bf16_f32 v78, v78, v78
    v_lshlrev_b32 v78, 16, v78
    v_mul_f32 v78, v24, v78
    v_cvt_pk_bf16_f32 v78, v78, v78
    v_lshlrev_b32 v78, 16, v78
    v_cndmask_b32 v114, v114, v78, vcc
    v_cvt_pk_bf16_f32 v79, v79, v79
    v_lshlrev_b32 v79, 16, v79
    v_mul_f32 v79, v24, v79
    v_cvt_pk_bf16_f32 v79, v79, v79
    v_lshlrev_b32 v79, 16, v79
    v_cndmask_b32 v115, v115, v79, vcc
L_recurrent_scan__compressed_kv_cla__moe_arch_mod__prompt_kernel_rt_noy_4:
    v_lshlrev_b32 v192, 16, v40
    v_and_b32 v193, 0xffff0000, v40
    v_sub_f32 v208, v192, v48
    v_sub_f32 v209, v193, v48
    v_cvt_pk_bf16_f32 v23, v208, v209
    v_lshlrev_b32 v208, 16, v23
    v_and_b32 v209, 0xffff0000, v23
    v_mul_f32 v208, v208, v49
    v_mul_f32 v209, v209, v49
    v_cvt_pk_bf16_f32 v23, v208, v209
    v_lshlrev_b32 v208, 16, v23
    v_and_b32 v209, 0xffff0000, v23
    v_add_f32 v208, v208, v100
    v_add_f32 v209, v209, v101
    v_cvt_pk_bf16_f32 v23, v208, v209
    v_lshlrev_b32 v208, 16, v23
    v_and_b32 v209, 0xffff0000, v23
    v_mul_f32 v24, 0xbfb8aa3b, v208
    v_mul_f32 v25, 0xbfb8aa3b, v209
    v_exp_f32 v24, v24
    v_exp_f32 v25, v25
    s_nop 0
    v_add_f32 v24, 1.0, v24
    v_add_f32 v25, 1.0, v25
    v_rcp_f32 v24, v24
    v_rcp_f32 v25, v25
    s_nop 0
    v_mul_f32 v208, v208, v24
    v_mul_f32 v209, v209, v25
    v_cvt_pk_bf16_f32 v23, v208, v209
    v_lshlrev_b32 v208, 16, v23
    v_and_b32 v209, 0xffff0000, v23
    v_lshlrev_b32 v194, 16, v41
    v_and_b32 v195, 0xffff0000, v41
    v_sub_f32 v210, v194, v48
    v_sub_f32 v211, v195, v48
    v_cvt_pk_bf16_f32 v23, v210, v211
    v_lshlrev_b32 v210, 16, v23
    v_and_b32 v211, 0xffff0000, v23
    v_mul_f32 v210, v210, v49
    v_mul_f32 v211, v211, v49
    v_cvt_pk_bf16_f32 v23, v210, v211
    v_lshlrev_b32 v210, 16, v23
    v_and_b32 v211, 0xffff0000, v23
    v_add_f32 v210, v210, v102
    v_add_f32 v211, v211, v103
    v_cvt_pk_bf16_f32 v23, v210, v211
    v_lshlrev_b32 v210, 16, v23
    v_and_b32 v211, 0xffff0000, v23
    v_mul_f32 v24, 0xbfb8aa3b, v210
    v_mul_f32 v25, 0xbfb8aa3b, v211
    v_exp_f32 v24, v24
    v_exp_f32 v25, v25
    s_nop 0
    v_add_f32 v24, 1.0, v24
    v_add_f32 v25, 1.0, v25
    v_rcp_f32 v24, v24
    v_rcp_f32 v25, v25
    s_nop 0
    v_mul_f32 v210, v210, v24
    v_mul_f32 v211, v211, v25
    v_cvt_pk_bf16_f32 v23, v210, v211
    v_lshlrev_b32 v210, 16, v23
    v_and_b32 v211, 0xffff0000, v23
    v_lshlrev_b32 v196, 16, v42
    v_and_b32 v197, 0xffff0000, v42
    v_sub_f32 v212, v196, v48
    v_sub_f32 v213, v197, v48
    v_cvt_pk_bf16_f32 v23, v212, v213
    v_lshlrev_b32 v212, 16, v23
    v_and_b32 v213, 0xffff0000, v23
    v_mul_f32 v212, v212, v49
    v_mul_f32 v213, v213, v49
    v_cvt_pk_bf16_f32 v23, v212, v213
    v_lshlrev_b32 v212, 16, v23
    v_and_b32 v213, 0xffff0000, v23
    v_add_f32 v212, v212, v104
    v_add_f32 v213, v213, v105
    v_cvt_pk_bf16_f32 v23, v212, v213
    v_lshlrev_b32 v212, 16, v23
    v_and_b32 v213, 0xffff0000, v23
    v_mul_f32 v24, 0xbfb8aa3b, v212
    v_mul_f32 v25, 0xbfb8aa3b, v213
    v_exp_f32 v24, v24
    v_exp_f32 v25, v25
    s_nop 0
    v_add_f32 v24, 1.0, v24
    v_add_f32 v25, 1.0, v25
    v_rcp_f32 v24, v24
    v_rcp_f32 v25, v25
    s_nop 0
    v_mul_f32 v212, v212, v24
    v_mul_f32 v213, v213, v25
    v_cvt_pk_bf16_f32 v23, v212, v213
    v_lshlrev_b32 v212, 16, v23
    v_and_b32 v213, 0xffff0000, v23
    v_lshlrev_b32 v198, 16, v43
    v_and_b32 v199, 0xffff0000, v43
    v_sub_f32 v214, v198, v48
    v_sub_f32 v215, v199, v48
    v_cvt_pk_bf16_f32 v23, v214, v215
    v_lshlrev_b32 v214, 16, v23
    v_and_b32 v215, 0xffff0000, v23
    v_mul_f32 v214, v214, v49
    v_mul_f32 v215, v215, v49
    v_cvt_pk_bf16_f32 v23, v214, v215
    v_lshlrev_b32 v214, 16, v23
    v_and_b32 v215, 0xffff0000, v23
    v_add_f32 v214, v214, v106
    v_add_f32 v215, v215, v107
    v_cvt_pk_bf16_f32 v23, v214, v215
    v_lshlrev_b32 v214, 16, v23
    v_and_b32 v215, 0xffff0000, v23
    v_mul_f32 v24, 0xbfb8aa3b, v214
    v_mul_f32 v25, 0xbfb8aa3b, v215
    v_exp_f32 v24, v24
    v_exp_f32 v25, v25
    s_nop 0
    v_add_f32 v24, 1.0, v24
    v_add_f32 v25, 1.0, v25
    v_rcp_f32 v24, v24
    v_rcp_f32 v25, v25
    s_nop 0
    v_mul_f32 v214, v214, v24
    v_mul_f32 v215, v215, v25
    v_cvt_pk_bf16_f32 v23, v214, v215
    v_lshlrev_b32 v214, 16, v23
    v_and_b32 v215, 0xffff0000, v23
    v_lshlrev_b32 v200, 16, v44
    v_and_b32 v201, 0xffff0000, v44
    v_sub_f32 v216, v200, v48
    v_sub_f32 v217, v201, v48
    v_cvt_pk_bf16_f32 v23, v216, v217
    v_lshlrev_b32 v216, 16, v23
    v_and_b32 v217, 0xffff0000, v23
    v_mul_f32 v216, v216, v49
    v_mul_f32 v217, v217, v49
    v_cvt_pk_bf16_f32 v23, v216, v217
    v_lshlrev_b32 v216, 16, v23
    v_and_b32 v217, 0xffff0000, v23
    v_add_f32 v216, v216, v108
    v_add_f32 v217, v217, v109
    v_cvt_pk_bf16_f32 v23, v216, v217
    v_lshlrev_b32 v216, 16, v23
    v_and_b32 v217, 0xffff0000, v23
    v_mul_f32 v24, 0xbfb8aa3b, v216
    v_mul_f32 v25, 0xbfb8aa3b, v217
    v_exp_f32 v24, v24
    v_exp_f32 v25, v25
    s_nop 0
    v_add_f32 v24, 1.0, v24
    v_add_f32 v25, 1.0, v25
    v_rcp_f32 v24, v24
    v_rcp_f32 v25, v25
    s_nop 0
    v_mul_f32 v216, v216, v24
    v_mul_f32 v217, v217, v25
    v_cvt_pk_bf16_f32 v23, v216, v217
    v_lshlrev_b32 v216, 16, v23
    v_and_b32 v217, 0xffff0000, v23
    v_lshlrev_b32 v202, 16, v45
    v_and_b32 v203, 0xffff0000, v45
    v_sub_f32 v218, v202, v48
    v_sub_f32 v219, v203, v48
    v_cvt_pk_bf16_f32 v23, v218, v219
    v_lshlrev_b32 v218, 16, v23
    v_and_b32 v219, 0xffff0000, v23
    v_mul_f32 v218, v218, v49
    v_mul_f32 v219, v219, v49
    v_cvt_pk_bf16_f32 v23, v218, v219
    v_lshlrev_b32 v218, 16, v23
    v_and_b32 v219, 0xffff0000, v23
    v_add_f32 v218, v218, v110
    v_add_f32 v219, v219, v111
    v_cvt_pk_bf16_f32 v23, v218, v219
    v_lshlrev_b32 v218, 16, v23
    v_and_b32 v219, 0xffff0000, v23
    v_mul_f32 v24, 0xbfb8aa3b, v218
    v_mul_f32 v25, 0xbfb8aa3b, v219
    v_exp_f32 v24, v24
    v_exp_f32 v25, v25
    s_nop 0
    v_add_f32 v24, 1.0, v24
    v_add_f32 v25, 1.0, v25
    v_rcp_f32 v24, v24
    v_rcp_f32 v25, v25
    s_nop 0
    v_mul_f32 v218, v218, v24
    v_mul_f32 v219, v219, v25
    v_cvt_pk_bf16_f32 v23, v218, v219
    v_lshlrev_b32 v218, 16, v23
    v_and_b32 v219, 0xffff0000, v23
    v_lshlrev_b32 v204, 16, v46
    v_and_b32 v205, 0xffff0000, v46
    v_sub_f32 v220, v204, v48
    v_sub_f32 v221, v205, v48
    v_cvt_pk_bf16_f32 v23, v220, v221
    v_lshlrev_b32 v220, 16, v23
    v_and_b32 v221, 0xffff0000, v23
    v_mul_f32 v220, v220, v49
    v_mul_f32 v221, v221, v49
    v_cvt_pk_bf16_f32 v23, v220, v221
    v_lshlrev_b32 v220, 16, v23
    v_and_b32 v221, 0xffff0000, v23
    v_add_f32 v220, v220, v112
    v_add_f32 v221, v221, v113
    v_cvt_pk_bf16_f32 v23, v220, v221
    v_lshlrev_b32 v220, 16, v23
    v_and_b32 v221, 0xffff0000, v23
    v_mul_f32 v24, 0xbfb8aa3b, v220
    v_mul_f32 v25, 0xbfb8aa3b, v221
    v_exp_f32 v24, v24
    v_exp_f32 v25, v25
    s_nop 0
    v_add_f32 v24, 1.0, v24
    v_add_f32 v25, 1.0, v25
    v_rcp_f32 v24, v24
    v_rcp_f32 v25, v25
    s_nop 0
    v_mul_f32 v220, v220, v24
    v_mul_f32 v221, v221, v25
    v_cvt_pk_bf16_f32 v23, v220, v221
    v_lshlrev_b32 v220, 16, v23
    v_and_b32 v221, 0xffff0000, v23
    v_lshlrev_b32 v206, 16, v47
    v_and_b32 v207, 0xffff0000, v47
    v_sub_f32 v222, v206, v48
    v_sub_f32 v223, v207, v48
    v_cvt_pk_bf16_f32 v23, v222, v223
    v_lshlrev_b32 v222, 16, v23
    v_and_b32 v223, 0xffff0000, v23
    v_mul_f32 v222, v222, v49
    v_mul_f32 v223, v223, v49
    v_cvt_pk_bf16_f32 v23, v222, v223
    v_lshlrev_b32 v222, 16, v23
    v_and_b32 v223, 0xffff0000, v23
    v_add_f32 v222, v222, v114
    v_add_f32 v223, v223, v115
    v_cvt_pk_bf16_f32 v23, v222, v223
    v_lshlrev_b32 v222, 16, v23
    v_and_b32 v223, 0xffff0000, v23
    v_mul_f32 v24, 0xbfb8aa3b, v222
    v_mul_f32 v25, 0xbfb8aa3b, v223
    v_exp_f32 v24, v24
    v_exp_f32 v25, v25
    s_nop 0
    v_add_f32 v24, 1.0, v24
    v_add_f32 v25, 1.0, v25
    v_rcp_f32 v24, v24
    v_rcp_f32 v25, v25
    s_nop 0
    v_mul_f32 v222, v222, v24
    v_mul_f32 v223, v223, v25
    v_cvt_pk_bf16_f32 v23, v222, v223
    v_lshlrev_b32 v222, 16, v23
    v_and_b32 v223, 0xffff0000, v23
    s_branch L_recurrent_scan__compressed_kv_cla__moe_arch_mod__prompt_kernel_back_181
L_end:
    s_endpgm
.section .rodata,"a"
.p2align 6
.amdhsa_kernel recurrent_scan__compressed_kv_cla__moe_arch_mod__prompt_kernel
  .amdhsa_next_free_vgpr 256
  .amdhsa_next_free_sgpr 102
  .amdhsa_accum_offset 256
  .amdhsa_group_segment_fixed_size 0
  .amdhsa_kernarg_size 112
  .amdhsa_user_sgpr_count 2
  .amdhsa_user_sgpr_kernarg_segment_ptr 1
  .amdhsa_system_sgpr_workgroup_id_x 1
.end_amdhsa_kernel
```

```asm
; @launch kernel=recurrent_scan__compressed_kv_cla__moe_arch_mod__prompt_kernel grid=(256,1,1) block=(512,1,1) lds=163840
.amdgcn_target "amdgcn-amd-amdhsa--gfx950"
.text
.globl recurrent_scan__compressed_kv_cla__moe_arch_mod__prompt_kernel
.p2align 8
.type recurrent_scan__compressed_kv_cla__moe_arch_mod__prompt_kernel,@function
recurrent_scan__compressed_kv_cla__moe_arch_mod__prompt_kernel:
    s_cmp_ge_u32 s2, 256
    s_cbranch_scc1 L_end
    s_load_dwordx4 s[44:47], s[0:1], 0
    s_load_dwordx4 s[48:51], s[0:1], 24
    s_load_dwordx2 s[52:53], s[0:1], 56
    s_load_dwordx4 s[88:91], s[0:1], 96
    s_load_dwordx4 s[92:95], s[0:1], 64
    s_load_dwordx2 s[96:97], s[0:1], 16
    s_load_dwordx2 s[24:25], s[0:1], 40
    s_load_dwordx4 s[4:7], s[0:1], 80
    v_and_b32 v1, 63, v0
    v_lshrrev_b32 v16, 6, v0
    s_and_b32 s29, s2, 7
    v_readfirstlane_b32 s28, v16
    s_lshl_b32 s29, s29, 2
    s_bfe_u32 s36, s2, 0x20003
    s_add_u32 s29, s29, s36
    s_lshr_b32 s30, s2, 5
    v_lshrrev_b32 v16, 3, v1
    s_lshl_b32 s36, s30, 8
    s_lshl_b32 s37, s28, 5
    s_add_u32 s36, s36, s37
    v_add_u32 v16, s36, v16
    v_lshlrev_b32 v16, 10, v16
    v_lshrrev_b32 v18, 4, v1
    v_and_b32 v19, 7, v1
    v_xor_b32 v19, v19, v18
    v_lshl_add_u32 v2, v19, 4, v16
    v_xor_b32 v19, 4, v19
    v_lshl_add_u32 v3, v19, 4, v16
    v_add_u32 v3, 7168, v3
    v_add_u32 v4, 14336, v2
    v_add_u32 v5, 14336, v3
    s_and_b32 s36, s28, 3
    s_lshl_b32 s37, s36, 4
    v_add_u32 v16, s37, v18
    v_lshlrev_b32 v16, 13, v16
    s_lshl_b32 s37, s29, 8
    v_add_u32 v16, s37, v16
    v_and_b32 v19, 15, v1
    v_lshlrev_b32 v18, 1, v18
    v_xor_b32 v19, v19, v18
    v_lshl_add_u32 v6, v19, 4, v16
    v_add_u32 v7, 31744, v6
    v_xor_b32 v19, 8, v19
    v_lshl_add_u32 v8, v19, 4, v16
    v_add_u32 v8, 63488, v8
    v_add_u32 v9, 31744, v8
    s_lshl_b32 s33, s28, 12
    s_add_u32 s34, s33, 65536
    s_mov_b32 s31, 0
    s_mov_b32 s32, 0
    s_mov_b32 s40, 128
    s_mov_b32 s41, 524288
    s_cmp_lt_u32 s28, 4
    s_cbranch_scc0 L_pro_b
    s_waitcnt lgkmcnt(0)
    s_mov_b32 s4, s46
    s_and_b32 s5, s47, 0xffff
    s_mov_b32 s6, 2097152
    s_mov_b32 s7, 0x20000
    s_mov_b32 s8, s48
    s_and_b32 s9, s49, 0xffff
    s_mov_b32 s10, 4194304
    s_mov_b32 s11, 0x20000
    s_mov_b32 s20, s50
    s_and_b32 s21, s51, 0xffff
    s_mov_b32 s22, 4194304
    s_mov_b32 s23, 0x20000
    s_barrier
    s_cmp_eq_u32 s2, 0
    s_cbranch_scc1 L_recurrent_scan__compressed_kv_cla__moe_arch_mod__prompt_kernel_rare_1
L_recurrent_scan__compressed_kv_cla__moe_arch_mod__prompt_kernel_back_2:
    s_add_u32 m0, s33, 0
    s_add_u32 s36, s31, 131072
    buffer_load_dwordx4 v2, s[4:7], s31 offen offset:0 lds
    buffer_load_dwordx4 v3, s[4:7], s31 offen offset:1024 lds
    buffer_load_dwordx4 v4, s[4:7], s31 offen offset:2048 lds
    buffer_load_dwordx4 v5, s[4:7], s31 offen offset:3072 lds
    s_add_u32 m0, s34, 0
    s_nop 0
    buffer_load_dwordx4 v6, s[8:11], s32 offen offset:0 nt lds
    buffer_load_dwordx4 v7, s[8:11], s32 offen offset:1024 nt lds
    buffer_load_dwordx4 v8, s[8:11], s32 offen offset:2048 nt lds
    buffer_load_dwordx4 v9, s[8:11], s32 offen offset:3072 nt lds
    s_add_u32 m0, s33, 16384
    s_nop 0
    buffer_load_dwordx4 v2, s[4:7], s36 offen offset:0 lds
    buffer_load_dwordx4 v3, s[4:7], s36 offen offset:1024 lds
    buffer_load_dwordx4 v4, s[4:7], s36 offen offset:2048 lds
    buffer_load_dwordx4 v5, s[4:7], s36 offen offset:3072 lds
    s_add_u32 m0, s34, 16384
    s_nop 0
    buffer_load_dwordx4 v6, s[20:23], s32 offen offset:0 nt lds
    buffer_load_dwordx4 v7, s[20:23], s32 offen offset:1024 nt lds
    buffer_load_dwordx4 v8, s[20:23], s32 offen offset:2048 nt lds
    buffer_load_dwordx4 v9, s[20:23], s32 offen offset:3072 nt lds
    s_add_u32 s31, s31, s40
    s_add_u32 s32, s32, s41
    s_add_u32 s54, s90, 0
    s_addc_u32 s55, s91, 0
    s_add_u32 s12, s54, 8388608
    s_addc_u32 s13, s55, 0
    s_and_b32 s13, s13, 0xffff
    s_mov_b32 s14, 33554432
    s_mov_b32 s15, 0x20000
    s_mov_b32 s24, s54
    s_and_b32 s25, s55, 0xffff
    s_mov_b32 s26, 83886080
    s_mov_b32 s27, 0x20000
    s_add_u32 s90, s54, 61865984
    s_addc_u32 s91, s55, 0
    v_and_b32 v16, 15, v1
    v_lshrrev_b32 v17, 4, v1
    s_bfe_u32 s36, s28, 0x10001
    s_lshl_b32 s36, s36, 14
    v_lshl_add_u32 v18, v16, 7, s36
    v_lshrrev_b32 v19, 1, v16
    v_xor_b32 v19, v19, v17
    v_lshl_add_u32 v10, v19, 4, v18
    v_xor_b32 v19, 4, v19
    v_lshl_add_u32 v11, v19, 4, v18
    v_lshrrev_b32 v16, 2, v16
    v_lshl_add_u32 v18, v17, 3, v16
    v_lshlrev_b32 v18, 8, v18
    s_lshr_b32 s36, s28, 2
    s_lshl_b32 s36, s36, 14
    s_add_u32 s36, s36, 65536
    v_add_u32 v18, s36, v18
    v_and_b32 v19, 3, v1
    v_lshl_add_u32 v18, v19, 3, v18
    v_and_b32 v17, 1, v17
    v_lshl_add_u32 v16, v17, 2, v16
    s_and_b32 s36, s28, 1
    s_lshl_b32 s36, s36, 2
    s_add_u32 s37, s36, 0
    v_xor_b32 v19, s37, v16
    v_lshl_add_u32 v12, v19, 5, v18
    s_add_u32 s37, s36, 1
    v_xor_b32 v19, s37, v16
    v_lshl_add_u32 v13, v19, 5, v18
    s_add_u32 s37, s36, 2
    v_xor_b32 v19, s37, v16
    v_lshl_add_u32 v14, v19, 5, v18
    s_add_u32 s37, s36, 3
    v_xor_b32 v19, s37, v16
    v_lshl_add_u32 v15, v19, 5, v18
    v_mov_b32 v128, 0
    v_mov_b32 v129, 0
    v_mov_b32 v130, 0
    v_mov_b32 v131, 0
    v_mov_b32 v132, 0
    v_mov_b32 v133, 0
    v_mov_b32 v134, 0
    v_mov_b32 v135, 0
    v_mov_b32 v136, 0
    v_mov_b32 v137, 0
    v_mov_b32 v138, 0
    v_mov_b32 v139, 0
    v_mov_b32 v140, 0
    v_mov_b32 v141, 0
    v_mov_b32 v142, 0
    v_mov_b32 v143, 0
    v_mov_b32 v144, 0
    v_mov_b32 v145, 0
    v_mov_b32 v146, 0
    v_mov_b32 v147, 0
    v_mov_b32 v148, 0
    v_mov_b32 v149, 0
    v_mov_b32 v150, 0
    v_mov_b32 v151, 0
    v_mov_b32 v152, 0
    v_mov_b32 v153, 0
    v_mov_b32 v154, 0
    v_mov_b32 v155, 0
    v_mov_b32 v156, 0
    v_mov_b32 v157, 0
    v_mov_b32 v158, 0
    v_mov_b32 v159, 0
    v_mov_b32 v160, 0
    v_mov_b32 v161, 0
    v_mov_b32 v162, 0
    v_mov_b32 v163, 0
    v_mov_b32 v164, 0
    v_mov_b32 v165, 0
    v_mov_b32 v166, 0
    v_mov_b32 v167, 0
    v_mov_b32 v168, 0
    v_mov_b32 v169, 0
    v_mov_b32 v170, 0
    v_mov_b32 v171, 0
    v_mov_b32 v172, 0
    v_mov_b32 v173, 0
    v_mov_b32 v174, 0
    v_mov_b32 v175, 0
    v_mov_b32 v176, 0
    v_mov_b32 v177, 0
    v_mov_b32 v178, 0
    v_mov_b32 v179, 0
    v_mov_b32 v180, 0
    v_mov_b32 v181, 0
    v_mov_b32 v182, 0
    v_mov_b32 v183, 0
    v_mov_b32 v184, 0
    v_mov_b32 v185, 0
    v_mov_b32 v186, 0
    v_mov_b32 v187, 0
    v_mov_b32 v188, 0
    v_mov_b32 v189, 0
    v_mov_b32 v190, 0
    v_mov_b32 v191, 0
    v_mov_b32 v192, 0
    v_mov_b32 v193, 0
    v_mov_b32 v194, 0
    v_mov_b32 v195, 0
    v_mov_b32 v196, 0
    v_mov_b32 v197, 0
    v_mov_b32 v198, 0
    v_mov_b32 v199, 0
    v_mov_b32 v200, 0
    v_mov_b32 v201, 0
    v_mov_b32 v202, 0
    v_mov_b32 v203, 0
    v_mov_b32 v204, 0
    v_mov_b32 v205, 0
    v_mov_b32 v206, 0
    v_mov_b32 v207, 0
    v_mov_b32 v208, 0
    v_mov_b32 v209, 0
    v_mov_b32 v210, 0
    v_mov_b32 v211, 0
    v_mov_b32 v212, 0
    v_mov_b32 v213, 0
    v_mov_b32 v214, 0
    v_mov_b32 v215, 0
    v_mov_b32 v216, 0
    v_mov_b32 v217, 0
    v_mov_b32 v218, 0
    v_mov_b32 v219, 0
    v_mov_b32 v220, 0
    v_mov_b32 v221, 0
    v_mov_b32 v222, 0
    v_mov_b32 v223, 0
    v_mov_b32 v224, 0
    v_mov_b32 v225, 0
    v_mov_b32 v226, 0
    v_mov_b32 v227, 0
    v_mov_b32 v228, 0
    v_mov_b32 v229, 0
    v_mov_b32 v230, 0
    v_mov_b32 v231, 0
    v_mov_b32 v232, 0
    v_mov_b32 v233, 0
    v_mov_b32 v234, 0
    v_mov_b32 v235, 0
    v_mov_b32 v236, 0
    v_mov_b32 v237, 0
    v_mov_b32 v238, 0
    v_mov_b32 v239, 0
    v_mov_b32 v240, 0
    v_mov_b32 v241, 0
    v_mov_b32 v242, 0
    v_mov_b32 v243, 0
    v_mov_b32 v244, 0
    v_mov_b32 v245, 0
    v_mov_b32 v246, 0
    v_mov_b32 v247, 0
    v_mov_b32 v248, 0
    v_mov_b32 v249, 0
    v_mov_b32 v250, 0
    v_mov_b32 v251, 0
    v_mov_b32 v252, 0
    v_mov_b32 v253, 0
    v_mov_b32 v254, 0
    v_mov_b32 v255, 0
    v_mov_b32 v118, 0
    v_mov_b32 v117, 0
    s_lshl_b32 s36, s30, 7
    s_lshl_b32 s37, s28, 4
    s_add_u32 s36, s36, s37
    v_bfe_u32 v17, v1, 1, 2
    v_add_u32 v17, s36, v17
    v_lshlrev_b32 v17, 13, v17
    v_and_b32 v19, 1, v1
    v_lshl_add_u32 v17, v19, 7, v17
    s_lshl_b32 s36, s29, 8
    v_add_u32 v17, s36, v17
    s_mov_b32 s45, 32768
    s_add_u32 m0, s33, 32768
    s_add_u32 s36, s31, 131072
    buffer_load_dwordx4 v2, s[4:7], s31 offen offset:0 lds
    buffer_load_dwordx4 v3, s[4:7], s31 offen offset:1024 lds
    buffer_load_dwordx4 v4, s[4:7], s31 offen offset:2048 lds
    buffer_load_dwordx4 v5, s[4:7], s31 offen offset:3072 lds
    s_add_u32 m0, s34, 32768
    s_nop 0
    buffer_load_dwordx4 v6, s[8:11], s32 offen offset:0 nt lds
    buffer_load_dwordx4 v7, s[8:11], s32 offen offset:1024 nt lds
    buffer_load_dwordx4 v8, s[8:11], s32 offen offset:2048 nt lds
    buffer_load_dwordx4 v9, s[8:11], s32 offen offset:3072 nt lds
    s_add_u32 m0, s33, 49152
    s_nop 0
    buffer_load_dwordx4 v2, s[4:7], s36 offen offset:0 lds
    buffer_load_dwordx4 v3, s[4:7], s36 offen offset:1024 lds
    buffer_load_dwordx4 v4, s[4:7], s36 offen offset:2048 lds
    buffer_load_dwordx4 v5, s[4:7], s36 offen offset:3072 lds
    s_add_u32 m0, s34, 49152
    s_nop 0
    buffer_load_dwordx4 v6, s[20:23], s32 offen offset:0 nt lds
    buffer_load_dwordx4 v7, s[20:23], s32 offen offset:1024 nt lds
    buffer_load_dwordx4 v8, s[20:23], s32 offen offset:2048 nt lds
    buffer_load_dwordx4 v9, s[20:23], s32 offen offset:3072 nt lds
    s_add_u32 s31, s31, s40
    s_add_u32 s32, s32, s41
    s_waitcnt vmcnt(16)
    s_branch L_pro_j
L_pro_b:
    s_and_b32 s60, s28, 3
    s_add_u32 s61, s60, 4
    s_lshl_b32 s42, s2, 3
    s_add_u32 s42, s42, s60
    s_add_u32 s43, s42, 4
    v_lshlrev_b32 v116, 4, v1
    s_lshl_b32 s36, s42, 11
    s_add_u32 s37, s36, 8192
    s_waitcnt lgkmcnt(0)
    s_mov_b32 s16, s44
    s_and_b32 s17, s45, 0xffff
    s_mov_b32 s18, 4194304
    s_mov_b32 s19, 0x20000
    s_mov_b32 s20, s52
    s_and_b32 s21, s53, 0xffff
    s_mov_b32 s22, 2048
    s_mov_b32 s23, 0x20000
    buffer_load_dwordx4 v[20:23], v116, s[16:19], s36 offen
    buffer_load_dwordx4 v[24:27], v116, s[16:19], s36 offen offset:1024
    buffer_load_dwordx4 v[28:31], v116, s[16:19], s37 offen
    buffer_load_dwordx4 v[32:35], v116, s[16:19], s37 offen offset:1024
    buffer_load_dwordx4 v[36:39], v116, s[20:23], 0 offen
    buffer_load_dwordx4 v[40:43], v116, s[20:23], 0 offen offset:1024
    s_barrier
    s_lshr_b32 s58, s2, 3
    s_and_b32 s59, s58, 7
    s_add_u32 s57, s58, 32
    s_cmp_eq_u32 s28, 4
    s_cbranch_scc0 L_recurrent_scan__compressed_kv_cla__moe_arch_mod__prompt_kernel_swn_4
    s_lshl_b32 s36, s58, 21
    s_min_u32 s36, s36, 75497468
    s_add_u32 s38, s90, s36
    s_addc_u32 s39, s91, 0
    s_load_dword s98, s[38:39], 0
    s_lshl_b32 s36, s57, 21
    s_min_u32 s36, s36, 75497468
    s_add_u32 s38, s90, s36
    s_addc_u32 s39, s91, 0
    s_load_dword s99, s[38:39], 0
    s_branch L_recurrent_scan__compressed_kv_cla__moe_arch_mod__prompt_kernel_swend_3
L_recurrent_scan__compressed_kv_cla__moe_arch_mod__prompt_kernel_swn_4:
    s_cmp_eq_u32 s28, 5
    s_cbranch_scc0 L_recurrent_scan__compressed_kv_cla__moe_arch_mod__prompt_kernel_swn_5
    s_lshl_b32 s36, s59, 21
    s_min_u32 s36, s36, 4194300
    s_add_u32 s38, s48, s36
    s_addc_u32 s39, s49, 0
    s_load_dword s98, s[38:39], 0
    s_lshl_b32 s36, s59, 21
    s_min_u32 s36, s36, 4194300
    s_add_u32 s38, s50, s36
    s_addc_u32 s39, s51, 0
    s_load_dword s99, s[38:39], 0
    s_lshl_b32 s36, s59, 21
    s_min_u32 s36, s36, 8388604
    s_add_u32 s38, s96, s36
    s_addc_u32 s39, s97, 0
    s_load_dword s3, s[38:39], 0
    s_lshl_b32 s36, s59, 21
    s_min_u32 s36, s36, 2097148
    s_add_u32 s38, s46, s36
    s_addc_u32 s39, s47, 0
    s_load_dword s35, s[38:39], 0
    s_branch L_recurrent_scan__compressed_kv_cla__moe_arch_mod__prompt_kernel_swend_3
L_recurrent_scan__compressed_kv_cla__moe_arch_mod__prompt_kernel_swn_5:
    s_cmp_eq_u32 s28, 6
    s_cbranch_scc0 L_recurrent_scan__compressed_kv_cla__moe_arch_mod__prompt_kernel_swn_6
    s_lshl_b32 s36, s59, 21
    s_min_u32 s36, s36, 7340028
    s_add_u32 s38, s92, s36
    s_addc_u32 s39, s93, 0
    s_load_dword s98, s[38:39], 0
    s_lshl_b32 s36, s59, 21
    s_min_u32 s36, s36, 7340028
    s_add_u32 s38, s94, s36
    s_addc_u32 s39, s95, 0
    s_load_dword s99, s[38:39], 0
    s_lshl_b32 s36, s59, 21
    s_min_u32 s36, s36, 4194300
    s_add_u32 s38, s44, s36
    s_addc_u32 s39, s45, 0
    s_load_dword s3, s[38:39], 0
    s_branch L_recurrent_scan__compressed_kv_cla__moe_arch_mod__prompt_kernel_swend_3
L_recurrent_scan__compressed_kv_cla__moe_arch_mod__prompt_kernel_swn_6:
    s_lshl_b32 s36, s59, 21
    s_min_u32 s36, s36, 8388604
    s_add_u32 s38, s24, s36
    s_addc_u32 s39, s25, 0
    s_load_dword s98, s[38:39], 0
    s_lshl_b32 s36, s59, 21
    s_min_u32 s36, s36, 7340028
    s_add_u32 s38, s4, s36
    s_addc_u32 s39, s5, 0
    s_load_dword s99, s[38:39], 0
    s_lshl_b32 s36, s59, 21
    s_min_u32 s36, s36, 4194300
    s_add_u32 s38, s6, s36
    s_addc_u32 s39, s7, 0
    s_load_dword s3, s[38:39], 0
L_recurrent_scan__compressed_kv_cla__moe_arch_mod__prompt_kernel_swend_3:
    s_mov_b32 s4, s46
    s_and_b32 s5, s47, 0xffff
    s_mov_b32 s6, 2097152
    s_mov_b32 s7, 0x20000
    s_mov_b32 s8, s50
    s_and_b32 s9, s51, 0xffff
    s_mov_b32 s10, 4194304
    s_mov_b32 s11, 0x20000
    s_mov_b32 s31, 256
    s_mov_b32 s32, 1048576
    s_add_u32 s54, s90, 0
    s_addc_u32 s55, s91, 0
    s_add_u32 s12, s54, 8388608
    s_addc_u32 s13, s55, 0
    s_and_b32 s13, s13, 0xffff
    s_mov_b32 s14, 33554432
    s_mov_b32 s15, 0x20000
    s_mov_b32 s24, s54
    s_and_b32 s25, s55, 0xffff
    s_mov_b32 s26, 83886080
    s_mov_b32 s27, 0x20000
    s_add_u32 s90, s54, 61865984
    s_addc_u32 s91, s55, 0
    v_and_b32 v16, 15, v1
    v_lshrrev_b32 v17, 4, v1
    s_bfe_u32 s36, s28, 0x10001
    s_lshl_b32 s36, s36, 14
    v_lshl_add_u32 v18, v16, 7, s36
    v_lshrrev_b32 v19, 1, v16
    v_xor_b32 v19, v19, v17
    v_lshl_add_u32 v10, v19, 4, v18
    v_xor_b32 v19, 4, v19
    v_lshl_add_u32 v11, v19, 4, v18
    v_lshrrev_b32 v16, 2, v16
    v_lshl_add_u32 v18, v17, 3, v16
    v_lshlrev_b32 v18, 8, v18
    s_lshr_b32 s36, s28, 2
    s_lshl_b32 s36, s36, 14
    s_add_u32 s36, s36, 65536
    v_add_u32 v18, s36, v18
    v_and_b32 v19, 3, v1
    v_lshl_add_u32 v18, v19, 3, v18
    v_and_b32 v17, 1, v17
    v_lshl_add_u32 v16, v17, 2, v16
    s_and_b32 s36, s28, 1
    s_lshl_b32 s36, s36, 2
    s_add_u32 s37, s36, 0
    v_xor_b32 v19, s37, v16
    v_lshl_add_u32 v12, v19, 5, v18
    s_add_u32 s37, s36, 1
    v_xor_b32 v19, s37, v16
    v_lshl_add_u32 v13, v19, 5, v18
    s_add_u32 s37, s36, 2
    v_xor_b32 v19, s37, v16
    v_lshl_add_u32 v14, v19, 5, v18
    s_add_u32 s37, s36, 3
    v_xor_b32 v19, s37, v16
    v_lshl_add_u32 v15, v19, 5, v18
    v_mov_b32 v128, 0
    v_mov_b32 v129, 0
    v_mov_b32 v130, 0
    v_mov_b32 v131, 0
    v_mov_b32 v132, 0
    v_mov_b32 v133, 0
    v_mov_b32 v134, 0
    v_mov_b32 v135, 0
    v_mov_b32 v136, 0
    v_mov_b32 v137, 0
    v_mov_b32 v138, 0
    v_mov_b32 v139, 0
    v_mov_b32 v140, 0
    v_mov_b32 v141, 0
    v_mov_b32 v142, 0
    v_mov_b32 v143, 0
    v_mov_b32 v144, 0
    v_mov_b32 v145, 0
    v_mov_b32 v146, 0
    v_mov_b32 v147, 0
    v_mov_b32 v148, 0
    v_mov_b32 v149, 0
    v_mov_b32 v150, 0
    v_mov_b32 v151, 0
    v_mov_b32 v152, 0
    v_mov_b32 v153, 0
    v_mov_b32 v154, 0
    v_mov_b32 v155, 0
    v_mov_b32 v156, 0
    v_mov_b32 v157, 0
    v_mov_b32 v158, 0
    v_mov_b32 v159, 0
    v_mov_b32 v160, 0
    v_mov_b32 v161, 0
    v_mov_b32 v162, 0
    v_mov_b32 v163, 0
    v_mov_b32 v164, 0
    v_mov_b32 v165, 0
    v_mov_b32 v166, 0
    v_mov_b32 v167, 0
    v_mov_b32 v168, 0
    v_mov_b32 v169, 0
    v_mov_b32 v170, 0
    v_mov_b32 v171, 0
    v_mov_b32 v172, 0
    v_mov_b32 v173, 0
    v_mov_b32 v174, 0
    v_mov_b32 v175, 0
    v_mov_b32 v176, 0
    v_mov_b32 v177, 0
    v_mov_b32 v178, 0
    v_mov_b32 v179, 0
    v_mov_b32 v180, 0
    v_mov_b32 v181, 0
    v_mov_b32 v182, 0
    v_mov_b32 v183, 0
    v_mov_b32 v184, 0
    v_mov_b32 v185, 0
    v_mov_b32 v186, 0
    v_mov_b32 v187, 0
    v_mov_b32 v188, 0
    v_mov_b32 v189, 0
    v_mov_b32 v190, 0
    v_mov_b32 v191, 0
    v_mov_b32 v192, 0
    v_mov_b32 v193, 0
    v_mov_b32 v194, 0
    v_mov_b32 v195, 0
    v_mov_b32 v196, 0
    v_mov_b32 v197, 0
    v_mov_b32 v198, 0
    v_mov_b32 v199, 0
    v_mov_b32 v200, 0
    v_mov_b32 v201, 0
    v_mov_b32 v202, 0
    v_mov_b32 v203, 0
    v_mov_b32 v204, 0
    v_mov_b32 v205, 0
    v_mov_b32 v206, 0
    v_mov_b32 v207, 0
    v_mov_b32 v208, 0
    v_mov_b32 v209, 0
    v_mov_b32 v210, 0
    v_mov_b32 v211, 0
    v_mov_b32 v212, 0
    v_mov_b32 v213, 0
    v_mov_b32 v214, 0
    v_mov_b32 v215, 0
    v_mov_b32 v216, 0
    v_mov_b32 v217, 0
    v_mov_b32 v218, 0
    v_mov_b32 v219, 0
    v_mov_b32 v220, 0
    v_mov_b32 v221, 0
    v_mov_b32 v222, 0
    v_mov_b32 v223, 0
    v_mov_b32 v224, 0
    v_mov_b32 v225, 0
    v_mov_b32 v226, 0
    v_mov_b32 v227, 0
    v_mov_b32 v228, 0
    v_mov_b32 v229, 0
    v_mov_b32 v230, 0
    v_mov_b32 v231, 0
    v_mov_b32 v232, 0
    v_mov_b32 v233, 0
    v_mov_b32 v234, 0
    v_mov_b32 v235, 0
    v_mov_b32 v236, 0
    v_mov_b32 v237, 0
    v_mov_b32 v238, 0
    v_mov_b32 v239, 0
    v_mov_b32 v240, 0
    v_mov_b32 v241, 0
    v_mov_b32 v242, 0
    v_mov_b32 v243, 0
    v_mov_b32 v244, 0
    v_mov_b32 v245, 0
    v_mov_b32 v246, 0
    v_mov_b32 v247, 0
    v_mov_b32 v248, 0
    v_mov_b32 v249, 0
    v_mov_b32 v250, 0
    v_mov_b32 v251, 0
    v_mov_b32 v252, 0
    v_mov_b32 v253, 0
    v_mov_b32 v254, 0
    v_mov_b32 v255, 0
    v_mov_b32 v118, 0
    v_mov_b32 v117, 0
    s_lshl_b32 s36, s30, 7
    s_lshl_b32 s37, s28, 4
    s_add_u32 s36, s36, s37
    v_bfe_u32 v17, v1, 1, 2
    v_add_u32 v17, s36, v17
    v_lshlrev_b32 v17, 13, v17
    v_and_b32 v19, 1, v1
    v_lshl_add_u32 v17, v19, 7, v17
    s_lshl_b32 s36, s29, 8
    v_add_u32 v17, s36, v17
    s_mov_b32 s45, 32768
    s_waitcnt vmcnt(0)
    v_lshlrev_b32 v44, 16, v36
    v_and_b32 v45, 0xffff0000, v36
    v_lshlrev_b32 v46, 16, v37
    v_and_b32 v47, 0xffff0000, v37
    v_lshlrev_b32 v48, 16, v38
    v_and_b32 v49, 0xffff0000, v38
    v_lshlrev_b32 v50, 16, v39
    v_and_b32 v51, 0xffff0000, v39
    v_lshlrev_b32 v52, 16, v40
    v_and_b32 v53, 0xffff0000, v40
    v_lshlrev_b32 v54, 16, v41
    v_and_b32 v55, 0xffff0000, v41
    v_lshlrev_b32 v56, 16, v42
    v_and_b32 v57, 0xffff0000, v42
    v_lshlrev_b32 v58, 16, v43
    v_and_b32 v59, 0xffff0000, v43
    v_lshlrev_b32 v60, 16, v20
    v_lshlrev_b32 v76, 16, v28
    v_and_b32 v61, 0xffff0000, v20
    v_and_b32 v77, 0xffff0000, v28
    v_lshlrev_b32 v62, 16, v21
    v_lshlrev_b32 v78, 16, v29
    v_and_b32 v63, 0xffff0000, v21
    v_and_b32 v79, 0xffff0000, v29
    v_lshlrev_b32 v64, 16, v22
    v_lshlrev_b32 v80, 16, v30
    v_and_b32 v65, 0xffff0000, v22
    v_and_b32 v81, 0xffff0000, v30
    v_lshlrev_b32 v66, 16, v23
    v_lshlrev_b32 v82, 16, v31
    v_and_b32 v67, 0xffff0000, v23
    v_and_b32 v83, 0xffff0000, v31
    v_lshlrev_b32 v68, 16, v24
    v_lshlrev_b32 v84, 16, v32
    v_and_b32 v69, 0xffff0000, v24
    v_and_b32 v85, 0xffff0000, v32
    v_lshlrev_b32 v70, 16, v25
    v_lshlrev_b32 v86, 16, v33
    v_and_b32 v71, 0xffff0000, v25
    v_and_b32 v87, 0xffff0000, v33
    v_lshlrev_b32 v72, 16, v26
    v_lshlrev_b32 v88, 16, v34
    v_and_b32 v73, 0xffff0000, v26
    v_and_b32 v89, 0xffff0000, v34
    v_lshlrev_b32 v74, 16, v27
    v_lshlrev_b32 v90, 16, v35
    v_and_b32 v75, 0xffff0000, v27
    v_and_b32 v91, 0xffff0000, v35
    v_add_f32 v92, v60, v61
    v_add_f32 v100, v76, v77
    v_add_f32 v92, v92, v62
    v_add_f32 v100, v100, v78
    v_add_f32 v92, v92, v63
    v_add_f32 v100, v100, v79
    v_add_f32 v92, v92, v64
    v_add_f32 v100, v100, v80
    v_add_f32 v92, v92, v65
    v_add_f32 v100, v100, v81
    v_add_f32 v92, v92, v66
    v_add_f32 v100, v100, v82
    v_add_f32 v92, v92, v67
    v_add_f32 v100, v100, v83
    v_add_f32 v92, v92, v68
    v_add_f32 v100, v100, v84
    v_add_f32 v92, v92, v69
    v_add_f32 v100, v100, v85
    v_add_f32 v92, v92, v70
    v_add_f32 v100, v100, v86
    v_add_f32 v92, v92, v71
    v_add_f32 v100, v100, v87
    v_add_f32 v92, v92, v72
    v_add_f32 v100, v100, v88
    v_add_f32 v92, v92, v73
    v_add_f32 v100, v100, v89
    v_add_f32 v92, v92, v74
    v_add_f32 v100, v100, v90
    v_add_f32 v92, v92, v75
    v_add_f32 v100, v100, v91
    s_nop 0
    v_add_f32_dpp v92, v92, v92 quad_perm:[1,0,3,2] row_mask:0xf bank_mask:0xf
    v_add_f32_dpp v100, v100, v100 quad_perm:[1,0,3,2] row_mask:0xf bank_mask:0xf
    s_nop 0
    v_add_f32_dpp v92, v92, v92 quad_perm:[2,3,0,1] row_mask:0xf bank_mask:0xf
    v_add_f32_dpp v100, v100, v100 quad_perm:[2,3,0,1] row_mask:0xf bank_mask:0xf
    s_nop 0
    v_add_f32_dpp v92, v92, v92 row_half_mirror row_mask:0xf bank_mask:0xf
    v_add_f32_dpp v100, v100, v100 row_half_mirror row_mask:0xf bank_mask:0xf
    s_nop 0
    v_add_f32_dpp v92, v92, v92 row_mirror row_mask:0xf bank_mask:0xf
    v_add_f32_dpp v100, v100, v100 row_mirror row_mask:0xf bank_mask:0xf
    v_readlane_b32 s36, v92, 0
    v_readlane_b32 s56, v100, 0
    v_readlane_b32 s37, v92, 16
    v_readlane_b32 s57, v100, 16
    v_readlane_b32 s38, v92, 32
    v_readlane_b32 s58, v100, 32
    v_readlane_b32 s39, v92, 48
    v_readlane_b32 s59, v100, 48
    v_mov_b32 v93, s36
    v_mov_b32 v101, s56
    v_add_f32 v93, s37, v93
    v_add_f32 v101, s57, v101
    v_add_f32 v93, s38, v93
    v_add_f32 v101, s58, v101
    v_add_f32 v93, s39, v93
    v_add_f32 v101, s59, v101
    v_mul_f32 v93, 0x3a800000, v93
    v_mul_f32 v101, 0x3a800000, v101
    v_sub_f32 v94, v60, v93
    v_sub_f32 v102, v76, v101
    v_mul_f32 v92, v94, v94
    v_mul_f32 v100, v102, v102
    v_sub_f32 v94, v61, v93
    v_sub_f32 v102, v77, v101
    v_fmac_f32 v92, v94, v94
    v_fmac_f32 v100, v102, v102
    v_sub_f32 v94, v62, v93
    v_sub_f32 v102, v78, v101
    v_fmac_f32 v92, v94, v94
    v_fmac_f32 v100, v102, v102
    v_sub_f32 v94, v63, v93
    v_sub_f32 v102, v79, v101
    v_fmac_f32 v92, v94, v94
    v_fmac_f32 v100, v102, v102
    v_sub_f32 v94, v64, v93
    v_sub_f32 v102, v80, v101
    v_fmac_f32 v92, v94, v94
    v_fmac_f32 v100, v102, v102
    v_sub_f32 v94, v65, v93
    v_sub_f32 v102, v81, v101
    v_fmac_f32 v92, v94, v94
    v_fmac_f32 v100, v102, v102
    v_sub_f32 v94, v66, v93
    v_sub_f32 v102, v82, v101
    v_fmac_f32 v92, v94, v94
    v_fmac_f32 v100, v102, v102
    v_sub_f32 v94, v67, v93
    v_sub_f32 v102, v83, v101
    v_fmac_f32 v92, v94, v94
    v_fmac_f32 v100, v102, v102
    v_sub_f32 v94, v68, v93
    v_sub_f32 v102, v84, v101
    v_fmac_f32 v92, v94, v94
    v_fmac_f32 v100, v102, v102
    v_sub_f32 v94, v69, v93
    v_sub_f32 v102, v85, v101
    v_fmac_f32 v92, v94, v94
    v_fmac_f32 v100, v102, v102
    v_sub_f32 v94, v70, v93
    v_sub_f32 v102, v86, v101
    v_fmac_f32 v92, v94, v94
    v_fmac_f32 v100, v102, v102
    v_sub_f32 v94, v71, v93
    v_sub_f32 v102, v87, v101
    v_fmac_f32 v92, v94, v94
    v_fmac_f32 v100, v102, v102
    v_sub_f32 v94, v72, v93
    v_sub_f32 v102, v88, v101
    v_fmac_f32 v92, v94, v94
    v_fmac_f32 v100, v102, v102
    v_sub_f32 v94, v73, v93
    v_sub_f32 v102, v89, v101
    v_fmac_f32 v92, v94, v94
    v_fmac_f32 v100, v102, v102
    v_sub_f32 v94, v74, v93
    v_sub_f32 v102, v90, v101
    v_fmac_f32 v92, v94, v94
    v_fmac_f32 v100, v102, v102
    v_sub_f32 v94, v75, v93
    v_sub_f32 v102, v91, v101
    v_fmac_f32 v92, v94, v94
    v_fmac_f32 v100, v102, v102
    s_nop 0
    v_add_f32_dpp v92, v92, v92 quad_perm:[1,0,3,2] row_mask:0xf bank_mask:0xf
    v_add_f32_dpp v100, v100, v100 quad_perm:[1,0,3,2] row_mask:0xf bank_mask:0xf
    s_nop 0
    v_add_f32_dpp v92, v92, v92 quad_perm:[2,3,0,1] row_mask:0xf bank_mask:0xf
    v_add_f32_dpp v100, v100, v100 quad_perm:[2,3,0,1] row_mask:0xf bank_mask:0xf
    s_nop 0
    v_add_f32_dpp v92, v92, v92 row_half_mirror row_mask:0xf bank_mask:0xf
    v_add_f32_dpp v100, v100, v100 row_half_mirror row_mask:0xf bank_mask:0xf
    s_nop 0
    v_add_f32_dpp v92, v92, v92 row_mirror row_mask:0xf bank_mask:0xf
    v_add_f32_dpp v100, v100, v100 row_mirror row_mask:0xf bank_mask:0xf
    v_readlane_b32 s36, v92, 0
    v_readlane_b32 s56, v100, 0
    v_readlane_b32 s37, v92, 16
    v_readlane_b32 s57, v100, 16
    v_readlane_b32 s38, v92, 32
    v_readlane_b32 s58, v100, 32
    v_readlane_b32 s39, v92, 48
    v_readlane_b32 s59, v100, 48
    v_mov_b32 v94, s36
    v_mov_b32 v102, s56
    v_add_f32 v94, s37, v94
    v_add_f32 v102, s57, v102
    v_add_f32 v94, s38, v94
    v_add_f32 v102, s58, v102
    v_add_f32 v94, s39, v94
    v_add_f32 v102, s59, v102
    v_mul_f32 v94, 0x3a800000, v94
    v_mul_f32 v102, 0x3a800000, v102
    v_cvt_pk_bf16_f32 v95, v93, v94
    v_cvt_pk_bf16_f32 v103, v101, v102
    v_lshlrev_b32 v98, 16, v95
    v_lshlrev_b32 v106, 16, v103
    v_and_b32 v94, 0xffff0000, v95
    v_and_b32 v102, 0xffff0000, v103
    v_add_f32 v94, 0x3727c5ac, v94
    v_add_f32 v102, 0x3727c5ac, v102
    v_cvt_pk_bf16_f32 v94, v94, v94
    v_cvt_pk_bf16_f32 v102, v102, v102
    v_lshlrev_b32 v94, 16, v94
    v_lshlrev_b32 v102, 16, v102
    v_sqrt_f32 v94, v94
    v_sqrt_f32 v102, v102
    v_cvt_pk_bf16_f32 v94, v94, v94
    v_cvt_pk_bf16_f32 v102, v102, v102
    v_lshlrev_b32 v94, 16, v94
    v_lshlrev_b32 v102, 16, v102
    v_rcp_f32 v99, v94
    v_rcp_f32 v107, v102
    v_fma_f32 v96, -v94, v99, 1.0
    v_fma_f32 v104, -v102, v107, 1.0
    v_fma_f32 v99, v96, v99, v99
    v_fma_f32 v107, v104, v107, v107
    v_sub_f32 v60, v60, v98
    v_sub_f32 v76, v76, v106
    v_sub_f32 v61, v61, v98
    v_sub_f32 v77, v77, v106
    v_cvt_pk_bf16_f32 v96, v60, v61
    v_cvt_pk_bf16_f32 v104, v76, v77
    v_lshlrev_b32 v60, 16, v96
    v_lshlrev_b32 v76, 16, v104
    v_and_b32 v61, 0xffff0000, v96
    v_and_b32 v77, 0xffff0000, v104
    v_mul_f32 v60, v60, v99
    v_mul_f32 v76, v76, v107
    v_mul_f32 v61, v61, v99
    v_mul_f32 v77, v77, v107
    v_cvt_pk_bf16_f32 v20, v60, v61
    v_cvt_pk_bf16_f32 v28, v76, v77
    v_lshlrev_b32 v60, 16, v20
    v_lshlrev_b32 v76, 16, v28
    v_and_b32 v61, 0xffff0000, v20
    v_and_b32 v77, 0xffff0000, v28
    v_mul_f32 v92, v60, v44
    v_mul_f32 v100, v76, v44
    v_fmac_f32 v92, v61, v45
    v_fmac_f32 v100, v77, v45
    v_sub_f32 v62, v62, v98
    v_sub_f32 v78, v78, v106
    v_sub_f32 v63, v63, v98
    v_sub_f32 v79, v79, v106
    v_cvt_pk_bf16_f32 v96, v62, v63
    v_cvt_pk_bf16_f32 v104, v78, v79
    v_lshlrev_b32 v62, 16, v96
    v_lshlrev_b32 v78, 16, v104
    v_and_b32 v63, 0xffff0000, v96
    v_and_b32 v79, 0xffff0000, v104
    v_mul_f32 v62, v62, v99
    v_mul_f32 v78, v78, v107
    v_mul_f32 v63, v63, v99
    v_mul_f32 v79, v79, v107
    v_cvt_pk_bf16_f32 v21, v62, v63
    v_cvt_pk_bf16_f32 v29, v78, v79
    v_lshlrev_b32 v62, 16, v21
    v_lshlrev_b32 v78, 16, v29
    v_and_b32 v63, 0xffff0000, v21
    v_and_b32 v79, 0xffff0000, v29
    v_fmac_f32 v92, v62, v46
    v_fmac_f32 v100, v78, v46
    v_fmac_f32 v92, v63, v47
    v_fmac_f32 v100, v79, v47
    v_sub_f32 v64, v64, v98
    v_sub_f32 v80, v80, v106
    v_sub_f32 v65, v65, v98
    v_sub_f32 v81, v81, v106
    v_cvt_pk_bf16_f32 v96, v64, v65
    v_cvt_pk_bf16_f32 v104, v80, v81
    v_lshlrev_b32 v64, 16, v96
    v_lshlrev_b32 v80, 16, v104
    v_and_b32 v65, 0xffff0000, v96
    v_and_b32 v81, 0xffff0000, v104
    v_mul_f32 v64, v64, v99
    v_mul_f32 v80, v80, v107
    v_mul_f32 v65, v65, v99
    v_mul_f32 v81, v81, v107
    v_cvt_pk_bf16_f32 v22, v64, v65
    v_cvt_pk_bf16_f32 v30, v80, v81
    v_lshlrev_b32 v64, 16, v22
    v_lshlrev_b32 v80, 16, v30
    v_and_b32 v65, 0xffff0000, v22
    v_and_b32 v81, 0xffff0000, v30
    v_fmac_f32 v92, v64, v48
    v_fmac_f32 v100, v80, v48
    v_fmac_f32 v92, v65, v49
    v_fmac_f32 v100, v81, v49
    v_sub_f32 v66, v66, v98
    v_sub_f32 v82, v82, v106
    v_sub_f32 v67, v67, v98
    v_sub_f32 v83, v83, v106
    v_cvt_pk_bf16_f32 v96, v66, v67
    v_cvt_pk_bf16_f32 v104, v82, v83
    v_lshlrev_b32 v66, 16, v96
    v_lshlrev_b32 v82, 16, v104
    v_and_b32 v67, 0xffff0000, v96
    v_and_b32 v83, 0xffff0000, v104
    v_mul_f32 v66, v66, v99
    v_mul_f32 v82, v82, v107
    v_mul_f32 v67, v67, v99
    v_mul_f32 v83, v83, v107
    v_cvt_pk_bf16_f32 v23, v66, v67
    v_cvt_pk_bf16_f32 v31, v82, v83
    v_lshlrev_b32 v66, 16, v23
    v_lshlrev_b32 v82, 16, v31
    v_and_b32 v67, 0xffff0000, v23
    v_and_b32 v83, 0xffff0000, v31
    v_fmac_f32 v92, v66, v50
    v_fmac_f32 v100, v82, v50
    v_fmac_f32 v92, v67, v51
    v_fmac_f32 v100, v83, v51
    v_sub_f32 v68, v68, v98
    v_sub_f32 v84, v84, v106
    v_sub_f32 v69, v69, v98
    v_sub_f32 v85, v85, v106
    v_cvt_pk_bf16_f32 v96, v68, v69
    v_cvt_pk_bf16_f32 v104, v84, v85
    v_lshlrev_b32 v68, 16, v96
    v_lshlrev_b32 v84, 16, v104
    v_and_b32 v69, 0xffff0000, v96
    v_and_b32 v85, 0xffff0000, v104
    v_mul_f32 v68, v68, v99
    v_mul_f32 v84, v84, v107
    v_mul_f32 v69, v69, v99
    v_mul_f32 v85, v85, v107
    v_cvt_pk_bf16_f32 v24, v68, v69
    v_cvt_pk_bf16_f32 v32, v84, v85
    v_lshlrev_b32 v68, 16, v24
    v_lshlrev_b32 v84, 16, v32
    v_and_b32 v69, 0xffff0000, v24
    v_and_b32 v85, 0xffff0000, v32
    v_fmac_f32 v92, v68, v52
    v_fmac_f32 v100, v84, v52
    v_fmac_f32 v92, v69, v53
    v_fmac_f32 v100, v85, v53
    v_sub_f32 v70, v70, v98
    v_sub_f32 v86, v86, v106
    v_sub_f32 v71, v71, v98
    v_sub_f32 v87, v87, v106
    v_cvt_pk_bf16_f32 v96, v70, v71
    v_cvt_pk_bf16_f32 v104, v86, v87
    v_lshlrev_b32 v70, 16, v96
    v_lshlrev_b32 v86, 16, v104
    v_and_b32 v71, 0xffff0000, v96
    v_and_b32 v87, 0xffff0000, v104
    v_mul_f32 v70, v70, v99
    v_mul_f32 v86, v86, v107
    v_mul_f32 v71, v71, v99
    v_mul_f32 v87, v87, v107
    v_cvt_pk_bf16_f32 v25, v70, v71
    v_cvt_pk_bf16_f32 v33, v86, v87
    v_lshlrev_b32 v70, 16, v25
    v_lshlrev_b32 v86, 16, v33
    v_and_b32 v71, 0xffff0000, v25
    v_and_b32 v87, 0xffff0000, v33
    v_fmac_f32 v92, v70, v54
    v_fmac_f32 v100, v86, v54
    v_fmac_f32 v92, v71, v55
    v_fmac_f32 v100, v87, v55
    v_sub_f32 v72, v72, v98
    v_sub_f32 v88, v88, v106
    v_sub_f32 v73, v73, v98
    v_sub_f32 v89, v89, v106
    v_cvt_pk_bf16_f32 v96, v72, v73
    v_cvt_pk_bf16_f32 v104, v88, v89
    v_lshlrev_b32 v72, 16, v96
    v_lshlrev_b32 v88, 16, v104
    v_and_b32 v73, 0xffff0000, v96
    v_and_b32 v89, 0xffff0000, v104
    v_mul_f32 v72, v72, v99
    v_mul_f32 v88, v88, v107
    v_mul_f32 v73, v73, v99
    v_mul_f32 v89, v89, v107
    v_cvt_pk_bf16_f32 v26, v72, v73
    v_cvt_pk_bf16_f32 v34, v88, v89
    v_lshlrev_b32 v72, 16, v26
    v_lshlrev_b32 v88, 16, v34
    v_and_b32 v73, 0xffff0000, v26
    v_and_b32 v89, 0xffff0000, v34
    v_fmac_f32 v92, v72, v56
    v_fmac_f32 v100, v88, v56
    v_fmac_f32 v92, v73, v57
    v_fmac_f32 v100, v89, v57
    v_sub_f32 v74, v74, v98
    v_sub_f32 v90, v90, v106
    v_sub_f32 v75, v75, v98
    v_sub_f32 v91, v91, v106
    v_cvt_pk_bf16_f32 v96, v74, v75
    v_cvt_pk_bf16_f32 v104, v90, v91
    v_lshlrev_b32 v74, 16, v96
    v_lshlrev_b32 v90, 16, v104
    v_and_b32 v75, 0xffff0000, v96
    v_and_b32 v91, 0xffff0000, v104
    v_mul_f32 v74, v74, v99
    v_mul_f32 v90, v90, v107
    v_mul_f32 v75, v75, v99
    v_mul_f32 v91, v91, v107
    v_cvt_pk_bf16_f32 v27, v74, v75
    v_cvt_pk_bf16_f32 v35, v90, v91
    v_lshlrev_b32 v74, 16, v27
    v_lshlrev_b32 v90, 16, v35
    v_and_b32 v75, 0xffff0000, v27
    v_and_b32 v91, 0xffff0000, v35
    v_fmac_f32 v92, v74, v58
    v_fmac_f32 v100, v90, v58
    v_fmac_f32 v92, v75, v59
    v_fmac_f32 v100, v91, v59
    s_mul_i32 s36, s60, 2064
    s_mul_i32 s56, s61, 2064
    s_add_u32 s36, s36, 131072
    s_add_u32 s56, s56, 131072
    v_lshl_add_u32 v95, v1, 4, s36
    v_lshl_add_u32 v103, v1, 4, s56
    ds_write_b128 v95, v[20:23]
    ds_write_b128 v103, v[28:31]
    ds_write_b128 v95, v[24:27] offset:1024
    ds_write_b128 v103, v[32:35] offset:1024
    s_nop 0
    v_add_f32_dpp v92, v92, v92 quad_perm:[1,0,3,2] row_mask:0xf bank_mask:0xf
    v_add_f32_dpp v100, v100, v100 quad_perm:[1,0,3,2] row_mask:0xf bank_mask:0xf
    s_nop 0
    v_add_f32_dpp v92, v92, v92 quad_perm:[2,3,0,1] row_mask:0xf bank_mask:0xf
    v_add_f32_dpp v100, v100, v100 quad_perm:[2,3,0,1] row_mask:0xf bank_mask:0xf
    s_nop 0
    v_add_f32_dpp v92, v92, v92 row_half_mirror row_mask:0xf bank_mask:0xf
    v_add_f32_dpp v100, v100, v100 row_half_mirror row_mask:0xf bank_mask:0xf
    s_nop 0
    v_add_f32_dpp v92, v92, v92 row_mirror row_mask:0xf bank_mask:0xf
    v_add_f32_dpp v100, v100, v100 row_mirror row_mask:0xf bank_mask:0xf
    v_readlane_b32 s36, v92, 0
    v_readlane_b32 s56, v100, 0
    v_readlane_b32 s37, v92, 16
    v_readlane_b32 s57, v100, 16
    v_readlane_b32 s38, v92, 32
    v_readlane_b32 s58, v100, 32
    v_readlane_b32 s39, v92, 48
    v_readlane_b32 s59, v100, 48
    v_mov_b32 v93, s36
    v_mov_b32 v101, s56
    v_add_f32 v93, s37, v93
    v_add_f32 v101, s57, v101
    v_add_f32 v93, s38, v93
    v_add_f32 v101, s58, v101
    v_add_f32 v93, s39, v93
    v_add_f32 v101, s59, v101
    v_cvt_pk_bf16_f32 v93, v93, v93
    v_cvt_pk_bf16_f32 v101, v101, v101
    v_lshlrev_b32 v93, 16, v93
    v_lshlrev_b32 v101, 16, v101
    v_ashrrev_i32 v95, 31, v93
    v_ashrrev_i32 v103, 31, v101
    v_or_b32 v95, 0x80000000, v95
    v_or_b32 v103, 0x80000000, v103
    v_xor_b32 v95, v93, v95
    v_xor_b32 v103, v101, v103
    v_and_b32 v95, 0xffff0000, v95
    v_and_b32 v103, 0xffff0000, v103
    s_sub_u32 s36, 0xffff, s42
    s_sub_u32 s56, 0xffff, s43
    v_or_b32 v95, s36, v95
    v_or_b32 v103, s56, v103
    s_lshl_b32 s37, s60, 3
    s_lshl_b32 s57, s61, 3
    s_add_u32 s37, s37, 147712
    s_add_u32 s57, s57, 147712
    v_mov_b32 v94, s37
    v_mov_b32 v102, s57
    ds_write_b64 v94, v[98:99]
    ds_write_b64 v102, v[106:107]
    ds_write_b32 v94, v95 offset:64
    ds_write_b32 v102, v103 offset:64
    s_waitcnt lgkmcnt(0)
L_pro_j:
    s_barrier
    ds_read_b128 v[20:23], v10 offset:0
    ds_read_b64_tr_b16 v[52:53], v12 offset:0
    ds_read_b64_tr_b16 v[54:55], v12 offset:1024
    ds_read_b64_tr_b16 v[56:57], v13 offset:0
    ds_read_b64_tr_b16 v[58:59], v13 offset:1024
    ds_read_b64_tr_b16 v[60:61], v14 offset:0
    ds_read_b64_tr_b16 v[62:63], v14 offset:1024
    ds_read_b64_tr_b16 v[64:65], v15 offset:0
    ds_read_b64_tr_b16 v[66:67], v15 offset:1024
    ds_read_b128 v[24:27], v10 offset:2048
    ds_read_b128 v[28:31], v10 offset:4096
    ds_read_b128 v[32:35], v10 offset:6144
    ds_read_b128 v[36:39], v10 offset:8192
    ds_read_b128 v[40:43], v10 offset:10240
    ds_read_b128 v[44:47], v10 offset:12288
    ds_read_b128 v[48:51], v10 offset:14336
    s_add_u32 s36, s2, s28
    s_cmp_eq_u32 s36, 0
    s_cbranch_scc1 L_recurrent_scan__compressed_kv_cla__moe_arch_mod__prompt_kernel_rare_7
L_recurrent_scan__compressed_kv_cla__moe_arch_mod__prompt_kernel_back_8:
    v_and_b32 v100, 7, v1
    v_lshrrev_b32 v101, 3, v1
    v_mul_u32_u24 v102, 2064, v100
    v_lshl_add_u32 v102, v101, 4, v102
    s_lshl_b32 s36, s28, 8
    s_add_u32 s36, s36, 131072
    v_add_u32 v102, s36, v102
    ds_read_b128 v[120:123], v102
    ds_read_b128 v[124:127], v102 offset:128
    v_lshlrev_b32 v100, 4, v100
    v_lshl_add_u32 v100, v101, 8, v100
    s_lshr_b32 s36, s2, 1
    s_lshl_b32 s36, s36, 15
    s_and_b32 s37, s2, 1
    s_lshl_b32 s37, s37, 7
    s_add_u32 s36, s36, s37
    s_lshl_b32 s37, s28, 12
    s_add_u32 s36, s36, s37
    s_waitcnt lgkmcnt(0)
    buffer_store_dwordx4 v[120:123], v100, s[24:27], s36 offen sc1
    buffer_store_dwordx4 v[124:127], v100, s[24:27], s36 offen offset:2048 sc1
    s_cmp_eq_u32 s28, 7
    s_cbranch_scc1 L_recurrent_scan__compressed_kv_cla__moe_arch_mod__prompt_kernel_rare_9
L_recurrent_scan__compressed_kv_cla__moe_arch_mod__prompt_kernel_back_10:
    s_mov_b32 s35, 0
    s_cmp_eq_u32 s28, 0
    s_cselect_b32 s43, 9, 0
    s_cselect_b32 s44, 2, 1
    s_cmp_lt_u32 s28, 4
    s_cbranch_scc0 L_kv_vloop
    .p2align 6
L_kv_kloop:
    s_waitcnt lgkmcnt(0)
    v_mfma_f32_16x16x32_bf16 v[128:131], v[52:55], v[20:23], v[128:131]
    ds_read_b128 v[68:71], v11 offset:0
    v_mfma_f32_16x16x32_bf16 v[132:135], v[56:59], v[20:23], v[132:135]
    ds_read_b64_tr_b16 v[100:101], v12 offset:8192
    v_mfma_f32_16x16x32_bf16 v[136:139], v[60:63], v[20:23], v[136:139]
    ds_read_b64_tr_b16 v[102:103], v12 offset:9216
    v_mfma_f32_16x16x32_bf16 v[140:143], v[64:67], v[20:23], v[140:143]
    ds_read_b64_tr_b16 v[104:105], v13 offset:8192
    v_mfma_f32_16x16x32_bf16 v[144:147], v[52:55], v[24:27], v[144:147]
    ds_read_b64_tr_b16 v[106:107], v13 offset:9216
    v_mfma_f32_16x16x32_bf16 v[148:151], v[56:59], v[24:27], v[148:151]
    ds_read_b64_tr_b16 v[108:109], v14 offset:8192
    v_mfma_f32_16x16x32_bf16 v[152:155], v[60:63], v[24:27], v[152:155]
    ds_read_b64_tr_b16 v[110:111], v14 offset:9216
    v_mfma_f32_16x16x32_bf16 v[156:159], v[64:67], v[24:27], v[156:159]
    ds_read_b64_tr_b16 v[112:113], v15 offset:8192
    v_mfma_f32_16x16x32_bf16 v[160:163], v[52:55], v[28:31], v[160:163]
    ds_read_b64_tr_b16 v[114:115], v15 offset:9216
    v_mfma_f32_16x16x32_bf16 v[164:167], v[56:59], v[28:31], v[164:167]
    ds_read_b128 v[72:75], v11 offset:2048
    v_mfma_f32_16x16x32_bf16 v[168:171], v[60:63], v[28:31], v[168:171]
    ds_read_b128 v[76:79], v11 offset:4096
    v_mfma_f32_16x16x32_bf16 v[172:175], v[64:67], v[28:31], v[172:175]
    ds_read_b128 v[80:83], v11 offset:6144
    v_mfma_f32_16x16x32_bf16 v[176:179], v[52:55], v[32:35], v[176:179]
    ds_read_b128 v[84:87], v11 offset:8192
    v_mfma_f32_16x16x32_bf16 v[180:183], v[56:59], v[32:35], v[180:183]
    ds_read_b128 v[88:91], v11 offset:10240
    v_mfma_f32_16x16x32_bf16 v[184:187], v[60:63], v[32:35], v[184:187]
    ds_read_b128 v[92:95], v11 offset:12288
    v_mfma_f32_16x16x32_bf16 v[188:191], v[64:67], v[32:35], v[188:191]
    ds_read_b128 v[96:99], v11 offset:14336
    v_mfma_f32_16x16x32_bf16 v[192:195], v[52:55], v[36:39], v[192:195]
    v_mfma_f32_16x16x32_bf16 v[196:199], v[56:59], v[36:39], v[196:199]
    v_mfma_f32_16x16x32_bf16 v[200:203], v[60:63], v[36:39], v[200:203]
    v_mfma_f32_16x16x32_bf16 v[204:207], v[64:67], v[36:39], v[204:207]
    v_mfma_f32_16x16x32_bf16 v[208:211], v[52:55], v[40:43], v[208:211]
    v_mfma_f32_16x16x32_bf16 v[212:215], v[56:59], v[40:43], v[212:215]
    v_mfma_f32_16x16x32_bf16 v[216:219], v[60:63], v[40:43], v[216:219]
    v_mfma_f32_16x16x32_bf16 v[220:223], v[64:67], v[40:43], v[220:223]
    v_mfma_f32_16x16x32_bf16 v[224:227], v[52:55], v[44:47], v[224:227]
    v_mfma_f32_16x16x32_bf16 v[228:231], v[56:59], v[44:47], v[228:231]
    v_mfma_f32_16x16x32_bf16 v[232:235], v[60:63], v[44:47], v[232:235]
    v_mfma_f32_16x16x32_bf16 v[236:239], v[64:67], v[44:47], v[236:239]
    v_mfma_f32_16x16x32_bf16 v[240:243], v[52:55], v[48:51], v[240:243]
    v_mfma_f32_16x16x32_bf16 v[244:247], v[56:59], v[48:51], v[244:247]
    v_mfma_f32_16x16x32_bf16 v[248:251], v[60:63], v[48:51], v[248:251]
    v_mfma_f32_16x16x32_bf16 v[252:255], v[64:67], v[48:51], v[252:255]
    s_cmp_eq_u32 s35, 3
    s_cbranch_scc1 L_recurrent_scan__compressed_kv_cla__moe_arch_mod__prompt_kernel_rare_11
L_recurrent_scan__compressed_kv_cla__moe_arch_mod__prompt_kernel_back_12:
    s_cmp_lt_u32 s35, s44
    s_cbranch_scc1 L_recurrent_scan__compressed_kv_cla__moe_arch_mod__prompt_kernel_w0_13
    s_waitcnt vmcnt(1)
L_recurrent_scan__compressed_kv_cla__moe_arch_mod__prompt_kernel_w0b_14:
    s_waitcnt lgkmcnt(0)
    s_barrier
    v_mfma_f32_16x16x32_bf16 v[128:131], v[100:103], v[68:71], v[128:131]
    ds_read_b128 v[20:23], v10 offset:32768
    s_add_u32 m0, s33, 0
    v_mfma_f32_16x16x32_bf16 v[132:135], v[104:107], v[68:71], v[132:135]
    ds_read_b64_tr_b16 v[52:53], v12 offset:32768
    buffer_load_dwordx4 v2, s[4:7], s31 offen offset:0 lds
    v_mfma_f32_16x16x32_bf16 v[136:139], v[108:111], v[68:71], v[136:139]
    ds_read_b64_tr_b16 v[54:55], v12 offset:33792
    v_mfma_f32_16x16x32_bf16 v[140:143], v[112:115], v[68:71], v[140:143]
    ds_read_b64_tr_b16 v[56:57], v13 offset:32768
    v_mfma_f32_16x16x32_bf16 v[144:147], v[100:103], v[72:75], v[144:147]
    ds_read_b64_tr_b16 v[58:59], v13 offset:33792
    buffer_load_dwordx4 v3, s[4:7], s31 offen offset:1024 lds
    v_mfma_f32_16x16x32_bf16 v[148:151], v[104:107], v[72:75], v[148:151]
    ds_read_b64_tr_b16 v[60:61], v14 offset:32768
    v_mfma_f32_16x16x32_bf16 v[152:155], v[108:111], v[72:75], v[152:155]
    ds_read_b64_tr_b16 v[62:63], v14 offset:33792
    v_mfma_f32_16x16x32_bf16 v[156:159], v[112:115], v[72:75], v[156:159]
    ds_read_b64_tr_b16 v[64:65], v15 offset:32768
    buffer_load_dwordx4 v4, s[4:7], s31 offen offset:2048 lds
    v_mfma_f32_16x16x32_bf16 v[160:163], v[100:103], v[76:79], v[160:163]
    ds_read_b64_tr_b16 v[66:67], v15 offset:33792
    v_mfma_f32_16x16x32_bf16 v[164:167], v[104:107], v[76:79], v[164:167]
    ds_read_b128 v[24:27], v10 offset:34816
    v_mfma_f32_16x16x32_bf16 v[168:171], v[108:111], v[76:79], v[168:171]
    ds_read_b128 v[28:31], v10 offset:36864
    buffer_load_dwordx4 v5, s[4:7], s31 offen offset:3072 lds
    v_mfma_f32_16x16x32_bf16 v[172:175], v[112:115], v[76:79], v[172:175]
    ds_read_b128 v[32:35], v10 offset:38912
    v_mfma_f32_16x16x32_bf16 v[176:179], v[100:103], v[80:83], v[176:179]
    ds_read_b128 v[36:39], v10 offset:40960
    s_add_u32 m0, s34, 0
    v_mfma_f32_16x16x32_bf16 v[180:183], v[104:107], v[80:83], v[180:183]
    ds_read_b128 v[40:43], v10 offset:43008
    buffer_load_dwordx4 v6, s[8:11], s32 offen offset:0 nt lds
    v_mfma_f32_16x16x32_bf16 v[184:187], v[108:111], v[80:83], v[184:187]
    ds_read_b128 v[44:47], v10 offset:45056
    v_mfma_f32_16x16x32_bf16 v[188:191], v[112:115], v[80:83], v[188:191]
    ds_read_b128 v[48:51], v10 offset:47104
    v_mfma_f32_16x16x32_bf16 v[192:195], v[100:103], v[84:87], v[192:195]
    buffer_load_dwordx4 v7, s[8:11], s32 offen offset:1024 nt lds
    v_mfma_f32_16x16x32_bf16 v[196:199], v[104:107], v[84:87], v[196:199]
    v_mfma_f32_16x16x32_bf16 v[200:203], v[108:111], v[84:87], v[200:203]
    v_mfma_f32_16x16x32_bf16 v[204:207], v[112:115], v[84:87], v[204:207]
    buffer_load_dwordx4 v8, s[8:11], s32 offen offset:2048 nt lds
    v_mfma_f32_16x16x32_bf16 v[208:211], v[100:103], v[88:91], v[208:211]
    v_mfma_f32_16x16x32_bf16 v[212:215], v[104:107], v[88:91], v[212:215]
    v_mfma_f32_16x16x32_bf16 v[216:219], v[108:111], v[88:91], v[216:219]
    buffer_load_dwordx4 v9, s[8:11], s32 offen offset:3072 nt lds
    v_mfma_f32_16x16x32_bf16 v[220:223], v[112:115], v[88:91], v[220:223]
    v_mfma_f32_16x16x32_bf16 v[224:227], v[100:103], v[92:95], v[224:227]
    v_mfma_f32_16x16x32_bf16 v[228:231], v[104:107], v[92:95], v[228:231]
    v_mfma_f32_16x16x32_bf16 v[232:235], v[108:111], v[92:95], v[232:235]
    v_mfma_f32_16x16x32_bf16 v[236:239], v[112:115], v[92:95], v[236:239]
    v_mfma_f32_16x16x32_bf16 v[240:243], v[100:103], v[96:99], v[240:243]
    v_mfma_f32_16x16x32_bf16 v[244:247], v[104:107], v[96:99], v[244:247]
    v_mfma_f32_16x16x32_bf16 v[248:251], v[108:111], v[96:99], v[248:251]
    v_mfma_f32_16x16x32_bf16 v[252:255], v[112:115], v[96:99], v[252:255]
    s_mov_b64 exec, 0xff
    global_load_dword v119, v17, s[96:97]
    s_mov_b64 exec, -1
    v_add_u32 v17, s45, v17
    s_nop 1
    s_add_u32 s31, s31, s40
    s_add_u32 s32, s32, s41
    s_waitcnt lgkmcnt(0)
    v_mfma_f32_16x16x32_bf16 v[128:131], v[52:55], v[20:23], v[128:131]
    ds_read_b128 v[68:71], v11 offset:32768
    v_mfma_f32_16x16x32_bf16 v[132:135], v[56:59], v[20:23], v[132:135]
    ds_read_b64_tr_b16 v[100:101], v12 offset:40960
    v_mfma_f32_16x16x32_bf16 v[136:139], v[60:63], v[20:23], v[136:139]
    ds_read_b64_tr_b16 v[102:103], v12 offset:41984
    v_mfma_f32_16x16x32_bf16 v[140:143], v[64:67], v[20:23], v[140:143]
    ds_read_b64_tr_b16 v[104:105], v13 offset:40960
    v_mfma_f32_16x16x32_bf16 v[144:147], v[52:55], v[24:27], v[144:147]
    ds_read_b64_tr_b16 v[106:107], v13 offset:41984
    v_mfma_f32_16x16x32_bf16 v[148:151], v[56:59], v[24:27], v[148:151]
    ds_read_b64_tr_b16 v[108:109], v14 offset:40960
    v_mfma_f32_16x16x32_bf16 v[152:155], v[60:63], v[24:27], v[152:155]
    ds_read_b64_tr_b16 v[110:111], v14 offset:41984
    v_mfma_f32_16x16x32_bf16 v[156:159], v[64:67], v[24:27], v[156:159]
    ds_read_b64_tr_b16 v[112:113], v15 offset:40960
    v_mfma_f32_16x16x32_bf16 v[160:163], v[52:55], v[28:31], v[160:163]
    ds_read_b64_tr_b16 v[114:115], v15 offset:41984
    v_mfma_f32_16x16x32_bf16 v[164:167], v[56:59], v[28:31], v[164:167]
    ds_read_b128 v[72:75], v11 offset:34816
    v_mfma_f32_16x16x32_bf16 v[168:171], v[60:63], v[28:31], v[168:171]
    ds_read_b128 v[76:79], v11 offset:36864
    v_mfma_f32_16x16x32_bf16 v[172:175], v[64:67], v[28:31], v[172:175]
    ds_read_b128 v[80:83], v11 offset:38912
    v_mfma_f32_16x16x32_bf16 v[176:179], v[52:55], v[32:35], v[176:179]
    ds_read_b128 v[84:87], v11 offset:40960
    v_mfma_f32_16x16x32_bf16 v[180:183], v[56:59], v[32:35], v[180:183]
    ds_read_b128 v[88:91], v11 offset:43008
    v_mfma_f32_16x16x32_bf16 v[184:187], v[60:63], v[32:35], v[184:187]
    ds_read_b128 v[92:95], v11 offset:45056
    v_mfma_f32_16x16x32_bf16 v[188:191], v[64:67], v[32:35], v[188:191]
    ds_read_b128 v[96:99], v11 offset:47104
    v_mfma_f32_16x16x32_bf16 v[192:195], v[52:55], v[36:39], v[192:195]
    v_mfma_f32_16x16x32_bf16 v[196:199], v[56:59], v[36:39], v[196:199]
    v_mfma_f32_16x16x32_bf16 v[200:203], v[60:63], v[36:39], v[200:203]
    v_mfma_f32_16x16x32_bf16 v[204:207], v[64:67], v[36:39], v[204:207]
    v_mfma_f32_16x16x32_bf16 v[208:211], v[52:55], v[40:43], v[208:211]
    s_bitcmp1_b32 s43, s35
    s_cbranch_scc1 L_recurrent_scan__compressed_kv_cla__moe_arch_mod__prompt_kernel_rare_19
L_recurrent_scan__compressed_kv_cla__moe_arch_mod__prompt_kernel_back_20:
    v_mfma_f32_16x16x32_bf16 v[212:215], v[56:59], v[40:43], v[212:215]
    v_mfma_f32_16x16x32_bf16 v[216:219], v[60:63], v[40:43], v[216:219]
    v_mfma_f32_16x16x32_bf16 v[220:223], v[64:67], v[40:43], v[220:223]
    v_mfma_f32_16x16x32_bf16 v[224:227], v[52:55], v[44:47], v[224:227]
    v_mfma_f32_16x16x32_bf16 v[228:231], v[56:59], v[44:47], v[228:231]
    v_mfma_f32_16x16x32_bf16 v[232:235], v[60:63], v[44:47], v[232:235]
    v_mfma_f32_16x16x32_bf16 v[236:239], v[64:67], v[44:47], v[236:239]
    v_mfma_f32_16x16x32_bf16 v[240:243], v[52:55], v[48:51], v[240:243]
    v_mfma_f32_16x16x32_bf16 v[244:247], v[56:59], v[48:51], v[244:247]
    v_mfma_f32_16x16x32_bf16 v[248:251], v[60:63], v[48:51], v[248:251]
    v_mfma_f32_16x16x32_bf16 v[252:255], v[64:67], v[48:51], v[252:255]
    s_bitcmp1_b32 s43, s35
    s_cbranch_scc1 L_recurrent_scan__compressed_kv_cla__moe_arch_mod__prompt_kernel_w0_21
    s_waitcnt vmcnt(1)
L_recurrent_scan__compressed_kv_cla__moe_arch_mod__prompt_kernel_w0b_22:
    s_waitcnt lgkmcnt(0)
    s_barrier
    v_mfma_f32_16x16x32_bf16 v[128:131], v[100:103], v[68:71], v[128:131]
    ds_read_b128 v[20:23], v10 offset:0
    s_add_u32 m0, s33, 32768
    v_mfma_f32_16x16x32_bf16 v[132:135], v[104:107], v[68:71], v[132:135]
    ds_read_b64_tr_b16 v[52:53], v12 offset:0
    buffer_load_dwordx4 v2, s[4:7], s31 offen offset:0 lds
    v_mfma_f32_16x16x32_bf16 v[136:139], v[108:111], v[68:71], v[136:139]
    ds_read_b64_tr_b16 v[54:55], v12 offset:1024
    v_mfma_f32_16x16x32_bf16 v[140:143], v[112:115], v[68:71], v[140:143]
    ds_read_b64_tr_b16 v[56:57], v13 offset:0
    v_mfma_f32_16x16x32_bf16 v[144:147], v[100:103], v[72:75], v[144:147]
    ds_read_b64_tr_b16 v[58:59], v13 offset:1024
    buffer_load_dwordx4 v3, s[4:7], s31 offen offset:1024 lds
    v_mfma_f32_16x16x32_bf16 v[148:151], v[104:107], v[72:75], v[148:151]
    ds_read_b64_tr_b16 v[60:61], v14 offset:0
    v_mfma_f32_16x16x32_bf16 v[152:155], v[108:111], v[72:75], v[152:155]
    ds_read_b64_tr_b16 v[62:63], v14 offset:1024
    v_mfma_f32_16x16x32_bf16 v[156:159], v[112:115], v[72:75], v[156:159]
    ds_read_b64_tr_b16 v[64:65], v15 offset:0
    buffer_load_dwordx4 v4, s[4:7], s31 offen offset:2048 lds
    v_mfma_f32_16x16x32_bf16 v[160:163], v[100:103], v[76:79], v[160:163]
    ds_read_b64_tr_b16 v[66:67], v15 offset:1024
    v_mfma_f32_16x16x32_bf16 v[164:167], v[104:107], v[76:79], v[164:167]
    ds_read_b128 v[24:27], v10 offset:2048
    v_mfma_f32_16x16x32_bf16 v[168:171], v[108:111], v[76:79], v[168:171]
    ds_read_b128 v[28:31], v10 offset:4096
    buffer_load_dwordx4 v5, s[4:7], s31 offen offset:3072 lds
    v_mfma_f32_16x16x32_bf16 v[172:175], v[112:115], v[76:79], v[172:175]
    ds_read_b128 v[32:35], v10 offset:6144
    v_mfma_f32_16x16x32_bf16 v[176:179], v[100:103], v[80:83], v[176:179]
    ds_read_b128 v[36:39], v10 offset:8192
    s_add_u32 m0, s34, 32768
    v_mfma_f32_16x16x32_bf16 v[180:183], v[104:107], v[80:83], v[180:183]
    ds_read_b128 v[40:43], v10 offset:10240
    buffer_load_dwordx4 v6, s[8:11], s32 offen offset:0 nt lds
    v_mfma_f32_16x16x32_bf16 v[184:187], v[108:111], v[80:83], v[184:187]
    ds_read_b128 v[44:47], v10 offset:12288
    v_mfma_f32_16x16x32_bf16 v[188:191], v[112:115], v[80:83], v[188:191]
    ds_read_b128 v[48:51], v10 offset:14336
    v_mfma_f32_16x16x32_bf16 v[192:195], v[100:103], v[84:87], v[192:195]
    buffer_load_dwordx4 v7, s[8:11], s32 offen offset:1024 nt lds
    v_mfma_f32_16x16x32_bf16 v[196:199], v[104:107], v[84:87], v[196:199]
    v_mfma_f32_16x16x32_bf16 v[200:203], v[108:111], v[84:87], v[200:203]
    v_mfma_f32_16x16x32_bf16 v[204:207], v[112:115], v[84:87], v[204:207]
    buffer_load_dwordx4 v8, s[8:11], s32 offen offset:2048 nt lds
    v_mfma_f32_16x16x32_bf16 v[208:211], v[100:103], v[88:91], v[208:211]
    v_mfma_f32_16x16x32_bf16 v[212:215], v[104:107], v[88:91], v[212:215]
    v_mfma_f32_16x16x32_bf16 v[216:219], v[108:111], v[88:91], v[216:219]
    buffer_load_dwordx4 v9, s[8:11], s32 offen offset:3072 nt lds
    v_mfma_f32_16x16x32_bf16 v[220:223], v[112:115], v[88:91], v[220:223]
    v_mfma_f32_16x16x32_bf16 v[224:227], v[100:103], v[92:95], v[224:227]
    v_mfma_f32_16x16x32_bf16 v[228:231], v[104:107], v[92:95], v[228:231]
    v_mfma_f32_16x16x32_bf16 v[232:235], v[108:111], v[92:95], v[232:235]
    v_mfma_f32_16x16x32_bf16 v[236:239], v[112:115], v[92:95], v[236:239]
    v_mfma_f32_16x16x32_bf16 v[240:243], v[100:103], v[96:99], v[240:243]
    v_mfma_f32_16x16x32_bf16 v[244:247], v[104:107], v[96:99], v[244:247]
    v_mfma_f32_16x16x32_bf16 v[248:251], v[108:111], v[96:99], v[248:251]
    s_add_u32 s36, s35, s28
    s_cmp_eq_u32 s36, 0
    s_cbranch_scc1 L_recurrent_scan__compressed_kv_cla__moe_arch_mod__prompt_kernel_rare_31
L_recurrent_scan__compressed_kv_cla__moe_arch_mod__prompt_kernel_back_32:
    v_mfma_f32_16x16x32_bf16 v[252:255], v[112:115], v[96:99], v[252:255]
    s_mov_b64 exec, 0xff
    global_load_dword v0, v17, s[96:97]
    s_mov_b64 exec, -1
    s_cmp_eq_u32 s35, 0
    s_cselect_b32 s45, s45, 0
    v_add_u32 v17, s45, v17
    s_nop 1
    s_add_u32 s31, s31, s40
    s_add_u32 s32, s32, s41
    s_add_u32 s35, s35, 1
    s_cmp_lt_u32 s35, 4
    s_cbranch_scc1 L_kv_kloop
    s_branch L_p1_done
    .p2align 6
L_kv_vloop:
    s_waitcnt lgkmcnt(0)
    v_mfma_f32_16x16x32_bf16 v[128:131], v[20:23], v[52:55], v[128:131]
    ds_read_b128 v[68:71], v11 offset:0
    v_mfma_f32_16x16x32_bf16 v[160:163], v[20:23], v[56:59], v[160:163]
    ds_read_b64_tr_b16 v[100:101], v12 offset:8192
    v_mfma_f32_16x16x32_bf16 v[192:195], v[20:23], v[60:63], v[192:195]
    ds_read_b64_tr_b16 v[102:103], v12 offset:9216
    v_mfma_f32_16x16x32_bf16 v[224:227], v[20:23], v[64:67], v[224:227]
    ds_read_b64_tr_b16 v[104:105], v13 offset:8192
    v_mfma_f32_16x16x32_bf16 v[132:135], v[24:27], v[52:55], v[132:135]
    ds_read_b64_tr_b16 v[106:107], v13 offset:9216
    v_mfma_f32_16x16x32_bf16 v[164:167], v[24:27], v[56:59], v[164:167]
    ds_read_b64_tr_b16 v[108:109], v14 offset:8192
    v_mfma_f32_16x16x32_bf16 v[196:199], v[24:27], v[60:63], v[196:199]
    ds_read_b64_tr_b16 v[110:111], v14 offset:9216
    v_mfma_f32_16x16x32_bf16 v[228:231], v[24:27], v[64:67], v[228:231]
    ds_read_b64_tr_b16 v[112:113], v15 offset:8192
    v_mfma_f32_16x16x32_bf16 v[136:139], v[28:31], v[52:55], v[136:139]
    ds_read_b64_tr_b16 v[114:115], v15 offset:9216
    v_mfma_f32_16x16x32_bf16 v[168:171], v[28:31], v[56:59], v[168:171]
    ds_read_b128 v[72:75], v11 offset:2048
    v_mfma_f32_16x16x32_bf16 v[200:203], v[28:31], v[60:63], v[200:203]
    ds_read_b128 v[76:79], v11 offset:4096
    v_mfma_f32_16x16x32_bf16 v[232:235], v[28:31], v[64:67], v[232:235]
    ds_read_b128 v[80:83], v11 offset:6144
    v_mfma_f32_16x16x32_bf16 v[140:143], v[32:35], v[52:55], v[140:143]
    ds_read_b128 v[84:87], v11 offset:8192
    v_mfma_f32_16x16x32_bf16 v[172:175], v[32:35], v[56:59], v[172:175]
    ds_read_b128 v[88:91], v11 offset:10240
    v_mfma_f32_16x16x32_bf16 v[204:207], v[32:35], v[60:63], v[204:207]
    ds_read_b128 v[92:95], v11 offset:12288
    v_mfma_f32_16x16x32_bf16 v[236:239], v[32:35], v[64:67], v[236:239]
    ds_read_b128 v[96:99], v11 offset:14336
    v_mfma_f32_16x16x32_bf16 v[144:147], v[36:39], v[52:55], v[144:147]
    v_mfma_f32_16x16x32_bf16 v[176:179], v[36:39], v[56:59], v[176:179]
    v_mfma_f32_16x16x32_bf16 v[208:211], v[36:39], v[60:63], v[208:211]
    v_mfma_f32_16x16x32_bf16 v[240:243], v[36:39], v[64:67], v[240:243]
    v_mfma_f32_16x16x32_bf16 v[148:151], v[40:43], v[52:55], v[148:151]
    v_mfma_f32_16x16x32_bf16 v[180:183], v[40:43], v[56:59], v[180:183]
    v_mfma_f32_16x16x32_bf16 v[212:215], v[40:43], v[60:63], v[212:215]
    v_mfma_f32_16x16x32_bf16 v[244:247], v[40:43], v[64:67], v[244:247]
    v_mfma_f32_16x16x32_bf16 v[152:155], v[44:47], v[52:55], v[152:155]
    v_mfma_f32_16x16x32_bf16 v[184:187], v[44:47], v[56:59], v[184:187]
    v_mfma_f32_16x16x32_bf16 v[216:219], v[44:47], v[60:63], v[216:219]
    v_mfma_f32_16x16x32_bf16 v[248:251], v[44:47], v[64:67], v[248:251]
    v_mfma_f32_16x16x32_bf16 v[156:159], v[48:51], v[52:55], v[156:159]
    v_mfma_f32_16x16x32_bf16 v[188:191], v[48:51], v[56:59], v[188:191]
    v_mfma_f32_16x16x32_bf16 v[220:223], v[48:51], v[60:63], v[220:223]
    v_mfma_f32_16x16x32_bf16 v[252:255], v[48:51], v[64:67], v[252:255]
    s_cmp_lt_u32 s35, s44
    s_cbranch_scc1 L_recurrent_scan__compressed_kv_cla__moe_arch_mod__prompt_kernel_w0_33
    s_waitcnt vmcnt(1)
L_recurrent_scan__compressed_kv_cla__moe_arch_mod__prompt_kernel_w0b_34:
    s_waitcnt lgkmcnt(0)
    s_barrier
    s_add_u32 m0, s33, 0
    s_nop 0
    buffer_load_dwordx4 v2, s[4:7], s31 offen offset:0 lds
    buffer_load_dwordx4 v3, s[4:7], s31 offen offset:1024 lds
    buffer_load_dwordx4 v4, s[4:7], s31 offen offset:2048 lds
    buffer_load_dwordx4 v5, s[4:7], s31 offen offset:3072 lds
    s_add_u32 m0, s34, 0
    s_nop 0
    buffer_load_dwordx4 v6, s[8:11], s32 offen offset:0 nt lds
    buffer_load_dwordx4 v7, s[8:11], s32 offen offset:1024 nt lds
    buffer_load_dwordx4 v8, s[8:11], s32 offen offset:2048 nt lds
    buffer_load_dwordx4 v9, s[8:11], s32 offen offset:3072 nt lds
    s_add_u32 s31, s31, s40
    s_add_u32 s32, s32, s41
    v_mfma_f32_16x16x32_bf16 v[128:131], v[68:71], v[100:103], v[128:131]
    ds_read_b128 v[20:23], v10 offset:32768
    v_mfma_f32_16x16x32_bf16 v[160:163], v[68:71], v[104:107], v[160:163]
    ds_read_b64_tr_b16 v[52:53], v12 offset:32768
    v_mfma_f32_16x16x32_bf16 v[192:195], v[68:71], v[108:111], v[192:195]
    ds_read_b64_tr_b16 v[54:55], v12 offset:33792
    v_mfma_f32_16x16x32_bf16 v[224:227], v[68:71], v[112:115], v[224:227]
    ds_read_b64_tr_b16 v[56:57], v13 offset:32768
    v_mfma_f32_16x16x32_bf16 v[132:135], v[72:75], v[100:103], v[132:135]
    ds_read_b64_tr_b16 v[58:59], v13 offset:33792
    v_mfma_f32_16x16x32_bf16 v[164:167], v[72:75], v[104:107], v[164:167]
    ds_read_b64_tr_b16 v[60:61], v14 offset:32768
    v_mfma_f32_16x16x32_bf16 v[196:199], v[72:75], v[108:111], v[196:199]
    ds_read_b64_tr_b16 v[62:63], v14 offset:33792
    v_mfma_f32_16x16x32_bf16 v[228:231], v[72:75], v[112:115], v[228:231]
    ds_read_b64_tr_b16 v[64:65], v15 offset:32768
    v_mfma_f32_16x16x32_bf16 v[136:139], v[76:79], v[100:103], v[136:139]
    ds_read_b64_tr_b16 v[66:67], v15 offset:33792
    v_mfma_f32_16x16x32_bf16 v[168:171], v[76:79], v[104:107], v[168:171]
    ds_read_b128 v[24:27], v10 offset:34816
    v_mfma_f32_16x16x32_bf16 v[200:203], v[76:79], v[108:111], v[200:203]
    ds_read_b128 v[28:31], v10 offset:36864
    v_mfma_f32_16x16x32_bf16 v[232:235], v[76:79], v[112:115], v[232:235]
    ds_read_b128 v[32:35], v10 offset:38912
    v_mfma_f32_16x16x32_bf16 v[140:143], v[80:83], v[100:103], v[140:143]
    ds_read_b128 v[36:39], v10 offset:40960
    v_mfma_f32_16x16x32_bf16 v[172:175], v[80:83], v[104:107], v[172:175]
    ds_read_b128 v[40:43], v10 offset:43008
    v_mfma_f32_16x16x32_bf16 v[204:207], v[80:83], v[108:111], v[204:207]
    ds_read_b128 v[44:47], v10 offset:45056
    v_mfma_f32_16x16x32_bf16 v[236:239], v[80:83], v[112:115], v[236:239]
    ds_read_b128 v[48:51], v10 offset:47104
    v_mfma_f32_16x16x32_bf16 v[144:147], v[84:87], v[100:103], v[144:147]
    v_mfma_f32_16x16x32_bf16 v[176:179], v[84:87], v[104:107], v[176:179]
    v_mfma_f32_16x16x32_bf16 v[208:211], v[84:87], v[108:111], v[208:211]
    v_mfma_f32_16x16x32_bf16 v[240:243], v[84:87], v[112:115], v[240:243]
    v_mfma_f32_16x16x32_bf16 v[148:151], v[88:91], v[100:103], v[148:151]
    v_mfma_f32_16x16x32_bf16 v[180:183], v[88:91], v[104:107], v[180:183]
    v_mfma_f32_16x16x32_bf16 v[212:215], v[88:91], v[108:111], v[212:215]
    v_mfma_f32_16x16x32_bf16 v[244:247], v[88:91], v[112:115], v[244:247]
    v_mfma_f32_16x16x32_bf16 v[152:155], v[92:95], v[100:103], v[152:155]
    v_mfma_f32_16x16x32_bf16 v[184:187], v[92:95], v[104:107], v[184:187]
    v_mfma_f32_16x16x32_bf16 v[216:219], v[92:95], v[108:111], v[216:219]
    v_mfma_f32_16x16x32_bf16 v[248:251], v[92:95], v[112:115], v[248:251]
    v_mfma_f32_16x16x32_bf16 v[156:159], v[96:99], v[100:103], v[156:159]
    v_mfma_f32_16x16x32_bf16 v[188:191], v[96:99], v[104:107], v[188:191]
    v_mfma_f32_16x16x32_bf16 v[220:223], v[96:99], v[108:111], v[220:223]
    v_mfma_f32_16x16x32_bf16 v[252:255], v[96:99], v[112:115], v[252:255]
    s_mov_b64 exec, 0xff
    global_load_dword v119, v17, s[96:97]
    s_mov_b64 exec, -1
    v_add_u32 v17, s45, v17
    s_nop 1
    s_waitcnt lgkmcnt(0)
    v_mfma_f32_16x16x32_bf16 v[128:131], v[20:23], v[52:55], v[128:131]
    ds_read_b128 v[68:71], v11 offset:32768
    v_mfma_f32_16x16x32_bf16 v[160:163], v[20:23], v[56:59], v[160:163]
    ds_read_b64_tr_b16 v[100:101], v12 offset:40960
    v_mfma_f32_16x16x32_bf16 v[192:195], v[20:23], v[60:63], v[192:195]
    ds_read_b64_tr_b16 v[102:103], v12 offset:41984
    v_mfma_f32_16x16x32_bf16 v[224:227], v[20:23], v[64:67], v[224:227]
    ds_read_b64_tr_b16 v[104:105], v13 offset:40960
    v_mfma_f32_16x16x32_bf16 v[132:135], v[24:27], v[52:55], v[132:135]
    ds_read_b64_tr_b16 v[106:107], v13 offset:41984
    v_mfma_f32_16x16x32_bf16 v[164:167], v[24:27], v[56:59], v[164:167]
    ds_read_b64_tr_b16 v[108:109], v14 offset:40960
    v_mfma_f32_16x16x32_bf16 v[196:199], v[24:27], v[60:63], v[196:199]
    ds_read_b64_tr_b16 v[110:111], v14 offset:41984
    v_mfma_f32_16x16x32_bf16 v[228:231], v[24:27], v[64:67], v[228:231]
    ds_read_b64_tr_b16 v[112:113], v15 offset:40960
    v_mfma_f32_16x16x32_bf16 v[136:139], v[28:31], v[52:55], v[136:139]
    ds_read_b64_tr_b16 v[114:115], v15 offset:41984
    v_mfma_f32_16x16x32_bf16 v[168:171], v[28:31], v[56:59], v[168:171]
    ds_read_b128 v[72:75], v11 offset:34816
    v_mfma_f32_16x16x32_bf16 v[200:203], v[28:31], v[60:63], v[200:203]
    ds_read_b128 v[76:79], v11 offset:36864
    v_mfma_f32_16x16x32_bf16 v[232:235], v[28:31], v[64:67], v[232:235]
    ds_read_b128 v[80:83], v11 offset:38912
    v_mfma_f32_16x16x32_bf16 v[140:143], v[32:35], v[52:55], v[140:143]
    ds_read_b128 v[84:87], v11 offset:40960
    v_mfma_f32_16x16x32_bf16 v[172:175], v[32:35], v[56:59], v[172:175]
    ds_read_b128 v[88:91], v11 offset:43008
    v_mfma_f32_16x16x32_bf16 v[204:207], v[32:35], v[60:63], v[204:207]
    ds_read_b128 v[92:95], v11 offset:45056
    v_mfma_f32_16x16x32_bf16 v[236:239], v[32:35], v[64:67], v[236:239]
    ds_read_b128 v[96:99], v11 offset:47104
    v_mfma_f32_16x16x32_bf16 v[144:147], v[36:39], v[52:55], v[144:147]
    v_mfma_f32_16x16x32_bf16 v[176:179], v[36:39], v[56:59], v[176:179]
    v_mfma_f32_16x16x32_bf16 v[208:211], v[36:39], v[60:63], v[208:211]
    v_mfma_f32_16x16x32_bf16 v[240:243], v[36:39], v[64:67], v[240:243]
    v_mfma_f32_16x16x32_bf16 v[148:151], v[40:43], v[52:55], v[148:151]
    v_mfma_f32_16x16x32_bf16 v[180:183], v[40:43], v[56:59], v[180:183]
    v_mfma_f32_16x16x32_bf16 v[212:215], v[40:43], v[60:63], v[212:215]
    v_mfma_f32_16x16x32_bf16 v[244:247], v[40:43], v[64:67], v[244:247]
    v_mfma_f32_16x16x32_bf16 v[152:155], v[44:47], v[52:55], v[152:155]
    v_mfma_f32_16x16x32_bf16 v[184:187], v[44:47], v[56:59], v[184:187]
    v_mfma_f32_16x16x32_bf16 v[216:219], v[44:47], v[60:63], v[216:219]
    v_mfma_f32_16x16x32_bf16 v[248:251], v[44:47], v[64:67], v[248:251]
    v_mfma_f32_16x16x32_bf16 v[156:159], v[48:51], v[52:55], v[156:159]
    v_mfma_f32_16x16x32_bf16 v[188:191], v[48:51], v[56:59], v[188:191]
    v_mfma_f32_16x16x32_bf16 v[220:223], v[48:51], v[60:63], v[220:223]
    v_mfma_f32_16x16x32_bf16 v[252:255], v[48:51], v[64:67], v[252:255]
    s_waitcnt vmcnt(1) lgkmcnt(0)
    s_barrier
    s_add_u32 m0, s33, 32768
    s_nop 0
    buffer_load_dwordx4 v2, s[4:7], s31 offen offset:0 lds
    buffer_load_dwordx4 v3, s[4:7], s31 offen offset:1024 lds
    buffer_load_dwordx4 v4, s[4:7], s31 offen offset:2048 lds
    buffer_load_dwordx4 v5, s[4:7], s31 offen offset:3072 lds
    s_add_u32 m0, s34, 32768
    s_nop 0
    buffer_load_dwordx4 v6, s[8:11], s32 offen offset:0 nt lds
    buffer_load_dwordx4 v7, s[8:11], s32 offen offset:1024 nt lds
    buffer_load_dwordx4 v8, s[8:11], s32 offen offset:2048 nt lds
    buffer_load_dwordx4 v9, s[8:11], s32 offen offset:3072 nt lds
    s_add_u32 s31, s31, s40
    s_add_u32 s32, s32, s41
    s_cmp_eq_u32 s35, 2
    s_cbranch_scc1 L_recurrent_scan__compressed_kv_cla__moe_arch_mod__prompt_kernel_rare_39
L_recurrent_scan__compressed_kv_cla__moe_arch_mod__prompt_kernel_back_40:
    v_mfma_f32_16x16x32_bf16 v[128:131], v[68:71], v[100:103], v[128:131]
    ds_read_b128 v[20:23], v10 offset:0
    v_mfma_f32_16x16x32_bf16 v[160:163], v[68:71], v[104:107], v[160:163]
    ds_read_b64_tr_b16 v[52:53], v12 offset:0
    v_mfma_f32_16x16x32_bf16 v[192:195], v[68:71], v[108:111], v[192:195]
    ds_read_b64_tr_b16 v[54:55], v12 offset:1024
    v_mfma_f32_16x16x32_bf16 v[224:227], v[68:71], v[112:115], v[224:227]
    ds_read_b64_tr_b16 v[56:57], v13 offset:0
    v_mfma_f32_16x16x32_bf16 v[132:135], v[72:75], v[100:103], v[132:135]
    ds_read_b64_tr_b16 v[58:59], v13 offset:1024
    v_mfma_f32_16x16x32_bf16 v[164:167], v[72:75], v[104:107], v[164:167]
    ds_read_b64_tr_b16 v[60:61], v14 offset:0
    v_mfma_f32_16x16x32_bf16 v[196:199], v[72:75], v[108:111], v[196:199]
    ds_read_b64_tr_b16 v[62:63], v14 offset:1024
    v_mfma_f32_16x16x32_bf16 v[228:231], v[72:75], v[112:115], v[228:231]
    ds_read_b64_tr_b16 v[64:65], v15 offset:0
    v_mfma_f32_16x16x32_bf16 v[136:139], v[76:79], v[100:103], v[136:139]
    ds_read_b64_tr_b16 v[66:67], v15 offset:1024
    v_mfma_f32_16x16x32_bf16 v[168:171], v[76:79], v[104:107], v[168:171]
    ds_read_b128 v[24:27], v10 offset:2048
    v_mfma_f32_16x16x32_bf16 v[200:203], v[76:79], v[108:111], v[200:203]
    ds_read_b128 v[28:31], v10 offset:4096
    v_mfma_f32_16x16x32_bf16 v[232:235], v[76:79], v[112:115], v[232:235]
    ds_read_b128 v[32:35], v10 offset:6144
    v_mfma_f32_16x16x32_bf16 v[140:143], v[80:83], v[100:103], v[140:143]
    ds_read_b128 v[36:39], v10 offset:8192
    v_mfma_f32_16x16x32_bf16 v[172:175], v[80:83], v[104:107], v[172:175]
    ds_read_b128 v[40:43], v10 offset:10240
    v_mfma_f32_16x16x32_bf16 v[204:207], v[80:83], v[108:111], v[204:207]
    ds_read_b128 v[44:47], v10 offset:12288
    v_mfma_f32_16x16x32_bf16 v[236:239], v[80:83], v[112:115], v[236:239]
    ds_read_b128 v[48:51], v10 offset:14336
    v_mfma_f32_16x16x32_bf16 v[144:147], v[84:87], v[100:103], v[144:147]
    v_mfma_f32_16x16x32_bf16 v[176:179], v[84:87], v[104:107], v[176:179]
    v_mfma_f32_16x16x32_bf16 v[208:211], v[84:87], v[108:111], v[208:211]
    v_mfma_f32_16x16x32_bf16 v[240:243], v[84:87], v[112:115], v[240:243]
    v_mfma_f32_16x16x32_bf16 v[148:151], v[88:91], v[100:103], v[148:151]
    v_mfma_f32_16x16x32_bf16 v[180:183], v[88:91], v[104:107], v[180:183]
    v_mfma_f32_16x16x32_bf16 v[212:215], v[88:91], v[108:111], v[212:215]
    v_mfma_f32_16x16x32_bf16 v[244:247], v[88:91], v[112:115], v[244:247]
    v_mfma_f32_16x16x32_bf16 v[152:155], v[92:95], v[100:103], v[152:155]
    v_mfma_f32_16x16x32_bf16 v[184:187], v[92:95], v[104:107], v[184:187]
    v_mfma_f32_16x16x32_bf16 v[216:219], v[92:95], v[108:111], v[216:219]
    v_mfma_f32_16x16x32_bf16 v[248:251], v[92:95], v[112:115], v[248:251]
    v_mfma_f32_16x16x32_bf16 v[156:159], v[96:99], v[100:103], v[156:159]
    v_mfma_f32_16x16x32_bf16 v[188:191], v[96:99], v[104:107], v[188:191]
    v_mfma_f32_16x16x32_bf16 v[220:223], v[96:99], v[108:111], v[220:223]
    v_mfma_f32_16x16x32_bf16 v[252:255], v[96:99], v[112:115], v[252:255]
    s_mov_b64 exec, 0xff
    global_load_dword v0, v17, s[96:97]
    s_mov_b64 exec, -1
    s_cmp_eq_u32 s35, 0
    s_cselect_b32 s45, s45, 0
    v_add_u32 v17, s45, v17
    s_nop 1
    s_add_u32 s35, s35, 1
    s_cmp_lt_u32 s35, 4
    s_cbranch_scc1 L_kv_vloop
L_p1_done:
    s_waitcnt vmcnt(9) lgkmcnt(0)
    s_and_b32 s36, s28, 3
    s_sub_u32 s37, 15, s30
    s_cmp_lt_u32 s28, 4
    s_cselect_b32 s37, s37, s30
    s_lshl_b32 s37, s37, 2
    s_add_u32 s37, s37, s36
    s_lshl_b32 s37, s37, 16
    v_lshl_add_u32 v6, v1, 4, s37
    v_add_u32 v7, 32768, v6
    s_mov_b32 s32, 0
    s_mov_b32 s8, s54
    s_and_b32 s9, s55, 0xffff
    s_mov_b32 s10, 4194304
    s_mov_b32 s11, 0x20000
    buffer_load_dwordx4 v[64:67], v6, s[8:11], s32 offen offset:0 sc1
    buffer_load_dwordx4 v[68:71], v7, s[8:11], s32 offen offset:0 sc1
    buffer_load_dwordx4 v[72:75], v6, s[8:11], s32 offen offset:1024 sc1
    buffer_load_dwordx4 v[76:79], v7, s[8:11], s32 offen offset:1024 sc1
    buffer_load_dwordx4 v[80:83], v6, s[8:11], s32 offen offset:2048 sc1
    buffer_load_dwordx4 v[84:87], v7, s[8:11], s32 offen offset:2048 sc1
    buffer_load_dwordx4 v[88:91], v6, s[8:11], s32 offen offset:3072 sc1
    buffer_load_dwordx4 v[92:95], v7, s[8:11], s32 offen offset:3072 sc1
    s_add_u32 s32, s32, 4096
    buffer_load_dwordx4 v[96:99], v6, s[8:11], s32 offen offset:0 sc1
    buffer_load_dwordx4 v[100:103], v7, s[8:11], s32 offen offset:0 sc1
    buffer_load_dwordx4 v[104:107], v6, s[8:11], s32 offen offset:1024 sc1
    buffer_load_dwordx4 v[108:111], v7, s[8:11], s32 offen offset:1024 sc1
    buffer_load_dwordx4 v[112:115], v6, s[8:11], s32 offen offset:2048 sc1
    buffer_load_dwordx4 v[116:119], v7, s[8:11], s32 offen offset:2048 sc1
    v_lshrrev_b32 v18, 4, v1
    v_bfe_u32 v20, v1, 2, 2
    v_lshl_add_u32 v19, v18, 3, v20
    v_lshlrev_b32 v19, 8, v19
    v_and_b32 v21, 3, v1
    v_lshl_add_u32 v19, v21, 3, v19
    v_and_b32 v21, 1, v18
    v_lshl_add_u32 v20, v21, 2, v20
    v_xor_b32 v21, 0, v20
    v_lshl_add_u32 v10, v21, 5, v19
    v_xor_b32 v21, 1, v20
    v_lshl_add_u32 v11, v21, 5, v19
    v_xor_b32 v21, 2, v20
    v_lshl_add_u32 v12, v21, 5, v19
    v_xor_b32 v21, 3, v20
    v_lshl_add_u32 v13, v21, 5, v19
    v_xor_b32 v21, 4, v20
    v_lshl_add_u32 v14, v21, 5, v19
    v_xor_b32 v21, 5, v20
    v_lshl_add_u32 v15, v21, 5, v19
    v_xor_b32 v21, 6, v20
    v_lshl_add_u32 v16, v21, 5, v19
    v_xor_b32 v21, 7, v20
    v_lshl_add_u32 v17, v21, 5, v19
    s_lshl_b32 s45, s29, 20
    ds_read_b64_tr_b16 v[24:25], v10 offset:0
    ds_read_b64_tr_b16 v[26:27], v10 offset:1024
    ds_read_b64_tr_b16 v[28:29], v11 offset:0
    ds_read_b64_tr_b16 v[30:31], v11 offset:1024
    ds_read_b64_tr_b16 v[32:33], v12 offset:0
    ds_read_b64_tr_b16 v[34:35], v12 offset:1024
    ds_read_b64_tr_b16 v[36:37], v13 offset:0
    ds_read_b64_tr_b16 v[38:39], v13 offset:1024
    ds_read_b64_tr_b16 v[40:41], v14 offset:0
    ds_read_b64_tr_b16 v[42:43], v14 offset:1024
    ds_read_b64_tr_b16 v[44:45], v15 offset:0
    ds_read_b64_tr_b16 v[46:47], v15 offset:1024
    v_cvt_pk_bf16_f32 v128, v128, v129
    v_cvt_pk_bf16_f32 v129, v130, v131
    v_cvt_pk_bf16_f32 v130, v132, v133
    v_cvt_pk_bf16_f32 v131, v134, v135
    v_cvt_pk_bf16_f32 v132, v136, v137
    v_cvt_pk_bf16_f32 v133, v138, v139
    v_cvt_pk_bf16_f32 v134, v140, v141
    v_cvt_pk_bf16_f32 v135, v142, v143
    v_cvt_pk_bf16_f32 v136, v144, v145
    v_cvt_pk_bf16_f32 v137, v146, v147
    v_cvt_pk_bf16_f32 v138, v148, v149
    v_cvt_pk_bf16_f32 v139, v150, v151
    v_cvt_pk_bf16_f32 v140, v152, v153
    v_cvt_pk_bf16_f32 v141, v154, v155
    v_cvt_pk_bf16_f32 v142, v156, v157
    v_cvt_pk_bf16_f32 v143, v158, v159
    v_cvt_pk_bf16_f32 v144, v160, v161
    v_cvt_pk_bf16_f32 v145, v162, v163
    v_cvt_pk_bf16_f32 v146, v164, v165
    v_cvt_pk_bf16_f32 v147, v166, v167
    v_cvt_pk_bf16_f32 v148, v168, v169
    v_cvt_pk_bf16_f32 v149, v170, v171
    v_cvt_pk_bf16_f32 v150, v172, v173
    v_cvt_pk_bf16_f32 v151, v174, v175
    v_cvt_pk_bf16_f32 v152, v176, v177
    v_cvt_pk_bf16_f32 v153, v178, v179
    v_cvt_pk_bf16_f32 v154, v180, v181
    v_cvt_pk_bf16_f32 v155, v182, v183
    v_cvt_pk_bf16_f32 v156, v184, v185
    v_cvt_pk_bf16_f32 v157, v186, v187
    v_cvt_pk_bf16_f32 v158, v188, v189
    v_cvt_pk_bf16_f32 v159, v190, v191
    v_cvt_pk_bf16_f32 v160, v192, v193
    v_cvt_pk_bf16_f32 v161, v194, v195
    v_cvt_pk_bf16_f32 v162, v196, v197
    v_cvt_pk_bf16_f32 v163, v198, v199
    v_cvt_pk_bf16_f32 v164, v200, v201
    v_cvt_pk_bf16_f32 v165, v202, v203
    v_cvt_pk_bf16_f32 v166, v204, v205
    v_cvt_pk_bf16_f32 v167, v206, v207
    v_cvt_pk_bf16_f32 v168, v208, v209
    v_cvt_pk_bf16_f32 v169, v210, v211
    v_cvt_pk_bf16_f32 v170, v212, v213
    v_cvt_pk_bf16_f32 v171, v214, v215
    v_cvt_pk_bf16_f32 v172, v216, v217
    v_cvt_pk_bf16_f32 v173, v218, v219
    v_cvt_pk_bf16_f32 v174, v220, v221
    v_cvt_pk_bf16_f32 v175, v222, v223
    v_cvt_pk_bf16_f32 v176, v224, v225
    v_cvt_pk_bf16_f32 v177, v226, v227
    v_cvt_pk_bf16_f32 v178, v228, v229
    v_cvt_pk_bf16_f32 v179, v230, v231
    v_cvt_pk_bf16_f32 v180, v232, v233
    v_cvt_pk_bf16_f32 v181, v234, v235
    v_cvt_pk_bf16_f32 v182, v236, v237
    v_cvt_pk_bf16_f32 v183, v238, v239
    v_cvt_pk_bf16_f32 v184, v240, v241
    v_cvt_pk_bf16_f32 v185, v242, v243
    v_cvt_pk_bf16_f32 v186, v244, v245
    v_cvt_pk_bf16_f32 v187, v246, v247
    v_cvt_pk_bf16_f32 v188, v248, v249
    v_cvt_pk_bf16_f32 v189, v250, v251
    v_cvt_pk_bf16_f32 v190, v252, v253
    v_cvt_pk_bf16_f32 v191, v254, v255
    s_mov_b32 s51, 0x55555555
    s_lshl_b32 s38, s29, 20
    s_lshl_b32 s37, s30, 17
    s_add_u32 s38, s38, s37
    s_bfe_u32 s37, s28, 0x10001
    s_lshl_b32 s37, s37, 16
    s_add_u32 s38, s38, s37
    s_lshr_b32 s36, s28, 2
    s_lshl_b32 s37, s36, 15
    s_add_u32 s38, s38, s37
    s_and_b32 s37, s28, 1
    s_add_u32 s36, s36, 11
    s_lshl_b32 s37, s37, s36
    s_add_u32 s38, s38, s37
    s_cmp_lt_u32 s28, 4
    s_cselect_b32 s36, 4, 32
    s_cselect_b32 s37, 16, 64
    s_cselect_b32 s39, 32, 4
    s_lshl_b32 s36, s36, 8
    s_lshl_b32 s37, s37, 8
    s_lshl_b32 s39, s39, 8
    s_mov_b32 s46, s38
    s_add_u32 s47, s46, s39
    s_add_u32 s48, s47, s39
    s_add_u32 s49, s48, s39
    s_cmp_eq_u32 s30, 0
    s_cselect_b32 s50, 0xffff, s51
    s_cselect_b32 s52, 4, 0
    v_lshlrev_b32 v58, 4, v1
    v_add_u32 v59, s36, v58
    v_add_u32 v60, s37, v58
    v_add_u32 v61, s36, v60
    v_mov_b32 v192, 0
    v_mov_b32 v193, 0
    v_mov_b32 v194, 0
    v_mov_b32 v195, 0
    v_mov_b32 v196, 0
    v_mov_b32 v197, 0
    v_mov_b32 v198, 0
    v_mov_b32 v199, 0
    v_mov_b32 v200, 0
    v_mov_b32 v201, 0
    v_mov_b32 v202, 0
    v_mov_b32 v203, 0
    v_mov_b32 v204, 0
    v_mov_b32 v205, 0
    v_mov_b32 v206, 0
    v_mov_b32 v207, 0
    v_mov_b32 v208, 0
    v_mov_b32 v209, 0
    v_mov_b32 v210, 0
    v_mov_b32 v211, 0
    v_mov_b32 v212, 0
    v_mov_b32 v213, 0
    v_mov_b32 v214, 0
    v_mov_b32 v215, 0
    v_mov_b32 v216, 0
    v_mov_b32 v217, 0
    v_mov_b32 v218, 0
    v_mov_b32 v219, 0
    v_mov_b32 v220, 0
    v_mov_b32 v221, 0
    v_mov_b32 v222, 0
    v_mov_b32 v223, 0
    v_mov_b32 v224, 0
    v_mov_b32 v225, 0
    v_mov_b32 v226, 0
    v_mov_b32 v227, 0
    v_mov_b32 v228, 0
    v_mov_b32 v229, 0
    v_mov_b32 v230, 0
    v_mov_b32 v231, 0
    v_mov_b32 v232, 0
    v_mov_b32 v233, 0
    v_mov_b32 v234, 0
    v_mov_b32 v235, 0
    v_mov_b32 v236, 0
    v_mov_b32 v237, 0
    v_mov_b32 v238, 0
    v_mov_b32 v239, 0
    v_mov_b32 v240, 0
    v_mov_b32 v241, 0
    v_mov_b32 v242, 0
    v_mov_b32 v243, 0
    v_mov_b32 v244, 0
    v_mov_b32 v245, 0
    v_mov_b32 v246, 0
    v_mov_b32 v247, 0
    v_mov_b32 v248, 0
    v_mov_b32 v249, 0
    v_mov_b32 v250, 0
    v_mov_b32 v251, 0
    v_mov_b32 v252, 0
    v_mov_b32 v253, 0
    v_mov_b32 v254, 0
    v_mov_b32 v255, 0
    s_mov_b32 s35, 0
    s_waitcnt vmcnt(6)
    .p2align 6
L_p2_loop:
    s_cmp_ge_u32 s35, 2
    s_cbranch_scc1 L_recurrent_scan__compressed_kv_cla__moe_arch_mod__prompt_kernel_rare_61
L_recurrent_scan__compressed_kv_cla__moe_arch_mod__prompt_kernel_back_62:
    s_waitcnt lgkmcnt(8)
    v_mfma_f32_16x16x32_bf16 v[192:195], v[24:27], v[64:67], v[192:195]
    ds_read_b64_tr_b16 v[48:49], v16 offset:0
    v_mfma_f32_16x16x32_bf16 v[224:227], v[24:27], v[68:71], v[224:227]
    ds_read_b64_tr_b16 v[50:51], v16 offset:1024
    v_mfma_f32_16x16x32_bf16 v[196:199], v[28:31], v[64:67], v[196:199]
    ds_read_b64_tr_b16 v[52:53], v17 offset:0
    buffer_load_dwordx4 v[120:123], v6, s[8:11], s32 offen offset:3072 sc1
    v_mfma_f32_16x16x32_bf16 v[228:231], v[28:31], v[68:71], v[228:231]
    ds_read_b64_tr_b16 v[54:55], v17 offset:1024
    s_waitcnt lgkmcnt(8)
    v_mfma_f32_16x16x32_bf16 v[200:203], v[32:35], v[64:67], v[200:203]
    ds_read_b64_tr_b16 v[24:25], v10 offset:8192
    v_mfma_f32_16x16x32_bf16 v[232:235], v[32:35], v[68:71], v[232:235]
    ds_read_b64_tr_b16 v[26:27], v10 offset:9216
    v_mfma_f32_16x16x32_bf16 v[204:207], v[36:39], v[64:67], v[204:207]
    ds_read_b64_tr_b16 v[28:29], v11 offset:8192
    buffer_load_dwordx4 v[124:127], v7, s[8:11], s32 offen offset:3072 sc1
    v_mfma_f32_16x16x32_bf16 v[236:239], v[36:39], v[68:71], v[236:239]
    ds_read_b64_tr_b16 v[30:31], v11 offset:9216
    s_add_u32 s32, s32, 4096
    s_waitcnt lgkmcnt(8)
    v_mfma_f32_16x16x32_bf16 v[208:211], v[40:43], v[64:67], v[208:211]
    ds_read_b64_tr_b16 v[32:33], v12 offset:8192
    s_cmp_lt_u32 s35, 3
    s_cselect_b32 s10, 4194304, 0
    v_mfma_f32_16x16x32_bf16 v[240:243], v[40:43], v[68:71], v[240:243]
    ds_read_b64_tr_b16 v[34:35], v12 offset:9216
    s_bitcmp1_b32 s50, 0
    s_cbranch_scc1 L_recurrent_scan__compressed_kv_cla__moe_arch_mod__prompt_kernel_rare_75
L_recurrent_scan__compressed_kv_cla__moe_arch_mod__prompt_kernel_back_76:
    v_mfma_f32_16x16x32_bf16 v[212:215], v[44:47], v[64:67], v[212:215]
    ds_read_b64_tr_b16 v[36:37], v13 offset:8192
    v_mfma_f32_16x16x32_bf16 v[244:247], v[44:47], v[68:71], v[244:247]
    ds_read_b64_tr_b16 v[38:39], v13 offset:9216
    s_waitcnt lgkmcnt(8)
    v_mfma_f32_16x16x32_bf16 v[216:219], v[48:51], v[64:67], v[216:219]
    ds_read_b64_tr_b16 v[40:41], v14 offset:8192
    v_mfma_f32_16x16x32_bf16 v[248:251], v[48:51], v[68:71], v[248:251]
    ds_read_b64_tr_b16 v[42:43], v14 offset:9216
    s_bitcmp1_b32 s50, 2
    s_cbranch_scc1 L_recurrent_scan__compressed_kv_cla__moe_arch_mod__prompt_kernel_rare_87
L_recurrent_scan__compressed_kv_cla__moe_arch_mod__prompt_kernel_back_88:
    v_mfma_f32_16x16x32_bf16 v[220:223], v[52:55], v[64:67], v[220:223]
    ds_read_b64_tr_b16 v[44:45], v15 offset:8192
    v_mfma_f32_16x16x32_bf16 v[252:255], v[52:55], v[68:71], v[252:255]
    ds_read_b64_tr_b16 v[46:47], v15 offset:9216
    s_waitcnt lgkmcnt(8)
    v_mfma_f32_16x16x32_bf16 v[192:195], v[24:27], v[72:75], v[192:195]
    ds_read_b64_tr_b16 v[48:49], v16 offset:8192
    v_mfma_f32_16x16x32_bf16 v[224:227], v[24:27], v[76:79], v[224:227]
    ds_read_b64_tr_b16 v[50:51], v16 offset:9216
    v_mfma_f32_16x16x32_bf16 v[196:199], v[28:31], v[72:75], v[196:199]
    ds_read_b64_tr_b16 v[52:53], v17 offset:8192
    buffer_load_dwordx4 v[64:67], v6, s[8:11], s32 offen offset:0 sc1
    v_mfma_f32_16x16x32_bf16 v[228:231], v[28:31], v[76:79], v[228:231]
    ds_read_b64_tr_b16 v[54:55], v17 offset:9216
    s_waitcnt lgkmcnt(8)
    v_mfma_f32_16x16x32_bf16 v[200:203], v[32:35], v[72:75], v[200:203]
    ds_read_b64_tr_b16 v[24:25], v10 offset:16384
    v_mfma_f32_16x16x32_bf16 v[232:235], v[32:35], v[76:79], v[232:235]
    ds_read_b64_tr_b16 v[26:27], v10 offset:17408
    v_mfma_f32_16x16x32_bf16 v[204:207], v[36:39], v[72:75], v[204:207]
    ds_read_b64_tr_b16 v[28:29], v11 offset:16384
    buffer_load_dwordx4 v[68:71], v7, s[8:11], s32 offen offset:0 sc1
    v_mfma_f32_16x16x32_bf16 v[236:239], v[36:39], v[76:79], v[236:239]
    ds_read_b64_tr_b16 v[30:31], v11 offset:17408
    s_waitcnt lgkmcnt(8)
    v_mfma_f32_16x16x32_bf16 v[208:211], v[40:43], v[72:75], v[208:211]
    ds_read_b64_tr_b16 v[32:33], v12 offset:16384
    v_mfma_f32_16x16x32_bf16 v[240:243], v[40:43], v[76:79], v[240:243]
    ds_read_b64_tr_b16 v[34:35], v12 offset:17408
    v_mfma_f32_16x16x32_bf16 v[212:215], v[44:47], v[72:75], v[212:215]
    ds_read_b64_tr_b16 v[36:37], v13 offset:16384
    v_mfma_f32_16x16x32_bf16 v[244:247], v[44:47], v[76:79], v[244:247]
    ds_read_b64_tr_b16 v[38:39], v13 offset:17408
    s_bitcmp1_b32 s50, 1
    s_cbranch_scc1 L_recurrent_scan__compressed_kv_cla__moe_arch_mod__prompt_kernel_rare_79
L_recurrent_scan__compressed_kv_cla__moe_arch_mod__prompt_kernel_back_80:
    s_waitcnt lgkmcnt(8)
    v_mfma_f32_16x16x32_bf16 v[216:219], v[48:51], v[72:75], v[216:219]
    ds_read_b64_tr_b16 v[40:41], v14 offset:16384
    v_mfma_f32_16x16x32_bf16 v[248:251], v[48:51], v[76:79], v[248:251]
    ds_read_b64_tr_b16 v[42:43], v14 offset:17408
    v_mfma_f32_16x16x32_bf16 v[220:223], v[52:55], v[72:75], v[220:223]
    ds_read_b64_tr_b16 v[44:45], v15 offset:16384
    v_mfma_f32_16x16x32_bf16 v[252:255], v[52:55], v[76:79], v[252:255]
    ds_read_b64_tr_b16 v[46:47], v15 offset:17408
    s_bitcmp1_b32 s50, 3
    s_cbranch_scc1 L_recurrent_scan__compressed_kv_cla__moe_arch_mod__prompt_kernel_rare_91
L_recurrent_scan__compressed_kv_cla__moe_arch_mod__prompt_kernel_back_92:
    s_waitcnt lgkmcnt(8)
    v_mfma_f32_16x16x32_bf16 v[192:195], v[24:27], v[80:83], v[192:195]
    ds_read_b64_tr_b16 v[48:49], v16 offset:16384
    v_mfma_f32_16x16x32_bf16 v[224:227], v[24:27], v[84:87], v[224:227]
    ds_read_b64_tr_b16 v[50:51], v16 offset:17408
    v_mfma_f32_16x16x32_bf16 v[196:199], v[28:31], v[80:83], v[196:199]
    ds_read_b64_tr_b16 v[52:53], v17 offset:16384
    buffer_load_dwordx4 v[72:75], v6, s[8:11], s32 offen offset:1024 sc1
    v_mfma_f32_16x16x32_bf16 v[228:231], v[28:31], v[84:87], v[228:231]
    ds_read_b64_tr_b16 v[54:55], v17 offset:17408
    s_waitcnt lgkmcnt(8)
    v_mfma_f32_16x16x32_bf16 v[200:203], v[32:35], v[80:83], v[200:203]
    ds_read_b64_tr_b16 v[24:25], v10 offset:24576
    v_mfma_f32_16x16x32_bf16 v[232:235], v[32:35], v[84:87], v[232:235]
    ds_read_b64_tr_b16 v[26:27], v10 offset:25600
    v_mfma_f32_16x16x32_bf16 v[204:207], v[36:39], v[80:83], v[204:207]
    ds_read_b64_tr_b16 v[28:29], v11 offset:24576
    buffer_load_dwordx4 v[76:79], v7, s[8:11], s32 offen offset:1024 sc1
    v_mfma_f32_16x16x32_bf16 v[236:239], v[36:39], v[84:87], v[236:239]
    ds_read_b64_tr_b16 v[30:31], v11 offset:25600
    s_waitcnt lgkmcnt(8)
    v_mfma_f32_16x16x32_bf16 v[208:211], v[40:43], v[80:83], v[208:211]
    ds_read_b64_tr_b16 v[32:33], v12 offset:24576
    v_mfma_f32_16x16x32_bf16 v[240:243], v[40:43], v[84:87], v[240:243]
    ds_read_b64_tr_b16 v[34:35], v12 offset:25600
    v_mfma_f32_16x16x32_bf16 v[212:215], v[44:47], v[80:83], v[212:215]
    ds_read_b64_tr_b16 v[36:37], v13 offset:24576
    v_mfma_f32_16x16x32_bf16 v[244:247], v[44:47], v[84:87], v[244:247]
    ds_read_b64_tr_b16 v[38:39], v13 offset:25600
    s_waitcnt lgkmcnt(8)
    v_mfma_f32_16x16x32_bf16 v[216:219], v[48:51], v[80:83], v[216:219]
    ds_read_b64_tr_b16 v[40:41], v14 offset:24576
    v_mfma_f32_16x16x32_bf16 v[248:251], v[48:51], v[84:87], v[248:251]
    ds_read_b64_tr_b16 v[42:43], v14 offset:25600
    v_mfma_f32_16x16x32_bf16 v[220:223], v[52:55], v[80:83], v[220:223]
    ds_read_b64_tr_b16 v[44:45], v15 offset:24576
    v_mfma_f32_16x16x32_bf16 v[252:255], v[52:55], v[84:87], v[252:255]
    ds_read_b64_tr_b16 v[46:47], v15 offset:25600
    s_waitcnt lgkmcnt(8)
    s_waitcnt vmcnt(16)
    v_mfma_f32_16x16x32_bf16 v[192:195], v[24:27], v[88:91], v[192:195]
    ds_read_b64_tr_b16 v[48:49], v16 offset:24576
    v_mfma_f32_16x16x32_bf16 v[224:227], v[24:27], v[92:95], v[224:227]
    ds_read_b64_tr_b16 v[50:51], v16 offset:25600
    v_mfma_f32_16x16x32_bf16 v[196:199], v[28:31], v[88:91], v[196:199]
    ds_read_b64_tr_b16 v[52:53], v17 offset:24576
    buffer_load_dwordx4 v[80:83], v6, s[8:11], s32 offen offset:2048 sc1
    v_mfma_f32_16x16x32_bf16 v[228:231], v[28:31], v[92:95], v[228:231]
    ds_read_b64_tr_b16 v[54:55], v17 offset:25600
    s_waitcnt lgkmcnt(8)
    v_mfma_f32_16x16x32_bf16 v[200:203], v[32:35], v[88:91], v[200:203]
    v_mfma_f32_16x16x32_bf16 v[232:235], v[32:35], v[92:95], v[232:235]
    v_mfma_f32_16x16x32_bf16 v[204:207], v[36:39], v[88:91], v[204:207]
    buffer_load_dwordx4 v[84:87], v7, s[8:11], s32 offen offset:2048 sc1
    v_mfma_f32_16x16x32_bf16 v[236:239], v[36:39], v[92:95], v[236:239]
    s_cmp_ge_u32 s35, 2
    s_cbranch_scc1 L_recurrent_scan__compressed_kv_cla__moe_arch_mod__prompt_kernel_rare_51
L_recurrent_scan__compressed_kv_cla__moe_arch_mod__prompt_kernel_back_52:
    s_waitcnt lgkmcnt(0)
    s_waitcnt vmcnt(8)
    s_barrier
    v_mfma_f32_16x16x32_bf16 v[208:211], v[40:43], v[88:91], v[208:211]
    ds_read_b64_tr_b16 v[24:25], v10 offset:32768
    ds_read_b64_tr_b16 v[26:27], v10 offset:33792
    v_mfma_f32_16x16x32_bf16 v[240:243], v[40:43], v[92:95], v[240:243]
    ds_read_b64_tr_b16 v[28:29], v11 offset:32768
    ds_read_b64_tr_b16 v[30:31], v11 offset:33792
    v_mfma_f32_16x16x32_bf16 v[212:215], v[44:47], v[88:91], v[212:215]
    ds_read_b64_tr_b16 v[32:33], v12 offset:32768
    ds_read_b64_tr_b16 v[34:35], v12 offset:33792
    v_mfma_f32_16x16x32_bf16 v[244:247], v[44:47], v[92:95], v[244:247]
    ds_read_b64_tr_b16 v[36:37], v13 offset:32768
    ds_read_b64_tr_b16 v[38:39], v13 offset:33792
    s_add_u32 m0, s33, 0
    v_mfma_f32_16x16x32_bf16 v[216:219], v[48:51], v[88:91], v[216:219]
    ds_read_b64_tr_b16 v[40:41], v14 offset:32768
    ds_read_b64_tr_b16 v[42:43], v14 offset:33792
    buffer_load_dwordx4 v2, s[4:7], s31 offen offset:0 sc1 lds
    v_mfma_f32_16x16x32_bf16 v[248:251], v[48:51], v[92:95], v[248:251]
    buffer_load_dwordx4 v3, s[4:7], s31 offen offset:1024 sc1 lds
    v_mfma_f32_16x16x32_bf16 v[220:223], v[52:55], v[88:91], v[220:223]
    ds_read_b64_tr_b16 v[44:45], v15 offset:32768
    ds_read_b64_tr_b16 v[46:47], v15 offset:33792
    buffer_load_dwordx4 v4, s[4:7], s31 offen offset:2048 sc1 lds
    v_mfma_f32_16x16x32_bf16 v[252:255], v[52:55], v[92:95], v[252:255]
    buffer_load_dwordx4 v5, s[4:7], s31 offen offset:3072 sc1 lds
    s_add_u32 s31, s31, s40
    s_cmp_ge_u32 s35, 2
    s_cbranch_scc1 L_recurrent_scan__compressed_kv_cla__moe_arch_mod__prompt_kernel_rare_67
L_recurrent_scan__compressed_kv_cla__moe_arch_mod__prompt_kernel_back_68:
    s_waitcnt lgkmcnt(8)
    s_waitcnt vmcnt(18)
    v_mfma_f32_16x16x32_bf16 v[192:195], v[24:27], v[96:99], v[192:195]
    ds_read_b64_tr_b16 v[48:49], v16 offset:32768
    v_mfma_f32_16x16x32_bf16 v[224:227], v[24:27], v[100:103], v[224:227]
    ds_read_b64_tr_b16 v[50:51], v16 offset:33792
    v_mfma_f32_16x16x32_bf16 v[196:199], v[28:31], v[96:99], v[196:199]
    ds_read_b64_tr_b16 v[52:53], v17 offset:32768
    buffer_load_dwordx4 v[88:91], v6, s[8:11], s32 offen offset:3072 sc1
    v_mfma_f32_16x16x32_bf16 v[228:231], v[28:31], v[100:103], v[228:231]
    ds_read_b64_tr_b16 v[54:55], v17 offset:33792
    s_waitcnt lgkmcnt(8)
    v_mfma_f32_16x16x32_bf16 v[200:203], v[32:35], v[96:99], v[200:203]
    ds_read_b64_tr_b16 v[24:25], v10 offset:40960
    v_mfma_f32_16x16x32_bf16 v[232:235], v[32:35], v[100:103], v[232:235]
    ds_read_b64_tr_b16 v[26:27], v10 offset:41984
    v_mfma_f32_16x16x32_bf16 v[204:207], v[36:39], v[96:99], v[204:207]
    ds_read_b64_tr_b16 v[28:29], v11 offset:40960
    buffer_load_dwordx4 v[92:95], v7, s[8:11], s32 offen offset:3072 sc1
    v_mfma_f32_16x16x32_bf16 v[236:239], v[36:39], v[100:103], v[236:239]
    ds_read_b64_tr_b16 v[30:31], v11 offset:41984
    s_add_u32 s32, s32, 4096
    s_waitcnt lgkmcnt(8)
    v_mfma_f32_16x16x32_bf16 v[208:211], v[40:43], v[96:99], v[208:211]
    ds_read_b64_tr_b16 v[32:33], v12 offset:40960
    v_mfma_f32_16x16x32_bf16 v[240:243], v[40:43], v[100:103], v[240:243]
    ds_read_b64_tr_b16 v[34:35], v12 offset:41984
    s_bitcmp1_b32 s50, 4
    s_cbranch_scc1 L_recurrent_scan__compressed_kv_cla__moe_arch_mod__prompt_kernel_rare_99
L_recurrent_scan__compressed_kv_cla__moe_arch_mod__prompt_kernel_back_100:
    v_mfma_f32_16x16x32_bf16 v[212:215], v[44:47], v[96:99], v[212:215]
    ds_read_b64_tr_b16 v[36:37], v13 offset:40960
    v_mfma_f32_16x16x32_bf16 v[244:247], v[44:47], v[100:103], v[244:247]
    ds_read_b64_tr_b16 v[38:39], v13 offset:41984
    s_waitcnt lgkmcnt(8)
    v_mfma_f32_16x16x32_bf16 v[216:219], v[48:51], v[96:99], v[216:219]
    ds_read_b64_tr_b16 v[40:41], v14 offset:40960
    v_mfma_f32_16x16x32_bf16 v[248:251], v[48:51], v[100:103], v[248:251]
    ds_read_b64_tr_b16 v[42:43], v14 offset:41984
    s_bitcmp1_b32 s50, 6
    s_cbranch_scc1 L_recurrent_scan__compressed_kv_cla__moe_arch_mod__prompt_kernel_rare_111
L_recurrent_scan__compressed_kv_cla__moe_arch_mod__prompt_kernel_back_112:
    v_mfma_f32_16x16x32_bf16 v[220:223], v[52:55], v[96:99], v[220:223]
    ds_read_b64_tr_b16 v[44:45], v15 offset:40960
    v_mfma_f32_16x16x32_bf16 v[252:255], v[52:55], v[100:103], v[252:255]
    ds_read_b64_tr_b16 v[46:47], v15 offset:41984
    s_waitcnt lgkmcnt(8)
    s_waitcnt vmcnt(20)
    v_mfma_f32_16x16x32_bf16 v[192:195], v[24:27], v[104:107], v[192:195]
    ds_read_b64_tr_b16 v[48:49], v16 offset:40960
    v_mfma_f32_16x16x32_bf16 v[224:227], v[24:27], v[108:111], v[224:227]
    ds_read_b64_tr_b16 v[50:51], v16 offset:41984
    v_mfma_f32_16x16x32_bf16 v[196:199], v[28:31], v[104:107], v[196:199]
    ds_read_b64_tr_b16 v[52:53], v17 offset:40960
    buffer_load_dwordx4 v[96:99], v6, s[8:11], s32 offen offset:0 sc1
    v_mfma_f32_16x16x32_bf16 v[228:231], v[28:31], v[108:111], v[228:231]
    ds_read_b64_tr_b16 v[54:55], v17 offset:41984
    s_waitcnt lgkmcnt(8)
    v_mfma_f32_16x16x32_bf16 v[200:203], v[32:35], v[104:107], v[200:203]
    ds_read_b64_tr_b16 v[24:25], v10 offset:49152
    v_mfma_f32_16x16x32_bf16 v[232:235], v[32:35], v[108:111], v[232:235]
    ds_read_b64_tr_b16 v[26:27], v10 offset:50176
    v_mfma_f32_16x16x32_bf16 v[204:207], v[36:39], v[104:107], v[204:207]
    ds_read_b64_tr_b16 v[28:29], v11 offset:49152
    buffer_load_dwordx4 v[100:103], v7, s[8:11], s32 offen offset:0 sc1
    v_mfma_f32_16x16x32_bf16 v[236:239], v[36:39], v[108:111], v[236:239]
    ds_read_b64_tr_b16 v[30:31], v11 offset:50176
    s_waitcnt lgkmcnt(8)
    v_mfma_f32_16x16x32_bf16 v[208:211], v[40:43], v[104:107], v[208:211]
    ds_read_b64_tr_b16 v[32:33], v12 offset:49152
    v_mfma_f32_16x16x32_bf16 v[240:243], v[40:43], v[108:111], v[240:243]
    ds_read_b64_tr_b16 v[34:35], v12 offset:50176
    v_mfma_f32_16x16x32_bf16 v[212:215], v[44:47], v[104:107], v[212:215]
    ds_read_b64_tr_b16 v[36:37], v13 offset:49152
    v_mfma_f32_16x16x32_bf16 v[244:247], v[44:47], v[108:111], v[244:247]
    ds_read_b64_tr_b16 v[38:39], v13 offset:50176
    s_bitcmp1_b32 s50, 5
    s_cbranch_scc1 L_recurrent_scan__compressed_kv_cla__moe_arch_mod__prompt_kernel_rare_103
L_recurrent_scan__compressed_kv_cla__moe_arch_mod__prompt_kernel_back_104:
    s_waitcnt lgkmcnt(8)
    v_mfma_f32_16x16x32_bf16 v[216:219], v[48:51], v[104:107], v[216:219]
    ds_read_b64_tr_b16 v[40:41], v14 offset:49152
    v_mfma_f32_16x16x32_bf16 v[248:251], v[48:51], v[108:111], v[248:251]
    ds_read_b64_tr_b16 v[42:43], v14 offset:50176
    v_mfma_f32_16x16x32_bf16 v[220:223], v[52:55], v[104:107], v[220:223]
    ds_read_b64_tr_b16 v[44:45], v15 offset:49152
    v_mfma_f32_16x16x32_bf16 v[252:255], v[52:55], v[108:111], v[252:255]
    ds_read_b64_tr_b16 v[46:47], v15 offset:50176
    s_bitcmp1_b32 s50, 7
    s_cbranch_scc1 L_recurrent_scan__compressed_kv_cla__moe_arch_mod__prompt_kernel_rare_115
L_recurrent_scan__compressed_kv_cla__moe_arch_mod__prompt_kernel_back_116:
    s_waitcnt lgkmcnt(8)
    s_waitcnt vmcnt(20)
    v_mfma_f32_16x16x32_bf16 v[192:195], v[24:27], v[112:115], v[192:195]
    ds_read_b64_tr_b16 v[48:49], v16 offset:49152
    v_mfma_f32_16x16x32_bf16 v[224:227], v[24:27], v[116:119], v[224:227]
    ds_read_b64_tr_b16 v[50:51], v16 offset:50176
    v_mfma_f32_16x16x32_bf16 v[196:199], v[28:31], v[112:115], v[196:199]
    ds_read_b64_tr_b16 v[52:53], v17 offset:49152
    buffer_load_dwordx4 v[104:107], v6, s[8:11], s32 offen offset:1024 sc1
    v_mfma_f32_16x16x32_bf16 v[228:231], v[28:31], v[116:119], v[228:231]
    ds_read_b64_tr_b16 v[54:55], v17 offset:50176
    s_waitcnt lgkmcnt(8)
    v_mfma_f32_16x16x32_bf16 v[200:203], v[32:35], v[112:115], v[200:203]
    ds_read_b64_tr_b16 v[24:25], v10 offset:57344
    v_mfma_f32_16x16x32_bf16 v[232:235], v[32:35], v[116:119], v[232:235]
    ds_read_b64_tr_b16 v[26:27], v10 offset:58368
    v_mfma_f32_16x16x32_bf16 v[204:207], v[36:39], v[112:115], v[204:207]
    ds_read_b64_tr_b16 v[28:29], v11 offset:57344
    buffer_load_dwordx4 v[108:111], v7, s[8:11], s32 offen offset:1024 sc1
    v_mfma_f32_16x16x32_bf16 v[236:239], v[36:39], v[116:119], v[236:239]
    ds_read_b64_tr_b16 v[30:31], v11 offset:58368
    s_waitcnt lgkmcnt(8)
    v_mfma_f32_16x16x32_bf16 v[208:211], v[40:43], v[112:115], v[208:211]
    ds_read_b64_tr_b16 v[32:33], v12 offset:57344
    v_mfma_f32_16x16x32_bf16 v[240:243], v[40:43], v[116:119], v[240:243]
    ds_read_b64_tr_b16 v[34:35], v12 offset:58368
    v_mfma_f32_16x16x32_bf16 v[212:215], v[44:47], v[112:115], v[212:215]
    ds_read_b64_tr_b16 v[36:37], v13 offset:57344
    v_mfma_f32_16x16x32_bf16 v[244:247], v[44:47], v[116:119], v[244:247]
    ds_read_b64_tr_b16 v[38:39], v13 offset:58368
    s_waitcnt lgkmcnt(8)
    v_mfma_f32_16x16x32_bf16 v[216:219], v[48:51], v[112:115], v[216:219]
    ds_read_b64_tr_b16 v[40:41], v14 offset:57344
    v_mfma_f32_16x16x32_bf16 v[248:251], v[48:51], v[116:119], v[248:251]
    ds_read_b64_tr_b16 v[42:43], v14 offset:58368
    v_mfma_f32_16x16x32_bf16 v[220:223], v[52:55], v[112:115], v[220:223]
    ds_read_b64_tr_b16 v[44:45], v15 offset:57344
    v_mfma_f32_16x16x32_bf16 v[252:255], v[52:55], v[116:119], v[252:255]
    ds_read_b64_tr_b16 v[46:47], v15 offset:58368
    s_waitcnt lgkmcnt(8)
    s_waitcnt vmcnt(16)
    v_mfma_f32_16x16x32_bf16 v[192:195], v[24:27], v[120:123], v[192:195]
    ds_read_b64_tr_b16 v[48:49], v16 offset:57344
    v_mfma_f32_16x16x32_bf16 v[224:227], v[24:27], v[124:127], v[224:227]
    ds_read_b64_tr_b16 v[50:51], v16 offset:58368
    v_mfma_f32_16x16x32_bf16 v[196:199], v[28:31], v[120:123], v[196:199]
    ds_read_b64_tr_b16 v[52:53], v17 offset:57344
    buffer_load_dwordx4 v[112:115], v6, s[8:11], s32 offen offset:2048 sc1
    v_mfma_f32_16x16x32_bf16 v[228:231], v[28:31], v[124:127], v[228:231]
    ds_read_b64_tr_b16 v[54:55], v17 offset:58368
    s_waitcnt lgkmcnt(8)
    v_mfma_f32_16x16x32_bf16 v[200:203], v[32:35], v[120:123], v[200:203]
    v_mfma_f32_16x16x32_bf16 v[232:235], v[32:35], v[124:127], v[232:235]
    v_mfma_f32_16x16x32_bf16 v[204:207], v[36:39], v[120:123], v[204:207]
    buffer_load_dwordx4 v[116:119], v7, s[8:11], s32 offen offset:2048 sc1
    v_mfma_f32_16x16x32_bf16 v[236:239], v[36:39], v[124:127], v[236:239]
    s_cmp_ge_u32 s35, 2
    s_cbranch_scc1 L_recurrent_scan__compressed_kv_cla__moe_arch_mod__prompt_kernel_rare_56
L_recurrent_scan__compressed_kv_cla__moe_arch_mod__prompt_kernel_back_57:
    s_waitcnt lgkmcnt(0)
    s_waitcnt vmcnt(8)
    s_barrier
    v_mfma_f32_16x16x32_bf16 v[208:211], v[40:43], v[120:123], v[208:211]
    ds_read_b64_tr_b16 v[24:25], v10 offset:0
    ds_read_b64_tr_b16 v[26:27], v10 offset:1024
    v_mfma_f32_16x16x32_bf16 v[240:243], v[40:43], v[124:127], v[240:243]
    ds_read_b64_tr_b16 v[28:29], v11 offset:0
    ds_read_b64_tr_b16 v[30:31], v11 offset:1024
    v_mfma_f32_16x16x32_bf16 v[212:215], v[44:47], v[120:123], v[212:215]
    ds_read_b64_tr_b16 v[32:33], v12 offset:0
    ds_read_b64_tr_b16 v[34:35], v12 offset:1024
    v_mfma_f32_16x16x32_bf16 v[244:247], v[44:47], v[124:127], v[244:247]
    ds_read_b64_tr_b16 v[36:37], v13 offset:0
    ds_read_b64_tr_b16 v[38:39], v13 offset:1024
    s_add_u32 m0, s33, 32768
    v_mfma_f32_16x16x32_bf16 v[216:219], v[48:51], v[120:123], v[216:219]
    ds_read_b64_tr_b16 v[40:41], v14 offset:0
    ds_read_b64_tr_b16 v[42:43], v14 offset:1024
    buffer_load_dwordx4 v2, s[4:7], s31 offen offset:0 sc1 lds
    v_mfma_f32_16x16x32_bf16 v[248:251], v[48:51], v[124:127], v[248:251]
    buffer_load_dwordx4 v3, s[4:7], s31 offen offset:1024 sc1 lds
    v_mfma_f32_16x16x32_bf16 v[220:223], v[52:55], v[120:123], v[220:223]
    ds_read_b64_tr_b16 v[44:45], v15 offset:0
    ds_read_b64_tr_b16 v[46:47], v15 offset:1024
    buffer_load_dwordx4 v4, s[4:7], s31 offen offset:2048 sc1 lds
    v_mfma_f32_16x16x32_bf16 v[252:255], v[52:55], v[124:127], v[252:255]
    buffer_load_dwordx4 v5, s[4:7], s31 offen offset:3072 sc1 lds
    s_add_u32 s31, s31, s40
    s_lshr_b32 s50, s50, 8
    s_add_u32 s35, s35, 1
    s_cmp_lt_u32 s35, 4
    s_cbranch_scc1 L_p2_loop
    s_load_dwordx2 s[4:5], s[0:1], 40
    s_load_dwordx2 s[8:9], s[0:1], 80
    s_load_dwordx2 s[96:97], s[0:1], 0
    s_load_dwordx2 s[98:99], s[0:1], 88
    s_cmp_lt_u32 s28, 4
    s_cbranch_scc0 L_grp1
    s_mov_b32 s36, 1040356334
    s_and_b32 s37, s28, 3
    s_lshl_b32 s37, s37, 13
    v_lshlrev_b32 v7, 4, v1
    v_add_u32 v4, s37, v7
    v_add_u32 v6, 4096, v4
    v_add_u32 v19, 131072, v4
    s_mov_b32 s43, s37
    s_add_u32 s44, s37, 98304
    s_waitcnt vmcnt(4) lgkmcnt(0)
    v_mul_f32 v192, s36, v192
    v_mul_f32 v193, s36, v193
    v_mul_f32 v194, s36, v194
    v_mul_f32 v195, s36, v195
    v_mul_f32 v196, s36, v196
    v_mul_f32 v197, s36, v197
    v_mul_f32 v198, s36, v198
    v_mul_f32 v199, s36, v199
    v_cvt_pk_bf16_f32 v128, v192, v193
    v_cvt_pk_bf16_f32 v129, v194, v195
    v_cvt_pk_bf16_f32 v130, v196, v197
    v_cvt_pk_bf16_f32 v131, v198, v199
    ds_write_b128 v19, v[128:131] offset:0
    v_mul_f32 v200, s36, v200
    v_mul_f32 v201, s36, v201
    v_mul_f32 v202, s36, v202
    v_mul_f32 v203, s36, v203
    v_mul_f32 v204, s36, v204
    v_mul_f32 v205, s36, v205
    v_mul_f32 v206, s36, v206
    v_mul_f32 v207, s36, v207
    v_cvt_pk_bf16_f32 v132, v200, v201
    v_cvt_pk_bf16_f32 v133, v202, v203
    v_cvt_pk_bf16_f32 v134, v204, v205
    v_cvt_pk_bf16_f32 v135, v206, v207
    ds_write_b128 v19, v[132:135] offset:1024
    v_mul_f32 v208, s36, v208
    v_mul_f32 v209, s36, v209
    v_mul_f32 v210, s36, v210
    v_mul_f32 v211, s36, v211
    v_mul_f32 v212, s36, v212
    v_mul_f32 v213, s36, v213
    v_mul_f32 v214, s36, v214
    v_mul_f32 v215, s36, v215
    v_cvt_pk_bf16_f32 v136, v208, v209
    v_cvt_pk_bf16_f32 v137, v210, v211
    v_cvt_pk_bf16_f32 v138, v212, v213
    v_cvt_pk_bf16_f32 v139, v214, v215
    ds_write_b128 v19, v[136:139] offset:2048
    v_mul_f32 v216, s36, v216
    v_mul_f32 v217, s36, v217
    v_mul_f32 v218, s36, v218
    v_mul_f32 v219, s36, v219
    v_mul_f32 v220, s36, v220
    v_mul_f32 v221, s36, v221
    v_mul_f32 v222, s36, v222
    v_mul_f32 v223, s36, v223
    v_cvt_pk_bf16_f32 v140, v216, v217
    v_cvt_pk_bf16_f32 v141, v218, v219
    v_cvt_pk_bf16_f32 v142, v220, v221
    v_cvt_pk_bf16_f32 v143, v222, v223
    ds_write_b128 v19, v[140:143] offset:3072
    v_mul_f32 v224, s36, v224
    v_mul_f32 v225, s36, v225
    v_mul_f32 v226, s36, v226
    v_mul_f32 v227, s36, v227
    v_mul_f32 v228, s36, v228
    v_mul_f32 v229, s36, v229
    v_mul_f32 v230, s36, v230
    v_mul_f32 v231, s36, v231
    v_cvt_pk_bf16_f32 v144, v224, v225
    v_cvt_pk_bf16_f32 v145, v226, v227
    v_cvt_pk_bf16_f32 v146, v228, v229
    v_cvt_pk_bf16_f32 v147, v230, v231
    ds_write_b128 v19, v[144:147] offset:4096
    v_mul_f32 v232, s36, v232
    v_mul_f32 v233, s36, v233
    v_mul_f32 v234, s36, v234
    v_mul_f32 v235, s36, v235
    v_mul_f32 v236, s36, v236
    v_mul_f32 v237, s36, v237
    v_mul_f32 v238, s36, v238
    v_mul_f32 v239, s36, v239
    v_cvt_pk_bf16_f32 v148, v232, v233
    v_cvt_pk_bf16_f32 v149, v234, v235
    v_cvt_pk_bf16_f32 v150, v236, v237
    v_cvt_pk_bf16_f32 v151, v238, v239
    ds_write_b128 v19, v[148:151] offset:5120
    v_mul_f32 v240, s36, v240
    v_mul_f32 v241, s36, v241
    v_mul_f32 v242, s36, v242
    v_mul_f32 v243, s36, v243
    v_mul_f32 v244, s36, v244
    v_mul_f32 v245, s36, v245
    v_mul_f32 v246, s36, v246
    v_mul_f32 v247, s36, v247
    v_cvt_pk_bf16_f32 v152, v240, v241
    v_cvt_pk_bf16_f32 v153, v242, v243
    v_cvt_pk_bf16_f32 v154, v244, v245
    v_cvt_pk_bf16_f32 v155, v246, v247
    ds_write_b128 v19, v[152:155] offset:6144
    v_mul_f32 v248, s36, v248
    v_mul_f32 v249, s36, v249
    v_mul_f32 v250, s36, v250
    v_mul_f32 v251, s36, v251
    v_mul_f32 v252, s36, v252
    v_mul_f32 v253, s36, v253
    v_mul_f32 v254, s36, v254
    v_mul_f32 v255, s36, v255
    v_cvt_pk_bf16_f32 v156, v248, v249
    v_cvt_pk_bf16_f32 v157, v250, v251
    v_cvt_pk_bf16_f32 v158, v252, v253
    v_cvt_pk_bf16_f32 v159, v254, v255
    ds_write_b128 v19, v[156:159] offset:7168
    v_mov_b32 v2, v7
    v_and_b32 v21, 15, v1
    v_lshrrev_b32 v22, 4, v1
    v_lshlrev_b32 v22, 2, v22
    v_sub_u32 v18, v21, v22
    s_mov_b32 s40, 0
    s_mov_b32 s41, 0
    s_lshl_b32 s51, s30, 1
    s_add_u32 s51, s51, 1
    s_and_b32 s36, s28, 3
    s_lshl_b32 s36, s36, 5
    s_sub_u32 s37, 15, s30
    s_lshl_b32 s37, s37, 7
    s_add_u32 s36, s36, s37
    s_sub_u32 s50, 0, s36
    s_add_u32 s36, s51, 1
    s_lshl_b32 s36, -1, s36
    s_or_b32 s48, s36, 0xaaaaaaaa
    s_and_b32 s48, s48, 0x7ffe
    s_or_b32 s39, s36, 0x55555555
    s_and_b32 s39, s39, 0xffff
    s_add_u32 s46, s45, 131072
    s_add_u32 s47, s45, 98304
    s_mov_b64 s[52:53], 0
    s_waitcnt lgkmcnt(0)
    s_barrier
    s_add_u32 s16, s54, 41943040
    s_addc_u32 s17, s55, 0
    s_and_b32 s17, s17, 0xffff
    s_mov_b32 s18, 16777216
    s_mov_b32 s19, 0x20000
    s_mov_b32 s4, s92
    s_and_b32 s5, s93, 0xffff
    s_mov_b32 s6, 7340032
    s_mov_b32 s7, 0x20000
    s_mov_b32 s8, s94
    s_and_b32 s9, s95, 0xffff
    s_mov_b32 s10, 7340032
    s_mov_b32 s11, 0x20000
    s_and_b32 s60, s29, 3
    s_add_u32 s60, s60, 4
    s_sub_u32 s3, s2, 32
    s_cmp_eq_u32 s28, 0
    s_cselect_b32 s36, 0xad, 0x2d
    s_cselect_b32 s42, 14, 12
    s_cmp_lt_u32 s3, 224
    s_cselect_b32 s36, s36, 0
    s_lshl_b32 s36, s36, s60
    s_or_b32 s42, s42, s36
    ds_read_b128 v[64:67], v2 offset:0
    ds_read_b128 v[68:71], v2 offset:1024
    ds_read_b128 v[72:75], v2 offset:2048
    ds_read_b128 v[76:79], v2 offset:3072
    ds_read_b128 v[80:83], v2 offset:4096
    ds_read_b128 v[84:87], v2 offset:5120
    ds_read_b128 v[88:91], v2 offset:6144
    ds_read_b128 v[92:95], v2 offset:7168
    s_waitcnt lgkmcnt(7)
    v_mfma_f32_16x16x32_bf16 v[96:99], v[64:67], v[128:131], 0
    v_mov_b32 v192, 0
    v_mov_b32 v193, 0
    v_mfma_f32_16x16x32_bf16 v[104:107], v[64:67], v[144:147], 0
    ds_read_b128 v[64:67], v2 offset:8192
    v_mov_b32 v194, 0
    v_mov_b32 v195, 0
    s_waitcnt lgkmcnt(7)
    v_mfma_f32_16x16x32_bf16 v[96:99], v[68:71], v[132:135], v[96:99]
    v_mov_b32 v196, 0
    v_mov_b32 v197, 0
    v_mfma_f32_16x16x32_bf16 v[104:107], v[68:71], v[148:151], v[104:107]
    ds_read_b128 v[68:71], v2 offset:9216
    v_mov_b32 v198, 0
    v_mov_b32 v199, 0
    s_waitcnt lgkmcnt(7)
    v_mfma_f32_16x16x32_bf16 v[96:99], v[72:75], v[136:139], v[96:99]
    v_mov_b32 v200, 0
    v_mov_b32 v201, 0
    v_mfma_f32_16x16x32_bf16 v[104:107], v[72:75], v[152:155], v[104:107]
    ds_read_b128 v[72:75], v2 offset:10240
    v_mov_b32 v202, 0
    v_mov_b32 v203, 0
    s_waitcnt lgkmcnt(7)
    v_mfma_f32_16x16x32_bf16 v[96:99], v[76:79], v[140:143], v[96:99]
    v_mov_b32 v204, 0
    v_mov_b32 v205, 0
    v_mfma_f32_16x16x32_bf16 v[104:107], v[76:79], v[156:159], v[104:107]
    ds_read_b128 v[76:79], v2 offset:11264
    v_mov_b32 v206, 0
    v_mov_b32 v207, 0
    s_waitcnt lgkmcnt(7)
    v_mfma_f32_16x16x32_bf16 v[100:103], v[80:83], v[128:131], 0
    v_mov_b32 v208, 0
    v_mov_b32 v209, 0
    v_mfma_f32_16x16x32_bf16 v[108:111], v[80:83], v[144:147], 0
    ds_read_b128 v[80:83], v2 offset:12288
    v_mov_b32 v210, 0
    v_mov_b32 v211, 0
    s_waitcnt lgkmcnt(7)
    v_mfma_f32_16x16x32_bf16 v[100:103], v[84:87], v[132:135], v[100:103]
    v_mov_b32 v212, 0
    v_mov_b32 v213, 0
    v_mfma_f32_16x16x32_bf16 v[108:111], v[84:87], v[148:151], v[108:111]
    ds_read_b128 v[84:87], v2 offset:13312
    v_mov_b32 v214, 0
    v_mov_b32 v215, 0
    s_waitcnt lgkmcnt(7)
    v_mfma_f32_16x16x32_bf16 v[100:103], v[88:91], v[136:139], v[100:103]
    v_mov_b32 v216, 0
    v_mov_b32 v217, 0
    v_mfma_f32_16x16x32_bf16 v[108:111], v[88:91], v[152:155], v[108:111]
    ds_read_b128 v[88:91], v2 offset:14336
    v_mov_b32 v218, 0
    v_mov_b32 v219, 0
    s_waitcnt lgkmcnt(7)
    v_mfma_f32_16x16x32_bf16 v[100:103], v[92:95], v[140:143], v[100:103]
    v_mov_b32 v220, 0
    v_mov_b32 v221, 0
    v_mfma_f32_16x16x32_bf16 v[108:111], v[92:95], v[156:159], v[108:111]
    ds_read_b128 v[92:95], v2 offset:15360
    v_mov_b32 v222, 0
    v_mov_b32 v223, 0
    s_waitcnt lgkmcnt(7)
    v_mfma_f32_16x16x32_bf16 v[112:115], v[64:67], v[128:131], 0
    v_mov_b32 v224, 0
    v_mov_b32 v225, 0
    v_mfma_f32_16x16x32_bf16 v[120:123], v[64:67], v[144:147], 0
    v_mov_b32 v226, 0
    v_mov_b32 v227, 0
    s_waitcnt lgkmcnt(6)
    v_mfma_f32_16x16x32_bf16 v[112:115], v[68:71], v[132:135], v[112:115]
    v_mov_b32 v228, 0
    v_mov_b32 v229, 0
    v_mfma_f32_16x16x32_bf16 v[120:123], v[68:71], v[148:151], v[120:123]
    v_mov_b32 v230, 0
    v_mov_b32 v231, 0
    s_waitcnt lgkmcnt(5)
    v_mfma_f32_16x16x32_bf16 v[112:115], v[72:75], v[136:139], v[112:115]
    v_mov_b32 v232, 0
    v_mov_b32 v233, 0
    v_mfma_f32_16x16x32_bf16 v[120:123], v[72:75], v[152:155], v[120:123]
    v_mov_b32 v234, 0
    v_mov_b32 v235, 0
    s_waitcnt lgkmcnt(4)
    v_mfma_f32_16x16x32_bf16 v[112:115], v[76:79], v[140:143], v[112:115]
    v_mov_b32 v236, 0
    v_mov_b32 v237, 0
    v_mfma_f32_16x16x32_bf16 v[120:123], v[76:79], v[156:159], v[120:123]
    v_mov_b32 v238, 0
    v_mov_b32 v239, 0
    s_waitcnt lgkmcnt(3)
    v_mfma_f32_16x16x32_bf16 v[116:119], v[80:83], v[128:131], 0
    v_mov_b32 v240, 0
    v_mov_b32 v241, 0
    v_mfma_f32_16x16x32_bf16 v[124:127], v[80:83], v[144:147], 0
    v_mov_b32 v242, 0
    v_mov_b32 v243, 0
    s_waitcnt lgkmcnt(2)
    v_mfma_f32_16x16x32_bf16 v[116:119], v[84:87], v[132:135], v[116:119]
    v_mov_b32 v244, 0
    v_mov_b32 v245, 0
    v_mfma_f32_16x16x32_bf16 v[124:127], v[84:87], v[148:151], v[124:127]
    v_mov_b32 v246, 0
    v_mov_b32 v247, 0
    s_waitcnt lgkmcnt(1)
    v_mfma_f32_16x16x32_bf16 v[116:119], v[88:91], v[136:139], v[116:119]
    v_mov_b32 v248, 0
    v_mov_b32 v249, 0
    v_mfma_f32_16x16x32_bf16 v[124:127], v[88:91], v[152:155], v[124:127]
    v_mov_b32 v250, 0
    v_mov_b32 v251, 0
    s_waitcnt lgkmcnt(0)
    v_mfma_f32_16x16x32_bf16 v[116:119], v[92:95], v[140:143], v[116:119]
    v_mov_b32 v252, 0
    v_mov_b32 v253, 0
    v_mfma_f32_16x16x32_bf16 v[124:127], v[92:95], v[156:159], v[124:127]
    v_mov_b32 v254, 0
    v_mov_b32 v255, 0
    v_mov_b32 v38, 0
    v_mov_b32 v39, 0
    s_cmp_lt_i32 s50, 0
    s_cbranch_scc0 L_recurrent_scan__compressed_kv_cla__moe_arch_mod__prompt_kernel_rare_117
L_recurrent_scan__compressed_kv_cla__moe_arch_mod__prompt_kernel_back_118:
    s_add_u32 s49, s50, 32
    v_add_u32 v24, 65536, v2
    s_cmp_le_u32 s40, s51
    s_cselect_b32 s36, 64, 128
    s_add_u32 s41, s41, s36
    s_add_u32 s50, s50, s36
    s_and_b32 s36, s41, 0xff
    v_lshl_add_u32 v2, s36, 8, v7
    s_cmp_eq_u32 s40, 16
    s_cselect_b64 s[20:21], -1, 0
    v_cndmask_b32 v5, v2, v24, s[20:21]
    v_mov_b32 v3, v24
    s_waitcnt vmcnt(0)
    s_barrier
    s_cmp_eq_u32 s28, 0
    s_cbranch_scc1 L_recurrent_scan__compressed_kv_cla__moe_arch_mod__prompt_kernel_rare_119
L_recurrent_scan__compressed_kv_cla__moe_arch_mod__prompt_kernel_back_120:
    ds_read_b128 v[64:67], v5 offset:0
    ds_read_b128 v[68:71], v5 offset:1024
    ds_read_b128 v[72:75], v5 offset:2048
    ds_read_b128 v[76:79], v5 offset:3072
    ds_read_b128 v[80:83], v5 offset:4096
    ds_read_b128 v[84:87], v5 offset:5120
    ds_read_b128 v[88:91], v5 offset:6144
    v_max3_f32 v21, v96, v97, v98
    v_max3_f32 v21, v21, v99, v100
    v_max3_f32 v21, v21, v101, v102
    v_max_f32 v21, v21, v103
    v_max3_f32 v22, v104, v105, v106
    v_max3_f32 v22, v22, v107, v108
    v_max3_f32 v22, v22, v109, v110
    v_max_f32 v22, v22, v111
    v_mov_b32 v23, v21
    s_nop 1
    v_permlane16_swap_b32 v21, v23
    s_nop 1
    v_max_f32 v21, v21, v23
    v_mov_b32 v23, v21
    s_nop 1
    v_permlane32_swap_b32 v21, v23
    s_nop 1
    v_max_f32 v21, v21, v23
    v_mov_b32 v23, v22
    s_nop 1
    v_permlane16_swap_b32 v22, v23
    s_nop 1
    v_max_f32 v22, v22, v23
    v_mov_b32 v23, v22
    s_nop 1
    v_permlane32_swap_b32 v22, v23
    s_nop 1
    v_max_f32 v22, v22, v23
    v_sub_f32 v40, 0, v21
    v_sub_f32 v41, 0, v21
    v_sub_f32 v42, 0, v21
    v_sub_f32 v43, 0, v21
    v_sub_f32 v44, 0, v22
    v_sub_f32 v45, 0, v22
    v_sub_f32 v46, 0, v22
    v_sub_f32 v47, 0, v22
    ds_write_b32 v19, v40
    ds_write_b32 v19, v44 offset:4
    v_sub_f32 v96, v96, v21
    v_sub_f32 v97, v97, v21
    v_sub_f32 v98, v98, v21
    v_sub_f32 v99, v99, v21
    v_sub_f32 v100, v100, v21
    v_sub_f32 v101, v101, v21
    v_sub_f32 v102, v102, v21
    v_sub_f32 v103, v103, v21
    v_sub_f32 v104, v104, v22
    v_sub_f32 v105, v105, v22
    v_sub_f32 v106, v106, v22
    v_sub_f32 v107, v107, v22
    v_sub_f32 v108, v108, v22
    v_sub_f32 v109, v109, v22
    v_sub_f32 v110, v110, v22
    v_sub_f32 v111, v111, v22
    v_sub_f32 v112, v112, v21
    v_sub_f32 v113, v113, v21
    v_sub_f32 v114, v114, v21
    v_sub_f32 v115, v115, v21
    v_sub_f32 v116, v116, v21
    v_sub_f32 v117, v117, v21
    v_sub_f32 v118, v118, v21
    v_sub_f32 v119, v119, v21
    v_sub_f32 v120, v120, v22
    v_sub_f32 v121, v121, v22
    v_sub_f32 v122, v122, v22
    v_sub_f32 v123, v123, v22
    v_sub_f32 v124, v124, v22
    v_sub_f32 v125, v125, v22
    v_sub_f32 v126, v126, v22
    v_sub_f32 v127, v127, v22
    v_exp_f32 v96, v96
    v_exp_f32 v97, v97
    v_add_f32 v38, v38, v96
    v_exp_f32 v98, v98
    v_add_f32 v38, v38, v97
    v_cvt_pk_bf16_f32 v48, v96, v97
    v_exp_f32 v99, v99
    v_add_f32 v38, v38, v98
    v_exp_f32 v104, v104
    v_add_f32 v38, v38, v99
    v_cvt_pk_bf16_f32 v49, v98, v99
    v_exp_f32 v105, v105
    v_add_f32 v39, v39, v104
    v_exp_f32 v106, v106
    v_add_f32 v39, v39, v105
    v_cvt_pk_bf16_f32 v52, v104, v105
    v_exp_f32 v107, v107
    v_add_f32 v39, v39, v106
    v_exp_f32 v100, v100
    v_add_f32 v39, v39, v107
    v_cvt_pk_bf16_f32 v53, v106, v107
    v_exp_f32 v101, v101
    v_add_f32 v38, v38, v100
    v_exp_f32 v102, v102
    v_add_f32 v38, v38, v101
    v_cvt_pk_bf16_f32 v50, v100, v101
    v_exp_f32 v103, v103
    v_add_f32 v38, v38, v102
    v_exp_f32 v108, v108
    v_add_f32 v38, v38, v103
    v_cvt_pk_bf16_f32 v51, v102, v103
    v_exp_f32 v109, v109
    v_add_f32 v39, v39, v108
    v_exp_f32 v110, v110
    v_add_f32 v39, v39, v109
    v_cvt_pk_bf16_f32 v54, v108, v109
    v_exp_f32 v111, v111
    v_add_f32 v39, v39, v110
    s_nop 0
    v_add_f32 v39, v39, v111
    v_cvt_pk_bf16_f32 v55, v110, v111
    .p2align 6
L_body0:
    s_cmp_lt_i32 s49, 0
    s_cbranch_scc0 L_recurrent_scan__compressed_kv_cla__moe_arch_mod__prompt_kernel_rare_121
L_recurrent_scan__compressed_kv_cla__moe_arch_mod__prompt_kernel_back_122:
    s_waitcnt lgkmcnt(3)
    v_mfma_f32_16x16x32_bf16 v[96:99], v[64:67], v[128:131], v[40:43]
    v_exp_f32 v112, v112
    v_mfma_f32_16x16x32_bf16 v[104:107], v[64:67], v[144:147], v[44:47]
    ds_read_b128 v[92:95], v2 offset:7168
    s_bitcmp1_b32 s48, s40
    s_cbranch_scc0 L_recurrent_scan__compressed_kv_cla__moe_arch_mod__prompt_kernel_nodma_141
    s_add_u32 m0, s43, 0
    s_nop 0
    buffer_load_dwordx4 v4, s[12:15], s46 offen offset:0 sc1 lds
    buffer_load_dwordx4 v4, s[12:15], s46 offen offset:1024 sc1 lds
L_recurrent_scan__compressed_kv_cla__moe_arch_mod__prompt_kernel_nodma_141:
    v_mfma_f32_16x16x32_bf16 v[96:99], v[68:71], v[132:135], v[96:99]
    v_exp_f32 v113, v113
    v_mfma_f32_16x16x32_bf16 v[104:107], v[68:71], v[148:151], v[104:107]
    ds_read_b128 v[64:67], v3 offset:0
    v_add_f32 v38, v38, v112
    v_mfma_f32_16x16x32_bf16 v[96:99], v[72:75], v[136:139], v[96:99]
    v_exp_f32 v114, v114
    v_mfma_f32_16x16x32_bf16 v[104:107], v[72:75], v[152:155], v[104:107]
    ds_read_b128 v[68:71], v3 offset:1024
    v_add_f32 v38, v38, v113
    v_cvt_pk_bf16_f32 v56, v112, v113
    s_bitcmp1_b32 s48, s40
    s_cbranch_scc0 L_recurrent_scan__compressed_kv_cla__moe_arch_mod__prompt_kernel_nodma_142
    s_add_u32 m0, s43, 0
    s_nop 0
    buffer_load_dwordx4 v4, s[12:15], s46 offen offset:2048 sc1 lds
    buffer_load_dwordx4 v4, s[12:15], s46 offen offset:3072 sc1 lds
L_recurrent_scan__compressed_kv_cla__moe_arch_mod__prompt_kernel_nodma_142:
    v_mfma_f32_16x16x32_bf16 v[96:99], v[76:79], v[140:143], v[96:99]
    v_exp_f32 v115, v115
    v_mfma_f32_16x16x32_bf16 v[104:107], v[76:79], v[156:159], v[104:107]
    ds_read_b128 v[72:75], v3 offset:2048
    v_add_f32 v38, v38, v114
    s_waitcnt lgkmcnt(3)
    v_mfma_f32_16x16x32_bf16 v[100:103], v[80:83], v[128:131], v[40:43]
    v_exp_f32 v120, v120
    v_mfma_f32_16x16x32_bf16 v[108:111], v[80:83], v[144:147], v[44:47]
    ds_read_b128 v[76:79], v3 offset:3072
    v_add_f32 v38, v38, v115
    v_cvt_pk_bf16_f32 v57, v114, v115
    s_bitcmp1_b32 s48, s40
    s_cbranch_scc0 L_recurrent_scan__compressed_kv_cla__moe_arch_mod__prompt_kernel_nodma_143
    s_add_u32 m0, s43, 4096
    s_nop 0
    buffer_load_dwordx4 v6, s[12:15], s46 offen offset:0 sc1 lds
    buffer_load_dwordx4 v6, s[12:15], s46 offen offset:1024 sc1 lds
L_recurrent_scan__compressed_kv_cla__moe_arch_mod__prompt_kernel_nodma_143:
    v_mfma_f32_16x16x32_bf16 v[100:103], v[84:87], v[132:135], v[100:103]
    v_exp_f32 v121, v121
    v_mfma_f32_16x16x32_bf16 v[108:111], v[84:87], v[148:151], v[108:111]
    ds_read_b128 v[80:83], v3 offset:4096
    v_add_f32 v39, v39, v120
    v_mfma_f32_16x16x32_bf16 v[100:103], v[88:91], v[136:139], v[100:103]
    v_exp_f32 v122, v122
    v_mfma_f32_16x16x32_bf16 v[108:111], v[88:91], v[152:155], v[108:111]
    ds_read_b128 v[84:87], v3 offset:5120
    v_add_f32 v39, v39, v121
    v_cvt_pk_bf16_f32 v60, v120, v121
    s_bitcmp1_b32 s48, s40
    s_cbranch_scc0 L_recurrent_scan__compressed_kv_cla__moe_arch_mod__prompt_kernel_nodma_144
    s_add_u32 m0, s43, 4096
    s_nop 0
    buffer_load_dwordx4 v6, s[12:15], s46 offen offset:2048 sc1 lds
    buffer_load_dwordx4 v6, s[12:15], s46 offen offset:3072 sc1 lds
    s_add_u32 s46, s46, 65536
    s_xor_b32 s43, s43, 32768
L_recurrent_scan__compressed_kv_cla__moe_arch_mod__prompt_kernel_nodma_144:
    v_mfma_f32_16x16x32_bf16 v[100:103], v[92:95], v[140:143], v[100:103]
    v_exp_f32 v123, v123
    v_mfma_f32_16x16x32_bf16 v[108:111], v[92:95], v[156:159], v[108:111]
    ds_read_b128 v[88:91], v3 offset:6144
    v_add_f32 v39, v39, v122
    s_waitcnt lgkmcnt(3)
    v_mfma_f32_16x16x32_bf16 v[192:195], v[64:67], v[48:51], v[192:195]
    v_exp_f32 v116, v116
    v_mfma_f32_16x16x32_bf16 v[224:227], v[64:67], v[52:55], v[224:227]
    ds_read_b128 v[92:95], v3 offset:7168
    v_add_f32 v39, v39, v123
    v_cvt_pk_bf16_f32 v61, v122, v123
    s_bitcmp1_b32 s39, s40
    s_cbranch_scc0 L_recurrent_scan__compressed_kv_cla__moe_arch_mod__prompt_kernel_nodma_145
    s_add_u32 m0, s44, 0
    s_nop 0
    buffer_load_dwordx4 v4, s[12:15], s47 offen offset:0 sc1 lds
    buffer_load_dwordx4 v4, s[12:15], s47 offen offset:1024 sc1 lds
L_recurrent_scan__compressed_kv_cla__moe_arch_mod__prompt_kernel_nodma_145:
    v_mfma_f32_16x16x32_bf16 v[196:199], v[68:71], v[48:51], v[196:199]
    v_exp_f32 v117, v117
    v_mfma_f32_16x16x32_bf16 v[228:231], v[68:71], v[52:55], v[228:231]
    ds_read_b128 v[64:67], v2 offset:8192
    v_add_f32 v38, v38, v116
    v_mfma_f32_16x16x32_bf16 v[200:203], v[72:75], v[48:51], v[200:203]
    v_exp_f32 v118, v118
    v_mfma_f32_16x16x32_bf16 v[232:235], v[72:75], v[52:55], v[232:235]
    ds_read_b128 v[68:71], v2 offset:9216
    v_add_f32 v38, v38, v117
    v_cvt_pk_bf16_f32 v58, v116, v117
    s_bitcmp1_b32 s39, s40
    s_cbranch_scc0 L_recurrent_scan__compressed_kv_cla__moe_arch_mod__prompt_kernel_nodma_146
    s_add_u32 m0, s44, 0
    s_nop 0
    buffer_load_dwordx4 v4, s[12:15], s47 offen offset:2048 sc1 lds
    buffer_load_dwordx4 v4, s[12:15], s47 offen offset:3072 sc1 lds
L_recurrent_scan__compressed_kv_cla__moe_arch_mod__prompt_kernel_nodma_146:
    v_mfma_f32_16x16x32_bf16 v[204:207], v[76:79], v[48:51], v[204:207]
    v_exp_f32 v119, v119
    v_mfma_f32_16x16x32_bf16 v[236:239], v[76:79], v[52:55], v[236:239]
    ds_read_b128 v[72:75], v2 offset:10240
    v_add_f32 v38, v38, v118
    s_waitcnt lgkmcnt(3)
    v_mfma_f32_16x16x32_bf16 v[208:211], v[80:83], v[48:51], v[208:211]
    v_exp_f32 v124, v124
    v_mfma_f32_16x16x32_bf16 v[240:243], v[80:83], v[52:55], v[240:243]
    ds_read_b128 v[76:79], v2 offset:11264
    v_add_f32 v38, v38, v119
    v_cvt_pk_bf16_f32 v59, v118, v119
    s_bitcmp1_b32 s39, s40
    s_cbranch_scc0 L_recurrent_scan__compressed_kv_cla__moe_arch_mod__prompt_kernel_nodma_147
    s_add_u32 m0, s44, 4096
    s_nop 0
    buffer_load_dwordx4 v6, s[12:15], s47 offen offset:0 sc1 lds
    buffer_load_dwordx4 v6, s[12:15], s47 offen offset:1024 sc1 lds
L_recurrent_scan__compressed_kv_cla__moe_arch_mod__prompt_kernel_nodma_147:
    v_mfma_f32_16x16x32_bf16 v[212:215], v[84:87], v[48:51], v[212:215]
    v_exp_f32 v125, v125
    v_mfma_f32_16x16x32_bf16 v[244:247], v[84:87], v[52:55], v[244:247]
    ds_read_b128 v[80:83], v2 offset:12288
    v_add_f32 v39, v39, v124
    v_mfma_f32_16x16x32_bf16 v[216:219], v[88:91], v[48:51], v[216:219]
    v_exp_f32 v126, v126
    v_mfma_f32_16x16x32_bf16 v[248:251], v[88:91], v[52:55], v[248:251]
    ds_read_b128 v[84:87], v2 offset:13312
    v_add_f32 v39, v39, v125
    v_cvt_pk_bf16_f32 v62, v124, v125
    s_bitcmp1_b32 s39, s40
    s_cbranch_scc0 L_recurrent_scan__compressed_kv_cla__moe_arch_mod__prompt_kernel_nodma_148
    s_add_u32 m0, s44, 4096
    s_nop 0
    buffer_load_dwordx4 v6, s[12:15], s47 offen offset:2048 sc1 lds
    buffer_load_dwordx4 v6, s[12:15], s47 offen offset:3072 sc1 lds
    s_add_u32 s47, s47, 65536
    s_xor_b32 s44, s44, 32768
L_recurrent_scan__compressed_kv_cla__moe_arch_mod__prompt_kernel_nodma_148:
    v_mfma_f32_16x16x32_bf16 v[220:223], v[92:95], v[48:51], v[220:223]
    v_exp_f32 v127, v127
    v_mfma_f32_16x16x32_bf16 v[252:255], v[92:95], v[52:55], v[252:255]
    ds_read_b128 v[88:91], v2 offset:14336
    v_add_f32 v39, v39, v126
    v_add_f32 v39, v39, v127
    v_cvt_pk_bf16_f32 v63, v126, v127
    s_cmp_lt_i32 s50, 0
    s_cbranch_scc0 L_recurrent_scan__compressed_kv_cla__moe_arch_mod__prompt_kernel_rare_123
L_recurrent_scan__compressed_kv_cla__moe_arch_mod__prompt_kernel_back_124:
    s_waitcnt lgkmcnt(3)
    v_mfma_f32_16x16x32_bf16 v[112:115], v[64:67], v[128:131], v[40:43]
    v_exp_f32 v96, v96
    v_mfma_f32_16x16x32_bf16 v[120:123], v[64:67], v[144:147], v[44:47]
    ds_read_b128 v[92:95], v2 offset:15360
    v_mfma_f32_16x16x32_bf16 v[112:115], v[68:71], v[132:135], v[112:115]
    v_exp_f32 v97, v97
    s_add_u32 s40, s40, 1
    v_mfma_f32_16x16x32_bf16 v[120:123], v[68:71], v[148:151], v[120:123]
    ds_read_b128 v[64:67], v3 offset:8192
    v_add_f32 v38, v38, v96
    s_add_u32 s49, s50, 32
    v_add_u32 v24, 65536, v2
    v_mfma_f32_16x16x32_bf16 v[112:115], v[72:75], v[136:139], v[112:115]
    v_exp_f32 v98, v98
    v_mfma_f32_16x16x32_bf16 v[120:123], v[72:75], v[152:155], v[120:123]
    ds_read_b128 v[68:71], v3 offset:9216
    v_add_f32 v38, v38, v97
    v_cvt_pk_bf16_f32 v48, v96, v97
    s_cmp_le_u32 s40, s51
    s_cselect_b32 s36, 64, 128
    v_mfma_f32_16x16x32_bf16 v[112:115], v[76:79], v[140:143], v[112:115]
    v_exp_f32 v99, v99
    v_mfma_f32_16x16x32_bf16 v[120:123], v[76:79], v[156:159], v[120:123]
    ds_read_b128 v[72:75], v3 offset:10240
    v_add_f32 v38, v38, v98
    s_add_u32 s41, s41, s36
    s_add_u32 s50, s50, s36
    s_waitcnt lgkmcnt(3)
    v_mfma_f32_16x16x32_bf16 v[116:119], v[80:83], v[128:131], v[40:43]
    v_exp_f32 v104, v104
    v_mfma_f32_16x16x32_bf16 v[124:127], v[80:83], v[144:147], v[44:47]
    ds_read_b128 v[76:79], v3 offset:11264
    v_add_f32 v38, v38, v99
    v_cvt_pk_bf16_f32 v49, v98, v99
    s_and_b32 s36, s41, 0xff
    v_lshl_add_u32 v2, s36, 8, v7
    v_mfma_f32_16x16x32_bf16 v[116:119], v[84:87], v[132:135], v[116:119]
    v_exp_f32 v105, v105
    v_mfma_f32_16x16x32_bf16 v[124:127], v[84:87], v[148:151], v[124:127]
    ds_read_b128 v[80:83], v3 offset:12288
    v_add_f32 v39, v39, v104
    s_cmp_eq_u32 s40, 16
    s_cselect_b64 s[20:21], -1, 0
    v_mfma_f32_16x16x32_bf16 v[116:119], v[88:91], v[136:139], v[116:119]
    v_exp_f32 v106, v106
    v_mfma_f32_16x16x32_bf16 v[124:127], v[88:91], v[152:155], v[124:127]
    ds_read_b128 v[84:87], v3 offset:13312
    v_add_f32 v39, v39, v105
    v_cvt_pk_bf16_f32 v52, v104, v105
    v_cndmask_b32 v5, v2, v24, s[20:21]
    v_mfma_f32_16x16x32_bf16 v[116:119], v[92:95], v[140:143], v[116:119]
    v_exp_f32 v107, v107
    v_mfma_f32_16x16x32_bf16 v[124:127], v[92:95], v[156:159], v[124:127]
    ds_read_b128 v[88:91], v3 offset:14336
    v_add_f32 v39, v39, v106
    s_waitcnt lgkmcnt(3)
    v_mfma_f32_16x16x32_bf16 v[192:195], v[64:67], v[56:59], v[192:195]
    v_exp_f32 v100, v100
    v_mfma_f32_16x16x32_bf16 v[224:227], v[64:67], v[60:63], v[224:227]
    ds_read_b128 v[92:95], v3 offset:15360
    v_add_f32 v39, v39, v107
    v_cvt_pk_bf16_f32 v53, v106, v107
    v_mfma_f32_16x16x32_bf16 v[196:199], v[68:71], v[56:59], v[196:199]
    v_exp_f32 v101, v101
    v_mfma_f32_16x16x32_bf16 v[228:231], v[68:71], v[60:63], v[228:231]
    v_add_f32 v38, v38, v100
    v_mov_b32 v3, v24
    v_mfma_f32_16x16x32_bf16 v[200:203], v[72:75], v[56:59], v[200:203]
    v_exp_f32 v102, v102
    v_mfma_f32_16x16x32_bf16 v[232:235], v[72:75], v[60:63], v[232:235]
    v_add_f32 v38, v38, v101
    v_cvt_pk_bf16_f32 v50, v100, v101
    s_waitcnt vmcnt(8) lgkmcnt(0)
    s_cmp_le_u32 s40, s51
    s_cbranch_scc1 L_recurrent_scan__compressed_kv_cla__moe_arch_mod__prompt_kernel_rlx_125
    s_waitcnt vmcnt(0)
L_recurrent_scan__compressed_kv_cla__moe_arch_mod__prompt_kernel_rlx_125:
    s_bitcmp1_b32 s42, s40
    s_cbranch_scc1 L_recurrent_scan__compressed_kv_cla__moe_arch_mod__prompt_kernel_rare_139
L_recurrent_scan__compressed_kv_cla__moe_arch_mod__prompt_kernel_back_140:
    s_barrier
    v_mfma_f32_16x16x32_bf16 v[204:207], v[76:79], v[56:59], v[204:207]
    v_exp_f32 v103, v103
    v_mfma_f32_16x16x32_bf16 v[236:239], v[76:79], v[60:63], v[236:239]
    ds_read_b128 v[68:71], v5 offset:1024
    ds_read_b128 v[64:67], v5 offset:0
    v_add_f32 v38, v38, v102
    v_mfma_f32_16x16x32_bf16 v[208:211], v[80:83], v[56:59], v[208:211]
    v_exp_f32 v108, v108
    v_mfma_f32_16x16x32_bf16 v[240:243], v[80:83], v[60:63], v[240:243]
    ds_read_b128 v[76:79], v5 offset:3072
    ds_read_b128 v[72:75], v5 offset:2048
    v_add_f32 v38, v38, v103
    v_cvt_pk_bf16_f32 v51, v102, v103
    v_mfma_f32_16x16x32_bf16 v[212:215], v[84:87], v[56:59], v[212:215]
    v_exp_f32 v109, v109
    v_mfma_f32_16x16x32_bf16 v[244:247], v[84:87], v[60:63], v[244:247]
    ds_read_b128 v[80:83], v5 offset:4096
    v_add_f32 v39, v39, v108
    v_mfma_f32_16x16x32_bf16 v[216:219], v[88:91], v[56:59], v[216:219]
    v_exp_f32 v110, v110
    v_mfma_f32_16x16x32_bf16 v[248:251], v[88:91], v[60:63], v[248:251]
    ds_read_b128 v[84:87], v5 offset:5120
    v_add_f32 v39, v39, v109
    v_cvt_pk_bf16_f32 v54, v108, v109
    v_mfma_f32_16x16x32_bf16 v[220:223], v[92:95], v[56:59], v[220:223]
    v_exp_f32 v111, v111
    v_mfma_f32_16x16x32_bf16 v[252:255], v[92:95], v[60:63], v[252:255]
    ds_read_b128 v[88:91], v5 offset:6144
    v_add_f32 v39, v39, v110
    v_add_f32 v39, v39, v111
    v_cvt_pk_bf16_f32 v55, v110, v111
    s_cmp_lg_u32 s40, 16
    s_cbranch_scc1 L_body0
    s_load_dwordx2 s[92:93], s[0:1], 40
    s_load_dwordx2 s[94:95], s[0:1], 80
    s_waitcnt vmcnt(0) lgkmcnt(0)
    s_mov_b32 s4, s94
    s_and_b32 s5, s95, 0xffff
    s_mov_b32 s6, 7340032
    s_mov_b32 s7, 0x20000
    s_mov_b32 s8, s92
    s_and_b32 s9, s93, 0xffff
    s_mov_b32 s10, 8388608
    s_mov_b32 s11, 0x20000
    s_lshr_b32 s38, s2, 4
    s_mul_i32 s38, s38, 224
    s_and_b32 s39, s2, 15
    s_lshl_b32 s39, s39, 7
    v_lshrrev_b32 v27, 3, v1
    s_lshl_b32 s36, s28, 5
    s_add_u32 s36, s36, s38
    v_add_u32 v27, s36, v27
    v_mul_u32_u24 v27, 2048, v27
    v_add_u32 v27, s39, v27
    v_bfe_u32 v28, v1, 4, 1
    v_lshlrev_b32 v28, 1, v28
    v_and_b32 v29, 7, v1
    v_xor_b32 v28, v28, v29
    v_lshl_add_u32 v26, v28, 4, v27
    v_xor_b32 v28, 4, v28
    v_lshl_add_u32 v27, v28, 4, v27
    v_add_u32 v27, 15360, v27
    v_add_u32 v28, 30720, v26
    v_add_u32 v29, 30720, v27
    s_lshl_b32 s36, s28, 12
    s_add_u32 s36, s36, 131072
    s_cmp_lt_u32 s28, 7
    s_cselect_b32 m0, s36, 0x30000
    s_cselect_b32 s6, 7340032, 0
    buffer_load_dwordx4 v26, s[4:7], 0 offen offset:0 lds
    buffer_load_dwordx4 v27, s[4:7], 0 offen offset:1024 lds
    buffer_load_dwordx4 v28, s[4:7], 0 offen offset:2048 lds
    buffer_load_dwordx4 v29, s[4:7], 0 offen offset:3072 lds
    s_lshr_b32 s36, s2, 5
    s_add_u32 s36, s36, 48
    s_lshl_b32 s36, s36, 7
    v_mov_b32 v12, s36
    global_load_dword v11, v12, s[90:91] sc1
    s_cmp_lt_i32 s49, 0
    s_cbranch_scc0 L_recurrent_scan__compressed_kv_cla__moe_arch_mod__prompt_kernel_rare_149
L_recurrent_scan__compressed_kv_cla__moe_arch_mod__prompt_kernel_back_150:
    s_waitcnt lgkmcnt(5)
    v_mfma_f32_16x16x32_bf16 v[192:195], v[64:67], v[48:51], v[192:195]
    v_exp_f32 v112, v112
    v_mfma_f32_16x16x32_bf16 v[224:227], v[64:67], v[52:55], v[224:227]
    ds_read_b128 v[92:95], v3 offset:7168
    v_add_f32 v38, v38, v112
    v_exp_f32 v113, v113
    v_mfma_f32_16x16x32_bf16 v[196:199], v[68:71], v[48:51], v[196:199]
    v_add_f32 v38, v38, v113
    v_cvt_pk_bf16_f32 v56, v112, v113
    v_exp_f32 v114, v114
    v_mfma_f32_16x16x32_bf16 v[228:231], v[68:71], v[52:55], v[228:231]
    ds_read_b128 v[64:67], v3 offset:8192
    v_add_f32 v38, v38, v114
    v_exp_f32 v115, v115
    s_waitcnt lgkmcnt(5)
    v_mfma_f32_16x16x32_bf16 v[200:203], v[72:75], v[48:51], v[200:203]
    v_add_f32 v38, v38, v115
    v_cvt_pk_bf16_f32 v57, v114, v115
    v_exp_f32 v120, v120
    v_mfma_f32_16x16x32_bf16 v[232:235], v[72:75], v[52:55], v[232:235]
    ds_read_b128 v[68:71], v3 offset:9216
    v_add_f32 v39, v39, v120
    v_exp_f32 v121, v121
    v_mfma_f32_16x16x32_bf16 v[204:207], v[76:79], v[48:51], v[204:207]
    v_add_f32 v39, v39, v121
    v_cvt_pk_bf16_f32 v60, v120, v121
    v_exp_f32 v122, v122
    v_mfma_f32_16x16x32_bf16 v[236:239], v[76:79], v[52:55], v[236:239]
    ds_read_b128 v[72:75], v3 offset:10240
    v_add_f32 v39, v39, v122
    v_exp_f32 v123, v123
    s_waitcnt lgkmcnt(6)
    v_mfma_f32_16x16x32_bf16 v[208:211], v[80:83], v[48:51], v[208:211]
    v_add_f32 v39, v39, v123
    v_cvt_pk_bf16_f32 v61, v122, v123
    v_exp_f32 v116, v116
    v_mfma_f32_16x16x32_bf16 v[240:243], v[80:83], v[52:55], v[240:243]
    ds_read_b128 v[76:79], v3 offset:11264
    v_add_f32 v38, v38, v116
    v_exp_f32 v117, v117
    s_waitcnt lgkmcnt(6)
    v_mfma_f32_16x16x32_bf16 v[212:215], v[84:87], v[48:51], v[212:215]
    v_add_f32 v38, v38, v117
    v_cvt_pk_bf16_f32 v58, v116, v117
    v_exp_f32 v118, v118
    v_mfma_f32_16x16x32_bf16 v[244:247], v[84:87], v[52:55], v[244:247]
    ds_read_b128 v[80:83], v3 offset:12288
    v_add_f32 v38, v38, v118
    v_exp_f32 v119, v119
    s_waitcnt lgkmcnt(6)
    v_mfma_f32_16x16x32_bf16 v[216:219], v[88:91], v[48:51], v[216:219]
    v_add_f32 v38, v38, v119
    v_cvt_pk_bf16_f32 v59, v118, v119
    v_exp_f32 v124, v124
    v_mfma_f32_16x16x32_bf16 v[248:251], v[88:91], v[52:55], v[248:251]
    ds_read_b128 v[84:87], v3 offset:13312
    v_add_f32 v39, v39, v124
    v_exp_f32 v125, v125
    s_waitcnt lgkmcnt(6)
    v_mfma_f32_16x16x32_bf16 v[220:223], v[92:95], v[48:51], v[220:223]
    v_add_f32 v39, v39, v125
    v_cvt_pk_bf16_f32 v62, v124, v125
    v_exp_f32 v126, v126
    v_mfma_f32_16x16x32_bf16 v[252:255], v[92:95], v[52:55], v[252:255]
    ds_read_b128 v[88:91], v3 offset:14336
    v_add_f32 v39, v39, v126
    v_exp_f32 v127, v127
    s_nop 0
    v_add_f32 v39, v39, v127
    v_cvt_pk_bf16_f32 v63, v126, v127
    s_nop 1
    s_waitcnt lgkmcnt(6)
    v_mfma_f32_16x16x32_bf16 v[192:195], v[64:67], v[56:59], v[192:195]
    v_mfma_f32_16x16x32_bf16 v[224:227], v[64:67], v[60:63], v[224:227]
    ds_read_b128 v[92:95], v3 offset:15360
    s_waitcnt lgkmcnt(6)
    v_mfma_f32_16x16x32_bf16 v[196:199], v[68:71], v[56:59], v[196:199]
    v_mfma_f32_16x16x32_bf16 v[228:231], v[68:71], v[60:63], v[228:231]
    s_waitcnt lgkmcnt(5)
    v_mfma_f32_16x16x32_bf16 v[200:203], v[72:75], v[56:59], v[200:203]
    v_mfma_f32_16x16x32_bf16 v[232:235], v[72:75], v[60:63], v[232:235]
    s_waitcnt lgkmcnt(4)
    v_mfma_f32_16x16x32_bf16 v[204:207], v[76:79], v[56:59], v[204:207]
    v_mfma_f32_16x16x32_bf16 v[236:239], v[76:79], v[60:63], v[236:239]
    s_waitcnt lgkmcnt(3)
    v_mfma_f32_16x16x32_bf16 v[208:211], v[80:83], v[56:59], v[208:211]
    v_mfma_f32_16x16x32_bf16 v[240:243], v[80:83], v[60:63], v[240:243]
    s_waitcnt lgkmcnt(2)
    v_mfma_f32_16x16x32_bf16 v[212:215], v[84:87], v[56:59], v[212:215]
    v_mfma_f32_16x16x32_bf16 v[244:247], v[84:87], v[60:63], v[244:247]
    s_waitcnt lgkmcnt(1)
    v_mfma_f32_16x16x32_bf16 v[216:219], v[88:91], v[56:59], v[216:219]
    v_mfma_f32_16x16x32_bf16 v[248:251], v[88:91], v[60:63], v[248:251]
    s_waitcnt lgkmcnt(0)
    v_mfma_f32_16x16x32_bf16 v[220:223], v[92:95], v[56:59], v[220:223]
    v_mfma_f32_16x16x32_bf16 v[252:255], v[92:95], v[60:63], v[252:255]
    s_lshl_b32 s37, s28, 13
    v_add_u32 v21, s37, v7
    v_xor_b32 v22, 32768, v21
    s_lshl_b32 s37, s28, 8
    s_add_u32 s37, s37, 159744
    v_lshl_add_u32 v23, v1, 2, s37
    v_xor_b32 v24, 1024, v23
    ds_write_b32 v23, v39
    s_mov_b32 s36, 0x5d800000
    v_cmp_nge_f32 vcc, s36, v38
    s_nop 0
    s_or_b64 s[52:53], s[52:53], vcc
    v_cmp_nge_f32 vcc, s36, v39
    s_nop 0
    s_or_b64 s[52:53], s[52:53], vcc
    s_or_b32 s36, s52, s53
    v_mov_b32 v26, s36
    s_lshl_b32 s37, s28, 2
    s_add_u32 s37, s37, 161792
    v_mov_b32 v27, s37
    ds_write_b32 v27, v26
    ds_write_b128 v21, v[224:227] offset:0
    ds_write_b128 v21, v[228:231] offset:1024
    ds_write_b128 v21, v[232:235] offset:2048
    ds_write_b128 v21, v[236:239] offset:3072
    ds_write_b128 v21, v[240:243] offset:4096
    ds_write_b128 v21, v[244:247] offset:5120
    ds_write_b128 v21, v[248:251] offset:6144
    ds_write_b128 v21, v[252:255] offset:7168
    v_mov_b32 v28, 161856
    v_mov_b32 v30, s56
    v_mov_b32 v31, s57
    v_mov_b32 v32, s58
    v_mov_b32 v33, s59
    ds_write_b128 v28, v[30:33]
    v_and_b32 v27, 7, v1
    v_lshlrev_b32 v27, 2, v27
    v_add_u32 v27, 161792, v27
    s_sub_u32 s36, 15, s30
    s_lshl_b32 s38, s36, 3
    s_and_b32 s37, s28, 3
    s_lshl_b32 s37, s37, 1
    s_add_u32 s38, s38, s37
    s_lshl_b32 s38, s38, 17
    s_lshl_b32 s37, s29, 12
    s_add_u32 s38, s38, s37
    s_waitcnt lgkmcnt(0)
    s_barrier
    ds_read_b32 v26, v27
    ds_read_b32 v25, v24
    ds_read_b128 v[64:67], v22 offset:0
    ds_read_b128 v[68:71], v22 offset:1024
    ds_read_b128 v[72:75], v22 offset:2048
    ds_read_b128 v[76:79], v22 offset:3072
    ds_read_b128 v[80:83], v22 offset:4096
    ds_read_b128 v[84:87], v22 offset:5120
    ds_read_b128 v[88:91], v22 offset:6144
    ds_read_b128 v[92:95], v22 offset:7168
    s_waitcnt lgkmcnt(8)
    v_add_f32 v25, v25, v38
    v_mov_b32 v20, v25
    s_nop 1
    v_permlane16_swap_b32 v25, v20
    s_nop 1
    v_add_f32 v25, v25, v20
    v_mov_b32 v20, v25
    s_nop 1
    v_permlane32_swap_b32 v25, v20
    s_nop 1
    v_add_f32 v25, v25, v20
    v_cmp_ne_u32 s[52:53], 0, v26
    v_rcp_f32 v25, v25
    s_waitcnt lgkmcnt(6)
    v_add_f32 v192, v192, v64
    v_add_f32 v193, v193, v65
    v_add_f32 v194, v194, v66
    v_add_f32 v195, v195, v67
    v_add_f32 v196, v196, v68
    v_add_f32 v197, v197, v69
    v_add_f32 v198, v198, v70
    v_add_f32 v199, v199, v71
    v_mul_f32 v192, v25, v192
    v_mul_f32 v193, v25, v193
    v_mul_f32 v194, v25, v194
    v_mul_f32 v195, v25, v195
    v_mul_f32 v196, v25, v196
    v_mul_f32 v197, v25, v197
    v_mul_f32 v198, v25, v198
    v_mul_f32 v199, v25, v199
    v_cvt_pk_bf16_f32 v48, v192, v193
    v_cvt_pk_bf16_f32 v49, v194, v195
    v_cvt_pk_bf16_f32 v50, v196, v197
    v_cvt_pk_bf16_f32 v51, v198, v199
    buffer_store_dwordx4 v[48:51], v7, s[16:19], s38 offen offset:0 sc1
    s_waitcnt lgkmcnt(4)
    v_add_f32 v200, v200, v72
    v_add_f32 v201, v201, v73
    v_add_f32 v202, v202, v74
    v_add_f32 v203, v203, v75
    v_add_f32 v204, v204, v76
    v_add_f32 v205, v205, v77
    v_add_f32 v206, v206, v78
    v_add_f32 v207, v207, v79
    v_mul_f32 v200, v25, v200
    v_mul_f32 v201, v25, v201
    v_mul_f32 v202, v25, v202
    v_mul_f32 v203, v25, v203
    v_mul_f32 v204, v25, v204
    v_mul_f32 v205, v25, v205
    v_mul_f32 v206, v25, v206
    v_mul_f32 v207, v25, v207
    v_cvt_pk_bf16_f32 v52, v200, v201
    v_cvt_pk_bf16_f32 v53, v202, v203
    v_cvt_pk_bf16_f32 v54, v204, v205
    v_cvt_pk_bf16_f32 v55, v206, v207
    buffer_store_dwordx4 v[52:55], v7, s[16:19], s38 offen offset:1024 sc1
    s_waitcnt lgkmcnt(2)
    v_add_f32 v208, v208, v80
    v_add_f32 v209, v209, v81
    v_add_f32 v210, v210, v82
    v_add_f32 v211, v211, v83
    v_add_f32 v212, v212, v84
    v_add_f32 v213, v213, v85
    v_add_f32 v214, v214, v86
    v_add_f32 v215, v215, v87
    v_mul_f32 v208, v25, v208
    v_mul_f32 v209, v25, v209
    v_mul_f32 v210, v25, v210
    v_mul_f32 v211, v25, v211
    v_mul_f32 v212, v25, v212
    v_mul_f32 v213, v25, v213
    v_mul_f32 v214, v25, v214
    v_mul_f32 v215, v25, v215
    v_cvt_pk_bf16_f32 v56, v208, v209
    v_cvt_pk_bf16_f32 v57, v210, v211
    v_cvt_pk_bf16_f32 v58, v212, v213
    v_cvt_pk_bf16_f32 v59, v214, v215
    buffer_store_dwordx4 v[56:59], v7, s[16:19], s38 offen offset:2048 sc1
    s_waitcnt lgkmcnt(0)
    v_add_f32 v216, v216, v88
    v_add_f32 v217, v217, v89
    v_add_f32 v218, v218, v90
    v_add_f32 v219, v219, v91
    v_add_f32 v220, v220, v92
    v_add_f32 v221, v221, v93
    v_add_f32 v222, v222, v94
    v_add_f32 v223, v223, v95
    v_mul_f32 v216, v25, v216
    v_mul_f32 v217, v25, v217
    v_mul_f32 v218, v25, v218
    v_mul_f32 v219, v25, v219
    v_mul_f32 v220, v25, v220
    v_mul_f32 v221, v25, v221
    v_mul_f32 v222, v25, v222
    v_mul_f32 v223, v25, v223
    v_cvt_pk_bf16_f32 v60, v216, v217
    v_cvt_pk_bf16_f32 v61, v218, v219
    v_cvt_pk_bf16_f32 v62, v220, v221
    v_cvt_pk_bf16_f32 v63, v222, v223
    buffer_store_dwordx4 v[60:63], v7, s[16:19], s38 offen offset:3072 sc1
    s_cmp_eq_u64 s[52:53], 0
    s_cbranch_scc1 L_p3_done
    v_mov_b32 v192, 0
    v_mov_b32 v193, 0
    v_mov_b32 v194, 0
    v_mov_b32 v195, 0
    v_mov_b32 v196, 0
    v_mov_b32 v197, 0
    v_mov_b32 v198, 0
    v_mov_b32 v199, 0
    v_mov_b32 v200, 0
    v_mov_b32 v201, 0
    v_mov_b32 v202, 0
    v_mov_b32 v203, 0
    v_mov_b32 v204, 0
    v_mov_b32 v205, 0
    v_mov_b32 v206, 0
    v_mov_b32 v207, 0
    v_mov_b32 v208, 0
    v_mov_b32 v209, 0
    v_mov_b32 v210, 0
    v_mov_b32 v211, 0
    v_mov_b32 v212, 0
    v_mov_b32 v213, 0
    v_mov_b32 v214, 0
    v_mov_b32 v215, 0
    v_mov_b32 v216, 0
    v_mov_b32 v217, 0
    v_mov_b32 v218, 0
    v_mov_b32 v219, 0
    v_mov_b32 v220, 0
    v_mov_b32 v221, 0
    v_mov_b32 v222, 0
    v_mov_b32 v223, 0
    v_mov_b32 v224, 0
    v_mov_b32 v225, 0
    v_mov_b32 v226, 0
    v_mov_b32 v227, 0
    v_mov_b32 v228, 0
    v_mov_b32 v229, 0
    v_mov_b32 v230, 0
    v_mov_b32 v231, 0
    v_mov_b32 v232, 0
    v_mov_b32 v233, 0
    v_mov_b32 v234, 0
    v_mov_b32 v235, 0
    v_mov_b32 v236, 0
    v_mov_b32 v237, 0
    v_mov_b32 v238, 0
    v_mov_b32 v239, 0
    v_mov_b32 v240, 0
    v_mov_b32 v241, 0
    v_mov_b32 v242, 0
    v_mov_b32 v243, 0
    v_mov_b32 v244, 0
    v_mov_b32 v245, 0
    v_mov_b32 v246, 0
    v_mov_b32 v247, 0
    v_mov_b32 v248, 0
    v_mov_b32 v249, 0
    v_mov_b32 v250, 0
    v_mov_b32 v251, 0
    v_mov_b32 v252, 0
    v_mov_b32 v253, 0
    v_mov_b32 v254, 0
    v_mov_b32 v255, 0
    v_mov_b32 v38, 0
    v_mov_b32 v40, 4048155338
    v_mov_b32 v39, 0
    v_mov_b32 v41, 4048155338
    s_lshl_b32 s43, s28, 12
    v_add_u32 v4, s43, v7
    s_mov_b32 s46, s45
    s_sub_u32 s40, 16, s30
    s_sub_u32 s39, 15, s30
    s_lshl_b32 s37, s39, 7
    s_and_b32 s36, s28, 3
    s_lshl_b32 s36, s36, 5
    s_add_u32 s36, s36, s37
    s_sub_u32 s50, 0, s36
L_recurrent_scan__compressed_kv_cla__moe_arch_mod__prompt_kernel_stile_151:
    s_waitcnt vmcnt(0) lgkmcnt(0)
    s_barrier
    s_mov_b32 m0, s43
    s_add_u32 s47, s46, 32768
    buffer_load_dwordx4 v4, s[12:15], s46 offen offset:0 sc1 lds
    buffer_load_dwordx4 v4, s[12:15], s46 offen offset:1024 sc1 lds
    buffer_load_dwordx4 v4, s[12:15], s46 offen offset:2048 sc1 lds
    buffer_load_dwordx4 v4, s[12:15], s46 offen offset:3072 sc1 lds
    s_add_u32 m0, s43, 32768
    s_add_u32 s46, s46, 65536
    buffer_load_dwordx4 v4, s[12:15], s47 offen offset:0 sc1 lds
    buffer_load_dwordx4 v4, s[12:15], s47 offen offset:1024 sc1 lds
    buffer_load_dwordx4 v4, s[12:15], s47 offen offset:2048 sc1 lds
    buffer_load_dwordx4 v4, s[12:15], s47 offen offset:3072 sc1 lds
    v_mov_b32 v2, v7
    s_mov_b32 s41, 4
    s_waitcnt vmcnt(0)
    s_barrier
L_recurrent_scan__compressed_kv_cla__moe_arch_mod__prompt_kernel_sunit_152:
    s_cmp_gt_i32 s50, 0
    s_cbranch_scc1 L_recurrent_scan__compressed_kv_cla__moe_arch_mod__prompt_kernel_snext_153
    ds_read_b128 v[64:67], v2 offset:0
    ds_read_b128 v[68:71], v2 offset:1024
    ds_read_b128 v[72:75], v2 offset:2048
    ds_read_b128 v[76:79], v2 offset:3072
    ds_read_b128 v[80:83], v2 offset:4096
    ds_read_b128 v[84:87], v2 offset:5120
    ds_read_b128 v[88:91], v2 offset:6144
    ds_read_b128 v[92:95], v2 offset:7168
    s_waitcnt lgkmcnt(0)
    v_mfma_f32_16x16x32_bf16 v[96:99], v[64:67], v[128:131], 0
    v_mfma_f32_16x16x32_bf16 v[104:107], v[64:67], v[144:147], 0
    v_mfma_f32_16x16x32_bf16 v[96:99], v[68:71], v[132:135], v[96:99]
    v_mfma_f32_16x16x32_bf16 v[104:107], v[68:71], v[148:151], v[104:107]
    v_mfma_f32_16x16x32_bf16 v[96:99], v[72:75], v[136:139], v[96:99]
    v_mfma_f32_16x16x32_bf16 v[104:107], v[72:75], v[152:155], v[104:107]
    v_mfma_f32_16x16x32_bf16 v[96:99], v[76:79], v[140:143], v[96:99]
    v_mfma_f32_16x16x32_bf16 v[104:107], v[76:79], v[156:159], v[104:107]
    v_mfma_f32_16x16x32_bf16 v[100:103], v[80:83], v[128:131], 0
    v_mfma_f32_16x16x32_bf16 v[108:111], v[80:83], v[144:147], 0
    v_mfma_f32_16x16x32_bf16 v[100:103], v[84:87], v[132:135], v[100:103]
    v_mfma_f32_16x16x32_bf16 v[108:111], v[84:87], v[148:151], v[108:111]
    v_mfma_f32_16x16x32_bf16 v[100:103], v[88:91], v[136:139], v[100:103]
    v_mfma_f32_16x16x32_bf16 v[108:111], v[88:91], v[152:155], v[108:111]
    v_mfma_f32_16x16x32_bf16 v[100:103], v[92:95], v[140:143], v[100:103]
    v_mfma_f32_16x16x32_bf16 v[108:111], v[92:95], v[156:159], v[108:111]
    ds_read_b128 v[64:67], v2 offset:32768
    ds_read_b128 v[68:71], v2 offset:33792
    ds_read_b128 v[72:75], v2 offset:34816
    ds_read_b128 v[76:79], v2 offset:35840
    ds_read_b128 v[80:83], v2 offset:36864
    ds_read_b128 v[84:87], v2 offset:37888
    ds_read_b128 v[88:91], v2 offset:38912
    ds_read_b128 v[92:95], v2 offset:39936
    s_nop 1
    s_cmp_lt_i32 s50, 0
    s_cbranch_scc0 L_recurrent_scan__compressed_kv_cla__moe_arch_mod__prompt_kernel_rare_154
L_recurrent_scan__compressed_kv_cla__moe_arch_mod__prompt_kernel_back_155:
    v_max3_f32 v22, v96, v97, v98
    v_max3_f32 v22, v22, v99, v100
    v_max3_f32 v22, v22, v101, v102
    v_max3_f32 v22, v22, v103, v40
    v_mov_b32 v24, v22
    s_nop 1
    v_permlane16_swap_b32 v22, v24
    s_nop 1
    v_max_f32 v22, v22, v24
    v_mov_b32 v24, v22
    s_nop 1
    v_permlane32_swap_b32 v22, v24
    s_nop 1
    v_max_f32 v22, v22, v24
    v_sub_f32 v25, v40, v22
    v_exp_f32 v25, v25
    v_mov_b32 v40, v22
    v_mul_f32 v38, v38, v25
    v_mul_f32 v192, v192, v25
    v_mul_f32 v193, v193, v25
    v_mul_f32 v194, v194, v25
    v_mul_f32 v195, v195, v25
    v_mul_f32 v196, v196, v25
    v_mul_f32 v197, v197, v25
    v_mul_f32 v198, v198, v25
    v_mul_f32 v199, v199, v25
    v_mul_f32 v200, v200, v25
    v_mul_f32 v201, v201, v25
    v_mul_f32 v202, v202, v25
    v_mul_f32 v203, v203, v25
    v_mul_f32 v204, v204, v25
    v_mul_f32 v205, v205, v25
    v_mul_f32 v206, v206, v25
    v_mul_f32 v207, v207, v25
    v_mul_f32 v208, v208, v25
    v_mul_f32 v209, v209, v25
    v_mul_f32 v210, v210, v25
    v_mul_f32 v211, v211, v25
    v_mul_f32 v212, v212, v25
    v_mul_f32 v213, v213, v25
    v_mul_f32 v214, v214, v25
    v_mul_f32 v215, v215, v25
    v_mul_f32 v216, v216, v25
    v_mul_f32 v217, v217, v25
    v_mul_f32 v218, v218, v25
    v_mul_f32 v219, v219, v25
    v_mul_f32 v220, v220, v25
    v_mul_f32 v221, v221, v25
    v_mul_f32 v222, v222, v25
    v_mul_f32 v223, v223, v25
    v_sub_f32 v96, v96, v22
    v_sub_f32 v97, v97, v22
    v_sub_f32 v98, v98, v22
    v_sub_f32 v99, v99, v22
    v_sub_f32 v100, v100, v22
    v_sub_f32 v101, v101, v22
    v_sub_f32 v102, v102, v22
    v_sub_f32 v103, v103, v22
    v_max3_f32 v23, v104, v105, v106
    v_max3_f32 v23, v23, v107, v108
    v_max3_f32 v23, v23, v109, v110
    v_max3_f32 v23, v23, v111, v41
    v_mov_b32 v24, v23
    s_nop 1
    v_permlane16_swap_b32 v23, v24
    s_nop 1
    v_max_f32 v23, v23, v24
    v_mov_b32 v24, v23
    s_nop 1
    v_permlane32_swap_b32 v23, v24
    s_nop 1
    v_max_f32 v23, v23, v24
    v_sub_f32 v25, v41, v23
    v_exp_f32 v25, v25
    v_mov_b32 v41, v23
    v_mul_f32 v39, v39, v25
    v_mul_f32 v224, v224, v25
    v_mul_f32 v225, v225, v25
    v_mul_f32 v226, v226, v25
    v_mul_f32 v227, v227, v25
    v_mul_f32 v228, v228, v25
    v_mul_f32 v229, v229, v25
    v_mul_f32 v230, v230, v25
    v_mul_f32 v231, v231, v25
    v_mul_f32 v232, v232, v25
    v_mul_f32 v233, v233, v25
    v_mul_f32 v234, v234, v25
    v_mul_f32 v235, v235, v25
    v_mul_f32 v236, v236, v25
    v_mul_f32 v237, v237, v25
    v_mul_f32 v238, v238, v25
    v_mul_f32 v239, v239, v25
    v_mul_f32 v240, v240, v25
    v_mul_f32 v241, v241, v25
    v_mul_f32 v242, v242, v25
    v_mul_f32 v243, v243, v25
    v_mul_f32 v244, v244, v25
    v_mul_f32 v245, v245, v25
    v_mul_f32 v246, v246, v25
    v_mul_f32 v247, v247, v25
    v_mul_f32 v248, v248, v25
    v_mul_f32 v249, v249, v25
    v_mul_f32 v250, v250, v25
    v_mul_f32 v251, v251, v25
    v_mul_f32 v252, v252, v25
    v_mul_f32 v253, v253, v25
    v_mul_f32 v254, v254, v25
    v_mul_f32 v255, v255, v25
    v_sub_f32 v104, v104, v23
    v_sub_f32 v105, v105, v23
    v_sub_f32 v106, v106, v23
    v_sub_f32 v107, v107, v23
    v_sub_f32 v108, v108, v23
    v_sub_f32 v109, v109, v23
    v_sub_f32 v110, v110, v23
    v_sub_f32 v111, v111, v23
    v_exp_f32 v96, v96
    v_exp_f32 v97, v97
    v_exp_f32 v98, v98
    v_exp_f32 v99, v99
    v_exp_f32 v104, v104
    v_exp_f32 v105, v105
    v_exp_f32 v106, v106
    v_exp_f32 v107, v107
    v_exp_f32 v100, v100
    v_exp_f32 v101, v101
    v_exp_f32 v102, v102
    v_exp_f32 v103, v103
    v_exp_f32 v108, v108
    v_exp_f32 v109, v109
    v_exp_f32 v110, v110
    v_exp_f32 v111, v111
    v_add_f32 v38, v38, v96
    v_add_f32 v38, v38, v97
    v_cvt_pk_bf16_f32 v48, v96, v97
    v_add_f32 v38, v38, v98
    v_add_f32 v38, v38, v99
    v_cvt_pk_bf16_f32 v49, v98, v99
    v_add_f32 v39, v39, v104
    v_add_f32 v39, v39, v105
    v_cvt_pk_bf16_f32 v52, v104, v105
    v_add_f32 v39, v39, v106
    v_add_f32 v39, v39, v107
    v_cvt_pk_bf16_f32 v53, v106, v107
    v_add_f32 v38, v38, v100
    v_add_f32 v38, v38, v101
    v_cvt_pk_bf16_f32 v50, v100, v101
    v_add_f32 v38, v38, v102
    v_add_f32 v38, v38, v103
    v_cvt_pk_bf16_f32 v51, v102, v103
    v_add_f32 v39, v39, v108
    v_add_f32 v39, v39, v109
    v_cvt_pk_bf16_f32 v54, v108, v109
    v_add_f32 v39, v39, v110
    v_add_f32 v39, v39, v111
    v_cvt_pk_bf16_f32 v55, v110, v111
    s_waitcnt lgkmcnt(0)
    s_nop 0
    v_mfma_f32_16x16x32_bf16 v[192:195], v[64:67], v[48:51], v[192:195]
    v_mfma_f32_16x16x32_bf16 v[224:227], v[64:67], v[52:55], v[224:227]
    v_mfma_f32_16x16x32_bf16 v[196:199], v[68:71], v[48:51], v[196:199]
    v_mfma_f32_16x16x32_bf16 v[228:231], v[68:71], v[52:55], v[228:231]
    v_mfma_f32_16x16x32_bf16 v[200:203], v[72:75], v[48:51], v[200:203]
    v_mfma_f32_16x16x32_bf16 v[232:235], v[72:75], v[52:55], v[232:235]
    v_mfma_f32_16x16x32_bf16 v[204:207], v[76:79], v[48:51], v[204:207]
    v_mfma_f32_16x16x32_bf16 v[236:239], v[76:79], v[52:55], v[236:239]
    v_mfma_f32_16x16x32_bf16 v[208:211], v[80:83], v[48:51], v[208:211]
    v_mfma_f32_16x16x32_bf16 v[240:243], v[80:83], v[52:55], v[240:243]
    v_mfma_f32_16x16x32_bf16 v[212:215], v[84:87], v[48:51], v[212:215]
    v_mfma_f32_16x16x32_bf16 v[244:247], v[84:87], v[52:55], v[244:247]
    v_mfma_f32_16x16x32_bf16 v[216:219], v[88:91], v[48:51], v[216:219]
    v_mfma_f32_16x16x32_bf16 v[248:251], v[88:91], v[52:55], v[248:251]
    v_mfma_f32_16x16x32_bf16 v[220:223], v[92:95], v[48:51], v[220:223]
    v_mfma_f32_16x16x32_bf16 v[252:255], v[92:95], v[52:55], v[252:255]
L_recurrent_scan__compressed_kv_cla__moe_arch_mod__prompt_kernel_snext_153:
    v_add_u32 v2, 8192, v2
    s_add_u32 s50, s50, 32
    s_sub_u32 s41, s41, 1
    s_cmp_lg_u32 s41, 0
    s_cbranch_scc1 L_recurrent_scan__compressed_kv_cla__moe_arch_mod__prompt_kernel_sunit_152
    s_sub_u32 s40, s40, 1
    s_cmp_lg_u32 s40, 0
    s_cbranch_scc1 L_recurrent_scan__compressed_kv_cla__moe_arch_mod__prompt_kernel_stile_151
    v_mov_b32 v20, v38
    s_nop 1
    v_permlane16_swap_b32 v38, v20
    s_nop 1
    v_add_f32 v38, v38, v20
    v_mov_b32 v20, v38
    s_nop 1
    v_permlane32_swap_b32 v38, v20
    s_nop 1
    v_add_f32 v38, v38, v20
    v_mov_b32 v20, v39
    s_nop 1
    v_permlane16_swap_b32 v39, v20
    s_nop 1
    v_add_f32 v39, v39, v20
    v_mov_b32 v20, v39
    s_nop 1
    v_permlane32_swap_b32 v39, v20
    s_nop 1
    v_add_f32 v39, v39, v20
    s_mov_b32 s36, 0x5d800000
    v_cmp_nge_f32 vcc, s36, v38
    s_nop 0
    s_or_b64 s[52:53], s[52:53], vcc
    v_cmp_nge_f32 vcc, s36, v39
    s_nop 0
    s_or_b64 s[52:53], s[52:53], vcc
    v_rcp_f32 v38, v38
    v_rcp_f32 v39, v39
    s_lshl_b32 s38, s39, 3
    s_and_b32 s37, s28, 3
    s_lshl_b32 s37, s37, 1
    s_add_u32 s38, s38, s37
    s_lshl_b32 s38, s38, 17
    s_lshl_b32 s37, s29, 12
    s_add_u32 s38, s38, s37
    v_mul_f32 v192, v38, v192
    v_mul_f32 v193, v38, v193
    v_mul_f32 v194, v38, v194
    v_mul_f32 v195, v38, v195
    v_mul_f32 v196, v38, v196
    v_mul_f32 v197, v38, v197
    v_mul_f32 v198, v38, v198
    v_mul_f32 v199, v38, v199
    v_cvt_pk_bf16_f32 v22, v192, v193
    v_cvt_pk_bf16_f32 v23, v194, v195
    v_cvt_pk_bf16_f32 v24, v196, v197
    v_cvt_pk_bf16_f32 v25, v198, v199
    buffer_store_dwordx4 v[22:25], v7, s[16:19], s38 offen offset:0 sc1
    v_mul_f32 v200, v38, v200
    v_mul_f32 v201, v38, v201
    v_mul_f32 v202, v38, v202
    v_mul_f32 v203, v38, v203
    v_mul_f32 v204, v38, v204
    v_mul_f32 v205, v38, v205
    v_mul_f32 v206, v38, v206
    v_mul_f32 v207, v38, v207
    v_cvt_pk_bf16_f32 v26, v200, v201
    v_cvt_pk_bf16_f32 v27, v202, v203
    v_cvt_pk_bf16_f32 v28, v204, v205
    v_cvt_pk_bf16_f32 v29, v206, v207
    buffer_store_dwordx4 v[26:29], v7, s[16:19], s38 offen offset:1024 sc1
    v_mul_f32 v208, v38, v208
    v_mul_f32 v209, v38, v209
    v_mul_f32 v210, v38, v210
    v_mul_f32 v211, v38, v211
    v_mul_f32 v212, v38, v212
    v_mul_f32 v213, v38, v213
    v_mul_f32 v214, v38, v214
    v_mul_f32 v215, v38, v215
    v_cvt_pk_bf16_f32 v30, v208, v209
    v_cvt_pk_bf16_f32 v31, v210, v211
    v_cvt_pk_bf16_f32 v32, v212, v213
    v_cvt_pk_bf16_f32 v33, v214, v215
    buffer_store_dwordx4 v[30:33], v7, s[16:19], s38 offen offset:2048 sc1
    v_mul_f32 v216, v38, v216
    v_mul_f32 v217, v38, v217
    v_mul_f32 v218, v38, v218
    v_mul_f32 v219, v38, v219
    v_mul_f32 v220, v38, v220
    v_mul_f32 v221, v38, v221
    v_mul_f32 v222, v38, v222
    v_mul_f32 v223, v38, v223
    v_cvt_pk_bf16_f32 v34, v216, v217
    v_cvt_pk_bf16_f32 v35, v218, v219
    v_cvt_pk_bf16_f32 v36, v220, v221
    v_cvt_pk_bf16_f32 v37, v222, v223
    buffer_store_dwordx4 v[34:37], v7, s[16:19], s38 offen offset:3072 sc1
    s_add_u32 s38, s38, 131072
    v_mul_f32 v224, v39, v224
    v_mul_f32 v225, v39, v225
    v_mul_f32 v226, v39, v226
    v_mul_f32 v227, v39, v227
    v_mul_f32 v228, v39, v228
    v_mul_f32 v229, v39, v229
    v_mul_f32 v230, v39, v230
    v_mul_f32 v231, v39, v231
    v_cvt_pk_bf16_f32 v22, v224, v225
    v_cvt_pk_bf16_f32 v23, v226, v227
    v_cvt_pk_bf16_f32 v24, v228, v229
    v_cvt_pk_bf16_f32 v25, v230, v231
    buffer_store_dwordx4 v[22:25], v7, s[16:19], s38 offen offset:0 sc1
    v_mul_f32 v232, v39, v232
    v_mul_f32 v233, v39, v233
    v_mul_f32 v234, v39, v234
    v_mul_f32 v235, v39, v235
    v_mul_f32 v236, v39, v236
    v_mul_f32 v237, v39, v237
    v_mul_f32 v238, v39, v238
    v_mul_f32 v239, v39, v239
    v_cvt_pk_bf16_f32 v26, v232, v233
    v_cvt_pk_bf16_f32 v27, v234, v235
    v_cvt_pk_bf16_f32 v28, v236, v237
    v_cvt_pk_bf16_f32 v29, v238, v239
    buffer_store_dwordx4 v[26:29], v7, s[16:19], s38 offen offset:1024 sc1
    v_mul_f32 v240, v39, v240
    v_mul_f32 v241, v39, v241
    v_mul_f32 v242, v39, v242
    v_mul_f32 v243, v39, v243
    v_mul_f32 v244, v39, v244
    v_mul_f32 v245, v39, v245
    v_mul_f32 v246, v39, v246
    v_mul_f32 v247, v39, v247
    v_cvt_pk_bf16_f32 v30, v240, v241
    v_cvt_pk_bf16_f32 v31, v242, v243
    v_cvt_pk_bf16_f32 v32, v244, v245
    v_cvt_pk_bf16_f32 v33, v246, v247
    buffer_store_dwordx4 v[30:33], v7, s[16:19], s38 offen offset:2048 sc1
    v_mul_f32 v248, v39, v248
    v_mul_f32 v249, v39, v249
    v_mul_f32 v250, v39, v250
    v_mul_f32 v251, v39, v251
    v_mul_f32 v252, v39, v252
    v_mul_f32 v253, v39, v253
    v_mul_f32 v254, v39, v254
    v_mul_f32 v255, v39, v255
    v_cvt_pk_bf16_f32 v34, v248, v249
    v_cvt_pk_bf16_f32 v35, v250, v251
    v_cvt_pk_bf16_f32 v36, v252, v253
    v_cvt_pk_bf16_f32 v37, v254, v255
    buffer_store_dwordx4 v[34:37], v7, s[16:19], s38 offen offset:3072 sc1
    s_branch L_p3_done
L_recurrent_scan__compressed_kv_cla__moe_arch_mod__prompt_kernel_rare_1:
    s_mul_i32 s36, s28, 12288
    s_add_u32 s36, s36, 61865984
    v_lshl_add_u32 v16, v1, 4, s36
    v_mov_b32 v108, 0
    v_mov_b32 v109, 0
    v_mov_b32 v110, 0
    v_mov_b32 v111, 0
    global_store_dwordx4 v16, v[108:111], s[90:91] sc1
    v_add_u32 v16, 1024, v16
    global_store_dwordx4 v16, v[108:111], s[90:91] sc1
    v_add_u32 v16, 1024, v16
    global_store_dwordx4 v16, v[108:111], s[90:91] sc1
    v_add_u32 v16, 1024, v16
    global_store_dwordx4 v16, v[108:111], s[90:91] sc1
    v_add_u32 v16, 1024, v16
    global_store_dwordx4 v16, v[108:111], s[90:91] sc1
    v_add_u32 v16, 1024, v16
    global_store_dwordx4 v16, v[108:111], s[90:91] sc1
    v_add_u32 v16, 1024, v16
    global_store_dwordx4 v16, v[108:111], s[90:91] sc1
    v_add_u32 v16, 1024, v16
    global_store_dwordx4 v16, v[108:111], s[90:91] sc1
    v_add_u32 v16, 1024, v16
    global_store_dwordx4 v16, v[108:111], s[90:91] sc1
    v_add_u32 v16, 1024, v16
    global_store_dwordx4 v16, v[108:111], s[90:91] sc1
    v_add_u32 v16, 1024, v16
    global_store_dwordx4 v16, v[108:111], s[90:91] sc1
    v_add_u32 v16, 1024, v16
    global_store_dwordx4 v16, v[108:111], s[90:91] sc1
    v_add_u32 v16, 1024, v16
    s_branch L_recurrent_scan__compressed_kv_cla__moe_arch_mod__prompt_kernel_back_2
L_recurrent_scan__compressed_kv_cla__moe_arch_mod__prompt_kernel_rare_7:
    v_mov_b32 v19, 1
    s_mov_b64 exec, 1
    global_store_dword v118, v19, s[88:89] sc1
    s_mov_b64 exec, -1
    s_branch L_recurrent_scan__compressed_kv_cla__moe_arch_mod__prompt_kernel_back_8
L_recurrent_scan__compressed_kv_cla__moe_arch_mod__prompt_kernel_rare_9:
    v_and_b32 v108, 7, v1
    v_lshlrev_b32 v108, 3, v108
    v_add_u32 v109, 147712, v108
    ds_read_b64 v[110:111], v109
    ds_read_b32 v112, v109 offset:64
    s_lshl_b32 s36, s2, 6
    s_add_u32 s36, s36, 4194304
    s_lshl_b32 s37, s2, 3
    s_add_u32 s37, s37, 4276224
    s_waitcnt lgkmcnt(0)
    v_mov_b32 v114, v112
    s_nop 1
    v_max_u32_dpp v114, v114, v114 quad_perm:[1,0,3,2] row_mask:0xf bank_mask:0xf
    s_nop 1
    v_max_u32_dpp v114, v114, v114 quad_perm:[2,3,0,1] row_mask:0xf bank_mask:0xf
    s_nop 1
    v_max_u32_dpp v114, v114, v114 row_half_mirror row_mask:0xf bank_mask:0xf
    v_cmp_eq_u32 vcc, v114, v112
    s_nop 1
    v_cndmask_b32 v115, v112, v118, vcc
    s_nop 1
    v_max_u32_dpp v115, v115, v115 quad_perm:[1,0,3,2] row_mask:0xf bank_mask:0xf
    s_nop 1
    v_max_u32_dpp v115, v115, v115 quad_perm:[2,3,0,1] row_mask:0xf bank_mask:0xf
    s_nop 1
    v_max_u32_dpp v115, v115, v115 row_half_mirror row_mask:0xf bank_mask:0xf
    s_mov_b64 exec, 0xff
    buffer_store_dwordx2 v[110:111], v108, s[24:27], s36 offen sc1
    s_mov_b64 exec, 1
    buffer_store_dwordx2 v[114:115], v108, s[24:27], s37 offen sc1
    s_mov_b64 exec, -1
    s_nop 3
    s_branch L_recurrent_scan__compressed_kv_cla__moe_arch_mod__prompt_kernel_back_10
L_recurrent_scan__compressed_kv_cla__moe_arch_mod__prompt_kernel_rare_11:
    v_lshrrev_b32 v3, 4, v1
    s_lshl_b32 s37, s28, 4
    v_add_u32 v19, s37, v3
    v_lshlrev_b32 v19, 13, v19
    s_lshl_b32 s37, s29, 8
    v_add_u32 v19, s37, v19
    v_and_b32 v16, 15, v1
    v_lshlrev_b32 v3, 1, v3
    v_xor_b32 v16, v16, v3
    v_lshl_add_u32 v2, v16, 4, v19
    v_add_u32 v3, 31744, v2
    v_xor_b32 v16, 8, v16
    v_lshl_add_u32 v4, v16, 4, v19
    v_add_u32 v4, 63488, v4
    v_add_u32 v5, 31744, v4
    s_mov_b32 s4, s96
    s_and_b32 s5, s97, 0xffff
    s_mov_b32 s6, 8388608
    s_mov_b32 s7, 0x20000
    s_mov_b32 s31, 0
    s_mov_b32 s40, 1048576
    s_mov_b32 s10, 0
    s_mov_b32 s34, 0x30000
    s_branch L_recurrent_scan__compressed_kv_cla__moe_arch_mod__prompt_kernel_back_12
L_recurrent_scan__compressed_kv_cla__moe_arch_mod__prompt_kernel_w0_13:
    s_cmp_eq_u32 s35, 0
    s_cbranch_scc0 L_recurrent_scan__compressed_kv_cla__moe_arch_mod__prompt_kernel_swn_16
    s_waitcnt vmcnt(2)
    s_branch L_recurrent_scan__compressed_kv_cla__moe_arch_mod__prompt_kernel_swend_15
L_recurrent_scan__compressed_kv_cla__moe_arch_mod__prompt_kernel_swn_16:
    s_waitcnt vmcnt(2)
L_recurrent_scan__compressed_kv_cla__moe_arch_mod__prompt_kernel_swend_15:
    s_branch L_recurrent_scan__compressed_kv_cla__moe_arch_mod__prompt_kernel_w0b_14
L_recurrent_scan__compressed_kv_cla__moe_arch_mod__prompt_kernel_rare_19:
    s_cmp_eq_u32 s35, 0
    s_cbranch_scc0 L_recurrent_scan__compressed_kv_cla__moe_arch_mod__prompt_kernel_swn_18
    global_load_dword v116, v118, s[88:89] sc1
    s_branch L_recurrent_scan__compressed_kv_cla__moe_arch_mod__prompt_kernel_swend_17
L_recurrent_scan__compressed_kv_cla__moe_arch_mod__prompt_kernel_swn_18:
    v_and_b32 v117, 15, v1
    v_add_u32 v117, 112, v117
    v_lshlrev_b32 v117, 7, v117
    global_load_dword v116, v117, s[90:91] sc1
L_recurrent_scan__compressed_kv_cla__moe_arch_mod__prompt_kernel_swend_17:
    s_branch L_recurrent_scan__compressed_kv_cla__moe_arch_mod__prompt_kernel_back_20
L_recurrent_scan__compressed_kv_cla__moe_arch_mod__prompt_kernel_rare_25:
    s_mov_b32 s61, 0x40000
L_recurrent_scan__compressed_kv_cla__moe_arch_mod__prompt_kernel_spin_23:
    s_sub_u32 s61, s61, 1
    s_cbranch_scc1 L_recurrent_scan__compressed_kv_cla__moe_arch_mod__prompt_kernel_spinx_24
    s_sleep 8
    global_load_dword v116, v118, s[88:89] sc1
    s_waitcnt vmcnt(0)
    v_readfirstlane_b32 s36, v116
    s_nop 0
    s_cmp_lt_u32 s36, 1
    s_cbranch_scc1 L_recurrent_scan__compressed_kv_cla__moe_arch_mod__prompt_kernel_spin_23
L_recurrent_scan__compressed_kv_cla__moe_arch_mod__prompt_kernel_spinx_24:
    s_branch L_recurrent_scan__compressed_kv_cla__moe_arch_mod__prompt_kernel_back_26
L_recurrent_scan__compressed_kv_cla__moe_arch_mod__prompt_kernel_w0_21:
    s_waitcnt vmcnt(0)
    s_cmp_eq_u32 s35, 0
    s_cbranch_scc0 L_recurrent_scan__compressed_kv_cla__moe_arch_mod__prompt_kernel_swn_30
    v_readfirstlane_b32 s36, v116
    s_nop 0
    s_cmp_lt_u32 s36, 1
    s_cbranch_scc1 L_recurrent_scan__compressed_kv_cla__moe_arch_mod__prompt_kernel_rare_25
L_recurrent_scan__compressed_kv_cla__moe_arch_mod__prompt_kernel_back_26:
    s_branch L_recurrent_scan__compressed_kv_cla__moe_arch_mod__prompt_kernel_swend_29
L_recurrent_scan__compressed_kv_cla__moe_arch_mod__prompt_kernel_swn_30:
    s_mov_b32 s61, 0x40000
L_recurrent_scan__compressed_kv_cla__moe_arch_mod__prompt_kernel_lspin_27:
    v_cmp_gt_u32 vcc, 16, v116
    s_nop 0
    s_cmp_eq_u64 vcc, 0
    s_cbranch_scc1 L_recurrent_scan__compressed_kv_cla__moe_arch_mod__prompt_kernel_lspinx_28
    s_sub_u32 s61, s61, 1
    s_cbranch_scc1 L_recurrent_scan__compressed_kv_cla__moe_arch_mod__prompt_kernel_lspinx_28
    s_sleep 8
    global_load_dword v116, v117, s[90:91] sc1
    s_waitcnt vmcnt(0)
    s_branch L_recurrent_scan__compressed_kv_cla__moe_arch_mod__prompt_kernel_lspin_27
L_recurrent_scan__compressed_kv_cla__moe_arch_mod__prompt_kernel_lspinx_28:
L_recurrent_scan__compressed_kv_cla__moe_arch_mod__prompt_kernel_swend_29:
    s_branch L_recurrent_scan__compressed_kv_cla__moe_arch_mod__prompt_kernel_w0b_22
L_recurrent_scan__compressed_kv_cla__moe_arch_mod__prompt_kernel_rare_31:
    s_lshr_b32 s36, s2, 4
    s_add_u32 s36, s36, 112
    s_lshl_b32 s36, s36, 7
    v_mov_b32 v16, s36
    v_mov_b32 v19, 1
    s_mov_b64 exec, 1
    global_atomic_add v16, v19, s[90:91]
    s_mov_b64 exec, -1
    s_nop 3
    s_branch L_recurrent_scan__compressed_kv_cla__moe_arch_mod__prompt_kernel_back_32
L_recurrent_scan__compressed_kv_cla__moe_arch_mod__prompt_kernel_w0_33:
    s_cmp_eq_u32 s35, 0
    s_cbranch_scc0 L_recurrent_scan__compressed_kv_cla__moe_arch_mod__prompt_kernel_swn_36
    s_waitcnt vmcnt(2)
    s_branch L_recurrent_scan__compressed_kv_cla__moe_arch_mod__prompt_kernel_swend_35
L_recurrent_scan__compressed_kv_cla__moe_arch_mod__prompt_kernel_swn_36:
    s_waitcnt vmcnt(2)
L_recurrent_scan__compressed_kv_cla__moe_arch_mod__prompt_kernel_swend_35:
    s_branch L_recurrent_scan__compressed_kv_cla__moe_arch_mod__prompt_kernel_w0b_34
L_recurrent_scan__compressed_kv_cla__moe_arch_mod__prompt_kernel_rare_39:
    v_lshrrev_b32 v3, 4, v1
    s_lshl_b32 s37, s28, 4
    v_add_u32 v19, s37, v3
    v_lshlrev_b32 v19, 13, v19
    s_lshl_b32 s37, s29, 8
    v_add_u32 v19, s37, v19
    v_and_b32 v16, 15, v1
    v_lshlrev_b32 v3, 1, v3
    v_xor_b32 v16, v16, v3
    v_lshl_add_u32 v2, v16, 4, v19
    v_add_u32 v3, 31744, v2
    v_xor_b32 v16, 8, v16
    v_lshl_add_u32 v4, v16, 4, v19
    v_add_u32 v4, 63488, v4
    v_add_u32 v5, 31744, v4
    s_mov_b32 s4, s96
    s_and_b32 s5, s97, 0xffff
    s_mov_b32 s6, 8388608
    s_mov_b32 s7, 0x20000
    s_mov_b32 s31, 0
    s_mov_b32 s40, 1048576
    s_mov_b32 s10, 0
    s_mov_b32 s34, 0x30000
    s_branch L_recurrent_scan__compressed_kv_cla__moe_arch_mod__prompt_kernel_back_40
L_recurrent_scan__compressed_kv_cla__moe_arch_mod__prompt_kernel_rare_45:
    s_mov_b32 s61, 0x40000
L_recurrent_scan__compressed_kv_cla__moe_arch_mod__prompt_kernel_spin_43:
    s_sub_u32 s61, s61, 1
    s_cbranch_scc1 L_recurrent_scan__compressed_kv_cla__moe_arch_mod__prompt_kernel_spinx_44
    s_sleep 8
    global_load_dword v56, v57, s[90:91] sc1
    s_waitcnt vmcnt(0)
    v_readfirstlane_b32 s36, v56
    s_nop 0
    s_cmp_lt_u32 s36, 1
    s_cbranch_scc1 L_recurrent_scan__compressed_kv_cla__moe_arch_mod__prompt_kernel_spin_43
L_recurrent_scan__compressed_kv_cla__moe_arch_mod__prompt_kernel_spinx_44:
    s_branch L_recurrent_scan__compressed_kv_cla__moe_arch_mod__prompt_kernel_back_46
L_recurrent_scan__compressed_kv_cla__moe_arch_mod__prompt_kernel_rare_51:
    s_cmp_lt_u32 s28, 4
    s_cbranch_scc0 L_recurrent_scan__compressed_kv_cla__moe_arch_mod__prompt_kernel_ng_48
    s_cmp_eq_u32 s35, 2
    s_cbranch_scc0 L_recurrent_scan__compressed_kv_cla__moe_arch_mod__prompt_kernel_swn_50
    s_branch L_recurrent_scan__compressed_kv_cla__moe_arch_mod__prompt_kernel_swend_49
L_recurrent_scan__compressed_kv_cla__moe_arch_mod__prompt_kernel_swn_50:
    s_mov_b64 s[4:5], s[12:13]
    s_mov_b32 s6, s14
    s_mov_b32 s31, s45
    s_mov_b32 s40, 65536
    v_add_u32 v2, s33, v58
    v_mov_b32 v3, v2
    v_mov_b32 v4, v2
    v_mov_b32 v5, v2
    s_cmp_eq_u32 s28, 0
    s_cbranch_scc0 L_recurrent_scan__compressed_kv_cla__moe_arch_mod__prompt_kernel_g_47
    s_waitcnt vmcnt(12)
    v_readfirstlane_b32 s36, v56
    s_nop 0
    s_cmp_lt_u32 s36, 1
    s_cbranch_scc1 L_recurrent_scan__compressed_kv_cla__moe_arch_mod__prompt_kernel_rare_45
L_recurrent_scan__compressed_kv_cla__moe_arch_mod__prompt_kernel_back_46:
L_recurrent_scan__compressed_kv_cla__moe_arch_mod__prompt_kernel_g_47:
L_recurrent_scan__compressed_kv_cla__moe_arch_mod__prompt_kernel_swend_49:
L_recurrent_scan__compressed_kv_cla__moe_arch_mod__prompt_kernel_ng_48:
    s_branch L_recurrent_scan__compressed_kv_cla__moe_arch_mod__prompt_kernel_back_52
L_recurrent_scan__compressed_kv_cla__moe_arch_mod__prompt_kernel_rare_56:
    s_cmp_lt_u32 s28, 4
    s_cbranch_scc0 L_recurrent_scan__compressed_kv_cla__moe_arch_mod__prompt_kernel_ng_53
    s_cmp_eq_u32 s35, 2
    s_cbranch_scc0 L_recurrent_scan__compressed_kv_cla__moe_arch_mod__prompt_kernel_swn_55
    s_cmp_eq_u32 s28, 0
    s_cbranch_scc0 L_recurrent_scan__compressed_kv_cla__moe_arch_mod__prompt_kernel_g_42
    s_add_u32 s36, s29, 64
    s_lshl_b32 s36, s36, 7
    v_mov_b32 v57, s36
    global_load_dword v56, v57, s[90:91] sc1
L_recurrent_scan__compressed_kv_cla__moe_arch_mod__prompt_kernel_g_42:
    s_branch L_recurrent_scan__compressed_kv_cla__moe_arch_mod__prompt_kernel_swend_54
L_recurrent_scan__compressed_kv_cla__moe_arch_mod__prompt_kernel_swn_55:
L_recurrent_scan__compressed_kv_cla__moe_arch_mod__prompt_kernel_swend_54:
L_recurrent_scan__compressed_kv_cla__moe_arch_mod__prompt_kernel_ng_53:
    s_branch L_recurrent_scan__compressed_kv_cla__moe_arch_mod__prompt_kernel_back_57
L_recurrent_scan__compressed_kv_cla__moe_arch_mod__prompt_kernel_rare_61:
    s_cmp_ge_u32 s28, 4
    s_cbranch_scc0 L_recurrent_scan__compressed_kv_cla__moe_arch_mod__prompt_kernel_ng_58
    s_cmp_eq_u32 s35, 2
    s_cbranch_scc0 L_recurrent_scan__compressed_kv_cla__moe_arch_mod__prompt_kernel_swn_60
    s_branch L_recurrent_scan__compressed_kv_cla__moe_arch_mod__prompt_kernel_swend_59
L_recurrent_scan__compressed_kv_cla__moe_arch_mod__prompt_kernel_swn_60:
    s_mov_b64 s[4:5], s[12:13]
    s_mov_b32 s6, s14
    s_mov_b32 s31, s45
    s_mov_b32 s40, 65536
    v_add_u32 v2, s33, v58
    v_mov_b32 v3, v2
    v_mov_b32 v4, v2
    v_mov_b32 v5, v2
L_recurrent_scan__compressed_kv_cla__moe_arch_mod__prompt_kernel_swend_59:
L_recurrent_scan__compressed_kv_cla__moe_arch_mod__prompt_kernel_ng_58:
    s_branch L_recurrent_scan__compressed_kv_cla__moe_arch_mod__prompt_kernel_back_62
L_recurrent_scan__compressed_kv_cla__moe_arch_mod__prompt_kernel_rare_67:
    s_cmp_eq_u32 s35, 3
    s_cbranch_scc0 L_recurrent_scan__compressed_kv_cla__moe_arch_mod__prompt_kernel_nv0_63
    s_add_u32 m0, s33, 65536
    s_add_u32 s36, s45, 32768
    buffer_load_dwordx4 v2, s[12:15], s36 offen offset:0 sc1 lds
    buffer_load_dwordx4 v2, s[12:15], s36 offen offset:1024 sc1 lds
    buffer_load_dwordx4 v2, s[12:15], s36 offen offset:2048 sc1 lds
    buffer_load_dwordx4 v2, s[12:15], s36 offen offset:3072 sc1 lds
L_recurrent_scan__compressed_kv_cla__moe_arch_mod__prompt_kernel_nv0_63:
    s_cmp_ge_u32 s28, 4
    s_cbranch_scc0 L_recurrent_scan__compressed_kv_cla__moe_arch_mod__prompt_kernel_ng_64
    s_cmp_eq_u32 s35, 2
    s_cbranch_scc0 L_recurrent_scan__compressed_kv_cla__moe_arch_mod__prompt_kernel_swn_66
    s_add_u32 s36, s28, s30
    s_cmp_eq_u32 s36, 4
    s_cbranch_scc0 L_recurrent_scan__compressed_kv_cla__moe_arch_mod__prompt_kernel_g_41
    s_add_u32 s36, s29, 64
    s_lshl_b32 s36, s36, 7
    v_mov_b32 v62, s36
    v_mov_b32 v63, 1
    s_mov_b64 exec, 1
    global_atomic_add v62, v63, s[90:91]
    s_mov_b64 exec, -1
    s_nop 3
L_recurrent_scan__compressed_kv_cla__moe_arch_mod__prompt_kernel_g_41:
    s_branch L_recurrent_scan__compressed_kv_cla__moe_arch_mod__prompt_kernel_swend_65
L_recurrent_scan__compressed_kv_cla__moe_arch_mod__prompt_kernel_swn_66:
L_recurrent_scan__compressed_kv_cla__moe_arch_mod__prompt_kernel_swend_65:
L_recurrent_scan__compressed_kv_cla__moe_arch_mod__prompt_kernel_ng_64:
    s_branch L_recurrent_scan__compressed_kv_cla__moe_arch_mod__prompt_kernel_back_68
L_recurrent_scan__compressed_kv_cla__moe_arch_mod__prompt_kernel_rare_75:
    s_add_u32 s36, s35, s52
    s_cmp_eq_u32 s36, 0
    s_cbranch_scc0 L_recurrent_scan__compressed_kv_cla__moe_arch_mod__prompt_kernel_swn_70
    buffer_store_dwordx4 v[128:131], v58, s[12:15], s46 offen sc1
    s_branch L_recurrent_scan__compressed_kv_cla__moe_arch_mod__prompt_kernel_swend_69
L_recurrent_scan__compressed_kv_cla__moe_arch_mod__prompt_kernel_swn_70:
    s_cmp_eq_u32 s36, 1
    s_cbranch_scc0 L_recurrent_scan__compressed_kv_cla__moe_arch_mod__prompt_kernel_swn_71
    buffer_store_dwordx4 v[144:147], v58, s[12:15], s47 offen sc1
    s_branch L_recurrent_scan__compressed_kv_cla__moe_arch_mod__prompt_kernel_swend_69
L_recurrent_scan__compressed_kv_cla__moe_arch_mod__prompt_kernel_swn_71:
    s_cmp_eq_u32 s36, 2
    s_cbranch_scc0 L_recurrent_scan__compressed_kv_cla__moe_arch_mod__prompt_kernel_swn_72
    buffer_store_dwordx4 v[160:163], v58, s[12:15], s48 offen sc1
    s_branch L_recurrent_scan__compressed_kv_cla__moe_arch_mod__prompt_kernel_swend_69
L_recurrent_scan__compressed_kv_cla__moe_arch_mod__prompt_kernel_swn_72:
    s_cmp_eq_u32 s36, 3
    s_cbranch_scc0 L_recurrent_scan__compressed_kv_cla__moe_arch_mod__prompt_kernel_swn_73
    buffer_store_dwordx4 v[176:179], v58, s[12:15], s49 offen sc1
    s_branch L_recurrent_scan__compressed_kv_cla__moe_arch_mod__prompt_kernel_swend_69
L_recurrent_scan__compressed_kv_cla__moe_arch_mod__prompt_kernel_swn_73:
    s_cmp_eq_u32 s36, 4
    s_cbranch_scc0 L_recurrent_scan__compressed_kv_cla__moe_arch_mod__prompt_kernel_swn_74
    buffer_store_dwordx4 v[128:131], v58, s[12:15], s46 offen sc1
    s_branch L_recurrent_scan__compressed_kv_cla__moe_arch_mod__prompt_kernel_swend_69
L_recurrent_scan__compressed_kv_cla__moe_arch_mod__prompt_kernel_swn_74:
    buffer_store_dwordx4 v[160:163], v58, s[12:15], s48 offen sc1
L_recurrent_scan__compressed_kv_cla__moe_arch_mod__prompt_kernel_swend_69:
    s_branch L_recurrent_scan__compressed_kv_cla__moe_arch_mod__prompt_kernel_back_76
L_recurrent_scan__compressed_kv_cla__moe_arch_mod__prompt_kernel_rare_79:
    s_add_u32 s36, s35, s52
    s_cmp_eq_u32 s36, 4
    s_cbranch_scc0 L_recurrent_scan__compressed_kv_cla__moe_arch_mod__prompt_kernel_swn_78
    buffer_store_dwordx4 v[132:135], v59, s[12:15], s46 offen sc1
    s_branch L_recurrent_scan__compressed_kv_cla__moe_arch_mod__prompt_kernel_swend_77
L_recurrent_scan__compressed_kv_cla__moe_arch_mod__prompt_kernel_swn_78:
    buffer_store_dwordx4 v[164:167], v59, s[12:15], s48 offen sc1
L_recurrent_scan__compressed_kv_cla__moe_arch_mod__prompt_kernel_swend_77:
    s_branch L_recurrent_scan__compressed_kv_cla__moe_arch_mod__prompt_kernel_back_80
L_recurrent_scan__compressed_kv_cla__moe_arch_mod__prompt_kernel_rare_87:
    s_add_u32 s36, s35, s52
    s_cmp_eq_u32 s36, 0
    s_cbranch_scc0 L_recurrent_scan__compressed_kv_cla__moe_arch_mod__prompt_kernel_swn_82
    buffer_store_dwordx4 v[132:135], v59, s[12:15], s46 offen sc1
    s_branch L_recurrent_scan__compressed_kv_cla__moe_arch_mod__prompt_kernel_swend_81
L_recurrent_scan__compressed_kv_cla__moe_arch_mod__prompt_kernel_swn_82:
    s_cmp_eq_u32 s36, 1
    s_cbranch_scc0 L_recurrent_scan__compressed_kv_cla__moe_arch_mod__prompt_kernel_swn_83
    buffer_store_dwordx4 v[148:151], v59, s[12:15], s47 offen sc1
    s_branch L_recurrent_scan__compressed_kv_cla__moe_arch_mod__prompt_kernel_swend_81
L_recurrent_scan__compressed_kv_cla__moe_arch_mod__prompt_kernel_swn_83:
    s_cmp_eq_u32 s36, 2
    s_cbranch_scc0 L_recurrent_scan__compressed_kv_cla__moe_arch_mod__prompt_kernel_swn_84
    buffer_store_dwordx4 v[164:167], v59, s[12:15], s48 offen sc1
    s_branch L_recurrent_scan__compressed_kv_cla__moe_arch_mod__prompt_kernel_swend_81
L_recurrent_scan__compressed_kv_cla__moe_arch_mod__prompt_kernel_swn_84:
    s_cmp_eq_u32 s36, 3
    s_cbranch_scc0 L_recurrent_scan__compressed_kv_cla__moe_arch_mod__prompt_kernel_swn_85
    buffer_store_dwordx4 v[180:183], v59, s[12:15], s49 offen sc1
    s_branch L_recurrent_scan__compressed_kv_cla__moe_arch_mod__prompt_kernel_swend_81
L_recurrent_scan__compressed_kv_cla__moe_arch_mod__prompt_kernel_swn_85:
    s_cmp_eq_u32 s36, 4
    s_cbranch_scc0 L_recurrent_scan__compressed_kv_cla__moe_arch_mod__prompt_kernel_swn_86
    buffer_store_dwordx4 v[136:139], v60, s[12:15], s46 offen sc1
    s_branch L_recurrent_scan__compressed_kv_cla__moe_arch_mod__prompt_kernel_swend_81
L_recurrent_scan__compressed_kv_cla__moe_arch_mod__prompt_kernel_swn_86:
    buffer_store_dwordx4 v[168:171], v60, s[12:15], s48 offen sc1
L_recurrent_scan__compressed_kv_cla__moe_arch_mod__prompt_kernel_swend_81:
    s_branch L_recurrent_scan__compressed_kv_cla__moe_arch_mod__prompt_kernel_back_88
L_recurrent_scan__compressed_kv_cla__moe_arch_mod__prompt_kernel_rare_91:
    s_add_u32 s36, s35, s52
    s_cmp_eq_u32 s36, 4
    s_cbranch_scc0 L_recurrent_scan__compressed_kv_cla__moe_arch_mod__prompt_kernel_swn_90
    buffer_store_dwordx4 v[140:143], v61, s[12:15], s46 offen sc1
    s_branch L_recurrent_scan__compressed_kv_cla__moe_arch_mod__prompt_kernel_swend_89
L_recurrent_scan__compressed_kv_cla__moe_arch_mod__prompt_kernel_swn_90:
    buffer_store_dwordx4 v[172:175], v61, s[12:15], s48 offen sc1
L_recurrent_scan__compressed_kv_cla__moe_arch_mod__prompt_kernel_swend_89:
    s_branch L_recurrent_scan__compressed_kv_cla__moe_arch_mod__prompt_kernel_back_92
L_recurrent_scan__compressed_kv_cla__moe_arch_mod__prompt_kernel_rare_99:
    s_add_u32 s36, s35, s52
    s_cmp_eq_u32 s36, 0
    s_cbranch_scc0 L_recurrent_scan__compressed_kv_cla__moe_arch_mod__prompt_kernel_swn_94
    buffer_store_dwordx4 v[136:139], v60, s[12:15], s46 offen sc1
    s_branch L_recurrent_scan__compressed_kv_cla__moe_arch_mod__prompt_kernel_swend_93
L_recurrent_scan__compressed_kv_cla__moe_arch_mod__prompt_kernel_swn_94:
    s_cmp_eq_u32 s36, 1
    s_cbranch_scc0 L_recurrent_scan__compressed_kv_cla__moe_arch_mod__prompt_kernel_swn_95
    buffer_store_dwordx4 v[152:155], v60, s[12:15], s47 offen sc1
    s_branch L_recurrent_scan__compressed_kv_cla__moe_arch_mod__prompt_kernel_swend_93
L_recurrent_scan__compressed_kv_cla__moe_arch_mod__prompt_kernel_swn_95:
    s_cmp_eq_u32 s36, 2
    s_cbranch_scc0 L_recurrent_scan__compressed_kv_cla__moe_arch_mod__prompt_kernel_swn_96
    buffer_store_dwordx4 v[168:171], v60, s[12:15], s48 offen sc1
    s_branch L_recurrent_scan__compressed_kv_cla__moe_arch_mod__prompt_kernel_swend_93
L_recurrent_scan__compressed_kv_cla__moe_arch_mod__prompt_kernel_swn_96:
    s_cmp_eq_u32 s36, 3
    s_cbranch_scc0 L_recurrent_scan__compressed_kv_cla__moe_arch_mod__prompt_kernel_swn_97
    buffer_store_dwordx4 v[184:187], v60, s[12:15], s49 offen sc1
    s_branch L_recurrent_scan__compressed_kv_cla__moe_arch_mod__prompt_kernel_swend_93
L_recurrent_scan__compressed_kv_cla__moe_arch_mod__prompt_kernel_swn_97:
    s_cmp_eq_u32 s36, 4
    s_cbranch_scc0 L_recurrent_scan__compressed_kv_cla__moe_arch_mod__prompt_kernel_swn_98
    buffer_store_dwordx4 v[144:147], v58, s[12:15], s47 offen sc1
    s_branch L_recurrent_scan__compressed_kv_cla__moe_arch_mod__prompt_kernel_swend_93
L_recurrent_scan__compressed_kv_cla__moe_arch_mod__prompt_kernel_swn_98:
    buffer_store_dwordx4 v[176:179], v58, s[12:15], s49 offen sc1
L_recurrent_scan__compressed_kv_cla__moe_arch_mod__prompt_kernel_swend_93:
    s_branch L_recurrent_scan__compressed_kv_cla__moe_arch_mod__prompt_kernel_back_100
L_recurrent_scan__compressed_kv_cla__moe_arch_mod__prompt_kernel_rare_103:
    s_add_u32 s36, s35, s52
    s_cmp_eq_u32 s36, 4
    s_cbranch_scc0 L_recurrent_scan__compressed_kv_cla__moe_arch_mod__prompt_kernel_swn_102
    buffer_store_dwordx4 v[148:151], v59, s[12:15], s47 offen sc1
    s_branch L_recurrent_scan__compressed_kv_cla__moe_arch_mod__prompt_kernel_swend_101
L_recurrent_scan__compressed_kv_cla__moe_arch_mod__prompt_kernel_swn_102:
    buffer_store_dwordx4 v[180:183], v59, s[12:15], s49 offen sc1
L_recurrent_scan__compressed_kv_cla__moe_arch_mod__prompt_kernel_swend_101:
    s_branch L_recurrent_scan__compressed_kv_cla__moe_arch_mod__prompt_kernel_back_104
L_recurrent_scan__compressed_kv_cla__moe_arch_mod__prompt_kernel_rare_111:
    s_add_u32 s36, s35, s52
    s_cmp_eq_u32 s36, 0
    s_cbranch_scc0 L_recurrent_scan__compressed_kv_cla__moe_arch_mod__prompt_kernel_swn_106
    buffer_store_dwordx4 v[140:143], v61, s[12:15], s46 offen sc1
    s_branch L_recurrent_scan__compressed_kv_cla__moe_arch_mod__prompt_kernel_swend_105
L_recurrent_scan__compressed_kv_cla__moe_arch_mod__prompt_kernel_swn_106:
    s_cmp_eq_u32 s36, 1
    s_cbranch_scc0 L_recurrent_scan__compressed_kv_cla__moe_arch_mod__prompt_kernel_swn_107
    buffer_store_dwordx4 v[156:159], v61, s[12:15], s47 offen sc1
    s_branch L_recurrent_scan__compressed_kv_cla__moe_arch_mod__prompt_kernel_swend_105
L_recurrent_scan__compressed_kv_cla__moe_arch_mod__prompt_kernel_swn_107:
    s_cmp_eq_u32 s36, 2
    s_cbranch_scc0 L_recurrent_scan__compressed_kv_cla__moe_arch_mod__prompt_kernel_swn_108
    buffer_store_dwordx4 v[172:175], v61, s[12:15], s48 offen sc1
    s_branch L_recurrent_scan__compressed_kv_cla__moe_arch_mod__prompt_kernel_swend_105
L_recurrent_scan__compressed_kv_cla__moe_arch_mod__prompt_kernel_swn_108:
    s_cmp_eq_u32 s36, 3
    s_cbranch_scc0 L_recurrent_scan__compressed_kv_cla__moe_arch_mod__prompt_kernel_swn_109
    buffer_store_dwordx4 v[188:191], v61, s[12:15], s49 offen sc1
    s_branch L_recurrent_scan__compressed_kv_cla__moe_arch_mod__prompt_kernel_swend_105
L_recurrent_scan__compressed_kv_cla__moe_arch_mod__prompt_kernel_swn_109:
    s_cmp_eq_u32 s36, 4
    s_cbranch_scc0 L_recurrent_scan__compressed_kv_cla__moe_arch_mod__prompt_kernel_swn_110
    buffer_store_dwordx4 v[152:155], v60, s[12:15], s47 offen sc1
    s_branch L_recurrent_scan__compressed_kv_cla__moe_arch_mod__prompt_kernel_swend_105
L_recurrent_scan__compressed_kv_cla__moe_arch_mod__prompt_kernel_swn_110:
    buffer_store_dwordx4 v[184:187], v60, s[12:15], s49 offen sc1
L_recurrent_scan__compressed_kv_cla__moe_arch_mod__prompt_kernel_swend_105:
    s_branch L_recurrent_scan__compressed_kv_cla__moe_arch_mod__prompt_kernel_back_112
L_recurrent_scan__compressed_kv_cla__moe_arch_mod__prompt_kernel_rare_115:
    s_add_u32 s36, s35, s52
    s_cmp_eq_u32 s36, 4
    s_cbranch_scc0 L_recurrent_scan__compressed_kv_cla__moe_arch_mod__prompt_kernel_swn_114
    buffer_store_dwordx4 v[156:159], v61, s[12:15], s47 offen sc1
    s_branch L_recurrent_scan__compressed_kv_cla__moe_arch_mod__prompt_kernel_swend_113
L_recurrent_scan__compressed_kv_cla__moe_arch_mod__prompt_kernel_swn_114:
    buffer_store_dwordx4 v[188:191], v61, s[12:15], s49 offen sc1
L_recurrent_scan__compressed_kv_cla__moe_arch_mod__prompt_kernel_swend_113:
    s_branch L_recurrent_scan__compressed_kv_cla__moe_arch_mod__prompt_kernel_back_116
L_recurrent_scan__compressed_kv_cla__moe_arch_mod__prompt_kernel_rare_117:
    v_mov_b32 v20, 4048155338
    v_subrev_u32 v21, s50, v18
    v_cmp_gt_i32 s[20:21], 0, v21
    v_cmp_gt_i32 s[22:23], 1, v21
    v_cmp_gt_i32 s[62:63], 2, v21
    v_cmp_gt_i32 vcc, 3, v21
    v_cndmask_b32 v96, v96, v20, s[20:21]
    v_cndmask_b32 v97, v97, v20, s[22:23]
    v_cndmask_b32 v98, v98, v20, s[62:63]
    v_cndmask_b32 v99, v99, v20, vcc
    v_cmp_gt_i32 s[20:21], 16, v21
    v_cmp_gt_i32 s[22:23], 17, v21
    v_cmp_gt_i32 s[62:63], 18, v21
    v_cmp_gt_i32 vcc, 19, v21
    v_cndmask_b32 v100, v100, v20, s[20:21]
    v_cndmask_b32 v101, v101, v20, s[22:23]
    v_cndmask_b32 v102, v102, v20, s[62:63]
    v_cndmask_b32 v103, v103, v20, vcc
    v_cmp_gt_i32 s[20:21], -16, v21
    v_cmp_gt_i32 s[22:23], -15, v21
    v_cmp_gt_i32 s[62:63], -14, v21
    v_cmp_gt_i32 vcc, -13, v21
    v_cndmask_b32 v104, v104, v20, s[20:21]
    v_cndmask_b32 v105, v105, v20, s[22:23]
    v_cndmask_b32 v106, v106, v20, s[62:63]
    v_cndmask_b32 v107, v107, v20, vcc
    v_cmp_gt_i32 s[20:21], 0, v21
    v_cmp_gt_i32 s[22:23], 1, v21
    v_cmp_gt_i32 s[62:63], 2, v21
    v_cmp_gt_i32 vcc, 3, v21
    v_cndmask_b32 v108, v108, v20, s[20:21]
    v_cndmask_b32 v109, v109, v20, s[22:23]
    v_cndmask_b32 v110, v110, v20, s[62:63]
    v_cndmask_b32 v111, v111, v20, vcc
    s_branch L_recurrent_scan__compressed_kv_cla__moe_arch_mod__prompt_kernel_back_118
L_recurrent_scan__compressed_kv_cla__moe_arch_mod__prompt_kernel_rare_119:
    s_lshl_b32 s36, s29, 7
    v_mov_b32 v13, s36
    global_load_dword v14, v13, s[90:91] sc1
    s_branch L_recurrent_scan__compressed_kv_cla__moe_arch_mod__prompt_kernel_back_120
L_recurrent_scan__compressed_kv_cla__moe_arch_mod__prompt_kernel_rare_121:
    v_mov_b32 v20, 4048155338
    v_subrev_u32 v21, s49, v18
    v_cmp_gt_i32 s[20:21], 0, v21
    v_cmp_gt_i32 s[22:23], 1, v21
    v_cmp_gt_i32 s[62:63], 2, v21
    v_cmp_gt_i32 vcc, 3, v21
    v_cndmask_b32 v112, v112, v20, s[20:21]
    v_cndmask_b32 v113, v113, v20, s[22:23]
    v_cndmask_b32 v114, v114, v20, s[62:63]
    v_cndmask_b32 v115, v115, v20, vcc
    v_cmp_gt_i32 s[20:21], 16, v21
    v_cmp_gt_i32 s[22:23], 17, v21
    v_cmp_gt_i32 s[62:63], 18, v21
    v_cmp_gt_i32 vcc, 19, v21
    v_cndmask_b32 v116, v116, v20, s[20:21]
    v_cndmask_b32 v117, v117, v20, s[22:23]
    v_cndmask_b32 v118, v118, v20, s[62:63]
    v_cndmask_b32 v119, v119, v20, vcc
    v_cmp_gt_i32 s[20:21], -16, v21
    v_cmp_gt_i32 s[22:23], -15, v21
    v_cmp_gt_i32 s[62:63], -14, v21
    v_cmp_gt_i32 vcc, -13, v21
    v_cndmask_b32 v120, v120, v20, s[20:21]
    v_cndmask_b32 v121, v121, v20, s[22:23]
    v_cndmask_b32 v122, v122, v20, s[62:63]
    v_cndmask_b32 v123, v123, v20, vcc
    v_cmp_gt_i32 s[20:21], 0, v21
    v_cmp_gt_i32 s[22:23], 1, v21
    v_cmp_gt_i32 s[62:63], 2, v21
    v_cmp_gt_i32 vcc, 3, v21
    v_cndmask_b32 v124, v124, v20, s[20:21]
    v_cndmask_b32 v125, v125, v20, s[22:23]
    v_cndmask_b32 v126, v126, v20, s[62:63]
    v_cndmask_b32 v127, v127, v20, vcc
    s_branch L_recurrent_scan__compressed_kv_cla__moe_arch_mod__prompt_kernel_back_122
L_recurrent_scan__compressed_kv_cla__moe_arch_mod__prompt_kernel_rare_123:
    v_mov_b32 v20, 4048155338
    v_subrev_u32 v21, s50, v18
    v_cmp_gt_i32 s[20:21], 0, v21
    v_cmp_gt_i32 s[22:23], 1, v21
    v_cmp_gt_i32 s[62:63], 2, v21
    v_cmp_gt_i32 vcc, 3, v21
    v_cndmask_b32 v96, v96, v20, s[20:21]
    v_cndmask_b32 v97, v97, v20, s[22:23]
    v_cndmask_b32 v98, v98, v20, s[62:63]
    v_cndmask_b32 v99, v99, v20, vcc
    v_cmp_gt_i32 s[20:21], 16, v21
    v_cmp_gt_i32 s[22:23], 17, v21
    v_cmp_gt_i32 s[62:63], 18, v21
    v_cmp_gt_i32 vcc, 19, v21
    v_cndmask_b32 v100, v100, v20, s[20:21]
    v_cndmask_b32 v101, v101, v20, s[22:23]
    v_cndmask_b32 v102, v102, v20, s[62:63]
    v_cndmask_b32 v103, v103, v20, vcc
    v_cmp_gt_i32 s[20:21], -16, v21
    v_cmp_gt_i32 s[22:23], -15, v21
    v_cmp_gt_i32 s[62:63], -14, v21
    v_cmp_gt_i32 vcc, -13, v21
    v_cndmask_b32 v104, v104, v20, s[20:21]
    v_cndmask_b32 v105, v105, v20, s[22:23]
    v_cndmask_b32 v106, v106, v20, s[62:63]
    v_cndmask_b32 v107, v107, v20, vcc
    v_cmp_gt_i32 s[20:21], 0, v21
    v_cmp_gt_i32 s[22:23], 1, v21
    v_cmp_gt_i32 s[62:63], 2, v21
    v_cmp_gt_i32 vcc, 3, v21
    v_cndmask_b32 v108, v108, v20, s[20:21]
    v_cndmask_b32 v109, v109, v20, s[22:23]
    v_cndmask_b32 v110, v110, v20, s[62:63]
    v_cndmask_b32 v111, v111, v20, vcc
    s_branch L_recurrent_scan__compressed_kv_cla__moe_arch_mod__prompt_kernel_back_124
L_recurrent_scan__compressed_kv_cla__moe_arch_mod__prompt_kernel_rare_133:
    s_mov_b32 s61, 0x40000
L_recurrent_scan__compressed_kv_cla__moe_arch_mod__prompt_kernel_spin_131:
    s_sub_u32 s61, s61, 1
    s_cbranch_scc1 L_recurrent_scan__compressed_kv_cla__moe_arch_mod__prompt_kernel_spinx_132
    s_sleep 8
    global_load_dword v14, v13, s[90:91] sc1
    s_waitcnt vmcnt(0)
    v_readfirstlane_b32 s36, v14
    s_nop 0
    s_cmp_lt_u32 s36, 8
    s_cbranch_scc1 L_recurrent_scan__compressed_kv_cla__moe_arch_mod__prompt_kernel_spin_131
L_recurrent_scan__compressed_kv_cla__moe_arch_mod__prompt_kernel_spinx_132:
    s_branch L_recurrent_scan__compressed_kv_cla__moe_arch_mod__prompt_kernel_back_134
L_recurrent_scan__compressed_kv_cla__moe_arch_mod__prompt_kernel_rare_139:
    s_cmp_eq_u32 s40, 1
    s_cbranch_scc0 L_recurrent_scan__compressed_kv_cla__moe_arch_mod__prompt_kernel_swn_136
    v_readfirstlane_b32 s36, v14
    s_nop 0
    s_cmp_lt_u32 s36, 8
    s_cbranch_scc1 L_recurrent_scan__compressed_kv_cla__moe_arch_mod__prompt_kernel_rare_133
L_recurrent_scan__compressed_kv_cla__moe_arch_mod__prompt_kernel_back_134:
    s_branch L_recurrent_scan__compressed_kv_cla__moe_arch_mod__prompt_kernel_swend_135
L_recurrent_scan__compressed_kv_cla__moe_arch_mod__prompt_kernel_swn_136:
    s_cmp_eq_u32 s40, 2
    s_cbranch_scc0 L_recurrent_scan__compressed_kv_cla__moe_arch_mod__prompt_kernel_swn_137
    s_mov_b32 s36, 4276224
    buffer_load_dwordx4 v[160:163], v7, s[24:27], s36 offen offset:0 sc1
    buffer_load_dwordx4 v[164:167], v7, s[24:27], s36 offen offset:1024 sc1
    s_branch L_recurrent_scan__compressed_kv_cla__moe_arch_mod__prompt_kernel_swend_135
L_recurrent_scan__compressed_kv_cla__moe_arch_mod__prompt_kernel_swn_137:
    s_cmp_eq_u32 s40, 3
    s_cbranch_scc0 L_recurrent_scan__compressed_kv_cla__moe_arch_mod__prompt_kernel_swn_138
    v_max_u32 v26, v160, v161
    v_min_u32 v27, v160, v161
    v_med3_u32 v27, v26, v27, v162
    v_max_u32 v26, v26, v162
    v_med3_u32 v27, v26, v27, v163
    v_max_u32 v26, v26, v163
    v_med3_u32 v27, v26, v27, v164
    v_max_u32 v26, v26, v164
    v_med3_u32 v27, v26, v27, v165
    v_max_u32 v26, v26, v165
    v_med3_u32 v27, v26, v27, v166
    v_max_u32 v26, v26, v166
    v_med3_u32 v27, v26, v27, v167
    v_max_u32 v26, v26, v167
    v_mov_b32 v28, v26
    s_nop 1
    v_max_u32_dpp v28, v28, v28 quad_perm:[1,0,3,2] row_mask:0xf bank_mask:0xf
    s_nop 1
    v_max_u32_dpp v28, v28, v28 quad_perm:[2,3,0,1] row_mask:0xf bank_mask:0xf
    s_nop 1
    v_max_u32_dpp v28, v28, v28 row_half_mirror row_mask:0xf bank_mask:0xf
    s_nop 1
    v_max_u32_dpp v28, v28, v28 row_mirror row_mask:0xf bank_mask:0xf
    s_nop 0
    v_readlane_b32 s20, v28, 0
    v_readlane_b32 s21, v28, 16
    v_readlane_b32 s22, v28, 32
    v_readlane_b32 s23, v28, 48
    s_max_u32 s20, s20, s21
    s_max_u32 s22, s22, s23
    s_max_u32 s20, s20, s22
    s_mov_b32 s58, s20
    v_cmp_eq_u32 vcc, s58, v26
    s_nop 1
    v_cndmask_b32 v28, v26, v27, vcc
    s_nop 1
    v_max_u32_dpp v28, v28, v28 quad_perm:[1,0,3,2] row_mask:0xf bank_mask:0xf
    s_nop 1
    v_max_u32_dpp v28, v28, v28 quad_perm:[2,3,0,1] row_mask:0xf bank_mask:0xf
    s_nop 1
    v_max_u32_dpp v28, v28, v28 row_half_mirror row_mask:0xf bank_mask:0xf
    s_nop 1
    v_max_u32_dpp v28, v28, v28 row_mirror row_mask:0xf bank_mask:0xf
    s_nop 0
    v_readlane_b32 s20, v28, 0
    v_readlane_b32 s21, v28, 16
    v_readlane_b32 s22, v28, 32
    v_readlane_b32 s23, v28, 48
    s_max_u32 s20, s20, s21
    s_max_u32 s22, s22, s23
    s_max_u32 s20, s20, s22
    s_mov_b32 s59, s20
    s_and_b32 s36, s58, 0xffff
    s_sub_u32 s56, 0xffff, s36
    s_and_b32 s36, s59, 0xffff
    s_sub_u32 s57, 0xffff, s36
    v_and_b32 v26, 1, v1
    v_mov_b32 v27, s56
    v_mov_b32 v28, s57
    v_cmp_eq_u32 vcc, 1, v26
    s_nop 1
    v_cndmask_b32 v27, v27, v28, vcc
    v_lshrrev_b32 v28, 4, v27
    v_lshlrev_b32 v28, 15, v28
    v_and_b32 v27, 15, v27
    v_lshl_add_u32 v28, v27, 4, v28
    v_lshrrev_b32 v29, 4, v1
    v_lshl_add_u32 v28, v29, 8, v28
    s_and_b32 s36, s3, 3
    s_lshl_b32 s36, s36, 13
    s_add_u32 s37, s36, 4096
    s_mov_b32 exec_lo, 0x00030003
    s_mov_b32 exec_hi, 0x00030003
    buffer_load_dwordx4 v[160:163], v28, s[24:27], s36 offen offset:0 sc1
    buffer_load_dwordx4 v[164:167], v28, s[24:27], s36 offen offset:1024 sc1
    buffer_load_dwordx4 v[168:171], v28, s[24:27], s36 offen offset:2048 sc1
    buffer_load_dwordx4 v[172:175], v28, s[24:27], s36 offen offset:3072 sc1
    buffer_load_dwordx4 v[176:179], v28, s[24:27], s37 offen offset:0 sc1
    buffer_load_dwordx4 v[180:183], v28, s[24:27], s37 offen offset:1024 sc1
    buffer_load_dwordx4 v[184:187], v28, s[24:27], s37 offen offset:2048 sc1
    buffer_load_dwordx4 v[188:191], v28, s[24:27], s37 offen offset:3072 sc1
    s_mov_b64 exec, -1
    s_branch L_recurrent_scan__compressed_kv_cla__moe_arch_mod__prompt_kernel_swend_135
L_recurrent_scan__compressed_kv_cla__moe_arch_mod__prompt_kernel_swn_138:
    s_sub_u32 s38, s40, s60
    s_cmp_eq_u32 s38, 0
    s_cbranch_scc0 L_recurrent_scan__compressed_kv_cla__moe_arch_mod__prompt_kernel_swn_127
    s_and_b32 s20, s3, 3
    s_lshl_b32 s20, s20, 8
    s_lshl_b32 s21, s28, 5
    s_add_u32 s20, s20, s21
    s_lshr_b32 s21, s3, 2
    s_lshl_b32 s21, s21, 7
    v_lshrrev_b32 v27, 3, v1
    s_lshl_b32 s36, s28, 5
    s_add_u32 s36, s36, s20
    v_add_u32 v27, s36, v27
    v_mul_u32_u24 v27, 7168, v27
    v_add_u32 v27, s21, v27
    v_bfe_u32 v28, v1, 4, 1
    v_lshlrev_b32 v28, 1, v28
    v_and_b32 v29, 7, v1
    v_xor_b32 v28, v28, v29
    v_lshl_add_u32 v26, v28, 4, v27
    v_xor_b32 v28, 4, v28
    v_lshl_add_u32 v27, v28, 4, v27
    v_add_u32 v27, 56320, v27
    v_add_u32 v28, 112640, v26
    v_add_u32 v29, 112640, v27
    s_lshl_b32 s36, s28, 13
    s_add_u32 m0, s36, 131072
    s_mov_b32 s37, 229376
    buffer_load_dwordx4 v26, s[4:7], 0 offen offset:0 nt lds
    buffer_load_dwordx4 v27, s[4:7], 0 offen offset:1024 nt lds
    buffer_load_dwordx4 v28, s[4:7], 0 offen offset:2048 nt lds
    buffer_load_dwordx4 v29, s[4:7], 0 offen offset:3072 nt lds
    s_add_u32 m0, s36, 135168
    s_nop 0
    buffer_load_dwordx4 v26, s[4:7], s37 offen offset:0 nt lds
    buffer_load_dwordx4 v27, s[4:7], s37 offen offset:1024 nt lds
    buffer_load_dwordx4 v28, s[4:7], s37 offen offset:2048 nt lds
    buffer_load_dwordx4 v29, s[4:7], s37 offen offset:3072 nt lds
    s_branch L_recurrent_scan__compressed_kv_cla__moe_arch_mod__prompt_kernel_swend_126
L_recurrent_scan__compressed_kv_cla__moe_arch_mod__prompt_kernel_swn_127:
    s_cmp_eq_u32 s38, 2
    s_cbranch_scc0 L_recurrent_scan__compressed_kv_cla__moe_arch_mod__prompt_kernel_swn_128
    v_lshrrev_b32 v8, 4, v1
    v_bfe_u32 v20, v1, 2, 2
    v_lshl_add_u32 v20, v8, 3, v20
    v_lshlrev_b32 v20, 7, v20
    v_and_b32 v21, 3, v1
    v_lshl_add_u32 v20, v21, 3, v20
    v_bfe_u32 v21, v1, 3, 2
    v_xor_b32 v21, s28, v21
    v_lshl_add_u32 v20, v21, 5, v20
    v_add_u32 v20, 131072, v20
    ds_read_b64_tr_b16 v[22:23], v20 offset:0
    ds_read_b64_tr_b16 v[24:25], v20 offset:512
    ds_read_b64_tr_b16 v[26:27], v20 offset:4096
    ds_read_b64_tr_b16 v[28:29], v20 offset:4608
    ds_read_b64_tr_b16 v[30:31], v20 offset:8192
    ds_read_b64_tr_b16 v[32:33], v20 offset:8704
    ds_read_b64_tr_b16 v[34:35], v20 offset:12288
    ds_read_b64_tr_b16 v[36:37], v20 offset:12800
    s_and_b32 s36, s3, 3
    s_lshl_b32 s36, s36, 1
    s_add_u32 s36, s36, 0
    s_mul_i32 s36, s36, 28672
    s_lshr_b32 s37, s3, 2
    s_lshl_b32 s37, s37, 8
    s_add_u32 s36, s36, s37
    s_lshl_b32 s37, s28, 6
    s_add_u32 s36, s36, s37
    s_add_u32 s36, s36, 58720256
    v_and_b32 v9, 1, v1
    v_mul_u32_u24 v9, 14336, v9
    v_lshl_add_u32 v9, v8, 4, v9
    s_waitcnt lgkmcnt(0)
    v_mfma_f32_16x16x32_bf16 v[10:13], v[22:25], v[160:163], 0
    v_mfma_f32_16x16x32_bf16 v[10:13], v[26:29], v[164:167], v[10:13]
    v_mfma_f32_16x16x32_bf16 v[10:13], v[30:33], v[168:171], v[10:13]
    v_mfma_f32_16x16x32_bf16 v[10:13], v[34:37], v[172:175], v[10:13]
    ds_read_b64_tr_b16 v[22:23], v20 offset:16384
    ds_read_b64_tr_b16 v[24:25], v20 offset:16896
    ds_read_b64_tr_b16 v[26:27], v20 offset:20480
    ds_read_b64_tr_b16 v[28:29], v20 offset:20992
    ds_read_b64_tr_b16 v[30:31], v20 offset:24576
    ds_read_b64_tr_b16 v[32:33], v20 offset:25088
    ds_read_b64_tr_b16 v[34:35], v20 offset:28672
    ds_read_b64_tr_b16 v[36:37], v20 offset:29184
    s_waitcnt lgkmcnt(0)
    v_mfma_f32_16x16x32_bf16 v[10:13], v[22:25], v[176:179], v[10:13]
    v_mfma_f32_16x16x32_bf16 v[10:13], v[26:29], v[180:183], v[10:13]
    v_mfma_f32_16x16x32_bf16 v[10:13], v[30:33], v[184:187], v[10:13]
    v_mfma_f32_16x16x32_bf16 v[10:13], v[34:37], v[188:191], v[10:13]
    s_nop 5
    s_mov_b32 exec_lo, 0x00030003
    s_mov_b32 exec_hi, 0x00030003
    buffer_store_dwordx4 v[10:13], v9, s[24:27], s36 offen sc1
    s_mov_b64 exec, -1
    s_nop 1
    s_branch L_recurrent_scan__compressed_kv_cla__moe_arch_mod__prompt_kernel_swend_126
L_recurrent_scan__compressed_kv_cla__moe_arch_mod__prompt_kernel_swn_128:
    s_cmp_eq_u32 s38, 3
    s_cbranch_scc0 L_recurrent_scan__compressed_kv_cla__moe_arch_mod__prompt_kernel_swn_129
    s_and_b32 s20, s3, 3
    s_lshl_b32 s20, s20, 8
    s_lshl_b32 s21, s28, 5
    s_add_u32 s20, s20, s21
    s_lshr_b32 s21, s3, 2
    s_lshl_b32 s21, s21, 7
    v_lshrrev_b32 v27, 3, v1
    s_lshl_b32 s36, s28, 5
    s_add_u32 s36, s36, s20
    v_add_u32 v27, s36, v27
    v_mul_u32_u24 v27, 7168, v27
    v_add_u32 v27, s21, v27
    v_bfe_u32 v28, v1, 4, 1
    v_lshlrev_b32 v28, 1, v28
    v_and_b32 v29, 7, v1
    v_xor_b32 v28, v28, v29
    v_lshl_add_u32 v26, v28, 4, v27
    v_xor_b32 v28, 4, v28
    v_lshl_add_u32 v27, v28, 4, v27
    v_add_u32 v27, 56320, v27
    v_add_u32 v28, 112640, v26
    v_add_u32 v29, 112640, v27
    s_lshl_b32 s36, s28, 13
    s_add_u32 m0, s36, 131072
    s_mov_b32 s37, 229376
    buffer_load_dwordx4 v26, s[8:11], 0 offen offset:0 nt lds
    buffer_load_dwordx4 v27, s[8:11], 0 offen offset:1024 nt lds
    buffer_load_dwordx4 v28, s[8:11], 0 offen offset:2048 nt lds
    buffer_load_dwordx4 v29, s[8:11], 0 offen offset:3072 nt lds
    s_add_u32 m0, s36, 135168
    s_nop 0
    buffer_load_dwordx4 v26, s[8:11], s37 offen offset:0 nt lds
    buffer_load_dwordx4 v27, s[8:11], s37 offen offset:1024 nt lds
    buffer_load_dwordx4 v28, s[8:11], s37 offen offset:2048 nt lds
    buffer_load_dwordx4 v29, s[8:11], s37 offen offset:3072 nt lds
    s_branch L_recurrent_scan__compressed_kv_cla__moe_arch_mod__prompt_kernel_swend_126
L_recurrent_scan__compressed_kv_cla__moe_arch_mod__prompt_kernel_swn_129:
    s_cmp_eq_u32 s38, 5
    s_cbranch_scc0 L_recurrent_scan__compressed_kv_cla__moe_arch_mod__prompt_kernel_swn_130
    v_lshrrev_b32 v8, 4, v1
    v_bfe_u32 v20, v1, 2, 2
    v_lshl_add_u32 v20, v8, 3, v20
    v_lshlrev_b32 v20, 7, v20
    v_and_b32 v21, 3, v1
    v_lshl_add_u32 v20, v21, 3, v20
    v_bfe_u32 v21, v1, 3, 2
    v_xor_b32 v21, s28, v21
    v_lshl_add_u32 v20, v21, 5, v20
    v_add_u32 v20, 131072, v20
    ds_read_b64_tr_b16 v[22:23], v20 offset:0
    ds_read_b64_tr_b16 v[24:25], v20 offset:512
    ds_read_b64_tr_b16 v[26:27], v20 offset:4096
    ds_read_b64_tr_b16 v[28:29], v20 offset:4608
    ds_read_b64_tr_b16 v[30:31], v20 offset:8192
    ds_read_b64_tr_b16 v[32:33], v20 offset:8704
    ds_read_b64_tr_b16 v[34:35], v20 offset:12288
    ds_read_b64_tr_b16 v[36:37], v20 offset:12800
    s_and_b32 s36, s3, 3
    s_lshl_b32 s36, s36, 1
    s_add_u32 s36, s36, 1
    s_mul_i32 s36, s36, 28672
    s_lshr_b32 s37, s3, 2
    s_lshl_b32 s37, s37, 8
    s_add_u32 s36, s36, s37
    s_lshl_b32 s37, s28, 6
    s_add_u32 s36, s36, s37
    s_add_u32 s36, s36, 58720256
    v_and_b32 v9, 1, v1
    v_mul_u32_u24 v9, 14336, v9
    v_lshl_add_u32 v9, v8, 4, v9
    s_waitcnt lgkmcnt(0)
    v_mfma_f32_16x16x32_bf16 v[10:13], v[22:25], v[160:163], 0
    v_mfma_f32_16x16x32_bf16 v[10:13], v[26:29], v[164:167], v[10:13]
    v_mfma_f32_16x16x32_bf16 v[10:13], v[30:33], v[168:171], v[10:13]
    v_mfma_f32_16x16x32_bf16 v[10:13], v[34:37], v[172:175], v[10:13]
    ds_read_b64_tr_b16 v[22:23], v20 offset:16384
    ds_read_b64_tr_b16 v[24:25], v20 offset:16896
    ds_read_b64_tr_b16 v[26:27], v20 offset:20480
    ds_read_b64_tr_b16 v[28:29], v20 offset:20992
    ds_read_b64_tr_b16 v[30:31], v20 offset:24576
    ds_read_b64_tr_b16 v[32:33], v20 offset:25088
    ds_read_b64_tr_b16 v[34:35], v20 offset:28672
    ds_read_b64_tr_b16 v[36:37], v20 offset:29184
    s_waitcnt lgkmcnt(0)
    v_mfma_f32_16x16x32_bf16 v[10:13], v[22:25], v[176:179], v[10:13]
    v_mfma_f32_16x16x32_bf16 v[10:13], v[26:29], v[180:183], v[10:13]
    v_mfma_f32_16x16x32_bf16 v[10:13], v[30:33], v[184:187], v[10:13]
    v_mfma_f32_16x16x32_bf16 v[10:13], v[34:37], v[188:191], v[10:13]
    s_nop 5
    s_mov_b32 exec_lo, 0x00030003
    s_mov_b32 exec_hi, 0x00030003
    buffer_store_dwordx4 v[10:13], v9, s[24:27], s36 offen sc1
    s_mov_b64 exec, -1
    s_nop 1
    s_branch L_recurrent_scan__compressed_kv_cla__moe_arch_mod__prompt_kernel_swend_126
L_recurrent_scan__compressed_kv_cla__moe_arch_mod__prompt_kernel_swn_130:
    s_mul_i32 s36, s3, 2341
    s_lshr_b32 s36, s36, 16
    s_add_u32 s36, s36, 48
    s_lshl_b32 s36, s36, 7
    v_mov_b32 v20, s36
    v_mov_b32 v21, 1
    s_mov_b64 exec, 1
    global_atomic_add v20, v21, s[90:91]
    s_mov_b64 exec, -1
    s_nop 3
L_recurrent_scan__compressed_kv_cla__moe_arch_mod__prompt_kernel_swend_126:
L_recurrent_scan__compressed_kv_cla__moe_arch_mod__prompt_kernel_swend_135:
    s_branch L_recurrent_scan__compressed_kv_cla__moe_arch_mod__prompt_kernel_back_140
L_recurrent_scan__compressed_kv_cla__moe_arch_mod__prompt_kernel_rare_149:
    v_mov_b32 v20, 4048155338
    v_subrev_u32 v21, s49, v18
    v_cmp_gt_i32 s[20:21], 0, v21
    v_cmp_gt_i32 s[22:23], 1, v21
    v_cmp_gt_i32 s[62:63], 2, v21
    v_cmp_gt_i32 vcc, 3, v21
    v_cndmask_b32 v112, v112, v20, s[20:21]
    v_cndmask_b32 v113, v113, v20, s[22:23]
    v_cndmask_b32 v114, v114, v20, s[62:63]
    v_cndmask_b32 v115, v115, v20, vcc
    v_cmp_gt_i32 s[20:21], 16, v21
    v_cmp_gt_i32 s[22:23], 17, v21
    v_cmp_gt_i32 s[62:63], 18, v21
    v_cmp_gt_i32 vcc, 19, v21
    v_cndmask_b32 v116, v116, v20, s[20:21]
    v_cndmask_b32 v117, v117, v20, s[22:23]
    v_cndmask_b32 v118, v118, v20, s[62:63]
    v_cndmask_b32 v119, v119, v20, vcc
    v_cmp_gt_i32 s[20:21], -16, v21
    v_cmp_gt_i32 s[22:23], -15, v21
    v_cmp_gt_i32 s[62:63], -14, v21
    v_cmp_gt_i32 vcc, -13, v21
    v_cndmask_b32 v120, v120, v20, s[20:21]
    v_cndmask_b32 v121, v121, v20, s[22:23]
    v_cndmask_b32 v122, v122, v20, s[62:63]
    v_cndmask_b32 v123, v123, v20, vcc
    v_cmp_gt_i32 s[20:21], 0, v21
    v_cmp_gt_i32 s[22:23], 1, v21
    v_cmp_gt_i32 s[62:63], 2, v21
    v_cmp_gt_i32 vcc, 3, v21
    v_cndmask_b32 v124, v124, v20, s[20:21]
    v_cndmask_b32 v125, v125, v20, s[22:23]
    v_cndmask_b32 v126, v126, v20, s[62:63]
    v_cndmask_b32 v127, v127, v20, vcc
    s_branch L_recurrent_scan__compressed_kv_cla__moe_arch_mod__prompt_kernel_back_150
L_recurrent_scan__compressed_kv_cla__moe_arch_mod__prompt_kernel_rare_154:
    v_mov_b32 v20, 4048155338
    v_subrev_u32 v21, s50, v18
    v_cmp_gt_i32 s[20:21], 0, v21
    v_cmp_gt_i32 s[22:23], 1, v21
    v_cmp_gt_i32 s[62:63], 2, v21
    v_cmp_gt_i32 vcc, 3, v21
    v_cndmask_b32 v96, v96, v20, s[20:21]
    v_cndmask_b32 v97, v97, v20, s[22:23]
    v_cndmask_b32 v98, v98, v20, s[62:63]
    v_cndmask_b32 v99, v99, v20, vcc
    v_cmp_gt_i32 s[20:21], 16, v21
    v_cmp_gt_i32 s[22:23], 17, v21
    v_cmp_gt_i32 s[62:63], 18, v21
    v_cmp_gt_i32 vcc, 19, v21
    v_cndmask_b32 v100, v100, v20, s[20:21]
    v_cndmask_b32 v101, v101, v20, s[22:23]
    v_cndmask_b32 v102, v102, v20, s[62:63]
    v_cndmask_b32 v103, v103, v20, vcc
    v_cmp_gt_i32 s[20:21], -16, v21
    v_cmp_gt_i32 s[22:23], -15, v21
    v_cmp_gt_i32 s[62:63], -14, v21
    v_cmp_gt_i32 vcc, -13, v21
    v_cndmask_b32 v104, v104, v20, s[20:21]
    v_cndmask_b32 v105, v105, v20, s[22:23]
    v_cndmask_b32 v106, v106, v20, s[62:63]
    v_cndmask_b32 v107, v107, v20, vcc
    v_cmp_gt_i32 s[20:21], 0, v21
    v_cmp_gt_i32 s[22:23], 1, v21
    v_cmp_gt_i32 s[62:63], 2, v21
    v_cmp_gt_i32 vcc, 3, v21
    v_cndmask_b32 v108, v108, v20, s[20:21]
    v_cndmask_b32 v109, v109, v20, s[22:23]
    v_cndmask_b32 v110, v110, v20, s[62:63]
    v_cndmask_b32 v111, v111, v20, vcc
    s_branch L_recurrent_scan__compressed_kv_cla__moe_arch_mod__prompt_kernel_back_155
L_grp1:
    s_mov_b32 s36, 1040356334
    s_and_b32 s37, s28, 3
    s_lshl_b32 s37, s37, 13
    v_lshlrev_b32 v7, 4, v1
    v_add_u32 v4, s37, v7
    v_add_u32 v6, 4096, v4
    v_add_u32 v19, 131072, v4
    s_mov_b32 s43, s37
    s_add_u32 s44, s37, 98304
    s_waitcnt vmcnt(4) lgkmcnt(0)
    v_mul_f32 v192, s36, v192
    v_mul_f32 v193, s36, v193
    v_mul_f32 v194, s36, v194
    v_mul_f32 v195, s36, v195
    v_mul_f32 v196, s36, v196
    v_mul_f32 v197, s36, v197
    v_mul_f32 v198, s36, v198
    v_mul_f32 v199, s36, v199
    v_cvt_pk_bf16_f32 v128, v192, v193
    v_cvt_pk_bf16_f32 v129, v194, v195
    v_cvt_pk_bf16_f32 v130, v196, v197
    v_cvt_pk_bf16_f32 v131, v198, v199
    v_mul_f32 v200, s36, v200
    v_mul_f32 v201, s36, v201
    v_mul_f32 v202, s36, v202
    v_mul_f32 v203, s36, v203
    v_mul_f32 v204, s36, v204
    v_mul_f32 v205, s36, v205
    v_mul_f32 v206, s36, v206
    v_mul_f32 v207, s36, v207
    v_cvt_pk_bf16_f32 v132, v200, v201
    v_cvt_pk_bf16_f32 v133, v202, v203
    v_cvt_pk_bf16_f32 v134, v204, v205
    v_cvt_pk_bf16_f32 v135, v206, v207
    v_mul_f32 v208, s36, v208
    v_mul_f32 v209, s36, v209
    v_mul_f32 v210, s36, v210
    v_mul_f32 v211, s36, v211
    v_mul_f32 v212, s36, v212
    v_mul_f32 v213, s36, v213
    v_mul_f32 v214, s36, v214
    v_mul_f32 v215, s36, v215
    v_cvt_pk_bf16_f32 v136, v208, v209
    v_cvt_pk_bf16_f32 v137, v210, v211
    v_cvt_pk_bf16_f32 v138, v212, v213
    v_cvt_pk_bf16_f32 v139, v214, v215
    v_mul_f32 v216, s36, v216
    v_mul_f32 v217, s36, v217
    v_mul_f32 v218, s36, v218
    v_mul_f32 v219, s36, v219
    v_mul_f32 v220, s36, v220
    v_mul_f32 v221, s36, v221
    v_mul_f32 v222, s36, v222
    v_mul_f32 v223, s36, v223
    v_cvt_pk_bf16_f32 v140, v216, v217
    v_cvt_pk_bf16_f32 v141, v218, v219
    v_cvt_pk_bf16_f32 v142, v220, v221
    v_cvt_pk_bf16_f32 v143, v222, v223
    v_mul_f32 v224, s36, v224
    v_mul_f32 v225, s36, v225
    v_mul_f32 v226, s36, v226
    v_mul_f32 v227, s36, v227
    v_mul_f32 v228, s36, v228
    v_mul_f32 v229, s36, v229
    v_mul_f32 v230, s36, v230
    v_mul_f32 v231, s36, v231
    v_cvt_pk_bf16_f32 v144, v224, v225
    v_cvt_pk_bf16_f32 v145, v226, v227
    v_cvt_pk_bf16_f32 v146, v228, v229
    v_cvt_pk_bf16_f32 v147, v230, v231
    v_mul_f32 v232, s36, v232
    v_mul_f32 v233, s36, v233
    v_mul_f32 v234, s36, v234
    v_mul_f32 v235, s36, v235
    v_mul_f32 v236, s36, v236
    v_mul_f32 v237, s36, v237
    v_mul_f32 v238, s36, v238
    v_mul_f32 v239, s36, v239
    v_cvt_pk_bf16_f32 v148, v232, v233
    v_cvt_pk_bf16_f32 v149, v234, v235
    v_cvt_pk_bf16_f32 v150, v236, v237
    v_cvt_pk_bf16_f32 v151, v238, v239
    v_mul_f32 v240, s36, v240
    v_mul_f32 v241, s36, v241
    v_mul_f32 v242, s36, v242
    v_mul_f32 v243, s36, v243
    v_mul_f32 v244, s36, v244
    v_mul_f32 v245, s36, v245
    v_mul_f32 v246, s36, v246
    v_mul_f32 v247, s36, v247
    v_cvt_pk_bf16_f32 v152, v240, v241
    v_cvt_pk_bf16_f32 v153, v242, v243
    v_cvt_pk_bf16_f32 v154, v244, v245
    v_cvt_pk_bf16_f32 v155, v246, v247
    v_mul_f32 v248, s36, v248
    v_mul_f32 v249, s36, v249
    v_mul_f32 v250, s36, v250
    v_mul_f32 v251, s36, v251
    v_mul_f32 v252, s36, v252
    v_mul_f32 v253, s36, v253
    v_mul_f32 v254, s36, v254
    v_mul_f32 v255, s36, v255
    v_cvt_pk_bf16_f32 v156, v248, v249
    v_cvt_pk_bf16_f32 v157, v250, v251
    v_cvt_pk_bf16_f32 v158, v252, v253
    v_cvt_pk_bf16_f32 v159, v254, v255
    v_mov_b32 v2, v7
    v_and_b32 v21, 15, v1
    v_lshrrev_b32 v22, 4, v1
    v_lshlrev_b32 v22, 2, v22
    v_sub_u32 v18, v21, v22
    s_mov_b32 s40, 0
    s_mov_b32 s41, 0
    s_lshl_b32 s51, s30, 1
    s_add_u32 s51, s51, 1
    s_and_b32 s36, s28, 3
    s_lshl_b32 s36, s36, 5
    s_lshl_b32 s37, s30, 7
    s_add_u32 s36, s36, s37
    s_sub_u32 s50, 0, s36
    s_lshl_b32 s42, s30, 8
    s_sub_u32 s42, s42, 1792
    s_mov_b64 s[52:53], 0
    s_waitcnt lgkmcnt(0)
    s_barrier
    ds_read_b128 v[160:163], v19 offset:0
    ds_read_b128 v[164:167], v19 offset:1024
    ds_read_b128 v[168:171], v19 offset:2048
    ds_read_b128 v[172:175], v19 offset:3072
    ds_read_b128 v[176:179], v19 offset:4096
    ds_read_b128 v[180:183], v19 offset:5120
    ds_read_b128 v[184:187], v19 offset:6144
    ds_read_b128 v[188:191], v19 offset:7168
    s_add_u32 s16, s54, 41943040
    s_addc_u32 s17, s55, 0
    s_and_b32 s17, s17, 0xffff
    s_mov_b32 s18, 16777216
    s_mov_b32 s19, 0x20000
    s_cmp_eq_u32 s28, 4
    s_cbranch_scc1 L_recurrent_scan__compressed_kv_cla__moe_arch_mod__prompt_kernel_rare_156
L_recurrent_scan__compressed_kv_cla__moe_arch_mod__prompt_kernel_back_157:
    s_sub_u32 s36, s2, 128
    s_lshl_b32 s36, s36, 2
    s_and_b32 s37, s28, 3
    s_add_u32 s36, s36, s37
    s_lshl_b32 s36, s36, 14
    v_lshl_add_u32 v13, v1, 7, s36
    s_cmp_ge_u32 s2, 128
    s_cselect_b32 s39, 9, 2
    ds_read_b128 v[64:67], v2 offset:0
    ds_read_b128 v[68:71], v2 offset:1024
    ds_read_b128 v[72:75], v2 offset:2048
    ds_read_b128 v[76:79], v2 offset:3072
    ds_read_b128 v[80:83], v2 offset:4096
    ds_read_b128 v[84:87], v2 offset:5120
    ds_read_b128 v[88:91], v2 offset:6144
    ds_read_b128 v[92:95], v2 offset:7168
    s_waitcnt lgkmcnt(7)
    v_mfma_f32_16x16x32_bf16 v[96:99], v[64:67], v[128:131], 0
    v_mov_b32 v192, 0
    v_mov_b32 v193, 0
    v_mfma_f32_16x16x32_bf16 v[104:107], v[64:67], v[144:147], 0
    ds_read_b128 v[64:67], v2 offset:8192
    v_mov_b32 v194, 0
    v_mov_b32 v195, 0
    s_waitcnt lgkmcnt(7)
    v_mfma_f32_16x16x32_bf16 v[96:99], v[68:71], v[132:135], v[96:99]
    v_mov_b32 v196, 0
    v_mov_b32 v197, 0
    v_mfma_f32_16x16x32_bf16 v[104:107], v[68:71], v[148:151], v[104:107]
    ds_read_b128 v[68:71], v2 offset:9216
    v_mov_b32 v198, 0
    v_mov_b32 v199, 0
    s_waitcnt lgkmcnt(7)
    v_mfma_f32_16x16x32_bf16 v[96:99], v[72:75], v[136:139], v[96:99]
    v_mov_b32 v200, 0
    v_mov_b32 v201, 0
    v_mfma_f32_16x16x32_bf16 v[104:107], v[72:75], v[152:155], v[104:107]
    ds_read_b128 v[72:75], v2 offset:10240
    v_mov_b32 v202, 0
    v_mov_b32 v203, 0
    s_waitcnt lgkmcnt(7)
    v_mfma_f32_16x16x32_bf16 v[96:99], v[76:79], v[140:143], v[96:99]
    v_mov_b32 v204, 0
    v_mov_b32 v205, 0
    v_mfma_f32_16x16x32_bf16 v[104:107], v[76:79], v[156:159], v[104:107]
    ds_read_b128 v[76:79], v2 offset:11264
    v_mov_b32 v206, 0
    v_mov_b32 v207, 0
    s_waitcnt lgkmcnt(7)
    v_mfma_f32_16x16x32_bf16 v[100:103], v[80:83], v[128:131], 0
    v_mov_b32 v208, 0
    v_mov_b32 v209, 0
    v_mfma_f32_16x16x32_bf16 v[108:111], v[80:83], v[144:147], 0
    ds_read_b128 v[80:83], v2 offset:12288
    v_mov_b32 v210, 0
    v_mov_b32 v211, 0
    s_waitcnt lgkmcnt(7)
    v_mfma_f32_16x16x32_bf16 v[100:103], v[84:87], v[132:135], v[100:103]
    v_mov_b32 v212, 0
    v_mov_b32 v213, 0
    v_mfma_f32_16x16x32_bf16 v[108:111], v[84:87], v[148:151], v[108:111]
    ds_read_b128 v[84:87], v2 offset:13312
    v_mov_b32 v214, 0
    v_mov_b32 v215, 0
    s_waitcnt lgkmcnt(7)
    v_mfma_f32_16x16x32_bf16 v[100:103], v[88:91], v[136:139], v[100:103]
    v_mov_b32 v216, 0
    v_mov_b32 v217, 0
    v_mfma_f32_16x16x32_bf16 v[108:111], v[88:91], v[152:155], v[108:111]
    ds_read_b128 v[88:91], v2 offset:14336
    v_mov_b32 v218, 0
    v_mov_b32 v219, 0
    s_waitcnt lgkmcnt(7)
    v_mfma_f32_16x16x32_bf16 v[100:103], v[92:95], v[140:143], v[100:103]
    v_mov_b32 v220, 0
    v_mov_b32 v221, 0
    v_mfma_f32_16x16x32_bf16 v[108:111], v[92:95], v[156:159], v[108:111]
    ds_read_b128 v[92:95], v2 offset:15360
    v_mov_b32 v222, 0
    v_mov_b32 v223, 0
    s_waitcnt lgkmcnt(7)
    v_mfma_f32_16x16x32_bf16 v[112:115], v[64:67], v[128:131], 0
    v_mov_b32 v224, 0
    v_mov_b32 v225, 0
    v_mfma_f32_16x16x32_bf16 v[120:123], v[64:67], v[144:147], 0
    v_mov_b32 v226, 0
    v_mov_b32 v227, 0
    s_waitcnt lgkmcnt(6)
    v_mfma_f32_16x16x32_bf16 v[112:115], v[68:71], v[132:135], v[112:115]
    v_mov_b32 v228, 0
    v_mov_b32 v229, 0
    v_mfma_f32_16x16x32_bf16 v[120:123], v[68:71], v[148:151], v[120:123]
    v_mov_b32 v230, 0
    v_mov_b32 v231, 0
    s_waitcnt lgkmcnt(5)
    v_mfma_f32_16x16x32_bf16 v[112:115], v[72:75], v[136:139], v[112:115]
    v_mov_b32 v232, 0
    v_mov_b32 v233, 0
    v_mfma_f32_16x16x32_bf16 v[120:123], v[72:75], v[152:155], v[120:123]
    v_mov_b32 v234, 0
    v_mov_b32 v235, 0
    s_waitcnt lgkmcnt(4)
    v_mfma_f32_16x16x32_bf16 v[112:115], v[76:79], v[140:143], v[112:115]
    v_mov_b32 v236, 0
    v_mov_b32 v237, 0
    v_mfma_f32_16x16x32_bf16 v[120:123], v[76:79], v[156:159], v[120:123]
    v_mov_b32 v238, 0
    v_mov_b32 v239, 0
    s_waitcnt lgkmcnt(3)
    v_mfma_f32_16x16x32_bf16 v[116:119], v[80:83], v[128:131], 0
    v_mov_b32 v240, 0
    v_mov_b32 v241, 0
    v_mfma_f32_16x16x32_bf16 v[124:127], v[80:83], v[144:147], 0
    v_mov_b32 v242, 0
    v_mov_b32 v243, 0
    s_waitcnt lgkmcnt(2)
    v_mfma_f32_16x16x32_bf16 v[116:119], v[84:87], v[132:135], v[116:119]
    v_mov_b32 v244, 0
    v_mov_b32 v245, 0
    v_mfma_f32_16x16x32_bf16 v[124:127], v[84:87], v[148:151], v[124:127]
    v_mov_b32 v246, 0
    v_mov_b32 v247, 0
    s_waitcnt lgkmcnt(1)
    v_mfma_f32_16x16x32_bf16 v[116:119], v[88:91], v[136:139], v[116:119]
    v_mov_b32 v248, 0
    v_mov_b32 v249, 0
    v_mfma_f32_16x16x32_bf16 v[124:127], v[88:91], v[152:155], v[124:127]
    v_mov_b32 v250, 0
    v_mov_b32 v251, 0
    s_waitcnt lgkmcnt(0)
    v_mfma_f32_16x16x32_bf16 v[116:119], v[92:95], v[140:143], v[116:119]
    v_mov_b32 v252, 0
    v_mov_b32 v253, 0
    v_mfma_f32_16x16x32_bf16 v[124:127], v[92:95], v[156:159], v[124:127]
    v_mov_b32 v254, 0
    v_mov_b32 v255, 0
    v_mov_b32 v38, 0
    v_mov_b32 v39, 0
    s_cmp_lt_i32 s50, 0
    s_cbranch_scc0 L_recurrent_scan__compressed_kv_cla__moe_arch_mod__prompt_kernel_rare_158
L_recurrent_scan__compressed_kv_cla__moe_arch_mod__prompt_kernel_back_159:
    s_add_u32 s49, s50, 32
    v_add_u32 v24, 65536, v2
    s_cmp_lt_u32 s40, s51
    s_cselect_b32 s36, 64, 128
    s_add_u32 s41, s41, s36
    s_cmp_eq_u32 s40, s51
    s_cselect_b32 s36, s42, s36
    s_add_u32 s50, s50, s36
    s_and_b32 s36, s41, 0xff
    v_lshl_add_u32 v2, s36, 8, v7
    s_cmp_eq_u32 s40, 16
    s_cselect_b64 s[20:21], -1, 0
    v_cndmask_b32 v5, v2, v24, s[20:21]
    v_mov_b32 v3, v24
    s_waitcnt vmcnt(1)
    s_cmp_eq_u32 s28, 4
    s_cbranch_scc1 L_recurrent_scan__compressed_kv_cla__moe_arch_mod__prompt_kernel_pw_160
    s_waitcnt vmcnt(0)
L_recurrent_scan__compressed_kv_cla__moe_arch_mod__prompt_kernel_pw_160:
    s_barrier
    ds_read_b128 v[64:67], v5 offset:0
    ds_read_b128 v[68:71], v5 offset:1024
    ds_read_b128 v[72:75], v5 offset:2048
    ds_read_b128 v[76:79], v5 offset:3072
    ds_read_b128 v[80:83], v5 offset:4096
    ds_read_b128 v[84:87], v5 offset:5120
    ds_read_b128 v[88:91], v5 offset:6144
    v_max3_f32 v21, v96, v97, v98
    v_max3_f32 v21, v21, v99, v100
    v_max3_f32 v21, v21, v101, v102
    v_max_f32 v21, v21, v103
    v_max3_f32 v22, v104, v105, v106
    v_max3_f32 v22, v22, v107, v108
    v_max3_f32 v22, v22, v109, v110
    v_max_f32 v22, v22, v111
    v_mov_b32 v23, v21
    s_nop 1
    v_permlane16_swap_b32 v21, v23
    s_nop 1
    v_max_f32 v21, v21, v23
    v_mov_b32 v23, v21
    s_nop 1
    v_permlane32_swap_b32 v21, v23
    s_nop 1
    v_max_f32 v21, v21, v23
    v_mov_b32 v23, v22
    s_nop 1
    v_permlane16_swap_b32 v22, v23
    s_nop 1
    v_max_f32 v22, v22, v23
    v_mov_b32 v23, v22
    s_nop 1
    v_permlane32_swap_b32 v22, v23
    s_nop 1
    v_max_f32 v22, v22, v23
    v_sub_f32 v40, 0, v21
    v_sub_f32 v41, 0, v21
    v_sub_f32 v42, 0, v21
    v_sub_f32 v43, 0, v21
    v_sub_f32 v44, 0, v22
    v_sub_f32 v45, 0, v22
    v_sub_f32 v46, 0, v22
    v_sub_f32 v47, 0, v22
    v_sub_f32 v96, v96, v21
    v_sub_f32 v97, v97, v21
    v_sub_f32 v98, v98, v21
    v_sub_f32 v99, v99, v21
    v_sub_f32 v100, v100, v21
    v_sub_f32 v101, v101, v21
    v_sub_f32 v102, v102, v21
    v_sub_f32 v103, v103, v21
    v_sub_f32 v104, v104, v22
    v_sub_f32 v105, v105, v22
    v_sub_f32 v106, v106, v22
    v_sub_f32 v107, v107, v22
    v_sub_f32 v108, v108, v22
    v_sub_f32 v109, v109, v22
    v_sub_f32 v110, v110, v22
    v_sub_f32 v111, v111, v22
    v_sub_f32 v112, v112, v21
    v_sub_f32 v113, v113, v21
    v_sub_f32 v114, v114, v21
    v_sub_f32 v115, v115, v21
    v_sub_f32 v116, v116, v21
    v_sub_f32 v117, v117, v21
    v_sub_f32 v118, v118, v21
    v_sub_f32 v119, v119, v21
    v_sub_f32 v120, v120, v22
    v_sub_f32 v121, v121, v22
    v_sub_f32 v122, v122, v22
    v_sub_f32 v123, v123, v22
    v_sub_f32 v124, v124, v22
    v_sub_f32 v125, v125, v22
    v_sub_f32 v126, v126, v22
    v_sub_f32 v127, v127, v22
    v_exp_f32 v96, v96
    v_exp_f32 v97, v97
    v_add_f32 v38, v38, v96
    v_exp_f32 v98, v98
    v_add_f32 v38, v38, v97
    v_cvt_pk_bf16_f32 v48, v96, v97
    v_exp_f32 v99, v99
    v_add_f32 v38, v38, v98
    v_exp_f32 v104, v104
    v_add_f32 v38, v38, v99
    v_cvt_pk_bf16_f32 v49, v98, v99
    v_exp_f32 v105, v105
    v_add_f32 v39, v39, v104
    v_exp_f32 v106, v106
    v_add_f32 v39, v39, v105
    v_cvt_pk_bf16_f32 v52, v104, v105
    v_exp_f32 v107, v107
    v_add_f32 v39, v39, v106
    v_exp_f32 v100, v100
    v_add_f32 v39, v39, v107
    v_cvt_pk_bf16_f32 v53, v106, v107
    v_exp_f32 v101, v101
    v_add_f32 v38, v38, v100
    v_exp_f32 v102, v102
    v_add_f32 v38, v38, v101
    v_cvt_pk_bf16_f32 v50, v100, v101
    v_exp_f32 v103, v103
    v_add_f32 v38, v38, v102
    v_exp_f32 v108, v108
    v_add_f32 v38, v38, v103
    v_cvt_pk_bf16_f32 v51, v102, v103
    v_exp_f32 v109, v109
    v_add_f32 v39, v39, v108
    v_exp_f32 v110, v110
    v_add_f32 v39, v39, v109
    v_cvt_pk_bf16_f32 v54, v108, v109
    v_exp_f32 v111, v111
    v_add_f32 v39, v39, v110
    s_nop 0
    v_add_f32 v39, v39, v111
    v_cvt_pk_bf16_f32 v55, v110, v111
    .p2align 6
L_body1:
    s_cmp_lt_i32 s49, 0
    s_cbranch_scc0 L_recurrent_scan__compressed_kv_cla__moe_arch_mod__prompt_kernel_rare_161
L_recurrent_scan__compressed_kv_cla__moe_arch_mod__prompt_kernel_back_162:
    s_waitcnt lgkmcnt(3)
    v_mfma_f32_16x16x32_bf16 v[96:99], v[64:67], v[128:131], v[40:43]
    v_exp_f32 v112, v112
    v_mfma_f32_16x16x32_bf16 v[104:107], v[64:67], v[144:147], v[44:47]
    ds_read_b128 v[92:95], v2 offset:7168
    v_mfma_f32_16x16x32_bf16 v[96:99], v[68:71], v[132:135], v[96:99]
    v_exp_f32 v113, v113
    v_mfma_f32_16x16x32_bf16 v[104:107], v[68:71], v[148:151], v[104:107]
    ds_read_b128 v[64:67], v3 offset:0
    v_add_f32 v38, v38, v112
    v_mfma_f32_16x16x32_bf16 v[96:99], v[72:75], v[136:139], v[96:99]
    v_exp_f32 v114, v114
    v_mfma_f32_16x16x32_bf16 v[104:107], v[72:75], v[152:155], v[104:107]
    ds_read_b128 v[68:71], v3 offset:1024
    v_add_f32 v38, v38, v113
    v_cvt_pk_bf16_f32 v56, v112, v113
    v_mfma_f32_16x16x32_bf16 v[96:99], v[76:79], v[140:143], v[96:99]
    v_exp_f32 v115, v115
    v_mfma_f32_16x16x32_bf16 v[104:107], v[76:79], v[156:159], v[104:107]
    ds_read_b128 v[72:75], v3 offset:2048
    v_add_f32 v38, v38, v114
    s_waitcnt lgkmcnt(3)
    v_mfma_f32_16x16x32_bf16 v[100:103], v[80:83], v[128:131], v[40:43]
    v_exp_f32 v120, v120
    v_mfma_f32_16x16x32_bf16 v[108:111], v[80:83], v[144:147], v[44:47]
    ds_read_b128 v[76:79], v3 offset:3072
    v_add_f32 v38, v38, v115
    v_cvt_pk_bf16_f32 v57, v114, v115
    v_mfma_f32_16x16x32_bf16 v[100:103], v[84:87], v[132:135], v[100:103]
    v_exp_f32 v121, v121
    v_mfma_f32_16x16x32_bf16 v[108:111], v[84:87], v[148:151], v[108:111]
    ds_read_b128 v[80:83], v3 offset:4096
    v_add_f32 v39, v39, v120
    v_mfma_f32_16x16x32_bf16 v[100:103], v[88:91], v[136:139], v[100:103]
    v_exp_f32 v122, v122
    v_mfma_f32_16x16x32_bf16 v[108:111], v[88:91], v[152:155], v[108:111]
    ds_read_b128 v[84:87], v3 offset:5120
    v_add_f32 v39, v39, v121
    v_cvt_pk_bf16_f32 v60, v120, v121
    v_mfma_f32_16x16x32_bf16 v[100:103], v[92:95], v[140:143], v[100:103]
    v_exp_f32 v123, v123
    v_mfma_f32_16x16x32_bf16 v[108:111], v[92:95], v[156:159], v[108:111]
    ds_read_b128 v[88:91], v3 offset:6144
    v_add_f32 v39, v39, v122
    s_waitcnt lgkmcnt(3)
    v_mfma_f32_16x16x32_bf16 v[192:195], v[64:67], v[48:51], v[192:195]
    v_exp_f32 v116, v116
    v_mfma_f32_16x16x32_bf16 v[224:227], v[64:67], v[52:55], v[224:227]
    ds_read_b128 v[92:95], v3 offset:7168
    v_add_f32 v39, v39, v123
    v_cvt_pk_bf16_f32 v61, v122, v123
    v_mfma_f32_16x16x32_bf16 v[196:199], v[68:71], v[48:51], v[196:199]
    v_exp_f32 v117, v117
    v_mfma_f32_16x16x32_bf16 v[228:231], v[68:71], v[52:55], v[228:231]
    ds_read_b128 v[64:67], v2 offset:8192
    v_add_f32 v38, v38, v116
    v_mfma_f32_16x16x32_bf16 v[200:203], v[72:75], v[48:51], v[200:203]
    v_exp_f32 v118, v118
    v_mfma_f32_16x16x32_bf16 v[232:235], v[72:75], v[52:55], v[232:235]
    ds_read_b128 v[68:71], v2 offset:9216
    v_add_f32 v38, v38, v117
    v_cvt_pk_bf16_f32 v58, v116, v117
    v_mfma_f32_16x16x32_bf16 v[204:207], v[76:79], v[48:51], v[204:207]
    v_exp_f32 v119, v119
    v_mfma_f32_16x16x32_bf16 v[236:239], v[76:79], v[52:55], v[236:239]
    ds_read_b128 v[72:75], v2 offset:10240
    v_add_f32 v38, v38, v118
    s_waitcnt lgkmcnt(3)
    v_mfma_f32_16x16x32_bf16 v[208:211], v[80:83], v[48:51], v[208:211]
    v_exp_f32 v124, v124
    v_mfma_f32_16x16x32_bf16 v[240:243], v[80:83], v[52:55], v[240:243]
    ds_read_b128 v[76:79], v2 offset:11264
    v_add_f32 v38, v38, v119
    v_cvt_pk_bf16_f32 v59, v118, v119
    v_mfma_f32_16x16x32_bf16 v[212:215], v[84:87], v[48:51], v[212:215]
    v_exp_f32 v125, v125
    v_mfma_f32_16x16x32_bf16 v[244:247], v[84:87], v[52:55], v[244:247]
    ds_read_b128 v[80:83], v2 offset:12288
    v_add_f32 v39, v39, v124
    v_mfma_f32_16x16x32_bf16 v[216:219], v[88:91], v[48:51], v[216:219]
    v_exp_f32 v126, v126
    v_mfma_f32_16x16x32_bf16 v[248:251], v[88:91], v[52:55], v[248:251]
    ds_read_b128 v[84:87], v2 offset:13312
    v_add_f32 v39, v39, v125
    v_cvt_pk_bf16_f32 v62, v124, v125
    v_mfma_f32_16x16x32_bf16 v[220:223], v[92:95], v[48:51], v[220:223]
    v_exp_f32 v127, v127
    v_mfma_f32_16x16x32_bf16 v[252:255], v[92:95], v[52:55], v[252:255]
    ds_read_b128 v[88:91], v2 offset:14336
    v_add_f32 v39, v39, v126
    v_add_f32 v39, v39, v127
    v_cvt_pk_bf16_f32 v63, v126, v127
    s_cmp_eq_u32 s40, s51
    s_cbranch_scc1 L_recurrent_scan__compressed_kv_cla__moe_arch_mod__prompt_kernel_rare_163
L_recurrent_scan__compressed_kv_cla__moe_arch_mod__prompt_kernel_back_164:
    s_cmp_lt_i32 s50, 0
    s_cbranch_scc0 L_recurrent_scan__compressed_kv_cla__moe_arch_mod__prompt_kernel_rare_165
L_recurrent_scan__compressed_kv_cla__moe_arch_mod__prompt_kernel_back_166:
    s_waitcnt lgkmcnt(3)
    v_mfma_f32_16x16x32_bf16 v[112:115], v[64:67], v[128:131], v[40:43]
    v_exp_f32 v96, v96
    v_mfma_f32_16x16x32_bf16 v[120:123], v[64:67], v[144:147], v[44:47]
    ds_read_b128 v[92:95], v2 offset:15360
    v_mfma_f32_16x16x32_bf16 v[112:115], v[68:71], v[132:135], v[112:115]
    v_exp_f32 v97, v97
    s_add_u32 s40, s40, 1
    v_mfma_f32_16x16x32_bf16 v[120:123], v[68:71], v[148:151], v[120:123]
    ds_read_b128 v[64:67], v3 offset:8192
    v_add_f32 v38, v38, v96
    s_add_u32 s49, s50, 32
    v_add_u32 v24, 65536, v2
    v_mfma_f32_16x16x32_bf16 v[112:115], v[72:75], v[136:139], v[112:115]
    v_exp_f32 v98, v98
    v_mfma_f32_16x16x32_bf16 v[120:123], v[72:75], v[152:155], v[120:123]
    ds_read_b128 v[68:71], v3 offset:9216
    v_add_f32 v38, v38, v97
    v_cvt_pk_bf16_f32 v48, v96, v97
    s_cmp_lt_u32 s40, s51
    s_cselect_b32 s36, 64, 128
    v_mfma_f32_16x16x32_bf16 v[112:115], v[76:79], v[140:143], v[112:115]
    v_exp_f32 v99, v99
    v_mfma_f32_16x16x32_bf16 v[120:123], v[76:79], v[156:159], v[120:123]
    ds_read_b128 v[72:75], v3 offset:10240
    v_add_f32 v38, v38, v98
    s_add_u32 s41, s41, s36
    s_waitcnt lgkmcnt(3)
    v_mfma_f32_16x16x32_bf16 v[116:119], v[80:83], v[128:131], v[40:43]
    v_exp_f32 v104, v104
    v_mfma_f32_16x16x32_bf16 v[124:127], v[80:83], v[144:147], v[44:47]
    ds_read_b128 v[76:79], v3 offset:11264
    v_add_f32 v38, v38, v99
    v_cvt_pk_bf16_f32 v49, v98, v99
    s_cmp_eq_u32 s40, s51
    s_cselect_b32 s36, s42, s36
    v_mfma_f32_16x16x32_bf16 v[116:119], v[84:87], v[132:135], v[116:119]
    v_exp_f32 v105, v105
    v_mfma_f32_16x16x32_bf16 v[124:127], v[84:87], v[148:151], v[124:127]
    ds_read_b128 v[80:83], v3 offset:12288
    v_add_f32 v39, v39, v104
    s_add_u32 s50, s50, s36
    v_mfma_f32_16x16x32_bf16 v[116:119], v[88:91], v[136:139], v[116:119]
    v_exp_f32 v106, v106
    v_mfma_f32_16x16x32_bf16 v[124:127], v[88:91], v[152:155], v[124:127]
    ds_read_b128 v[84:87], v3 offset:13312
    v_add_f32 v39, v39, v105
    v_cvt_pk_bf16_f32 v52, v104, v105
    s_and_b32 s36, s41, 0xff
    v_lshl_add_u32 v2, s36, 8, v7
    v_mfma_f32_16x16x32_bf16 v[116:119], v[92:95], v[140:143], v[116:119]
    v_exp_f32 v107, v107
    v_mfma_f32_16x16x32_bf16 v[124:127], v[92:95], v[156:159], v[124:127]
    ds_read_b128 v[88:91], v3 offset:14336
    v_add_f32 v39, v39, v106
    s_cmp_eq_u32 s40, 16
    s_cselect_b64 s[20:21], -1, 0
    s_waitcnt lgkmcnt(3)
    v_mfma_f32_16x16x32_bf16 v[192:195], v[64:67], v[56:59], v[192:195]
    v_exp_f32 v100, v100
    v_mfma_f32_16x16x32_bf16 v[224:227], v[64:67], v[60:63], v[224:227]
    ds_read_b128 v[92:95], v3 offset:15360
    v_add_f32 v39, v39, v107
    v_cvt_pk_bf16_f32 v53, v106, v107
    v_cndmask_b32 v5, v2, v24, s[20:21]
    v_mfma_f32_16x16x32_bf16 v[196:199], v[68:71], v[56:59], v[196:199]
    v_exp_f32 v101, v101
    v_mfma_f32_16x16x32_bf16 v[228:231], v[68:71], v[60:63], v[228:231]
    v_add_f32 v38, v38, v100
    v_mov_b32 v3, v24
    v_mfma_f32_16x16x32_bf16 v[200:203], v[72:75], v[56:59], v[200:203]
    v_exp_f32 v102, v102
    v_mfma_f32_16x16x32_bf16 v[232:235], v[72:75], v[60:63], v[232:235]
    v_add_f32 v38, v38, v101
    v_cvt_pk_bf16_f32 v50, v100, v101
    s_waitcnt lgkmcnt(0)
    s_barrier
    v_mfma_f32_16x16x32_bf16 v[204:207], v[76:79], v[56:59], v[204:207]
    v_exp_f32 v103, v103
    v_mfma_f32_16x16x32_bf16 v[236:239], v[76:79], v[60:63], v[236:239]
    ds_read_b128 v[68:71], v5 offset:1024
    ds_read_b128 v[64:67], v5 offset:0
    v_add_f32 v38, v38, v102
    v_mfma_f32_16x16x32_bf16 v[208:211], v[80:83], v[56:59], v[208:211]
    v_exp_f32 v108, v108
    v_mfma_f32_16x16x32_bf16 v[240:243], v[80:83], v[60:63], v[240:243]
    ds_read_b128 v[76:79], v5 offset:3072
    ds_read_b128 v[72:75], v5 offset:2048
    v_add_f32 v38, v38, v103
    v_cvt_pk_bf16_f32 v51, v102, v103
    v_mfma_f32_16x16x32_bf16 v[212:215], v[84:87], v[56:59], v[212:215]
    v_exp_f32 v109, v109
    v_mfma_f32_16x16x32_bf16 v[244:247], v[84:87], v[60:63], v[244:247]
    ds_read_b128 v[80:83], v5 offset:4096
    v_add_f32 v39, v39, v108
    v_mfma_f32_16x16x32_bf16 v[216:219], v[88:91], v[56:59], v[216:219]
    v_exp_f32 v110, v110
    v_mfma_f32_16x16x32_bf16 v[248:251], v[88:91], v[60:63], v[248:251]
    ds_read_b128 v[84:87], v5 offset:5120
    v_add_f32 v39, v39, v109
    v_cvt_pk_bf16_f32 v54, v108, v109
    v_mfma_f32_16x16x32_bf16 v[220:223], v[92:95], v[56:59], v[220:223]
    v_exp_f32 v111, v111
    v_mfma_f32_16x16x32_bf16 v[252:255], v[92:95], v[60:63], v[252:255]
    ds_read_b128 v[88:91], v5 offset:6144
    v_add_f32 v39, v39, v110
    v_add_f32 v39, v39, v111
    v_cvt_pk_bf16_f32 v55, v110, v111
    s_cmp_lt_u32 s40, s39
    s_cbranch_scc1 L_recurrent_scan__compressed_kv_cla__moe_arch_mod__prompt_kernel_rare_183
L_recurrent_scan__compressed_kv_cla__moe_arch_mod__prompt_kernel_back_184:
    s_sub_u32 s36, s40, s51
    s_cmp_lt_u32 s36, 2
    s_cbranch_scc1 L_recurrent_scan__compressed_kv_cla__moe_arch_mod__prompt_kernel_rare_170
L_recurrent_scan__compressed_kv_cla__moe_arch_mod__prompt_kernel_back_171:
    s_cmp_lg_u32 s40, 16
    s_cbranch_scc1 L_body1
    s_load_dwordx2 s[92:93], s[0:1], 40
    s_load_dwordx2 s[94:95], s[0:1], 80
    s_waitcnt vmcnt(0) lgkmcnt(0)
    s_mov_b32 s4, s94
    s_and_b32 s5, s95, 0xffff
    s_mov_b32 s6, 7340032
    s_mov_b32 s7, 0x20000
    s_mov_b32 s8, s92
    s_and_b32 s9, s93, 0xffff
    s_mov_b32 s10, 8388608
    s_mov_b32 s11, 0x20000
    s_lshr_b32 s38, s2, 4
    s_mul_i32 s38, s38, 224
    s_and_b32 s39, s2, 15
    s_lshl_b32 s39, s39, 7
    v_lshrrev_b32 v27, 3, v1
    s_lshl_b32 s36, s28, 5
    s_add_u32 s36, s36, s38
    v_add_u32 v27, s36, v27
    v_mul_u32_u24 v27, 2048, v27
    v_add_u32 v27, s39, v27
    v_bfe_u32 v28, v1, 4, 1
    v_lshlrev_b32 v28, 1, v28
    v_and_b32 v29, 7, v1
    v_xor_b32 v28, v28, v29
    v_lshl_add_u32 v26, v28, 4, v27
    v_xor_b32 v28, 4, v28
    v_lshl_add_u32 v27, v28, 4, v27
    v_add_u32 v27, 15360, v27
    v_add_u32 v28, 30720, v26
    v_add_u32 v29, 30720, v27
    s_lshl_b32 s36, s28, 12
    s_add_u32 s36, s36, 131072
    s_cmp_lt_u32 s28, 7
    s_cselect_b32 m0, s36, 0x30000
    s_cselect_b32 s6, 7340032, 0
    buffer_load_dwordx4 v26, s[4:7], 0 offen offset:0 lds
    buffer_load_dwordx4 v27, s[4:7], 0 offen offset:1024 lds
    buffer_load_dwordx4 v28, s[4:7], 0 offen offset:2048 lds
    buffer_load_dwordx4 v29, s[4:7], 0 offen offset:3072 lds
    s_lshr_b32 s36, s2, 5
    s_add_u32 s36, s36, 48
    s_lshl_b32 s36, s36, 7
    v_mov_b32 v12, s36
    global_load_dword v11, v12, s[90:91] sc1
    s_cmp_lt_i32 s49, 0
    s_cbranch_scc0 L_recurrent_scan__compressed_kv_cla__moe_arch_mod__prompt_kernel_rare_168
L_recurrent_scan__compressed_kv_cla__moe_arch_mod__prompt_kernel_back_169:
    s_waitcnt lgkmcnt(5)
    v_mfma_f32_16x16x32_bf16 v[192:195], v[64:67], v[48:51], v[192:195]
    v_exp_f32 v112, v112
    v_mfma_f32_16x16x32_bf16 v[224:227], v[64:67], v[52:55], v[224:227]
    ds_read_b128 v[92:95], v3 offset:7168
    v_add_f32 v38, v38, v112
    v_exp_f32 v113, v113
    v_mfma_f32_16x16x32_bf16 v[196:199], v[68:71], v[48:51], v[196:199]
    v_add_f32 v38, v38, v113
    v_cvt_pk_bf16_f32 v56, v112, v113
    v_exp_f32 v114, v114
    v_mfma_f32_16x16x32_bf16 v[228:231], v[68:71], v[52:55], v[228:231]
    ds_read_b128 v[64:67], v3 offset:8192
    v_add_f32 v38, v38, v114
    v_exp_f32 v115, v115
    s_waitcnt lgkmcnt(5)
    v_mfma_f32_16x16x32_bf16 v[200:203], v[72:75], v[48:51], v[200:203]
    v_add_f32 v38, v38, v115
    v_cvt_pk_bf16_f32 v57, v114, v115
    v_exp_f32 v120, v120
    v_mfma_f32_16x16x32_bf16 v[232:235], v[72:75], v[52:55], v[232:235]
    ds_read_b128 v[68:71], v3 offset:9216
    v_add_f32 v39, v39, v120
    v_exp_f32 v121, v121
    v_mfma_f32_16x16x32_bf16 v[204:207], v[76:79], v[48:51], v[204:207]
    v_add_f32 v39, v39, v121
    v_cvt_pk_bf16_f32 v60, v120, v121
    v_exp_f32 v122, v122
    v_mfma_f32_16x16x32_bf16 v[236:239], v[76:79], v[52:55], v[236:239]
    ds_read_b128 v[72:75], v3 offset:10240
    v_add_f32 v39, v39, v122
    v_exp_f32 v123, v123
    s_waitcnt lgkmcnt(6)
    v_mfma_f32_16x16x32_bf16 v[208:211], v[80:83], v[48:51], v[208:211]
    v_add_f32 v39, v39, v123
    v_cvt_pk_bf16_f32 v61, v122, v123
    v_exp_f32 v116, v116
    v_mfma_f32_16x16x32_bf16 v[240:243], v[80:83], v[52:55], v[240:243]
    ds_read_b128 v[76:79], v3 offset:11264
    v_add_f32 v38, v38, v116
    v_exp_f32 v117, v117
    s_waitcnt lgkmcnt(6)
    v_mfma_f32_16x16x32_bf16 v[212:215], v[84:87], v[48:51], v[212:215]
    v_add_f32 v38, v38, v117
    v_cvt_pk_bf16_f32 v58, v116, v117
    v_exp_f32 v118, v118
    v_mfma_f32_16x16x32_bf16 v[244:247], v[84:87], v[52:55], v[244:247]
    ds_read_b128 v[80:83], v3 offset:12288
    v_add_f32 v38, v38, v118
    v_exp_f32 v119, v119
    s_waitcnt lgkmcnt(6)
    v_mfma_f32_16x16x32_bf16 v[216:219], v[88:91], v[48:51], v[216:219]
    v_add_f32 v38, v38, v119
    v_cvt_pk_bf16_f32 v59, v118, v119
    v_exp_f32 v124, v124
    v_mfma_f32_16x16x32_bf16 v[248:251], v[88:91], v[52:55], v[248:251]
    ds_read_b128 v[84:87], v3 offset:13312
    v_add_f32 v39, v39, v124
    v_exp_f32 v125, v125
    s_waitcnt lgkmcnt(6)
    v_mfma_f32_16x16x32_bf16 v[220:223], v[92:95], v[48:51], v[220:223]
    v_add_f32 v39, v39, v125
    v_cvt_pk_bf16_f32 v62, v124, v125
    v_exp_f32 v126, v126
    v_mfma_f32_16x16x32_bf16 v[252:255], v[92:95], v[52:55], v[252:255]
    ds_read_b128 v[88:91], v3 offset:14336
    v_add_f32 v39, v39, v126
    v_exp_f32 v127, v127
    s_nop 0
    v_add_f32 v39, v39, v127
    v_cvt_pk_bf16_f32 v63, v126, v127
    s_nop 1
    s_waitcnt lgkmcnt(6)
    v_mfma_f32_16x16x32_bf16 v[192:195], v[64:67], v[56:59], v[192:195]
    v_mfma_f32_16x16x32_bf16 v[224:227], v[64:67], v[60:63], v[224:227]
    ds_read_b128 v[92:95], v3 offset:15360
    s_waitcnt lgkmcnt(6)
    v_mfma_f32_16x16x32_bf16 v[196:199], v[68:71], v[56:59], v[196:199]
    v_mfma_f32_16x16x32_bf16 v[228:231], v[68:71], v[60:63], v[228:231]
    s_waitcnt lgkmcnt(5)
    v_mfma_f32_16x16x32_bf16 v[200:203], v[72:75], v[56:59], v[200:203]
    v_mfma_f32_16x16x32_bf16 v[232:235], v[72:75], v[60:63], v[232:235]
    s_waitcnt lgkmcnt(4)
    v_mfma_f32_16x16x32_bf16 v[204:207], v[76:79], v[56:59], v[204:207]
    v_mfma_f32_16x16x32_bf16 v[236:239], v[76:79], v[60:63], v[236:239]
    s_waitcnt lgkmcnt(3)
    v_mfma_f32_16x16x32_bf16 v[208:211], v[80:83], v[56:59], v[208:211]
    v_mfma_f32_16x16x32_bf16 v[240:243], v[80:83], v[60:63], v[240:243]
    s_waitcnt lgkmcnt(2)
    v_mfma_f32_16x16x32_bf16 v[212:215], v[84:87], v[56:59], v[212:215]
    v_mfma_f32_16x16x32_bf16 v[244:247], v[84:87], v[60:63], v[244:247]
    s_waitcnt lgkmcnt(1)
    v_mfma_f32_16x16x32_bf16 v[216:219], v[88:91], v[56:59], v[216:219]
    v_mfma_f32_16x16x32_bf16 v[248:251], v[88:91], v[60:63], v[248:251]
    s_waitcnt lgkmcnt(0)
    v_mfma_f32_16x16x32_bf16 v[220:223], v[92:95], v[56:59], v[220:223]
    v_mfma_f32_16x16x32_bf16 v[252:255], v[92:95], v[60:63], v[252:255]
    s_lshl_b32 s37, s28, 13
    v_add_u32 v21, s37, v7
    v_xor_b32 v22, 32768, v21
    s_lshl_b32 s37, s28, 8
    s_add_u32 s37, s37, 159744
    v_lshl_add_u32 v23, v1, 2, s37
    v_xor_b32 v24, 1024, v23
    ds_write_b32 v23, v38
    s_mov_b32 s36, 0x5d800000
    v_cmp_nge_f32 vcc, s36, v38
    s_nop 0
    s_or_b64 s[52:53], s[52:53], vcc
    v_cmp_nge_f32 vcc, s36, v39
    s_nop 0
    s_or_b64 s[52:53], s[52:53], vcc
    s_or_b32 s36, s52, s53
    v_mov_b32 v26, s36
    s_lshl_b32 s37, s28, 2
    s_add_u32 s37, s37, 161792
    v_mov_b32 v27, s37
    ds_write_b32 v27, v26
    ds_write_b128 v21, v[192:195] offset:0
    ds_write_b128 v21, v[196:199] offset:1024
    ds_write_b128 v21, v[200:203] offset:2048
    ds_write_b128 v21, v[204:207] offset:3072
    ds_write_b128 v21, v[208:211] offset:4096
    ds_write_b128 v21, v[212:215] offset:5120
    ds_write_b128 v21, v[216:219] offset:6144
    ds_write_b128 v21, v[220:223] offset:7168
    v_mov_b32 v28, 161856
    v_and_b32 v27, 7, v1
    v_lshlrev_b32 v27, 2, v27
    v_add_u32 v27, 161792, v27
    s_sub_u32 s36, 15, s30
    s_lshl_b32 s38, s36, 3
    s_and_b32 s37, s28, 3
    s_lshl_b32 s37, s37, 1
    s_add_u32 s38, s38, s37
    s_add_u32 s38, s38, 1
    s_lshl_b32 s38, s38, 17
    s_lshl_b32 s37, s29, 12
    s_add_u32 s38, s38, s37
    s_waitcnt lgkmcnt(0)
    s_barrier
    ds_read_b128 v[30:33], v28
    ds_read_b32 v26, v27
    ds_read_b32 v25, v24
    ds_read_b128 v[64:67], v22 offset:0
    ds_read_b128 v[68:71], v22 offset:1024
    ds_read_b128 v[72:75], v22 offset:2048
    ds_read_b128 v[76:79], v22 offset:3072
    ds_read_b128 v[80:83], v22 offset:4096
    ds_read_b128 v[84:87], v22 offset:5120
    ds_read_b128 v[88:91], v22 offset:6144
    ds_read_b128 v[92:95], v22 offset:7168
    s_waitcnt lgkmcnt(8)
    v_add_f32 v25, v25, v39
    v_mov_b32 v20, v25
    s_nop 1
    v_permlane16_swap_b32 v25, v20
    s_nop 1
    v_add_f32 v25, v25, v20
    v_mov_b32 v20, v25
    s_nop 1
    v_permlane32_swap_b32 v25, v20
    s_nop 1
    v_add_f32 v25, v25, v20
    v_cmp_ne_u32 s[52:53], 0, v26
    v_readfirstlane_b32 s56, v30
    v_readfirstlane_b32 s57, v31
    v_readfirstlane_b32 s58, v32
    v_readfirstlane_b32 s59, v33
    v_rcp_f32 v25, v25
    s_waitcnt lgkmcnt(6)
    v_add_f32 v224, v224, v64
    v_add_f32 v225, v225, v65
    v_add_f32 v226, v226, v66
    v_add_f32 v227, v227, v67
    v_add_f32 v228, v228, v68
    v_add_f32 v229, v229, v69
    v_add_f32 v230, v230, v70
    v_add_f32 v231, v231, v71
    v_mul_f32 v224, v25, v224
    v_mul_f32 v225, v25, v225
    v_mul_f32 v226, v25, v226
    v_mul_f32 v227, v25, v227
    v_mul_f32 v228, v25, v228
    v_mul_f32 v229, v25, v229
    v_mul_f32 v230, v25, v230
    v_mul_f32 v231, v25, v231
    v_cvt_pk_bf16_f32 v48, v224, v225
    v_cvt_pk_bf16_f32 v49, v226, v227
    v_cvt_pk_bf16_f32 v50, v228, v229
    v_cvt_pk_bf16_f32 v51, v230, v231
    buffer_store_dwordx4 v[48:51], v7, s[16:19], s38 offen offset:0 sc1
    s_waitcnt lgkmcnt(4)
    v_add_f32 v232, v232, v72
    v_add_f32 v233, v233, v73
    v_add_f32 v234, v234, v74
    v_add_f32 v235, v235, v75
    v_add_f32 v236, v236, v76
    v_add_f32 v237, v237, v77
    v_add_f32 v238, v238, v78
    v_add_f32 v239, v239, v79
    v_mul_f32 v232, v25, v232
    v_mul_f32 v233, v25, v233
    v_mul_f32 v234, v25, v234
    v_mul_f32 v235, v25, v235
    v_mul_f32 v236, v25, v236
    v_mul_f32 v237, v25, v237
    v_mul_f32 v238, v25, v238
    v_mul_f32 v239, v25, v239
    v_cvt_pk_bf16_f32 v52, v232, v233
    v_cvt_pk_bf16_f32 v53, v234, v235
    v_cvt_pk_bf16_f32 v54, v236, v237
    v_cvt_pk_bf16_f32 v55, v238, v239
    buffer_store_dwordx4 v[52:55], v7, s[16:19], s38 offen offset:1024 sc1
    s_waitcnt lgkmcnt(2)
    v_add_f32 v240, v240, v80
    v_add_f32 v241, v241, v81
    v_add_f32 v242, v242, v82
    v_add_f32 v243, v243, v83
    v_add_f32 v244, v244, v84
    v_add_f32 v245, v245, v85
    v_add_f32 v246, v246, v86
    v_add_f32 v247, v247, v87
    v_mul_f32 v240, v25, v240
    v_mul_f32 v241, v25, v241
    v_mul_f32 v242, v25, v242
    v_mul_f32 v243, v25, v243
    v_mul_f32 v244, v25, v244
    v_mul_f32 v245, v25, v245
    v_mul_f32 v246, v25, v246
    v_mul_f32 v247, v25, v247
    v_cvt_pk_bf16_f32 v56, v240, v241
    v_cvt_pk_bf16_f32 v57, v242, v243
    v_cvt_pk_bf16_f32 v58, v244, v245
    v_cvt_pk_bf16_f32 v59, v246, v247
    buffer_store_dwordx4 v[56:59], v7, s[16:19], s38 offen offset:2048 sc1
    s_waitcnt lgkmcnt(0)
    v_add_f32 v248, v248, v88
    v_add_f32 v249, v249, v89
    v_add_f32 v250, v250, v90
    v_add_f32 v251, v251, v91
    v_add_f32 v252, v252, v92
    v_add_f32 v253, v253, v93
    v_add_f32 v254, v254, v94
    v_add_f32 v255, v255, v95
    v_mul_f32 v248, v25, v248
    v_mul_f32 v249, v25, v249
    v_mul_f32 v250, v25, v250
    v_mul_f32 v251, v25, v251
    v_mul_f32 v252, v25, v252
    v_mul_f32 v253, v25, v253
    v_mul_f32 v254, v25, v254
    v_mul_f32 v255, v25, v255
    v_cvt_pk_bf16_f32 v60, v248, v249
    v_cvt_pk_bf16_f32 v61, v250, v251
    v_cvt_pk_bf16_f32 v62, v252, v253
    v_cvt_pk_bf16_f32 v63, v254, v255
    buffer_store_dwordx4 v[60:63], v7, s[16:19], s38 offen offset:3072 sc1
    s_cmp_eq_u64 s[52:53], 0
    s_cbranch_scc1 L_p3_done
    v_swap_b32 v128, v160
    v_swap_b32 v129, v161
    v_swap_b32 v130, v162
    v_swap_b32 v131, v163
    v_swap_b32 v132, v164
    v_swap_b32 v133, v165
    v_swap_b32 v134, v166
    v_swap_b32 v135, v167
    v_swap_b32 v136, v168
    v_swap_b32 v137, v169
    v_swap_b32 v138, v170
    v_swap_b32 v139, v171
    v_swap_b32 v140, v172
    v_swap_b32 v141, v173
    v_swap_b32 v142, v174
    v_swap_b32 v143, v175
    v_swap_b32 v144, v176
    v_swap_b32 v145, v177
    v_swap_b32 v146, v178
    v_swap_b32 v147, v179
    v_swap_b32 v148, v180
    v_swap_b32 v149, v181
    v_swap_b32 v150, v182
    v_swap_b32 v151, v183
    v_swap_b32 v152, v184
    v_swap_b32 v153, v185
    v_swap_b32 v154, v186
    v_swap_b32 v155, v187
    v_swap_b32 v156, v188
    v_swap_b32 v157, v189
    v_swap_b32 v158, v190
    v_swap_b32 v159, v191
    v_mov_b32 v192, 0
    v_mov_b32 v193, 0
    v_mov_b32 v194, 0
    v_mov_b32 v195, 0
    v_mov_b32 v196, 0
    v_mov_b32 v197, 0
    v_mov_b32 v198, 0
    v_mov_b32 v199, 0
    v_mov_b32 v200, 0
    v_mov_b32 v201, 0
    v_mov_b32 v202, 0
    v_mov_b32 v203, 0
    v_mov_b32 v204, 0
    v_mov_b32 v205, 0
    v_mov_b32 v206, 0
    v_mov_b32 v207, 0
    v_mov_b32 v208, 0
    v_mov_b32 v209, 0
    v_mov_b32 v210, 0
    v_mov_b32 v211, 0
    v_mov_b32 v212, 0
    v_mov_b32 v213, 0
    v_mov_b32 v214, 0
    v_mov_b32 v215, 0
    v_mov_b32 v216, 0
    v_mov_b32 v217, 0
    v_mov_b32 v218, 0
    v_mov_b32 v219, 0
    v_mov_b32 v220, 0
    v_mov_b32 v221, 0
    v_mov_b32 v222, 0
    v_mov_b32 v223, 0
    v_mov_b32 v224, 0
    v_mov_b32 v225, 0
    v_mov_b32 v226, 0
    v_mov_b32 v227, 0
    v_mov_b32 v228, 0
    v_mov_b32 v229, 0
    v_mov_b32 v230, 0
    v_mov_b32 v231, 0
    v_mov_b32 v232, 0
    v_mov_b32 v233, 0
    v_mov_b32 v234, 0
    v_mov_b32 v235, 0
    v_mov_b32 v236, 0
    v_mov_b32 v237, 0
    v_mov_b32 v238, 0
    v_mov_b32 v239, 0
    v_mov_b32 v240, 0
    v_mov_b32 v241, 0
    v_mov_b32 v242, 0
    v_mov_b32 v243, 0
    v_mov_b32 v244, 0
    v_mov_b32 v245, 0
    v_mov_b32 v246, 0
    v_mov_b32 v247, 0
    v_mov_b32 v248, 0
    v_mov_b32 v249, 0
    v_mov_b32 v250, 0
    v_mov_b32 v251, 0
    v_mov_b32 v252, 0
    v_mov_b32 v253, 0
    v_mov_b32 v254, 0
    v_mov_b32 v255, 0
    v_mov_b32 v38, 0
    v_mov_b32 v40, 4048155338
    v_mov_b32 v39, 0
    v_mov_b32 v41, 4048155338
    s_lshl_b32 s43, s28, 12
    v_add_u32 v4, s43, v7
    s_mov_b32 s46, s45
    s_sub_u32 s40, 16, s30
    s_mov_b32 s39, s30
    s_lshl_b32 s37, s39, 7
    s_and_b32 s36, s28, 3
    s_lshl_b32 s36, s36, 5
    s_add_u32 s36, s36, s37
    s_sub_u32 s50, 0, s36
L_recurrent_scan__compressed_kv_cla__moe_arch_mod__prompt_kernel_stile_185:
    s_waitcnt vmcnt(0) lgkmcnt(0)
    s_barrier
    s_mov_b32 m0, s43
    s_add_u32 s47, s46, 32768
    buffer_load_dwordx4 v4, s[12:15], s46 offen offset:0 sc1 lds
    buffer_load_dwordx4 v4, s[12:15], s46 offen offset:1024 sc1 lds
    buffer_load_dwordx4 v4, s[12:15], s46 offen offset:2048 sc1 lds
    buffer_load_dwordx4 v4, s[12:15], s46 offen offset:3072 sc1 lds
    s_add_u32 m0, s43, 32768
    s_add_u32 s46, s46, 65536
    buffer_load_dwordx4 v4, s[12:15], s47 offen offset:0 sc1 lds
    buffer_load_dwordx4 v4, s[12:15], s47 offen offset:1024 sc1 lds
    buffer_load_dwordx4 v4, s[12:15], s47 offen offset:2048 sc1 lds
    buffer_load_dwordx4 v4, s[12:15], s47 offen offset:3072 sc1 lds
    v_mov_b32 v2, v7
    s_mov_b32 s41, 4
    s_waitcnt vmcnt(0)
    s_barrier
L_recurrent_scan__compressed_kv_cla__moe_arch_mod__prompt_kernel_sunit_186:
    s_cmp_gt_i32 s50, 0
    s_cbranch_scc1 L_recurrent_scan__compressed_kv_cla__moe_arch_mod__prompt_kernel_snext_187
    ds_read_b128 v[64:67], v2 offset:0
    ds_read_b128 v[68:71], v2 offset:1024
    ds_read_b128 v[72:75], v2 offset:2048
    ds_read_b128 v[76:79], v2 offset:3072
    ds_read_b128 v[80:83], v2 offset:4096
    ds_read_b128 v[84:87], v2 offset:5120
    ds_read_b128 v[88:91], v2 offset:6144
    ds_read_b128 v[92:95], v2 offset:7168
    s_waitcnt lgkmcnt(0)
    v_mfma_f32_16x16x32_bf16 v[96:99], v[64:67], v[128:131], 0
    v_mfma_f32_16x16x32_bf16 v[104:107], v[64:67], v[144:147], 0
    v_mfma_f32_16x16x32_bf16 v[96:99], v[68:71], v[132:135], v[96:99]
    v_mfma_f32_16x16x32_bf16 v[104:107], v[68:71], v[148:151], v[104:107]
    v_mfma_f32_16x16x32_bf16 v[96:99], v[72:75], v[136:139], v[96:99]
    v_mfma_f32_16x16x32_bf16 v[104:107], v[72:75], v[152:155], v[104:107]
    v_mfma_f32_16x16x32_bf16 v[96:99], v[76:79], v[140:143], v[96:99]
    v_mfma_f32_16x16x32_bf16 v[104:107], v[76:79], v[156:159], v[104:107]
    v_mfma_f32_16x16x32_bf16 v[100:103], v[80:83], v[128:131], 0
    v_mfma_f32_16x16x32_bf16 v[108:111], v[80:83], v[144:147], 0
    v_mfma_f32_16x16x32_bf16 v[100:103], v[84:87], v[132:135], v[100:103]
    v_mfma_f32_16x16x32_bf16 v[108:111], v[84:87], v[148:151], v[108:111]
    v_mfma_f32_16x16x32_bf16 v[100:103], v[88:91], v[136:139], v[100:103]
    v_mfma_f32_16x16x32_bf16 v[108:111], v[88:91], v[152:155], v[108:111]
    v_mfma_f32_16x16x32_bf16 v[100:103], v[92:95], v[140:143], v[100:103]
    v_mfma_f32_16x16x32_bf16 v[108:111], v[92:95], v[156:159], v[108:111]
    ds_read_b128 v[64:67], v2 offset:32768
    ds_read_b128 v[68:71], v2 offset:33792
    ds_read_b128 v[72:75], v2 offset:34816
    ds_read_b128 v[76:79], v2 offset:35840
    ds_read_b128 v[80:83], v2 offset:36864
    ds_read_b128 v[84:87], v2 offset:37888
    ds_read_b128 v[88:91], v2 offset:38912
    ds_read_b128 v[92:95], v2 offset:39936
    s_nop 1
    s_cmp_lt_i32 s50, 0
    s_cbranch_scc0 L_recurrent_scan__compressed_kv_cla__moe_arch_mod__prompt_kernel_rare_188
L_recurrent_scan__compressed_kv_cla__moe_arch_mod__prompt_kernel_back_189:
    v_max3_f32 v22, v96, v97, v98
    v_max3_f32 v22, v22, v99, v100
    v_max3_f32 v22, v22, v101, v102
    v_max3_f32 v22, v22, v103, v40
    v_mov_b32 v24, v22
    s_nop 1
    v_permlane16_swap_b32 v22, v24
    s_nop 1
    v_max_f32 v22, v22, v24
    v_mov_b32 v24, v22
    s_nop 1
    v_permlane32_swap_b32 v22, v24
    s_nop 1
    v_max_f32 v22, v22, v24
    v_sub_f32 v25, v40, v22
    v_exp_f32 v25, v25
    v_mov_b32 v40, v22
    v_mul_f32 v38, v38, v25
    v_mul_f32 v192, v192, v25
    v_mul_f32 v193, v193, v25
    v_mul_f32 v194, v194, v25
    v_mul_f32 v195, v195, v25
    v_mul_f32 v196, v196, v25
    v_mul_f32 v197, v197, v25
    v_mul_f32 v198, v198, v25
    v_mul_f32 v199, v199, v25
    v_mul_f32 v200, v200, v25
    v_mul_f32 v201, v201, v25
    v_mul_f32 v202, v202, v25
    v_mul_f32 v203, v203, v25
    v_mul_f32 v204, v204, v25
    v_mul_f32 v205, v205, v25
    v_mul_f32 v206, v206, v25
    v_mul_f32 v207, v207, v25
    v_mul_f32 v208, v208, v25
    v_mul_f32 v209, v209, v25
    v_mul_f32 v210, v210, v25
    v_mul_f32 v211, v211, v25
    v_mul_f32 v212, v212, v25
    v_mul_f32 v213, v213, v25
    v_mul_f32 v214, v214, v25
    v_mul_f32 v215, v215, v25
    v_mul_f32 v216, v216, v25
    v_mul_f32 v217, v217, v25
    v_mul_f32 v218, v218, v25
    v_mul_f32 v219, v219, v25
    v_mul_f32 v220, v220, v25
    v_mul_f32 v221, v221, v25
    v_mul_f32 v222, v222, v25
    v_mul_f32 v223, v223, v25
    v_sub_f32 v96, v96, v22
    v_sub_f32 v97, v97, v22
    v_sub_f32 v98, v98, v22
    v_sub_f32 v99, v99, v22
    v_sub_f32 v100, v100, v22
    v_sub_f32 v101, v101, v22
    v_sub_f32 v102, v102, v22
    v_sub_f32 v103, v103, v22
    v_max3_f32 v23, v104, v105, v106
    v_max3_f32 v23, v23, v107, v108
    v_max3_f32 v23, v23, v109, v110
    v_max3_f32 v23, v23, v111, v41
    v_mov_b32 v24, v23
    s_nop 1
    v_permlane16_swap_b32 v23, v24
    s_nop 1
    v_max_f32 v23, v23, v24
    v_mov_b32 v24, v23
    s_nop 1
    v_permlane32_swap_b32 v23, v24
    s_nop 1
    v_max_f32 v23, v23, v24
    v_sub_f32 v25, v41, v23
    v_exp_f32 v25, v25
    v_mov_b32 v41, v23
    v_mul_f32 v39, v39, v25
    v_mul_f32 v224, v224, v25
    v_mul_f32 v225, v225, v25
    v_mul_f32 v226, v226, v25
    v_mul_f32 v227, v227, v25
    v_mul_f32 v228, v228, v25
    v_mul_f32 v229, v229, v25
    v_mul_f32 v230, v230, v25
    v_mul_f32 v231, v231, v25
    v_mul_f32 v232, v232, v25
    v_mul_f32 v233, v233, v25
    v_mul_f32 v234, v234, v25
    v_mul_f32 v235, v235, v25
    v_mul_f32 v236, v236, v25
    v_mul_f32 v237, v237, v25
    v_mul_f32 v238, v238, v25
    v_mul_f32 v239, v239, v25
    v_mul_f32 v240, v240, v25
    v_mul_f32 v241, v241, v25
    v_mul_f32 v242, v242, v25
    v_mul_f32 v243, v243, v25
    v_mul_f32 v244, v244, v25
    v_mul_f32 v245, v245, v25
    v_mul_f32 v246, v246, v25
    v_mul_f32 v247, v247, v25
    v_mul_f32 v248, v248, v25
    v_mul_f32 v249, v249, v25
    v_mul_f32 v250, v250, v25
    v_mul_f32 v251, v251, v25
    v_mul_f32 v252, v252, v25
    v_mul_f32 v253, v253, v25
    v_mul_f32 v254, v254, v25
    v_mul_f32 v255, v255, v25
    v_sub_f32 v104, v104, v23
    v_sub_f32 v105, v105, v23
    v_sub_f32 v106, v106, v23
    v_sub_f32 v107, v107, v23
    v_sub_f32 v108, v108, v23
    v_sub_f32 v109, v109, v23
    v_sub_f32 v110, v110, v23
    v_sub_f32 v111, v111, v23
    v_exp_f32 v96, v96
    v_exp_f32 v97, v97
    v_exp_f32 v98, v98
    v_exp_f32 v99, v99
    v_exp_f32 v104, v104
    v_exp_f32 v105, v105
    v_exp_f32 v106, v106
    v_exp_f32 v107, v107
    v_exp_f32 v100, v100
    v_exp_f32 v101, v101
    v_exp_f32 v102, v102
    v_exp_f32 v103, v103
    v_exp_f32 v108, v108
    v_exp_f32 v109, v109
    v_exp_f32 v110, v110
    v_exp_f32 v111, v111
    v_add_f32 v38, v38, v96
    v_add_f32 v38, v38, v97
    v_cvt_pk_bf16_f32 v48, v96, v97
    v_add_f32 v38, v38, v98
    v_add_f32 v38, v38, v99
    v_cvt_pk_bf16_f32 v49, v98, v99
    v_add_f32 v39, v39, v104
    v_add_f32 v39, v39, v105
    v_cvt_pk_bf16_f32 v52, v104, v105
    v_add_f32 v39, v39, v106
    v_add_f32 v39, v39, v107
    v_cvt_pk_bf16_f32 v53, v106, v107
    v_add_f32 v38, v38, v100
    v_add_f32 v38, v38, v101
    v_cvt_pk_bf16_f32 v50, v100, v101
    v_add_f32 v38, v38, v102
    v_add_f32 v38, v38, v103
    v_cvt_pk_bf16_f32 v51, v102, v103
    v_add_f32 v39, v39, v108
    v_add_f32 v39, v39, v109
    v_cvt_pk_bf16_f32 v54, v108, v109
    v_add_f32 v39, v39, v110
    v_add_f32 v39, v39, v111
    v_cvt_pk_bf16_f32 v55, v110, v111
    s_waitcnt lgkmcnt(0)
    s_nop 0
    v_mfma_f32_16x16x32_bf16 v[192:195], v[64:67], v[48:51], v[192:195]
    v_mfma_f32_16x16x32_bf16 v[224:227], v[64:67], v[52:55], v[224:227]
    v_mfma_f32_16x16x32_bf16 v[196:199], v[68:71], v[48:51], v[196:199]
    v_mfma_f32_16x16x32_bf16 v[228:231], v[68:71], v[52:55], v[228:231]
    v_mfma_f32_16x16x32_bf16 v[200:203], v[72:75], v[48:51], v[200:203]
    v_mfma_f32_16x16x32_bf16 v[232:235], v[72:75], v[52:55], v[232:235]
    v_mfma_f32_16x16x32_bf16 v[204:207], v[76:79], v[48:51], v[204:207]
    v_mfma_f32_16x16x32_bf16 v[236:239], v[76:79], v[52:55], v[236:239]
    v_mfma_f32_16x16x32_bf16 v[208:211], v[80:83], v[48:51], v[208:211]
    v_mfma_f32_16x16x32_bf16 v[240:243], v[80:83], v[52:55], v[240:243]
    v_mfma_f32_16x16x32_bf16 v[212:215], v[84:87], v[48:51], v[212:215]
    v_mfma_f32_16x16x32_bf16 v[244:247], v[84:87], v[52:55], v[244:247]
    v_mfma_f32_16x16x32_bf16 v[216:219], v[88:91], v[48:51], v[216:219]
    v_mfma_f32_16x16x32_bf16 v[248:251], v[88:91], v[52:55], v[248:251]
    v_mfma_f32_16x16x32_bf16 v[220:223], v[92:95], v[48:51], v[220:223]
    v_mfma_f32_16x16x32_bf16 v[252:255], v[92:95], v[52:55], v[252:255]
L_recurrent_scan__compressed_kv_cla__moe_arch_mod__prompt_kernel_snext_187:
    v_add_u32 v2, 8192, v2
    s_add_u32 s50, s50, 32
    s_sub_u32 s41, s41, 1
    s_cmp_lg_u32 s41, 0
    s_cbranch_scc1 L_recurrent_scan__compressed_kv_cla__moe_arch_mod__prompt_kernel_sunit_186
    s_sub_u32 s40, s40, 1
    s_cmp_lg_u32 s40, 0
    s_cbranch_scc1 L_recurrent_scan__compressed_kv_cla__moe_arch_mod__prompt_kernel_stile_185
    v_mov_b32 v20, v38
    s_nop 1
    v_permlane16_swap_b32 v38, v20
    s_nop 1
    v_add_f32 v38, v38, v20
    v_mov_b32 v20, v38
    s_nop 1
    v_permlane32_swap_b32 v38, v20
    s_nop 1
    v_add_f32 v38, v38, v20
    v_mov_b32 v20, v39
    s_nop 1
    v_permlane16_swap_b32 v39, v20
    s_nop 1
    v_add_f32 v39, v39, v20
    v_mov_b32 v20, v39
    s_nop 1
    v_permlane32_swap_b32 v39, v20
    s_nop 1
    v_add_f32 v39, v39, v20
    s_mov_b32 s36, 0x5d800000
    v_cmp_nge_f32 vcc, s36, v38
    s_nop 0
    s_or_b64 s[52:53], s[52:53], vcc
    v_cmp_nge_f32 vcc, s36, v39
    s_nop 0
    s_or_b64 s[52:53], s[52:53], vcc
    v_rcp_f32 v38, v38
    v_rcp_f32 v39, v39
    s_lshl_b32 s38, s39, 3
    s_and_b32 s37, s28, 3
    s_lshl_b32 s37, s37, 1
    s_add_u32 s38, s38, s37
    s_lshl_b32 s38, s38, 17
    s_lshl_b32 s37, s29, 12
    s_add_u32 s38, s38, s37
    v_mul_f32 v192, v38, v192
    v_mul_f32 v193, v38, v193
    v_mul_f32 v194, v38, v194
    v_mul_f32 v195, v38, v195
    v_mul_f32 v196, v38, v196
    v_mul_f32 v197, v38, v197
    v_mul_f32 v198, v38, v198
    v_mul_f32 v199, v38, v199
    v_cvt_pk_bf16_f32 v22, v192, v193
    v_cvt_pk_bf16_f32 v23, v194, v195
    v_cvt_pk_bf16_f32 v24, v196, v197
    v_cvt_pk_bf16_f32 v25, v198, v199
    buffer_store_dwordx4 v[22:25], v7, s[16:19], s38 offen offset:0 sc1
    v_mul_f32 v200, v38, v200
    v_mul_f32 v201, v38, v201
    v_mul_f32 v202, v38, v202
    v_mul_f32 v203, v38, v203
    v_mul_f32 v204, v38, v204
    v_mul_f32 v205, v38, v205
    v_mul_f32 v206, v38, v206
    v_mul_f32 v207, v38, v207
    v_cvt_pk_bf16_f32 v26, v200, v201
    v_cvt_pk_bf16_f32 v27, v202, v203
    v_cvt_pk_bf16_f32 v28, v204, v205
    v_cvt_pk_bf16_f32 v29, v206, v207
    buffer_store_dwordx4 v[26:29], v7, s[16:19], s38 offen offset:1024 sc1
    v_mul_f32 v208, v38, v208
    v_mul_f32 v209, v38, v209
    v_mul_f32 v210, v38, v210
    v_mul_f32 v211, v38, v211
    v_mul_f32 v212, v38, v212
    v_mul_f32 v213, v38, v213
    v_mul_f32 v214, v38, v214
    v_mul_f32 v215, v38, v215
    v_cvt_pk_bf16_f32 v30, v208, v209
    v_cvt_pk_bf16_f32 v31, v210, v211
    v_cvt_pk_bf16_f32 v32, v212, v213
    v_cvt_pk_bf16_f32 v33, v214, v215
    buffer_store_dwordx4 v[30:33], v7, s[16:19], s38 offen offset:2048 sc1
    v_mul_f32 v216, v38, v216
    v_mul_f32 v217, v38, v217
    v_mul_f32 v218, v38, v218
    v_mul_f32 v219, v38, v219
    v_mul_f32 v220, v38, v220
    v_mul_f32 v221, v38, v221
    v_mul_f32 v222, v38, v222
    v_mul_f32 v223, v38, v223
    v_cvt_pk_bf16_f32 v34, v216, v217
    v_cvt_pk_bf16_f32 v35, v218, v219
    v_cvt_pk_bf16_f32 v36, v220, v221
    v_cvt_pk_bf16_f32 v37, v222, v223
    buffer_store_dwordx4 v[34:37], v7, s[16:19], s38 offen offset:3072 sc1
    s_add_u32 s38, s38, 131072
    v_mul_f32 v224, v39, v224
    v_mul_f32 v225, v39, v225
    v_mul_f32 v226, v39, v226
    v_mul_f32 v227, v39, v227
    v_mul_f32 v228, v39, v228
    v_mul_f32 v229, v39, v229
    v_mul_f32 v230, v39, v230
    v_mul_f32 v231, v39, v231
    v_cvt_pk_bf16_f32 v22, v224, v225
    v_cvt_pk_bf16_f32 v23, v226, v227
    v_cvt_pk_bf16_f32 v24, v228, v229
    v_cvt_pk_bf16_f32 v25, v230, v231
    buffer_store_dwordx4 v[22:25], v7, s[16:19], s38 offen offset:0 sc1
    v_mul_f32 v232, v39, v232
    v_mul_f32 v233, v39, v233
    v_mul_f32 v234, v39, v234
    v_mul_f32 v235, v39, v235
    v_mul_f32 v236, v39, v236
    v_mul_f32 v237, v39, v237
    v_mul_f32 v238, v39, v238
    v_mul_f32 v239, v39, v239
    v_cvt_pk_bf16_f32 v26, v232, v233
    v_cvt_pk_bf16_f32 v27, v234, v235
    v_cvt_pk_bf16_f32 v28, v236, v237
    v_cvt_pk_bf16_f32 v29, v238, v239
    buffer_store_dwordx4 v[26:29], v7, s[16:19], s38 offen offset:1024 sc1
    v_mul_f32 v240, v39, v240
    v_mul_f32 v241, v39, v241
    v_mul_f32 v242, v39, v242
    v_mul_f32 v243, v39, v243
    v_mul_f32 v244, v39, v244
    v_mul_f32 v245, v39, v245
    v_mul_f32 v246, v39, v246
    v_mul_f32 v247, v39, v247
    v_cvt_pk_bf16_f32 v30, v240, v241
    v_cvt_pk_bf16_f32 v31, v242, v243
    v_cvt_pk_bf16_f32 v32, v244, v245
    v_cvt_pk_bf16_f32 v33, v246, v247
    buffer_store_dwordx4 v[30:33], v7, s[16:19], s38 offen offset:2048 sc1
    v_mul_f32 v248, v39, v248
    v_mul_f32 v249, v39, v249
    v_mul_f32 v250, v39, v250
    v_mul_f32 v251, v39, v251
    v_mul_f32 v252, v39, v252
    v_mul_f32 v253, v39, v253
    v_mul_f32 v254, v39, v254
    v_mul_f32 v255, v39, v255
    v_cvt_pk_bf16_f32 v34, v248, v249
    v_cvt_pk_bf16_f32 v35, v250, v251
    v_cvt_pk_bf16_f32 v36, v252, v253
    v_cvt_pk_bf16_f32 v37, v254, v255
    buffer_store_dwordx4 v[34:37], v7, s[16:19], s38 offen offset:3072 sc1
    s_branch L_p3_done
L_recurrent_scan__compressed_kv_cla__moe_arch_mod__prompt_kernel_rare_156:
    s_lshl_b32 s36, s29, 7
    v_mov_b32 v20, s36
    v_mov_b32 v21, 1
    s_mov_b64 exec, 1
    global_atomic_add v20, v21, s[90:91]
    s_mov_b64 exec, -1
    s_nop 3
    s_branch L_recurrent_scan__compressed_kv_cla__moe_arch_mod__prompt_kernel_back_157
L_recurrent_scan__compressed_kv_cla__moe_arch_mod__prompt_kernel_rare_158:
    v_mov_b32 v20, 4048155338
    v_subrev_u32 v21, s50, v18
    v_cmp_gt_i32 s[20:21], 0, v21
    v_cmp_gt_i32 s[22:23], 1, v21
    v_cmp_gt_i32 s[62:63], 2, v21
    v_cmp_gt_i32 vcc, 3, v21
    v_cndmask_b32 v96, v96, v20, s[20:21]
    v_cndmask_b32 v97, v97, v20, s[22:23]
    v_cndmask_b32 v98, v98, v20, s[62:63]
    v_cndmask_b32 v99, v99, v20, vcc
    v_cmp_gt_i32 s[20:21], 16, v21
    v_cmp_gt_i32 s[22:23], 17, v21
    v_cmp_gt_i32 s[62:63], 18, v21
    v_cmp_gt_i32 vcc, 19, v21
    v_cndmask_b32 v100, v100, v20, s[20:21]
    v_cndmask_b32 v101, v101, v20, s[22:23]
    v_cndmask_b32 v102, v102, v20, s[62:63]
    v_cndmask_b32 v103, v103, v20, vcc
    v_cmp_gt_i32 s[20:21], -16, v21
    v_cmp_gt_i32 s[22:23], -15, v21
    v_cmp_gt_i32 s[62:63], -14, v21
    v_cmp_gt_i32 vcc, -13, v21
    v_cndmask_b32 v104, v104, v20, s[20:21]
    v_cndmask_b32 v105, v105, v20, s[22:23]
    v_cndmask_b32 v106, v106, v20, s[62:63]
    v_cndmask_b32 v107, v107, v20, vcc
    v_cmp_gt_i32 s[20:21], 0, v21
    v_cmp_gt_i32 s[22:23], 1, v21
    v_cmp_gt_i32 s[62:63], 2, v21
    v_cmp_gt_i32 vcc, 3, v21
    v_cndmask_b32 v108, v108, v20, s[20:21]
    v_cndmask_b32 v109, v109, v20, s[22:23]
    v_cndmask_b32 v110, v110, v20, s[62:63]
    v_cndmask_b32 v111, v111, v20, vcc
    s_branch L_recurrent_scan__compressed_kv_cla__moe_arch_mod__prompt_kernel_back_159
L_recurrent_scan__compressed_kv_cla__moe_arch_mod__prompt_kernel_rare_161:
    v_mov_b32 v20, 4048155338
    v_subrev_u32 v21, s49, v18
    v_cmp_gt_i32 s[20:21], 0, v21
    v_cmp_gt_i32 s[22:23], 1, v21
    v_cmp_gt_i32 s[62:63], 2, v21
    v_cmp_gt_i32 vcc, 3, v21
    v_cndmask_b32 v112, v112, v20, s[20:21]
    v_cndmask_b32 v113, v113, v20, s[22:23]
    v_cndmask_b32 v114, v114, v20, s[62:63]
    v_cndmask_b32 v115, v115, v20, vcc
    v_cmp_gt_i32 s[20:21], 16, v21
    v_cmp_gt_i32 s[22:23], 17, v21
    v_cmp_gt_i32 s[62:63], 18, v21
    v_cmp_gt_i32 vcc, 19, v21
    v_cndmask_b32 v116, v116, v20, s[20:21]
    v_cndmask_b32 v117, v117, v20, s[22:23]
    v_cndmask_b32 v118, v118, v20, s[62:63]
    v_cndmask_b32 v119, v119, v20, vcc
    v_cmp_gt_i32 s[20:21], -16, v21
    v_cmp_gt_i32 s[22:23], -15, v21
    v_cmp_gt_i32 s[62:63], -14, v21
    v_cmp_gt_i32 vcc, -13, v21
    v_cndmask_b32 v120, v120, v20, s[20:21]
    v_cndmask_b32 v121, v121, v20, s[22:23]
    v_cndmask_b32 v122, v122, v20, s[62:63]
    v_cndmask_b32 v123, v123, v20, vcc
    v_cmp_gt_i32 s[20:21], 0, v21
    v_cmp_gt_i32 s[22:23], 1, v21
    v_cmp_gt_i32 s[62:63], 2, v21
    v_cmp_gt_i32 vcc, 3, v21
    v_cndmask_b32 v124, v124, v20, s[20:21]
    v_cndmask_b32 v125, v125, v20, s[22:23]
    v_cndmask_b32 v126, v126, v20, s[62:63]
    v_cndmask_b32 v127, v127, v20, vcc
    s_branch L_recurrent_scan__compressed_kv_cla__moe_arch_mod__prompt_kernel_back_162
L_recurrent_scan__compressed_kv_cla__moe_arch_mod__prompt_kernel_rare_163:
    v_mov_b32 v8, v38
    v_mov_b32 v9, v39
    v_mov_b32 v38, 0
    v_mov_b32 v39, 0
    s_branch L_recurrent_scan__compressed_kv_cla__moe_arch_mod__prompt_kernel_back_164
L_recurrent_scan__compressed_kv_cla__moe_arch_mod__prompt_kernel_rare_165:
    v_mov_b32 v20, 4048155338
    v_subrev_u32 v21, s50, v18
    v_cmp_gt_i32 s[20:21], 0, v21
    v_cmp_gt_i32 s[22:23], 1, v21
    v_cmp_gt_i32 s[62:63], 2, v21
    v_cmp_gt_i32 vcc, 3, v21
    v_cndmask_b32 v96, v96, v20, s[20:21]
    v_cndmask_b32 v97, v97, v20, s[22:23]
    v_cndmask_b32 v98, v98, v20, s[62:63]
    v_cndmask_b32 v99, v99, v20, vcc
    v_cmp_gt_i32 s[20:21], 16, v21
    v_cmp_gt_i32 s[22:23], 17, v21
    v_cmp_gt_i32 s[62:63], 18, v21
    v_cmp_gt_i32 vcc, 19, v21
    v_cndmask_b32 v100, v100, v20, s[20:21]
    v_cndmask_b32 v101, v101, v20, s[22:23]
    v_cndmask_b32 v102, v102, v20, s[62:63]
    v_cndmask_b32 v103, v103, v20, vcc
    v_cmp_gt_i32 s[20:21], -16, v21
    v_cmp_gt_i32 s[22:23], -15, v21
    v_cmp_gt_i32 s[62:63], -14, v21
    v_cmp_gt_i32 vcc, -13, v21
    v_cndmask_b32 v104, v104, v20, s[20:21]
    v_cndmask_b32 v105, v105, v20, s[22:23]
    v_cndmask_b32 v106, v106, v20, s[62:63]
    v_cndmask_b32 v107, v107, v20, vcc
    v_cmp_gt_i32 s[20:21], 0, v21
    v_cmp_gt_i32 s[22:23], 1, v21
    v_cmp_gt_i32 s[62:63], 2, v21
    v_cmp_gt_i32 vcc, 3, v21
    v_cndmask_b32 v108, v108, v20, s[20:21]
    v_cndmask_b32 v109, v109, v20, s[22:23]
    v_cndmask_b32 v110, v110, v20, s[62:63]
    v_cndmask_b32 v111, v111, v20, vcc
    s_branch L_recurrent_scan__compressed_kv_cla__moe_arch_mod__prompt_kernel_back_166
L_recurrent_scan__compressed_kv_cla__moe_arch_mod__prompt_kernel_rare_168:
    v_mov_b32 v20, 4048155338
    v_subrev_u32 v21, s49, v18
    v_cmp_gt_i32 s[20:21], 0, v21
    v_cmp_gt_i32 s[22:23], 1, v21
    v_cmp_gt_i32 s[62:63], 2, v21
    v_cmp_gt_i32 vcc, 3, v21
    v_cndmask_b32 v112, v112, v20, s[20:21]
    v_cndmask_b32 v113, v113, v20, s[22:23]
    v_cndmask_b32 v114, v114, v20, s[62:63]
    v_cndmask_b32 v115, v115, v20, vcc
    v_cmp_gt_i32 s[20:21], 16, v21
    v_cmp_gt_i32 s[22:23], 17, v21
    v_cmp_gt_i32 s[62:63], 18, v21
    v_cmp_gt_i32 vcc, 19, v21
    v_cndmask_b32 v116, v116, v20, s[20:21]
    v_cndmask_b32 v117, v117, v20, s[22:23]
    v_cndmask_b32 v118, v118, v20, s[62:63]
    v_cndmask_b32 v119, v119, v20, vcc
    v_cmp_gt_i32 s[20:21], -16, v21
    v_cmp_gt_i32 s[22:23], -15, v21
    v_cmp_gt_i32 s[62:63], -14, v21
    v_cmp_gt_i32 vcc, -13, v21
    v_cndmask_b32 v120, v120, v20, s[20:21]
    v_cndmask_b32 v121, v121, v20, s[22:23]
    v_cndmask_b32 v122, v122, v20, s[62:63]
    v_cndmask_b32 v123, v123, v20, vcc
    v_cmp_gt_i32 s[20:21], 0, v21
    v_cmp_gt_i32 s[22:23], 1, v21
    v_cmp_gt_i32 s[62:63], 2, v21
    v_cmp_gt_i32 vcc, 3, v21
    v_cndmask_b32 v124, v124, v20, s[20:21]
    v_cndmask_b32 v125, v125, v20, s[22:23]
    v_cndmask_b32 v126, v126, v20, s[62:63]
    v_cndmask_b32 v127, v127, v20, vcc
    s_branch L_recurrent_scan__compressed_kv_cla__moe_arch_mod__prompt_kernel_back_169
L_recurrent_scan__compressed_kv_cla__moe_arch_mod__prompt_kernel_rare_170:
    s_cmp_lg_u32 s40, s51
    s_cbranch_scc1 L_recurrent_scan__compressed_kv_cla__moe_arch_mod__prompt_kernel_epi_172
    v_swap_b32 v128, v160
    v_swap_b32 v129, v161
    v_swap_b32 v130, v162
    v_swap_b32 v131, v163
    v_swap_b32 v132, v164
    v_swap_b32 v133, v165
    v_swap_b32 v134, v166
    v_swap_b32 v135, v167
    v_swap_b32 v136, v168
    v_swap_b32 v137, v169
    v_swap_b32 v138, v170
    v_swap_b32 v139, v171
    v_swap_b32 v140, v172
    v_swap_b32 v141, v173
    v_swap_b32 v142, v174
    v_swap_b32 v143, v175
    v_swap_b32 v144, v176
    v_swap_b32 v145, v177
    v_swap_b32 v146, v178
    v_swap_b32 v147, v179
    v_swap_b32 v148, v180
    v_swap_b32 v149, v181
    v_swap_b32 v150, v182
    v_swap_b32 v151, v183
    v_swap_b32 v152, v184
    v_swap_b32 v153, v185
    v_swap_b32 v154, v186
    v_swap_b32 v155, v187
    v_swap_b32 v156, v188
    v_swap_b32 v157, v189
    v_swap_b32 v158, v190
    v_swap_b32 v159, v191
    v_mov_b32 v40, v14
    v_mov_b32 v41, v14
    v_mov_b32 v42, v14
    v_mov_b32 v43, v14
    v_mov_b32 v44, v15
    v_mov_b32 v45, v15
    v_mov_b32 v46, v15
    v_mov_b32 v47, v15
    s_nop 1
    s_branch L_recurrent_scan__compressed_kv_cla__moe_arch_mod__prompt_kernel_back_171
L_recurrent_scan__compressed_kv_cla__moe_arch_mod__prompt_kernel_epi_172:
    v_mov_b32 v20, v8
    s_nop 1
    v_permlane16_swap_b32 v8, v20
    s_nop 1
    v_add_f32 v8, v8, v20
    v_mov_b32 v20, v8
    s_nop 1
    v_permlane32_swap_b32 v8, v20
    s_nop 1
    v_add_f32 v8, v8, v20
    v_mov_b32 v20, v9
    s_nop 1
    v_permlane16_swap_b32 v9, v20
    s_nop 1
    v_add_f32 v9, v9, v20
    v_mov_b32 v20, v9
    s_nop 1
    v_permlane32_swap_b32 v9, v20
    s_nop 1
    v_add_f32 v9, v9, v20
    s_mov_b32 s36, 0x5d800000
    v_cmp_nge_f32 vcc, s36, v8
    s_nop 0
    s_or_b64 s[52:53], s[52:53], vcc
    v_cmp_nge_f32 vcc, s36, v9
    s_nop 0
    s_or_b64 s[52:53], s[52:53], vcc
    v_rcp_f32 v8, v8
    v_rcp_f32 v9, v9
    s_lshl_b32 s38, s30, 3
    s_and_b32 s37, s28, 3
    s_lshl_b32 s37, s37, 1
    s_add_u32 s38, s38, s37
    s_lshl_b32 s38, s38, 17
    s_lshl_b32 s37, s29, 12
    s_add_u32 s38, s38, s37
    v_mul_f32 v192, v8, v192
    v_mul_f32 v193, v8, v193
    v_mul_f32 v194, v8, v194
    v_mul_f32 v195, v8, v195
    v_mul_f32 v196, v8, v196
    v_mul_f32 v197, v8, v197
    v_mul_f32 v198, v8, v198
    v_mul_f32 v199, v8, v199
    v_cvt_pk_bf16_f32 v22, v192, v193
    v_cvt_pk_bf16_f32 v23, v194, v195
    v_cvt_pk_bf16_f32 v24, v196, v197
    v_cvt_pk_bf16_f32 v25, v198, v199
    buffer_store_dwordx4 v[22:25], v7, s[16:19], s38 offen offset:0 sc1
    v_mov_b32 v192, 0
    v_mov_b32 v193, 0
    v_mov_b32 v194, 0
    v_mov_b32 v195, 0
    v_mov_b32 v196, 0
    v_mov_b32 v197, 0
    v_mov_b32 v198, 0
    v_mov_b32 v199, 0
    v_mul_f32 v200, v8, v200
    v_mul_f32 v201, v8, v201
    v_mul_f32 v202, v8, v202
    v_mul_f32 v203, v8, v203
    v_mul_f32 v204, v8, v204
    v_mul_f32 v205, v8, v205
    v_mul_f32 v206, v8, v206
    v_mul_f32 v207, v8, v207
    v_cvt_pk_bf16_f32 v26, v200, v201
    v_cvt_pk_bf16_f32 v27, v202, v203
    v_cvt_pk_bf16_f32 v28, v204, v205
    v_cvt_pk_bf16_f32 v29, v206, v207
    buffer_store_dwordx4 v[26:29], v7, s[16:19], s38 offen offset:1024 sc1
    v_mov_b32 v200, 0
    v_mov_b32 v201, 0
    v_mov_b32 v202, 0
    v_mov_b32 v203, 0
    v_mov_b32 v204, 0
    v_mov_b32 v205, 0
    v_mov_b32 v206, 0
    v_mov_b32 v207, 0
    v_mul_f32 v208, v8, v208
    v_mul_f32 v209, v8, v209
    v_mul_f32 v210, v8, v210
    v_mul_f32 v211, v8, v211
    v_mul_f32 v212, v8, v212
    v_mul_f32 v213, v8, v213
    v_mul_f32 v214, v8, v214
    v_mul_f32 v215, v8, v215
    v_cvt_pk_bf16_f32 v30, v208, v209
    v_cvt_pk_bf16_f32 v31, v210, v211
    v_cvt_pk_bf16_f32 v32, v212, v213
    v_cvt_pk_bf16_f32 v33, v214, v215
    buffer_store_dwordx4 v[30:33], v7, s[16:19], s38 offen offset:2048 sc1
    v_mov_b32 v208, 0
    v_mov_b32 v209, 0
    v_mov_b32 v210, 0
    v_mov_b32 v211, 0
    v_mov_b32 v212, 0
    v_mov_b32 v213, 0
    v_mov_b32 v214, 0
    v_mov_b32 v215, 0
    v_mul_f32 v216, v8, v216
    v_mul_f32 v217, v8, v217
    v_mul_f32 v218, v8, v218
    v_mul_f32 v219, v8, v219
    v_mul_f32 v220, v8, v220
    v_mul_f32 v221, v8, v221
    v_mul_f32 v222, v8, v222
    v_mul_f32 v223, v8, v223
    v_cvt_pk_bf16_f32 v34, v216, v217
    v_cvt_pk_bf16_f32 v35, v218, v219
    v_cvt_pk_bf16_f32 v36, v220, v221
    v_cvt_pk_bf16_f32 v37, v222, v223
    buffer_store_dwordx4 v[34:37], v7, s[16:19], s38 offen offset:3072 sc1
    v_mov_b32 v216, 0
    v_mov_b32 v217, 0
    v_mov_b32 v218, 0
    v_mov_b32 v219, 0
    v_mov_b32 v220, 0
    v_mov_b32 v221, 0
    v_mov_b32 v222, 0
    v_mov_b32 v223, 0
    s_add_u32 s38, s38, 131072
    v_mul_f32 v224, v9, v224
    v_mul_f32 v225, v9, v225
    v_mul_f32 v226, v9, v226
    v_mul_f32 v227, v9, v227
    v_mul_f32 v228, v9, v228
    v_mul_f32 v229, v9, v229
    v_mul_f32 v230, v9, v230
    v_mul_f32 v231, v9, v231
    v_cvt_pk_bf16_f32 v22, v224, v225
    v_cvt_pk_bf16_f32 v23, v226, v227
    v_cvt_pk_bf16_f32 v24, v228, v229
    v_cvt_pk_bf16_f32 v25, v230, v231
    buffer_store_dwordx4 v[22:25], v7, s[16:19], s38 offen offset:0 sc1
    v_mov_b32 v224, 0
    v_mov_b32 v225, 0
    v_mov_b32 v226, 0
    v_mov_b32 v227, 0
    v_mov_b32 v228, 0
    v_mov_b32 v229, 0
    v_mov_b32 v230, 0
    v_mov_b32 v231, 0
    v_mul_f32 v232, v9, v232
    v_mul_f32 v233, v9, v233
    v_mul_f32 v234, v9, v234
    v_mul_f32 v235, v9, v235
    v_mul_f32 v236, v9, v236
    v_mul_f32 v237, v9, v237
    v_mul_f32 v238, v9, v238
    v_mul_f32 v239, v9, v239
    v_cvt_pk_bf16_f32 v26, v232, v233
    v_cvt_pk_bf16_f32 v27, v234, v235
    v_cvt_pk_bf16_f32 v28, v236, v237
    v_cvt_pk_bf16_f32 v29, v238, v239
    buffer_store_dwordx4 v[26:29], v7, s[16:19], s38 offen offset:1024 sc1
    v_mov_b32 v232, 0
    v_mov_b32 v233, 0
    v_mov_b32 v234, 0
    v_mov_b32 v235, 0
    v_mov_b32 v236, 0
    v_mov_b32 v237, 0
    v_mov_b32 v238, 0
    v_mov_b32 v239, 0
    v_mul_f32 v240, v9, v240
    v_mul_f32 v241, v9, v241
    v_mul_f32 v242, v9, v242
    v_mul_f32 v243, v9, v243
    v_mul_f32 v244, v9, v244
    v_mul_f32 v245, v9, v245
    v_mul_f32 v246, v9, v246
    v_mul_f32 v247, v9, v247
    v_cvt_pk_bf16_f32 v30, v240, v241
    v_cvt_pk_bf16_f32 v31, v242, v243
    v_cvt_pk_bf16_f32 v32, v244, v245
    v_cvt_pk_bf16_f32 v33, v246, v247
    buffer_store_dwordx4 v[30:33], v7, s[16:19], s38 offen offset:2048 sc1
    v_mov_b32 v240, 0
    v_mov_b32 v241, 0
    v_mov_b32 v242, 0
    v_mov_b32 v243, 0
    v_mov_b32 v244, 0
    v_mov_b32 v245, 0
    v_mov_b32 v246, 0
    v_mov_b32 v247, 0
    v_mul_f32 v248, v9, v248
    v_mul_f32 v249, v9, v249
    v_mul_f32 v250, v9, v250
    v_mul_f32 v251, v9, v251
    v_mul_f32 v252, v9, v252
    v_mul_f32 v253, v9, v253
    v_mul_f32 v254, v9, v254
    v_mul_f32 v255, v9, v255
    v_cvt_pk_bf16_f32 v34, v248, v249
    v_cvt_pk_bf16_f32 v35, v250, v251
    v_cvt_pk_bf16_f32 v36, v252, v253
    v_cvt_pk_bf16_f32 v37, v254, v255
    buffer_store_dwordx4 v[34:37], v7, s[16:19], s38 offen offset:3072 sc1
    v_mov_b32 v248, 0
    v_mov_b32 v249, 0
    v_mov_b32 v250, 0
    v_mov_b32 v251, 0
    v_mov_b32 v252, 0
    v_mov_b32 v253, 0
    v_mov_b32 v254, 0
    v_mov_b32 v255, 0
    s_branch L_recurrent_scan__compressed_kv_cla__moe_arch_mod__prompt_kernel_back_171
L_recurrent_scan__compressed_kv_cla__moe_arch_mod__prompt_kernel_rare_183:
    s_cmp_eq_u32 s40, 1
    s_cbranch_scc0 L_recurrent_scan__compressed_kv_cla__moe_arch_mod__prompt_kernel_nm_173
    ds_read_b64 v[14:15], v19
    s_waitcnt lgkmcnt(0)
L_recurrent_scan__compressed_kv_cla__moe_arch_mod__prompt_kernel_nm_173:
    s_cmp_eq_u32 s39, 2
    s_cbranch_scc1 L_recurrent_scan__compressed_kv_cla__moe_arch_mod__prompt_kernel_bt_174
    s_waitcnt vmcnt(3)
    s_cmp_eq_u32 s40, 1
    s_cbranch_scc0 L_recurrent_scan__compressed_kv_cla__moe_arch_mod__prompt_kernel_swn_176
    v_add_u32 v11, 0, v13
    v_min_u32 v11, 7339904, v11
    s_mov_b32 exec_hi, 0
    global_load_dword v10, v11, s[8:9]
    s_mov_b32 exec_hi, -1
    s_nop 1
    s_branch L_recurrent_scan__compressed_kv_cla__moe_arch_mod__prompt_kernel_swend_175
L_recurrent_scan__compressed_kv_cla__moe_arch_mod__prompt_kernel_swn_176:
    s_cmp_eq_u32 s40, 2
    s_cbranch_scc0 L_recurrent_scan__compressed_kv_cla__moe_arch_mod__prompt_kernel_swn_177
    v_add_u32 v11, 4096, v13
    v_min_u32 v11, 7339904, v11
    s_mov_b32 exec_hi, 0
    global_load_dword v12, v11, s[8:9]
    s_mov_b32 exec_hi, -1
    s_nop 1
    s_branch L_recurrent_scan__compressed_kv_cla__moe_arch_mod__prompt_kernel_swend_175
L_recurrent_scan__compressed_kv_cla__moe_arch_mod__prompt_kernel_swn_177:
    s_cmp_eq_u32 s40, 3
    s_cbranch_scc0 L_recurrent_scan__compressed_kv_cla__moe_arch_mod__prompt_kernel_swn_178
    v_add_u32 v11, 8192, v13
    v_min_u32 v11, 7339904, v11
    s_mov_b32 exec_hi, 0
    global_load_dword v16, v11, s[8:9]
    s_mov_b32 exec_hi, -1
    s_nop 1
    s_branch L_recurrent_scan__compressed_kv_cla__moe_arch_mod__prompt_kernel_swend_175
L_recurrent_scan__compressed_kv_cla__moe_arch_mod__prompt_kernel_swn_178:
    s_cmp_eq_u32 s40, 4
    s_cbranch_scc0 L_recurrent_scan__compressed_kv_cla__moe_arch_mod__prompt_kernel_swn_179
    v_add_u32 v11, 12288, v13
    v_min_u32 v11, 7339904, v11
    s_mov_b32 exec_hi, 0
    global_load_dword v17, v11, s[8:9]
    s_mov_b32 exec_hi, -1
    s_nop 1
    s_branch L_recurrent_scan__compressed_kv_cla__moe_arch_mod__prompt_kernel_swend_175
L_recurrent_scan__compressed_kv_cla__moe_arch_mod__prompt_kernel_swn_179:
    s_cmp_eq_u32 s40, 5
    s_cbranch_scc0 L_recurrent_scan__compressed_kv_cla__moe_arch_mod__prompt_kernel_swn_180
    v_add_u32 v11, 0, v13
    v_min_u32 v11, 8388480, v11
    s_mov_b32 exec_hi, 0
    global_load_dword v10, v11, s[4:5]
    s_mov_b32 exec_hi, -1
    s_nop 1
    s_branch L_recurrent_scan__compressed_kv_cla__moe_arch_mod__prompt_kernel_swend_175
L_recurrent_scan__compressed_kv_cla__moe_arch_mod__prompt_kernel_swn_180:
    s_cmp_eq_u32 s40, 6
    s_cbranch_scc0 L_recurrent_scan__compressed_kv_cla__moe_arch_mod__prompt_kernel_swn_181
    v_add_u32 v11, 4096, v13
    v_min_u32 v11, 8388480, v11
    s_mov_b32 exec_hi, 0
    global_load_dword v12, v11, s[4:5]
    s_mov_b32 exec_hi, -1
    s_nop 1
    s_branch L_recurrent_scan__compressed_kv_cla__moe_arch_mod__prompt_kernel_swend_175
L_recurrent_scan__compressed_kv_cla__moe_arch_mod__prompt_kernel_swn_181:
    s_cmp_eq_u32 s40, 7
    s_cbranch_scc0 L_recurrent_scan__compressed_kv_cla__moe_arch_mod__prompt_kernel_swn_182
    v_add_u32 v11, 8192, v13
    v_min_u32 v11, 8388480, v11
    s_mov_b32 exec_hi, 0
    global_load_dword v16, v11, s[4:5]
    s_mov_b32 exec_hi, -1
    s_nop 1
    s_branch L_recurrent_scan__compressed_kv_cla__moe_arch_mod__prompt_kernel_swend_175
L_recurrent_scan__compressed_kv_cla__moe_arch_mod__prompt_kernel_swn_182:
    v_add_u32 v11, 12288, v13
    v_min_u32 v11, 8388480, v11
    s_mov_b32 exec_hi, 0
    global_load_dword v17, v11, s[4:5]
    s_mov_b32 exec_hi, -1
    s_nop 1
L_recurrent_scan__compressed_kv_cla__moe_arch_mod__prompt_kernel_swend_175:
L_recurrent_scan__compressed_kv_cla__moe_arch_mod__prompt_kernel_bt_174:
    s_branch L_recurrent_scan__compressed_kv_cla__moe_arch_mod__prompt_kernel_back_184
L_recurrent_scan__compressed_kv_cla__moe_arch_mod__prompt_kernel_rare_188:
    v_mov_b32 v20, 4048155338
    v_subrev_u32 v21, s50, v18
    v_cmp_gt_i32 s[20:21], 0, v21
    v_cmp_gt_i32 s[22:23], 1, v21
    v_cmp_gt_i32 s[62:63], 2, v21
    v_cmp_gt_i32 vcc, 3, v21
    v_cndmask_b32 v96, v96, v20, s[20:21]
    v_cndmask_b32 v97, v97, v20, s[22:23]
    v_cndmask_b32 v98, v98, v20, s[62:63]
    v_cndmask_b32 v99, v99, v20, vcc
    v_cmp_gt_i32 s[20:21], 16, v21
    v_cmp_gt_i32 s[22:23], 17, v21
    v_cmp_gt_i32 s[62:63], 18, v21
    v_cmp_gt_i32 vcc, 19, v21
    v_cndmask_b32 v100, v100, v20, s[20:21]
    v_cndmask_b32 v101, v101, v20, s[22:23]
    v_cndmask_b32 v102, v102, v20, s[62:63]
    v_cndmask_b32 v103, v103, v20, vcc
    v_cmp_gt_i32 s[20:21], -16, v21
    v_cmp_gt_i32 s[22:23], -15, v21
    v_cmp_gt_i32 s[62:63], -14, v21
    v_cmp_gt_i32 vcc, -13, v21
    v_cndmask_b32 v104, v104, v20, s[20:21]
    v_cndmask_b32 v105, v105, v20, s[22:23]
    v_cndmask_b32 v106, v106, v20, s[62:63]
    v_cndmask_b32 v107, v107, v20, vcc
    v_cmp_gt_i32 s[20:21], 0, v21
    v_cmp_gt_i32 s[22:23], 1, v21
    v_cmp_gt_i32 s[62:63], 2, v21
    v_cmp_gt_i32 vcc, 3, v21
    v_cndmask_b32 v108, v108, v20, s[20:21]
    v_cndmask_b32 v109, v109, v20, s[22:23]
    v_cndmask_b32 v110, v110, v20, s[62:63]
    v_cndmask_b32 v111, v111, v20, vcc
    s_branch L_recurrent_scan__compressed_kv_cla__moe_arch_mod__prompt_kernel_back_189
L_p3_done:
    s_waitcnt vmcnt(4)
    s_and_b32 s36, s2, 7
    s_lshl_b32 s36, s36, 2
    s_sub_u32 s40, 47, s30
    s_lshl_b32 s40, s40, 7
    s_add_u32 s40, s40, s36
    s_add_u32 s41, s30, 32
    s_lshl_b32 s41, s41, 7
    s_add_u32 s41, s41, s36
    v_mov_b32 v30, v11
    v_mov_b32 v31, v12
    s_and_b32 s63, s30, 1
    s_bfe_u32 s36, s2, 0x10002
    s_lshl_b32 s36, s36, 3
    s_add_u32 s30, s30, s36
    s_and_b32 s29, s29, 15
    s_and_b32 s36, s28, 3
    s_lshl_b32 s37, s29, 2
    s_add_u32 s36, s36, s37
    s_lshl_b32 s36, s36, 18
    s_lshr_b32 s37, s28, 2
    s_lshl_b32 s37, s37, 12
    s_add_u32 s36, s36, s37
    s_lshl_b32 s37, s63, 16
    s_add_u32 s36, s36, s37
    v_lshl_add_u32 v2, v1, 4, s36
    v_add_u32 v3, 131072, v2
    v_lshrrev_b32 v19, 4, v1
    s_lshl_b32 s36, s28, 5
    s_lshl_b32 s37, s63, 11
    s_add_u32 s36, s36, s37
    v_add_u32 v18, s36, v19
    v_lshlrev_b32 v18, 11, v18
    s_lshr_b32 s36, s30, 1
    s_lshl_b32 s36, s36, 8
    v_add_u32 v18, s36, v18
    v_lshlrev_b32 v20, 1, v19
    v_and_b32 v21, 15, v1
    v_xor_b32 v20, v20, v21
    v_lshl_add_u32 v6, v20, 4, v18
    v_xor_b32 v20, 8, v20
    v_lshl_add_u32 v7, v20, 4, v18
    v_add_u32 v7, 7168, v7
    v_add_u32 v8, 14336, v6
    v_add_u32 v9, 14336, v7
    s_lshl_b32 s33, s28, 13
    s_add_u32 s36, s2, 1
    s_and_b32 s62, s36, 3
    s_lshl_b32 s31, s62, 14
    s_lshl_b32 s32, s62, 20
    s_waitcnt vmcnt(0)
    s_barrier
    s_cmp_eq_u32 s28, 0
    s_cbranch_scc1 L_recurrent_scan__compressed_kv_cla__moe_arch_mod__prompt_kernel_rare_190
L_recurrent_scan__compressed_kv_cla__moe_arch_mod__prompt_kernel_back_191:
    s_mov_b32 s34, s33
    s_add_u32 m0, s34, 65536
    s_nop 0
    buffer_load_dwordx4 v6, s[8:11], s32 offen offset:0 lds
    buffer_load_dwordx4 v7, s[8:11], s32 offen offset:1024 lds
    buffer_load_dwordx4 v8, s[8:11], s32 offen offset:2048 lds
    buffer_load_dwordx4 v9, s[8:11], s32 offen offset:3072 lds
    s_add_u32 m0, s34, 69632
    s_add_u32 s37, s32, 32768
    buffer_load_dwordx4 v6, s[8:11], s37 offen offset:0 lds
    buffer_load_dwordx4 v7, s[8:11], s37 offen offset:1024 lds
    buffer_load_dwordx4 v8, s[8:11], s37 offen offset:2048 lds
    buffer_load_dwordx4 v9, s[8:11], s37 offen offset:3072 lds
    s_add_u32 s32, s32, 524288
    s_and_b32 s32, s32, 0x3fffff
    s_add_u32 m0, s34, 0
    s_nop 0
    buffer_load_dwordx4 v6, s[8:11], s32 offen offset:0 lds
    buffer_load_dwordx4 v7, s[8:11], s32 offen offset:1024 lds
    buffer_load_dwordx4 v8, s[8:11], s32 offen offset:2048 lds
    buffer_load_dwordx4 v9, s[8:11], s32 offen offset:3072 lds
    s_add_u32 m0, s34, 4096
    s_add_u32 s37, s32, 32768
    buffer_load_dwordx4 v6, s[8:11], s37 offen offset:0 lds
    buffer_load_dwordx4 v7, s[8:11], s37 offen offset:1024 lds
    buffer_load_dwordx4 v8, s[8:11], s37 offen offset:2048 lds
    buffer_load_dwordx4 v9, s[8:11], s37 offen offset:3072 lds
    s_mov_b32 s10, 0
    s_mov_b32 s34, 0x30000
    s_add_u32 s4, s54, 41943040
    s_addc_u32 s5, s55, 0
    s_and_b32 s5, s5, 0xffff
    s_mov_b32 s6, 16777216
    s_mov_b32 s7, 0x20000
    s_mov_b32 s16, s96
    s_and_b32 s17, s97, 0xffff
    s_mov_b32 s18, 4194304
    s_mov_b32 s19, 0x20000
    s_mov_b32 s20, s98
    s_and_b32 s21, s99, 0xffff
    s_mov_b32 s22, 4194304
    s_mov_b32 s23, 0x20000
    v_readfirstlane_b32 s36, v30
    s_nop 0
    s_cmp_lt_u32 s36, 28
    s_cbranch_scc1 L_recurrent_scan__compressed_kv_cla__moe_arch_mod__prompt_kernel_rare_212
L_recurrent_scan__compressed_kv_cla__moe_arch_mod__prompt_kernel_back_213:
    s_lshr_b32 s36, s2, 4
    s_mul_i32 s36, s36, 224
    s_min_u32 s37, s28, 6
    s_lshl_b32 s37, s37, 5
    s_add_u32 s36, s36, s37
    s_lshl_b32 s36, s36, 2
    s_add_u32 s36, s36, 58720256
    v_and_b32 v26, 15, v1
    v_mul_u32_u24 v26, 14336, v26
    v_lshl_add_u32 v26, v19, 5, v26
    buffer_load_dwordx4 v[96:99], v26, s[24:27], s36 offen offset:0 sc1
    buffer_load_dwordx4 v[100:103], v26, s[24:27], s36 offen offset:16 sc1
    s_lshl_b32 s36, s29, 7
    s_and_b32 s37, s28, 3
    s_lshl_b32 s37, s37, 5
    s_add_u32 s36, s36, s37
    s_lshr_b32 s37, s28, 2
    s_lshl_b32 s37, s37, 4
    s_add_u32 s38, s36, s37
    v_and_b32 v14, 15, v1
    v_add_u32 v14, s38, v14
    v_lshlrev_b32 v15, 11, v14
    v_lshl_add_u32 v15, v19, 3, v15
    s_lshl_b32 s36, s30, 7
    v_add_u32 v15, s36, v15
    v_lshlrev_b32 v16, 3, v14
    v_bfe_u32 v20, v1, 2, 2
    v_lshl_add_u32 v18, v19, 2, v20
    v_and_b32 v20, 7, v18
    v_lshlrev_b32 v18, 8, v18
    s_lshr_b32 s36, s28, 2
    s_lshl_b32 s36, s36, 15
    s_add_u32 s36, s36, 65536
    v_add_u32 v18, s36, v18
    v_and_b32 v21, 3, v1
    v_lshl_add_u32 v18, v21, 3, v18
    v_xor_b32 v21, 0, v20
    v_lshl_add_u32 v50, v21, 5, v18
    v_xor_b32 v21, 1, v20
    v_lshl_add_u32 v51, v21, 5, v18
    v_xor_b32 v21, 2, v20
    v_lshl_add_u32 v52, v21, 5, v18
    v_xor_b32 v21, 3, v20
    v_lshl_add_u32 v53, v21, 5, v18
    v_xor_b32 v21, 4, v20
    v_lshl_add_u32 v54, v21, 5, v18
    v_xor_b32 v21, 5, v20
    v_lshl_add_u32 v55, v21, 5, v18
    v_xor_b32 v21, 6, v20
    v_lshl_add_u32 v56, v21, 5, v18
    v_xor_b32 v21, 7, v20
    v_lshl_add_u32 v57, v21, 5, v18
    v_mov_b32 v192, 0
    v_mov_b32 v193, 0
    v_mov_b32 v194, 0
    v_mov_b32 v195, 0
    v_mov_b32 v196, 0
    v_mov_b32 v197, 0
    v_mov_b32 v198, 0
    v_mov_b32 v199, 0
    v_mov_b32 v200, 0
    v_mov_b32 v201, 0
    v_mov_b32 v202, 0
    v_mov_b32 v203, 0
    v_mov_b32 v204, 0
    v_mov_b32 v205, 0
    v_mov_b32 v206, 0
    v_mov_b32 v207, 0
    v_mov_b32 v208, 0
    v_mov_b32 v209, 0
    v_mov_b32 v210, 0
    v_mov_b32 v211, 0
    v_mov_b32 v212, 0
    v_mov_b32 v213, 0
    v_mov_b32 v214, 0
    v_mov_b32 v215, 0
    v_mov_b32 v216, 0
    v_mov_b32 v217, 0
    v_mov_b32 v218, 0
    v_mov_b32 v219, 0
    v_mov_b32 v220, 0
    v_mov_b32 v221, 0
    v_mov_b32 v222, 0
    v_mov_b32 v223, 0
    v_mov_b32 v224, 0
    v_mov_b32 v225, 0
    v_mov_b32 v226, 0
    v_mov_b32 v227, 0
    v_mov_b32 v228, 0
    v_mov_b32 v229, 0
    v_mov_b32 v230, 0
    v_mov_b32 v231, 0
    v_mov_b32 v232, 0
    v_mov_b32 v233, 0
    v_mov_b32 v234, 0
    v_mov_b32 v235, 0
    v_mov_b32 v236, 0
    v_mov_b32 v237, 0
    v_mov_b32 v238, 0
    v_mov_b32 v239, 0
    v_mov_b32 v240, 0
    v_mov_b32 v241, 0
    v_mov_b32 v242, 0
    v_mov_b32 v243, 0
    v_mov_b32 v244, 0
    v_mov_b32 v245, 0
    v_mov_b32 v246, 0
    v_mov_b32 v247, 0
    v_mov_b32 v248, 0
    v_mov_b32 v249, 0
    v_mov_b32 v250, 0
    v_mov_b32 v251, 0
    v_mov_b32 v252, 0
    v_mov_b32 v253, 0
    v_mov_b32 v254, 0
    v_mov_b32 v255, 0
    s_mov_b32 s60, 15
    s_cmp_eq_u32 s28, 3
    s_cbranch_scc0 L_recurrent_scan__compressed_kv_cla__moe_arch_mod__prompt_kernel_w7j_214
    v_add_u32 v30, s62, v1
    v_and_b32 v30, 3, v30
    s_add_u32 s36, s29, 32
    s_lshl_b32 s36, s36, 7
    s_lshl_b32 s37, s63, 4
    s_add_u32 s36, s36, s37
    v_lshl_add_u32 v30, v30, 2, s36
    s_mov_b32 s61, 0x40000
L_recurrent_scan__compressed_kv_cla__moe_arch_mod__prompt_kernel_cspin_215:
    s_sub_u32 s61, s61, 1
    s_cbranch_scc1 L_recurrent_scan__compressed_kv_cla__moe_arch_mod__prompt_kernel_cspinx_216
    global_load_dword v31, v30, s[90:91] sc1
    s_waitcnt vmcnt(0)
    v_cmp_le_u32 vcc, 4, v31
    s_nop 0
    s_and_b32 s60, vcc_lo, 15
    s_and_b32 s36, s60, 3
    s_cmp_eq_u32 s36, 3
    s_cbranch_scc1 L_recurrent_scan__compressed_kv_cla__moe_arch_mod__prompt_kernel_cspinx_216
    s_sleep 6
    s_branch L_recurrent_scan__compressed_kv_cla__moe_arch_mod__prompt_kernel_cspin_215
L_recurrent_scan__compressed_kv_cla__moe_arch_mod__prompt_kernel_cspinx_216:
L_recurrent_scan__compressed_kv_cla__moe_arch_mod__prompt_kernel_w7j_214:
    s_waitcnt vmcnt(10)
    s_waitcnt lgkmcnt(0)
    s_barrier
    buffer_load_dwordx4 v[128:131], v2, s[4:7], s31 offen offset:0 sc1
    buffer_load_dwordx4 v[132:135], v3, s[4:7], s31 offen offset:0 sc1
    buffer_load_dwordx4 v[136:139], v2, s[4:7], s31 offen offset:1024 sc1
    buffer_load_dwordx4 v[140:143], v3, s[4:7], s31 offen offset:1024 sc1
    buffer_load_dwordx4 v[144:147], v2, s[4:7], s31 offen offset:2048 sc1
    buffer_load_dwordx4 v[148:151], v3, s[4:7], s31 offen offset:2048 sc1
    buffer_load_dwordx4 v[152:155], v2, s[4:7], s31 offen offset:3072 sc1
    buffer_load_dwordx4 v[156:159], v3, s[4:7], s31 offen offset:3072 sc1
    s_add_u32 s31, s31, 8192
    s_and_b32 s31, s31, 0xffff
    s_lshl_b32 s36, s28, 13
    s_add_u32 s36, s36, 65536
    v_lshl_add_u32 v20, v1, 4, s36
    v_xor_b32 v21, 32768, v20
    ds_read_b64_tr_b16 v[64:65], v50 offset:0
    ds_read_b64_tr_b16 v[66:67], v50 offset:4096
    ds_read_b64_tr_b16 v[68:69], v51 offset:0
    ds_read_b64_tr_b16 v[70:71], v51 offset:4096
    ds_read_b64_tr_b16 v[72:73], v52 offset:0
    ds_read_b64_tr_b16 v[74:75], v52 offset:4096
    ds_read_b64_tr_b16 v[76:77], v53 offset:0
    ds_read_b64_tr_b16 v[78:79], v53 offset:4096
    ds_read_b64_tr_b16 v[80:81], v54 offset:0
    ds_read_b64_tr_b16 v[82:83], v54 offset:4096
    ds_read_b64_tr_b16 v[84:85], v55 offset:0
    ds_read_b64_tr_b16 v[86:87], v55 offset:4096
    s_mov_b32 s35, 0
    s_waitcnt vmcnt(4)
    buffer_load_dwordx4 v[160:163], v2, s[4:7], s31 offen offset:0 sc1
    buffer_load_dwordx4 v[164:167], v3, s[4:7], s31 offen offset:0 sc1
    buffer_load_dwordx4 v[168:171], v2, s[4:7], s31 offen offset:1024 sc1
    buffer_load_dwordx4 v[172:175], v3, s[4:7], s31 offen offset:1024 sc1
    buffer_load_dwordx4 v[176:179], v2, s[4:7], s31 offen offset:2048 sc1
    buffer_load_dwordx4 v[180:183], v3, s[4:7], s31 offen offset:2048 sc1
    .p2align 6
L_p4_loop:
    s_cmp_eq_u32 s35, 1
    s_cbranch_scc1 L_recurrent_scan__compressed_kv_cla__moe_arch_mod__prompt_kernel_rare_195
L_recurrent_scan__compressed_kv_cla__moe_arch_mod__prompt_kernel_back_196:
    s_waitcnt lgkmcnt(8)
    v_mfma_f32_16x16x32_bf16 v[192:195], v[64:67], v[128:131], v[192:195]
    ds_read_b64_tr_b16 v[88:89], v56 offset:0
    s_add_u32 m0, s34, 0
    v_mfma_f32_16x16x32_bf16 v[224:227], v[64:67], v[132:135], v[224:227]
    ds_read_b64_tr_b16 v[90:91], v56 offset:4096
    buffer_load_dwordx4 v6, s[8:11], s32 offen offset:0 lds
    v_mfma_f32_16x16x32_bf16 v[196:199], v[68:71], v[128:131], v[196:199]
    ds_read_b64_tr_b16 v[92:93], v57 offset:0
    buffer_load_dwordx4 v[184:187], v2, s[4:7], s31 offen offset:3072 sc1
    v_mfma_f32_16x16x32_bf16 v[228:231], v[68:71], v[132:135], v[228:231]
    ds_read_b64_tr_b16 v[94:95], v57 offset:4096
    s_waitcnt lgkmcnt(8)
    v_mfma_f32_16x16x32_bf16 v[200:203], v[72:75], v[128:131], v[200:203]
    ds_read_b64_tr_b16 v[64:65], v50 offset:8192
    buffer_load_dwordx4 v7, s[8:11], s32 offen offset:1024 lds
    v_mfma_f32_16x16x32_bf16 v[232:235], v[72:75], v[132:135], v[232:235]
    ds_read_b64_tr_b16 v[66:67], v50 offset:12288
    buffer_load_dwordx4 v[188:191], v3, s[4:7], s31 offen offset:3072 sc1
    v_mfma_f32_16x16x32_bf16 v[204:207], v[76:79], v[128:131], v[204:207]
    ds_read_b64_tr_b16 v[68:69], v51 offset:8192
    s_add_u32 s31, s31, 8192
    s_and_b32 s31, s31, 0xffff
    v_mfma_f32_16x16x32_bf16 v[236:239], v[76:79], v[132:135], v[236:239]
    ds_read_b64_tr_b16 v[70:71], v51 offset:12288
    buffer_load_dwordx4 v8, s[8:11], s32 offen offset:2048 lds
    s_waitcnt lgkmcnt(8)
    v_mfma_f32_16x16x32_bf16 v[208:211], v[80:83], v[128:131], v[208:211]
    ds_read_b64_tr_b16 v[72:73], v52 offset:8192
    s_cmp_lt_u32 s35, 3
    s_cselect_b32 s6, 16777216, 0
    v_mfma_f32_16x16x32_bf16 v[240:243], v[80:83], v[132:135], v[240:243]
    ds_read_b64_tr_b16 v[74:75], v52 offset:12288
    v_mfma_f32_16x16x32_bf16 v[212:215], v[84:87], v[128:131], v[212:215]
    ds_read_b64_tr_b16 v[76:77], v53 offset:8192
    buffer_load_dwordx4 v9, s[8:11], s32 offen offset:3072 lds
    v_mfma_f32_16x16x32_bf16 v[244:247], v[84:87], v[132:135], v[244:247]
    ds_read_b64_tr_b16 v[78:79], v53 offset:12288
    s_waitcnt lgkmcnt(8)
    v_mfma_f32_16x16x32_bf16 v[216:219], v[88:91], v[128:131], v[216:219]
    ds_read_b64_tr_b16 v[80:81], v54 offset:8192
    s_add_u32 m0, s34, 4096
    s_add_u32 s37, s32, 32768
    v_mfma_f32_16x16x32_bf16 v[248:251], v[88:91], v[132:135], v[248:251]
    ds_read_b64_tr_b16 v[82:83], v54 offset:12288
    buffer_load_dwordx4 v6, s[8:11], s37 offen offset:0 lds
    v_mfma_f32_16x16x32_bf16 v[220:223], v[92:95], v[128:131], v[220:223]
    ds_read_b64_tr_b16 v[84:85], v55 offset:8192
    v_mfma_f32_16x16x32_bf16 v[252:255], v[92:95], v[132:135], v[252:255]
    ds_read_b64_tr_b16 v[86:87], v55 offset:12288
    s_waitcnt lgkmcnt(8)
    v_mfma_f32_16x16x32_bf16 v[192:195], v[64:67], v[136:139], v[192:195]
    ds_read_b64_tr_b16 v[88:89], v56 offset:8192
    buffer_load_dwordx4 v7, s[8:11], s37 offen offset:1024 lds
    v_mfma_f32_16x16x32_bf16 v[224:227], v[64:67], v[140:143], v[224:227]
    ds_read_b64_tr_b16 v[90:91], v56 offset:12288
    v_mfma_f32_16x16x32_bf16 v[196:199], v[68:71], v[136:139], v[196:199]
    ds_read_b64_tr_b16 v[92:93], v57 offset:8192
    v_mfma_f32_16x16x32_bf16 v[228:231], v[68:71], v[140:143], v[228:231]
    ds_read_b64_tr_b16 v[94:95], v57 offset:12288
    buffer_load_dwordx4 v8, s[8:11], s37 offen offset:2048 lds
    s_waitcnt lgkmcnt(8)
    v_mfma_f32_16x16x32_bf16 v[200:203], v[72:75], v[136:139], v[200:203]
    ds_read_b64_tr_b16 v[64:65], v50 offset:16384
    v_mfma_f32_16x16x32_bf16 v[232:235], v[72:75], v[140:143], v[232:235]
    ds_read_b64_tr_b16 v[66:67], v50 offset:20480
    v_mfma_f32_16x16x32_bf16 v[204:207], v[76:79], v[136:139], v[204:207]
    ds_read_b64_tr_b16 v[68:69], v51 offset:16384
    buffer_load_dwordx4 v9, s[8:11], s37 offen offset:3072 lds
    v_mfma_f32_16x16x32_bf16 v[236:239], v[76:79], v[140:143], v[236:239]
    ds_read_b64_tr_b16 v[70:71], v51 offset:20480
    s_add_u32 s32, s32, 524288
    s_and_b32 s32, s32, 0x3fffff
    s_waitcnt lgkmcnt(8)
    v_mfma_f32_16x16x32_bf16 v[208:211], v[80:83], v[136:139], v[208:211]
    ds_read_b64_tr_b16 v[72:73], v52 offset:16384
    v_mfma_f32_16x16x32_bf16 v[240:243], v[80:83], v[140:143], v[240:243]
    ds_read_b64_tr_b16 v[74:75], v52 offset:20480
    buffer_load_dwordx4 v[128:131], v2, s[4:7], s31 offen offset:0 sc1
    v_mfma_f32_16x16x32_bf16 v[212:215], v[84:87], v[136:139], v[212:215]
    ds_read_b64_tr_b16 v[76:77], v53 offset:16384
    v_mfma_f32_16x16x32_bf16 v[244:247], v[84:87], v[140:143], v[244:247]
    ds_read_b64_tr_b16 v[78:79], v53 offset:20480
    s_waitcnt lgkmcnt(8)
    v_mfma_f32_16x16x32_bf16 v[216:219], v[88:91], v[136:139], v[216:219]
    ds_read_b64_tr_b16 v[80:81], v54 offset:16384
    v_mfma_f32_16x16x32_bf16 v[248:251], v[88:91], v[140:143], v[248:251]
    ds_read_b64_tr_b16 v[82:83], v54 offset:20480
    buffer_load_dwordx4 v[132:135], v3, s[4:7], s31 offen offset:0 sc1
    v_mfma_f32_16x16x32_bf16 v[220:223], v[92:95], v[136:139], v[220:223]
    ds_read_b64_tr_b16 v[84:85], v55 offset:16384
    v_mfma_f32_16x16x32_bf16 v[252:255], v[92:95], v[140:143], v[252:255]
    ds_read_b64_tr_b16 v[86:87], v55 offset:20480
    s_waitcnt lgkmcnt(8)
    s_waitcnt vmcnt(20)
    v_mfma_f32_16x16x32_bf16 v[192:195], v[64:67], v[144:147], v[192:195]
    ds_read_b64_tr_b16 v[88:89], v56 offset:16384
    v_mfma_f32_16x16x32_bf16 v[224:227], v[64:67], v[148:151], v[224:227]
    ds_read_b64_tr_b16 v[90:91], v56 offset:20480
    v_mfma_f32_16x16x32_bf16 v[196:199], v[68:71], v[144:147], v[196:199]
    ds_read_b64_tr_b16 v[92:93], v57 offset:16384
    buffer_load_dwordx4 v[136:139], v2, s[4:7], s31 offen offset:1024 sc1
    v_mfma_f32_16x16x32_bf16 v[228:231], v[68:71], v[148:151], v[228:231]
    ds_read_b64_tr_b16 v[94:95], v57 offset:20480
    s_waitcnt lgkmcnt(8)
    v_mfma_f32_16x16x32_bf16 v[200:203], v[72:75], v[144:147], v[200:203]
    ds_read_b64_tr_b16 v[64:65], v50 offset:24576
    v_mfma_f32_16x16x32_bf16 v[232:235], v[72:75], v[148:151], v[232:235]
    ds_read_b64_tr_b16 v[66:67], v50 offset:28672
    v_xor_b32 v50, 65536, v50
    v_mfma_f32_16x16x32_bf16 v[204:207], v[76:79], v[144:147], v[204:207]
    ds_read_b64_tr_b16 v[68:69], v51 offset:24576
    buffer_load_dwordx4 v[140:143], v3, s[4:7], s31 offen offset:1024 sc1
    v_mfma_f32_16x16x32_bf16 v[236:239], v[76:79], v[148:151], v[236:239]
    ds_read_b64_tr_b16 v[70:71], v51 offset:28672
    v_xor_b32 v51, 65536, v51
    s_waitcnt lgkmcnt(8)
    v_mfma_f32_16x16x32_bf16 v[208:211], v[80:83], v[144:147], v[208:211]
    ds_read_b64_tr_b16 v[72:73], v52 offset:24576
    v_mfma_f32_16x16x32_bf16 v[240:243], v[80:83], v[148:151], v[240:243]
    ds_read_b64_tr_b16 v[74:75], v52 offset:28672
    v_xor_b32 v52, 65536, v52
    v_mfma_f32_16x16x32_bf16 v[212:215], v[84:87], v[144:147], v[212:215]
    ds_read_b64_tr_b16 v[76:77], v53 offset:24576
    v_mfma_f32_16x16x32_bf16 v[244:247], v[84:87], v[148:151], v[244:247]
    ds_read_b64_tr_b16 v[78:79], v53 offset:28672
    v_xor_b32 v53, 65536, v53
    s_waitcnt lgkmcnt(8)
    v_mfma_f32_16x16x32_bf16 v[216:219], v[88:91], v[144:147], v[216:219]
    ds_read_b64_tr_b16 v[80:81], v54 offset:24576
    v_mfma_f32_16x16x32_bf16 v[248:251], v[88:91], v[148:151], v[248:251]
    ds_read_b64_tr_b16 v[82:83], v54 offset:28672
    v_xor_b32 v54, 65536, v54
    v_mfma_f32_16x16x32_bf16 v[220:223], v[92:95], v[144:147], v[220:223]
    ds_read_b64_tr_b16 v[84:85], v55 offset:24576
    v_mfma_f32_16x16x32_bf16 v[252:255], v[92:95], v[148:151], v[252:255]
    ds_read_b64_tr_b16 v[86:87], v55 offset:28672
    v_xor_b32 v55, 65536, v55
    s_waitcnt lgkmcnt(8)
    s_waitcnt vmcnt(20)
    v_mfma_f32_16x16x32_bf16 v[192:195], v[64:67], v[152:155], v[192:195]
    ds_read_b64_tr_b16 v[88:89], v56 offset:24576
    v_mfma_f32_16x16x32_bf16 v[224:227], v[64:67], v[156:159], v[224:227]
    ds_read_b64_tr_b16 v[90:91], v56 offset:28672
    v_xor_b32 v56, 65536, v56
    v_mfma_f32_16x16x32_bf16 v[196:199], v[68:71], v[152:155], v[196:199]
    ds_read_b64_tr_b16 v[92:93], v57 offset:24576
    buffer_load_dwordx4 v[144:147], v2, s[4:7], s31 offen offset:2048 sc1
    v_mfma_f32_16x16x32_bf16 v[228:231], v[68:71], v[156:159], v[228:231]
    ds_read_b64_tr_b16 v[94:95], v57 offset:28672
    v_xor_b32 v57, 65536, v57
    s_waitcnt lgkmcnt(8)
    v_mfma_f32_16x16x32_bf16 v[200:203], v[72:75], v[152:155], v[200:203]
    v_mfma_f32_16x16x32_bf16 v[232:235], v[72:75], v[156:159], v[232:235]
    v_mfma_f32_16x16x32_bf16 v[204:207], v[76:79], v[152:155], v[204:207]
    buffer_load_dwordx4 v[148:151], v3, s[4:7], s31 offen offset:2048 sc1
    v_mfma_f32_16x16x32_bf16 v[236:239], v[76:79], v[156:159], v[236:239]
    s_waitcnt lgkmcnt(0)
    s_waitcnt vmcnt(6)
    s_barrier
    v_mfma_f32_16x16x32_bf16 v[208:211], v[80:83], v[152:155], v[208:211]
    ds_read_b64_tr_b16 v[64:65], v50 offset:0
    ds_read_b64_tr_b16 v[66:67], v50 offset:4096
    v_mfma_f32_16x16x32_bf16 v[240:243], v[80:83], v[156:159], v[240:243]
    ds_read_b64_tr_b16 v[68:69], v51 offset:0
    ds_read_b64_tr_b16 v[70:71], v51 offset:4096
    v_mfma_f32_16x16x32_bf16 v[212:215], v[84:87], v[152:155], v[212:215]
    ds_read_b64_tr_b16 v[72:73], v52 offset:0
    ds_read_b64_tr_b16 v[74:75], v52 offset:4096
    v_mfma_f32_16x16x32_bf16 v[244:247], v[84:87], v[156:159], v[244:247]
    ds_read_b64_tr_b16 v[76:77], v53 offset:0
    ds_read_b64_tr_b16 v[78:79], v53 offset:4096
    v_mfma_f32_16x16x32_bf16 v[216:219], v[88:91], v[152:155], v[216:219]
    ds_read_b64_tr_b16 v[80:81], v54 offset:0
    ds_read_b64_tr_b16 v[82:83], v54 offset:4096
    v_mfma_f32_16x16x32_bf16 v[248:251], v[88:91], v[156:159], v[248:251]
    v_mfma_f32_16x16x32_bf16 v[220:223], v[92:95], v[152:155], v[220:223]
    ds_read_b64_tr_b16 v[84:85], v55 offset:0
    ds_read_b64_tr_b16 v[86:87], v55 offset:4096
    s_cmp_lt_u32 s35, 3
    s_cselect_b32 s10, 8388608, 0
    s_cselect_b32 s34, s33, 0x20000
    v_mfma_f32_16x16x32_bf16 v[252:255], v[92:95], v[156:159], v[252:255]
    s_cmp_lg_u32 s35, 2
    s_cbranch_scc1 L_recurrent_scan__compressed_kv_cla__moe_arch_mod__prompt_kernel_rare_200
L_recurrent_scan__compressed_kv_cla__moe_arch_mod__prompt_kernel_back_201:
    s_waitcnt lgkmcnt(8)
    v_mfma_f32_16x16x32_bf16 v[192:195], v[64:67], v[160:163], v[192:195]
    ds_read_b64_tr_b16 v[88:89], v56 offset:0
    s_add_u32 m0, s34, 65536
    v_mfma_f32_16x16x32_bf16 v[224:227], v[64:67], v[164:167], v[224:227]
    ds_read_b64_tr_b16 v[90:91], v56 offset:4096
    buffer_load_dwordx4 v6, s[8:11], s32 offen offset:0 lds
    v_mfma_f32_16x16x32_bf16 v[196:199], v[68:71], v[160:163], v[196:199]
    ds_read_b64_tr_b16 v[92:93], v57 offset:0
    buffer_load_dwordx4 v[152:155], v2, s[4:7], s31 offen offset:3072 sc1
    v_mfma_f32_16x16x32_bf16 v[228:231], v[68:71], v[164:167], v[228:231]
    ds_read_b64_tr_b16 v[94:95], v57 offset:4096
    s_waitcnt lgkmcnt(8)
    v_mfma_f32_16x16x32_bf16 v[200:203], v[72:75], v[160:163], v[200:203]
    ds_read_b64_tr_b16 v[64:65], v50 offset:8192
    buffer_load_dwordx4 v7, s[8:11], s32 offen offset:1024 lds
    v_mfma_f32_16x16x32_bf16 v[232:235], v[72:75], v[164:167], v[232:235]
    ds_read_b64_tr_b16 v[66:67], v50 offset:12288
    buffer_load_dwordx4 v[156:159], v3, s[4:7], s31 offen offset:3072 sc1
    v_mfma_f32_16x16x32_bf16 v[204:207], v[76:79], v[160:163], v[204:207]
    ds_read_b64_tr_b16 v[68:69], v51 offset:8192
    s_add_u32 s31, s31, 8192
    s_and_b32 s31, s31, 0xffff
    v_mfma_f32_16x16x32_bf16 v[236:239], v[76:79], v[164:167], v[236:239]
    ds_read_b64_tr_b16 v[70:71], v51 offset:12288
    buffer_load_dwordx4 v8, s[8:11], s32 offen offset:2048 lds
    s_waitcnt lgkmcnt(8)
    v_mfma_f32_16x16x32_bf16 v[208:211], v[80:83], v[160:163], v[208:211]
    ds_read_b64_tr_b16 v[72:73], v52 offset:8192
    v_mfma_f32_16x16x32_bf16 v[240:243], v[80:83], v[164:167], v[240:243]
    ds_read_b64_tr_b16 v[74:75], v52 offset:12288
    v_mfma_f32_16x16x32_bf16 v[212:215], v[84:87], v[160:163], v[212:215]
    ds_read_b64_tr_b16 v[76:77], v53 offset:8192
    buffer_load_dwordx4 v9, s[8:11], s32 offen offset:3072 lds
    v_mfma_f32_16x16x32_bf16 v[244:247], v[84:87], v[164:167], v[244:247]
    ds_read_b64_tr_b16 v[78:79], v53 offset:12288
    s_waitcnt lgkmcnt(8)
    v_mfma_f32_16x16x32_bf16 v[216:219], v[88:91], v[160:163], v[216:219]
    ds_read_b64_tr_b16 v[80:81], v54 offset:8192
    s_add_u32 m0, s34, 69632
    s_add_u32 s37, s32, 32768
    v_mfma_f32_16x16x32_bf16 v[248:251], v[88:91], v[164:167], v[248:251]
    ds_read_b64_tr_b16 v[82:83], v54 offset:12288
    buffer_load_dwordx4 v6, s[8:11], s37 offen offset:0 lds
    v_mfma_f32_16x16x32_bf16 v[220:223], v[92:95], v[160:163], v[220:223]
    ds_read_b64_tr_b16 v[84:85], v55 offset:8192
    v_mfma_f32_16x16x32_bf16 v[252:255], v[92:95], v[164:167], v[252:255]
    ds_read_b64_tr_b16 v[86:87], v55 offset:12288
    s_waitcnt lgkmcnt(8)
    v_mfma_f32_16x16x32_bf16 v[192:195], v[64:67], v[168:171], v[192:195]
    ds_read_b64_tr_b16 v[88:89], v56 offset:8192
    buffer_load_dwordx4 v7, s[8:11], s37 offen offset:1024 lds
    v_mfma_f32_16x16x32_bf16 v[224:227], v[64:67], v[172:175], v[224:227]
    ds_read_b64_tr_b16 v[90:91], v56 offset:12288
    v_mfma_f32_16x16x32_bf16 v[196:199], v[68:71], v[168:171], v[196:199]
    ds_read_b64_tr_b16 v[92:93], v57 offset:8192
    v_mfma_f32_16x16x32_bf16 v[228:231], v[68:71], v[172:175], v[228:231]
    ds_read_b64_tr_b16 v[94:95], v57 offset:12288
    buffer_load_dwordx4 v8, s[8:11], s37 offen offset:2048 lds
    s_waitcnt lgkmcnt(8)
    v_mfma_f32_16x16x32_bf16 v[200:203], v[72:75], v[168:171], v[200:203]
    ds_read_b64_tr_b16 v[64:65], v50 offset:16384
    v_mfma_f32_16x16x32_bf16 v[232:235], v[72:75], v[172:175], v[232:235]
    ds_read_b64_tr_b16 v[66:67], v50 offset:20480
    v_mfma_f32_16x16x32_bf16 v[204:207], v[76:79], v[168:171], v[204:207]
    ds_read_b64_tr_b16 v[68:69], v51 offset:16384
    buffer_load_dwordx4 v9, s[8:11], s37 offen offset:3072 lds
    v_mfma_f32_16x16x32_bf16 v[236:239], v[76:79], v[172:175], v[236:239]
    ds_read_b64_tr_b16 v[70:71], v51 offset:20480
    s_add_u32 s32, s32, 524288
    s_and_b32 s32, s32, 0x3fffff
    s_waitcnt lgkmcnt(8)
    v_mfma_f32_16x16x32_bf16 v[208:211], v[80:83], v[168:171], v[208:211]
    ds_read_b64_tr_b16 v[72:73], v52 offset:16384
    v_mfma_f32_16x16x32_bf16 v[240:243], v[80:83], v[172:175], v[240:243]
    ds_read_b64_tr_b16 v[74:75], v52 offset:20480
    buffer_load_dwordx4 v[160:163], v2, s[4:7], s31 offen offset:0 sc1
    v_mfma_f32_16x16x32_bf16 v[212:215], v[84:87], v[168:171], v[212:215]
    ds_read_b64_tr_b16 v[76:77], v53 offset:16384
    v_mfma_f32_16x16x32_bf16 v[244:247], v[84:87], v[172:175], v[244:247]
    ds_read_b64_tr_b16 v[78:79], v53 offset:20480
    s_waitcnt lgkmcnt(8)
    v_mfma_f32_16x16x32_bf16 v[216:219], v[88:91], v[168:171], v[216:219]
    ds_read_b64_tr_b16 v[80:81], v54 offset:16384
    v_mfma_f32_16x16x32_bf16 v[248:251], v[88:91], v[172:175], v[248:251]
    ds_read_b64_tr_b16 v[82:83], v54 offset:20480
    buffer_load_dwordx4 v[164:167], v3, s[4:7], s31 offen offset:0 sc1
    v_mfma_f32_16x16x32_bf16 v[220:223], v[92:95], v[168:171], v[220:223]
    ds_read_b64_tr_b16 v[84:85], v55 offset:16384
    v_mfma_f32_16x16x32_bf16 v[252:255], v[92:95], v[172:175], v[252:255]
    ds_read_b64_tr_b16 v[86:87], v55 offset:20480
    s_waitcnt lgkmcnt(8)
    v_mfma_f32_16x16x32_bf16 v[192:195], v[64:67], v[176:179], v[192:195]
    ds_read_b64_tr_b16 v[88:89], v56 offset:16384
    v_mfma_f32_16x16x32_bf16 v[224:227], v[64:67], v[180:183], v[224:227]
    ds_read_b64_tr_b16 v[90:91], v56 offset:20480
    v_mfma_f32_16x16x32_bf16 v[196:199], v[68:71], v[176:179], v[196:199]
    ds_read_b64_tr_b16 v[92:93], v57 offset:16384
    buffer_load_dwordx4 v[168:171], v2, s[4:7], s31 offen offset:1024 sc1
    v_mfma_f32_16x16x32_bf16 v[228:231], v[68:71], v[180:183], v[228:231]
    ds_read_b64_tr_b16 v[94:95], v57 offset:20480
    s_waitcnt lgkmcnt(8)
    v_mfma_f32_16x16x32_bf16 v[200:203], v[72:75], v[176:179], v[200:203]
    ds_read_b64_tr_b16 v[64:65], v50 offset:24576
    v_mfma_f32_16x16x32_bf16 v[232:235], v[72:75], v[180:183], v[232:235]
    ds_read_b64_tr_b16 v[66:67], v50 offset:28672
    v_xor_b32 v50, 65536, v50
    v_mfma_f32_16x16x32_bf16 v[204:207], v[76:79], v[176:179], v[204:207]
    ds_read_b64_tr_b16 v[68:69], v51 offset:24576
    buffer_load_dwordx4 v[172:175], v3, s[4:7], s31 offen offset:1024 sc1
    v_mfma_f32_16x16x32_bf16 v[236:239], v[76:79], v[180:183], v[236:239]
    ds_read_b64_tr_b16 v[70:71], v51 offset:28672
    v_xor_b32 v51, 65536, v51
    s_waitcnt lgkmcnt(8)
    v_mfma_f32_16x16x32_bf16 v[208:211], v[80:83], v[176:179], v[208:211]
    ds_read_b64_tr_b16 v[72:73], v52 offset:24576
    v_mfma_f32_16x16x32_bf16 v[240:243], v[80:83], v[180:183], v[240:243]
    ds_read_b64_tr_b16 v[74:75], v52 offset:28672
    v_xor_b32 v52, 65536, v52
    v_mfma_f32_16x16x32_bf16 v[212:215], v[84:87], v[176:179], v[212:215]
    ds_read_b64_tr_b16 v[76:77], v53 offset:24576
    v_mfma_f32_16x16x32_bf16 v[244:247], v[84:87], v[180:183], v[244:247]
    ds_read_b64_tr_b16 v[78:79], v53 offset:28672
    v_xor_b32 v53, 65536, v53
    s_waitcnt lgkmcnt(8)
    v_mfma_f32_16x16x32_bf16 v[216:219], v[88:91], v[176:179], v[216:219]
    ds_read_b64_tr_b16 v[80:81], v54 offset:24576
    v_mfma_f32_16x16x32_bf16 v[248:251], v[88:91], v[180:183], v[248:251]
    ds_read_b64_tr_b16 v[82:83], v54 offset:28672
    v_xor_b32 v54, 65536, v54
    v_mfma_f32_16x16x32_bf16 v[220:223], v[92:95], v[176:179], v[220:223]
    ds_read_b64_tr_b16 v[84:85], v55 offset:24576
    v_mfma_f32_16x16x32_bf16 v[252:255], v[92:95], v[180:183], v[252:255]
    ds_read_b64_tr_b16 v[86:87], v55 offset:28672
    v_xor_b32 v55, 65536, v55
    s_waitcnt lgkmcnt(8)
    v_mfma_f32_16x16x32_bf16 v[192:195], v[64:67], v[184:187], v[192:195]
    ds_read_b64_tr_b16 v[88:89], v56 offset:24576
    v_mfma_f32_16x16x32_bf16 v[224:227], v[64:67], v[188:191], v[224:227]
    ds_read_b64_tr_b16 v[90:91], v56 offset:28672
    v_xor_b32 v56, 65536, v56
    v_mfma_f32_16x16x32_bf16 v[196:199], v[68:71], v[184:187], v[196:199]
    ds_read_b64_tr_b16 v[92:93], v57 offset:24576
    buffer_load_dwordx4 v[176:179], v2, s[4:7], s31 offen offset:2048 sc1
    v_mfma_f32_16x16x32_bf16 v[228:231], v[68:71], v[188:191], v[228:231]
    ds_read_b64_tr_b16 v[94:95], v57 offset:28672
    v_xor_b32 v57, 65536, v57
    s_waitcnt lgkmcnt(8)
    v_mfma_f32_16x16x32_bf16 v[200:203], v[72:75], v[184:187], v[200:203]
    v_mfma_f32_16x16x32_bf16 v[232:235], v[72:75], v[188:191], v[232:235]
    v_mfma_f32_16x16x32_bf16 v[204:207], v[76:79], v[184:187], v[204:207]
    buffer_load_dwordx4 v[180:183], v3, s[4:7], s31 offen offset:2048 sc1
    v_mfma_f32_16x16x32_bf16 v[236:239], v[76:79], v[188:191], v[236:239]
    s_cmp_lt_u32 s60, 15
    s_cbranch_scc1 L_recurrent_scan__compressed_kv_cla__moe_arch_mod__prompt_kernel_rare_208
L_recurrent_scan__compressed_kv_cla__moe_arch_mod__prompt_kernel_back_209:
    s_waitcnt lgkmcnt(0)
    s_waitcnt vmcnt(6)
    s_barrier
    v_mfma_f32_16x16x32_bf16 v[208:211], v[80:83], v[184:187], v[208:211]
    ds_read_b64_tr_b16 v[64:65], v50 offset:0
    ds_read_b64_tr_b16 v[66:67], v50 offset:4096
    v_mfma_f32_16x16x32_bf16 v[240:243], v[80:83], v[188:191], v[240:243]
    ds_read_b64_tr_b16 v[68:69], v51 offset:0
    ds_read_b64_tr_b16 v[70:71], v51 offset:4096
    v_mfma_f32_16x16x32_bf16 v[212:215], v[84:87], v[184:187], v[212:215]
    ds_read_b64_tr_b16 v[72:73], v52 offset:0
    ds_read_b64_tr_b16 v[74:75], v52 offset:4096
    v_mfma_f32_16x16x32_bf16 v[244:247], v[84:87], v[188:191], v[244:247]
    ds_read_b64_tr_b16 v[76:77], v53 offset:0
    ds_read_b64_tr_b16 v[78:79], v53 offset:4096
    v_mfma_f32_16x16x32_bf16 v[216:219], v[88:91], v[184:187], v[216:219]
    ds_read_b64_tr_b16 v[80:81], v54 offset:0
    ds_read_b64_tr_b16 v[82:83], v54 offset:4096
    v_mfma_f32_16x16x32_bf16 v[248:251], v[88:91], v[188:191], v[248:251]
    v_mfma_f32_16x16x32_bf16 v[220:223], v[92:95], v[184:187], v[220:223]
    ds_read_b64_tr_b16 v[84:85], v55 offset:0
    ds_read_b64_tr_b16 v[86:87], v55 offset:4096
    v_mfma_f32_16x16x32_bf16 v[252:255], v[92:95], v[188:191], v[252:255]
    s_add_u32 s35, s35, 1
    s_cmp_lt_u32 s35, 4
    s_cbranch_scc1 L_p4_loop
    s_waitcnt vmcnt(0) lgkmcnt(0)
    s_nop 3
    s_cmp_lt_u32 s28, 4
    s_cbranch_scc0 L_p4_e1
    ds_write_b128 v20, v[224:227] offset:0
    ds_write_b128 v20, v[228:231] offset:1024
    ds_write_b128 v20, v[232:235] offset:2048
    ds_write_b128 v20, v[236:239] offset:3072
    ds_write_b128 v20, v[240:243] offset:4096
    ds_write_b128 v20, v[244:247] offset:5120
    ds_write_b128 v20, v[248:251] offset:6144
    ds_write_b128 v20, v[252:255] offset:7168
    s_waitcnt lgkmcnt(0)
    s_barrier
    ds_read_b128 v[128:131], v21 offset:0
    ds_read_b128 v[132:135], v21 offset:1024
    ds_read_b128 v[136:139], v21 offset:2048
    ds_read_b128 v[140:143], v21 offset:3072
    ds_read_b128 v[144:147], v21 offset:4096
    ds_read_b128 v[148:151], v21 offset:5120
    ds_read_b128 v[152:155], v21 offset:6144
    ds_read_b128 v[156:159], v21 offset:7168
    s_waitcnt lgkmcnt(7)
    v_add_f32 v128, v128, v192
    v_add_f32 v129, v129, v193
    v_add_f32 v130, v130, v194
    v_add_f32 v131, v131, v195
    s_waitcnt lgkmcnt(6)
    v_add_f32 v132, v132, v196
    v_add_f32 v133, v133, v197
    v_add_f32 v134, v134, v198
    v_add_f32 v135, v135, v199
    s_waitcnt lgkmcnt(5)
    v_add_f32 v136, v136, v200
    v_add_f32 v137, v137, v201
    v_add_f32 v138, v138, v202
    v_add_f32 v139, v139, v203
    s_waitcnt lgkmcnt(4)
    v_add_f32 v140, v140, v204
    v_add_f32 v141, v141, v205
    v_add_f32 v142, v142, v206
    v_add_f32 v143, v143, v207
    s_waitcnt lgkmcnt(3)
    v_add_f32 v144, v144, v208
    v_add_f32 v145, v145, v209
    v_add_f32 v146, v146, v210
    v_add_f32 v147, v147, v211
    s_waitcnt lgkmcnt(2)
    v_add_f32 v148, v148, v212
    v_add_f32 v149, v149, v213
    v_add_f32 v150, v150, v214
    v_add_f32 v151, v151, v215
    s_waitcnt lgkmcnt(1)
    v_add_f32 v152, v152, v216
    v_add_f32 v153, v153, v217
    v_add_f32 v154, v154, v218
    v_add_f32 v155, v155, v219
    s_waitcnt lgkmcnt(0)
    v_add_f32 v156, v156, v220
    v_add_f32 v157, v157, v221
    v_add_f32 v158, v158, v222
    v_add_f32 v159, v159, v223
    s_branch L_p4_done
L_p4_e1:
    ds_write_b128 v20, v[192:195] offset:0
    ds_write_b128 v20, v[196:199] offset:1024
    ds_write_b128 v20, v[200:203] offset:2048
    ds_write_b128 v20, v[204:207] offset:3072
    ds_write_b128 v20, v[208:211] offset:4096
    ds_write_b128 v20, v[212:215] offset:5120
    ds_write_b128 v20, v[216:219] offset:6144
    ds_write_b128 v20, v[220:223] offset:7168
    s_waitcnt lgkmcnt(0)
    s_barrier
    ds_read_b128 v[128:131], v21 offset:0
    ds_read_b128 v[132:135], v21 offset:1024
    ds_read_b128 v[136:139], v21 offset:2048
    ds_read_b128 v[140:143], v21 offset:3072
    ds_read_b128 v[144:147], v21 offset:4096
    ds_read_b128 v[148:151], v21 offset:5120
    ds_read_b128 v[152:155], v21 offset:6144
    ds_read_b128 v[156:159], v21 offset:7168
    s_waitcnt lgkmcnt(7)
    v_add_f32 v128, v128, v224
    v_add_f32 v129, v129, v225
    v_add_f32 v130, v130, v226
    v_add_f32 v131, v131, v227
    s_waitcnt lgkmcnt(6)
    v_add_f32 v132, v132, v228
    v_add_f32 v133, v133, v229
    v_add_f32 v134, v134, v230
    v_add_f32 v135, v135, v231
    s_waitcnt lgkmcnt(5)
    v_add_f32 v136, v136, v232
    v_add_f32 v137, v137, v233
    v_add_f32 v138, v138, v234
    v_add_f32 v139, v139, v235
    s_waitcnt lgkmcnt(4)
    v_add_f32 v140, v140, v236
    v_add_f32 v141, v141, v237
    v_add_f32 v142, v142, v238
    v_add_f32 v143, v143, v239
    s_waitcnt lgkmcnt(3)
    v_add_f32 v144, v144, v240
    v_add_f32 v145, v145, v241
    v_add_f32 v146, v146, v242
    v_add_f32 v147, v147, v243
    s_waitcnt lgkmcnt(2)
    v_add_f32 v148, v148, v244
    v_add_f32 v149, v149, v245
    v_add_f32 v150, v150, v246
    v_add_f32 v151, v151, v247
    s_waitcnt lgkmcnt(1)
    v_add_f32 v152, v152, v248
    v_add_f32 v153, v153, v249
    v_add_f32 v154, v154, v250
    v_add_f32 v155, v155, v251
    s_waitcnt lgkmcnt(0)
    v_add_f32 v156, v156, v252
    v_add_f32 v157, v157, v253
    v_add_f32 v158, v158, v254
    v_add_f32 v159, v159, v255
L_p4_done:
    s_cmp_eq_u32 s63, 0
    s_cbranch_scc1 L_recurrent_scan__compressed_kv_cla__moe_arch_mod__prompt_kernel_p1_217
    v_swap_b32 v128, v144
    v_swap_b32 v129, v145
    v_swap_b32 v130, v146
    v_swap_b32 v131, v147
    v_swap_b32 v132, v148
    v_swap_b32 v133, v149
    v_swap_b32 v134, v150
    v_swap_b32 v135, v151
    v_swap_b32 v136, v152
    v_swap_b32 v137, v153
    v_swap_b32 v138, v154
    v_swap_b32 v139, v155
    v_swap_b32 v140, v156
    v_swap_b32 v141, v157
    v_swap_b32 v142, v158
    v_swap_b32 v143, v159
L_recurrent_scan__compressed_kv_cla__moe_arch_mod__prompt_kernel_p1_217:
    s_lshl_b32 s36, s2, 15
    s_lshl_b32 s37, s28, 12
    s_add_u32 s36, s36, s37
    s_add_u32 s36, s36, 67108864
    s_xor_b32 s39, s36, 1048576
    v_lshlrev_b32 v22, 4, v1
    buffer_store_dwordx4 v[144:147], v22, s[24:27], s36 offen offset:0 sc1
    buffer_store_dwordx4 v[148:151], v22, s[24:27], s36 offen offset:1024 sc1
    buffer_store_dwordx4 v[152:155], v22, s[24:27], s36 offen offset:2048 sc1
    buffer_store_dwordx4 v[156:159], v22, s[24:27], s36 offen offset:3072 sc1
    s_add_u32 s36, s2, 128
    s_lshl_b32 s36, s36, 7
    s_xor_b32 s37, s36, 4096
    v_mov_b32 v30, s37
    s_mov_b32 s40, s36
    v_lshlrev_b32 v96, 16, v40
    v_and_b32 v97, 0xffff0000, v40
    v_sub_f32 v112, v96, v48
    v_sub_f32 v113, v97, v48
    v_cvt_pk_bf16_f32 v23, v112, v113
    v_lshlrev_b32 v112, 16, v23
    v_and_b32 v113, 0xffff0000, v23
    v_mul_f32 v112, v112, v49
    v_mul_f32 v113, v113, v49
    v_cvt_pk_bf16_f32 v23, v112, v113
    v_lshlrev_b32 v112, 16, v23
    v_and_b32 v113, 0xffff0000, v23
    v_mul_f32 v24, 0xbfb8aa3b, v112
    v_mul_f32 v25, 0xbfb8aa3b, v113
    v_exp_f32 v24, v24
    v_exp_f32 v25, v25
    s_nop 0
    v_add_f32 v24, 1.0, v24
    v_add_f32 v25, 1.0, v25
    v_rcp_f32 v24, v24
    v_rcp_f32 v25, v25
    s_nop 0
    v_mul_f32 v112, v112, v24
    v_mul_f32 v113, v113, v25
    v_cvt_pk_bf16_f32 v23, v112, v113
    v_lshlrev_b32 v112, 16, v23
    v_and_b32 v113, 0xffff0000, v23
    v_lshlrev_b32 v98, 16, v41
    v_and_b32 v99, 0xffff0000, v41
    v_sub_f32 v114, v98, v48
    v_sub_f32 v115, v99, v48
    v_cvt_pk_bf16_f32 v23, v114, v115
    v_lshlrev_b32 v114, 16, v23
    v_and_b32 v115, 0xffff0000, v23
    v_mul_f32 v114, v114, v49
    v_mul_f32 v115, v115, v49
    v_cvt_pk_bf16_f32 v23, v114, v115
    v_lshlrev_b32 v114, 16, v23
    v_and_b32 v115, 0xffff0000, v23
    v_mul_f32 v24, 0xbfb8aa3b, v114
    v_mul_f32 v25, 0xbfb8aa3b, v115
    v_exp_f32 v24, v24
    v_exp_f32 v25, v25
    s_nop 0
    v_add_f32 v24, 1.0, v24
    v_add_f32 v25, 1.0, v25
    v_rcp_f32 v24, v24
    v_rcp_f32 v25, v25
    s_nop 0
    v_mul_f32 v114, v114, v24
    v_mul_f32 v115, v115, v25
    v_cvt_pk_bf16_f32 v23, v114, v115
    v_lshlrev_b32 v114, 16, v23
    v_and_b32 v115, 0xffff0000, v23
    v_lshlrev_b32 v100, 16, v42
    v_and_b32 v101, 0xffff0000, v42
    v_sub_f32 v116, v100, v48
    v_sub_f32 v117, v101, v48
    v_cvt_pk_bf16_f32 v23, v116, v117
    v_lshlrev_b32 v116, 16, v23
    v_and_b32 v117, 0xffff0000, v23
    v_mul_f32 v116, v116, v49
    v_mul_f32 v117, v117, v49
    v_cvt_pk_bf16_f32 v23, v116, v117
    v_lshlrev_b32 v116, 16, v23
    v_and_b32 v117, 0xffff0000, v23
    v_mul_f32 v24, 0xbfb8aa3b, v116
    v_mul_f32 v25, 0xbfb8aa3b, v117
    v_exp_f32 v24, v24
    v_exp_f32 v25, v25
    s_nop 0
    v_add_f32 v24, 1.0, v24
    v_add_f32 v25, 1.0, v25
    v_rcp_f32 v24, v24
    v_rcp_f32 v25, v25
    s_nop 0
    v_mul_f32 v116, v116, v24
    v_mul_f32 v117, v117, v25
    v_cvt_pk_bf16_f32 v23, v116, v117
    v_lshlrev_b32 v116, 16, v23
    v_and_b32 v117, 0xffff0000, v23
    v_lshlrev_b32 v102, 16, v43
    v_and_b32 v103, 0xffff0000, v43
    v_sub_f32 v118, v102, v48
    v_sub_f32 v119, v103, v48
    v_cvt_pk_bf16_f32 v23, v118, v119
    v_lshlrev_b32 v118, 16, v23
    v_and_b32 v119, 0xffff0000, v23
    v_mul_f32 v118, v118, v49
    v_mul_f32 v119, v119, v49
    v_cvt_pk_bf16_f32 v23, v118, v119
    v_lshlrev_b32 v118, 16, v23
    v_and_b32 v119, 0xffff0000, v23
    v_mul_f32 v24, 0xbfb8aa3b, v118
    v_mul_f32 v25, 0xbfb8aa3b, v119
    v_exp_f32 v24, v24
    v_exp_f32 v25, v25
    s_nop 0
    v_add_f32 v24, 1.0, v24
    v_add_f32 v25, 1.0, v25
    v_rcp_f32 v24, v24
    v_rcp_f32 v25, v25
    s_nop 0
    v_mul_f32 v118, v118, v24
    v_mul_f32 v119, v119, v25
    v_cvt_pk_bf16_f32 v23, v118, v119
    v_lshlrev_b32 v118, 16, v23
    v_and_b32 v119, 0xffff0000, v23
    s_waitcnt vmcnt(0)
    v_mov_b32 v26, s40
    v_mov_b32 v27, 1
    s_mov_b64 exec, 1
    global_atomic_add v26, v27, s[90:91]
    s_mov_b64 exec, -1
    s_nop 3
    v_lshlrev_b32 v104, 16, v44
    v_and_b32 v105, 0xffff0000, v44
    v_sub_f32 v120, v104, v48
    v_sub_f32 v121, v105, v48
    v_cvt_pk_bf16_f32 v23, v120, v121
    v_lshlrev_b32 v120, 16, v23
    v_and_b32 v121, 0xffff0000, v23
    v_mul_f32 v120, v120, v49
    v_mul_f32 v121, v121, v49
    v_cvt_pk_bf16_f32 v23, v120, v121
    v_lshlrev_b32 v120, 16, v23
    v_and_b32 v121, 0xffff0000, v23
    v_mul_f32 v24, 0xbfb8aa3b, v120
    v_mul_f32 v25, 0xbfb8aa3b, v121
    v_exp_f32 v24, v24
    v_exp_f32 v25, v25
    s_nop 0
    v_add_f32 v24, 1.0, v24
    v_add_f32 v25, 1.0, v25
    v_rcp_f32 v24, v24
    v_rcp_f32 v25, v25
    s_nop 0
    v_mul_f32 v120, v120, v24
    v_mul_f32 v121, v121, v25
    v_cvt_pk_bf16_f32 v23, v120, v121
    v_lshlrev_b32 v120, 16, v23
    v_and_b32 v121, 0xffff0000, v23
    v_lshlrev_b32 v106, 16, v45
    v_and_b32 v107, 0xffff0000, v45
    v_sub_f32 v122, v106, v48
    v_sub_f32 v123, v107, v48
    v_cvt_pk_bf16_f32 v23, v122, v123
    v_lshlrev_b32 v122, 16, v23
    v_and_b32 v123, 0xffff0000, v23
    v_mul_f32 v122, v122, v49
    v_mul_f32 v123, v123, v49
    v_cvt_pk_bf16_f32 v23, v122, v123
    v_lshlrev_b32 v122, 16, v23
    v_and_b32 v123, 0xffff0000, v23
    v_mul_f32 v24, 0xbfb8aa3b, v122
    v_mul_f32 v25, 0xbfb8aa3b, v123
    v_exp_f32 v24, v24
    v_exp_f32 v25, v25
    s_nop 0
    v_add_f32 v24, 1.0, v24
    v_add_f32 v25, 1.0, v25
    v_rcp_f32 v24, v24
    v_rcp_f32 v25, v25
    s_nop 0
    v_mul_f32 v122, v122, v24
    v_mul_f32 v123, v123, v25
    v_cvt_pk_bf16_f32 v23, v122, v123
    v_lshlrev_b32 v122, 16, v23
    v_and_b32 v123, 0xffff0000, v23
    v_lshlrev_b32 v108, 16, v46
    v_and_b32 v109, 0xffff0000, v46
    v_sub_f32 v124, v108, v48
    v_sub_f32 v125, v109, v48
    v_cvt_pk_bf16_f32 v23, v124, v125
    v_lshlrev_b32 v124, 16, v23
    v_and_b32 v125, 0xffff0000, v23
    v_mul_f32 v124, v124, v49
    v_mul_f32 v125, v125, v49
    v_cvt_pk_bf16_f32 v23, v124, v125
    v_lshlrev_b32 v124, 16, v23
    v_and_b32 v125, 0xffff0000, v23
    v_mul_f32 v24, 0xbfb8aa3b, v124
    v_mul_f32 v25, 0xbfb8aa3b, v125
    v_exp_f32 v24, v24
    v_exp_f32 v25, v25
    s_nop 0
    v_add_f32 v24, 1.0, v24
    v_add_f32 v25, 1.0, v25
    v_rcp_f32 v24, v24
    v_rcp_f32 v25, v25
    s_nop 0
    v_mul_f32 v124, v124, v24
    v_mul_f32 v125, v125, v25
    v_cvt_pk_bf16_f32 v23, v124, v125
    v_lshlrev_b32 v124, 16, v23
    v_and_b32 v125, 0xffff0000, v23
    v_lshlrev_b32 v110, 16, v47
    v_and_b32 v111, 0xffff0000, v47
    v_sub_f32 v126, v110, v48
    v_sub_f32 v127, v111, v48
    v_cvt_pk_bf16_f32 v23, v126, v127
    v_lshlrev_b32 v126, 16, v23
    v_and_b32 v127, 0xffff0000, v23
    v_mul_f32 v126, v126, v49
    v_mul_f32 v127, v127, v49
    v_cvt_pk_bf16_f32 v23, v126, v127
    v_lshlrev_b32 v126, 16, v23
    v_and_b32 v127, 0xffff0000, v23
    v_mul_f32 v24, 0xbfb8aa3b, v126
    v_mul_f32 v25, 0xbfb8aa3b, v127
    v_exp_f32 v24, v24
    v_exp_f32 v25, v25
    s_nop 0
    v_add_f32 v24, 1.0, v24
    v_add_f32 v25, 1.0, v25
    v_rcp_f32 v24, v24
    v_rcp_f32 v25, v25
    s_nop 0
    v_mul_f32 v126, v126, v24
    v_mul_f32 v127, v127, v25
    v_cvt_pk_bf16_f32 v23, v126, v127
    v_lshlrev_b32 v126, 16, v23
    v_and_b32 v127, 0xffff0000, v23
    s_sub_u32 s36, s56, s38
    s_sub_u32 s37, s57, s38
    s_min_u32 s36, s36, s37
    s_cmp_lt_u32 s36, 16
    s_cbranch_scc1 L_recurrent_scan__compressed_kv_cla__moe_arch_mod__prompt_kernel_rare_218
L_recurrent_scan__compressed_kv_cla__moe_arch_mod__prompt_kernel_back_219:
    s_cmp_eq_u32 s28, 7
    s_cbranch_scc1 L_recurrent_scan__compressed_kv_cla__moe_arch_mod__prompt_kernel_rare_222
L_recurrent_scan__compressed_kv_cla__moe_arch_mod__prompt_kernel_back_223:
    s_barrier
    v_lshlrev_b32 v22, 4, v1
    buffer_load_dwordx4 v[64:67], v22, s[24:27], s39 offen offset:0 sc1
    buffer_load_dwordx4 v[68:71], v22, s[24:27], s39 offen offset:1024 sc1
    buffer_load_dwordx4 v[72:75], v22, s[24:27], s39 offen offset:2048 sc1
    buffer_load_dwordx4 v[76:79], v22, s[24:27], s39 offen offset:3072 sc1
    s_waitcnt vmcnt(3)
    v_add_f32 v128, v128, v64
    v_add_f32 v129, v129, v65
    v_cvt_pk_bf16_f32 v23, v128, v129
    v_lshlrev_b32 v128, 16, v23
    v_and_b32 v129, 0xffff0000, v23
    v_mul_f32 v128, v128, v112
    v_mul_f32 v129, v129, v113
    v_cvt_pk_bf16_f32 v23, v128, v129
    v_lshlrev_b32 v128, 16, v23
    v_and_b32 v129, 0xffff0000, v23
    v_add_f32 v128, v128, v96
    v_add_f32 v129, v129, v97
    v_cvt_pk_bf16_f32 v80, v128, v129
    v_add_f32 v130, v130, v66
    v_add_f32 v131, v131, v67
    v_cvt_pk_bf16_f32 v23, v130, v131
    v_lshlrev_b32 v130, 16, v23
    v_and_b32 v131, 0xffff0000, v23
    v_mul_f32 v130, v130, v114
    v_mul_f32 v131, v131, v115
    v_cvt_pk_bf16_f32 v23, v130, v131
    v_lshlrev_b32 v130, 16, v23
    v_and_b32 v131, 0xffff0000, v23
    v_add_f32 v130, v130, v98
    v_add_f32 v131, v131, v99
    v_cvt_pk_bf16_f32 v81, v130, v131
    buffer_store_dwordx2 v[80:81], v15, s[20:23], 0 offen offset:0
    s_waitcnt vmcnt(3)
    v_add_f32 v132, v132, v68
    v_add_f32 v133, v133, v69
    v_cvt_pk_bf16_f32 v23, v132, v133
    v_lshlrev_b32 v132, 16, v23
    v_and_b32 v133, 0xffff0000, v23
    v_mul_f32 v132, v132, v116
    v_mul_f32 v133, v133, v117
    v_cvt_pk_bf16_f32 v23, v132, v133
    v_lshlrev_b32 v132, 16, v23
    v_and_b32 v133, 0xffff0000, v23
    v_add_f32 v132, v132, v100
    v_add_f32 v133, v133, v101
    v_cvt_pk_bf16_f32 v82, v132, v133
    v_add_f32 v134, v134, v70
    v_add_f32 v135, v135, v71
    v_cvt_pk_bf16_f32 v23, v134, v135
    v_lshlrev_b32 v134, 16, v23
    v_and_b32 v135, 0xffff0000, v23
    v_mul_f32 v134, v134, v118
    v_mul_f32 v135, v135, v119
    v_cvt_pk_bf16_f32 v23, v134, v135
    v_lshlrev_b32 v134, 16, v23
    v_and_b32 v135, 0xffff0000, v23
    v_add_f32 v134, v134, v102
    v_add_f32 v135, v135, v103
    v_cvt_pk_bf16_f32 v83, v134, v135
    buffer_store_dwordx2 v[82:83], v15, s[20:23], 0 offen offset:32
    s_waitcnt vmcnt(3)
    v_add_f32 v136, v136, v72
    v_add_f32 v137, v137, v73
    v_cvt_pk_bf16_f32 v23, v136, v137
    v_lshlrev_b32 v136, 16, v23
    v_and_b32 v137, 0xffff0000, v23
    v_mul_f32 v136, v136, v120
    v_mul_f32 v137, v137, v121
    v_cvt_pk_bf16_f32 v23, v136, v137
    v_lshlrev_b32 v136, 16, v23
    v_and_b32 v137, 0xffff0000, v23
    v_add_f32 v136, v136, v104
    v_add_f32 v137, v137, v105
    v_cvt_pk_bf16_f32 v84, v136, v137
    v_add_f32 v138, v138, v74
    v_add_f32 v139, v139, v75
    v_cvt_pk_bf16_f32 v23, v138, v139
    v_lshlrev_b32 v138, 16, v23
    v_and_b32 v139, 0xffff0000, v23
    v_mul_f32 v138, v138, v122
    v_mul_f32 v139, v139, v123
    v_cvt_pk_bf16_f32 v23, v138, v139
    v_lshlrev_b32 v138, 16, v23
    v_and_b32 v139, 0xffff0000, v23
    v_add_f32 v138, v138, v106
    v_add_f32 v139, v139, v107
    v_cvt_pk_bf16_f32 v85, v138, v139
    buffer_store_dwordx2 v[84:85], v15, s[20:23], 0 offen offset:64
    s_waitcnt vmcnt(3)
    v_add_f32 v140, v140, v76
    v_add_f32 v141, v141, v77
    v_cvt_pk_bf16_f32 v23, v140, v141
    v_lshlrev_b32 v140, 16, v23
    v_and_b32 v141, 0xffff0000, v23
    v_mul_f32 v140, v140, v124
    v_mul_f32 v141, v141, v125
    v_cvt_pk_bf16_f32 v23, v140, v141
    v_lshlrev_b32 v140, 16, v23
    v_and_b32 v141, 0xffff0000, v23
    v_add_f32 v140, v140, v108
    v_add_f32 v141, v141, v109
    v_cvt_pk_bf16_f32 v86, v140, v141
    v_add_f32 v142, v142, v78
    v_add_f32 v143, v143, v79
    v_cvt_pk_bf16_f32 v23, v142, v143
    v_lshlrev_b32 v142, 16, v23
    v_and_b32 v143, 0xffff0000, v23
    v_mul_f32 v142, v142, v126
    v_mul_f32 v143, v143, v127
    v_cvt_pk_bf16_f32 v23, v142, v143
    v_lshlrev_b32 v142, 16, v23
    v_and_b32 v143, 0xffff0000, v23
    v_add_f32 v142, v142, v110
    v_add_f32 v143, v143, v111
    v_cvt_pk_bf16_f32 v87, v142, v143
    buffer_store_dwordx2 v[86:87], v15, s[20:23], 0 offen offset:96
    s_endpgm
L_recurrent_scan__compressed_kv_cla__moe_arch_mod__prompt_kernel_rare_190:
    v_mov_b32 v26, s40
    v_mov_b32 v27, s41
    v_cmp_eq_u32 vcc, 1, v1
    v_mov_b32 v28, 1
    s_nop 0
    v_cndmask_b32 v26, v26, v27, vcc
    s_mov_b64 exec, 3
    global_atomic_add v26, v28, s[90:91]
    s_mov_b64 exec, -1
    s_branch L_recurrent_scan__compressed_kv_cla__moe_arch_mod__prompt_kernel_back_191
L_recurrent_scan__compressed_kv_cla__moe_arch_mod__prompt_kernel_rare_195:
    s_cmp_lt_u32 s28, 4
    s_cbranch_scc0 L_recurrent_scan__compressed_kv_cla__moe_arch_mod__prompt_kernel_g_193
    s_lshl_b32 s36, s28, 10
    s_add_u32 s36, s36, 131072
    v_lshl_add_u32 v28, v1, 4, s36
    ds_read_b128 v[96:99], v28 offset:0
    ds_read_b128 v[100:103], v28 offset:4096
    ds_read_b128 v[104:107], v28 offset:8192
    ds_read_b128 v[108:111], v28 offset:12288
    ds_read_b128 v[112:115], v28 offset:16384
    ds_read_b128 v[116:119], v28 offset:20480
    ds_read_b128 v[120:123], v28 offset:24576
    s_lshr_b32 s36, s2, 4
    s_lshl_b32 s36, s36, 13
    s_and_b32 s37, s2, 15
    s_lshl_b32 s37, s37, 8
    s_add_u32 s36, s36, s37
    s_lshl_b32 s37, s28, 6
    s_add_u32 s36, s36, s37
    s_add_u32 s36, s36, 59768832
    v_and_b32 v28, 1, v1
    v_lshlrev_b32 v28, 12, v28
    v_lshl_add_u32 v28, v19, 4, v28
    s_waitcnt lgkmcnt(0)
    v_add_f32 v96, v96, v100
    v_add_f32 v97, v97, v101
    v_add_f32 v98, v98, v102
    v_add_f32 v99, v99, v103
    v_add_f32 v96, v96, v104
    v_add_f32 v97, v97, v105
    v_add_f32 v98, v98, v106
    v_add_f32 v99, v99, v107
    v_add_f32 v96, v96, v108
    v_add_f32 v97, v97, v109
    v_add_f32 v98, v98, v110
    v_add_f32 v99, v99, v111
    v_add_f32 v96, v96, v112
    v_add_f32 v97, v97, v113
    v_add_f32 v98, v98, v114
    v_add_f32 v99, v99, v115
    v_add_f32 v96, v96, v116
    v_add_f32 v97, v97, v117
    v_add_f32 v98, v98, v118
    v_add_f32 v99, v99, v119
    v_add_f32 v96, v96, v120
    v_add_f32 v97, v97, v121
    v_add_f32 v98, v98, v122
    v_add_f32 v99, v99, v123
    s_mov_b32 exec_lo, 0x00030003
    s_mov_b32 exec_hi, 0x00030003
    buffer_store_dwordx4 v[96:99], v28, s[24:27], s36 offen sc1
    s_mov_b64 exec, -1
    s_nop 3
L_recurrent_scan__compressed_kv_cla__moe_arch_mod__prompt_kernel_g_193:
    s_branch L_recurrent_scan__compressed_kv_cla__moe_arch_mod__prompt_kernel_back_196
L_recurrent_scan__compressed_kv_cla__moe_arch_mod__prompt_kernel_rare_200:
    s_cmp_eq_u32 s35, 0
    s_cbranch_scc0 L_recurrent_scan__compressed_kv_cla__moe_arch_mod__prompt_kernel_swn_198
    s_cmp_lt_u32 s28, 7
    s_cbranch_scc0 L_recurrent_scan__compressed_kv_cla__moe_arch_mod__prompt_kernel_g_192
    v_lshrrev_b32 v28, 4, v1
    v_bfe_u32 v26, v1, 2, 2
    v_lshl_add_u32 v26, v28, 3, v26
    v_lshlrev_b32 v26, 7, v26
    v_and_b32 v27, 3, v1
    v_lshl_add_u32 v26, v27, 3, v26
    v_bfe_u32 v27, v1, 3, 2
    s_lshl_b32 s36, s28, 12
    s_add_u32 s36, s36, 131072
    v_add_u32 v26, s36, v26
    v_xor_b32 v28, 0, v27
    v_lshl_add_u32 v28, v28, 5, v26
    ds_read_b64_tr_b16 v[112:113], v28 offset:0
    ds_read_b64_tr_b16 v[114:115], v28 offset:512
    v_xor_b32 v28, 1, v27
    v_lshl_add_u32 v28, v28, 5, v26
    ds_read_b64_tr_b16 v[116:117], v28 offset:0
    ds_read_b64_tr_b16 v[118:119], v28 offset:512
    v_xor_b32 v28, 2, v27
    v_lshl_add_u32 v28, v28, 5, v26
    ds_read_b64_tr_b16 v[120:121], v28 offset:0
    ds_read_b64_tr_b16 v[122:123], v28 offset:512
    v_xor_b32 v28, 3, v27
    v_lshl_add_u32 v28, v28, 5, v26
    ds_read_b64_tr_b16 v[124:125], v28 offset:0
    ds_read_b64_tr_b16 v[126:127], v28 offset:512
    v_add_f32_dpp v96, v96, v96 row_ror:4 row_mask:0xf bank_mask:0xf
    v_add_f32_dpp v97, v97, v97 row_ror:4 row_mask:0xf bank_mask:0xf
    v_add_f32_dpp v98, v98, v98 row_ror:4 row_mask:0xf bank_mask:0xf
    v_add_f32_dpp v99, v99, v99 row_ror:4 row_mask:0xf bank_mask:0xf
    v_add_f32_dpp v100, v100, v100 row_ror:4 row_mask:0xf bank_mask:0xf
    v_add_f32_dpp v101, v101, v101 row_ror:4 row_mask:0xf bank_mask:0xf
    v_add_f32_dpp v102, v102, v102 row_ror:4 row_mask:0xf bank_mask:0xf
    v_add_f32_dpp v103, v103, v103 row_ror:4 row_mask:0xf bank_mask:0xf
    v_add_f32_dpp v96, v96, v96 row_ror:8 row_mask:0xf bank_mask:0xf
    v_add_f32_dpp v97, v97, v97 row_ror:8 row_mask:0xf bank_mask:0xf
    v_add_f32_dpp v98, v98, v98 row_ror:8 row_mask:0xf bank_mask:0xf
    v_add_f32_dpp v99, v99, v99 row_ror:8 row_mask:0xf bank_mask:0xf
    v_add_f32_dpp v100, v100, v100 row_ror:8 row_mask:0xf bank_mask:0xf
    v_add_f32_dpp v101, v101, v101 row_ror:8 row_mask:0xf bank_mask:0xf
    v_add_f32_dpp v102, v102, v102 row_ror:8 row_mask:0xf bank_mask:0xf
    v_add_f32_dpp v103, v103, v103 row_ror:8 row_mask:0xf bank_mask:0xf
    v_cvt_pk_bf16_f32 v29, v96, v97
    v_lshlrev_b32 v96, 16, v29
    v_and_b32 v97, 0xffff0000, v29
    v_cvt_pk_bf16_f32 v29, v98, v99
    v_lshlrev_b32 v98, 16, v29
    v_and_b32 v99, 0xffff0000, v29
    v_cvt_pk_bf16_f32 v29, v100, v101
    v_lshlrev_b32 v100, 16, v29
    v_and_b32 v101, 0xffff0000, v29
    v_cvt_pk_bf16_f32 v29, v102, v103
    v_lshlrev_b32 v102, 16, v29
    v_and_b32 v103, 0xffff0000, v29
    v_mul_f32 v104, 0xbfb8aa3b, v96
    v_mul_f32 v105, 0xbfb8aa3b, v97
    v_mul_f32 v106, 0xbfb8aa3b, v98
    v_mul_f32 v107, 0xbfb8aa3b, v99
    v_mul_f32 v108, 0xbfb8aa3b, v100
    v_mul_f32 v109, 0xbfb8aa3b, v101
    v_mul_f32 v110, 0xbfb8aa3b, v102
    v_mul_f32 v111, 0xbfb8aa3b, v103
    v_exp_f32 v104, v104
    v_exp_f32 v105, v105
    v_exp_f32 v106, v106
    v_exp_f32 v107, v107
    v_exp_f32 v108, v108
    v_exp_f32 v109, v109
    v_exp_f32 v110, v110
    v_exp_f32 v111, v111
    v_add_f32 v104, 1.0, v104
    v_add_f32 v105, 1.0, v105
    v_add_f32 v106, 1.0, v106
    v_add_f32 v107, 1.0, v107
    v_add_f32 v108, 1.0, v108
    v_add_f32 v109, 1.0, v109
    v_add_f32 v110, 1.0, v110
    v_add_f32 v111, 1.0, v111
    v_rcp_f32 v104, v104
    v_rcp_f32 v105, v105
    v_rcp_f32 v106, v106
    v_rcp_f32 v107, v107
    v_rcp_f32 v108, v108
    v_rcp_f32 v109, v109
    v_rcp_f32 v110, v110
    v_rcp_f32 v111, v111
    v_mul_f32 v104, v96, v104
    v_mul_f32 v105, v97, v105
    v_mul_f32 v106, v98, v106
    v_mul_f32 v107, v99, v107
    v_mul_f32 v108, v100, v108
    v_mul_f32 v109, v101, v109
    v_mul_f32 v110, v102, v110
    v_mul_f32 v111, v103, v111
    v_cvt_pk_bf16_f32 v29, v104, v105
    v_lshlrev_b32 v104, 16, v29
    v_and_b32 v105, 0xffff0000, v29
    v_cvt_pk_bf16_f32 v29, v106, v107
    v_lshlrev_b32 v106, 16, v29
    v_and_b32 v107, 0xffff0000, v29
    v_cvt_pk_bf16_f32 v29, v108, v109
    v_lshlrev_b32 v108, 16, v29
    v_and_b32 v109, 0xffff0000, v29
    v_cvt_pk_bf16_f32 v29, v110, v111
    v_lshlrev_b32 v110, 16, v29
    v_and_b32 v111, 0xffff0000, v29
    v_mul_f32_dpp v96, v96, v104 quad_perm:[2,3,0,1] row_mask:0xf bank_mask:0xf
    v_mul_f32_dpp v97, v97, v105 quad_perm:[2,3,0,1] row_mask:0xf bank_mask:0xf
    v_mul_f32_dpp v98, v98, v106 quad_perm:[2,3,0,1] row_mask:0xf bank_mask:0xf
    v_mul_f32_dpp v99, v99, v107 quad_perm:[2,3,0,1] row_mask:0xf bank_mask:0xf
    v_mul_f32_dpp v100, v100, v108 quad_perm:[2,3,0,1] row_mask:0xf bank_mask:0xf
    v_mul_f32_dpp v101, v101, v109 quad_perm:[2,3,0,1] row_mask:0xf bank_mask:0xf
    v_mul_f32_dpp v102, v102, v110 quad_perm:[2,3,0,1] row_mask:0xf bank_mask:0xf
    v_mul_f32_dpp v103, v103, v111 quad_perm:[2,3,0,1] row_mask:0xf bank_mask:0xf
    v_cvt_pk_bf16_f32 v36, v96, v97
    v_cvt_pk_bf16_f32 v37, v98, v99
    v_cvt_pk_bf16_f32 v38, v100, v101
    v_cvt_pk_bf16_f32 v39, v102, v103
    s_waitcnt lgkmcnt(0)
    v_lshl_add_u32 v28, v1, 4, s36
    v_mfma_f32_16x16x32_bf16 v[96:99], v[112:115], v[36:39], 0
    v_mfma_f32_16x16x32_bf16 v[100:103], v[116:119], v[36:39], 0
    v_mfma_f32_16x16x32_bf16 v[104:107], v[120:123], v[36:39], 0
    v_mfma_f32_16x16x32_bf16 v[108:111], v[124:127], v[36:39], 0
    s_nop 7
    ds_write_b128 v28, v[96:99] offset:0
    ds_write_b128 v28, v[100:103] offset:1024
    ds_write_b128 v28, v[104:107] offset:2048
    ds_write_b128 v28, v[108:111] offset:3072
L_recurrent_scan__compressed_kv_cla__moe_arch_mod__prompt_kernel_g_192:
    s_branch L_recurrent_scan__compressed_kv_cla__moe_arch_mod__prompt_kernel_swend_197
L_recurrent_scan__compressed_kv_cla__moe_arch_mod__prompt_kernel_swn_198:
    s_cmp_eq_u32 s35, 1
    s_cbranch_scc0 L_recurrent_scan__compressed_kv_cla__moe_arch_mod__prompt_kernel_swn_199
    s_cmp_eq_u32 s28, 0
    s_cbranch_scc0 L_recurrent_scan__compressed_kv_cla__moe_arch_mod__prompt_kernel_g_194
    s_and_b32 s36, s2, 15
    s_add_u32 s36, s36, 96
    s_lshl_b32 s36, s36, 7
    v_mov_b32 v26, s36
    v_mov_b32 v27, 1
    s_mov_b64 exec, 1
    global_atomic_add v26, v27, s[90:91]
    s_mov_b64 exec, -1
    s_nop 3
L_recurrent_scan__compressed_kv_cla__moe_arch_mod__prompt_kernel_g_194:
    s_branch L_recurrent_scan__compressed_kv_cla__moe_arch_mod__prompt_kernel_swend_197
L_recurrent_scan__compressed_kv_cla__moe_arch_mod__prompt_kernel_swn_199:
    buffer_load_dwordx2 v[40:41], v15, s[16:19], 0 offen offset:0
    buffer_load_dwordx2 v[42:43], v15, s[16:19], 0 offen offset:32
    buffer_load_dwordx2 v[44:45], v15, s[16:19], 0 offen offset:64
    buffer_load_dwordx2 v[46:47], v15, s[16:19], 0 offen offset:96
    s_mov_b32 s36, 4194304
    buffer_load_dwordx2 v[48:49], v16, s[24:27], s36 offen sc1
L_recurrent_scan__compressed_kv_cla__moe_arch_mod__prompt_kernel_swend_197:
    s_branch L_recurrent_scan__compressed_kv_cla__moe_arch_mod__prompt_kernel_back_201
L_recurrent_scan__compressed_kv_cla__moe_arch_mod__prompt_kernel_rare_208:
    s_cmp_eq_u32 s35, 0
    s_cbranch_scc0 L_recurrent_scan__compressed_kv_cla__moe_arch_mod__prompt_kernel_swn_207
    s_mov_b32 s61, 0x40000
L_recurrent_scan__compressed_kv_cla__moe_arch_mod__prompt_kernel_cspin_202:
    s_sub_u32 s61, s61, 1
    s_cbranch_scc1 L_recurrent_scan__compressed_kv_cla__moe_arch_mod__prompt_kernel_cspinx_203
    global_load_dword v31, v30, s[90:91] sc1
    s_waitcnt vmcnt(0)
    v_cmp_le_u32 vcc, 4, v31
    s_nop 0
    s_and_b32 s60, vcc_lo, 15
    s_and_b32 s36, s60, 7
    s_cmp_eq_u32 s36, 7
    s_cbranch_scc1 L_recurrent_scan__compressed_kv_cla__moe_arch_mod__prompt_kernel_cspinx_203
    s_sleep 6
    s_branch L_recurrent_scan__compressed_kv_cla__moe_arch_mod__prompt_kernel_cspin_202
L_recurrent_scan__compressed_kv_cla__moe_arch_mod__prompt_kernel_cspinx_203:
    s_branch L_recurrent_scan__compressed_kv_cla__moe_arch_mod__prompt_kernel_swend_206
L_recurrent_scan__compressed_kv_cla__moe_arch_mod__prompt_kernel_swn_207:
    s_mov_b32 s61, 0x40000
L_recurrent_scan__compressed_kv_cla__moe_arch_mod__prompt_kernel_cspin_204:
    s_sub_u32 s61, s61, 1
    s_cbranch_scc1 L_recurrent_scan__compressed_kv_cla__moe_arch_mod__prompt_kernel_cspinx_205
    global_load_dword v31, v30, s[90:91] sc1
    s_waitcnt vmcnt(0)
    v_cmp_le_u32 vcc, 4, v31
    s_nop 0
    s_and_b32 s60, vcc_lo, 15
    s_and_b32 s36, s60, 15
    s_cmp_eq_u32 s36, 15
    s_cbranch_scc1 L_recurrent_scan__compressed_kv_cla__moe_arch_mod__prompt_kernel_cspinx_205
    s_sleep 6
    s_branch L_recurrent_scan__compressed_kv_cla__moe_arch_mod__prompt_kernel_cspin_204
L_recurrent_scan__compressed_kv_cla__moe_arch_mod__prompt_kernel_cspinx_205:
L_recurrent_scan__compressed_kv_cla__moe_arch_mod__prompt_kernel_swend_206:
    s_branch L_recurrent_scan__compressed_kv_cla__moe_arch_mod__prompt_kernel_back_209
L_recurrent_scan__compressed_kv_cla__moe_arch_mod__prompt_kernel_rare_212:
    s_mov_b32 s61, 0x40000
L_recurrent_scan__compressed_kv_cla__moe_arch_mod__prompt_kernel_spin_210:
    s_sub_u32 s61, s61, 1
    s_cbranch_scc1 L_recurrent_scan__compressed_kv_cla__moe_arch_mod__prompt_kernel_spinx_211
    s_sleep 8
    global_load_dword v30, v31, s[90:91] sc1
    s_waitcnt vmcnt(0)
    v_readfirstlane_b32 s36, v30
    s_nop 0
    s_cmp_lt_u32 s36, 28
    s_cbranch_scc1 L_recurrent_scan__compressed_kv_cla__moe_arch_mod__prompt_kernel_spin_210
L_recurrent_scan__compressed_kv_cla__moe_arch_mod__prompt_kernel_spinx_211:
    s_branch L_recurrent_scan__compressed_kv_cla__moe_arch_mod__prompt_kernel_back_213
L_recurrent_scan__compressed_kv_cla__moe_arch_mod__prompt_kernel_rare_218:
    v_mov_b32 v160, 0
    v_mov_b32 v161, 0
    v_mov_b32 v162, 0
    v_mov_b32 v163, 0
    v_mov_b32 v164, 0
    v_mov_b32 v165, 0
    v_mov_b32 v166, 0
    v_mov_b32 v167, 0
    v_mov_b32 v168, 0
    v_mov_b32 v169, 0
    v_mov_b32 v170, 0
    v_mov_b32 v171, 0
    v_mov_b32 v172, 0
    v_mov_b32 v173, 0
    v_mov_b32 v174, 0
    v_mov_b32 v175, 0
    s_add_u32 s36, s30, 96
    s_lshl_b32 s36, s36, 7
    v_mov_b32 v22, s36
    s_mov_b32 s61, 0x40000
L_recurrent_scan__compressed_kv_cla__moe_arch_mod__prompt_kernel_rt_spin_1:
    s_sub_u32 s61, s61, 1
    s_cbranch_scc1 L_recurrent_scan__compressed_kv_cla__moe_arch_mod__prompt_kernel_rt_spinx_2
    s_sleep 1
    global_load_dword v23, v22, s[90:91] sc1
    s_waitcnt vmcnt(0)
    v_readfirstlane_b32 s36, v23
    s_nop 0
    s_cmp_lt_u32 s36, 16
    s_cbranch_scc1 L_recurrent_scan__compressed_kv_cla__moe_arch_mod__prompt_kernel_rt_spin_1
L_recurrent_scan__compressed_kv_cla__moe_arch_mod__prompt_kernel_rt_spinx_2:
    s_sub_u32 s36, s56, s38
    s_cmp_lt_u32 s36, 16
    s_cbranch_scc0 L_recurrent_scan__compressed_kv_cla__moe_arch_mod__prompt_kernel_rt_noy_3
    s_lshl_b32 s37, s30, 8
    s_add_u32 s37, s37, 59768832
    v_and_b32 v22, 15, v1
    v_lshlrev_b32 v22, 13, v22
    v_lshl_add_u32 v22, v19, 4, v22
    buffer_load_dwordx4 v[64:67], v22, s[24:27], s37 offen offset:0 sc1
    buffer_load_dwordx4 v[68:71], v22, s[24:27], s37 offen offset:64 sc1
    buffer_load_dwordx4 v[72:75], v22, s[24:27], s37 offen offset:128 sc1
    buffer_load_dwordx4 v[76:79], v22, s[24:27], s37 offen offset:192 sc1
    s_and_b32 s36, s58, 0xffff0000
    s_cmp_lt_i32 s36, 0
    s_cselect_b32 s37, 0x80000000, -1
    s_xor_b32 s36, s36, s37
    s_and_b32 s36, s36, 0xffff0000
    v_mov_b32 v24, s36
    v_mul_f32 v24, 0xbfb8aa3b, v24
    v_exp_f32 v24, v24
    s_nop 0
    v_add_f32 v24, 1.0, v24
    v_rcp_f32 v24, v24
    s_nop 0
    v_cvt_pk_bf16_f32 v24, v24, v24
    v_lshlrev_b32 v24, 16, v24
    s_waitcnt vmcnt(0)
    v_add_f32_dpp v64, v64, v64 quad_perm:[1,0,3,2] row_mask:0xf bank_mask:0xf
    v_add_f32_dpp v65, v65, v65 quad_perm:[1,0,3,2] row_mask:0xf bank_mask:0xf
    v_add_f32_dpp v66, v66, v66 quad_perm:[1,0,3,2] row_mask:0xf bank_mask:0xf
    v_add_f32_dpp v67, v67, v67 quad_perm:[1,0,3,2] row_mask:0xf bank_mask:0xf
    v_add_f32_dpp v68, v68, v68 quad_perm:[1,0,3,2] row_mask:0xf bank_mask:0xf
    v_add_f32_dpp v69, v69, v69 quad_perm:[1,0,3,2] row_mask:0xf bank_mask:0xf
    v_add_f32_dpp v70, v70, v70 quad_perm:[1,0,3,2] row_mask:0xf bank_mask:0xf
    v_add_f32_dpp v71, v71, v71 quad_perm:[1,0,3,2] row_mask:0xf bank_mask:0xf
    v_add_f32_dpp v72, v72, v72 quad_perm:[1,0,3,2] row_mask:0xf bank_mask:0xf
    v_add_f32_dpp v73, v73, v73 quad_perm:[1,0,3,2] row_mask:0xf bank_mask:0xf
    v_add_f32_dpp v74, v74, v74 quad_perm:[1,0,3,2] row_mask:0xf bank_mask:0xf
    v_add_f32_dpp v75, v75, v75 quad_perm:[1,0,3,2] row_mask:0xf bank_mask:0xf
    v_add_f32_dpp v76, v76, v76 quad_perm:[1,0,3,2] row_mask:0xf bank_mask:0xf
    v_add_f32_dpp v77, v77, v77 quad_perm:[1,0,3,2] row_mask:0xf bank_mask:0xf
    v_add_f32_dpp v78, v78, v78 quad_perm:[1,0,3,2] row_mask:0xf bank_mask:0xf
    v_add_f32_dpp v79, v79, v79 quad_perm:[1,0,3,2] row_mask:0xf bank_mask:0xf
    v_add_f32_dpp v64, v64, v64 quad_perm:[2,3,0,1] row_mask:0xf bank_mask:0xf
    v_add_f32_dpp v65, v65, v65 quad_perm:[2,3,0,1] row_mask:0xf bank_mask:0xf
    v_add_f32_dpp v66, v66, v66 quad_perm:[2,3,0,1] row_mask:0xf bank_mask:0xf
    v_add_f32_dpp v67, v67, v67 quad_perm:[2,3,0,1] row_mask:0xf bank_mask:0xf
    v_add_f32_dpp v68, v68, v68 quad_perm:[2,3,0,1] row_mask:0xf bank_mask:0xf
    v_add_f32_dpp v69, v69, v69 quad_perm:[2,3,0,1] row_mask:0xf bank_mask:0xf
    v_add_f32_dpp v70, v70, v70 quad_perm:[2,3,0,1] row_mask:0xf bank_mask:0xf
    v_add_f32_dpp v71, v71, v71 quad_perm:[2,3,0,1] row_mask:0xf bank_mask:0xf
    v_add_f32_dpp v72, v72, v72 quad_perm:[2,3,0,1] row_mask:0xf bank_mask:0xf
    v_add_f32_dpp v73, v73, v73 quad_perm:[2,3,0,1] row_mask:0xf bank_mask:0xf
    v_add_f32_dpp v74, v74, v74 quad_perm:[2,3,0,1] row_mask:0xf bank_mask:0xf
    v_add_f32_dpp v75, v75, v75 quad_perm:[2,3,0,1] row_mask:0xf bank_mask:0xf
    v_add_f32_dpp v76, v76, v76 quad_perm:[2,3,0,1] row_mask:0xf bank_mask:0xf
    v_add_f32_dpp v77, v77, v77 quad_perm:[2,3,0,1] row_mask:0xf bank_mask:0xf
    v_add_f32_dpp v78, v78, v78 quad_perm:[2,3,0,1] row_mask:0xf bank_mask:0xf
    v_add_f32_dpp v79, v79, v79 quad_perm:[2,3,0,1] row_mask:0xf bank_mask:0xf
    v_add_f32_dpp v64, v64, v64 row_half_mirror row_mask:0xf bank_mask:0xf
    v_add_f32_dpp v65, v65, v65 row_half_mirror row_mask:0xf bank_mask:0xf
    v_add_f32_dpp v66, v66, v66 row_half_mirror row_mask:0xf bank_mask:0xf
    v_add_f32_dpp v67, v67, v67 row_half_mirror row_mask:0xf bank_mask:0xf
    v_add_f32_dpp v68, v68, v68 row_half_mirror row_mask:0xf bank_mask:0xf
    v_add_f32_dpp v69, v69, v69 row_half_mirror row_mask:0xf bank_mask:0xf
    v_add_f32_dpp v70, v70, v70 row_half_mirror row_mask:0xf bank_mask:0xf
    v_add_f32_dpp v71, v71, v71 row_half_mirror row_mask:0xf bank_mask:0xf
    v_add_f32_dpp v72, v72, v72 row_half_mirror row_mask:0xf bank_mask:0xf
    v_add_f32_dpp v73, v73, v73 row_half_mirror row_mask:0xf bank_mask:0xf
    v_add_f32_dpp v74, v74, v74 row_half_mirror row_mask:0xf bank_mask:0xf
    v_add_f32_dpp v75, v75, v75 row_half_mirror row_mask:0xf bank_mask:0xf
    v_add_f32_dpp v76, v76, v76 row_half_mirror row_mask:0xf bank_mask:0xf
    v_add_f32_dpp v77, v77, v77 row_half_mirror row_mask:0xf bank_mask:0xf
    v_add_f32_dpp v78, v78, v78 row_half_mirror row_mask:0xf bank_mask:0xf
    v_add_f32_dpp v79, v79, v79 row_half_mirror row_mask:0xf bank_mask:0xf
    v_add_f32_dpp v64, v64, v64 row_mirror row_mask:0xf bank_mask:0xf
    v_add_f32_dpp v65, v65, v65 row_mirror row_mask:0xf bank_mask:0xf
    v_add_f32_dpp v66, v66, v66 row_mirror row_mask:0xf bank_mask:0xf
    v_add_f32_dpp v67, v67, v67 row_mirror row_mask:0xf bank_mask:0xf
    v_add_f32_dpp v68, v68, v68 row_mirror row_mask:0xf bank_mask:0xf
    v_add_f32_dpp v69, v69, v69 row_mirror row_mask:0xf bank_mask:0xf
    v_add_f32_dpp v70, v70, v70 row_mirror row_mask:0xf bank_mask:0xf
    v_add_f32_dpp v71, v71, v71 row_mirror row_mask:0xf bank_mask:0xf
    v_add_f32_dpp v72, v72, v72 row_mirror row_mask:0xf bank_mask:0xf
    v_add_f32_dpp v73, v73, v73 row_mirror row_mask:0xf bank_mask:0xf
    v_add_f32_dpp v74, v74, v74 row_mirror row_mask:0xf bank_mask:0xf
    v_add_f32_dpp v75, v75, v75 row_mirror row_mask:0xf bank_mask:0xf
    v_add_f32_dpp v76, v76, v76 row_mirror row_mask:0xf bank_mask:0xf
    v_add_f32_dpp v77, v77, v77 row_mirror row_mask:0xf bank_mask:0xf
    v_add_f32_dpp v78, v78, v78 row_mirror row_mask:0xf bank_mask:0xf
    v_add_f32_dpp v79, v79, v79 row_mirror row_mask:0xf bank_mask:0xf
    v_cmp_eq_u32 vcc, s56, v14
    v_cvt_pk_bf16_f32 v64, v64, v64
    v_lshlrev_b32 v64, 16, v64
    v_mul_f32 v64, v24, v64
    v_cvt_pk_bf16_f32 v64, v64, v64
    v_lshlrev_b32 v64, 16, v64
    v_cndmask_b32 v160, v160, v64, vcc
    v_cvt_pk_bf16_f32 v65, v65, v65
    v_lshlrev_b32 v65, 16, v65
    v_mul_f32 v65, v24, v65
    v_cvt_pk_bf16_f32 v65, v65, v65
    v_lshlrev_b32 v65, 16, v65
    v_cndmask_b32 v161, v161, v65, vcc
    v_cvt_pk_bf16_f32 v66, v66, v66
    v_lshlrev_b32 v66, 16, v66
    v_mul_f32 v66, v24, v66
    v_cvt_pk_bf16_f32 v66, v66, v66
    v_lshlrev_b32 v66, 16, v66
    v_cndmask_b32 v162, v162, v66, vcc
    v_cvt_pk_bf16_f32 v67, v67, v67
    v_lshlrev_b32 v67, 16, v67
    v_mul_f32 v67, v24, v67
    v_cvt_pk_bf16_f32 v67, v67, v67
    v_lshlrev_b32 v67, 16, v67
    v_cndmask_b32 v163, v163, v67, vcc
    v_cvt_pk_bf16_f32 v68, v68, v68
    v_lshlrev_b32 v68, 16, v68
    v_mul_f32 v68, v24, v68
    v_cvt_pk_bf16_f32 v68, v68, v68
    v_lshlrev_b32 v68, 16, v68
    v_cndmask_b32 v164, v164, v68, vcc
    v_cvt_pk_bf16_f32 v69, v69, v69
    v_lshlrev_b32 v69, 16, v69
    v_mul_f32 v69, v24, v69
    v_cvt_pk_bf16_f32 v69, v69, v69
    v_lshlrev_b32 v69, 16, v69
    v_cndmask_b32 v165, v165, v69, vcc
    v_cvt_pk_bf16_f32 v70, v70, v70
    v_lshlrev_b32 v70, 16, v70
    v_mul_f32 v70, v24, v70
    v_cvt_pk_bf16_f32 v70, v70, v70
    v_lshlrev_b32 v70, 16, v70
    v_cndmask_b32 v166, v166, v70, vcc
    v_cvt_pk_bf16_f32 v71, v71, v71
    v_lshlrev_b32 v71, 16, v71
    v_mul_f32 v71, v24, v71
    v_cvt_pk_bf16_f32 v71, v71, v71
    v_lshlrev_b32 v71, 16, v71
    v_cndmask_b32 v167, v167, v71, vcc
    v_cvt_pk_bf16_f32 v72, v72, v72
    v_lshlrev_b32 v72, 16, v72
    v_mul_f32 v72, v24, v72
    v_cvt_pk_bf16_f32 v72, v72, v72
    v_lshlrev_b32 v72, 16, v72
    v_cndmask_b32 v168, v168, v72, vcc
    v_cvt_pk_bf16_f32 v73, v73, v73
    v_lshlrev_b32 v73, 16, v73
    v_mul_f32 v73, v24, v73
    v_cvt_pk_bf16_f32 v73, v73, v73
    v_lshlrev_b32 v73, 16, v73
    v_cndmask_b32 v169, v169, v73, vcc
    v_cvt_pk_bf16_f32 v74, v74, v74
    v_lshlrev_b32 v74, 16, v74
    v_mul_f32 v74, v24, v74
    v_cvt_pk_bf16_f32 v74, v74, v74
    v_lshlrev_b32 v74, 16, v74
    v_cndmask_b32 v170, v170, v74, vcc
    v_cvt_pk_bf16_f32 v75, v75, v75
    v_lshlrev_b32 v75, 16, v75
    v_mul_f32 v75, v24, v75
    v_cvt_pk_bf16_f32 v75, v75, v75
    v_lshlrev_b32 v75, 16, v75
    v_cndmask_b32 v171, v171, v75, vcc
    v_cvt_pk_bf16_f32 v76, v76, v76
    v_lshlrev_b32 v76, 16, v76
    v_mul_f32 v76, v24, v76
    v_cvt_pk_bf16_f32 v76, v76, v76
    v_lshlrev_b32 v76, 16, v76
    v_cndmask_b32 v172, v172, v76, vcc
    v_cvt_pk_bf16_f32 v77, v77, v77
    v_lshlrev_b32 v77, 16, v77
    v_mul_f32 v77, v24, v77
    v_cvt_pk_bf16_f32 v77, v77, v77
    v_lshlrev_b32 v77, 16, v77
    v_cndmask_b32 v173, v173, v77, vcc
    v_cvt_pk_bf16_f32 v78, v78, v78
    v_lshlrev_b32 v78, 16, v78
    v_mul_f32 v78, v24, v78
    v_cvt_pk_bf16_f32 v78, v78, v78
    v_lshlrev_b32 v78, 16, v78
    v_cndmask_b32 v174, v174, v78, vcc
    v_cvt_pk_bf16_f32 v79, v79, v79
    v_lshlrev_b32 v79, 16, v79
    v_mul_f32 v79, v24, v79
    v_cvt_pk_bf16_f32 v79, v79, v79
    v_lshlrev_b32 v79, 16, v79
    v_cndmask_b32 v175, v175, v79, vcc
L_recurrent_scan__compressed_kv_cla__moe_arch_mod__prompt_kernel_rt_noy_3:
    s_sub_u32 s36, s57, s38
    s_cmp_lt_u32 s36, 16
    s_cbranch_scc0 L_recurrent_scan__compressed_kv_cla__moe_arch_mod__prompt_kernel_rt_noy_4
    s_lshl_b32 s37, s30, 8
    s_add_u32 s37, s37, 59772928
    v_and_b32 v22, 15, v1
    v_lshlrev_b32 v22, 13, v22
    v_lshl_add_u32 v22, v19, 4, v22
    buffer_load_dwordx4 v[64:67], v22, s[24:27], s37 offen offset:0 sc1
    buffer_load_dwordx4 v[68:71], v22, s[24:27], s37 offen offset:64 sc1
    buffer_load_dwordx4 v[72:75], v22, s[24:27], s37 offen offset:128 sc1
    buffer_load_dwordx4 v[76:79], v22, s[24:27], s37 offen offset:192 sc1
    s_and_b32 s36, s59, 0xffff0000
    s_cmp_lt_i32 s36, 0
    s_cselect_b32 s37, 0x80000000, -1
    s_xor_b32 s36, s36, s37
    s_and_b32 s36, s36, 0xffff0000
    v_mov_b32 v24, s36
    v_mul_f32 v24, 0xbfb8aa3b, v24
    v_exp_f32 v24, v24
    s_nop 0
    v_add_f32 v24, 1.0, v24
    v_rcp_f32 v24, v24
    s_nop 0
    v_cvt_pk_bf16_f32 v24, v24, v24
    v_lshlrev_b32 v24, 16, v24
    s_waitcnt vmcnt(0)
    v_add_f32_dpp v64, v64, v64 quad_perm:[1,0,3,2] row_mask:0xf bank_mask:0xf
    v_add_f32_dpp v65, v65, v65 quad_perm:[1,0,3,2] row_mask:0xf bank_mask:0xf
    v_add_f32_dpp v66, v66, v66 quad_perm:[1,0,3,2] row_mask:0xf bank_mask:0xf
    v_add_f32_dpp v67, v67, v67 quad_perm:[1,0,3,2] row_mask:0xf bank_mask:0xf
    v_add_f32_dpp v68, v68, v68 quad_perm:[1,0,3,2] row_mask:0xf bank_mask:0xf
    v_add_f32_dpp v69, v69, v69 quad_perm:[1,0,3,2] row_mask:0xf bank_mask:0xf
    v_add_f32_dpp v70, v70, v70 quad_perm:[1,0,3,2] row_mask:0xf bank_mask:0xf
    v_add_f32_dpp v71, v71, v71 quad_perm:[1,0,3,2] row_mask:0xf bank_mask:0xf
    v_add_f32_dpp v72, v72, v72 quad_perm:[1,0,3,2] row_mask:0xf bank_mask:0xf
    v_add_f32_dpp v73, v73, v73 quad_perm:[1,0,3,2] row_mask:0xf bank_mask:0xf
    v_add_f32_dpp v74, v74, v74 quad_perm:[1,0,3,2] row_mask:0xf bank_mask:0xf
    v_add_f32_dpp v75, v75, v75 quad_perm:[1,0,3,2] row_mask:0xf bank_mask:0xf
    v_add_f32_dpp v76, v76, v76 quad_perm:[1,0,3,2] row_mask:0xf bank_mask:0xf
    v_add_f32_dpp v77, v77, v77 quad_perm:[1,0,3,2] row_mask:0xf bank_mask:0xf
    v_add_f32_dpp v78, v78, v78 quad_perm:[1,0,3,2] row_mask:0xf bank_mask:0xf
    v_add_f32_dpp v79, v79, v79 quad_perm:[1,0,3,2] row_mask:0xf bank_mask:0xf
    v_add_f32_dpp v64, v64, v64 quad_perm:[2,3,0,1] row_mask:0xf bank_mask:0xf
    v_add_f32_dpp v65, v65, v65 quad_perm:[2,3,0,1] row_mask:0xf bank_mask:0xf
    v_add_f32_dpp v66, v66, v66 quad_perm:[2,3,0,1] row_mask:0xf bank_mask:0xf
    v_add_f32_dpp v67, v67, v67 quad_perm:[2,3,0,1] row_mask:0xf bank_mask:0xf
    v_add_f32_dpp v68, v68, v68 quad_perm:[2,3,0,1] row_mask:0xf bank_mask:0xf
    v_add_f32_dpp v69, v69, v69 quad_perm:[2,3,0,1] row_mask:0xf bank_mask:0xf
    v_add_f32_dpp v70, v70, v70 quad_perm:[2,3,0,1] row_mask:0xf bank_mask:0xf
    v_add_f32_dpp v71, v71, v71 quad_perm:[2,3,0,1] row_mask:0xf bank_mask:0xf
    v_add_f32_dpp v72, v72, v72 quad_perm:[2,3,0,1] row_mask:0xf bank_mask:0xf
    v_add_f32_dpp v73, v73, v73 quad_perm:[2,3,0,1] row_mask:0xf bank_mask:0xf
    v_add_f32_dpp v74, v74, v74 quad_perm:[2,3,0,1] row_mask:0xf bank_mask:0xf
    v_add_f32_dpp v75, v75, v75 quad_perm:[2,3,0,1] row_mask:0xf bank_mask:0xf
    v_add_f32_dpp v76, v76, v76 quad_perm:[2,3,0,1] row_mask:0xf bank_mask:0xf
    v_add_f32_dpp v77, v77, v77 quad_perm:[2,3,0,1] row_mask:0xf bank_mask:0xf
    v_add_f32_dpp v78, v78, v78 quad_perm:[2,3,0,1] row_mask:0xf bank_mask:0xf
    v_add_f32_dpp v79, v79, v79 quad_perm:[2,3,0,1] row_mask:0xf bank_mask:0xf
    v_add_f32_dpp v64, v64, v64 row_half_mirror row_mask:0xf bank_mask:0xf
    v_add_f32_dpp v65, v65, v65 row_half_mirror row_mask:0xf bank_mask:0xf
    v_add_f32_dpp v66, v66, v66 row_half_mirror row_mask:0xf bank_mask:0xf
    v_add_f32_dpp v67, v67, v67 row_half_mirror row_mask:0xf bank_mask:0xf
    v_add_f32_dpp v68, v68, v68 row_half_mirror row_mask:0xf bank_mask:0xf
    v_add_f32_dpp v69, v69, v69 row_half_mirror row_mask:0xf bank_mask:0xf
    v_add_f32_dpp v70, v70, v70 row_half_mirror row_mask:0xf bank_mask:0xf
    v_add_f32_dpp v71, v71, v71 row_half_mirror row_mask:0xf bank_mask:0xf
    v_add_f32_dpp v72, v72, v72 row_half_mirror row_mask:0xf bank_mask:0xf
    v_add_f32_dpp v73, v73, v73 row_half_mirror row_mask:0xf bank_mask:0xf
    v_add_f32_dpp v74, v74, v74 row_half_mirror row_mask:0xf bank_mask:0xf
    v_add_f32_dpp v75, v75, v75 row_half_mirror row_mask:0xf bank_mask:0xf
    v_add_f32_dpp v76, v76, v76 row_half_mirror row_mask:0xf bank_mask:0xf
    v_add_f32_dpp v77, v77, v77 row_half_mirror row_mask:0xf bank_mask:0xf
    v_add_f32_dpp v78, v78, v78 row_half_mirror row_mask:0xf bank_mask:0xf
    v_add_f32_dpp v79, v79, v79 row_half_mirror row_mask:0xf bank_mask:0xf
    v_add_f32_dpp v64, v64, v64 row_mirror row_mask:0xf bank_mask:0xf
    v_add_f32_dpp v65, v65, v65 row_mirror row_mask:0xf bank_mask:0xf
    v_add_f32_dpp v66, v66, v66 row_mirror row_mask:0xf bank_mask:0xf
    v_add_f32_dpp v67, v67, v67 row_mirror row_mask:0xf bank_mask:0xf
    v_add_f32_dpp v68, v68, v68 row_mirror row_mask:0xf bank_mask:0xf
    v_add_f32_dpp v69, v69, v69 row_mirror row_mask:0xf bank_mask:0xf
    v_add_f32_dpp v70, v70, v70 row_mirror row_mask:0xf bank_mask:0xf
    v_add_f32_dpp v71, v71, v71 row_mirror row_mask:0xf bank_mask:0xf
    v_add_f32_dpp v72, v72, v72 row_mirror row_mask:0xf bank_mask:0xf
    v_add_f32_dpp v73, v73, v73 row_mirror row_mask:0xf bank_mask:0xf
    v_add_f32_dpp v74, v74, v74 row_mirror row_mask:0xf bank_mask:0xf
    v_add_f32_dpp v75, v75, v75 row_mirror row_mask:0xf bank_mask:0xf
    v_add_f32_dpp v76, v76, v76 row_mirror row_mask:0xf bank_mask:0xf
    v_add_f32_dpp v77, v77, v77 row_mirror row_mask:0xf bank_mask:0xf
    v_add_f32_dpp v78, v78, v78 row_mirror row_mask:0xf bank_mask:0xf
    v_add_f32_dpp v79, v79, v79 row_mirror row_mask:0xf bank_mask:0xf
    v_cmp_eq_u32 vcc, s57, v14
    v_cvt_pk_bf16_f32 v64, v64, v64
    v_lshlrev_b32 v64, 16, v64
    v_mul_f32 v64, v24, v64
    v_cvt_pk_bf16_f32 v64, v64, v64
    v_lshlrev_b32 v64, 16, v64
    v_cndmask_b32 v160, v160, v64, vcc
    v_cvt_pk_bf16_f32 v65, v65, v65
    v_lshlrev_b32 v65, 16, v65
    v_mul_f32 v65, v24, v65
    v_cvt_pk_bf16_f32 v65, v65, v65
    v_lshlrev_b32 v65, 16, v65
    v_cndmask_b32 v161, v161, v65, vcc
    v_cvt_pk_bf16_f32 v66, v66, v66
    v_lshlrev_b32 v66, 16, v66
    v_mul_f32 v66, v24, v66
    v_cvt_pk_bf16_f32 v66, v66, v66
    v_lshlrev_b32 v66, 16, v66
    v_cndmask_b32 v162, v162, v66, vcc
    v_cvt_pk_bf16_f32 v67, v67, v67
    v_lshlrev_b32 v67, 16, v67
    v_mul_f32 v67, v24, v67
    v_cvt_pk_bf16_f32 v67, v67, v67
    v_lshlrev_b32 v67, 16, v67
    v_cndmask_b32 v163, v163, v67, vcc
    v_cvt_pk_bf16_f32 v68, v68, v68
    v_lshlrev_b32 v68, 16, v68
    v_mul_f32 v68, v24, v68
    v_cvt_pk_bf16_f32 v68, v68, v68
    v_lshlrev_b32 v68, 16, v68
    v_cndmask_b32 v164, v164, v68, vcc
    v_cvt_pk_bf16_f32 v69, v69, v69
    v_lshlrev_b32 v69, 16, v69
    v_mul_f32 v69, v24, v69
    v_cvt_pk_bf16_f32 v69, v69, v69
    v_lshlrev_b32 v69, 16, v69
    v_cndmask_b32 v165, v165, v69, vcc
    v_cvt_pk_bf16_f32 v70, v70, v70
    v_lshlrev_b32 v70, 16, v70
    v_mul_f32 v70, v24, v70
    v_cvt_pk_bf16_f32 v70, v70, v70
    v_lshlrev_b32 v70, 16, v70
    v_cndmask_b32 v166, v166, v70, vcc
    v_cvt_pk_bf16_f32 v71, v71, v71
    v_lshlrev_b32 v71, 16, v71
    v_mul_f32 v71, v24, v71
    v_cvt_pk_bf16_f32 v71, v71, v71
    v_lshlrev_b32 v71, 16, v71
    v_cndmask_b32 v167, v167, v71, vcc
    v_cvt_pk_bf16_f32 v72, v72, v72
    v_lshlrev_b32 v72, 16, v72
    v_mul_f32 v72, v24, v72
    v_cvt_pk_bf16_f32 v72, v72, v72
    v_lshlrev_b32 v72, 16, v72
    v_cndmask_b32 v168, v168, v72, vcc
    v_cvt_pk_bf16_f32 v73, v73, v73
    v_lshlrev_b32 v73, 16, v73
    v_mul_f32 v73, v24, v73
    v_cvt_pk_bf16_f32 v73, v73, v73
    v_lshlrev_b32 v73, 16, v73
    v_cndmask_b32 v169, v169, v73, vcc
    v_cvt_pk_bf16_f32 v74, v74, v74
    v_lshlrev_b32 v74, 16, v74
    v_mul_f32 v74, v24, v74
    v_cvt_pk_bf16_f32 v74, v74, v74
    v_lshlrev_b32 v74, 16, v74
    v_cndmask_b32 v170, v170, v74, vcc
    v_cvt_pk_bf16_f32 v75, v75, v75
    v_lshlrev_b32 v75, 16, v75
    v_mul_f32 v75, v24, v75
    v_cvt_pk_bf16_f32 v75, v75, v75
    v_lshlrev_b32 v75, 16, v75
    v_cndmask_b32 v171, v171, v75, vcc
    v_cvt_pk_bf16_f32 v76, v76, v76
    v_lshlrev_b32 v76, 16, v76
    v_mul_f32 v76, v24, v76
    v_cvt_pk_bf16_f32 v76, v76, v76
    v_lshlrev_b32 v76, 16, v76
    v_cndmask_b32 v172, v172, v76, vcc
    v_cvt_pk_bf16_f32 v77, v77, v77
    v_lshlrev_b32 v77, 16, v77
    v_mul_f32 v77, v24, v77
    v_cvt_pk_bf16_f32 v77, v77, v77
    v_lshlrev_b32 v77, 16, v77
    v_cndmask_b32 v173, v173, v77, vcc
    v_cvt_pk_bf16_f32 v78, v78, v78
    v_lshlrev_b32 v78, 16, v78
    v_mul_f32 v78, v24, v78
    v_cvt_pk_bf16_f32 v78, v78, v78
    v_lshlrev_b32 v78, 16, v78
    v_cndmask_b32 v174, v174, v78, vcc
    v_cvt_pk_bf16_f32 v79, v79, v79
    v_lshlrev_b32 v79, 16, v79
    v_mul_f32 v79, v24, v79
    v_cvt_pk_bf16_f32 v79, v79, v79
    v_lshlrev_b32 v79, 16, v79
    v_cndmask_b32 v175, v175, v79, vcc
L_recurrent_scan__compressed_kv_cla__moe_arch_mod__prompt_kernel_rt_noy_4:
    v_lshlrev_b32 v96, 16, v40
    v_and_b32 v97, 0xffff0000, v40
    v_sub_f32 v112, v96, v48
    v_sub_f32 v113, v97, v48
    v_cvt_pk_bf16_f32 v23, v112, v113
    v_lshlrev_b32 v112, 16, v23
    v_and_b32 v113, 0xffff0000, v23
    v_mul_f32 v112, v112, v49
    v_mul_f32 v113, v113, v49
    v_cvt_pk_bf16_f32 v23, v112, v113
    v_lshlrev_b32 v112, 16, v23
    v_and_b32 v113, 0xffff0000, v23
    v_add_f32 v112, v112, v160
    v_add_f32 v113, v113, v161
    v_cvt_pk_bf16_f32 v23, v112, v113
    v_lshlrev_b32 v112, 16, v23
    v_and_b32 v113, 0xffff0000, v23
    v_mul_f32 v24, 0xbfb8aa3b, v112
    v_mul_f32 v25, 0xbfb8aa3b, v113
    v_exp_f32 v24, v24
    v_exp_f32 v25, v25
    s_nop 0
    v_add_f32 v24, 1.0, v24
    v_add_f32 v25, 1.0, v25
    v_rcp_f32 v24, v24
    v_rcp_f32 v25, v25
    s_nop 0
    v_mul_f32 v112, v112, v24
    v_mul_f32 v113, v113, v25
    v_cvt_pk_bf16_f32 v23, v112, v113
    v_lshlrev_b32 v112, 16, v23
    v_and_b32 v113, 0xffff0000, v23
    v_lshlrev_b32 v98, 16, v41
    v_and_b32 v99, 0xffff0000, v41
    v_sub_f32 v114, v98, v48
    v_sub_f32 v115, v99, v48
    v_cvt_pk_bf16_f32 v23, v114, v115
    v_lshlrev_b32 v114, 16, v23
    v_and_b32 v115, 0xffff0000, v23
    v_mul_f32 v114, v114, v49
    v_mul_f32 v115, v115, v49
    v_cvt_pk_bf16_f32 v23, v114, v115
    v_lshlrev_b32 v114, 16, v23
    v_and_b32 v115, 0xffff0000, v23
    v_add_f32 v114, v114, v162
    v_add_f32 v115, v115, v163
    v_cvt_pk_bf16_f32 v23, v114, v115
    v_lshlrev_b32 v114, 16, v23
    v_and_b32 v115, 0xffff0000, v23
    v_mul_f32 v24, 0xbfb8aa3b, v114
    v_mul_f32 v25, 0xbfb8aa3b, v115
    v_exp_f32 v24, v24
    v_exp_f32 v25, v25
    s_nop 0
    v_add_f32 v24, 1.0, v24
    v_add_f32 v25, 1.0, v25
    v_rcp_f32 v24, v24
    v_rcp_f32 v25, v25
    s_nop 0
    v_mul_f32 v114, v114, v24
    v_mul_f32 v115, v115, v25
    v_cvt_pk_bf16_f32 v23, v114, v115
    v_lshlrev_b32 v114, 16, v23
    v_and_b32 v115, 0xffff0000, v23
    v_lshlrev_b32 v100, 16, v42
    v_and_b32 v101, 0xffff0000, v42
    v_sub_f32 v116, v100, v48
    v_sub_f32 v117, v101, v48
    v_cvt_pk_bf16_f32 v23, v116, v117
    v_lshlrev_b32 v116, 16, v23
    v_and_b32 v117, 0xffff0000, v23
    v_mul_f32 v116, v116, v49
    v_mul_f32 v117, v117, v49
    v_cvt_pk_bf16_f32 v23, v116, v117
    v_lshlrev_b32 v116, 16, v23
    v_and_b32 v117, 0xffff0000, v23
    v_add_f32 v116, v116, v164
    v_add_f32 v117, v117, v165
    v_cvt_pk_bf16_f32 v23, v116, v117
    v_lshlrev_b32 v116, 16, v23
    v_and_b32 v117, 0xffff0000, v23
    v_mul_f32 v24, 0xbfb8aa3b, v116
    v_mul_f32 v25, 0xbfb8aa3b, v117
    v_exp_f32 v24, v24
    v_exp_f32 v25, v25
    s_nop 0
    v_add_f32 v24, 1.0, v24
    v_add_f32 v25, 1.0, v25
    v_rcp_f32 v24, v24
    v_rcp_f32 v25, v25
    s_nop 0
    v_mul_f32 v116, v116, v24
    v_mul_f32 v117, v117, v25
    v_cvt_pk_bf16_f32 v23, v116, v117
    v_lshlrev_b32 v116, 16, v23
    v_and_b32 v117, 0xffff0000, v23
    v_lshlrev_b32 v102, 16, v43
    v_and_b32 v103, 0xffff0000, v43
    v_sub_f32 v118, v102, v48
    v_sub_f32 v119, v103, v48
    v_cvt_pk_bf16_f32 v23, v118, v119
    v_lshlrev_b32 v118, 16, v23
    v_and_b32 v119, 0xffff0000, v23
    v_mul_f32 v118, v118, v49
    v_mul_f32 v119, v119, v49
    v_cvt_pk_bf16_f32 v23, v118, v119
    v_lshlrev_b32 v118, 16, v23
    v_and_b32 v119, 0xffff0000, v23
    v_add_f32 v118, v118, v166
    v_add_f32 v119, v119, v167
    v_cvt_pk_bf16_f32 v23, v118, v119
    v_lshlrev_b32 v118, 16, v23
    v_and_b32 v119, 0xffff0000, v23
    v_mul_f32 v24, 0xbfb8aa3b, v118
    v_mul_f32 v25, 0xbfb8aa3b, v119
    v_exp_f32 v24, v24
    v_exp_f32 v25, v25
    s_nop 0
    v_add_f32 v24, 1.0, v24
    v_add_f32 v25, 1.0, v25
    v_rcp_f32 v24, v24
    v_rcp_f32 v25, v25
    s_nop 0
    v_mul_f32 v118, v118, v24
    v_mul_f32 v119, v119, v25
    v_cvt_pk_bf16_f32 v23, v118, v119
    v_lshlrev_b32 v118, 16, v23
    v_and_b32 v119, 0xffff0000, v23
    v_lshlrev_b32 v104, 16, v44
    v_and_b32 v105, 0xffff0000, v44
    v_sub_f32 v120, v104, v48
    v_sub_f32 v121, v105, v48
    v_cvt_pk_bf16_f32 v23, v120, v121
    v_lshlrev_b32 v120, 16, v23
    v_and_b32 v121, 0xffff0000, v23
    v_mul_f32 v120, v120, v49
    v_mul_f32 v121, v121, v49
    v_cvt_pk_bf16_f32 v23, v120, v121
    v_lshlrev_b32 v120, 16, v23
    v_and_b32 v121, 0xffff0000, v23
    v_add_f32 v120, v120, v168
    v_add_f32 v121, v121, v169
    v_cvt_pk_bf16_f32 v23, v120, v121
    v_lshlrev_b32 v120, 16, v23
    v_and_b32 v121, 0xffff0000, v23
    v_mul_f32 v24, 0xbfb8aa3b, v120
    v_mul_f32 v25, 0xbfb8aa3b, v121
    v_exp_f32 v24, v24
    v_exp_f32 v25, v25
    s_nop 0
    v_add_f32 v24, 1.0, v24
    v_add_f32 v25, 1.0, v25
    v_rcp_f32 v24, v24
    v_rcp_f32 v25, v25
    s_nop 0
    v_mul_f32 v120, v120, v24
    v_mul_f32 v121, v121, v25
    v_cvt_pk_bf16_f32 v23, v120, v121
    v_lshlrev_b32 v120, 16, v23
    v_and_b32 v121, 0xffff0000, v23
    v_lshlrev_b32 v106, 16, v45
    v_and_b32 v107, 0xffff0000, v45
    v_sub_f32 v122, v106, v48
    v_sub_f32 v123, v107, v48
    v_cvt_pk_bf16_f32 v23, v122, v123
    v_lshlrev_b32 v122, 16, v23
    v_and_b32 v123, 0xffff0000, v23
    v_mul_f32 v122, v122, v49
    v_mul_f32 v123, v123, v49
    v_cvt_pk_bf16_f32 v23, v122, v123
    v_lshlrev_b32 v122, 16, v23
    v_and_b32 v123, 0xffff0000, v23
    v_add_f32 v122, v122, v170
    v_add_f32 v123, v123, v171
    v_cvt_pk_bf16_f32 v23, v122, v123
    v_lshlrev_b32 v122, 16, v23
    v_and_b32 v123, 0xffff0000, v23
    v_mul_f32 v24, 0xbfb8aa3b, v122
    v_mul_f32 v25, 0xbfb8aa3b, v123
    v_exp_f32 v24, v24
    v_exp_f32 v25, v25
    s_nop 0
    v_add_f32 v24, 1.0, v24
    v_add_f32 v25, 1.0, v25
    v_rcp_f32 v24, v24
    v_rcp_f32 v25, v25
    s_nop 0
    v_mul_f32 v122, v122, v24
    v_mul_f32 v123, v123, v25
    v_cvt_pk_bf16_f32 v23, v122, v123
    v_lshlrev_b32 v122, 16, v23
    v_and_b32 v123, 0xffff0000, v23
    v_lshlrev_b32 v108, 16, v46
    v_and_b32 v109, 0xffff0000, v46
    v_sub_f32 v124, v108, v48
    v_sub_f32 v125, v109, v48
    v_cvt_pk_bf16_f32 v23, v124, v125
    v_lshlrev_b32 v124, 16, v23
    v_and_b32 v125, 0xffff0000, v23
    v_mul_f32 v124, v124, v49
    v_mul_f32 v125, v125, v49
    v_cvt_pk_bf16_f32 v23, v124, v125
    v_lshlrev_b32 v124, 16, v23
    v_and_b32 v125, 0xffff0000, v23
    v_add_f32 v124, v124, v172
    v_add_f32 v125, v125, v173
    v_cvt_pk_bf16_f32 v23, v124, v125
    v_lshlrev_b32 v124, 16, v23
    v_and_b32 v125, 0xffff0000, v23
    v_mul_f32 v24, 0xbfb8aa3b, v124
    v_mul_f32 v25, 0xbfb8aa3b, v125
    v_exp_f32 v24, v24
    v_exp_f32 v25, v25
    s_nop 0
    v_add_f32 v24, 1.0, v24
    v_add_f32 v25, 1.0, v25
    v_rcp_f32 v24, v24
    v_rcp_f32 v25, v25
    s_nop 0
    v_mul_f32 v124, v124, v24
    v_mul_f32 v125, v125, v25
    v_cvt_pk_bf16_f32 v23, v124, v125
    v_lshlrev_b32 v124, 16, v23
    v_and_b32 v125, 0xffff0000, v23
    v_lshlrev_b32 v110, 16, v47
    v_and_b32 v111, 0xffff0000, v47
    v_sub_f32 v126, v110, v48
    v_sub_f32 v127, v111, v48
    v_cvt_pk_bf16_f32 v23, v126, v127
    v_lshlrev_b32 v126, 16, v23
    v_and_b32 v127, 0xffff0000, v23
    v_mul_f32 v126, v126, v49
    v_mul_f32 v127, v127, v49
    v_cvt_pk_bf16_f32 v23, v126, v127
    v_lshlrev_b32 v126, 16, v23
    v_and_b32 v127, 0xffff0000, v23
    v_add_f32 v126, v126, v174
    v_add_f32 v127, v127, v175
    v_cvt_pk_bf16_f32 v23, v126, v127
    v_lshlrev_b32 v126, 16, v23
    v_and_b32 v127, 0xffff0000, v23
    v_mul_f32 v24, 0xbfb8aa3b, v126
    v_mul_f32 v25, 0xbfb8aa3b, v127
    v_exp_f32 v24, v24
    v_exp_f32 v25, v25
    s_nop 0
    v_add_f32 v24, 1.0, v24
    v_add_f32 v25, 1.0, v25
    v_rcp_f32 v24, v24
    v_rcp_f32 v25, v25
    s_nop 0
    v_mul_f32 v126, v126, v24
    v_mul_f32 v127, v127, v25
    v_cvt_pk_bf16_f32 v23, v126, v127
    v_lshlrev_b32 v126, 16, v23
    v_and_b32 v127, 0xffff0000, v23
    s_branch L_recurrent_scan__compressed_kv_cla__moe_arch_mod__prompt_kernel_back_219
L_recurrent_scan__compressed_kv_cla__moe_arch_mod__prompt_kernel_rare_222:
    s_mov_b32 s61, 0x40000
L_recurrent_scan__compressed_kv_cla__moe_arch_mod__prompt_kernel_spin_220:
    s_sub_u32 s61, s61, 1
    s_cbranch_scc1 L_recurrent_scan__compressed_kv_cla__moe_arch_mod__prompt_kernel_spinx_221
    s_sleep 1
    global_load_dword v31, v30, s[90:91] sc1
    s_waitcnt vmcnt(0)
    v_readfirstlane_b32 s36, v31
    s_nop 0
    s_cmp_lt_u32 s36, 8
    s_cbranch_scc1 L_recurrent_scan__compressed_kv_cla__moe_arch_mod__prompt_kernel_spin_220
L_recurrent_scan__compressed_kv_cla__moe_arch_mod__prompt_kernel_spinx_221:
    s_branch L_recurrent_scan__compressed_kv_cla__moe_arch_mod__prompt_kernel_back_223
L_end:
    s_endpgm
.section .rodata,"a"
.p2align 6
.amdhsa_kernel recurrent_scan__compressed_kv_cla__moe_arch_mod__prompt_kernel
  .amdhsa_next_free_vgpr 256
  .amdhsa_next_free_sgpr 102
  .amdhsa_accum_offset 256
  .amdhsa_group_segment_fixed_size 0
  .amdhsa_kernarg_size 112
  .amdhsa_user_sgpr_count 2
  .amdhsa_user_sgpr_kernarg_segment_ptr 1
  .amdhsa_system_sgpr_workgroup_id_x 1
.end_amdhsa_kernel
```

```asm
; @launch kernel=recurrent_scan__compressed_kv_cla__moe_arch_mod__prompt_kernel grid=(256,1,1) block=(512,1,1) lds=163840
.amdgcn_target "amdgcn-amd-amdhsa--gfx950"
.text
.globl recurrent_scan__compressed_kv_cla__moe_arch_mod__prompt_kernel
.p2align 8
.type recurrent_scan__compressed_kv_cla__moe_arch_mod__prompt_kernel,@function
recurrent_scan__compressed_kv_cla__moe_arch_mod__prompt_kernel:
    s_cmp_ge_u32 s2, 256
    s_cbranch_scc1 L_end
    s_load_dwordx4 s[44:47], s[0:1], 0
    s_load_dwordx2 s[52:53], s[0:1], 56
    s_load_dwordx4 s[48:51], s[0:1], 24
    s_getpc_b64 s[36:37]
L_pc:
    s_lshr_b32 s38, s2, 3
    s_lshl_b32 s38, s38, 7
    v_lshl_add_u32 v16, v0, 12, s38
    v_cmp_gt_u32 vcc, L_end-L_pc-4, v16
    v_mov_b32 v17, s37
    s_and_b64 exec, exec, vcc
    s_cbranch_execz L_nocpf
    v_add_co_u32 v16, vcc, s36, v16
    s_nop 1
    v_addc_co_u32 v17, vcc, 0, v17, vcc
    global_load_dword v119, v[16:17], off
L_nocpf:
    s_mov_b64 exec, -1
    v_lshrrev_b32 v16, 6, v0
    v_and_b32 v1, 63, v0
    v_readfirstlane_b32 s28, v16
    v_lshlrev_b32 v116, 4, v1
    s_lshl_b32 s42, s2, 3
    s_cmp_lt_u32 s28, 4
    s_cbranch_scc1 L_nox
    s_add_u32 s43, s42, s28
    s_sub_u32 s42, s43, 4
    v_lshl_add_u32 v18, s42, 11, v116
    v_add_u32 v19, 8192, v18
    s_waitcnt lgkmcnt(0)
    global_load_dwordx4 v[20:23], v18, s[44:45]
    global_load_dwordx4 v[24:27], v18, s[44:45] offset:1024
    global_load_dwordx4 v[28:31], v19, s[44:45]
    global_load_dwordx4 v[32:35], v19, s[44:45] offset:1024
    global_load_dwordx4 v[36:39], v116, s[52:53]
    global_load_dwordx4 v[40:43], v116, s[52:53] offset:1024
L_nox:
    s_load_dwordx4 s[88:91], s[0:1], 96
    s_load_dwordx4 s[92:95], s[0:1], 64
    s_load_dwordx2 s[96:97], s[0:1], 16
    s_and_b32 s29, s2, 7
    s_lshl_b32 s29, s29, 2
    s_bfe_u32 s36, s2, 0x20003
    s_add_u32 s29, s29, s36
    s_lshr_b32 s30, s2, 5
    v_lshrrev_b32 v16, 3, v1
    s_lshl_b32 s36, s30, 8
    s_lshl_b32 s37, s28, 5
    s_add_u32 s36, s36, s37
    v_add_u32 v16, s36, v16
    v_lshlrev_b32 v16, 10, v16
    v_lshrrev_b32 v18, 4, v1
    v_and_b32 v19, 7, v1
    v_xor_b32 v19, v19, v18
    v_lshl_add_u32 v2, v19, 4, v16
    v_xor_b32 v19, 4, v19
    v_lshl_add_u32 v3, v19, 4, v16
    v_add_u32 v3, 7168, v3
    v_add_u32 v4, 14336, v2
    v_add_u32 v5, 14336, v3
    s_and_b32 s36, s28, 3
    s_lshl_b32 s37, s36, 4
    v_add_u32 v16, s37, v18
    v_lshlrev_b32 v16, 13, v16
    s_lshl_b32 s37, s29, 8
    v_add_u32 v16, s37, v16
    v_and_b32 v19, 15, v1
    v_lshlrev_b32 v18, 1, v18
    v_xor_b32 v19, v19, v18
    v_lshl_add_u32 v6, v19, 4, v16
    v_add_u32 v7, 31744, v6
    v_xor_b32 v19, 8, v19
    v_lshl_add_u32 v8, v19, 4, v16
    v_add_u32 v8, 63488, v8
    v_add_u32 v9, 31744, v8
    s_lshl_b32 s33, s28, 12
    s_add_u32 s34, s33, 65536
    s_mov_b32 s31, 0
    s_mov_b32 s32, 0
    s_mov_b32 s40, 128
    s_mov_b32 s41, 524288
    s_waitcnt lgkmcnt(0)
    s_mov_b32 s4, s46
    s_and_b32 s5, s47, 0xffff
    s_mov_b32 s6, 2097152
    s_mov_b32 s7, 0x20000
    s_mov_b32 s8, s48
    s_and_b32 s9, s49, 0xffff
    s_mov_b32 s10, 4194304
    s_mov_b32 s11, 0x20000
    s_mov_b32 s20, s50
    s_and_b32 s21, s51, 0xffff
    s_mov_b32 s22, 4194304
    s_mov_b32 s23, 0x20000
    s_cmp_lt_u32 s28, 4
    s_cbranch_scc0 L_pro_s
    s_cmp_eq_u32 s2, 0
    s_cbranch_scc1 L_recurrent_scan__compressed_kv_cla__moe_arch_mod__prompt_kernel_rare_1
L_recurrent_scan__compressed_kv_cla__moe_arch_mod__prompt_kernel_back_2:
    s_add_u32 m0, s33, 0
    s_add_u32 s36, s31, 131072
    buffer_load_dwordx4 v2, s[4:7], s31 offen offset:0 lds
    buffer_load_dwordx4 v3, s[4:7], s31 offen offset:1024 lds
    buffer_load_dwordx4 v4, s[4:7], s31 offen offset:2048 lds
    buffer_load_dwordx4 v5, s[4:7], s31 offen offset:3072 lds
    s_add_u32 m0, s34, 0
    s_nop 0
    buffer_load_dwordx4 v6, s[8:11], s32 offen offset:0 nt lds
    buffer_load_dwordx4 v7, s[8:11], s32 offen offset:1024 nt lds
    buffer_load_dwordx4 v8, s[8:11], s32 offen offset:2048 nt lds
    buffer_load_dwordx4 v9, s[8:11], s32 offen offset:3072 nt lds
    s_add_u32 m0, s33, 16384
    s_nop 0
    buffer_load_dwordx4 v2, s[4:7], s36 offen offset:0 lds
    buffer_load_dwordx4 v3, s[4:7], s36 offen offset:1024 lds
    buffer_load_dwordx4 v4, s[4:7], s36 offen offset:2048 lds
    buffer_load_dwordx4 v5, s[4:7], s36 offen offset:3072 lds
    s_add_u32 m0, s34, 16384
    s_nop 0
    buffer_load_dwordx4 v6, s[20:23], s32 offen offset:0 nt lds
    buffer_load_dwordx4 v7, s[20:23], s32 offen offset:1024 nt lds
    buffer_load_dwordx4 v8, s[20:23], s32 offen offset:2048 nt lds
    buffer_load_dwordx4 v9, s[20:23], s32 offen offset:3072 nt lds
    s_add_u32 s31, s31, s40
    s_add_u32 s32, s32, s41
L_pro_s:
    s_add_u32 s54, s90, 0
    s_addc_u32 s55, s91, 0
    s_add_u32 s12, s54, 8388608
    s_addc_u32 s13, s55, 0
    s_and_b32 s13, s13, 0xffff
    s_mov_b32 s14, 33554432
    s_mov_b32 s15, 0x20000
    s_mov_b32 s24, s54
    s_and_b32 s25, s55, 0xffff
    s_mov_b32 s26, 83886080
    s_mov_b32 s27, 0x20000
    s_add_u32 s90, s54, 61865984
    s_addc_u32 s91, s55, 0
    v_and_b32 v16, 15, v1
    v_lshrrev_b32 v17, 4, v1
    s_bfe_u32 s36, s28, 0x10001
    s_lshl_b32 s36, s36, 14
    v_lshl_add_u32 v18, v16, 7, s36
    v_lshrrev_b32 v19, 1, v16
    v_xor_b32 v19, v19, v17
    v_lshl_add_u32 v10, v19, 4, v18
    v_xor_b32 v19, 4, v19
    v_lshl_add_u32 v11, v19, 4, v18
    v_lshrrev_b32 v16, 2, v16
    v_lshl_add_u32 v18, v17, 3, v16
    v_lshlrev_b32 v18, 8, v18
    s_lshr_b32 s36, s28, 2
    s_lshl_b32 s36, s36, 14
    s_add_u32 s36, s36, 65536
    v_add_u32 v18, s36, v18
    v_and_b32 v19, 3, v1
    v_lshl_add_u32 v18, v19, 3, v18
    v_and_b32 v17, 1, v17
    v_lshl_add_u32 v16, v17, 2, v16
    s_and_b32 s36, s28, 1
    s_lshl_b32 s36, s36, 2
    s_add_u32 s37, s36, 0
    v_xor_b32 v19, s37, v16
    v_lshl_add_u32 v12, v19, 5, v18
    s_add_u32 s37, s36, 1
    v_xor_b32 v19, s37, v16
    v_lshl_add_u32 v13, v19, 5, v18
    s_add_u32 s37, s36, 2
    v_xor_b32 v19, s37, v16
    v_lshl_add_u32 v14, v19, 5, v18
    s_add_u32 s37, s36, 3
    v_xor_b32 v19, s37, v16
    v_lshl_add_u32 v15, v19, 5, v18
    v_mov_b64 v[128:129], 0
    v_mov_b64 v[130:131], 0
    v_mov_b64 v[132:133], 0
    v_mov_b64 v[134:135], 0
    v_mov_b64 v[136:137], 0
    v_mov_b64 v[138:139], 0
    v_mov_b64 v[140:141], 0
    v_mov_b64 v[142:143], 0
    v_mov_b64 v[144:145], 0
    v_mov_b64 v[146:147], 0
    v_mov_b64 v[148:149], 0
    v_mov_b64 v[150:151], 0
    v_mov_b64 v[152:153], 0
    v_mov_b64 v[154:155], 0
    v_mov_b64 v[156:157], 0
    v_mov_b64 v[158:159], 0
    v_mov_b64 v[160:161], 0
    v_mov_b64 v[162:163], 0
    v_mov_b64 v[164:165], 0
    v_mov_b64 v[166:167], 0
    v_mov_b64 v[168:169], 0
    v_mov_b64 v[170:171], 0
    v_mov_b64 v[172:173], 0
    v_mov_b64 v[174:175], 0
    v_mov_b64 v[176:177], 0
    v_mov_b64 v[178:179], 0
    v_mov_b64 v[180:181], 0
    v_mov_b64 v[182:183], 0
    v_mov_b64 v[184:185], 0
    v_mov_b64 v[186:187], 0
    v_mov_b64 v[188:189], 0
    v_mov_b64 v[190:191], 0
    v_mov_b64 v[192:193], 0
    v_mov_b64 v[194:195], 0
    v_mov_b64 v[196:197], 0
    v_mov_b64 v[198:199], 0
    v_mov_b64 v[200:201], 0
    v_mov_b64 v[202:203], 0
    v_mov_b64 v[204:205], 0
    v_mov_b64 v[206:207], 0
    v_mov_b64 v[208:209], 0
    v_mov_b64 v[210:211], 0
    v_mov_b64 v[212:213], 0
    v_mov_b64 v[214:215], 0
    v_mov_b64 v[216:217], 0
    v_mov_b64 v[218:219], 0
    v_mov_b64 v[220:221], 0
    v_mov_b64 v[222:223], 0
    v_mov_b64 v[224:225], 0
    v_mov_b64 v[226:227], 0
    v_mov_b64 v[228:229], 0
    v_mov_b64 v[230:231], 0
    v_mov_b64 v[232:233], 0
    v_mov_b64 v[234:235], 0
    v_mov_b64 v[236:237], 0
    v_mov_b64 v[238:239], 0
    v_mov_b64 v[240:241], 0
    v_mov_b64 v[242:243], 0
    v_mov_b64 v[244:245], 0
    v_mov_b64 v[246:247], 0
    v_mov_b64 v[248:249], 0
    v_mov_b64 v[250:251], 0
    v_mov_b64 v[252:253], 0
    v_mov_b64 v[254:255], 0
    v_mov_b32 v118, 0
    v_mov_b32 v117, 0
    s_lshl_b32 s36, s30, 7
    s_lshl_b32 s37, s28, 4
    s_add_u32 s36, s36, s37
    v_bfe_u32 v17, v1, 1, 2
    v_add_u32 v17, s36, v17
    v_lshlrev_b32 v17, 13, v17
    v_and_b32 v19, 1, v1
    v_lshl_add_u32 v17, v19, 7, v17
    s_lshl_b32 s36, s29, 8
    v_add_u32 v17, s36, v17
    s_mov_b32 s45, 32768
    s_cmp_lt_u32 s28, 4
    s_cbranch_scc0 L_pro_b
    s_add_u32 m0, s33, 32768
    s_add_u32 s36, s31, 131072
    buffer_load_dwordx4 v2, s[4:7], s31 offen offset:0 lds
    buffer_load_dwordx4 v3, s[4:7], s31 offen offset:1024 lds
    buffer_load_dwordx4 v4, s[4:7], s31 offen offset:2048 lds
    buffer_load_dwordx4 v5, s[4:7], s31 offen offset:3072 lds
    s_add_u32 m0, s34, 32768
    s_nop 0
    buffer_load_dwordx4 v6, s[8:11], s32 offen offset:0 nt lds
    buffer_load_dwordx4 v7, s[8:11], s32 offen offset:1024 nt lds
    buffer_load_dwordx4 v8, s[8:11], s32 offen offset:2048 nt lds
    buffer_load_dwordx4 v9, s[8:11], s32 offen offset:3072 nt lds
    s_add_u32 m0, s33, 49152
    s_nop 0
    buffer_load_dwordx4 v2, s[4:7], s36 offen offset:0 lds
    buffer_load_dwordx4 v3, s[4:7], s36 offen offset:1024 lds
    buffer_load_dwordx4 v4, s[4:7], s36 offen offset:2048 lds
    buffer_load_dwordx4 v5, s[4:7], s36 offen offset:3072 lds
    s_add_u32 m0, s34, 49152
    s_nop 0
    buffer_load_dwordx4 v6, s[20:23], s32 offen offset:0 nt lds
    buffer_load_dwordx4 v7, s[20:23], s32 offen offset:1024 nt lds
    buffer_load_dwordx4 v8, s[20:23], s32 offen offset:2048 nt lds
    buffer_load_dwordx4 v9, s[20:23], s32 offen offset:3072 nt lds
    s_add_u32 s31, s31, s40
    s_add_u32 s32, s32, s41
    s_waitcnt vmcnt(16)
    s_branch L_pro_j
L_pro_b:
    s_mov_b64 s[8:9], s[20:21]
    s_mov_b32 s31, 256
    s_mov_b32 s32, 1048576
    s_and_b32 s60, s28, 3
    s_waitcnt vmcnt(0)
    s_mov_b32 s3, 0
L_ln:
    v_lshlrev_b32 v44, 16, v36
    v_and_b32 v45, 0xffff0000, v36
    v_lshlrev_b32 v46, 16, v37
    v_and_b32 v47, 0xffff0000, v37
    v_lshlrev_b32 v48, 16, v38
    v_and_b32 v49, 0xffff0000, v38
    v_lshlrev_b32 v50, 16, v39
    v_and_b32 v51, 0xffff0000, v39
    v_lshlrev_b32 v52, 16, v40
    v_and_b32 v53, 0xffff0000, v40
    v_lshlrev_b32 v54, 16, v41
    v_and_b32 v55, 0xffff0000, v41
    v_lshlrev_b32 v56, 16, v42
    v_and_b32 v57, 0xffff0000, v42
    v_lshlrev_b32 v58, 16, v43
    v_and_b32 v59, 0xffff0000, v43
    v_lshlrev_b32 v60, 16, v20
    v_lshlrev_b32 v76, 16, v28
    v_and_b32 v61, 0xffff0000, v20
    v_and_b32 v77, 0xffff0000, v28
    v_lshlrev_b32 v62, 16, v21
    v_lshlrev_b32 v78, 16, v29
    v_and_b32 v63, 0xffff0000, v21
    v_and_b32 v79, 0xffff0000, v29
    v_lshlrev_b32 v64, 16, v22
    v_lshlrev_b32 v80, 16, v30
    v_and_b32 v65, 0xffff0000, v22
    v_and_b32 v81, 0xffff0000, v30
    v_lshlrev_b32 v66, 16, v23
    v_lshlrev_b32 v82, 16, v31
    v_and_b32 v67, 0xffff0000, v23
    v_and_b32 v83, 0xffff0000, v31
    v_lshlrev_b32 v68, 16, v24
    v_lshlrev_b32 v84, 16, v32
    v_and_b32 v69, 0xffff0000, v24
    v_and_b32 v85, 0xffff0000, v32
    v_lshlrev_b32 v70, 16, v25
    v_lshlrev_b32 v86, 16, v33
    v_and_b32 v71, 0xffff0000, v25
    v_and_b32 v87, 0xffff0000, v33
    v_lshlrev_b32 v72, 16, v26
    v_lshlrev_b32 v88, 16, v34
    v_and_b32 v73, 0xffff0000, v26
    v_and_b32 v89, 0xffff0000, v34
    v_lshlrev_b32 v74, 16, v27
    v_lshlrev_b32 v90, 16, v35
    v_and_b32 v75, 0xffff0000, v27
    v_and_b32 v91, 0xffff0000, v35
    v_add_f32 v92, v60, v61
    v_add_f32 v100, v76, v77
    v_add_f32 v92, v92, v62
    v_add_f32 v100, v100, v78
    v_add_f32 v92, v92, v63
    v_add_f32 v100, v100, v79
    v_add_f32 v92, v92, v64
    v_add_f32 v100, v100, v80
    v_add_f32 v92, v92, v65
    v_add_f32 v100, v100, v81
    v_add_f32 v92, v92, v66
    v_add_f32 v100, v100, v82
    v_add_f32 v92, v92, v67
    v_add_f32 v100, v100, v83
    v_add_f32 v92, v92, v68
    v_add_f32 v100, v100, v84
    v_add_f32 v92, v92, v69
    v_add_f32 v100, v100, v85
    v_add_f32 v92, v92, v70
    v_add_f32 v100, v100, v86
    v_add_f32 v92, v92, v71
    v_add_f32 v100, v100, v87
    v_add_f32 v92, v92, v72
    v_add_f32 v100, v100, v88
    v_add_f32 v92, v92, v73
    v_add_f32 v100, v100, v89
    v_add_f32 v92, v92, v74
    v_add_f32 v100, v100, v90
    v_add_f32 v92, v92, v75
    v_add_f32 v100, v100, v91
    s_nop 0
    v_add_f32_dpp v92, v92, v92 quad_perm:[1,0,3,2] row_mask:0xf bank_mask:0xf
    v_add_f32_dpp v100, v100, v100 quad_perm:[1,0,3,2] row_mask:0xf bank_mask:0xf
    s_nop 0
    v_add_f32_dpp v92, v92, v92 quad_perm:[2,3,0,1] row_mask:0xf bank_mask:0xf
    v_add_f32_dpp v100, v100, v100 quad_perm:[2,3,0,1] row_mask:0xf bank_mask:0xf
    s_nop 0
    v_add_f32_dpp v92, v92, v92 row_half_mirror row_mask:0xf bank_mask:0xf
    v_add_f32_dpp v100, v100, v100 row_half_mirror row_mask:0xf bank_mask:0xf
    s_nop 0
    v_add_f32_dpp v92, v92, v92 row_mirror row_mask:0xf bank_mask:0xf
    v_add_f32_dpp v100, v100, v100 row_mirror row_mask:0xf bank_mask:0xf
    v_readlane_b32 s36, v92, 0
    v_readlane_b32 s56, v100, 0
    v_readlane_b32 s37, v92, 16
    v_readlane_b32 s57, v100, 16
    v_readlane_b32 s38, v92, 32
    v_readlane_b32 s58, v100, 32
    v_readlane_b32 s39, v92, 48
    v_readlane_b32 s59, v100, 48
    v_mov_b32 v93, s36
    v_mov_b32 v101, s56
    v_add_f32 v93, s37, v93
    v_add_f32 v101, s57, v101
    v_add_f32 v93, s38, v93
    v_add_f32 v101, s58, v101
    v_add_f32 v93, s39, v93
    v_add_f32 v101, s59, v101
    v_mul_f32 v93, 0x3a800000, v93
    v_mul_f32 v101, 0x3a800000, v101
    v_sub_f32 v94, v60, v93
    v_sub_f32 v102, v76, v101
    v_mul_f32 v92, v94, v94
    v_mul_f32 v100, v102, v102
    v_sub_f32 v94, v61, v93
    v_sub_f32 v102, v77, v101
    v_fmac_f32 v92, v94, v94
    v_fmac_f32 v100, v102, v102
    v_sub_f32 v94, v62, v93
    v_sub_f32 v102, v78, v101
    v_fmac_f32 v92, v94, v94
    v_fmac_f32 v100, v102, v102
    v_sub_f32 v94, v63, v93
    v_sub_f32 v102, v79, v101
    v_fmac_f32 v92, v94, v94
    v_fmac_f32 v100, v102, v102
    v_sub_f32 v94, v64, v93
    v_sub_f32 v102, v80, v101
    v_fmac_f32 v92, v94, v94
    v_fmac_f32 v100, v102, v102
    v_sub_f32 v94, v65, v93
    v_sub_f32 v102, v81, v101
    v_fmac_f32 v92, v94, v94
    v_fmac_f32 v100, v102, v102
    v_sub_f32 v94, v66, v93
    v_sub_f32 v102, v82, v101
    v_fmac_f32 v92, v94, v94
    v_fmac_f32 v100, v102, v102
    v_sub_f32 v94, v67, v93
    v_sub_f32 v102, v83, v101
    v_fmac_f32 v92, v94, v94
    v_fmac_f32 v100, v102, v102
    v_sub_f32 v94, v68, v93
    v_sub_f32 v102, v84, v101
    v_fmac_f32 v92, v94, v94
    v_fmac_f32 v100, v102, v102
    v_sub_f32 v94, v69, v93
    v_sub_f32 v102, v85, v101
    v_fmac_f32 v92, v94, v94
    v_fmac_f32 v100, v102, v102
    v_sub_f32 v94, v70, v93
    v_sub_f32 v102, v86, v101
    v_fmac_f32 v92, v94, v94
    v_fmac_f32 v100, v102, v102
    v_sub_f32 v94, v71, v93
    v_sub_f32 v102, v87, v101
    v_fmac_f32 v92, v94, v94
    v_fmac_f32 v100, v102, v102
    v_sub_f32 v94, v72, v93
    v_sub_f32 v102, v88, v101
    v_fmac_f32 v92, v94, v94
    v_fmac_f32 v100, v102, v102
    v_sub_f32 v94, v73, v93
    v_sub_f32 v102, v89, v101
    v_fmac_f32 v92, v94, v94
    v_fmac_f32 v100, v102, v102
    v_sub_f32 v94, v74, v93
    v_sub_f32 v102, v90, v101
    v_fmac_f32 v92, v94, v94
    v_fmac_f32 v100, v102, v102
    v_sub_f32 v94, v75, v93
    v_sub_f32 v102, v91, v101
    v_fmac_f32 v92, v94, v94
    v_fmac_f32 v100, v102, v102
    s_nop 0
    v_add_f32_dpp v92, v92, v92 quad_perm:[1,0,3,2] row_mask:0xf bank_mask:0xf
    v_add_f32_dpp v100, v100, v100 quad_perm:[1,0,3,2] row_mask:0xf bank_mask:0xf
    s_nop 0
    v_add_f32_dpp v92, v92, v92 quad_perm:[2,3,0,1] row_mask:0xf bank_mask:0xf
    v_add_f32_dpp v100, v100, v100 quad_perm:[2,3,0,1] row_mask:0xf bank_mask:0xf
    s_nop 0
    v_add_f32_dpp v92, v92, v92 row_half_mirror row_mask:0xf bank_mask:0xf
    v_add_f32_dpp v100, v100, v100 row_half_mirror row_mask:0xf bank_mask:0xf
    s_nop 0
    v_add_f32_dpp v92, v92, v92 row_mirror row_mask:0xf bank_mask:0xf
    v_add_f32_dpp v100, v100, v100 row_mirror row_mask:0xf bank_mask:0xf
    v_readlane_b32 s36, v92, 0
    v_readlane_b32 s56, v100, 0
    v_readlane_b32 s37, v92, 16
    v_readlane_b32 s57, v100, 16
    v_readlane_b32 s38, v92, 32
    v_readlane_b32 s58, v100, 32
    v_readlane_b32 s39, v92, 48
    v_readlane_b32 s59, v100, 48
    v_mov_b32 v94, s36
    v_mov_b32 v102, s56
    v_add_f32 v94, s37, v94
    v_add_f32 v102, s57, v102
    v_add_f32 v94, s38, v94
    v_add_f32 v102, s58, v102
    v_add_f32 v94, s39, v94
    v_add_f32 v102, s59, v102
    v_mul_f32 v94, 0x3a800000, v94
    v_mul_f32 v102, 0x3a800000, v102
    v_cvt_pk_bf16_f32 v95, v93, v94
    v_cvt_pk_bf16_f32 v103, v101, v102
    v_lshlrev_b32 v98, 16, v95
    v_lshlrev_b32 v106, 16, v103
    v_and_b32 v94, 0xffff0000, v95
    v_and_b32 v102, 0xffff0000, v103
    v_add_f32 v94, 0x3727c5ac, v94
    v_add_f32 v102, 0x3727c5ac, v102
    v_cvt_pk_bf16_f32 v94, v94, v94
    v_cvt_pk_bf16_f32 v102, v102, v102
    v_lshlrev_b32 v94, 16, v94
    v_lshlrev_b32 v102, 16, v102
    v_sqrt_f32 v94, v94
    v_sqrt_f32 v102, v102
    v_cvt_pk_bf16_f32 v94, v94, v94
    v_cvt_pk_bf16_f32 v102, v102, v102
    v_lshlrev_b32 v94, 16, v94
    v_lshlrev_b32 v102, 16, v102
    v_rcp_f32 v99, v94
    v_rcp_f32 v107, v102
    v_fma_f32 v96, -v94, v99, 1.0
    v_fma_f32 v104, -v102, v107, 1.0
    v_fma_f32 v99, v96, v99, v99
    v_fma_f32 v107, v104, v107, v107
    v_sub_f32 v60, v60, v98
    v_sub_f32 v76, v76, v106
    v_sub_f32 v61, v61, v98
    v_sub_f32 v77, v77, v106
    v_cvt_pk_bf16_f32 v96, v60, v61
    v_cvt_pk_bf16_f32 v104, v76, v77
    v_lshlrev_b32 v60, 16, v96
    v_lshlrev_b32 v76, 16, v104
    v_and_b32 v61, 0xffff0000, v96
    v_and_b32 v77, 0xffff0000, v104
    v_mul_f32 v60, v60, v99
    v_mul_f32 v76, v76, v107
    v_mul_f32 v61, v61, v99
    v_mul_f32 v77, v77, v107
    v_cvt_pk_bf16_f32 v108, v60, v61
    v_cvt_pk_bf16_f32 v120, v76, v77
    v_lshlrev_b32 v60, 16, v108
    v_lshlrev_b32 v76, 16, v120
    v_and_b32 v61, 0xffff0000, v108
    v_and_b32 v77, 0xffff0000, v120
    v_mul_f32 v92, v60, v44
    v_mul_f32 v100, v76, v44
    v_fmac_f32 v92, v61, v45
    v_fmac_f32 v100, v77, v45
    v_sub_f32 v62, v62, v98
    v_sub_f32 v78, v78, v106
    v_sub_f32 v63, v63, v98
    v_sub_f32 v79, v79, v106
    v_cvt_pk_bf16_f32 v96, v62, v63
    v_cvt_pk_bf16_f32 v104, v78, v79
    v_lshlrev_b32 v62, 16, v96
    v_lshlrev_b32 v78, 16, v104
    v_and_b32 v63, 0xffff0000, v96
    v_and_b32 v79, 0xffff0000, v104
    v_mul_f32 v62, v62, v99
    v_mul_f32 v78, v78, v107
    v_mul_f32 v63, v63, v99
    v_mul_f32 v79, v79, v107
    v_cvt_pk_bf16_f32 v109, v62, v63
    v_cvt_pk_bf16_f32 v121, v78, v79
    v_lshlrev_b32 v62, 16, v109
    v_lshlrev_b32 v78, 16, v121
    v_and_b32 v63, 0xffff0000, v109
    v_and_b32 v79, 0xffff0000, v121
    v_fmac_f32 v92, v62, v46
    v_fmac_f32 v100, v78, v46
    v_fmac_f32 v92, v63, v47
    v_fmac_f32 v100, v79, v47
    v_sub_f32 v64, v64, v98
    v_sub_f32 v80, v80, v106
    v_sub_f32 v65, v65, v98
    v_sub_f32 v81, v81, v106
    v_cvt_pk_bf16_f32 v96, v64, v65
    v_cvt_pk_bf16_f32 v104, v80, v81
    v_lshlrev_b32 v64, 16, v96
    v_lshlrev_b32 v80, 16, v104
    v_and_b32 v65, 0xffff0000, v96
    v_and_b32 v81, 0xffff0000, v104
    v_mul_f32 v64, v64, v99
    v_mul_f32 v80, v80, v107
    v_mul_f32 v65, v65, v99
    v_mul_f32 v81, v81, v107
    v_cvt_pk_bf16_f32 v110, v64, v65
    v_cvt_pk_bf16_f32 v122, v80, v81
    v_lshlrev_b32 v64, 16, v110
    v_lshlrev_b32 v80, 16, v122
    v_and_b32 v65, 0xffff0000, v110
    v_and_b32 v81, 0xffff0000, v122
    v_fmac_f32 v92, v64, v48
    v_fmac_f32 v100, v80, v48
    v_fmac_f32 v92, v65, v49
    v_fmac_f32 v100, v81, v49
    v_sub_f32 v66, v66, v98
    v_sub_f32 v82, v82, v106
    v_sub_f32 v67, v67, v98
    v_sub_f32 v83, v83, v106
    v_cvt_pk_bf16_f32 v96, v66, v67
    v_cvt_pk_bf16_f32 v104, v82, v83
    v_lshlrev_b32 v66, 16, v96
    v_lshlrev_b32 v82, 16, v104
    v_and_b32 v67, 0xffff0000, v96
    v_and_b32 v83, 0xffff0000, v104
    v_mul_f32 v66, v66, v99
    v_mul_f32 v82, v82, v107
    v_mul_f32 v67, v67, v99
    v_mul_f32 v83, v83, v107
    v_cvt_pk_bf16_f32 v111, v66, v67
    v_cvt_pk_bf16_f32 v123, v82, v83
    v_lshlrev_b32 v66, 16, v111
    v_lshlrev_b32 v82, 16, v123
    v_and_b32 v67, 0xffff0000, v111
    v_and_b32 v83, 0xffff0000, v123
    v_fmac_f32 v92, v66, v50
    v_fmac_f32 v100, v82, v50
    v_fmac_f32 v92, v67, v51
    v_fmac_f32 v100, v83, v51
    v_sub_f32 v68, v68, v98
    v_sub_f32 v84, v84, v106
    v_sub_f32 v69, v69, v98
    v_sub_f32 v85, v85, v106
    v_cvt_pk_bf16_f32 v96, v68, v69
    v_cvt_pk_bf16_f32 v104, v84, v85
    v_lshlrev_b32 v68, 16, v96
    v_lshlrev_b32 v84, 16, v104
    v_and_b32 v69, 0xffff0000, v96
    v_and_b32 v85, 0xffff0000, v104
    v_mul_f32 v68, v68, v99
    v_mul_f32 v84, v84, v107
    v_mul_f32 v69, v69, v99
    v_mul_f32 v85, v85, v107
    v_cvt_pk_bf16_f32 v112, v68, v69
    v_cvt_pk_bf16_f32 v124, v84, v85
    v_lshlrev_b32 v68, 16, v112
    v_lshlrev_b32 v84, 16, v124
    v_and_b32 v69, 0xffff0000, v112
    v_and_b32 v85, 0xffff0000, v124
    v_fmac_f32 v92, v68, v52
    v_fmac_f32 v100, v84, v52
    v_fmac_f32 v92, v69, v53
    v_fmac_f32 v100, v85, v53
    v_sub_f32 v70, v70, v98
    v_sub_f32 v86, v86, v106
    v_sub_f32 v71, v71, v98
    v_sub_f32 v87, v87, v106
    v_cvt_pk_bf16_f32 v96, v70, v71
    v_cvt_pk_bf16_f32 v104, v86, v87
    v_lshlrev_b32 v70, 16, v96
    v_lshlrev_b32 v86, 16, v104
    v_and_b32 v71, 0xffff0000, v96
    v_and_b32 v87, 0xffff0000, v104
    v_mul_f32 v70, v70, v99
    v_mul_f32 v86, v86, v107
    v_mul_f32 v71, v71, v99
    v_mul_f32 v87, v87, v107
    v_cvt_pk_bf16_f32 v113, v70, v71
    v_cvt_pk_bf16_f32 v125, v86, v87
    v_lshlrev_b32 v70, 16, v113
    v_lshlrev_b32 v86, 16, v125
    v_and_b32 v71, 0xffff0000, v113
    v_and_b32 v87, 0xffff0000, v125
    v_fmac_f32 v92, v70, v54
    v_fmac_f32 v100, v86, v54
    v_fmac_f32 v92, v71, v55
    v_fmac_f32 v100, v87, v55
    v_sub_f32 v72, v72, v98
    v_sub_f32 v88, v88, v106
    v_sub_f32 v73, v73, v98
    v_sub_f32 v89, v89, v106
    v_cvt_pk_bf16_f32 v96, v72, v73
    v_cvt_pk_bf16_f32 v104, v88, v89
    v_lshlrev_b32 v72, 16, v96
    v_lshlrev_b32 v88, 16, v104
    v_and_b32 v73, 0xffff0000, v96
    v_and_b32 v89, 0xffff0000, v104
    v_mul_f32 v72, v72, v99
    v_mul_f32 v88, v88, v107
    v_mul_f32 v73, v73, v99
    v_mul_f32 v89, v89, v107
    v_cvt_pk_bf16_f32 v114, v72, v73
    v_cvt_pk_bf16_f32 v126, v88, v89
    v_lshlrev_b32 v72, 16, v114
    v_lshlrev_b32 v88, 16, v126
    v_and_b32 v73, 0xffff0000, v114
    v_and_b32 v89, 0xffff0000, v126
    v_fmac_f32 v92, v72, v56
    v_fmac_f32 v100, v88, v56
    v_fmac_f32 v92, v73, v57
    v_fmac_f32 v100, v89, v57
    v_sub_f32 v74, v74, v98
    v_sub_f32 v90, v90, v106
    v_sub_f32 v75, v75, v98
    v_sub_f32 v91, v91, v106
    v_cvt_pk_bf16_f32 v96, v74, v75
    v_cvt_pk_bf16_f32 v104, v90, v91
    v_lshlrev_b32 v74, 16, v96
    v_lshlrev_b32 v90, 16, v104
    v_and_b32 v75, 0xffff0000, v96
    v_and_b32 v91, 0xffff0000, v104
    v_mul_f32 v74, v74, v99
    v_mul_f32 v90, v90, v107
    v_mul_f32 v75, v75, v99
    v_mul_f32 v91, v91, v107
    v_cvt_pk_bf16_f32 v115, v74, v75
    v_cvt_pk_bf16_f32 v127, v90, v91
    v_lshlrev_b32 v74, 16, v115
    v_lshlrev_b32 v90, 16, v127
    v_and_b32 v75, 0xffff0000, v115
    v_and_b32 v91, 0xffff0000, v127
    v_fmac_f32 v92, v74, v58
    v_fmac_f32 v100, v90, v58
    v_fmac_f32 v92, v75, v59
    v_fmac_f32 v100, v91, v59
    s_mul_i32 s36, s60, 2064
    s_mul_i32 s56, s28, 2064
    s_add_u32 s36, s36, 131072
    s_add_u32 s56, s56, 131072
    v_lshl_add_u32 v95, v1, 4, s36
    v_lshl_add_u32 v103, v1, 4, s56
    ds_write_b128 v95, v[108:111]
    ds_write_b128 v103, v[120:123]
    ds_write_b128 v95, v[112:115] offset:1024
    ds_write_b128 v103, v[124:127] offset:1024
    s_nop 0
    v_add_f32_dpp v92, v92, v92 quad_perm:[1,0,3,2] row_mask:0xf bank_mask:0xf
    v_add_f32_dpp v100, v100, v100 quad_perm:[1,0,3,2] row_mask:0xf bank_mask:0xf
    s_nop 0
    v_add_f32_dpp v92, v92, v92 quad_perm:[2,3,0,1] row_mask:0xf bank_mask:0xf
    v_add_f32_dpp v100, v100, v100 quad_perm:[2,3,0,1] row_mask:0xf bank_mask:0xf
    s_nop 0
    v_add_f32_dpp v92, v92, v92 row_half_mirror row_mask:0xf bank_mask:0xf
    v_add_f32_dpp v100, v100, v100 row_half_mirror row_mask:0xf bank_mask:0xf
    s_nop 0
    v_add_f32_dpp v92, v92, v92 row_mirror row_mask:0xf bank_mask:0xf
    v_add_f32_dpp v100, v100, v100 row_mirror row_mask:0xf bank_mask:0xf
    v_readlane_b32 s36, v92, 0
    v_readlane_b32 s56, v100, 0
    v_readlane_b32 s37, v92, 16
    v_readlane_b32 s57, v100, 16
    v_readlane_b32 s38, v92, 32
    v_readlane_b32 s58, v100, 32
    v_readlane_b32 s39, v92, 48
    v_readlane_b32 s59, v100, 48
    v_mov_b32 v93, s36
    v_mov_b32 v101, s56
    v_add_f32 v93, s37, v93
    v_add_f32 v101, s57, v101
    v_add_f32 v93, s38, v93
    v_add_f32 v101, s58, v101
    v_add_f32 v93, s39, v93
    v_add_f32 v101, s59, v101
    v_cvt_pk_bf16_f32 v93, v93, v93
    v_cvt_pk_bf16_f32 v101, v101, v101
    v_lshlrev_b32 v93, 16, v93
    v_lshlrev_b32 v101, 16, v101
    v_ashrrev_i32 v95, 31, v93
    v_ashrrev_i32 v103, 31, v101
    v_or_b32 v95, 0x80000000, v95
    v_or_b32 v103, 0x80000000, v103
    v_xor_b32 v95, v93, v95
    v_xor_b32 v103, v101, v103
    v_and_b32 v95, 0xffff0000, v95
    v_and_b32 v103, 0xffff0000, v103
    s_sub_u32 s36, 0xffff, s42
    s_sub_u32 s56, 0xffff, s43
    v_or_b32 v95, s36, v95
    v_or_b32 v103, s56, v103
    s_lshl_b32 s37, s60, 3
    s_lshl_b32 s57, s28, 3
    s_add_u32 s37, s37, 147712
    s_add_u32 s57, s57, 147712
    v_mov_b32 v94, s37
    v_mov_b32 v102, s57
    ds_write_b64 v94, v[98:99]
    ds_write_b64 v102, v[106:107]
    ds_write_b32 v94, v95 offset:64
    ds_write_b32 v102, v103 offset:64
    s_waitcnt vmcnt(0) lgkmcnt(0)
    s_cmp_eq_u32 s3, 0
    s_mov_b32 s3, 0
    s_cbranch_scc0 L_ln
L_pro_j:
    s_barrier
    ds_read_b128 v[20:23], v10 offset:0
    ds_read_b64_tr_b16 v[52:53], v12 offset:0
    ds_read_b64_tr_b16 v[54:55], v12 offset:1024
    ds_read_b64_tr_b16 v[56:57], v13 offset:0
    ds_read_b64_tr_b16 v[58:59], v13 offset:1024
    ds_read_b64_tr_b16 v[60:61], v14 offset:0
    ds_read_b64_tr_b16 v[62:63], v14 offset:1024
    ds_read_b64_tr_b16 v[64:65], v15 offset:0
    ds_read_b64_tr_b16 v[66:67], v15 offset:1024
    ds_read_b128 v[24:27], v10 offset:2048
    ds_read_b128 v[28:31], v10 offset:4096
    ds_read_b128 v[32:35], v10 offset:6144
    ds_read_b128 v[36:39], v10 offset:8192
    ds_read_b128 v[40:43], v10 offset:10240
    ds_read_b128 v[44:47], v10 offset:12288
    ds_read_b128 v[48:51], v10 offset:14336
    s_add_u32 s36, s2, s28
    s_cmp_eq_u32 s36, 0
    s_cbranch_scc1 L_recurrent_scan__compressed_kv_cla__moe_arch_mod__prompt_kernel_rare_3
L_recurrent_scan__compressed_kv_cla__moe_arch_mod__prompt_kernel_back_4:
    v_and_b32 v100, 7, v1
    v_lshrrev_b32 v101, 3, v1
    v_mul_u32_u24 v102, 2064, v100
    v_lshl_add_u32 v102, v101, 4, v102
    s_lshl_b32 s36, s28, 8
    s_add_u32 s36, s36, 131072
    v_add_u32 v102, s36, v102
    ds_read_b128 v[120:123], v102
    ds_read_b128 v[124:127], v102 offset:128
    v_lshlrev_b32 v100, 4, v100
    v_lshl_add_u32 v100, v101, 8, v100
    s_lshr_b32 s36, s2, 1
    s_lshl_b32 s36, s36, 15
    s_and_b32 s37, s2, 1
    s_lshl_b32 s37, s37, 7
    s_add_u32 s36, s36, s37
    s_lshl_b32 s37, s28, 12
    s_add_u32 s36, s36, s37
    s_waitcnt lgkmcnt(0)
    buffer_store_dwordx4 v[120:123], v100, s[24:27], s36 offen sc1
    buffer_store_dwordx4 v[124:127], v100, s[24:27], s36 offen offset:2048 sc1
    s_cmp_eq_u32 s28, 7
    s_cbranch_scc1 L_recurrent_scan__compressed_kv_cla__moe_arch_mod__prompt_kernel_rare_5
L_recurrent_scan__compressed_kv_cla__moe_arch_mod__prompt_kernel_back_6:
    s_mov_b32 s35, 0
    s_cmp_eq_u32 s28, 0
    s_cselect_b32 s43, 9, 0
    s_cselect_b32 s44, 2, 1
    s_cmp_lt_u32 s28, 4
    s_cbranch_scc0 L_kv_vloop
    .p2align 6
L_kv_kloop:
    s_waitcnt lgkmcnt(0)
    v_mfma_f32_16x16x32_bf16 v[128:131], v[52:55], v[20:23], v[128:131]
    ds_read_b128 v[68:71], v11 offset:0
    v_mfma_f32_16x16x32_bf16 v[132:135], v[56:59], v[20:23], v[132:135]
    ds_read_b64_tr_b16 v[100:101], v12 offset:8192
    v_mfma_f32_16x16x32_bf16 v[136:139], v[60:63], v[20:23], v[136:139]
    ds_read_b64_tr_b16 v[102:103], v12 offset:9216
    v_mfma_f32_16x16x32_bf16 v[140:143], v[64:67], v[20:23], v[140:143]
    ds_read_b64_tr_b16 v[104:105], v13 offset:8192
    v_mfma_f32_16x16x32_bf16 v[144:147], v[52:55], v[24:27], v[144:147]
    ds_read_b64_tr_b16 v[106:107], v13 offset:9216
    v_mfma_f32_16x16x32_bf16 v[148:151], v[56:59], v[24:27], v[148:151]
    ds_read_b64_tr_b16 v[108:109], v14 offset:8192
    v_mfma_f32_16x16x32_bf16 v[152:155], v[60:63], v[24:27], v[152:155]
    ds_read_b64_tr_b16 v[110:111], v14 offset:9216
    v_mfma_f32_16x16x32_bf16 v[156:159], v[64:67], v[24:27], v[156:159]
    ds_read_b64_tr_b16 v[112:113], v15 offset:8192
    v_mfma_f32_16x16x32_bf16 v[160:163], v[52:55], v[28:31], v[160:163]
    ds_read_b64_tr_b16 v[114:115], v15 offset:9216
    v_mfma_f32_16x16x32_bf16 v[164:167], v[56:59], v[28:31], v[164:167]
    ds_read_b128 v[72:75], v11 offset:2048
    v_mfma_f32_16x16x32_bf16 v[168:171], v[60:63], v[28:31], v[168:171]
    ds_read_b128 v[76:79], v11 offset:4096
    v_mfma_f32_16x16x32_bf16 v[172:175], v[64:67], v[28:31], v[172:175]
    ds_read_b128 v[80:83], v11 offset:6144
    v_mfma_f32_16x16x32_bf16 v[176:179], v[52:55], v[32:35], v[176:179]
    ds_read_b128 v[84:87], v11 offset:8192
    v_mfma_f32_16x16x32_bf16 v[180:183], v[56:59], v[32:35], v[180:183]
    ds_read_b128 v[88:91], v11 offset:10240
    v_mfma_f32_16x16x32_bf16 v[184:187], v[60:63], v[32:35], v[184:187]
    ds_read_b128 v[92:95], v11 offset:12288
    v_mfma_f32_16x16x32_bf16 v[188:191], v[64:67], v[32:35], v[188:191]
    ds_read_b128 v[96:99], v11 offset:14336
    v_mfma_f32_16x16x32_bf16 v[192:195], v[52:55], v[36:39], v[192:195]
    v_mfma_f32_16x16x32_bf16 v[196:199], v[56:59], v[36:39], v[196:199]
    v_mfma_f32_16x16x32_bf16 v[200:203], v[60:63], v[36:39], v[200:203]
    v_mfma_f32_16x16x32_bf16 v[204:207], v[64:67], v[36:39], v[204:207]
    v_mfma_f32_16x16x32_bf16 v[208:211], v[52:55], v[40:43], v[208:211]
    v_mfma_f32_16x16x32_bf16 v[212:215], v[56:59], v[40:43], v[212:215]
    v_mfma_f32_16x16x32_bf16 v[216:219], v[60:63], v[40:43], v[216:219]
    v_mfma_f32_16x16x32_bf16 v[220:223], v[64:67], v[40:43], v[220:223]
    v_mfma_f32_16x16x32_bf16 v[224:227], v[52:55], v[44:47], v[224:227]
    v_mfma_f32_16x16x32_bf16 v[228:231], v[56:59], v[44:47], v[228:231]
    v_mfma_f32_16x16x32_bf16 v[232:235], v[60:63], v[44:47], v[232:235]
    v_mfma_f32_16x16x32_bf16 v[236:239], v[64:67], v[44:47], v[236:239]
    v_mfma_f32_16x16x32_bf16 v[240:243], v[52:55], v[48:51], v[240:243]
    v_mfma_f32_16x16x32_bf16 v[244:247], v[56:59], v[48:51], v[244:247]
    v_mfma_f32_16x16x32_bf16 v[248:251], v[60:63], v[48:51], v[248:251]
    v_mfma_f32_16x16x32_bf16 v[252:255], v[64:67], v[48:51], v[252:255]
    s_cmp_eq_u32 s35, 3
    s_cbranch_scc1 L_recurrent_scan__compressed_kv_cla__moe_arch_mod__prompt_kernel_rare_7
L_recurrent_scan__compressed_kv_cla__moe_arch_mod__prompt_kernel_back_8:
    s_cmp_lt_u32 s35, s44
    s_cbranch_scc1 L_recurrent_scan__compressed_kv_cla__moe_arch_mod__prompt_kernel_w0_9
    s_waitcnt vmcnt(1)
L_recurrent_scan__compressed_kv_cla__moe_arch_mod__prompt_kernel_w0b_10:
    s_waitcnt lgkmcnt(0)
    s_barrier
    v_mfma_f32_16x16x32_bf16 v[128:131], v[100:103], v[68:71], v[128:131]
    ds_read_b128 v[20:23], v10 offset:32768
    s_add_u32 m0, s33, 0
    v_mfma_f32_16x16x32_bf16 v[132:135], v[104:107], v[68:71], v[132:135]
    ds_read_b64_tr_b16 v[52:53], v12 offset:32768
    buffer_load_dwordx4 v2, s[4:7], s31 offen offset:0 lds
    v_mfma_f32_16x16x32_bf16 v[136:139], v[108:111], v[68:71], v[136:139]
    ds_read_b64_tr_b16 v[54:55], v12 offset:33792
    v_mfma_f32_16x16x32_bf16 v[140:143], v[112:115], v[68:71], v[140:143]
    ds_read_b64_tr_b16 v[56:57], v13 offset:32768
    v_mfma_f32_16x16x32_bf16 v[144:147], v[100:103], v[72:75], v[144:147]
    ds_read_b64_tr_b16 v[58:59], v13 offset:33792
    buffer_load_dwordx4 v3, s[4:7], s31 offen offset:1024 lds
    v_mfma_f32_16x16x32_bf16 v[148:151], v[104:107], v[72:75], v[148:151]
    ds_read_b64_tr_b16 v[60:61], v14 offset:32768
    v_mfma_f32_16x16x32_bf16 v[152:155], v[108:111], v[72:75], v[152:155]
    ds_read_b64_tr_b16 v[62:63], v14 offset:33792
    v_mfma_f32_16x16x32_bf16 v[156:159], v[112:115], v[72:75], v[156:159]
    ds_read_b64_tr_b16 v[64:65], v15 offset:32768
    buffer_load_dwordx4 v4, s[4:7], s31 offen offset:2048 lds
    v_mfma_f32_16x16x32_bf16 v[160:163], v[100:103], v[76:79], v[160:163]
    ds_read_b64_tr_b16 v[66:67], v15 offset:33792
    v_mfma_f32_16x16x32_bf16 v[164:167], v[104:107], v[76:79], v[164:167]
    ds_read_b128 v[24:27], v10 offset:34816
    v_mfma_f32_16x16x32_bf16 v[168:171], v[108:111], v[76:79], v[168:171]
    ds_read_b128 v[28:31], v10 offset:36864
    buffer_load_dwordx4 v5, s[4:7], s31 offen offset:3072 lds
    v_mfma_f32_16x16x32_bf16 v[172:175], v[112:115], v[76:79], v[172:175]
    ds_read_b128 v[32:35], v10 offset:38912
    v_mfma_f32_16x16x32_bf16 v[176:179], v[100:103], v[80:83], v[176:179]
    ds_read_b128 v[36:39], v10 offset:40960
    s_add_u32 m0, s34, 0
    v_mfma_f32_16x16x32_bf16 v[180:183], v[104:107], v[80:83], v[180:183]
    ds_read_b128 v[40:43], v10 offset:43008
    buffer_load_dwordx4 v6, s[8:11], s32 offen offset:0 nt lds
    v_mfma_f32_16x16x32_bf16 v[184:187], v[108:111], v[80:83], v[184:187]
    ds_read_b128 v[44:47], v10 offset:45056
    v_mfma_f32_16x16x32_bf16 v[188:191], v[112:115], v[80:83], v[188:191]
    ds_read_b128 v[48:51], v10 offset:47104
    v_mfma_f32_16x16x32_bf16 v[192:195], v[100:103], v[84:87], v[192:195]
    buffer_load_dwordx4 v7, s[8:11], s32 offen offset:1024 nt lds
    v_mfma_f32_16x16x32_bf16 v[196:199], v[104:107], v[84:87], v[196:199]
    v_mfma_f32_16x16x32_bf16 v[200:203], v[108:111], v[84:87], v[200:203]
    v_mfma_f32_16x16x32_bf16 v[204:207], v[112:115], v[84:87], v[204:207]
    buffer_load_dwordx4 v8, s[8:11], s32 offen offset:2048 nt lds
    v_mfma_f32_16x16x32_bf16 v[208:211], v[100:103], v[88:91], v[208:211]
    v_mfma_f32_16x16x32_bf16 v[212:215], v[104:107], v[88:91], v[212:215]
    v_mfma_f32_16x16x32_bf16 v[216:219], v[108:111], v[88:91], v[216:219]
    buffer_load_dwordx4 v9, s[8:11], s32 offen offset:3072 nt lds
    v_mfma_f32_16x16x32_bf16 v[220:223], v[112:115], v[88:91], v[220:223]
    v_mfma_f32_16x16x32_bf16 v[224:227], v[100:103], v[92:95], v[224:227]
    v_mfma_f32_16x16x32_bf16 v[228:231], v[104:107], v[92:95], v[228:231]
    v_mfma_f32_16x16x32_bf16 v[232:235], v[108:111], v[92:95], v[232:235]
    v_mfma_f32_16x16x32_bf16 v[236:239], v[112:115], v[92:95], v[236:239]
    v_mfma_f32_16x16x32_bf16 v[240:243], v[100:103], v[96:99], v[240:243]
    v_mfma_f32_16x16x32_bf16 v[244:247], v[104:107], v[96:99], v[244:247]
    v_mfma_f32_16x16x32_bf16 v[248:251], v[108:111], v[96:99], v[248:251]
    v_mfma_f32_16x16x32_bf16 v[252:255], v[112:115], v[96:99], v[252:255]
    s_mov_b64 exec, 0xff
    global_load_dword v119, v17, s[96:97]
    s_mov_b64 exec, -1
    v_add_u32 v17, s45, v17
    s_nop 1
    s_add_u32 s31, s31, s40
    s_add_u32 s32, s32, s41
    s_waitcnt lgkmcnt(0)
    v_mfma_f32_16x16x32_bf16 v[128:131], v[52:55], v[20:23], v[128:131]
    ds_read_b128 v[68:71], v11 offset:32768
    v_mfma_f32_16x16x32_bf16 v[132:135], v[56:59], v[20:23], v[132:135]
    ds_read_b64_tr_b16 v[100:101], v12 offset:40960
    v_mfma_f32_16x16x32_bf16 v[136:139], v[60:63], v[20:23], v[136:139]
    ds_read_b64_tr_b16 v[102:103], v12 offset:41984
    v_mfma_f32_16x16x32_bf16 v[140:143], v[64:67], v[20:23], v[140:143]
    ds_read_b64_tr_b16 v[104:105], v13 offset:40960
    v_mfma_f32_16x16x32_bf16 v[144:147], v[52:55], v[24:27], v[144:147]
    ds_read_b64_tr_b16 v[106:107], v13 offset:41984
    v_mfma_f32_16x16x32_bf16 v[148:151], v[56:59], v[24:27], v[148:151]
    ds_read_b64_tr_b16 v[108:109], v14 offset:40960
    v_mfma_f32_16x16x32_bf16 v[152:155], v[60:63], v[24:27], v[152:155]
    ds_read_b64_tr_b16 v[110:111], v14 offset:41984
    v_mfma_f32_16x16x32_bf16 v[156:159], v[64:67], v[24:27], v[156:159]
    ds_read_b64_tr_b16 v[112:113], v15 offset:40960
    v_mfma_f32_16x16x32_bf16 v[160:163], v[52:55], v[28:31], v[160:163]
    ds_read_b64_tr_b16 v[114:115], v15 offset:41984
    v_mfma_f32_16x16x32_bf16 v[164:167], v[56:59], v[28:31], v[164:167]
    ds_read_b128 v[72:75], v11 offset:34816
    v_mfma_f32_16x16x32_bf16 v[168:171], v[60:63], v[28:31], v[168:171]
    ds_read_b128 v[76:79], v11 offset:36864
    v_mfma_f32_16x16x32_bf16 v[172:175], v[64:67], v[28:31], v[172:175]
    ds_read_b128 v[80:83], v11 offset:38912
    v_mfma_f32_16x16x32_bf16 v[176:179], v[52:55], v[32:35], v[176:179]
    ds_read_b128 v[84:87], v11 offset:40960
    v_mfma_f32_16x16x32_bf16 v[180:183], v[56:59], v[32:35], v[180:183]
    ds_read_b128 v[88:91], v11 offset:43008
    v_mfma_f32_16x16x32_bf16 v[184:187], v[60:63], v[32:35], v[184:187]
    ds_read_b128 v[92:95], v11 offset:45056
    v_mfma_f32_16x16x32_bf16 v[188:191], v[64:67], v[32:35], v[188:191]
    ds_read_b128 v[96:99], v11 offset:47104
    v_mfma_f32_16x16x32_bf16 v[192:195], v[52:55], v[36:39], v[192:195]
    v_mfma_f32_16x16x32_bf16 v[196:199], v[56:59], v[36:39], v[196:199]
    v_mfma_f32_16x16x32_bf16 v[200:203], v[60:63], v[36:39], v[200:203]
    v_mfma_f32_16x16x32_bf16 v[204:207], v[64:67], v[36:39], v[204:207]
    v_mfma_f32_16x16x32_bf16 v[208:211], v[52:55], v[40:43], v[208:211]
    s_bitcmp1_b32 s43, s35
    s_cbranch_scc1 L_recurrent_scan__compressed_kv_cla__moe_arch_mod__prompt_kernel_rare_15
L_recurrent_scan__compressed_kv_cla__moe_arch_mod__prompt_kernel_back_16:
    v_mfma_f32_16x16x32_bf16 v[212:215], v[56:59], v[40:43], v[212:215]
    v_mfma_f32_16x16x32_bf16 v[216:219], v[60:63], v[40:43], v[216:219]
    v_mfma_f32_16x16x32_bf16 v[220:223], v[64:67], v[40:43], v[220:223]
    v_mfma_f32_16x16x32_bf16 v[224:227], v[52:55], v[44:47], v[224:227]
    v_mfma_f32_16x16x32_bf16 v[228:231], v[56:59], v[44:47], v[228:231]
    v_mfma_f32_16x16x32_bf16 v[232:235], v[60:63], v[44:47], v[232:235]
    v_mfma_f32_16x16x32_bf16 v[236:239], v[64:67], v[44:47], v[236:239]
    v_mfma_f32_16x16x32_bf16 v[240:243], v[52:55], v[48:51], v[240:243]
    v_mfma_f32_16x16x32_bf16 v[244:247], v[56:59], v[48:51], v[244:247]
    v_mfma_f32_16x16x32_bf16 v[248:251], v[60:63], v[48:51], v[248:251]
    v_mfma_f32_16x16x32_bf16 v[252:255], v[64:67], v[48:51], v[252:255]
    s_bitcmp1_b32 s43, s35
    s_cbranch_scc1 L_recurrent_scan__compressed_kv_cla__moe_arch_mod__prompt_kernel_w0_17
    s_waitcnt vmcnt(1)
L_recurrent_scan__compressed_kv_cla__moe_arch_mod__prompt_kernel_w0b_18:
    s_waitcnt lgkmcnt(0)
    s_cmp_eq_u32 s35, 3
    s_barrier
    s_cbranch_scc1 L_p1_fin0
    v_mfma_f32_16x16x32_bf16 v[128:131], v[100:103], v[68:71], v[128:131]
    ds_read_b128 v[20:23], v10 offset:0
    s_add_u32 m0, s33, 32768
    v_mfma_f32_16x16x32_bf16 v[132:135], v[104:107], v[68:71], v[132:135]
    ds_read_b64_tr_b16 v[52:53], v12 offset:0
    buffer_load_dwordx4 v2, s[4:7], s31 offen offset:0 lds
    v_mfma_f32_16x16x32_bf16 v[136:139], v[108:111], v[68:71], v[136:139]
    ds_read_b64_tr_b16 v[54:55], v12 offset:1024
    v_mfma_f32_16x16x32_bf16 v[140:143], v[112:115], v[68:71], v[140:143]
    ds_read_b64_tr_b16 v[56:57], v13 offset:0
    v_mfma_f32_16x16x32_bf16 v[144:147], v[100:103], v[72:75], v[144:147]
    ds_read_b64_tr_b16 v[58:59], v13 offset:1024
    buffer_load_dwordx4 v3, s[4:7], s31 offen offset:1024 lds
    v_mfma_f32_16x16x32_bf16 v[148:151], v[104:107], v[72:75], v[148:151]
    ds_read_b64_tr_b16 v[60:61], v14 offset:0
    v_mfma_f32_16x16x32_bf16 v[152:155], v[108:111], v[72:75], v[152:155]
    ds_read_b64_tr_b16 v[62:63], v14 offset:1024
    v_mfma_f32_16x16x32_bf16 v[156:159], v[112:115], v[72:75], v[156:159]
    ds_read_b64_tr_b16 v[64:65], v15 offset:0
    buffer_load_dwordx4 v4, s[4:7], s31 offen offset:2048 lds
    v_mfma_f32_16x16x32_bf16 v[160:163], v[100:103], v[76:79], v[160:163]
    ds_read_b64_tr_b16 v[66:67], v15 offset:1024
    v_mfma_f32_16x16x32_bf16 v[164:167], v[104:107], v[76:79], v[164:167]
    ds_read_b128 v[24:27], v10 offset:2048
    v_mfma_f32_16x16x32_bf16 v[168:171], v[108:111], v[76:79], v[168:171]
    ds_read_b128 v[28:31], v10 offset:4096
    buffer_load_dwordx4 v5, s[4:7], s31 offen offset:3072 lds
    v_mfma_f32_16x16x32_bf16 v[172:175], v[112:115], v[76:79], v[172:175]
    ds_read_b128 v[32:35], v10 offset:6144
    v_mfma_f32_16x16x32_bf16 v[176:179], v[100:103], v[80:83], v[176:179]
    ds_read_b128 v[36:39], v10 offset:8192
    s_add_u32 m0, s34, 32768
    v_mfma_f32_16x16x32_bf16 v[180:183], v[104:107], v[80:83], v[180:183]
    ds_read_b128 v[40:43], v10 offset:10240
    buffer_load_dwordx4 v6, s[8:11], s32 offen offset:0 nt lds
    v_mfma_f32_16x16x32_bf16 v[184:187], v[108:111], v[80:83], v[184:187]
    ds_read_b128 v[44:47], v10 offset:12288
    v_mfma_f32_16x16x32_bf16 v[188:191], v[112:115], v[80:83], v[188:191]
    ds_read_b128 v[48:51], v10 offset:14336
    v_mfma_f32_16x16x32_bf16 v[192:195], v[100:103], v[84:87], v[192:195]
    buffer_load_dwordx4 v7, s[8:11], s32 offen offset:1024 nt lds
    v_mfma_f32_16x16x32_bf16 v[196:199], v[104:107], v[84:87], v[196:199]
    v_mfma_f32_16x16x32_bf16 v[200:203], v[108:111], v[84:87], v[200:203]
    v_mfma_f32_16x16x32_bf16 v[204:207], v[112:115], v[84:87], v[204:207]
    buffer_load_dwordx4 v8, s[8:11], s32 offen offset:2048 nt lds
    v_mfma_f32_16x16x32_bf16 v[208:211], v[100:103], v[88:91], v[208:211]
    v_mfma_f32_16x16x32_bf16 v[212:215], v[104:107], v[88:91], v[212:215]
    v_mfma_f32_16x16x32_bf16 v[216:219], v[108:111], v[88:91], v[216:219]
    buffer_load_dwordx4 v9, s[8:11], s32 offen offset:3072 nt lds
    v_mfma_f32_16x16x32_bf16 v[220:223], v[112:115], v[88:91], v[220:223]
    v_mfma_f32_16x16x32_bf16 v[224:227], v[100:103], v[92:95], v[224:227]
    v_mfma_f32_16x16x32_bf16 v[228:231], v[104:107], v[92:95], v[228:231]
    v_mfma_f32_16x16x32_bf16 v[232:235], v[108:111], v[92:95], v[232:235]
    v_mfma_f32_16x16x32_bf16 v[236:239], v[112:115], v[92:95], v[236:239]
    v_mfma_f32_16x16x32_bf16 v[240:243], v[100:103], v[96:99], v[240:243]
    v_mfma_f32_16x16x32_bf16 v[244:247], v[104:107], v[96:99], v[244:247]
    v_mfma_f32_16x16x32_bf16 v[248:251], v[108:111], v[96:99], v[248:251]
    s_add_u32 s36, s35, s28
    s_cmp_eq_u32 s36, 0
    s_cbranch_scc1 L_recurrent_scan__compressed_kv_cla__moe_arch_mod__prompt_kernel_rare_27
L_recurrent_scan__compressed_kv_cla__moe_arch_mod__prompt_kernel_back_28:
    v_mfma_f32_16x16x32_bf16 v[252:255], v[112:115], v[96:99], v[252:255]
    s_mov_b64 exec, 0xff
    global_load_dword v0, v17, s[96:97]
    s_mov_b64 exec, -1
    s_cmp_eq_u32 s35, 0
    s_cselect_b32 s45, s45, 0
    v_add_u32 v17, s45, v17
    s_nop 1
    s_add_u32 s31, s31, s40
    s_add_u32 s32, s32, s41
    s_add_u32 s35, s35, 1
    s_branch L_kv_kloop
L_p1_fin0:
    v_mfma_f32_16x16x32_bf16 v[128:131], v[100:103], v[68:71], v[128:131]
    s_and_b32 s36, s28, 3
    s_sub_u32 s37, 15, s30
    s_cmp_lt_u32 s28, 4
    s_cselect_b32 s37, s37, s30
    s_lshl_b32 s37, s37, 2
    s_add_u32 s37, s37, s36
    s_lshl_b32 s37, s37, 16
    v_lshl_add_u32 v6, v1, 4, s37
    v_add_u32 v7, 32768, v6
    s_mov_b32 s32, 0
    s_mov_b32 s8, s54
    s_and_b32 s9, s55, 0xffff
    s_mov_b32 s10, 4194304
    s_mov_b32 s11, 0x20000
    v_mfma_f32_16x16x32_bf16 v[132:135], v[104:107], v[68:71], v[132:135]
    buffer_load_dwordx4 v[24:27], v6, s[8:11], s32 offen offset:0 sc1
    v_mfma_f32_16x16x32_bf16 v[136:139], v[108:111], v[68:71], v[136:139]
    v_lshrrev_b32 v18, 4, v1
    v_mfma_f32_16x16x32_bf16 v[140:143], v[112:115], v[68:71], v[140:143]
    buffer_load_dwordx4 v[28:31], v7, s[8:11], s32 offen offset:0 sc1
    v_bfe_u32 v20, v1, 2, 2
    v_mfma_f32_16x16x32_bf16 v[144:147], v[100:103], v[72:75], v[144:147]
    v_lshl_add_u32 v19, v18, 3, v20
    v_mfma_f32_16x16x32_bf16 v[148:151], v[104:107], v[72:75], v[148:151]
    buffer_load_dwordx4 v[32:35], v6, s[8:11], s32 offen offset:1024 sc1
    v_lshlrev_b32 v19, 8, v19
    v_mfma_f32_16x16x32_bf16 v[152:155], v[108:111], v[72:75], v[152:155]
    v_and_b32 v21, 3, v1
    v_mfma_f32_16x16x32_bf16 v[156:159], v[112:115], v[72:75], v[156:159]
    buffer_load_dwordx4 v[36:39], v7, s[8:11], s32 offen offset:1024 sc1
    v_lshl_add_u32 v19, v21, 3, v19
    v_mfma_f32_16x16x32_bf16 v[160:163], v[100:103], v[76:79], v[160:163]
    v_and_b32 v21, 1, v18
    v_mfma_f32_16x16x32_bf16 v[164:167], v[104:107], v[76:79], v[164:167]
    buffer_load_dwordx4 v[40:43], v6, s[8:11], s32 offen offset:2048 sc1
    v_lshl_add_u32 v20, v21, 2, v20
    v_mfma_f32_16x16x32_bf16 v[168:171], v[108:111], v[76:79], v[168:171]
    v_xor_b32 v21, 0, v20
    v_mfma_f32_16x16x32_bf16 v[172:175], v[112:115], v[76:79], v[172:175]
    buffer_load_dwordx4 v[44:47], v7, s[8:11], s32 offen offset:2048 sc1
    v_lshl_add_u32 v10, v21, 5, v19
    v_mfma_f32_16x16x32_bf16 v[176:179], v[100:103], v[80:83], v[176:179]
    v_xor_b32 v21, 1, v20
    v_mfma_f32_16x16x32_bf16 v[180:183], v[104:107], v[80:83], v[180:183]
    buffer_load_dwordx4 v[48:51], v6, s[8:11], s32 offen offset:3072 sc1
    v_lshl_add_u32 v11, v21, 5, v19
    v_mfma_f32_16x16x32_bf16 v[184:187], v[108:111], v[80:83], v[184:187]
    v_xor_b32 v21, 2, v20
    v_mfma_f32_16x16x32_bf16 v[188:191], v[112:115], v[80:83], v[188:191]
    buffer_load_dwordx4 v[52:55], v7, s[8:11], s32 offen offset:3072 sc1
    v_lshl_add_u32 v12, v21, 5, v19
    v_mfma_f32_16x16x32_bf16 v[192:195], v[100:103], v[84:87], v[192:195]
    v_xor_b32 v21, 3, v20
    v_mfma_f32_16x16x32_bf16 v[196:199], v[104:107], v[84:87], v[196:199]
    s_add_u32 m0, s33, 32768
    v_lshl_add_u32 v13, v21, 5, v19
    v_mfma_f32_16x16x32_bf16 v[200:203], v[108:111], v[84:87], v[200:203]
    v_xor_b32 v21, 4, v20
    v_mfma_f32_16x16x32_bf16 v[204:207], v[112:115], v[84:87], v[204:207]
    buffer_load_dwordx4 v2, s[4:7], s31 offen offset:0 lds
    v_lshl_add_u32 v14, v21, 5, v19
    v_mfma_f32_16x16x32_bf16 v[208:211], v[100:103], v[88:91], v[208:211]
    v_xor_b32 v21, 5, v20
    v_mfma_f32_16x16x32_bf16 v[212:215], v[104:107], v[88:91], v[212:215]
    buffer_load_dwordx4 v3, s[4:7], s31 offen offset:1024 lds
    v_lshl_add_u32 v15, v21, 5, v19
    v_mfma_f32_16x16x32_bf16 v[216:219], v[108:111], v[88:91], v[216:219]
    v_xor_b32 v21, 6, v20
    v_mfma_f32_16x16x32_bf16 v[220:223], v[112:115], v[88:91], v[220:223]
    buffer_load_dwordx4 v4, s[4:7], s31 offen offset:2048 lds
    v_lshl_add_u32 v16, v21, 5, v19
    v_mfma_f32_16x16x32_bf16 v[224:227], v[100:103], v[92:95], v[224:227]
    v_xor_b32 v21, 7, v20
    v_mfma_f32_16x16x32_bf16 v[228:231], v[104:107], v[92:95], v[228:231]
    buffer_load_dwordx4 v5, s[4:7], s31 offen offset:3072 lds
    v_lshl_add_u32 v17, v21, 5, v19
    v_mfma_f32_16x16x32_bf16 v[232:235], v[108:111], v[92:95], v[232:235]
    s_lshl_b32 s45, s29, 20
    v_mfma_f32_16x16x32_bf16 v[236:239], v[112:115], v[92:95], v[236:239]
    s_add_u32 s31, s31, s40
    v_mfma_f32_16x16x32_bf16 v[240:243], v[100:103], v[96:99], v[240:243]
    v_mfma_f32_16x16x32_bf16 v[244:247], v[104:107], v[96:99], v[244:247]
    s_add_u32 s32, s32, 4096
    v_mfma_f32_16x16x32_bf16 v[248:251], v[108:111], v[96:99], v[248:251]
    v_mfma_f32_16x16x32_bf16 v[252:255], v[112:115], v[96:99], v[252:255]
    s_branch L_p1_done
    .p2align 6
L_kv_vloop:
    s_waitcnt lgkmcnt(0)
    v_mfma_f32_16x16x32_bf16 v[128:131], v[20:23], v[52:55], v[128:131]
    ds_read_b128 v[68:71], v11 offset:0
    v_mfma_f32_16x16x32_bf16 v[160:163], v[20:23], v[56:59], v[160:163]
    ds_read_b64_tr_b16 v[100:101], v12 offset:8192
    v_mfma_f32_16x16x32_bf16 v[192:195], v[20:23], v[60:63], v[192:195]
    ds_read_b64_tr_b16 v[102:103], v12 offset:9216
    v_mfma_f32_16x16x32_bf16 v[224:227], v[20:23], v[64:67], v[224:227]
    ds_read_b64_tr_b16 v[104:105], v13 offset:8192
    v_mfma_f32_16x16x32_bf16 v[132:135], v[24:27], v[52:55], v[132:135]
    ds_read_b64_tr_b16 v[106:107], v13 offset:9216
    v_mfma_f32_16x16x32_bf16 v[164:167], v[24:27], v[56:59], v[164:167]
    ds_read_b64_tr_b16 v[108:109], v14 offset:8192
    v_mfma_f32_16x16x32_bf16 v[196:199], v[24:27], v[60:63], v[196:199]
    ds_read_b64_tr_b16 v[110:111], v14 offset:9216
    v_mfma_f32_16x16x32_bf16 v[228:231], v[24:27], v[64:67], v[228:231]
    ds_read_b64_tr_b16 v[112:113], v15 offset:8192
    v_mfma_f32_16x16x32_bf16 v[136:139], v[28:31], v[52:55], v[136:139]
    ds_read_b64_tr_b16 v[114:115], v15 offset:9216
    v_mfma_f32_16x16x32_bf16 v[168:171], v[28:31], v[56:59], v[168:171]
    ds_read_b128 v[72:75], v11 offset:2048
    v_mfma_f32_16x16x32_bf16 v[200:203], v[28:31], v[60:63], v[200:203]
    ds_read_b128 v[76:79], v11 offset:4096
    v_mfma_f32_16x16x32_bf16 v[232:235], v[28:31], v[64:67], v[232:235]
    ds_read_b128 v[80:83], v11 offset:6144
    v_mfma_f32_16x16x32_bf16 v[140:143], v[32:35], v[52:55], v[140:143]
    ds_read_b128 v[84:87], v11 offset:8192
    v_mfma_f32_16x16x32_bf16 v[172:175], v[32:35], v[56:59], v[172:175]
    ds_read_b128 v[88:91], v11 offset:10240
    v_mfma_f32_16x16x32_bf16 v[204:207], v[32:35], v[60:63], v[204:207]
    ds_read_b128 v[92:95], v11 offset:12288
    v_mfma_f32_16x16x32_bf16 v[236:239], v[32:35], v[64:67], v[236:239]
    ds_read_b128 v[96:99], v11 offset:14336
    v_mfma_f32_16x16x32_bf16 v[144:147], v[36:39], v[52:55], v[144:147]
    v_mfma_f32_16x16x32_bf16 v[176:179], v[36:39], v[56:59], v[176:179]
    v_mfma_f32_16x16x32_bf16 v[208:211], v[36:39], v[60:63], v[208:211]
    v_mfma_f32_16x16x32_bf16 v[240:243], v[36:39], v[64:67], v[240:243]
    v_mfma_f32_16x16x32_bf16 v[148:151], v[40:43], v[52:55], v[148:151]
    v_mfma_f32_16x16x32_bf16 v[180:183], v[40:43], v[56:59], v[180:183]
    v_mfma_f32_16x16x32_bf16 v[212:215], v[40:43], v[60:63], v[212:215]
    v_mfma_f32_16x16x32_bf16 v[244:247], v[40:43], v[64:67], v[244:247]
    v_mfma_f32_16x16x32_bf16 v[152:155], v[44:47], v[52:55], v[152:155]
    v_mfma_f32_16x16x32_bf16 v[184:187], v[44:47], v[56:59], v[184:187]
    v_mfma_f32_16x16x32_bf16 v[216:219], v[44:47], v[60:63], v[216:219]
    v_mfma_f32_16x16x32_bf16 v[248:251], v[44:47], v[64:67], v[248:251]
    v_mfma_f32_16x16x32_bf16 v[156:159], v[48:51], v[52:55], v[156:159]
    v_mfma_f32_16x16x32_bf16 v[188:191], v[48:51], v[56:59], v[188:191]
    v_mfma_f32_16x16x32_bf16 v[220:223], v[48:51], v[60:63], v[220:223]
    v_mfma_f32_16x16x32_bf16 v[252:255], v[48:51], v[64:67], v[252:255]
    s_cmp_lt_u32 s35, s44
    s_cbranch_scc1 L_recurrent_scan__compressed_kv_cla__moe_arch_mod__prompt_kernel_w0_29
    s_waitcnt vmcnt(1)
L_recurrent_scan__compressed_kv_cla__moe_arch_mod__prompt_kernel_w0b_30:
    s_waitcnt lgkmcnt(0)
    s_barrier
    s_add_u32 m0, s33, 0
    s_nop 0
    buffer_load_dwordx4 v2, s[4:7], s31 offen offset:0 lds
    buffer_load_dwordx4 v3, s[4:7], s31 offen offset:1024 lds
    buffer_load_dwordx4 v4, s[4:7], s31 offen offset:2048 lds
    buffer_load_dwordx4 v5, s[4:7], s31 offen offset:3072 lds
    s_add_u32 m0, s34, 0
    s_nop 0
    buffer_load_dwordx4 v6, s[8:11], s32 offen offset:0 nt lds
    buffer_load_dwordx4 v7, s[8:11], s32 offen offset:1024 nt lds
    buffer_load_dwordx4 v8, s[8:11], s32 offen offset:2048 nt lds
    buffer_load_dwordx4 v9, s[8:11], s32 offen offset:3072 nt lds
    s_add_u32 s31, s31, s40
    s_add_u32 s32, s32, s41
    v_mfma_f32_16x16x32_bf16 v[128:131], v[68:71], v[100:103], v[128:131]
    ds_read_b128 v[20:23], v10 offset:32768
    v_mfma_f32_16x16x32_bf16 v[160:163], v[68:71], v[104:107], v[160:163]
    ds_read_b64_tr_b16 v[52:53], v12 offset:32768
    v_mfma_f32_16x16x32_bf16 v[192:195], v[68:71], v[108:111], v[192:195]
    ds_read_b64_tr_b16 v[54:55], v12 offset:33792
    v_mfma_f32_16x16x32_bf16 v[224:227], v[68:71], v[112:115], v[224:227]
    ds_read_b64_tr_b16 v[56:57], v13 offset:32768
    v_mfma_f32_16x16x32_bf16 v[132:135], v[72:75], v[100:103], v[132:135]
    ds_read_b64_tr_b16 v[58:59], v13 offset:33792
    v_mfma_f32_16x16x32_bf16 v[164:167], v[72:75], v[104:107], v[164:167]
    ds_read_b64_tr_b16 v[60:61], v14 offset:32768
    v_mfma_f32_16x16x32_bf16 v[196:199], v[72:75], v[108:111], v[196:199]
    ds_read_b64_tr_b16 v[62:63], v14 offset:33792
    v_mfma_f32_16x16x32_bf16 v[228:231], v[72:75], v[112:115], v[228:231]
    ds_read_b64_tr_b16 v[64:65], v15 offset:32768
    v_mfma_f32_16x16x32_bf16 v[136:139], v[76:79], v[100:103], v[136:139]
    ds_read_b64_tr_b16 v[66:67], v15 offset:33792
    v_mfma_f32_16x16x32_bf16 v[168:171], v[76:79], v[104:107], v[168:171]
    ds_read_b128 v[24:27], v10 offset:34816
    v_mfma_f32_16x16x32_bf16 v[200:203], v[76:79], v[108:111], v[200:203]
    ds_read_b128 v[28:31], v10 offset:36864
    v_mfma_f32_16x16x32_bf16 v[232:235], v[76:79], v[112:115], v[232:235]
    ds_read_b128 v[32:35], v10 offset:38912
    v_mfma_f32_16x16x32_bf16 v[140:143], v[80:83], v[100:103], v[140:143]
    ds_read_b128 v[36:39], v10 offset:40960
    v_mfma_f32_16x16x32_bf16 v[172:175], v[80:83], v[104:107], v[172:175]
    ds_read_b128 v[40:43], v10 offset:43008
    v_mfma_f32_16x16x32_bf16 v[204:207], v[80:83], v[108:111], v[204:207]
    ds_read_b128 v[44:47], v10 offset:45056
    v_mfma_f32_16x16x32_bf16 v[236:239], v[80:83], v[112:115], v[236:239]
    ds_read_b128 v[48:51], v10 offset:47104
    v_mfma_f32_16x16x32_bf16 v[144:147], v[84:87], v[100:103], v[144:147]
    v_mfma_f32_16x16x32_bf16 v[176:179], v[84:87], v[104:107], v[176:179]
    v_mfma_f32_16x16x32_bf16 v[208:211], v[84:87], v[108:111], v[208:211]
    v_mfma_f32_16x16x32_bf16 v[240:243], v[84:87], v[112:115], v[240:243]
    v_mfma_f32_16x16x32_bf16 v[148:151], v[88:91], v[100:103], v[148:151]
    v_mfma_f32_16x16x32_bf16 v[180:183], v[88:91], v[104:107], v[180:183]
    v_mfma_f32_16x16x32_bf16 v[212:215], v[88:91], v[108:111], v[212:215]
    v_mfma_f32_16x16x32_bf16 v[244:247], v[88:91], v[112:115], v[244:247]
    v_mfma_f32_16x16x32_bf16 v[152:155], v[92:95], v[100:103], v[152:155]
    v_mfma_f32_16x16x32_bf16 v[184:187], v[92:95], v[104:107], v[184:187]
    v_mfma_f32_16x16x32_bf16 v[216:219], v[92:95], v[108:111], v[216:219]
    v_mfma_f32_16x16x32_bf16 v[248:251], v[92:95], v[112:115], v[248:251]
    v_mfma_f32_16x16x32_bf16 v[156:159], v[96:99], v[100:103], v[156:159]
    v_mfma_f32_16x16x32_bf16 v[188:191], v[96:99], v[104:107], v[188:191]
    v_mfma_f32_16x16x32_bf16 v[220:223], v[96:99], v[108:111], v[220:223]
    v_mfma_f32_16x16x32_bf16 v[252:255], v[96:99], v[112:115], v[252:255]
    s_mov_b64 exec, 0xff
    global_load_dword v119, v17, s[96:97]
    s_mov_b64 exec, -1
    v_add_u32 v17, s45, v17
    s_nop 1
    s_waitcnt lgkmcnt(0)
    v_mfma_f32_16x16x32_bf16 v[128:131], v[20:23], v[52:55], v[128:131]
    ds_read_b128 v[68:71], v11 offset:32768
    v_mfma_f32_16x16x32_bf16 v[160:163], v[20:23], v[56:59], v[160:163]
    ds_read_b64_tr_b16 v[100:101], v12 offset:40960
    v_mfma_f32_16x16x32_bf16 v[192:195], v[20:23], v[60:63], v[192:195]
    ds_read_b64_tr_b16 v[102:103], v12 offset:41984
    v_mfma_f32_16x16x32_bf16 v[224:227], v[20:23], v[64:67], v[224:227]
    ds_read_b64_tr_b16 v[104:105], v13 offset:40960
    v_mfma_f32_16x16x32_bf16 v[132:135], v[24:27], v[52:55], v[132:135]
    ds_read_b64_tr_b16 v[106:107], v13 offset:41984
    v_mfma_f32_16x16x32_bf16 v[164:167], v[24:27], v[56:59], v[164:167]
    ds_read_b64_tr_b16 v[108:109], v14 offset:40960
    v_mfma_f32_16x16x32_bf16 v[196:199], v[24:27], v[60:63], v[196:199]
    ds_read_b64_tr_b16 v[110:111], v14 offset:41984
    v_mfma_f32_16x16x32_bf16 v[228:231], v[24:27], v[64:67], v[228:231]
    ds_read_b64_tr_b16 v[112:113], v15 offset:40960
    v_mfma_f32_16x16x32_bf16 v[136:139], v[28:31], v[52:55], v[136:139]
    ds_read_b64_tr_b16 v[114:115], v15 offset:41984
    v_mfma_f32_16x16x32_bf16 v[168:171], v[28:31], v[56:59], v[168:171]
    ds_read_b128 v[72:75], v11 offset:34816
    v_mfma_f32_16x16x32_bf16 v[200:203], v[28:31], v[60:63], v[200:203]
    ds_read_b128 v[76:79], v11 offset:36864
    v_mfma_f32_16x16x32_bf16 v[232:235], v[28:31], v[64:67], v[232:235]
    ds_read_b128 v[80:83], v11 offset:38912
    v_mfma_f32_16x16x32_bf16 v[140:143], v[32:35], v[52:55], v[140:143]
    ds_read_b128 v[84:87], v11 offset:40960
    v_mfma_f32_16x16x32_bf16 v[172:175], v[32:35], v[56:59], v[172:175]
    ds_read_b128 v[88:91], v11 offset:43008
    v_mfma_f32_16x16x32_bf16 v[204:207], v[32:35], v[60:63], v[204:207]
    ds_read_b128 v[92:95], v11 offset:45056
    v_mfma_f32_16x16x32_bf16 v[236:239], v[32:35], v[64:67], v[236:239]
    ds_read_b128 v[96:99], v11 offset:47104
    v_mfma_f32_16x16x32_bf16 v[144:147], v[36:39], v[52:55], v[144:147]
    v_mfma_f32_16x16x32_bf16 v[176:179], v[36:39], v[56:59], v[176:179]
    v_mfma_f32_16x16x32_bf16 v[208:211], v[36:39], v[60:63], v[208:211]
    v_mfma_f32_16x16x32_bf16 v[240:243], v[36:39], v[64:67], v[240:243]
    v_mfma_f32_16x16x32_bf16 v[148:151], v[40:43], v[52:55], v[148:151]
    v_mfma_f32_16x16x32_bf16 v[180:183], v[40:43], v[56:59], v[180:183]
    v_mfma_f32_16x16x32_bf16 v[212:215], v[40:43], v[60:63], v[212:215]
    v_mfma_f32_16x16x32_bf16 v[244:247], v[40:43], v[64:67], v[244:247]
    v_mfma_f32_16x16x32_bf16 v[152:155], v[44:47], v[52:55], v[152:155]
    v_mfma_f32_16x16x32_bf16 v[184:187], v[44:47], v[56:59], v[184:187]
    v_mfma_f32_16x16x32_bf16 v[216:219], v[44:47], v[60:63], v[216:219]
    v_mfma_f32_16x16x32_bf16 v[248:251], v[44:47], v[64:67], v[248:251]
    v_mfma_f32_16x16x32_bf16 v[156:159], v[48:51], v[52:55], v[156:159]
    v_mfma_f32_16x16x32_bf16 v[188:191], v[48:51], v[56:59], v[188:191]
    v_mfma_f32_16x16x32_bf16 v[220:223], v[48:51], v[60:63], v[220:223]
    v_mfma_f32_16x16x32_bf16 v[252:255], v[48:51], v[64:67], v[252:255]
    s_waitcnt vmcnt(1) lgkmcnt(0)
    s_cmp_eq_u32 s35, 3
    s_barrier
    s_cbranch_scc1 L_p1_fin1
    s_add_u32 m0, s33, 32768
    s_nop 0
    buffer_load_dwordx4 v2, s[4:7], s31 offen offset:0 lds
    buffer_load_dwordx4 v3, s[4:7], s31 offen offset:1024 lds
    buffer_load_dwordx4 v4, s[4:7], s31 offen offset:2048 lds
    buffer_load_dwordx4 v5, s[4:7], s31 offen offset:3072 lds
    s_add_u32 m0, s34, 32768
    s_nop 0
    buffer_load_dwordx4 v6, s[8:11], s32 offen offset:0 nt lds
    buffer_load_dwordx4 v7, s[8:11], s32 offen offset:1024 nt lds
    buffer_load_dwordx4 v8, s[8:11], s32 offen offset:2048 nt lds
    buffer_load_dwordx4 v9, s[8:11], s32 offen offset:3072 nt lds
    s_add_u32 s31, s31, s40
    s_add_u32 s32, s32, s41
    s_cmp_eq_u32 s35, 2
    s_cbranch_scc1 L_recurrent_scan__compressed_kv_cla__moe_arch_mod__prompt_kernel_rare_35
L_recurrent_scan__compressed_kv_cla__moe_arch_mod__prompt_kernel_back_36:
    v_mfma_f32_16x16x32_bf16 v[128:131], v[68:71], v[100:103], v[128:131]
    ds_read_b128 v[20:23], v10 offset:0
    v_mfma_f32_16x16x32_bf16 v[160:163], v[68:71], v[104:107], v[160:163]
    ds_read_b64_tr_b16 v[52:53], v12 offset:0
    v_mfma_f32_16x16x32_bf16 v[192:195], v[68:71], v[108:111], v[192:195]
    ds_read_b64_tr_b16 v[54:55], v12 offset:1024
    v_mfma_f32_16x16x32_bf16 v[224:227], v[68:71], v[112:115], v[224:227]
    ds_read_b64_tr_b16 v[56:57], v13 offset:0
    v_mfma_f32_16x16x32_bf16 v[132:135], v[72:75], v[100:103], v[132:135]
    ds_read_b64_tr_b16 v[58:59], v13 offset:1024
    v_mfma_f32_16x16x32_bf16 v[164:167], v[72:75], v[104:107], v[164:167]
    ds_read_b64_tr_b16 v[60:61], v14 offset:0
    v_mfma_f32_16x16x32_bf16 v[196:199], v[72:75], v[108:111], v[196:199]
    ds_read_b64_tr_b16 v[62:63], v14 offset:1024
    v_mfma_f32_16x16x32_bf16 v[228:231], v[72:75], v[112:115], v[228:231]
    ds_read_b64_tr_b16 v[64:65], v15 offset:0
    v_mfma_f32_16x16x32_bf16 v[136:139], v[76:79], v[100:103], v[136:139]
    ds_read_b64_tr_b16 v[66:67], v15 offset:1024
    v_mfma_f32_16x16x32_bf16 v[168:171], v[76:79], v[104:107], v[168:171]
    ds_read_b128 v[24:27], v10 offset:2048
    v_mfma_f32_16x16x32_bf16 v[200:203], v[76:79], v[108:111], v[200:203]
    ds_read_b128 v[28:31], v10 offset:4096
    v_mfma_f32_16x16x32_bf16 v[232:235], v[76:79], v[112:115], v[232:235]
    ds_read_b128 v[32:35], v10 offset:6144
    v_mfma_f32_16x16x32_bf16 v[140:143], v[80:83], v[100:103], v[140:143]
    ds_read_b128 v[36:39], v10 offset:8192
    v_mfma_f32_16x16x32_bf16 v[172:175], v[80:83], v[104:107], v[172:175]
    ds_read_b128 v[40:43], v10 offset:10240
    v_mfma_f32_16x16x32_bf16 v[204:207], v[80:83], v[108:111], v[204:207]
    ds_read_b128 v[44:47], v10 offset:12288
    v_mfma_f32_16x16x32_bf16 v[236:239], v[80:83], v[112:115], v[236:239]
    ds_read_b128 v[48:51], v10 offset:14336
    v_mfma_f32_16x16x32_bf16 v[144:147], v[84:87], v[100:103], v[144:147]
    v_mfma_f32_16x16x32_bf16 v[176:179], v[84:87], v[104:107], v[176:179]
    v_mfma_f32_16x16x32_bf16 v[208:211], v[84:87], v[108:111], v[208:211]
    v_mfma_f32_16x16x32_bf16 v[240:243], v[84:87], v[112:115], v[240:243]
    v_mfma_f32_16x16x32_bf16 v[148:151], v[88:91], v[100:103], v[148:151]
    v_mfma_f32_16x16x32_bf16 v[180:183], v[88:91], v[104:107], v[180:183]
    v_mfma_f32_16x16x32_bf16 v[212:215], v[88:91], v[108:111], v[212:215]
    v_mfma_f32_16x16x32_bf16 v[244:247], v[88:91], v[112:115], v[244:247]
    v_mfma_f32_16x16x32_bf16 v[152:155], v[92:95], v[100:103], v[152:155]
    v_mfma_f32_16x16x32_bf16 v[184:187], v[92:95], v[104:107], v[184:187]
    v_mfma_f32_16x16x32_bf16 v[216:219], v[92:95], v[108:111], v[216:219]
    v_mfma_f32_16x16x32_bf16 v[248:251], v[92:95], v[112:115], v[248:251]
    v_mfma_f32_16x16x32_bf16 v[156:159], v[96:99], v[100:103], v[156:159]
    v_mfma_f32_16x16x32_bf16 v[188:191], v[96:99], v[104:107], v[188:191]
    v_mfma_f32_16x16x32_bf16 v[220:223], v[96:99], v[108:111], v[220:223]
    v_mfma_f32_16x16x32_bf16 v[252:255], v[96:99], v[112:115], v[252:255]
    s_mov_b64 exec, 0xff
    global_load_dword v0, v17, s[96:97]
    s_mov_b64 exec, -1
    s_cmp_eq_u32 s35, 0
    s_cselect_b32 s45, s45, 0
    v_add_u32 v17, s45, v17
    s_nop 1
    s_add_u32 s35, s35, 1
    s_branch L_kv_vloop
L_p1_fin1:
    s_and_b32 s36, s28, 3
    s_sub_u32 s37, 15, s30
    s_cmp_lt_u32 s28, 4
    s_cselect_b32 s37, s37, s30
    s_lshl_b32 s37, s37, 2
    s_add_u32 s37, s37, s36
    s_lshl_b32 s37, s37, 16
    v_lshl_add_u32 v6, v1, 4, s37
    v_add_u32 v7, 32768, v6
    s_mov_b32 s32, 0
    s_mov_b32 s8, s54
    s_and_b32 s9, s55, 0xffff
    s_mov_b32 s10, 4194304
    s_mov_b32 s11, 0x20000
    buffer_load_dwordx4 v[24:27], v6, s[8:11], s32 offen offset:0 sc1
    buffer_load_dwordx4 v[28:31], v7, s[8:11], s32 offen offset:0 sc1
    buffer_load_dwordx4 v[32:35], v6, s[8:11], s32 offen offset:1024 sc1
    buffer_load_dwordx4 v[36:39], v7, s[8:11], s32 offen offset:1024 sc1
    buffer_load_dwordx4 v[40:43], v6, s[8:11], s32 offen offset:2048 sc1
    buffer_load_dwordx4 v[44:47], v7, s[8:11], s32 offen offset:2048 sc1
    buffer_load_dwordx4 v[48:51], v6, s[8:11], s32 offen offset:3072 sc1
    buffer_load_dwordx4 v[52:55], v7, s[8:11], s32 offen offset:3072 sc1
    s_add_u32 m0, s33, 32768
    s_nop 0
    buffer_load_dwordx4 v2, s[4:7], s31 offen offset:0 lds
    buffer_load_dwordx4 v3, s[4:7], s31 offen offset:1024 lds
    buffer_load_dwordx4 v4, s[4:7], s31 offen offset:2048 lds
    buffer_load_dwordx4 v5, s[4:7], s31 offen offset:3072 lds
    s_add_u32 s31, s31, s40
    s_add_u32 s32, s32, 4096
    v_mfma_f32_16x16x32_bf16 v[128:131], v[68:71], v[100:103], v[128:131]
    v_mfma_f32_16x16x32_bf16 v[160:163], v[68:71], v[104:107], v[160:163]
    v_mfma_f32_16x16x32_bf16 v[192:195], v[68:71], v[108:111], v[192:195]
    v_lshrrev_b32 v18, 4, v1
    v_mfma_f32_16x16x32_bf16 v[224:227], v[68:71], v[112:115], v[224:227]
    v_bfe_u32 v20, v1, 2, 2
    v_mfma_f32_16x16x32_bf16 v[132:135], v[72:75], v[100:103], v[132:135]
    v_lshl_add_u32 v19, v18, 3, v20
    v_mfma_f32_16x16x32_bf16 v[164:167], v[72:75], v[104:107], v[164:167]
    v_lshlrev_b32 v19, 8, v19
    v_mfma_f32_16x16x32_bf16 v[196:199], v[72:75], v[108:111], v[196:199]
    v_and_b32 v21, 3, v1
    v_mfma_f32_16x16x32_bf16 v[228:231], v[72:75], v[112:115], v[228:231]
    v_lshl_add_u32 v19, v21, 3, v19
    v_mfma_f32_16x16x32_bf16 v[136:139], v[76:79], v[100:103], v[136:139]
    v_and_b32 v21, 1, v18
    v_mfma_f32_16x16x32_bf16 v[168:171], v[76:79], v[104:107], v[168:171]
    v_lshl_add_u32 v20, v21, 2, v20
    v_mfma_f32_16x16x32_bf16 v[200:203], v[76:79], v[108:111], v[200:203]
    v_xor_b32 v21, 0, v20
    v_mfma_f32_16x16x32_bf16 v[232:235], v[76:79], v[112:115], v[232:235]
    v_lshl_add_u32 v10, v21, 5, v19
    v_mfma_f32_16x16x32_bf16 v[140:143], v[80:83], v[100:103], v[140:143]
    v_xor_b32 v21, 1, v20
    v_mfma_f32_16x16x32_bf16 v[172:175], v[80:83], v[104:107], v[172:175]
    v_lshl_add_u32 v11, v21, 5, v19
    v_mfma_f32_16x16x32_bf16 v[204:207], v[80:83], v[108:111], v[204:207]
    v_xor_b32 v21, 2, v20
    v_mfma_f32_16x16x32_bf16 v[236:239], v[80:83], v[112:115], v[236:239]
    v_lshl_add_u32 v12, v21, 5, v19
    v_mfma_f32_16x16x32_bf16 v[144:147], v[84:87], v[100:103], v[144:147]
    v_xor_b32 v21, 3, v20
    v_mfma_f32_16x16x32_bf16 v[176:179], v[84:87], v[104:107], v[176:179]
    v_lshl_add_u32 v13, v21, 5, v19
    v_mfma_f32_16x16x32_bf16 v[208:211], v[84:87], v[108:111], v[208:211]
    v_xor_b32 v21, 4, v20
    v_mfma_f32_16x16x32_bf16 v[240:243], v[84:87], v[112:115], v[240:243]
    v_lshl_add_u32 v14, v21, 5, v19
    v_mfma_f32_16x16x32_bf16 v[148:151], v[88:91], v[100:103], v[148:151]
    v_xor_b32 v21, 5, v20
    v_mfma_f32_16x16x32_bf16 v[180:183], v[88:91], v[104:107], v[180:183]
    v_lshl_add_u32 v15, v21, 5, v19
    v_mfma_f32_16x16x32_bf16 v[212:215], v[88:91], v[108:111], v[212:215]
    v_xor_b32 v21, 6, v20
    v_mfma_f32_16x16x32_bf16 v[244:247], v[88:91], v[112:115], v[244:247]
    v_lshl_add_u32 v16, v21, 5, v19
    v_mfma_f32_16x16x32_bf16 v[152:155], v[92:95], v[100:103], v[152:155]
    v_xor_b32 v21, 7, v20
    v_mfma_f32_16x16x32_bf16 v[184:187], v[92:95], v[104:107], v[184:187]
    v_lshl_add_u32 v17, v21, 5, v19
    v_mfma_f32_16x16x32_bf16 v[216:219], v[92:95], v[108:111], v[216:219]
    s_lshl_b32 s45, s29, 20
    v_mfma_f32_16x16x32_bf16 v[248:251], v[92:95], v[112:115], v[248:251]
    v_mfma_f32_16x16x32_bf16 v[156:159], v[96:99], v[100:103], v[156:159]
    v_mfma_f32_16x16x32_bf16 v[188:191], v[96:99], v[104:107], v[188:191]
    v_mfma_f32_16x16x32_bf16 v[220:223], v[96:99], v[108:111], v[220:223]
    v_mfma_f32_16x16x32_bf16 v[252:255], v[96:99], v[112:115], v[252:255]
L_p1_done:
    s_waitcnt vmcnt(12)
    buffer_load_dwordx4 v[96:99], v6, s[8:11], s32 offen offset:0 sc1
    buffer_load_dwordx4 v[100:103], v7, s[8:11], s32 offen offset:0 sc1
    buffer_load_dwordx4 v[104:107], v6, s[8:11], s32 offen offset:1024 sc1
    buffer_load_dwordx4 v[108:111], v7, s[8:11], s32 offen offset:1024 sc1
    buffer_load_dwordx4 v[112:115], v6, s[8:11], s32 offen offset:2048 sc1
    buffer_load_dwordx4 v[116:119], v7, s[8:11], s32 offen offset:2048 sc1
    ds_read_b64_tr_b16 v[64:65], v10 offset:0
    ds_read_b64_tr_b16 v[66:67], v10 offset:1024
    ds_read_b64_tr_b16 v[68:69], v11 offset:0
    ds_read_b64_tr_b16 v[70:71], v11 offset:1024
    ds_read_b64_tr_b16 v[72:73], v12 offset:0
    ds_read_b64_tr_b16 v[74:75], v12 offset:1024
    ds_read_b64_tr_b16 v[76:77], v13 offset:0
    ds_read_b64_tr_b16 v[78:79], v13 offset:1024
    ds_read_b64_tr_b16 v[80:81], v14 offset:0
    ds_read_b64_tr_b16 v[82:83], v14 offset:1024
    ds_read_b64_tr_b16 v[84:85], v15 offset:0
    ds_read_b64_tr_b16 v[86:87], v15 offset:1024
    v_cvt_pk_bf16_f32 v128, v128, v129
    v_cvt_pk_bf16_f32 v129, v130, v131
    v_cvt_pk_bf16_f32 v130, v132, v133
    v_cvt_pk_bf16_f32 v131, v134, v135
    v_cvt_pk_bf16_f32 v132, v136, v137
    v_cvt_pk_bf16_f32 v133, v138, v139
    v_cvt_pk_bf16_f32 v134, v140, v141
    v_cvt_pk_bf16_f32 v135, v142, v143
    v_cvt_pk_bf16_f32 v136, v144, v145
    v_cvt_pk_bf16_f32 v137, v146, v147
    v_cvt_pk_bf16_f32 v138, v148, v149
    v_cvt_pk_bf16_f32 v139, v150, v151
    v_cvt_pk_bf16_f32 v140, v152, v153
    v_cvt_pk_bf16_f32 v141, v154, v155
    v_cvt_pk_bf16_f32 v142, v156, v157
    v_cvt_pk_bf16_f32 v143, v158, v159
    v_cvt_pk_bf16_f32 v144, v160, v161
    v_cvt_pk_bf16_f32 v145, v162, v163
    v_cvt_pk_bf16_f32 v146, v164, v165
    v_cvt_pk_bf16_f32 v147, v166, v167
    v_cvt_pk_bf16_f32 v148, v168, v169
    v_cvt_pk_bf16_f32 v149, v170, v171
    v_cvt_pk_bf16_f32 v150, v172, v173
    v_cvt_pk_bf16_f32 v151, v174, v175
    v_cvt_pk_bf16_f32 v152, v176, v177
    v_cvt_pk_bf16_f32 v153, v178, v179
    v_cvt_pk_bf16_f32 v154, v180, v181
    v_cvt_pk_bf16_f32 v155, v182, v183
    v_cvt_pk_bf16_f32 v156, v184, v185
    v_cvt_pk_bf16_f32 v157, v186, v187
    v_cvt_pk_bf16_f32 v158, v188, v189
    v_cvt_pk_bf16_f32 v159, v190, v191
    v_cvt_pk_bf16_f32 v160, v192, v193
    v_cvt_pk_bf16_f32 v161, v194, v195
    v_cvt_pk_bf16_f32 v162, v196, v197
    v_cvt_pk_bf16_f32 v163, v198, v199
    v_cvt_pk_bf16_f32 v164, v200, v201
    v_cvt_pk_bf16_f32 v165, v202, v203
    v_cvt_pk_bf16_f32 v166, v204, v205
    v_cvt_pk_bf16_f32 v167, v206, v207
    v_cvt_pk_bf16_f32 v168, v208, v209
    v_cvt_pk_bf16_f32 v169, v210, v211
    v_cvt_pk_bf16_f32 v170, v212, v213
    v_cvt_pk_bf16_f32 v171, v214, v215
    v_cvt_pk_bf16_f32 v172, v216, v217
    v_cvt_pk_bf16_f32 v173, v218, v219
    v_cvt_pk_bf16_f32 v174, v220, v221
    v_cvt_pk_bf16_f32 v175, v222, v223
    v_cvt_pk_bf16_f32 v176, v224, v225
    v_cvt_pk_bf16_f32 v177, v226, v227
    v_cvt_pk_bf16_f32 v178, v228, v229
    v_cvt_pk_bf16_f32 v179, v230, v231
    v_cvt_pk_bf16_f32 v180, v232, v233
    v_cvt_pk_bf16_f32 v181, v234, v235
    v_cvt_pk_bf16_f32 v182, v236, v237
    v_cvt_pk_bf16_f32 v183, v238, v239
    v_cvt_pk_bf16_f32 v184, v240, v241
    v_cvt_pk_bf16_f32 v185, v242, v243
    v_cvt_pk_bf16_f32 v186, v244, v245
    v_cvt_pk_bf16_f32 v187, v246, v247
    v_cvt_pk_bf16_f32 v188, v248, v249
    v_cvt_pk_bf16_f32 v189, v250, v251
    v_cvt_pk_bf16_f32 v190, v252, v253
    v_cvt_pk_bf16_f32 v191, v254, v255
    s_lshl_b32 s38, s29, 20
    s_lshl_b32 s37, s30, 17
    s_add_u32 s38, s38, s37
    s_bfe_u32 s37, s28, 0x10001
    s_lshl_b32 s37, s37, 16
    s_add_u32 s38, s38, s37
    s_lshr_b32 s36, s28, 2
    s_lshl_b32 s37, s36, 15
    s_add_u32 s38, s38, s37
    s_and_b32 s37, s28, 1
    s_add_u32 s36, s36, 11
    s_lshl_b32 s37, s37, s36
    s_add_u32 s38, s38, s37
    s_cmp_lt_u32 s28, 4
    s_cselect_b32 s36, 4, 32
    s_cselect_b32 s37, 16, 64
    s_cselect_b32 s39, 32, 4
    s_lshl_b32 s36, s36, 8
    s_lshl_b32 s37, s37, 8
    s_lshl_b32 s39, s39, 8
    s_mov_b64 s[16:17], s[12:13]
    s_mov_b64 s[18:19], s[14:15]
    s_cmp_eq_u32 s30, 0
    s_cselect_b32 s52, 2, 4
    v_lshlrev_b32 v58, 4, v1
    v_add_u32 v59, s36, v58
    v_add_u32 v60, s37, v58
    v_add_u32 v61, s36, v60
    v_mov_b64 v[192:193], 0
    v_mov_b64 v[194:195], 0
    v_mov_b64 v[196:197], 0
    v_mov_b64 v[198:199], 0
    v_mov_b64 v[200:201], 0
    v_mov_b64 v[202:203], 0
    v_mov_b64 v[204:205], 0
    v_mov_b64 v[206:207], 0
    v_mov_b64 v[208:209], 0
    v_mov_b64 v[210:211], 0
    v_mov_b64 v[212:213], 0
    v_mov_b64 v[214:215], 0
    v_mov_b64 v[216:217], 0
    v_mov_b64 v[218:219], 0
    v_mov_b64 v[220:221], 0
    v_mov_b64 v[222:223], 0
    v_mov_b64 v[224:225], 0
    v_mov_b64 v[226:227], 0
    v_mov_b64 v[228:229], 0
    v_mov_b64 v[230:231], 0
    v_mov_b64 v[232:233], 0
    v_mov_b64 v[234:235], 0
    v_mov_b64 v[236:237], 0
    v_mov_b64 v[238:239], 0
    v_mov_b64 v[240:241], 0
    v_mov_b64 v[242:243], 0
    v_mov_b64 v[244:245], 0
    v_mov_b64 v[246:247], 0
    v_mov_b64 v[248:249], 0
    v_mov_b64 v[250:251], 0
    v_mov_b64 v[252:253], 0
    v_mov_b64 v[254:255], 0
    s_mov_b32 s35, 0
    s_waitcnt vmcnt(10)
    s_cmp_eq_u32 s30, 0
    s_cbranch_scc1 L_recurrent_scan__compressed_kv_cla__moe_arch_mod__prompt_kernel_rare_65
L_recurrent_scan__compressed_kv_cla__moe_arch_mod__prompt_kernel_back_66:
    .p2align 6
L_p2_loop:
    s_cmp_ge_u32 s35, 2
    s_cbranch_scc1 L_recurrent_scan__compressed_kv_cla__moe_arch_mod__prompt_kernel_rare_57
L_recurrent_scan__compressed_kv_cla__moe_arch_mod__prompt_kernel_back_58:
    s_waitcnt lgkmcnt(8)
    v_mfma_f32_16x16x32_bf16 v[192:195], v[64:67], v[24:27], v[192:195]
    ds_read_b64_tr_b16 v[88:89], v16 offset:0
    v_mfma_f32_16x16x32_bf16 v[224:227], v[64:67], v[28:31], v[224:227]
    ds_read_b64_tr_b16 v[90:91], v16 offset:1024
    v_mfma_f32_16x16x32_bf16 v[196:199], v[68:71], v[24:27], v[196:199]
    ds_read_b64_tr_b16 v[92:93], v17 offset:0
    buffer_load_dwordx4 v[120:123], v6, s[8:11], s32 offen offset:3072 sc1
    v_mfma_f32_16x16x32_bf16 v[228:231], v[68:71], v[28:31], v[228:231]
    ds_read_b64_tr_b16 v[94:95], v17 offset:1024
    s_waitcnt lgkmcnt(8)
    v_mfma_f32_16x16x32_bf16 v[200:203], v[72:75], v[24:27], v[200:203]
    ds_read_b64_tr_b16 v[64:65], v10 offset:8192
    v_mfma_f32_16x16x32_bf16 v[232:235], v[72:75], v[28:31], v[232:235]
    ds_read_b64_tr_b16 v[66:67], v10 offset:9216
    v_mfma_f32_16x16x32_bf16 v[204:207], v[76:79], v[24:27], v[204:207]
    ds_read_b64_tr_b16 v[68:69], v11 offset:8192
    buffer_load_dwordx4 v[124:127], v7, s[8:11], s32 offen offset:3072 sc1
    v_mfma_f32_16x16x32_bf16 v[236:239], v[76:79], v[28:31], v[236:239]
    ds_read_b64_tr_b16 v[70:71], v11 offset:9216
    s_add_u32 s32, s32, 4096
    s_waitcnt lgkmcnt(8)
    v_mfma_f32_16x16x32_bf16 v[208:211], v[80:83], v[24:27], v[208:211]
    ds_read_b64_tr_b16 v[72:73], v12 offset:8192
    s_cmp_lt_u32 s35, 3
    s_cselect_b32 s10, 4194304, 0
    v_mfma_f32_16x16x32_bf16 v[240:243], v[80:83], v[28:31], v[240:243]
    ds_read_b64_tr_b16 v[74:75], v12 offset:9216
    s_cmp_lt_u32 s35, s52
    s_cselect_b32 s18, s18, 0
    v_mfma_f32_16x16x32_bf16 v[212:215], v[84:87], v[24:27], v[212:215]
    ds_read_b64_tr_b16 v[76:77], v13 offset:8192
    buffer_store_dwordx4 v[128:131], v58, s[16:19], s38 offen sc1
    v_mfma_f32_16x16x32_bf16 v[244:247], v[84:87], v[28:31], v[244:247]
    ds_read_b64_tr_b16 v[78:79], v13 offset:9216
    s_waitcnt lgkmcnt(8)
    v_mfma_f32_16x16x32_bf16 v[216:219], v[88:91], v[24:27], v[216:219]
    ds_read_b64_tr_b16 v[80:81], v14 offset:8192
    v_mov_b64 v[128:129], v[144:145]
    v_mfma_f32_16x16x32_bf16 v[248:251], v[88:91], v[28:31], v[248:251]
    ds_read_b64_tr_b16 v[82:83], v14 offset:9216
    v_mfma_f32_16x16x32_bf16 v[220:223], v[92:95], v[24:27], v[220:223]
    ds_read_b64_tr_b16 v[84:85], v15 offset:8192
    v_mov_b64 v[130:131], v[146:147]
    v_mfma_f32_16x16x32_bf16 v[252:255], v[92:95], v[28:31], v[252:255]
    ds_read_b64_tr_b16 v[86:87], v15 offset:9216
    s_waitcnt lgkmcnt(8)
    v_mfma_f32_16x16x32_bf16 v[192:195], v[64:67], v[32:35], v[192:195]
    ds_read_b64_tr_b16 v[88:89], v16 offset:8192
    v_mov_b64 v[144:145], v[160:161]
    v_mfma_f32_16x16x32_bf16 v[224:227], v[64:67], v[36:39], v[224:227]
    ds_read_b64_tr_b16 v[90:91], v16 offset:9216
    v_mfma_f32_16x16x32_bf16 v[196:199], v[68:71], v[32:35], v[196:199]
    ds_read_b64_tr_b16 v[92:93], v17 offset:8192
    buffer_load_dwordx4 v[24:27], v6, s[8:11], s32 offen offset:0 sc1
    v_mov_b64 v[146:147], v[162:163]
    v_mfma_f32_16x16x32_bf16 v[228:231], v[68:71], v[36:39], v[228:231]
    ds_read_b64_tr_b16 v[94:95], v17 offset:9216
    s_waitcnt lgkmcnt(8)
    v_mfma_f32_16x16x32_bf16 v[200:203], v[72:75], v[32:35], v[200:203]
    ds_read_b64_tr_b16 v[64:65], v10 offset:16384
    v_mov_b64 v[160:161], v[176:177]
    v_mfma_f32_16x16x32_bf16 v[232:235], v[72:75], v[36:39], v[232:235]
    ds_read_b64_tr_b16 v[66:67], v10 offset:17408
    v_mfma_f32_16x16x32_bf16 v[204:207], v[76:79], v[32:35], v[204:207]
    ds_read_b64_tr_b16 v[68:69], v11 offset:16384
    buffer_load_dwordx4 v[28:31], v7, s[8:11], s32 offen offset:0 sc1
    v_mov_b64 v[162:163], v[178:179]
    v_mfma_f32_16x16x32_bf16 v[236:239], v[76:79], v[36:39], v[236:239]
    ds_read_b64_tr_b16 v[70:71], v11 offset:17408
    s_waitcnt lgkmcnt(8)
    v_mfma_f32_16x16x32_bf16 v[208:211], v[80:83], v[32:35], v[208:211]
    ds_read_b64_tr_b16 v[72:73], v12 offset:16384
    v_mfma_f32_16x16x32_bf16 v[240:243], v[80:83], v[36:39], v[240:243]
    ds_read_b64_tr_b16 v[74:75], v12 offset:17408
    v_mfma_f32_16x16x32_bf16 v[212:215], v[84:87], v[32:35], v[212:215]
    ds_read_b64_tr_b16 v[76:77], v13 offset:16384
    v_mfma_f32_16x16x32_bf16 v[244:247], v[84:87], v[36:39], v[244:247]
    ds_read_b64_tr_b16 v[78:79], v13 offset:17408
    s_waitcnt lgkmcnt(8)
    v_mfma_f32_16x16x32_bf16 v[216:219], v[88:91], v[32:35], v[216:219]
    ds_read_b64_tr_b16 v[80:81], v14 offset:16384
    v_mfma_f32_16x16x32_bf16 v[248:251], v[88:91], v[36:39], v[248:251]
    ds_read_b64_tr_b16 v[82:83], v14 offset:17408
    v_mfma_f32_16x16x32_bf16 v[220:223], v[92:95], v[32:35], v[220:223]
    ds_read_b64_tr_b16 v[84:85], v15 offset:16384
    buffer_store_dwordx4 v[132:135], v59, s[16:19], s38 offen sc1
    v_mfma_f32_16x16x32_bf16 v[252:255], v[92:95], v[36:39], v[252:255]
    ds_read_b64_tr_b16 v[86:87], v15 offset:17408
    s_waitcnt lgkmcnt(8)
    v_mfma_f32_16x16x32_bf16 v[192:195], v[64:67], v[40:43], v[192:195]
    ds_read_b64_tr_b16 v[88:89], v16 offset:16384
    v_mov_b64 v[132:133], v[148:149]
    v_mfma_f32_16x16x32_bf16 v[224:227], v[64:67], v[44:47], v[224:227]
    ds_read_b64_tr_b16 v[90:91], v16 offset:17408
    v_mfma_f32_16x16x32_bf16 v[196:199], v[68:71], v[40:43], v[196:199]
    ds_read_b64_tr_b16 v[92:93], v17 offset:16384
    buffer_load_dwordx4 v[32:35], v6, s[8:11], s32 offen offset:1024 sc1
    v_mov_b64 v[134:135], v[150:151]
    v_mfma_f32_16x16x32_bf16 v[228:231], v[68:71], v[44:47], v[228:231]
    ds_read_b64_tr_b16 v[94:95], v17 offset:17408
    s_waitcnt lgkmcnt(8)
    v_mfma_f32_16x16x32_bf16 v[200:203], v[72:75], v[40:43], v[200:203]
    ds_read_b64_tr_b16 v[64:65], v10 offset:24576
    v_mov_b64 v[148:149], v[164:165]
    v_mfma_f32_16x16x32_bf16 v[232:235], v[72:75], v[44:47], v[232:235]
    ds_read_b64_tr_b16 v[66:67], v10 offset:25600
    v_mfma_f32_16x16x32_bf16 v[204:207], v[76:79], v[40:43], v[204:207]
    ds_read_b64_tr_b16 v[68:69], v11 offset:24576
    buffer_load_dwordx4 v[36:39], v7, s[8:11], s32 offen offset:1024 sc1
    v_mov_b64 v[150:151], v[166:167]
    v_mfma_f32_16x16x32_bf16 v[236:239], v[76:79], v[44:47], v[236:239]
    ds_read_b64_tr_b16 v[70:71], v11 offset:25600
    s_waitcnt lgkmcnt(8)
    v_mfma_f32_16x16x32_bf16 v[208:211], v[80:83], v[40:43], v[208:211]
    ds_read_b64_tr_b16 v[72:73], v12 offset:24576
    v_mov_b64 v[164:165], v[180:181]
    v_mfma_f32_16x16x32_bf16 v[240:243], v[80:83], v[44:47], v[240:243]
    ds_read_b64_tr_b16 v[74:75], v12 offset:25600
    v_mfma_f32_16x16x32_bf16 v[212:215], v[84:87], v[40:43], v[212:215]
    ds_read_b64_tr_b16 v[76:77], v13 offset:24576
    v_mov_b64 v[166:167], v[182:183]
    v_mfma_f32_16x16x32_bf16 v[244:247], v[84:87], v[44:47], v[244:247]
    ds_read_b64_tr_b16 v[78:79], v13 offset:25600
    s_waitcnt lgkmcnt(8)
    v_mfma_f32_16x16x32_bf16 v[216:219], v[88:91], v[40:43], v[216:219]
    ds_read_b64_tr_b16 v[80:81], v14 offset:24576
    v_mfma_f32_16x16x32_bf16 v[248:251], v[88:91], v[44:47], v[248:251]
    ds_read_b64_tr_b16 v[82:83], v14 offset:25600
    v_mfma_f32_16x16x32_bf16 v[220:223], v[92:95], v[40:43], v[220:223]
    ds_read_b64_tr_b16 v[84:85], v15 offset:24576
    v_mfma_f32_16x16x32_bf16 v[252:255], v[92:95], v[44:47], v[252:255]
    ds_read_b64_tr_b16 v[86:87], v15 offset:25600
    s_waitcnt lgkmcnt(8)
    s_waitcnt vmcnt(20)
    v_mfma_f32_16x16x32_bf16 v[192:195], v[64:67], v[48:51], v[192:195]
    ds_read_b64_tr_b16 v[88:89], v16 offset:24576
    v_mfma_f32_16x16x32_bf16 v[224:227], v[64:67], v[52:55], v[224:227]
    ds_read_b64_tr_b16 v[90:91], v16 offset:25600
    v_mfma_f32_16x16x32_bf16 v[196:199], v[68:71], v[48:51], v[196:199]
    ds_read_b64_tr_b16 v[92:93], v17 offset:24576
    buffer_load_dwordx4 v[40:43], v6, s[8:11], s32 offen offset:2048 sc1
    v_mfma_f32_16x16x32_bf16 v[228:231], v[68:71], v[52:55], v[228:231]
    ds_read_b64_tr_b16 v[94:95], v17 offset:25600
    s_waitcnt lgkmcnt(8)
    v_mfma_f32_16x16x32_bf16 v[200:203], v[72:75], v[48:51], v[200:203]
    v_mfma_f32_16x16x32_bf16 v[232:235], v[72:75], v[52:55], v[232:235]
    v_mfma_f32_16x16x32_bf16 v[204:207], v[76:79], v[48:51], v[204:207]
    buffer_load_dwordx4 v[44:47], v7, s[8:11], s32 offen offset:2048 sc1
    v_mfma_f32_16x16x32_bf16 v[236:239], v[76:79], v[52:55], v[236:239]
    s_cmp_ge_u32 s35, 2
    s_cbranch_scc1 L_recurrent_scan__compressed_kv_cla__moe_arch_mod__prompt_kernel_rare_47
L_recurrent_scan__compressed_kv_cla__moe_arch_mod__prompt_kernel_back_48:
    s_waitcnt lgkmcnt(0)
    s_waitcnt vmcnt(10)
    s_barrier
    v_mfma_f32_16x16x32_bf16 v[208:211], v[80:83], v[48:51], v[208:211]
    ds_read_b64_tr_b16 v[64:65], v10 offset:32768
    ds_read_b64_tr_b16 v[66:67], v10 offset:33792
    v_mfma_f32_16x16x32_bf16 v[240:243], v[80:83], v[52:55], v[240:243]
    ds_read_b64_tr_b16 v[68:69], v11 offset:32768
    ds_read_b64_tr_b16 v[70:71], v11 offset:33792
    v_mfma_f32_16x16x32_bf16 v[212:215], v[84:87], v[48:51], v[212:215]
    ds_read_b64_tr_b16 v[72:73], v12 offset:32768
    ds_read_b64_tr_b16 v[74:75], v12 offset:33792
    v_mfma_f32_16x16x32_bf16 v[244:247], v[84:87], v[52:55], v[244:247]
    ds_read_b64_tr_b16 v[76:77], v13 offset:32768
    ds_read_b64_tr_b16 v[78:79], v13 offset:33792
    s_add_u32 m0, s33, 0
    v_mfma_f32_16x16x32_bf16 v[216:219], v[88:91], v[48:51], v[216:219]
    ds_read_b64_tr_b16 v[80:81], v14 offset:32768
    ds_read_b64_tr_b16 v[82:83], v14 offset:33792
    buffer_load_dwordx4 v2, s[4:7], s31 offen offset:0 sc1 lds
    v_mfma_f32_16x16x32_bf16 v[248:251], v[88:91], v[52:55], v[248:251]
    buffer_load_dwordx4 v3, s[4:7], s31 offen offset:1024 sc1 lds
    v_mfma_f32_16x16x32_bf16 v[220:223], v[92:95], v[48:51], v[220:223]
    ds_read_b64_tr_b16 v[84:85], v15 offset:32768
    ds_read_b64_tr_b16 v[86:87], v15 offset:33792
    buffer_load_dwordx4 v4, s[4:7], s31 offen offset:2048 sc1 lds
    v_mfma_f32_16x16x32_bf16 v[252:255], v[92:95], v[52:55], v[252:255]
    buffer_load_dwordx4 v5, s[4:7], s31 offen offset:3072 sc1 lds
    s_add_u32 s31, s31, s40
    s_cmp_ge_u32 s35, 2
    s_cbranch_scc1 L_recurrent_scan__compressed_kv_cla__moe_arch_mod__prompt_kernel_rare_63
L_recurrent_scan__compressed_kv_cla__moe_arch_mod__prompt_kernel_back_64:
    s_waitcnt lgkmcnt(8)
    s_waitcnt vmcnt(18)
    v_mfma_f32_16x16x32_bf16 v[192:195], v[64:67], v[96:99], v[192:195]
    ds_read_b64_tr_b16 v[88:89], v16 offset:32768
    v_mfma_f32_16x16x32_bf16 v[224:227], v[64:67], v[100:103], v[224:227]
    ds_read_b64_tr_b16 v[90:91], v16 offset:33792
    v_mfma_f32_16x16x32_bf16 v[196:199], v[68:71], v[96:99], v[196:199]
    ds_read_b64_tr_b16 v[92:93], v17 offset:32768
    buffer_load_dwordx4 v[48:51], v6, s[8:11], s32 offen offset:3072 sc1
    v_mfma_f32_16x16x32_bf16 v[228:231], v[68:71], v[100:103], v[228:231]
    ds_read_b64_tr_b16 v[94:95], v17 offset:33792
    s_waitcnt lgkmcnt(8)
    v_mfma_f32_16x16x32_bf16 v[200:203], v[72:75], v[96:99], v[200:203]
    ds_read_b64_tr_b16 v[64:65], v10 offset:40960
    v_mfma_f32_16x16x32_bf16 v[232:235], v[72:75], v[100:103], v[232:235]
    ds_read_b64_tr_b16 v[66:67], v10 offset:41984
    v_mfma_f32_16x16x32_bf16 v[204:207], v[76:79], v[96:99], v[204:207]
    ds_read_b64_tr_b16 v[68:69], v11 offset:40960
    buffer_load_dwordx4 v[52:55], v7, s[8:11], s32 offen offset:3072 sc1
    v_mfma_f32_16x16x32_bf16 v[236:239], v[76:79], v[100:103], v[236:239]
    ds_read_b64_tr_b16 v[70:71], v11 offset:41984
    s_add_u32 s32, s32, 4096
    s_waitcnt lgkmcnt(8)
    v_mfma_f32_16x16x32_bf16 v[208:211], v[80:83], v[96:99], v[208:211]
    ds_read_b64_tr_b16 v[72:73], v12 offset:40960
    v_mfma_f32_16x16x32_bf16 v[240:243], v[80:83], v[100:103], v[240:243]
    ds_read_b64_tr_b16 v[74:75], v12 offset:41984
    v_mfma_f32_16x16x32_bf16 v[212:215], v[84:87], v[96:99], v[212:215]
    ds_read_b64_tr_b16 v[76:77], v13 offset:40960
    buffer_store_dwordx4 v[136:139], v60, s[16:19], s38 offen sc1
    v_mfma_f32_16x16x32_bf16 v[244:247], v[84:87], v[100:103], v[244:247]
    ds_read_b64_tr_b16 v[78:79], v13 offset:41984
    s_waitcnt lgkmcnt(8)
    v_mfma_f32_16x16x32_bf16 v[216:219], v[88:91], v[96:99], v[216:219]
    ds_read_b64_tr_b16 v[80:81], v14 offset:40960
    v_mov_b64 v[136:137], v[152:153]
    v_mfma_f32_16x16x32_bf16 v[248:251], v[88:91], v[100:103], v[248:251]
    ds_read_b64_tr_b16 v[82:83], v14 offset:41984
    v_mfma_f32_16x16x32_bf16 v[220:223], v[92:95], v[96:99], v[220:223]
    ds_read_b64_tr_b16 v[84:85], v15 offset:40960
    v_mov_b64 v[138:139], v[154:155]
    v_mfma_f32_16x16x32_bf16 v[252:255], v[92:95], v[100:103], v[252:255]
    ds_read_b64_tr_b16 v[86:87], v15 offset:41984
    s_waitcnt lgkmcnt(8)
    s_waitcnt vmcnt(19)
    v_mfma_f32_16x16x32_bf16 v[192:195], v[64:67], v[104:107], v[192:195]
    ds_read_b64_tr_b16 v[88:89], v16 offset:40960
    v_mov_b64 v[152:153], v[168:169]
    v_mfma_f32_16x16x32_bf16 v[224:227], v[64:67], v[108:111], v[224:227]
    ds_read_b64_tr_b16 v[90:91], v16 offset:41984
    v_mfma_f32_16x16x32_bf16 v[196:199], v[68:71], v[104:107], v[196:199]
    ds_read_b64_tr_b16 v[92:93], v17 offset:40960
    buffer_load_dwordx4 v[96:99], v6, s[8:11], s32 offen offset:0 sc1
    v_mov_b64 v[154:155], v[170:171]
    v_mfma_f32_16x16x32_bf16 v[228:231], v[68:71], v[108:111], v[228:231]
    ds_read_b64_tr_b16 v[94:95], v17 offset:41984
    s_waitcnt lgkmcnt(8)
    v_mfma_f32_16x16x32_bf16 v[200:203], v[72:75], v[104:107], v[200:203]
    ds_read_b64_tr_b16 v[64:65], v10 offset:49152
    v_mov_b64 v[168:169], v[184:185]
    v_mfma_f32_16x16x32_bf16 v[232:235], v[72:75], v[108:111], v[232:235]
    ds_read_b64_tr_b16 v[66:67], v10 offset:50176
    v_mfma_f32_16x16x32_bf16 v[204:207], v[76:79], v[104:107], v[204:207]
    ds_read_b64_tr_b16 v[68:69], v11 offset:49152
    buffer_load_dwordx4 v[100:103], v7, s[8:11], s32 offen offset:0 sc1
    v_mov_b64 v[170:171], v[186:187]
    v_mfma_f32_16x16x32_bf16 v[236:239], v[76:79], v[108:111], v[236:239]
    ds_read_b64_tr_b16 v[70:71], v11 offset:50176
    s_waitcnt lgkmcnt(8)
    v_mfma_f32_16x16x32_bf16 v[208:211], v[80:83], v[104:107], v[208:211]
    ds_read_b64_tr_b16 v[72:73], v12 offset:49152
    v_mfma_f32_16x16x32_bf16 v[240:243], v[80:83], v[108:111], v[240:243]
    ds_read_b64_tr_b16 v[74:75], v12 offset:50176
    v_mfma_f32_16x16x32_bf16 v[212:215], v[84:87], v[104:107], v[212:215]
    ds_read_b64_tr_b16 v[76:77], v13 offset:49152
    v_mfma_f32_16x16x32_bf16 v[244:247], v[84:87], v[108:111], v[244:247]
    ds_read_b64_tr_b16 v[78:79], v13 offset:50176
    s_waitcnt lgkmcnt(8)
    v_mfma_f32_16x16x32_bf16 v[216:219], v[88:91], v[104:107], v[216:219]
    ds_read_b64_tr_b16 v[80:81], v14 offset:49152
    v_mfma_f32_16x16x32_bf16 v[248:251], v[88:91], v[108:111], v[248:251]
    ds_read_b64_tr_b16 v[82:83], v14 offset:50176
    v_mfma_f32_16x16x32_bf16 v[220:223], v[92:95], v[104:107], v[220:223]
    ds_read_b64_tr_b16 v[84:85], v15 offset:49152
    buffer_store_dwordx4 v[140:143], v61, s[16:19], s38 offen sc1
    v_mfma_f32_16x16x32_bf16 v[252:255], v[92:95], v[108:111], v[252:255]
    ds_read_b64_tr_b16 v[86:87], v15 offset:50176
    s_add_u32 s38, s38, s39
    s_waitcnt lgkmcnt(8)
    s_waitcnt vmcnt(20)
    v_mfma_f32_16x16x32_bf16 v[192:195], v[64:67], v[112:115], v[192:195]
    ds_read_b64_tr_b16 v[88:89], v16 offset:49152
    v_mov_b64 v[140:141], v[156:157]
    v_mfma_f32_16x16x32_bf16 v[224:227], v[64:67], v[116:119], v[224:227]
    ds_read_b64_tr_b16 v[90:91], v16 offset:50176
    v_mfma_f32_16x16x32_bf16 v[196:199], v[68:71], v[112:115], v[196:199]
    ds_read_b64_tr_b16 v[92:93], v17 offset:49152
    buffer_load_dwordx4 v[104:107], v6, s[8:11], s32 offen offset:1024 sc1
    v_mov_b64 v[142:143], v[158:159]
    v_mfma_f32_16x16x32_bf16 v[228:231], v[68:71], v[116:119], v[228:231]
    ds_read_b64_tr_b16 v[94:95], v17 offset:50176
    s_waitcnt lgkmcnt(8)
    v_mfma_f32_16x16x32_bf16 v[200:203], v[72:75], v[112:115], v[200:203]
    ds_read_b64_tr_b16 v[64:65], v10 offset:57344
    v_mov_b64 v[156:157], v[172:173]
    v_mfma_f32_16x16x32_bf16 v[232:235], v[72:75], v[116:119], v[232:235]
    ds_read_b64_tr_b16 v[66:67], v10 offset:58368
    v_mfma_f32_16x16x32_bf16 v[204:207], v[76:79], v[112:115], v[204:207]
    ds_read_b64_tr_b16 v[68:69], v11 offset:57344
    buffer_load_dwordx4 v[108:111], v7, s[8:11], s32 offen offset:1024 sc1
    v_mov_b64 v[158:159], v[174:175]
    v_mfma_f32_16x16x32_bf16 v[236:239], v[76:79], v[116:119], v[236:239]
    ds_read_b64_tr_b16 v[70:71], v11 offset:58368
    s_waitcnt lgkmcnt(8)
    v_mfma_f32_16x16x32_bf16 v[208:211], v[80:83], v[112:115], v[208:211]
    ds_read_b64_tr_b16 v[72:73], v12 offset:57344
    v_mov_b64 v[172:173], v[188:189]
    v_mfma_f32_16x16x32_bf16 v[240:243], v[80:83], v[116:119], v[240:243]
    ds_read_b64_tr_b16 v[74:75], v12 offset:58368
    v_mfma_f32_16x16x32_bf16 v[212:215], v[84:87], v[112:115], v[212:215]
    ds_read_b64_tr_b16 v[76:77], v13 offset:57344
    v_mov_b64 v[174:175], v[190:191]
    v_mfma_f32_16x16x32_bf16 v[244:247], v[84:87], v[116:119], v[244:247]
    ds_read_b64_tr_b16 v[78:79], v13 offset:58368
    s_waitcnt lgkmcnt(8)
    v_mfma_f32_16x16x32_bf16 v[216:219], v[88:91], v[112:115], v[216:219]
    ds_read_b64_tr_b16 v[80:81], v14 offset:57344
    v_mfma_f32_16x16x32_bf16 v[248:251], v[88:91], v[116:119], v[248:251]
    ds_read_b64_tr_b16 v[82:83], v14 offset:58368
    v_mfma_f32_16x16x32_bf16 v[220:223], v[92:95], v[112:115], v[220:223]
    ds_read_b64_tr_b16 v[84:85], v15 offset:57344
    v_mfma_f32_16x16x32_bf16 v[252:255], v[92:95], v[116:119], v[252:255]
    ds_read_b64_tr_b16 v[86:87], v15 offset:58368
    s_waitcnt lgkmcnt(8)
    s_waitcnt vmcnt(20)
    v_mfma_f32_16x16x32_bf16 v[192:195], v[64:67], v[120:123], v[192:195]
    ds_read_b64_tr_b16 v[88:89], v16 offset:57344
    v_mfma_f32_16x16x32_bf16 v[224:227], v[64:67], v[124:127], v[224:227]
    ds_read_b64_tr_b16 v[90:91], v16 offset:58368
    v_mfma_f32_16x16x32_bf16 v[196:199], v[68:71], v[120:123], v[196:199]
    ds_read_b64_tr_b16 v[92:93], v17 offset:57344
    buffer_load_dwordx4 v[112:115], v6, s[8:11], s32 offen offset:2048 sc1
    v_mfma_f32_16x16x32_bf16 v[228:231], v[68:71], v[124:127], v[228:231]
    ds_read_b64_tr_b16 v[94:95], v17 offset:58368
    s_waitcnt lgkmcnt(8)
    v_mfma_f32_16x16x32_bf16 v[200:203], v[72:75], v[120:123], v[200:203]
    v_mfma_f32_16x16x32_bf16 v[232:235], v[72:75], v[124:127], v[232:235]
    v_mfma_f32_16x16x32_bf16 v[204:207], v[76:79], v[120:123], v[204:207]
    buffer_load_dwordx4 v[116:119], v7, s[8:11], s32 offen offset:2048 sc1
    v_mfma_f32_16x16x32_bf16 v[236:239], v[76:79], v[124:127], v[236:239]
    s_cmp_ge_u32 s35, 2
    s_cbranch_scc1 L_recurrent_scan__compressed_kv_cla__moe_arch_mod__prompt_kernel_rare_52
L_recurrent_scan__compressed_kv_cla__moe_arch_mod__prompt_kernel_back_53:
    s_waitcnt lgkmcnt(0)
    s_waitcnt vmcnt(10)
    s_barrier
    v_mfma_f32_16x16x32_bf16 v[208:211], v[80:83], v[120:123], v[208:211]
    ds_read_b64_tr_b16 v[64:65], v10 offset:0
    ds_read_b64_tr_b16 v[66:67], v10 offset:1024
    v_mfma_f32_16x16x32_bf16 v[240:243], v[80:83], v[124:127], v[240:243]
    ds_read_b64_tr_b16 v[68:69], v11 offset:0
    ds_read_b64_tr_b16 v[70:71], v11 offset:1024
    v_mfma_f32_16x16x32_bf16 v[212:215], v[84:87], v[120:123], v[212:215]
    ds_read_b64_tr_b16 v[72:73], v12 offset:0
    ds_read_b64_tr_b16 v[74:75], v12 offset:1024
    v_mfma_f32_16x16x32_bf16 v[244:247], v[84:87], v[124:127], v[244:247]
    ds_read_b64_tr_b16 v[76:77], v13 offset:0
    ds_read_b64_tr_b16 v[78:79], v13 offset:1024
    s_add_u32 m0, s33, 32768
    v_mfma_f32_16x16x32_bf16 v[216:219], v[88:91], v[120:123], v[216:219]
    ds_read_b64_tr_b16 v[80:81], v14 offset:0
    ds_read_b64_tr_b16 v[82:83], v14 offset:1024
    buffer_load_dwordx4 v2, s[4:7], s31 offen offset:0 sc1 lds
    v_mfma_f32_16x16x32_bf16 v[248:251], v[88:91], v[124:127], v[248:251]
    buffer_load_dwordx4 v3, s[4:7], s31 offen offset:1024 sc1 lds
    v_mfma_f32_16x16x32_bf16 v[220:223], v[92:95], v[120:123], v[220:223]
    ds_read_b64_tr_b16 v[84:85], v15 offset:0
    ds_read_b64_tr_b16 v[86:87], v15 offset:1024
    buffer_load_dwordx4 v4, s[4:7], s31 offen offset:2048 sc1 lds
    v_mfma_f32_16x16x32_bf16 v[252:255], v[92:95], v[124:127], v[252:255]
    buffer_load_dwordx4 v5, s[4:7], s31 offen offset:3072 sc1 lds
    s_add_u32 s31, s31, s40
    s_add_u32 s35, s35, 1
    s_cmp_lt_u32 s35, 4
    s_cbranch_scc1 L_p2_loop
    s_load_dwordx2 s[32:33], s[0:1], 40
    s_load_dwordx2 s[34:35], s[0:1], 80
    s_load_dwordx2 s[96:97], s[0:1], 0
    s_load_dwordx2 s[98:99], s[0:1], 88
    s_cmp_lt_u32 s28, 4
    s_cbranch_scc0 L_grp1
    v_mov_b32 v20, 1040356334
    s_and_b32 s37, s28, 3
    s_lshl_b32 s37, s37, 13
    v_lshlrev_b32 v7, 4, v1
    v_add_u32 v4, s37, v7
    v_add_u32 v6, 4096, v4
    v_add_u32 v19, 131072, v4
    s_mov_b32 s43, s37
    s_add_u32 s44, s37, 98304
    s_waitcnt vmcnt(4) lgkmcnt(0)
    v_pk_mul_f32 v[192:193], v[192:193], v[20:21] op_sel:[0,0] op_sel_hi:[1,0]
    v_pk_mul_f32 v[194:195], v[194:195], v[20:21] op_sel:[0,0] op_sel_hi:[1,0]
    v_pk_mul_f32 v[196:197], v[196:197], v[20:21] op_sel:[0,0] op_sel_hi:[1,0]
    v_pk_mul_f32 v[198:199], v[198:199], v[20:21] op_sel:[0,0] op_sel_hi:[1,0]
    v_cvt_pk_bf16_f32 v128, v192, v193
    v_cvt_pk_bf16_f32 v129, v194, v195
    v_cvt_pk_bf16_f32 v130, v196, v197
    v_cvt_pk_bf16_f32 v131, v198, v199
    ds_write_b128 v19, v[128:131] offset:0
    v_pk_mul_f32 v[200:201], v[200:201], v[20:21] op_sel:[0,0] op_sel_hi:[1,0]
    v_pk_mul_f32 v[202:203], v[202:203], v[20:21] op_sel:[0,0] op_sel_hi:[1,0]
    v_pk_mul_f32 v[204:205], v[204:205], v[20:21] op_sel:[0,0] op_sel_hi:[1,0]
    v_pk_mul_f32 v[206:207], v[206:207], v[20:21] op_sel:[0,0] op_sel_hi:[1,0]
    v_cvt_pk_bf16_f32 v132, v200, v201
    v_cvt_pk_bf16_f32 v133, v202, v203
    v_cvt_pk_bf16_f32 v134, v204, v205
    v_cvt_pk_bf16_f32 v135, v206, v207
    ds_write_b128 v19, v[132:135] offset:1024
    v_pk_mul_f32 v[208:209], v[208:209], v[20:21] op_sel:[0,0] op_sel_hi:[1,0]
    v_pk_mul_f32 v[210:211], v[210:211], v[20:21] op_sel:[0,0] op_sel_hi:[1,0]
    v_pk_mul_f32 v[212:213], v[212:213], v[20:21] op_sel:[0,0] op_sel_hi:[1,0]
    v_pk_mul_f32 v[214:215], v[214:215], v[20:21] op_sel:[0,0] op_sel_hi:[1,0]
    v_cvt_pk_bf16_f32 v136, v208, v209
    v_cvt_pk_bf16_f32 v137, v210, v211
    v_cvt_pk_bf16_f32 v138, v212, v213
    v_cvt_pk_bf16_f32 v139, v214, v215
    ds_write_b128 v19, v[136:139] offset:2048
    v_pk_mul_f32 v[216:217], v[216:217], v[20:21] op_sel:[0,0] op_sel_hi:[1,0]
    v_pk_mul_f32 v[218:219], v[218:219], v[20:21] op_sel:[0,0] op_sel_hi:[1,0]
    v_pk_mul_f32 v[220:221], v[220:221], v[20:21] op_sel:[0,0] op_sel_hi:[1,0]
    v_pk_mul_f32 v[222:223], v[222:223], v[20:21] op_sel:[0,0] op_sel_hi:[1,0]
    v_cvt_pk_bf16_f32 v140, v216, v217
    v_cvt_pk_bf16_f32 v141, v218, v219
    v_cvt_pk_bf16_f32 v142, v220, v221
    v_cvt_pk_bf16_f32 v143, v222, v223
    ds_write_b128 v19, v[140:143] offset:3072
    v_pk_mul_f32 v[224:225], v[224:225], v[20:21] op_sel:[0,0] op_sel_hi:[1,0]
    v_pk_mul_f32 v[226:227], v[226:227], v[20:21] op_sel:[0,0] op_sel_hi:[1,0]
    v_pk_mul_f32 v[228:229], v[228:229], v[20:21] op_sel:[0,0] op_sel_hi:[1,0]
    v_pk_mul_f32 v[230:231], v[230:231], v[20:21] op_sel:[0,0] op_sel_hi:[1,0]
    v_cvt_pk_bf16_f32 v144, v224, v225
    v_cvt_pk_bf16_f32 v145, v226, v227
    v_cvt_pk_bf16_f32 v146, v228, v229
    v_cvt_pk_bf16_f32 v147, v230, v231
    ds_write_b128 v19, v[144:147] offset:4096
    v_pk_mul_f32 v[232:233], v[232:233], v[20:21] op_sel:[0,0] op_sel_hi:[1,0]
    v_pk_mul_f32 v[234:235], v[234:235], v[20:21] op_sel:[0,0] op_sel_hi:[1,0]
    v_pk_mul_f32 v[236:237], v[236:237], v[20:21] op_sel:[0,0] op_sel_hi:[1,0]
    v_pk_mul_f32 v[238:239], v[238:239], v[20:21] op_sel:[0,0] op_sel_hi:[1,0]
    v_cvt_pk_bf16_f32 v148, v232, v233
    v_cvt_pk_bf16_f32 v149, v234, v235
    v_cvt_pk_bf16_f32 v150, v236, v237
    v_cvt_pk_bf16_f32 v151, v238, v239
    ds_write_b128 v19, v[148:151] offset:5120
    v_pk_mul_f32 v[240:241], v[240:241], v[20:21] op_sel:[0,0] op_sel_hi:[1,0]
    v_pk_mul_f32 v[242:243], v[242:243], v[20:21] op_sel:[0,0] op_sel_hi:[1,0]
    v_pk_mul_f32 v[244:245], v[244:245], v[20:21] op_sel:[0,0] op_sel_hi:[1,0]
    v_pk_mul_f32 v[246:247], v[246:247], v[20:21] op_sel:[0,0] op_sel_hi:[1,0]
    v_cvt_pk_bf16_f32 v152, v240, v241
    v_cvt_pk_bf16_f32 v153, v242, v243
    v_cvt_pk_bf16_f32 v154, v244, v245
    v_cvt_pk_bf16_f32 v155, v246, v247
    ds_write_b128 v19, v[152:155] offset:6144
    v_pk_mul_f32 v[248:249], v[248:249], v[20:21] op_sel:[0,0] op_sel_hi:[1,0]
    v_pk_mul_f32 v[250:251], v[250:251], v[20:21] op_sel:[0,0] op_sel_hi:[1,0]
    v_pk_mul_f32 v[252:253], v[252:253], v[20:21] op_sel:[0,0] op_sel_hi:[1,0]
    v_pk_mul_f32 v[254:255], v[254:255], v[20:21] op_sel:[0,0] op_sel_hi:[1,0]
    v_cvt_pk_bf16_f32 v156, v248, v249
    v_cvt_pk_bf16_f32 v157, v250, v251
    v_cvt_pk_bf16_f32 v158, v252, v253
    v_cvt_pk_bf16_f32 v159, v254, v255
    ds_write_b128 v19, v[156:159] offset:7168
    v_mov_b32 v2, v7
    v_and_b32 v21, 15, v1
    v_lshrrev_b32 v22, 4, v1
    v_lshlrev_b32 v22, 2, v22
    v_sub_u32 v18, v21, v22
    s_mov_b32 s40, 0
    s_mov_b32 s41, 0
    s_lshl_b32 s51, s30, 1
    s_add_u32 s51, s51, 1
    s_and_b32 s36, s28, 3
    s_lshl_b32 s36, s36, 5
    s_sub_u32 s37, 15, s30
    s_lshl_b32 s37, s37, 7
    s_add_u32 s36, s36, s37
    s_sub_u32 s50, 0, s36
    s_add_u32 s36, s51, 1
    s_lshl_b32 s36, -1, s36
    s_or_b32 s48, s36, 0xaaaaaaaa
    s_and_b32 s48, s48, 0x7ffe
    s_or_b32 s39, s36, 0x55555555
    s_and_b32 s39, s39, 0xffff
    s_add_u32 s46, s45, 131072
    s_add_u32 s47, s45, 98304
    s_mov_b64 s[52:53], 0
    s_mov_b32 s31, 0x3f803f80
    s_waitcnt lgkmcnt(0)
    s_barrier
    s_add_u32 s16, s54, 41943040
    s_addc_u32 s17, s55, 0
    s_and_b32 s17, s17, 0xffff
    s_mov_b32 s18, 16777216
    s_mov_b32 s19, 0x20000
    s_mov_b32 s4, s92
    s_and_b32 s5, s93, 0xffff
    s_mov_b32 s6, 7340032
    s_mov_b32 s7, 0x20000
    s_mov_b32 s8, s94
    s_and_b32 s9, s95, 0xffff
    s_mov_b32 s10, 7340032
    s_mov_b32 s11, 0x20000
    s_and_b32 s60, s29, 3
    s_add_u32 s60, s60, 4
    s_sub_u32 s3, s2, 32
    s_cmp_eq_u32 s28, 0
    s_cselect_b32 s36, 0xad, 0x2d
    s_cselect_b32 s42, 14, 12
    s_cmp_lt_u32 s3, 224
    s_cselect_b32 s36, s36, 0
    s_lshl_b32 s36, s36, s60
    s_or_b32 s42, s42, s36
    ds_read_b128 v[64:67], v2 offset:0
    ds_read_b128 v[68:71], v2 offset:1024
    ds_read_b128 v[72:75], v2 offset:2048
    ds_read_b128 v[76:79], v2 offset:3072
    ds_read_b128 v[80:83], v2 offset:4096
    ds_read_b128 v[84:87], v2 offset:5120
    ds_read_b128 v[88:91], v2 offset:6144
    ds_read_b128 v[92:95], v2 offset:7168
    s_waitcnt lgkmcnt(7)
    v_mfma_f32_16x16x32_bf16 v[96:99], v[64:67], v[128:131], 0
    v_mov_b64 v[192:193], 0
    v_mov_b64 v[194:195], 0
    v_mfma_f32_16x16x32_bf16 v[104:107], v[64:67], v[144:147], 0
    ds_read_b128 v[64:67], v2 offset:8192
    v_mov_b64 v[196:197], 0
    s_waitcnt lgkmcnt(7)
    v_mfma_f32_16x16x32_bf16 v[96:99], v[68:71], v[132:135], v[96:99]
    v_mov_b64 v[198:199], 0
    v_mfma_f32_16x16x32_bf16 v[104:107], v[68:71], v[148:151], v[104:107]
    ds_read_b128 v[68:71], v2 offset:9216
    v_mov_b64 v[200:201], 0
    s_waitcnt lgkmcnt(7)
    v_mfma_f32_16x16x32_bf16 v[96:99], v[72:75], v[136:139], v[96:99]
    v_mov_b64 v[202:203], 0
    v_mfma_f32_16x16x32_bf16 v[104:107], v[72:75], v[152:155], v[104:107]
    ds_read_b128 v[72:75], v2 offset:10240
    v_mov_b64 v[204:205], 0
    s_waitcnt lgkmcnt(7)
    v_mfma_f32_16x16x32_bf16 v[96:99], v[76:79], v[140:143], v[96:99]
    v_mov_b64 v[206:207], 0
    v_mfma_f32_16x16x32_bf16 v[104:107], v[76:79], v[156:159], v[104:107]
    ds_read_b128 v[76:79], v2 offset:11264
    v_mov_b64 v[208:209], 0
    s_waitcnt lgkmcnt(7)
    v_mfma_f32_16x16x32_bf16 v[100:103], v[80:83], v[128:131], 0
    v_mov_b64 v[210:211], 0
    v_mfma_f32_16x16x32_bf16 v[108:111], v[80:83], v[144:147], 0
    ds_read_b128 v[80:83], v2 offset:12288
    v_mov_b64 v[212:213], 0
    s_waitcnt lgkmcnt(7)
    v_mfma_f32_16x16x32_bf16 v[100:103], v[84:87], v[132:135], v[100:103]
    v_mov_b64 v[214:215], 0
    v_mfma_f32_16x16x32_bf16 v[108:111], v[84:87], v[148:151], v[108:111]
    ds_read_b128 v[84:87], v2 offset:13312
    v_mov_b64 v[216:217], 0
    s_waitcnt lgkmcnt(7)
    v_mfma_f32_16x16x32_bf16 v[100:103], v[88:91], v[136:139], v[100:103]
    v_mov_b64 v[218:219], 0
    v_mfma_f32_16x16x32_bf16 v[108:111], v[88:91], v[152:155], v[108:111]
    ds_read_b128 v[88:91], v2 offset:14336
    v_mov_b64 v[220:221], 0
    s_waitcnt lgkmcnt(7)
    v_mfma_f32_16x16x32_bf16 v[100:103], v[92:95], v[140:143], v[100:103]
    v_mov_b64 v[222:223], 0
    v_mfma_f32_16x16x32_bf16 v[108:111], v[92:95], v[156:159], v[108:111]
    ds_read_b128 v[92:95], v2 offset:15360
    v_mov_b64 v[224:225], 0
    s_waitcnt lgkmcnt(7)
    v_mfma_f32_16x16x32_bf16 v[112:115], v[64:67], v[128:131], 0
    v_mov_b64 v[226:227], 0
    v_mfma_f32_16x16x32_bf16 v[120:123], v[64:67], v[144:147], 0
    v_mov_b64 v[228:229], 0
    s_waitcnt lgkmcnt(6)
    v_mfma_f32_16x16x32_bf16 v[112:115], v[68:71], v[132:135], v[112:115]
    v_mov_b64 v[230:231], 0
    v_mfma_f32_16x16x32_bf16 v[120:123], v[68:71], v[148:151], v[120:123]
    v_mov_b64 v[232:233], 0
    s_waitcnt lgkmcnt(5)
    v_mfma_f32_16x16x32_bf16 v[112:115], v[72:75], v[136:139], v[112:115]
    v_mov_b64 v[234:235], 0
    v_mfma_f32_16x16x32_bf16 v[120:123], v[72:75], v[152:155], v[120:123]
    v_mov_b64 v[236:237], 0
    s_waitcnt lgkmcnt(4)
    v_mfma_f32_16x16x32_bf16 v[112:115], v[76:79], v[140:143], v[112:115]
    v_mov_b64 v[238:239], 0
    v_mfma_f32_16x16x32_bf16 v[120:123], v[76:79], v[156:159], v[120:123]
    v_mov_b64 v[240:241], 0
    s_waitcnt lgkmcnt(3)
    v_mfma_f32_16x16x32_bf16 v[116:119], v[80:83], v[128:131], 0
    v_mov_b64 v[242:243], 0
    v_mfma_f32_16x16x32_bf16 v[124:127], v[80:83], v[144:147], 0
    v_mov_b64 v[244:245], 0
    s_waitcnt lgkmcnt(2)
    v_mfma_f32_16x16x32_bf16 v[116:119], v[84:87], v[132:135], v[116:119]
    v_mov_b64 v[246:247], 0
    v_mfma_f32_16x16x32_bf16 v[124:127], v[84:87], v[148:151], v[124:127]
    v_mov_b64 v[248:249], 0
    s_waitcnt lgkmcnt(1)
    v_mfma_f32_16x16x32_bf16 v[116:119], v[88:91], v[136:139], v[116:119]
    v_mov_b64 v[250:251], 0
    v_mfma_f32_16x16x32_bf16 v[124:127], v[88:91], v[152:155], v[124:127]
    v_mov_b64 v[252:253], 0
    s_waitcnt lgkmcnt(0)
    v_mfma_f32_16x16x32_bf16 v[116:119], v[92:95], v[140:143], v[116:119]
    v_mov_b64 v[254:255], 0
    v_mfma_f32_16x16x32_bf16 v[124:127], v[92:95], v[156:159], v[124:127]
    v_mov_b64 v[38:39], 0
    s_cmp_lt_i32 s50, 0
    s_cbranch_scc0 L_recurrent_scan__compressed_kv_cla__moe_arch_mod__prompt_kernel_rare_67
L_recurrent_scan__compressed_kv_cla__moe_arch_mod__prompt_kernel_back_68:
    s_add_u32 s49, s50, 32
    v_add_u32 v24, 65536, v2
    s_cmp_le_u32 s40, s51
    s_cselect_b32 s36, 64, 128
    s_add_u32 s41, s41, s36
    s_add_u32 s50, s50, s36
    s_and_b32 s36, s41, 0xff
    v_lshl_add_u32 v2, s36, 8, v7
    s_cmp_eq_u32 s40, 16
    s_cselect_b64 s[20:21], -1, 0
    v_cndmask_b32 v5, v2, v24, s[20:21]
    v_mov_b32 v3, v24
    s_waitcnt vmcnt(0)
    s_barrier
    s_cmp_eq_u32 s28, 0
    s_cbranch_scc1 L_recurrent_scan__compressed_kv_cla__moe_arch_mod__prompt_kernel_rare_69
L_recurrent_scan__compressed_kv_cla__moe_arch_mod__prompt_kernel_back_70:
    ds_read_b128 v[64:67], v5 offset:0
    ds_read_b128 v[68:71], v5 offset:1024
    ds_read_b128 v[72:75], v5 offset:2048
    ds_read_b128 v[76:79], v5 offset:3072
    ds_read_b128 v[80:83], v5 offset:4096
    ds_read_b128 v[84:87], v5 offset:5120
    ds_read_b128 v[88:91], v5 offset:6144
    v_max3_f32 v21, v96, v97, v98
    v_max3_f32 v21, v21, v99, v100
    v_max3_f32 v21, v21, v101, v102
    v_max_f32 v21, v21, v103
    v_max3_f32 v22, v104, v105, v106
    v_max3_f32 v22, v22, v107, v108
    v_max3_f32 v22, v22, v109, v110
    v_max_f32 v22, v22, v111
    v_mov_b32 v23, v21
    s_nop 1
    v_permlane16_swap_b32 v21, v23
    s_nop 1
    v_max_f32 v21, v21, v23
    v_mov_b32 v23, v21
    s_nop 1
    v_permlane32_swap_b32 v21, v23
    s_nop 1
    v_max_f32 v21, v21, v23
    v_mov_b32 v23, v22
    s_nop 1
    v_permlane16_swap_b32 v22, v23
    s_nop 1
    v_max_f32 v22, v22, v23
    v_mov_b32 v23, v22
    s_nop 1
    v_permlane32_swap_b32 v22, v23
    s_nop 1
    v_max_f32 v22, v22, v23
    v_sub_f32 v40, 0, v21
    v_sub_f32 v41, 0, v21
    v_sub_f32 v42, 0, v21
    v_sub_f32 v43, 0, v21
    v_sub_f32 v44, 0, v22
    v_sub_f32 v45, 0, v22
    v_sub_f32 v46, 0, v22
    v_sub_f32 v47, 0, v22
    ds_write_b32 v19, v40
    ds_write_b32 v19, v44 offset:4
    v_pk_add_f32 v[96:97], v[96:97], v[40:41]
    v_pk_add_f32 v[98:99], v[98:99], v[40:41]
    v_pk_add_f32 v[100:101], v[100:101], v[40:41]
    v_pk_add_f32 v[102:103], v[102:103], v[40:41]
    v_pk_add_f32 v[104:105], v[104:105], v[44:45]
    v_pk_add_f32 v[106:107], v[106:107], v[44:45]
    v_pk_add_f32 v[108:109], v[108:109], v[44:45]
    v_pk_add_f32 v[110:111], v[110:111], v[44:45]
    v_pk_add_f32 v[112:113], v[112:113], v[40:41]
    v_pk_add_f32 v[114:115], v[114:115], v[40:41]
    v_pk_add_f32 v[116:117], v[116:117], v[40:41]
    v_pk_add_f32 v[118:119], v[118:119], v[40:41]
    v_pk_add_f32 v[120:121], v[120:121], v[44:45]
    v_pk_add_f32 v[122:123], v[122:123], v[44:45]
    v_pk_add_f32 v[124:125], v[124:125], v[44:45]
    v_pk_add_f32 v[126:127], v[126:127], v[44:45]
    v_exp_f32 v96, v96
    v_exp_f32 v97, v97
    v_add_f32 v38, v38, v96
    v_exp_f32 v98, v98
    v_add_f32 v38, v38, v97
    v_cvt_pk_bf16_f32 v48, v96, v97
    v_exp_f32 v99, v99
    v_add_f32 v38, v38, v98
    v_exp_f32 v104, v104
    v_add_f32 v38, v38, v99
    v_cvt_pk_bf16_f32 v49, v98, v99
    v_exp_f32 v105, v105
    v_add_f32 v39, v39, v104
    v_exp_f32 v106, v106
    v_add_f32 v39, v39, v105
    v_cvt_pk_bf16_f32 v52, v104, v105
    v_exp_f32 v107, v107
    v_add_f32 v39, v39, v106
    v_exp_f32 v100, v100
    v_add_f32 v39, v39, v107
    v_cvt_pk_bf16_f32 v53, v106, v107
    v_exp_f32 v101, v101
    v_add_f32 v38, v38, v100
    v_exp_f32 v102, v102
    v_add_f32 v38, v38, v101
    v_cvt_pk_bf16_f32 v50, v100, v101
    v_exp_f32 v103, v103
    v_add_f32 v38, v38, v102
    v_exp_f32 v108, v108
    v_add_f32 v38, v38, v103
    v_cvt_pk_bf16_f32 v51, v102, v103
    v_exp_f32 v109, v109
    v_add_f32 v39, v39, v108
    v_exp_f32 v110, v110
    v_add_f32 v39, v39, v109
    v_cvt_pk_bf16_f32 v54, v108, v109
    v_exp_f32 v111, v111
    v_add_f32 v39, v39, v110
    s_nop 0
    v_add_f32 v39, v39, v111
    v_cvt_pk_bf16_f32 v55, v110, v111
    .p2align 6
L_body0:
    s_cmp_lt_i32 s49, 0
    s_cbranch_scc0 L_recurrent_scan__compressed_kv_cla__moe_arch_mod__prompt_kernel_rare_71
L_recurrent_scan__compressed_kv_cla__moe_arch_mod__prompt_kernel_back_72:
    s_waitcnt lgkmcnt(3)
    v_mfma_f32_16x16x32_bf16 v[96:99], v[64:67], v[128:131], v[40:43]
    v_exp_f32 v112, v112
    v_mfma_f32_16x16x32_bf16 v[104:107], v[64:67], v[144:147], v[44:47]
    ds_read_b128 v[92:95], v2 offset:7168
    s_bitcmp1_b32 s48, s40
    s_cbranch_scc0 L_recurrent_scan__compressed_kv_cla__moe_arch_mod__prompt_kernel_nodma_91
    s_add_u32 m0, s43, 0
    s_nop 0
    buffer_load_dwordx4 v4, s[12:15], s46 offen offset:0 sc1 lds
    buffer_load_dwordx4 v4, s[12:15], s46 offen offset:1024 sc1 lds
L_recurrent_scan__compressed_kv_cla__moe_arch_mod__prompt_kernel_nodma_91:
    v_mfma_f32_16x16x32_bf16 v[96:99], v[68:71], v[132:135], v[96:99]
    v_exp_f32 v113, v113
    v_mfma_f32_16x16x32_bf16 v[104:107], v[68:71], v[148:151], v[104:107]
    ds_read_b128 v[64:67], v3 offset:0
    v_add_f32 v38, v38, v112
    v_mfma_f32_16x16x32_bf16 v[96:99], v[72:75], v[136:139], v[96:99]
    v_exp_f32 v114, v114
    v_mfma_f32_16x16x32_bf16 v[104:107], v[72:75], v[152:155], v[104:107]
    ds_read_b128 v[68:71], v3 offset:1024
    v_add_f32 v38, v38, v113
    v_cvt_pk_bf16_f32 v56, v112, v113
    s_bitcmp1_b32 s48, s40
    s_cbranch_scc0 L_recurrent_scan__compressed_kv_cla__moe_arch_mod__prompt_kernel_nodma_92
    s_add_u32 m0, s43, 0
    s_nop 0
    buffer_load_dwordx4 v4, s[12:15], s46 offen offset:2048 sc1 lds
    buffer_load_dwordx4 v4, s[12:15], s46 offen offset:3072 sc1 lds
L_recurrent_scan__compressed_kv_cla__moe_arch_mod__prompt_kernel_nodma_92:
    v_mfma_f32_16x16x32_bf16 v[96:99], v[76:79], v[140:143], v[96:99]
    v_exp_f32 v115, v115
    v_mfma_f32_16x16x32_bf16 v[104:107], v[76:79], v[156:159], v[104:107]
    ds_read_b128 v[72:75], v3 offset:2048
    v_add_f32 v38, v38, v114
    s_waitcnt lgkmcnt(3)
    v_mfma_f32_16x16x32_bf16 v[100:103], v[80:83], v[128:131], v[40:43]
    v_exp_f32 v120, v120
    v_mfma_f32_16x16x32_bf16 v[108:111], v[80:83], v[144:147], v[44:47]
    ds_read_b128 v[76:79], v3 offset:3072
    v_add_f32 v38, v38, v115
    v_cvt_pk_bf16_f32 v57, v114, v115
    s_bitcmp1_b32 s48, s40
    s_cbranch_scc0 L_recurrent_scan__compressed_kv_cla__moe_arch_mod__prompt_kernel_nodma_93
    s_add_u32 m0, s43, 4096
    s_nop 0
    buffer_load_dwordx4 v6, s[12:15], s46 offen offset:0 sc1 lds
    buffer_load_dwordx4 v6, s[12:15], s46 offen offset:1024 sc1 lds
L_recurrent_scan__compressed_kv_cla__moe_arch_mod__prompt_kernel_nodma_93:
    v_mfma_f32_16x16x32_bf16 v[100:103], v[84:87], v[132:135], v[100:103]
    v_exp_f32 v121, v121
    v_mfma_f32_16x16x32_bf16 v[108:111], v[84:87], v[148:151], v[108:111]
    ds_read_b128 v[80:83], v3 offset:4096
    v_add_f32 v39, v39, v120
    v_mfma_f32_16x16x32_bf16 v[100:103], v[88:91], v[136:139], v[100:103]
    v_exp_f32 v122, v122
    v_mfma_f32_16x16x32_bf16 v[108:111], v[88:91], v[152:155], v[108:111]
    ds_read_b128 v[84:87], v3 offset:5120
    v_add_f32 v39, v39, v121
    v_cvt_pk_bf16_f32 v60, v120, v121
    s_bitcmp1_b32 s48, s40
    s_cbranch_scc0 L_recurrent_scan__compressed_kv_cla__moe_arch_mod__prompt_kernel_nodma_94
    s_add_u32 m0, s43, 4096
    s_nop 0
    buffer_load_dwordx4 v6, s[12:15], s46 offen offset:2048 sc1 lds
    buffer_load_dwordx4 v6, s[12:15], s46 offen offset:3072 sc1 lds
    s_add_u32 s46, s46, 65536
    s_xor_b32 s43, s43, 32768
L_recurrent_scan__compressed_kv_cla__moe_arch_mod__prompt_kernel_nodma_94:
    v_mfma_f32_16x16x32_bf16 v[100:103], v[92:95], v[140:143], v[100:103]
    v_exp_f32 v123, v123
    v_mfma_f32_16x16x32_bf16 v[108:111], v[92:95], v[156:159], v[108:111]
    ds_read_b128 v[88:91], v3 offset:6144
    v_add_f32 v39, v39, v122
    s_waitcnt lgkmcnt(3)
    v_mfma_f32_16x16x32_bf16 v[192:195], v[64:67], v[48:51], v[192:195]
    v_exp_f32 v116, v116
    v_mfma_f32_16x16x32_bf16 v[224:227], v[64:67], v[52:55], v[224:227]
    ds_read_b128 v[92:95], v3 offset:7168
    v_add_f32 v39, v39, v123
    v_cvt_pk_bf16_f32 v61, v122, v123
    s_bitcmp1_b32 s39, s40
    s_cbranch_scc0 L_recurrent_scan__compressed_kv_cla__moe_arch_mod__prompt_kernel_nodma_95
    s_add_u32 m0, s44, 0
    s_nop 0
    buffer_load_dwordx4 v4, s[12:15], s47 offen offset:0 sc1 lds
    buffer_load_dwordx4 v4, s[12:15], s47 offen offset:1024 sc1 lds
L_recurrent_scan__compressed_kv_cla__moe_arch_mod__prompt_kernel_nodma_95:
    v_mfma_f32_16x16x32_bf16 v[196:199], v[68:71], v[48:51], v[196:199]
    v_exp_f32 v117, v117
    v_mfma_f32_16x16x32_bf16 v[228:231], v[68:71], v[52:55], v[228:231]
    ds_read_b128 v[64:67], v2 offset:8192
    v_add_f32 v38, v38, v116
    v_mfma_f32_16x16x32_bf16 v[200:203], v[72:75], v[48:51], v[200:203]
    v_exp_f32 v118, v118
    v_mfma_f32_16x16x32_bf16 v[232:235], v[72:75], v[52:55], v[232:235]
    ds_read_b128 v[68:71], v2 offset:9216
    v_add_f32 v38, v38, v117
    v_cvt_pk_bf16_f32 v58, v116, v117
    s_bitcmp1_b32 s39, s40
    s_cbranch_scc0 L_recurrent_scan__compressed_kv_cla__moe_arch_mod__prompt_kernel_nodma_96
    s_add_u32 m0, s44, 0
    s_nop 0
    buffer_load_dwordx4 v4, s[12:15], s47 offen offset:2048 sc1 lds
    buffer_load_dwordx4 v4, s[12:15], s47 offen offset:3072 sc1 lds
L_recurrent_scan__compressed_kv_cla__moe_arch_mod__prompt_kernel_nodma_96:
    v_mfma_f32_16x16x32_bf16 v[204:207], v[76:79], v[48:51], v[204:207]
    v_exp_f32 v119, v119
    v_mfma_f32_16x16x32_bf16 v[236:239], v[76:79], v[52:55], v[236:239]
    ds_read_b128 v[72:75], v2 offset:10240
    v_add_f32 v38, v38, v118
    s_waitcnt lgkmcnt(3)
    v_mfma_f32_16x16x32_bf16 v[208:211], v[80:83], v[48:51], v[208:211]
    v_exp_f32 v124, v124
    v_mfma_f32_16x16x32_bf16 v[240:243], v[80:83], v[52:55], v[240:243]
    ds_read_b128 v[76:79], v2 offset:11264
    v_add_f32 v38, v38, v119
    v_cvt_pk_bf16_f32 v59, v118, v119
    s_bitcmp1_b32 s39, s40
    s_cbranch_scc0 L_recurrent_scan__compressed_kv_cla__moe_arch_mod__prompt_kernel_nodma_97
    s_add_u32 m0, s44, 4096
    s_nop 0
    buffer_load_dwordx4 v6, s[12:15], s47 offen offset:0 sc1 lds
    buffer_load_dwordx4 v6, s[12:15], s47 offen offset:1024 sc1 lds
L_recurrent_scan__compressed_kv_cla__moe_arch_mod__prompt_kernel_nodma_97:
    v_mfma_f32_16x16x32_bf16 v[212:215], v[84:87], v[48:51], v[212:215]
    v_exp_f32 v125, v125
    v_mfma_f32_16x16x32_bf16 v[244:247], v[84:87], v[52:55], v[244:247]
    ds_read_b128 v[80:83], v2 offset:12288
    v_add_f32 v39, v39, v124
    v_mfma_f32_16x16x32_bf16 v[216:219], v[88:91], v[48:51], v[216:219]
    v_exp_f32 v126, v126
    v_mfma_f32_16x16x32_bf16 v[248:251], v[88:91], v[52:55], v[248:251]
    ds_read_b128 v[84:87], v2 offset:13312
    v_add_f32 v39, v39, v125
    v_cvt_pk_bf16_f32 v62, v124, v125
    s_bitcmp1_b32 s39, s40
    s_cbranch_scc0 L_recurrent_scan__compressed_kv_cla__moe_arch_mod__prompt_kernel_nodma_98
    s_add_u32 m0, s44, 4096
    s_nop 0
    buffer_load_dwordx4 v6, s[12:15], s47 offen offset:2048 sc1 lds
    buffer_load_dwordx4 v6, s[12:15], s47 offen offset:3072 sc1 lds
    s_add_u32 s47, s47, 65536
    s_xor_b32 s44, s44, 32768
L_recurrent_scan__compressed_kv_cla__moe_arch_mod__prompt_kernel_nodma_98:
    v_mfma_f32_16x16x32_bf16 v[220:223], v[92:95], v[48:51], v[220:223]
    v_exp_f32 v127, v127
    v_mfma_f32_16x16x32_bf16 v[252:255], v[92:95], v[52:55], v[252:255]
    ds_read_b128 v[88:91], v2 offset:14336
    v_add_f32 v39, v39, v126
    v_add_f32 v39, v39, v127
    v_cvt_pk_bf16_f32 v63, v126, v127
    s_cmp_lt_i32 s50, 0
    s_cbranch_scc0 L_recurrent_scan__compressed_kv_cla__moe_arch_mod__prompt_kernel_rare_73
L_recurrent_scan__compressed_kv_cla__moe_arch_mod__prompt_kernel_back_74:
    s_waitcnt lgkmcnt(3)
    v_mfma_f32_16x16x32_bf16 v[112:115], v[64:67], v[128:131], v[40:43]
    v_exp_f32 v96, v96
    v_mfma_f32_16x16x32_bf16 v[120:123], v[64:67], v[144:147], v[44:47]
    ds_read_b128 v[92:95], v2 offset:15360
    v_mfma_f32_16x16x32_bf16 v[112:115], v[68:71], v[132:135], v[112:115]
    v_exp_f32 v97, v97
    s_add_u32 s40, s40, 1
    v_mfma_f32_16x16x32_bf16 v[120:123], v[68:71], v[148:151], v[120:123]
    ds_read_b128 v[64:67], v3 offset:8192
    v_add_f32 v38, v38, v96
    s_add_u32 s49, s50, 32
    v_add_u32 v24, 65536, v2
    v_mfma_f32_16x16x32_bf16 v[112:115], v[72:75], v[136:139], v[112:115]
    v_exp_f32 v98, v98
    v_mfma_f32_16x16x32_bf16 v[120:123], v[72:75], v[152:155], v[120:123]
    ds_read_b128 v[68:71], v3 offset:9216
    v_add_f32 v38, v38, v97
    v_cvt_pk_bf16_f32 v48, v96, v97
    s_cmp_le_u32 s40, s51
    s_cselect_b32 s36, 64, 128
    v_mfma_f32_16x16x32_bf16 v[112:115], v[76:79], v[140:143], v[112:115]
    v_exp_f32 v99, v99
    v_mfma_f32_16x16x32_bf16 v[120:123], v[76:79], v[156:159], v[120:123]
    ds_read_b128 v[72:75], v3 offset:10240
    v_add_f32 v38, v38, v98
    s_add_u32 s41, s41, s36
    s_add_u32 s50, s50, s36
    s_waitcnt lgkmcnt(3)
    v_mfma_f32_16x16x32_bf16 v[116:119], v[80:83], v[128:131], v[40:43]
    v_exp_f32 v104, v104
    v_mfma_f32_16x16x32_bf16 v[124:127], v[80:83], v[144:147], v[44:47]
    ds_read_b128 v[76:79], v3 offset:11264
    v_add_f32 v38, v38, v99
    v_cvt_pk_bf16_f32 v49, v98, v99
    s_and_b32 s36, s41, 0xff
    v_lshl_add_u32 v2, s36, 8, v7
    v_mfma_f32_16x16x32_bf16 v[116:119], v[84:87], v[132:135], v[116:119]
    v_exp_f32 v105, v105
    v_mfma_f32_16x16x32_bf16 v[124:127], v[84:87], v[148:151], v[124:127]
    ds_read_b128 v[80:83], v3 offset:12288
    v_add_f32 v39, v39, v104
    s_cmp_eq_u32 s40, 16
    s_cselect_b64 s[20:21], -1, 0
    v_mfma_f32_16x16x32_bf16 v[116:119], v[88:91], v[136:139], v[116:119]
    v_exp_f32 v106, v106
    v_mfma_f32_16x16x32_bf16 v[124:127], v[88:91], v[152:155], v[124:127]
    ds_read_b128 v[84:87], v3 offset:13312
    v_add_f32 v39, v39, v105
    v_cvt_pk_bf16_f32 v52, v104, v105
    v_cndmask_b32 v5, v2, v24, s[20:21]
    v_mfma_f32_16x16x32_bf16 v[116:119], v[92:95], v[140:143], v[116:119]
    v_exp_f32 v107, v107
    v_mfma_f32_16x16x32_bf16 v[124:127], v[92:95], v[156:159], v[124:127]
    ds_read_b128 v[88:91], v3 offset:14336
    v_add_f32 v39, v39, v106
    s_waitcnt lgkmcnt(3)
    v_mfma_f32_16x16x32_bf16 v[192:195], v[64:67], v[56:59], v[192:195]
    v_exp_f32 v100, v100
    v_mfma_f32_16x16x32_bf16 v[224:227], v[64:67], v[60:63], v[224:227]
    ds_read_b128 v[92:95], v3 offset:15360
    v_add_f32 v39, v39, v107
    v_cvt_pk_bf16_f32 v53, v106, v107
    v_mfma_f32_16x16x32_bf16 v[196:199], v[68:71], v[56:59], v[196:199]
    v_exp_f32 v101, v101
    v_mfma_f32_16x16x32_bf16 v[228:231], v[68:71], v[60:63], v[228:231]
    v_add_f32 v38, v38, v100
    v_mov_b32 v3, v24
    v_mfma_f32_16x16x32_bf16 v[200:203], v[72:75], v[56:59], v[200:203]
    v_exp_f32 v102, v102
    v_mfma_f32_16x16x32_bf16 v[232:235], v[72:75], v[60:63], v[232:235]
    v_add_f32 v38, v38, v101
    v_cvt_pk_bf16_f32 v50, v100, v101
    s_waitcnt vmcnt(8) lgkmcnt(0)
    s_cmp_le_u32 s40, s51
    s_cbranch_scc1 L_recurrent_scan__compressed_kv_cla__moe_arch_mod__prompt_kernel_rlx_75
    s_waitcnt vmcnt(0)
L_recurrent_scan__compressed_kv_cla__moe_arch_mod__prompt_kernel_rlx_75:
    s_bitcmp1_b32 s42, s40
    s_cbranch_scc1 L_recurrent_scan__compressed_kv_cla__moe_arch_mod__prompt_kernel_rare_89
L_recurrent_scan__compressed_kv_cla__moe_arch_mod__prompt_kernel_back_90:
    s_barrier
    v_mfma_f32_16x16x32_bf16 v[204:207], v[76:79], v[56:59], v[204:207]
    v_exp_f32 v103, v103
    v_mfma_f32_16x16x32_bf16 v[236:239], v[76:79], v[60:63], v[236:239]
    ds_read_b128 v[68:71], v5 offset:1024
    ds_read_b128 v[64:67], v5 offset:0
    v_add_f32 v38, v38, v102
    v_mfma_f32_16x16x32_bf16 v[208:211], v[80:83], v[56:59], v[208:211]
    v_exp_f32 v108, v108
    v_mfma_f32_16x16x32_bf16 v[240:243], v[80:83], v[60:63], v[240:243]
    ds_read_b128 v[76:79], v5 offset:3072
    ds_read_b128 v[72:75], v5 offset:2048
    v_add_f32 v38, v38, v103
    v_cvt_pk_bf16_f32 v51, v102, v103
    v_mfma_f32_16x16x32_bf16 v[212:215], v[84:87], v[56:59], v[212:215]
    v_exp_f32 v109, v109
    v_mfma_f32_16x16x32_bf16 v[244:247], v[84:87], v[60:63], v[244:247]
    ds_read_b128 v[80:83], v5 offset:4096
    v_add_f32 v39, v39, v108
    v_mfma_f32_16x16x32_bf16 v[216:219], v[88:91], v[56:59], v[216:219]
    v_exp_f32 v110, v110
    v_mfma_f32_16x16x32_bf16 v[248:251], v[88:91], v[60:63], v[248:251]
    ds_read_b128 v[84:87], v5 offset:5120
    v_add_f32 v39, v39, v109
    v_cvt_pk_bf16_f32 v54, v108, v109
    v_mfma_f32_16x16x32_bf16 v[220:223], v[92:95], v[56:59], v[220:223]
    v_exp_f32 v111, v111
    v_mfma_f32_16x16x32_bf16 v[252:255], v[92:95], v[60:63], v[252:255]
    ds_read_b128 v[88:91], v5 offset:6144
    v_add_f32 v39, v39, v110
    v_add_f32 v39, v39, v111
    v_cvt_pk_bf16_f32 v55, v110, v111
    s_cmp_lg_u32 s40, 16
    s_cbranch_scc1 L_body0
    s_mov_b32 s4, s34
    s_and_b32 s5, s35, 0xffff
    s_mov_b32 s6, 7340032
    s_mov_b32 s7, 0x20000
    s_mov_b32 s8, s32
    s_and_b32 s9, s33, 0xffff
    s_mov_b32 s10, 8388608
    s_mov_b32 s11, 0x20000
    s_lshr_b32 s38, s2, 4
    s_mul_i32 s38, s38, 224
    s_and_b32 s39, s2, 15
    s_lshl_b32 s39, s39, 7
    v_lshrrev_b32 v27, 3, v1
    s_lshl_b32 s36, s28, 5
    s_add_u32 s36, s36, s38
    v_add_u32 v27, s36, v27
    v_mul_u32_u24 v27, 2048, v27
    v_add_u32 v27, s39, v27
    v_bfe_u32 v28, v1, 4, 1
    v_lshlrev_b32 v28, 1, v28
    v_and_b32 v29, 7, v1
    v_xor_b32 v28, v28, v29
    v_lshl_add_u32 v26, v28, 4, v27
    v_xor_b32 v28, 4, v28
    v_lshl_add_u32 v27, v28, 4, v27
    v_add_u32 v27, 15360, v27
    v_add_u32 v28, 30720, v26
    v_add_u32 v29, 30720, v27
    s_lshl_b32 s36, s28, 12
    s_add_u32 s36, s36, 131072
    s_cmp_lt_u32 s28, 7
    s_cselect_b32 m0, s36, 0x30000
    s_cselect_b32 s6, 7340032, 0
    buffer_load_dwordx4 v26, s[4:7], 0 offen offset:0 lds
    buffer_load_dwordx4 v27, s[4:7], 0 offen offset:1024 lds
    buffer_load_dwordx4 v28, s[4:7], 0 offen offset:2048 lds
    buffer_load_dwordx4 v29, s[4:7], 0 offen offset:3072 lds
    s_lshr_b32 s36, s2, 5
    s_add_u32 s36, s36, 48
    s_lshl_b32 s36, s36, 7
    v_mov_b32 v12, s36
    global_load_dword v11, v12, s[90:91] sc1
    s_cmp_lt_i32 s49, 0
    s_cbranch_scc0 L_recurrent_scan__compressed_kv_cla__moe_arch_mod__prompt_kernel_rare_99
L_recurrent_scan__compressed_kv_cla__moe_arch_mod__prompt_kernel_back_100:
    s_waitcnt lgkmcnt(5)
    v_mfma_f32_16x16x32_bf16 v[192:195], v[64:67], v[48:51], v[192:195]
    v_exp_f32 v112, v112
    v_mfma_f32_16x16x32_bf16 v[224:227], v[64:67], v[52:55], v[224:227]
    ds_read_b128 v[92:95], v3 offset:7168
    v_add_f32 v38, v38, v112
    v_exp_f32 v113, v113
    v_mfma_f32_16x16x32_bf16 v[196:199], v[68:71], v[48:51], v[196:199]
    v_add_f32 v38, v38, v113
    v_cvt_pk_bf16_f32 v56, v112, v113
    v_exp_f32 v114, v114
    v_mfma_f32_16x16x32_bf16 v[228:231], v[68:71], v[52:55], v[228:231]
    ds_read_b128 v[64:67], v3 offset:8192
    v_add_f32 v38, v38, v114
    v_exp_f32 v115, v115
    s_waitcnt lgkmcnt(5)
    v_mfma_f32_16x16x32_bf16 v[200:203], v[72:75], v[48:51], v[200:203]
    v_add_f32 v38, v38, v115
    v_cvt_pk_bf16_f32 v57, v114, v115
    v_exp_f32 v120, v120
    v_mfma_f32_16x16x32_bf16 v[232:235], v[72:75], v[52:55], v[232:235]
    ds_read_b128 v[68:71], v3 offset:9216
    v_add_f32 v39, v39, v120
    v_exp_f32 v121, v121
    v_mfma_f32_16x16x32_bf16 v[204:207], v[76:79], v[48:51], v[204:207]
    v_add_f32 v39, v39, v121
    v_cvt_pk_bf16_f32 v60, v120, v121
    v_exp_f32 v122, v122
    v_mfma_f32_16x16x32_bf16 v[236:239], v[76:79], v[52:55], v[236:239]
    ds_read_b128 v[72:75], v3 offset:10240
    v_add_f32 v39, v39, v122
    v_exp_f32 v123, v123
    s_waitcnt lgkmcnt(6)
    v_mfma_f32_16x16x32_bf16 v[208:211], v[80:83], v[48:51], v[208:211]
    v_add_f32 v39, v39, v123
    v_cvt_pk_bf16_f32 v61, v122, v123
    v_exp_f32 v116, v116
    v_mfma_f32_16x16x32_bf16 v[240:243], v[80:83], v[52:55], v[240:243]
    ds_read_b128 v[76:79], v3 offset:11264
    v_add_f32 v38, v38, v116
    v_exp_f32 v117, v117
    s_waitcnt lgkmcnt(6)
    v_mfma_f32_16x16x32_bf16 v[212:215], v[84:87], v[48:51], v[212:215]
    v_add_f32 v38, v38, v117
    v_cvt_pk_bf16_f32 v58, v116, v117
    v_exp_f32 v118, v118
    v_mfma_f32_16x16x32_bf16 v[244:247], v[84:87], v[52:55], v[244:247]
    ds_read_b128 v[80:83], v3 offset:12288
    v_add_f32 v38, v38, v118
    v_exp_f32 v119, v119
    s_waitcnt lgkmcnt(6)
    v_mfma_f32_16x16x32_bf16 v[216:219], v[88:91], v[48:51], v[216:219]
    v_add_f32 v38, v38, v119
    v_cvt_pk_bf16_f32 v59, v118, v119
    v_exp_f32 v124, v124
    v_mfma_f32_16x16x32_bf16 v[248:251], v[88:91], v[52:55], v[248:251]
    ds_read_b128 v[84:87], v3 offset:13312
    v_add_f32 v39, v39, v124
    v_exp_f32 v125, v125
    s_waitcnt lgkmcnt(6)
    v_mfma_f32_16x16x32_bf16 v[220:223], v[92:95], v[48:51], v[220:223]
    v_add_f32 v39, v39, v125
    v_cvt_pk_bf16_f32 v62, v124, v125
    v_exp_f32 v126, v126
    v_mfma_f32_16x16x32_bf16 v[252:255], v[92:95], v[52:55], v[252:255]
    ds_read_b128 v[88:91], v3 offset:14336
    v_add_f32 v39, v39, v126
    v_exp_f32 v127, v127
    s_nop 0
    v_add_f32 v39, v39, v127
    v_cvt_pk_bf16_f32 v63, v126, v127
    s_nop 1
    s_waitcnt lgkmcnt(6)
    v_mfma_f32_16x16x32_bf16 v[192:195], v[64:67], v[56:59], v[192:195]
    v_mfma_f32_16x16x32_bf16 v[224:227], v[64:67], v[60:63], v[224:227]
    ds_read_b128 v[92:95], v3 offset:15360
    s_waitcnt lgkmcnt(6)
    v_mfma_f32_16x16x32_bf16 v[196:199], v[68:71], v[56:59], v[196:199]
    v_mfma_f32_16x16x32_bf16 v[228:231], v[68:71], v[60:63], v[228:231]
    s_waitcnt lgkmcnt(5)
    v_mfma_f32_16x16x32_bf16 v[200:203], v[72:75], v[56:59], v[200:203]
    v_mfma_f32_16x16x32_bf16 v[232:235], v[72:75], v[60:63], v[232:235]
    s_waitcnt lgkmcnt(4)
    v_mfma_f32_16x16x32_bf16 v[204:207], v[76:79], v[56:59], v[204:207]
    v_mfma_f32_16x16x32_bf16 v[236:239], v[76:79], v[60:63], v[236:239]
    s_waitcnt lgkmcnt(3)
    v_mfma_f32_16x16x32_bf16 v[208:211], v[80:83], v[56:59], v[208:211]
    v_mfma_f32_16x16x32_bf16 v[240:243], v[80:83], v[60:63], v[240:243]
    s_waitcnt lgkmcnt(2)
    v_mfma_f32_16x16x32_bf16 v[212:215], v[84:87], v[56:59], v[212:215]
    v_mfma_f32_16x16x32_bf16 v[244:247], v[84:87], v[60:63], v[244:247]
    s_waitcnt lgkmcnt(1)
    v_mfma_f32_16x16x32_bf16 v[216:219], v[88:91], v[56:59], v[216:219]
    v_mfma_f32_16x16x32_bf16 v[248:251], v[88:91], v[60:63], v[248:251]
    s_waitcnt lgkmcnt(0)
    v_mfma_f32_16x16x32_bf16 v[220:223], v[92:95], v[56:59], v[220:223]
    v_mfma_f32_16x16x32_bf16 v[252:255], v[92:95], v[60:63], v[252:255]
    s_waitcnt vmcnt(0)
    v_readfirstlane_b32 s36, v11
    s_nop 0
    s_cmp_lt_u32 s36, 28
    s_cbranch_scc1 L_recurrent_scan__compressed_kv_cla__moe_arch_mod__prompt_kernel_rare_103
L_recurrent_scan__compressed_kv_cla__moe_arch_mod__prompt_kernel_back_104:
    s_lshr_b32 s36, s2, 4
    s_mul_i32 s36, s36, 7
    s_min_u32 s37, s28, 6
    s_add_u32 s36, s36, s37
    s_lshl_b32 s36, s36, 11
    s_add_u32 s36, s36, 58720256
    v_and_b32 v11, 15, v1
    v_lshlrev_b32 v11, 4, v11
    v_lshrrev_b32 v12, 4, v1
    v_lshl_add_u32 v11, v12, 9, v11
    buffer_load_dwordx4 v[96:99], v11, s[24:27], s36 offen offset:0 sc1
    buffer_load_dwordx4 v[100:103], v11, s[24:27], s36 offen offset:256 sc1
    s_lshl_b32 s37, s28, 13
    v_add_u32 v21, s37, v7
    v_xor_b32 v22, 32768, v21
    s_lshl_b32 s37, s28, 8
    s_add_u32 s37, s37, 159744
    v_lshl_add_u32 v23, v1, 2, s37
    v_xor_b32 v24, 1024, v23
    ds_write_b32 v23, v39
    s_mov_b32 s36, 0x5d800000
    v_cmp_nge_f32 vcc, s36, v38
    s_nop 0
    s_or_b64 s[52:53], s[52:53], vcc
    v_cmp_nge_f32 vcc, s36, v39
    s_nop 0
    s_or_b64 s[52:53], s[52:53], vcc
    s_or_b32 s36, s52, s53
    v_mov_b32 v26, s36
    s_lshl_b32 s37, s28, 2
    s_add_u32 s37, s37, 161792
    v_mov_b32 v27, s37
    ds_write_b32 v27, v26
    ds_write_b128 v21, v[224:227] offset:0
    ds_write_b128 v21, v[228:231] offset:1024
    ds_write_b128 v21, v[232:235] offset:2048
    ds_write_b128 v21, v[236:239] offset:3072
    ds_write_b128 v21, v[240:243] offset:4096
    ds_write_b128 v21, v[244:247] offset:5120
    ds_write_b128 v21, v[248:251] offset:6144
    ds_write_b128 v21, v[252:255] offset:7168
    v_mov_b32 v28, 161856
    v_mov_b32 v30, s56
    v_mov_b32 v31, s57
    v_mov_b32 v32, s58
    v_mov_b32 v33, s59
    ds_write_b128 v28, v[30:33]
    v_and_b32 v27, 7, v1
    v_lshlrev_b32 v27, 2, v27
    v_add_u32 v27, 161792, v27
    s_sub_u32 s36, 15, s30
    s_lshl_b32 s38, s36, 3
    s_and_b32 s37, s28, 3
    s_lshl_b32 s37, s37, 1
    s_add_u32 s38, s38, s37
    s_lshl_b32 s38, s38, 17
    s_lshl_b32 s37, s29, 12
    s_add_u32 s38, s38, s37
    s_waitcnt lgkmcnt(0)
    s_barrier
    ds_read_b32 v26, v27
    ds_read_b32 v25, v24
    ds_read_b128 v[64:67], v22 offset:0
    ds_read_b128 v[68:71], v22 offset:1024
    ds_read_b128 v[72:75], v22 offset:2048
    ds_read_b128 v[76:79], v22 offset:3072
    ds_read_b128 v[80:83], v22 offset:4096
    ds_read_b128 v[84:87], v22 offset:5120
    ds_read_b128 v[88:91], v22 offset:6144
    ds_read_b128 v[92:95], v22 offset:7168
    s_waitcnt lgkmcnt(8)
    v_add_f32 v25, v25, v38
    v_mov_b32 v20, v25
    s_nop 1
    v_permlane16_swap_b32 v25, v20
    s_nop 1
    v_add_f32 v25, v25, v20
    v_mov_b32 v20, v25
    s_nop 1
    v_permlane32_swap_b32 v25, v20
    s_nop 1
    v_add_f32 v25, v25, v20
    v_cmp_ne_u32 s[52:53], 0, v26
    v_rcp_f32 v25, v25
    s_waitcnt lgkmcnt(6)
    v_pk_add_f32 v[192:193], v[192:193], v[64:65]
    v_pk_add_f32 v[194:195], v[194:195], v[66:67]
    v_pk_add_f32 v[196:197], v[196:197], v[68:69]
    v_pk_add_f32 v[198:199], v[198:199], v[70:71]
    v_pk_mul_f32 v[192:193], v[192:193], v[24:25] op_sel:[0,1] op_sel_hi:[1,1]
    v_pk_mul_f32 v[194:195], v[194:195], v[24:25] op_sel:[0,1] op_sel_hi:[1,1]
    v_pk_mul_f32 v[196:197], v[196:197], v[24:25] op_sel:[0,1] op_sel_hi:[1,1]
    v_pk_mul_f32 v[198:199], v[198:199], v[24:25] op_sel:[0,1] op_sel_hi:[1,1]
    v_cvt_pk_bf16_f32 v48, v192, v193
    v_cvt_pk_bf16_f32 v49, v194, v195
    v_cvt_pk_bf16_f32 v50, v196, v197
    v_cvt_pk_bf16_f32 v51, v198, v199
    buffer_store_dwordx4 v[48:51], v7, s[16:19], s38 offen offset:0 sc1
    s_waitcnt lgkmcnt(4)
    v_pk_add_f32 v[200:201], v[200:201], v[72:73]
    v_pk_add_f32 v[202:203], v[202:203], v[74:75]
    v_pk_add_f32 v[204:205], v[204:205], v[76:77]
    v_pk_add_f32 v[206:207], v[206:207], v[78:79]
    v_pk_mul_f32 v[200:201], v[200:201], v[24:25] op_sel:[0,1] op_sel_hi:[1,1]
    v_pk_mul_f32 v[202:203], v[202:203], v[24:25] op_sel:[0,1] op_sel_hi:[1,1]
    v_pk_mul_f32 v[204:205], v[204:205], v[24:25] op_sel:[0,1] op_sel_hi:[1,1]
    v_pk_mul_f32 v[206:207], v[206:207], v[24:25] op_sel:[0,1] op_sel_hi:[1,1]
    v_cvt_pk_bf16_f32 v52, v200, v201
    v_cvt_pk_bf16_f32 v53, v202, v203
    v_cvt_pk_bf16_f32 v54, v204, v205
    v_cvt_pk_bf16_f32 v55, v206, v207
    buffer_store_dwordx4 v[52:55], v7, s[16:19], s38 offen offset:1024 sc1
    s_waitcnt lgkmcnt(2)
    v_pk_add_f32 v[208:209], v[208:209], v[80:81]
    v_pk_add_f32 v[210:211], v[210:211], v[82:83]
    v_pk_add_f32 v[212:213], v[212:213], v[84:85]
    v_pk_add_f32 v[214:215], v[214:215], v[86:87]
    v_pk_mul_f32 v[208:209], v[208:209], v[24:25] op_sel:[0,1] op_sel_hi:[1,1]
    v_pk_mul_f32 v[210:211], v[210:211], v[24:25] op_sel:[0,1] op_sel_hi:[1,1]
    v_pk_mul_f32 v[212:213], v[212:213], v[24:25] op_sel:[0,1] op_sel_hi:[1,1]
    v_pk_mul_f32 v[214:215], v[214:215], v[24:25] op_sel:[0,1] op_sel_hi:[1,1]
    v_cvt_pk_bf16_f32 v56, v208, v209
    v_cvt_pk_bf16_f32 v57, v210, v211
    v_cvt_pk_bf16_f32 v58, v212, v213
    v_cvt_pk_bf16_f32 v59, v214, v215
    buffer_store_dwordx4 v[56:59], v7, s[16:19], s38 offen offset:2048 sc1
    s_waitcnt lgkmcnt(0)
    v_pk_add_f32 v[216:217], v[216:217], v[88:89]
    v_pk_add_f32 v[218:219], v[218:219], v[90:91]
    v_pk_add_f32 v[220:221], v[220:221], v[92:93]
    v_pk_add_f32 v[222:223], v[222:223], v[94:95]
    v_pk_mul_f32 v[216:217], v[216:217], v[24:25] op_sel:[0,1] op_sel_hi:[1,1]
    v_pk_mul_f32 v[218:219], v[218:219], v[24:25] op_sel:[0,1] op_sel_hi:[1,1]
    v_pk_mul_f32 v[220:221], v[220:221], v[24:25] op_sel:[0,1] op_sel_hi:[1,1]
    v_pk_mul_f32 v[222:223], v[222:223], v[24:25] op_sel:[0,1] op_sel_hi:[1,1]
    v_cvt_pk_bf16_f32 v60, v216, v217
    v_cvt_pk_bf16_f32 v61, v218, v219
    v_cvt_pk_bf16_f32 v62, v220, v221
    v_cvt_pk_bf16_f32 v63, v222, v223
    buffer_store_dwordx4 v[60:63], v7, s[16:19], s38 offen offset:3072 sc1
    s_cmp_eq_u64 s[52:53], 0
    s_cbranch_scc1 L_p3_done
    s_waitcnt vmcnt(0)
    v_mov_b32 v112, v96
    v_mov_b32 v113, v97
    v_mov_b32 v114, v98
    v_mov_b32 v115, v99
    v_mov_b32 v116, v100
    v_mov_b32 v117, v101
    v_mov_b32 v118, v102
    v_mov_b32 v119, v103
    v_mov_b32 v192, 0
    v_mov_b32 v193, 0
    v_mov_b32 v194, 0
    v_mov_b32 v195, 0
    v_mov_b32 v196, 0
    v_mov_b32 v197, 0
    v_mov_b32 v198, 0
    v_mov_b32 v199, 0
    v_mov_b32 v200, 0
    v_mov_b32 v201, 0
    v_mov_b32 v202, 0
    v_mov_b32 v203, 0
    v_mov_b32 v204, 0
    v_mov_b32 v205, 0
    v_mov_b32 v206, 0
    v_mov_b32 v207, 0
    v_mov_b32 v208, 0
    v_mov_b32 v209, 0
    v_mov_b32 v210, 0
    v_mov_b32 v211, 0
    v_mov_b32 v212, 0
    v_mov_b32 v213, 0
    v_mov_b32 v214, 0
    v_mov_b32 v215, 0
    v_mov_b32 v216, 0
    v_mov_b32 v217, 0
    v_mov_b32 v218, 0
    v_mov_b32 v219, 0
    v_mov_b32 v220, 0
    v_mov_b32 v221, 0
    v_mov_b32 v222, 0
    v_mov_b32 v223, 0
    v_mov_b32 v224, 0
    v_mov_b32 v225, 0
    v_mov_b32 v226, 0
    v_mov_b32 v227, 0
    v_mov_b32 v228, 0
    v_mov_b32 v229, 0
    v_mov_b32 v230, 0
    v_mov_b32 v231, 0
    v_mov_b32 v232, 0
    v_mov_b32 v233, 0
    v_mov_b32 v234, 0
    v_mov_b32 v235, 0
    v_mov_b32 v236, 0
    v_mov_b32 v237, 0
    v_mov_b32 v238, 0
    v_mov_b32 v239, 0
    v_mov_b32 v240, 0
    v_mov_b32 v241, 0
    v_mov_b32 v242, 0
    v_mov_b32 v243, 0
    v_mov_b32 v244, 0
    v_mov_b32 v245, 0
    v_mov_b32 v246, 0
    v_mov_b32 v247, 0
    v_mov_b32 v248, 0
    v_mov_b32 v249, 0
    v_mov_b32 v250, 0
    v_mov_b32 v251, 0
    v_mov_b32 v252, 0
    v_mov_b32 v253, 0
    v_mov_b32 v254, 0
    v_mov_b32 v255, 0
    v_mov_b32 v38, 0
    v_mov_b32 v40, 4048155338
    v_mov_b32 v39, 0
    v_mov_b32 v41, 4048155338
    s_lshl_b32 s43, s28, 12
    v_add_u32 v4, s43, v7
    s_mov_b32 s46, s45
    s_sub_u32 s40, 16, s30
    s_sub_u32 s39, 15, s30
    s_lshl_b32 s37, s39, 7
    s_and_b32 s36, s28, 3
    s_lshl_b32 s36, s36, 5
    s_add_u32 s36, s36, s37
    s_sub_u32 s50, 0, s36
L_recurrent_scan__compressed_kv_cla__moe_arch_mod__prompt_kernel_stile_105:
    s_waitcnt vmcnt(0) lgkmcnt(0)
    s_barrier
    s_mov_b32 m0, s43
    s_add_u32 s47, s46, 32768
    buffer_load_dwordx4 v4, s[12:15], s46 offen offset:0 sc1 lds
    buffer_load_dwordx4 v4, s[12:15], s46 offen offset:1024 sc1 lds
    buffer_load_dwordx4 v4, s[12:15], s46 offen offset:2048 sc1 lds
    buffer_load_dwordx4 v4, s[12:15], s46 offen offset:3072 sc1 lds
    s_add_u32 m0, s43, 32768
    s_add_u32 s46, s46, 65536
    buffer_load_dwordx4 v4, s[12:15], s47 offen offset:0 sc1 lds
    buffer_load_dwordx4 v4, s[12:15], s47 offen offset:1024 sc1 lds
    buffer_load_dwordx4 v4, s[12:15], s47 offen offset:2048 sc1 lds
    buffer_load_dwordx4 v4, s[12:15], s47 offen offset:3072 sc1 lds
    v_mov_b32 v2, v7
    s_mov_b32 s41, 4
    s_waitcnt vmcnt(0)
    s_barrier
L_recurrent_scan__compressed_kv_cla__moe_arch_mod__prompt_kernel_sunit_106:
    s_cmp_gt_i32 s50, 0
    s_cbranch_scc1 L_recurrent_scan__compressed_kv_cla__moe_arch_mod__prompt_kernel_snext_107
    ds_read_b128 v[64:67], v2 offset:0
    ds_read_b128 v[68:71], v2 offset:1024
    ds_read_b128 v[72:75], v2 offset:2048
    ds_read_b128 v[76:79], v2 offset:3072
    ds_read_b128 v[80:83], v2 offset:4096
    ds_read_b128 v[84:87], v2 offset:5120
    ds_read_b128 v[88:91], v2 offset:6144
    ds_read_b128 v[92:95], v2 offset:7168
    s_waitcnt lgkmcnt(0)
    v_mfma_f32_16x16x32_bf16 v[96:99], v[64:67], v[128:131], 0
    v_mfma_f32_16x16x32_bf16 v[104:107], v[64:67], v[144:147], 0
    v_mfma_f32_16x16x32_bf16 v[96:99], v[68:71], v[132:135], v[96:99]
    v_mfma_f32_16x16x32_bf16 v[104:107], v[68:71], v[148:151], v[104:107]
    v_mfma_f32_16x16x32_bf16 v[96:99], v[72:75], v[136:139], v[96:99]
    v_mfma_f32_16x16x32_bf16 v[104:107], v[72:75], v[152:155], v[104:107]
    v_mfma_f32_16x16x32_bf16 v[96:99], v[76:79], v[140:143], v[96:99]
    v_mfma_f32_16x16x32_bf16 v[104:107], v[76:79], v[156:159], v[104:107]
    v_mfma_f32_16x16x32_bf16 v[100:103], v[80:83], v[128:131], 0
    v_mfma_f32_16x16x32_bf16 v[108:111], v[80:83], v[144:147], 0
    v_mfma_f32_16x16x32_bf16 v[100:103], v[84:87], v[132:135], v[100:103]
    v_mfma_f32_16x16x32_bf16 v[108:111], v[84:87], v[148:151], v[108:111]
    v_mfma_f32_16x16x32_bf16 v[100:103], v[88:91], v[136:139], v[100:103]
    v_mfma_f32_16x16x32_bf16 v[108:111], v[88:91], v[152:155], v[108:111]
    v_mfma_f32_16x16x32_bf16 v[100:103], v[92:95], v[140:143], v[100:103]
    v_mfma_f32_16x16x32_bf16 v[108:111], v[92:95], v[156:159], v[108:111]
    ds_read_b128 v[64:67], v2 offset:32768
    ds_read_b128 v[68:71], v2 offset:33792
    ds_read_b128 v[72:75], v2 offset:34816
    ds_read_b128 v[76:79], v2 offset:35840
    ds_read_b128 v[80:83], v2 offset:36864
    ds_read_b128 v[84:87], v2 offset:37888
    ds_read_b128 v[88:91], v2 offset:38912
    ds_read_b128 v[92:95], v2 offset:39936
    s_nop 1
    s_cmp_lt_i32 s50, 0
    s_cbranch_scc0 L_recurrent_scan__compressed_kv_cla__moe_arch_mod__prompt_kernel_rare_108
L_recurrent_scan__compressed_kv_cla__moe_arch_mod__prompt_kernel_back_109:
    v_max3_f32 v22, v96, v97, v98
    v_max3_f32 v22, v22, v99, v100
    v_max3_f32 v22, v22, v101, v102
    v_max3_f32 v22, v22, v103, v40
    v_mov_b32 v24, v22
    s_nop 1
    v_permlane16_swap_b32 v22, v24
    s_nop 1
    v_max_f32 v22, v22, v24
    v_mov_b32 v24, v22
    s_nop 1
    v_permlane32_swap_b32 v22, v24
    s_nop 1
    v_max_f32 v22, v22, v24
    v_sub_f32 v25, v40, v22
    v_exp_f32 v25, v25
    v_mov_b32 v40, v22
    v_mul_f32 v38, v38, v25
    v_mul_f32 v192, v192, v25
    v_mul_f32 v193, v193, v25
    v_mul_f32 v194, v194, v25
    v_mul_f32 v195, v195, v25
    v_mul_f32 v196, v196, v25
    v_mul_f32 v197, v197, v25
    v_mul_f32 v198, v198, v25
    v_mul_f32 v199, v199, v25
    v_mul_f32 v200, v200, v25
    v_mul_f32 v201, v201, v25
    v_mul_f32 v202, v202, v25
    v_mul_f32 v203, v203, v25
    v_mul_f32 v204, v204, v25
    v_mul_f32 v205, v205, v25
    v_mul_f32 v206, v206, v25
    v_mul_f32 v207, v207, v25
    v_mul_f32 v208, v208, v25
    v_mul_f32 v209, v209, v25
    v_mul_f32 v210, v210, v25
    v_mul_f32 v211, v211, v25
    v_mul_f32 v212, v212, v25
    v_mul_f32 v213, v213, v25
    v_mul_f32 v214, v214, v25
    v_mul_f32 v215, v215, v25
    v_mul_f32 v216, v216, v25
    v_mul_f32 v217, v217, v25
    v_mul_f32 v218, v218, v25
    v_mul_f32 v219, v219, v25
    v_mul_f32 v220, v220, v25
    v_mul_f32 v221, v221, v25
    v_mul_f32 v222, v222, v25
    v_mul_f32 v223, v223, v25
    v_sub_f32 v96, v96, v22
    v_sub_f32 v97, v97, v22
    v_sub_f32 v98, v98, v22
    v_sub_f32 v99, v99, v22
    v_sub_f32 v100, v100, v22
    v_sub_f32 v101, v101, v22
    v_sub_f32 v102, v102, v22
    v_sub_f32 v103, v103, v22
    v_max3_f32 v23, v104, v105, v106
    v_max3_f32 v23, v23, v107, v108
    v_max3_f32 v23, v23, v109, v110
    v_max3_f32 v23, v23, v111, v41
    v_mov_b32 v24, v23
    s_nop 1
    v_permlane16_swap_b32 v23, v24
    s_nop 1
    v_max_f32 v23, v23, v24
    v_mov_b32 v24, v23
    s_nop 1
    v_permlane32_swap_b32 v23, v24
    s_nop 1
    v_max_f32 v23, v23, v24
    v_sub_f32 v25, v41, v23
    v_exp_f32 v25, v25
    v_mov_b32 v41, v23
    v_mul_f32 v39, v39, v25
    v_mul_f32 v224, v224, v25
    v_mul_f32 v225, v225, v25
    v_mul_f32 v226, v226, v25
    v_mul_f32 v227, v227, v25
    v_mul_f32 v228, v228, v25
    v_mul_f32 v229, v229, v25
    v_mul_f32 v230, v230, v25
    v_mul_f32 v231, v231, v25
    v_mul_f32 v232, v232, v25
    v_mul_f32 v233, v233, v25
    v_mul_f32 v234, v234, v25
    v_mul_f32 v235, v235, v25
    v_mul_f32 v236, v236, v25
    v_mul_f32 v237, v237, v25
    v_mul_f32 v238, v238, v25
    v_mul_f32 v239, v239, v25
    v_mul_f32 v240, v240, v25
    v_mul_f32 v241, v241, v25
    v_mul_f32 v242, v242, v25
    v_mul_f32 v243, v243, v25
    v_mul_f32 v244, v244, v25
    v_mul_f32 v245, v245, v25
    v_mul_f32 v246, v246, v25
    v_mul_f32 v247, v247, v25
    v_mul_f32 v248, v248, v25
    v_mul_f32 v249, v249, v25
    v_mul_f32 v250, v250, v25
    v_mul_f32 v251, v251, v25
    v_mul_f32 v252, v252, v25
    v_mul_f32 v253, v253, v25
    v_mul_f32 v254, v254, v25
    v_mul_f32 v255, v255, v25
    v_sub_f32 v104, v104, v23
    v_sub_f32 v105, v105, v23
    v_sub_f32 v106, v106, v23
    v_sub_f32 v107, v107, v23
    v_sub_f32 v108, v108, v23
    v_sub_f32 v109, v109, v23
    v_sub_f32 v110, v110, v23
    v_sub_f32 v111, v111, v23
    v_exp_f32 v96, v96
    v_exp_f32 v97, v97
    v_exp_f32 v98, v98
    v_exp_f32 v99, v99
    v_exp_f32 v104, v104
    v_exp_f32 v105, v105
    v_exp_f32 v106, v106
    v_exp_f32 v107, v107
    v_exp_f32 v100, v100
    v_exp_f32 v101, v101
    v_exp_f32 v102, v102
    v_exp_f32 v103, v103
    v_exp_f32 v108, v108
    v_exp_f32 v109, v109
    v_exp_f32 v110, v110
    v_exp_f32 v111, v111
    v_add_f32 v38, v38, v96
    v_add_f32 v38, v38, v97
    v_cvt_pk_bf16_f32 v48, v96, v97
    v_add_f32 v38, v38, v98
    v_add_f32 v38, v38, v99
    v_cvt_pk_bf16_f32 v49, v98, v99
    v_add_f32 v39, v39, v104
    v_add_f32 v39, v39, v105
    v_cvt_pk_bf16_f32 v52, v104, v105
    v_add_f32 v39, v39, v106
    v_add_f32 v39, v39, v107
    v_cvt_pk_bf16_f32 v53, v106, v107
    v_add_f32 v38, v38, v100
    v_add_f32 v38, v38, v101
    v_cvt_pk_bf16_f32 v50, v100, v101
    v_add_f32 v38, v38, v102
    v_add_f32 v38, v38, v103
    v_cvt_pk_bf16_f32 v51, v102, v103
    v_add_f32 v39, v39, v108
    v_add_f32 v39, v39, v109
    v_cvt_pk_bf16_f32 v54, v108, v109
    v_add_f32 v39, v39, v110
    v_add_f32 v39, v39, v111
    v_cvt_pk_bf16_f32 v55, v110, v111
    s_waitcnt lgkmcnt(0)
    s_nop 0
    v_mfma_f32_16x16x32_bf16 v[192:195], v[64:67], v[48:51], v[192:195]
    v_mfma_f32_16x16x32_bf16 v[224:227], v[64:67], v[52:55], v[224:227]
    v_mfma_f32_16x16x32_bf16 v[196:199], v[68:71], v[48:51], v[196:199]
    v_mfma_f32_16x16x32_bf16 v[228:231], v[68:71], v[52:55], v[228:231]
    v_mfma_f32_16x16x32_bf16 v[200:203], v[72:75], v[48:51], v[200:203]
    v_mfma_f32_16x16x32_bf16 v[232:235], v[72:75], v[52:55], v[232:235]
    v_mfma_f32_16x16x32_bf16 v[204:207], v[76:79], v[48:51], v[204:207]
    v_mfma_f32_16x16x32_bf16 v[236:239], v[76:79], v[52:55], v[236:239]
    v_mfma_f32_16x16x32_bf16 v[208:211], v[80:83], v[48:51], v[208:211]
    v_mfma_f32_16x16x32_bf16 v[240:243], v[80:83], v[52:55], v[240:243]
    v_mfma_f32_16x16x32_bf16 v[212:215], v[84:87], v[48:51], v[212:215]
    v_mfma_f32_16x16x32_bf16 v[244:247], v[84:87], v[52:55], v[244:247]
    v_mfma_f32_16x16x32_bf16 v[216:219], v[88:91], v[48:51], v[216:219]
    v_mfma_f32_16x16x32_bf16 v[248:251], v[88:91], v[52:55], v[248:251]
    v_mfma_f32_16x16x32_bf16 v[220:223], v[92:95], v[48:51], v[220:223]
    v_mfma_f32_16x16x32_bf16 v[252:255], v[92:95], v[52:55], v[252:255]
L_recurrent_scan__compressed_kv_cla__moe_arch_mod__prompt_kernel_snext_107:
    v_add_u32 v2, 8192, v2
    s_add_u32 s50, s50, 32
    s_sub_u32 s41, s41, 1
    s_cmp_lg_u32 s41, 0
    s_cbranch_scc1 L_recurrent_scan__compressed_kv_cla__moe_arch_mod__prompt_kernel_sunit_106
    s_sub_u32 s40, s40, 1
    s_cmp_lg_u32 s40, 0
    s_cbranch_scc1 L_recurrent_scan__compressed_kv_cla__moe_arch_mod__prompt_kernel_stile_105
    v_mov_b32 v20, v38
    s_nop 1
    v_permlane16_swap_b32 v38, v20
    s_nop 1
    v_add_f32 v38, v38, v20
    v_mov_b32 v20, v38
    s_nop 1
    v_permlane32_swap_b32 v38, v20
    s_nop 1
    v_add_f32 v38, v38, v20
    v_mov_b32 v20, v39
    s_nop 1
    v_permlane16_swap_b32 v39, v20
    s_nop 1
    v_add_f32 v39, v39, v20
    v_mov_b32 v20, v39
    s_nop 1
    v_permlane32_swap_b32 v39, v20
    s_nop 1
    v_add_f32 v39, v39, v20
    s_mov_b32 s36, 0x5d800000
    v_cmp_nge_f32 vcc, s36, v38
    s_nop 0
    s_or_b64 s[52:53], s[52:53], vcc
    v_cmp_nge_f32 vcc, s36, v39
    s_nop 0
    s_or_b64 s[52:53], s[52:53], vcc
    v_rcp_f32 v38, v38
    v_rcp_f32 v39, v39
    s_lshl_b32 s38, s39, 3
    s_and_b32 s37, s28, 3
    s_lshl_b32 s37, s37, 1
    s_add_u32 s38, s38, s37
    s_lshl_b32 s38, s38, 17
    s_lshl_b32 s37, s29, 12
    s_add_u32 s38, s38, s37
    v_pk_mul_f32 v[192:193], v[192:193], v[38:39] op_sel:[0,0] op_sel_hi:[1,0]
    v_pk_mul_f32 v[194:195], v[194:195], v[38:39] op_sel:[0,0] op_sel_hi:[1,0]
    v_pk_mul_f32 v[196:197], v[196:197], v[38:39] op_sel:[0,0] op_sel_hi:[1,0]
    v_pk_mul_f32 v[198:199], v[198:199], v[38:39] op_sel:[0,0] op_sel_hi:[1,0]
    v_cvt_pk_bf16_f32 v22, v192, v193
    v_cvt_pk_bf16_f32 v23, v194, v195
    v_cvt_pk_bf16_f32 v24, v196, v197
    v_cvt_pk_bf16_f32 v25, v198, v199
    buffer_store_dwordx4 v[22:25], v7, s[16:19], s38 offen offset:0 sc1
    v_pk_mul_f32 v[200:201], v[200:201], v[38:39] op_sel:[0,0] op_sel_hi:[1,0]
    v_pk_mul_f32 v[202:203], v[202:203], v[38:39] op_sel:[0,0] op_sel_hi:[1,0]
    v_pk_mul_f32 v[204:205], v[204:205], v[38:39] op_sel:[0,0] op_sel_hi:[1,0]
    v_pk_mul_f32 v[206:207], v[206:207], v[38:39] op_sel:[0,0] op_sel_hi:[1,0]
    v_cvt_pk_bf16_f32 v26, v200, v201
    v_cvt_pk_bf16_f32 v27, v202, v203
    v_cvt_pk_bf16_f32 v28, v204, v205
    v_cvt_pk_bf16_f32 v29, v206, v207
    buffer_store_dwordx4 v[26:29], v7, s[16:19], s38 offen offset:1024 sc1
    v_pk_mul_f32 v[208:209], v[208:209], v[38:39] op_sel:[0,0] op_sel_hi:[1,0]
    v_pk_mul_f32 v[210:211], v[210:211], v[38:39] op_sel:[0,0] op_sel_hi:[1,0]
    v_pk_mul_f32 v[212:213], v[212:213], v[38:39] op_sel:[0,0] op_sel_hi:[1,0]
    v_pk_mul_f32 v[214:215], v[214:215], v[38:39] op_sel:[0,0] op_sel_hi:[1,0]
    v_cvt_pk_bf16_f32 v30, v208, v209
    v_cvt_pk_bf16_f32 v31, v210, v211
    v_cvt_pk_bf16_f32 v32, v212, v213
    v_cvt_pk_bf16_f32 v33, v214, v215
    buffer_store_dwordx4 v[30:33], v7, s[16:19], s38 offen offset:2048 sc1
    v_pk_mul_f32 v[216:217], v[216:217], v[38:39] op_sel:[0,0] op_sel_hi:[1,0]
    v_pk_mul_f32 v[218:219], v[218:219], v[38:39] op_sel:[0,0] op_sel_hi:[1,0]
    v_pk_mul_f32 v[220:221], v[220:221], v[38:39] op_sel:[0,0] op_sel_hi:[1,0]
    v_pk_mul_f32 v[222:223], v[222:223], v[38:39] op_sel:[0,0] op_sel_hi:[1,0]
    v_cvt_pk_bf16_f32 v34, v216, v217
    v_cvt_pk_bf16_f32 v35, v218, v219
    v_cvt_pk_bf16_f32 v36, v220, v221
    v_cvt_pk_bf16_f32 v37, v222, v223
    buffer_store_dwordx4 v[34:37], v7, s[16:19], s38 offen offset:3072 sc1
    s_add_u32 s38, s38, 131072
    v_pk_mul_f32 v[224:225], v[224:225], v[38:39] op_sel:[0,1] op_sel_hi:[1,1]
    v_pk_mul_f32 v[226:227], v[226:227], v[38:39] op_sel:[0,1] op_sel_hi:[1,1]
    v_pk_mul_f32 v[228:229], v[228:229], v[38:39] op_sel:[0,1] op_sel_hi:[1,1]
    v_pk_mul_f32 v[230:231], v[230:231], v[38:39] op_sel:[0,1] op_sel_hi:[1,1]
    v_cvt_pk_bf16_f32 v22, v224, v225
    v_cvt_pk_bf16_f32 v23, v226, v227
    v_cvt_pk_bf16_f32 v24, v228, v229
    v_cvt_pk_bf16_f32 v25, v230, v231
    buffer_store_dwordx4 v[22:25], v7, s[16:19], s38 offen offset:0 sc1
    v_pk_mul_f32 v[232:233], v[232:233], v[38:39] op_sel:[0,1] op_sel_hi:[1,1]
    v_pk_mul_f32 v[234:235], v[234:235], v[38:39] op_sel:[0,1] op_sel_hi:[1,1]
    v_pk_mul_f32 v[236:237], v[236:237], v[38:39] op_sel:[0,1] op_sel_hi:[1,1]
    v_pk_mul_f32 v[238:239], v[238:239], v[38:39] op_sel:[0,1] op_sel_hi:[1,1]
    v_cvt_pk_bf16_f32 v26, v232, v233
    v_cvt_pk_bf16_f32 v27, v234, v235
    v_cvt_pk_bf16_f32 v28, v236, v237
    v_cvt_pk_bf16_f32 v29, v238, v239
    buffer_store_dwordx4 v[26:29], v7, s[16:19], s38 offen offset:1024 sc1
    v_pk_mul_f32 v[240:241], v[240:241], v[38:39] op_sel:[0,1] op_sel_hi:[1,1]
    v_pk_mul_f32 v[242:243], v[242:243], v[38:39] op_sel:[0,1] op_sel_hi:[1,1]
    v_pk_mul_f32 v[244:245], v[244:245], v[38:39] op_sel:[0,1] op_sel_hi:[1,1]
    v_pk_mul_f32 v[246:247], v[246:247], v[38:39] op_sel:[0,1] op_sel_hi:[1,1]
    v_cvt_pk_bf16_f32 v30, v240, v241
    v_cvt_pk_bf16_f32 v31, v242, v243
    v_cvt_pk_bf16_f32 v32, v244, v245
    v_cvt_pk_bf16_f32 v33, v246, v247
    buffer_store_dwordx4 v[30:33], v7, s[16:19], s38 offen offset:2048 sc1
    v_pk_mul_f32 v[248:249], v[248:249], v[38:39] op_sel:[0,1] op_sel_hi:[1,1]
    v_pk_mul_f32 v[250:251], v[250:251], v[38:39] op_sel:[0,1] op_sel_hi:[1,1]
    v_pk_mul_f32 v[252:253], v[252:253], v[38:39] op_sel:[0,1] op_sel_hi:[1,1]
    v_pk_mul_f32 v[254:255], v[254:255], v[38:39] op_sel:[0,1] op_sel_hi:[1,1]
    v_cvt_pk_bf16_f32 v34, v248, v249
    v_cvt_pk_bf16_f32 v35, v250, v251
    v_cvt_pk_bf16_f32 v36, v252, v253
    v_cvt_pk_bf16_f32 v37, v254, v255
    buffer_store_dwordx4 v[34:37], v7, s[16:19], s38 offen offset:3072 sc1
    v_mov_b32 v96, v112
    v_mov_b32 v97, v113
    v_mov_b32 v98, v114
    v_mov_b32 v99, v115
    v_mov_b32 v100, v116
    v_mov_b32 v101, v117
    v_mov_b32 v102, v118
    v_mov_b32 v103, v119
    s_branch L_p3_done
L_recurrent_scan__compressed_kv_cla__moe_arch_mod__prompt_kernel_rare_1:
    s_mul_i32 s36, s28, 12288
    s_add_u32 s36, s36, 61865984
    v_lshl_add_u32 v16, v1, 4, s36
    v_mov_b32 v108, 0
    v_mov_b32 v109, 0
    v_mov_b32 v110, 0
    v_mov_b32 v111, 0
    global_store_dwordx4 v16, v[108:111], s[90:91] sc1
    v_add_u32 v16, 1024, v16
    global_store_dwordx4 v16, v[108:111], s[90:91] sc1
    v_add_u32 v16, 1024, v16
    global_store_dwordx4 v16, v[108:111], s[90:91] sc1
    v_add_u32 v16, 1024, v16
    global_store_dwordx4 v16, v[108:111], s[90:91] sc1
    v_add_u32 v16, 1024, v16
    global_store_dwordx4 v16, v[108:111], s[90:91] sc1
    v_add_u32 v16, 1024, v16
    global_store_dwordx4 v16, v[108:111], s[90:91] sc1
    v_add_u32 v16, 1024, v16
    global_store_dwordx4 v16, v[108:111], s[90:91] sc1
    v_add_u32 v16, 1024, v16
    global_store_dwordx4 v16, v[108:111], s[90:91] sc1
    v_add_u32 v16, 1024, v16
    global_store_dwordx4 v16, v[108:111], s[90:91] sc1
    v_add_u32 v16, 1024, v16
    global_store_dwordx4 v16, v[108:111], s[90:91] sc1
    v_add_u32 v16, 1024, v16
    global_store_dwordx4 v16, v[108:111], s[90:91] sc1
    v_add_u32 v16, 1024, v16
    global_store_dwordx4 v16, v[108:111], s[90:91] sc1
    v_add_u32 v16, 1024, v16
    s_branch L_recurrent_scan__compressed_kv_cla__moe_arch_mod__prompt_kernel_back_2
L_recurrent_scan__compressed_kv_cla__moe_arch_mod__prompt_kernel_rare_3:
    v_mov_b32 v19, 1
    s_mov_b64 exec, 1
    global_store_dword v118, v19, s[88:89] sc1
    s_mov_b64 exec, -1
    s_branch L_recurrent_scan__compressed_kv_cla__moe_arch_mod__prompt_kernel_back_4
L_recurrent_scan__compressed_kv_cla__moe_arch_mod__prompt_kernel_rare_5:
    v_and_b32 v108, 7, v1
    v_lshlrev_b32 v108, 3, v108
    v_add_u32 v109, 147712, v108
    ds_read_b64 v[110:111], v109
    ds_read_b32 v112, v109 offset:64
    s_lshl_b32 s36, s2, 6
    s_add_u32 s36, s36, 4194304
    s_lshl_b32 s37, s2, 3
    s_add_u32 s37, s37, 4276224
    s_waitcnt lgkmcnt(0)
    v_mov_b32 v114, v112
    s_nop 1
    v_max_u32_dpp v114, v114, v114 quad_perm:[1,0,3,2] row_mask:0xf bank_mask:0xf
    s_nop 1
    v_max_u32_dpp v114, v114, v114 quad_perm:[2,3,0,1] row_mask:0xf bank_mask:0xf
    s_nop 1
    v_max_u32_dpp v114, v114, v114 row_half_mirror row_mask:0xf bank_mask:0xf
    v_cmp_eq_u32 vcc, v114, v112
    s_nop 1
    v_cndmask_b32 v115, v112, v118, vcc
    s_nop 1
    v_max_u32_dpp v115, v115, v115 quad_perm:[1,0,3,2] row_mask:0xf bank_mask:0xf
    s_nop 1
    v_max_u32_dpp v115, v115, v115 quad_perm:[2,3,0,1] row_mask:0xf bank_mask:0xf
    s_nop 1
    v_max_u32_dpp v115, v115, v115 row_half_mirror row_mask:0xf bank_mask:0xf
    s_mov_b64 exec, 0xff
    buffer_store_dwordx2 v[110:111], v108, s[24:27], s36 offen sc1
    s_mov_b64 exec, 1
    buffer_store_dwordx2 v[114:115], v108, s[24:27], s37 offen sc1
    s_mov_b64 exec, -1
    s_nop 3
    s_branch L_recurrent_scan__compressed_kv_cla__moe_arch_mod__prompt_kernel_back_6
L_recurrent_scan__compressed_kv_cla__moe_arch_mod__prompt_kernel_rare_7:
    v_lshrrev_b32 v3, 4, v1
    s_lshl_b32 s37, s28, 4
    v_add_u32 v19, s37, v3
    v_lshlrev_b32 v19, 13, v19
    s_lshl_b32 s37, s29, 8
    v_add_u32 v19, s37, v19
    v_and_b32 v16, 15, v1
    v_lshlrev_b32 v3, 1, v3
    v_xor_b32 v16, v16, v3
    v_lshl_add_u32 v2, v16, 4, v19
    v_add_u32 v3, 31744, v2
    v_xor_b32 v16, 8, v16
    v_lshl_add_u32 v4, v16, 4, v19
    v_add_u32 v4, 63488, v4
    v_add_u32 v5, 31744, v4
    s_mov_b32 s4, s96
    s_and_b32 s5, s97, 0xffff
    s_mov_b32 s6, 8388608
    s_mov_b32 s7, 0x20000
    s_mov_b32 s31, 0
    s_mov_b32 s40, 1048576
    s_mov_b32 s10, 0
    s_mov_b32 s34, 0x30000
    s_branch L_recurrent_scan__compressed_kv_cla__moe_arch_mod__prompt_kernel_back_8
L_recurrent_scan__compressed_kv_cla__moe_arch_mod__prompt_kernel_w0_9:
    s_cmp_eq_u32 s35, 0
    s_cbranch_scc0 L_recurrent_scan__compressed_kv_cla__moe_arch_mod__prompt_kernel_swn_12
    s_waitcnt vmcnt(2)
    s_branch L_recurrent_scan__compressed_kv_cla__moe_arch_mod__prompt_kernel_swend_11
L_recurrent_scan__compressed_kv_cla__moe_arch_mod__prompt_kernel_swn_12:
    s_waitcnt vmcnt(2)
L_recurrent_scan__compressed_kv_cla__moe_arch_mod__prompt_kernel_swend_11:
    s_branch L_recurrent_scan__compressed_kv_cla__moe_arch_mod__prompt_kernel_w0b_10
L_recurrent_scan__compressed_kv_cla__moe_arch_mod__prompt_kernel_rare_15:
    s_cmp_eq_u32 s35, 0
    s_cbranch_scc0 L_recurrent_scan__compressed_kv_cla__moe_arch_mod__prompt_kernel_swn_14
    global_load_dword v116, v118, s[88:89] sc1
    s_branch L_recurrent_scan__compressed_kv_cla__moe_arch_mod__prompt_kernel_swend_13
L_recurrent_scan__compressed_kv_cla__moe_arch_mod__prompt_kernel_swn_14:
    v_and_b32 v117, 15, v1
    v_add_u32 v117, 112, v117
    v_lshlrev_b32 v117, 7, v117
    global_load_dword v116, v117, s[90:91] sc1
L_recurrent_scan__compressed_kv_cla__moe_arch_mod__prompt_kernel_swend_13:
    s_branch L_recurrent_scan__compressed_kv_cla__moe_arch_mod__prompt_kernel_back_16
L_recurrent_scan__compressed_kv_cla__moe_arch_mod__prompt_kernel_rare_21:
    s_mov_b32 s61, 0x40000
L_recurrent_scan__compressed_kv_cla__moe_arch_mod__prompt_kernel_spin_19:
    s_sub_u32 s61, s61, 1
    s_cbranch_scc1 L_recurrent_scan__compressed_kv_cla__moe_arch_mod__prompt_kernel_spinx_20
    s_sleep 8
    global_load_dword v116, v118, s[88:89] sc1
    s_waitcnt vmcnt(0)
    v_readfirstlane_b32 s36, v116
    s_nop 0
    s_cmp_lt_u32 s36, 1
    s_cbranch_scc1 L_recurrent_scan__compressed_kv_cla__moe_arch_mod__prompt_kernel_spin_19
L_recurrent_scan__compressed_kv_cla__moe_arch_mod__prompt_kernel_spinx_20:
    s_branch L_recurrent_scan__compressed_kv_cla__moe_arch_mod__prompt_kernel_back_22
L_recurrent_scan__compressed_kv_cla__moe_arch_mod__prompt_kernel_w0_17:
    s_waitcnt vmcnt(0)
    s_cmp_eq_u32 s35, 0
    s_cbranch_scc0 L_recurrent_scan__compressed_kv_cla__moe_arch_mod__prompt_kernel_swn_26
    v_readfirstlane_b32 s36, v116
    s_nop 0
    s_cmp_lt_u32 s36, 1
    s_cbranch_scc1 L_recurrent_scan__compressed_kv_cla__moe_arch_mod__prompt_kernel_rare_21
L_recurrent_scan__compressed_kv_cla__moe_arch_mod__prompt_kernel_back_22:
    s_branch L_recurrent_scan__compressed_kv_cla__moe_arch_mod__prompt_kernel_swend_25
L_recurrent_scan__compressed_kv_cla__moe_arch_mod__prompt_kernel_swn_26:
    s_mov_b32 s61, 0x40000
L_recurrent_scan__compressed_kv_cla__moe_arch_mod__prompt_kernel_lspin_23:
    v_cmp_gt_u32 vcc, 16, v116
    s_nop 0
    s_cmp_eq_u64 vcc, 0
    s_cbranch_scc1 L_recurrent_scan__compressed_kv_cla__moe_arch_mod__prompt_kernel_lspinx_24
    s_sub_u32 s61, s61, 1
    s_cbranch_scc1 L_recurrent_scan__compressed_kv_cla__moe_arch_mod__prompt_kernel_lspinx_24
    s_sleep 8
    global_load_dword v116, v117, s[90:91] sc1
    s_waitcnt vmcnt(0)
    s_branch L_recurrent_scan__compressed_kv_cla__moe_arch_mod__prompt_kernel_lspin_23
L_recurrent_scan__compressed_kv_cla__moe_arch_mod__prompt_kernel_lspinx_24:
L_recurrent_scan__compressed_kv_cla__moe_arch_mod__prompt_kernel_swend_25:
    s_branch L_recurrent_scan__compressed_kv_cla__moe_arch_mod__prompt_kernel_w0b_18
L_recurrent_scan__compressed_kv_cla__moe_arch_mod__prompt_kernel_rare_27:
    s_lshr_b32 s36, s2, 4
    s_add_u32 s36, s36, 112
    s_lshl_b32 s36, s36, 7
    v_mov_b32 v16, s36
    v_mov_b32 v19, 1
    s_mov_b64 exec, 1
    global_atomic_add v16, v19, s[90:91]
    s_mov_b64 exec, -1
    s_nop 3
    s_branch L_recurrent_scan__compressed_kv_cla__moe_arch_mod__prompt_kernel_back_28
L_recurrent_scan__compressed_kv_cla__moe_arch_mod__prompt_kernel_w0_29:
    s_cmp_eq_u32 s35, 0
    s_cbranch_scc0 L_recurrent_scan__compressed_kv_cla__moe_arch_mod__prompt_kernel_swn_32
    s_waitcnt vmcnt(2)
    s_branch L_recurrent_scan__compressed_kv_cla__moe_arch_mod__prompt_kernel_swend_31
L_recurrent_scan__compressed_kv_cla__moe_arch_mod__prompt_kernel_swn_32:
    s_waitcnt vmcnt(2)
L_recurrent_scan__compressed_kv_cla__moe_arch_mod__prompt_kernel_swend_31:
    s_branch L_recurrent_scan__compressed_kv_cla__moe_arch_mod__prompt_kernel_w0b_30
L_recurrent_scan__compressed_kv_cla__moe_arch_mod__prompt_kernel_rare_35:
    v_lshrrev_b32 v3, 4, v1
    s_lshl_b32 s37, s28, 4
    v_add_u32 v19, s37, v3
    v_lshlrev_b32 v19, 13, v19
    s_lshl_b32 s37, s29, 8
    v_add_u32 v19, s37, v19
    v_and_b32 v16, 15, v1
    v_lshlrev_b32 v3, 1, v3
    v_xor_b32 v16, v16, v3
    v_lshl_add_u32 v2, v16, 4, v19
    v_add_u32 v3, 31744, v2
    v_xor_b32 v16, 8, v16
    v_lshl_add_u32 v4, v16, 4, v19
    v_add_u32 v4, 63488, v4
    v_add_u32 v5, 31744, v4
    s_mov_b32 s4, s96
    s_and_b32 s5, s97, 0xffff
    s_mov_b32 s6, 8388608
    s_mov_b32 s7, 0x20000
    s_mov_b32 s31, 0
    s_mov_b32 s40, 1048576
    s_mov_b32 s10, 0
    s_mov_b32 s34, 0x30000
    s_branch L_recurrent_scan__compressed_kv_cla__moe_arch_mod__prompt_kernel_back_36
L_recurrent_scan__compressed_kv_cla__moe_arch_mod__prompt_kernel_rare_41:
    s_mov_b32 s61, 0x40000
L_recurrent_scan__compressed_kv_cla__moe_arch_mod__prompt_kernel_spin_39:
    s_sub_u32 s61, s61, 1
    s_cbranch_scc1 L_recurrent_scan__compressed_kv_cla__moe_arch_mod__prompt_kernel_spinx_40
    s_sleep 8
    global_load_dword v56, v57, s[90:91] sc1
    s_waitcnt vmcnt(0)
    v_readfirstlane_b32 s36, v56
    s_nop 0
    s_cmp_lt_u32 s36, 1
    s_cbranch_scc1 L_recurrent_scan__compressed_kv_cla__moe_arch_mod__prompt_kernel_spin_39
L_recurrent_scan__compressed_kv_cla__moe_arch_mod__prompt_kernel_spinx_40:
    s_branch L_recurrent_scan__compressed_kv_cla__moe_arch_mod__prompt_kernel_back_42
L_recurrent_scan__compressed_kv_cla__moe_arch_mod__prompt_kernel_rare_47:
    s_cmp_lt_u32 s28, 4
    s_cbranch_scc0 L_recurrent_scan__compressed_kv_cla__moe_arch_mod__prompt_kernel_ng_44
    s_cmp_eq_u32 s35, 2
    s_cbranch_scc0 L_recurrent_scan__compressed_kv_cla__moe_arch_mod__prompt_kernel_swn_46
    s_branch L_recurrent_scan__compressed_kv_cla__moe_arch_mod__prompt_kernel_swend_45
L_recurrent_scan__compressed_kv_cla__moe_arch_mod__prompt_kernel_swn_46:
    s_mov_b64 s[4:5], s[12:13]
    s_mov_b32 s6, s14
    s_mov_b32 s31, s45
    s_mov_b32 s40, 65536
    v_add_u32 v2, s33, v58
    v_mov_b32 v3, v2
    v_mov_b32 v4, v2
    v_mov_b32 v5, v2
    s_cmp_eq_u32 s28, 0
    s_cbranch_scc0 L_recurrent_scan__compressed_kv_cla__moe_arch_mod__prompt_kernel_g_43
    s_waitcnt vmcnt(14)
    v_readfirstlane_b32 s36, v56
    s_nop 0
    s_cmp_lt_u32 s36, 1
    s_cbranch_scc1 L_recurrent_scan__compressed_kv_cla__moe_arch_mod__prompt_kernel_rare_41
L_recurrent_scan__compressed_kv_cla__moe_arch_mod__prompt_kernel_back_42:
L_recurrent_scan__compressed_kv_cla__moe_arch_mod__prompt_kernel_g_43:
L_recurrent_scan__compressed_kv_cla__moe_arch_mod__prompt_kernel_swend_45:
L_recurrent_scan__compressed_kv_cla__moe_arch_mod__prompt_kernel_ng_44:
    s_branch L_recurrent_scan__compressed_kv_cla__moe_arch_mod__prompt_kernel_back_48
L_recurrent_scan__compressed_kv_cla__moe_arch_mod__prompt_kernel_rare_52:
    s_cmp_lt_u32 s28, 4
    s_cbranch_scc0 L_recurrent_scan__compressed_kv_cla__moe_arch_mod__prompt_kernel_ng_49
    s_cmp_eq_u32 s35, 2
    s_cbranch_scc0 L_recurrent_scan__compressed_kv_cla__moe_arch_mod__prompt_kernel_swn_51
    s_cmp_eq_u32 s28, 0
    s_cbranch_scc0 L_recurrent_scan__compressed_kv_cla__moe_arch_mod__prompt_kernel_g_38
    s_add_u32 s36, s29, 64
    s_lshl_b32 s36, s36, 7
    v_mov_b32 v57, s36
    global_load_dword v56, v57, s[90:91] sc1
L_recurrent_scan__compressed_kv_cla__moe_arch_mod__prompt_kernel_g_38:
    s_branch L_recurrent_scan__compressed_kv_cla__moe_arch_mod__prompt_kernel_swend_50
L_recurrent_scan__compressed_kv_cla__moe_arch_mod__prompt_kernel_swn_51:
L_recurrent_scan__compressed_kv_cla__moe_arch_mod__prompt_kernel_swend_50:
L_recurrent_scan__compressed_kv_cla__moe_arch_mod__prompt_kernel_ng_49:
    s_branch L_recurrent_scan__compressed_kv_cla__moe_arch_mod__prompt_kernel_back_53
L_recurrent_scan__compressed_kv_cla__moe_arch_mod__prompt_kernel_rare_57:
    s_cmp_ge_u32 s28, 4
    s_cbranch_scc0 L_recurrent_scan__compressed_kv_cla__moe_arch_mod__prompt_kernel_ng_54
    s_cmp_eq_u32 s35, 2
    s_cbranch_scc0 L_recurrent_scan__compressed_kv_cla__moe_arch_mod__prompt_kernel_swn_56
    s_branch L_recurrent_scan__compressed_kv_cla__moe_arch_mod__prompt_kernel_swend_55
L_recurrent_scan__compressed_kv_cla__moe_arch_mod__prompt_kernel_swn_56:
    s_mov_b64 s[4:5], s[12:13]
    s_mov_b32 s6, s14
    s_mov_b32 s31, s45
    s_mov_b32 s40, 65536
    v_add_u32 v2, s33, v58
    v_mov_b32 v3, v2
    v_mov_b32 v4, v2
    v_mov_b32 v5, v2
L_recurrent_scan__compressed_kv_cla__moe_arch_mod__prompt_kernel_swend_55:
L_recurrent_scan__compressed_kv_cla__moe_arch_mod__prompt_kernel_ng_54:
    s_branch L_recurrent_scan__compressed_kv_cla__moe_arch_mod__prompt_kernel_back_58
L_recurrent_scan__compressed_kv_cla__moe_arch_mod__prompt_kernel_rare_63:
    s_cmp_eq_u32 s35, 3
    s_cbranch_scc0 L_recurrent_scan__compressed_kv_cla__moe_arch_mod__prompt_kernel_nv0_59
    s_add_u32 m0, s33, 65536
    s_add_u32 s36, s45, 32768
    buffer_load_dwordx4 v2, s[12:15], s36 offen offset:0 sc1 lds
    buffer_load_dwordx4 v2, s[12:15], s36 offen offset:1024 sc1 lds
    buffer_load_dwordx4 v2, s[12:15], s36 offen offset:2048 sc1 lds
    buffer_load_dwordx4 v2, s[12:15], s36 offen offset:3072 sc1 lds
L_recurrent_scan__compressed_kv_cla__moe_arch_mod__prompt_kernel_nv0_59:
    s_cmp_ge_u32 s28, 4
    s_cbranch_scc0 L_recurrent_scan__compressed_kv_cla__moe_arch_mod__prompt_kernel_ng_60
    s_cmp_eq_u32 s35, 2
    s_cbranch_scc0 L_recurrent_scan__compressed_kv_cla__moe_arch_mod__prompt_kernel_swn_62
    s_add_u32 s36, s28, s30
    s_cmp_eq_u32 s36, 4
    s_cbranch_scc0 L_recurrent_scan__compressed_kv_cla__moe_arch_mod__prompt_kernel_g_37
    s_add_u32 s36, s29, 64
    s_lshl_b32 s36, s36, 7
    v_mov_b32 v62, s36
    v_mov_b32 v63, 1
    s_mov_b64 exec, 1
    global_atomic_add v62, v63, s[90:91]
    s_mov_b64 exec, -1
    s_nop 3
L_recurrent_scan__compressed_kv_cla__moe_arch_mod__prompt_kernel_g_37:
    s_branch L_recurrent_scan__compressed_kv_cla__moe_arch_mod__prompt_kernel_swend_61
L_recurrent_scan__compressed_kv_cla__moe_arch_mod__prompt_kernel_swn_62:
L_recurrent_scan__compressed_kv_cla__moe_arch_mod__prompt_kernel_swend_61:
L_recurrent_scan__compressed_kv_cla__moe_arch_mod__prompt_kernel_ng_60:
    s_branch L_recurrent_scan__compressed_kv_cla__moe_arch_mod__prompt_kernel_back_64
L_recurrent_scan__compressed_kv_cla__moe_arch_mod__prompt_kernel_rare_65:
    s_lshl_b32 s36, s39, 1
    s_add_u32 s36, s36, s38
    s_add_u32 s37, s36, s39
    buffer_store_dwordx4 v[160:163], v58, s[16:19], s36 offen sc1
    buffer_store_dwordx4 v[164:167], v59, s[16:19], s36 offen sc1
    buffer_store_dwordx4 v[168:171], v60, s[16:19], s36 offen sc1
    buffer_store_dwordx4 v[172:175], v61, s[16:19], s36 offen sc1
    buffer_store_dwordx4 v[176:179], v58, s[16:19], s37 offen sc1
    buffer_store_dwordx4 v[180:183], v59, s[16:19], s37 offen sc1
    buffer_store_dwordx4 v[184:187], v60, s[16:19], s37 offen sc1
    buffer_store_dwordx4 v[188:191], v61, s[16:19], s37 offen sc1
    s_branch L_recurrent_scan__compressed_kv_cla__moe_arch_mod__prompt_kernel_back_66
L_recurrent_scan__compressed_kv_cla__moe_arch_mod__prompt_kernel_rare_67:
    v_mov_b32 v20, 4048155338
    v_subrev_u32 v21, s50, v18
    v_cmp_gt_i32 s[20:21], 0, v21
    v_cmp_gt_i32 s[22:23], 1, v21
    v_cmp_gt_i32 s[62:63], 2, v21
    v_cmp_gt_i32 vcc, 3, v21
    v_cndmask_b32 v96, v96, v20, s[20:21]
    v_cndmask_b32 v97, v97, v20, s[22:23]
    v_cndmask_b32 v98, v98, v20, s[62:63]
    v_cndmask_b32 v99, v99, v20, vcc
    v_cmp_gt_i32 s[20:21], 16, v21
    v_cmp_gt_i32 s[22:23], 17, v21
    v_cmp_gt_i32 s[62:63], 18, v21
    v_cmp_gt_i32 vcc, 19, v21
    v_cndmask_b32 v100, v100, v20, s[20:21]
    v_cndmask_b32 v101, v101, v20, s[22:23]
    v_cndmask_b32 v102, v102, v20, s[62:63]
    v_cndmask_b32 v103, v103, v20, vcc
    v_cmp_gt_i32 s[20:21], -16, v21
    v_cmp_gt_i32 s[22:23], -15, v21
    v_cmp_gt_i32 s[62:63], -14, v21
    v_cmp_gt_i32 vcc, -13, v21
    v_cndmask_b32 v104, v104, v20, s[20:21]
    v_cndmask_b32 v105, v105, v20, s[22:23]
    v_cndmask_b32 v106, v106, v20, s[62:63]
    v_cndmask_b32 v107, v107, v20, vcc
    v_cmp_gt_i32 s[20:21], 0, v21
    v_cmp_gt_i32 s[22:23], 1, v21
    v_cmp_gt_i32 s[62:63], 2, v21
    v_cmp_gt_i32 vcc, 3, v21
    v_cndmask_b32 v108, v108, v20, s[20:21]
    v_cndmask_b32 v109, v109, v20, s[22:23]
    v_cndmask_b32 v110, v110, v20, s[62:63]
    v_cndmask_b32 v111, v111, v20, vcc
    s_branch L_recurrent_scan__compressed_kv_cla__moe_arch_mod__prompt_kernel_back_68
L_recurrent_scan__compressed_kv_cla__moe_arch_mod__prompt_kernel_rare_69:
    s_lshl_b32 s36, s29, 7
    v_mov_b32 v13, s36
    global_load_dword v14, v13, s[90:91] sc1
    s_branch L_recurrent_scan__compressed_kv_cla__moe_arch_mod__prompt_kernel_back_70
L_recurrent_scan__compressed_kv_cla__moe_arch_mod__prompt_kernel_rare_71:
    v_mov_b32 v20, 4048155338
    v_subrev_u32 v21, s49, v18
    v_cmp_gt_i32 s[20:21], 0, v21
    v_cmp_gt_i32 s[22:23], 1, v21
    v_cmp_gt_i32 s[62:63], 2, v21
    v_cmp_gt_i32 vcc, 3, v21
    v_cndmask_b32 v112, v112, v20, s[20:21]
    v_cndmask_b32 v113, v113, v20, s[22:23]
    v_cndmask_b32 v114, v114, v20, s[62:63]
    v_cndmask_b32 v115, v115, v20, vcc
    v_cmp_gt_i32 s[20:21], 16, v21
    v_cmp_gt_i32 s[22:23], 17, v21
    v_cmp_gt_i32 s[62:63], 18, v21
    v_cmp_gt_i32 vcc, 19, v21
    v_cndmask_b32 v116, v116, v20, s[20:21]
    v_cndmask_b32 v117, v117, v20, s[22:23]
    v_cndmask_b32 v118, v118, v20, s[62:63]
    v_cndmask_b32 v119, v119, v20, vcc
    v_cmp_gt_i32 s[20:21], -16, v21
    v_cmp_gt_i32 s[22:23], -15, v21
    v_cmp_gt_i32 s[62:63], -14, v21
    v_cmp_gt_i32 vcc, -13, v21
    v_cndmask_b32 v120, v120, v20, s[20:21]
    v_cndmask_b32 v121, v121, v20, s[22:23]
    v_cndmask_b32 v122, v122, v20, s[62:63]
    v_cndmask_b32 v123, v123, v20, vcc
    v_cmp_gt_i32 s[20:21], 0, v21
    v_cmp_gt_i32 s[22:23], 1, v21
    v_cmp_gt_i32 s[62:63], 2, v21
    v_cmp_gt_i32 vcc, 3, v21
    v_cndmask_b32 v124, v124, v20, s[20:21]
    v_cndmask_b32 v125, v125, v20, s[22:23]
    v_cndmask_b32 v126, v126, v20, s[62:63]
    v_cndmask_b32 v127, v127, v20, vcc
    s_branch L_recurrent_scan__compressed_kv_cla__moe_arch_mod__prompt_kernel_back_72
L_recurrent_scan__compressed_kv_cla__moe_arch_mod__prompt_kernel_rare_73:
    v_mov_b32 v20, 4048155338
    v_subrev_u32 v21, s50, v18
    v_cmp_gt_i32 s[20:21], 0, v21
    v_cmp_gt_i32 s[22:23], 1, v21
    v_cmp_gt_i32 s[62:63], 2, v21
    v_cmp_gt_i32 vcc, 3, v21
    v_cndmask_b32 v96, v96, v20, s[20:21]
    v_cndmask_b32 v97, v97, v20, s[22:23]
    v_cndmask_b32 v98, v98, v20, s[62:63]
    v_cndmask_b32 v99, v99, v20, vcc
    v_cmp_gt_i32 s[20:21], 16, v21
    v_cmp_gt_i32 s[22:23], 17, v21
    v_cmp_gt_i32 s[62:63], 18, v21
    v_cmp_gt_i32 vcc, 19, v21
    v_cndmask_b32 v100, v100, v20, s[20:21]
    v_cndmask_b32 v101, v101, v20, s[22:23]
    v_cndmask_b32 v102, v102, v20, s[62:63]
    v_cndmask_b32 v103, v103, v20, vcc
    v_cmp_gt_i32 s[20:21], -16, v21
    v_cmp_gt_i32 s[22:23], -15, v21
    v_cmp_gt_i32 s[62:63], -14, v21
    v_cmp_gt_i32 vcc, -13, v21
    v_cndmask_b32 v104, v104, v20, s[20:21]
    v_cndmask_b32 v105, v105, v20, s[22:23]
    v_cndmask_b32 v106, v106, v20, s[62:63]
    v_cndmask_b32 v107, v107, v20, vcc
    v_cmp_gt_i32 s[20:21], 0, v21
    v_cmp_gt_i32 s[22:23], 1, v21
    v_cmp_gt_i32 s[62:63], 2, v21
    v_cmp_gt_i32 vcc, 3, v21
    v_cndmask_b32 v108, v108, v20, s[20:21]
    v_cndmask_b32 v109, v109, v20, s[22:23]
    v_cndmask_b32 v110, v110, v20, s[62:63]
    v_cndmask_b32 v111, v111, v20, vcc
    s_branch L_recurrent_scan__compressed_kv_cla__moe_arch_mod__prompt_kernel_back_74
L_recurrent_scan__compressed_kv_cla__moe_arch_mod__prompt_kernel_rare_83:
    s_mov_b32 s61, 0x40000
L_recurrent_scan__compressed_kv_cla__moe_arch_mod__prompt_kernel_spin_81:
    s_sub_u32 s61, s61, 1
    s_cbranch_scc1 L_recurrent_scan__compressed_kv_cla__moe_arch_mod__prompt_kernel_spinx_82
    s_sleep 8
    global_load_dword v14, v13, s[90:91] sc1
    s_waitcnt vmcnt(0)
    v_readfirstlane_b32 s36, v14
    s_nop 0
    s_cmp_lt_u32 s36, 8
    s_cbranch_scc1 L_recurrent_scan__compressed_kv_cla__moe_arch_mod__prompt_kernel_spin_81
L_recurrent_scan__compressed_kv_cla__moe_arch_mod__prompt_kernel_spinx_82:
    s_branch L_recurrent_scan__compressed_kv_cla__moe_arch_mod__prompt_kernel_back_84
L_recurrent_scan__compressed_kv_cla__moe_arch_mod__prompt_kernel_rare_89:
    s_cmp_eq_u32 s40, 1
    s_cbranch_scc0 L_recurrent_scan__compressed_kv_cla__moe_arch_mod__prompt_kernel_swn_86
    v_readfirstlane_b32 s36, v14
    s_nop 0
    s_cmp_lt_u32 s36, 8
    s_cbranch_scc1 L_recurrent_scan__compressed_kv_cla__moe_arch_mod__prompt_kernel_rare_83
L_recurrent_scan__compressed_kv_cla__moe_arch_mod__prompt_kernel_back_84:
    s_branch L_recurrent_scan__compressed_kv_cla__moe_arch_mod__prompt_kernel_swend_85
L_recurrent_scan__compressed_kv_cla__moe_arch_mod__prompt_kernel_swn_86:
    s_cmp_eq_u32 s40, 2
    s_cbranch_scc0 L_recurrent_scan__compressed_kv_cla__moe_arch_mod__prompt_kernel_swn_87
    s_mov_b32 s36, 4276224
    buffer_load_dwordx4 v[160:163], v7, s[24:27], s36 offen offset:0 sc1
    buffer_load_dwordx4 v[164:167], v7, s[24:27], s36 offen offset:1024 sc1
    s_branch L_recurrent_scan__compressed_kv_cla__moe_arch_mod__prompt_kernel_swend_85
L_recurrent_scan__compressed_kv_cla__moe_arch_mod__prompt_kernel_swn_87:
    s_cmp_eq_u32 s40, 3
    s_cbranch_scc0 L_recurrent_scan__compressed_kv_cla__moe_arch_mod__prompt_kernel_swn_88
    v_max_u32 v26, v160, v161
    v_min_u32 v27, v160, v161
    v_med3_u32 v27, v26, v27, v162
    v_max_u32 v26, v26, v162
    v_med3_u32 v27, v26, v27, v163
    v_max_u32 v26, v26, v163
    v_med3_u32 v27, v26, v27, v164
    v_max_u32 v26, v26, v164
    v_med3_u32 v27, v26, v27, v165
    v_max_u32 v26, v26, v165
    v_med3_u32 v27, v26, v27, v166
    v_max_u32 v26, v26, v166
    v_med3_u32 v27, v26, v27, v167
    v_max_u32 v26, v26, v167
    v_mov_b32 v28, v26
    s_nop 1
    v_max_u32_dpp v28, v28, v28 quad_perm:[1,0,3,2] row_mask:0xf bank_mask:0xf
    s_nop 1
    v_max_u32_dpp v28, v28, v28 quad_perm:[2,3,0,1] row_mask:0xf bank_mask:0xf
    s_nop 1
    v_max_u32_dpp v28, v28, v28 row_half_mirror row_mask:0xf bank_mask:0xf
    s_nop 1
    v_max_u32_dpp v28, v28, v28 row_mirror row_mask:0xf bank_mask:0xf
    s_nop 0
    v_readlane_b32 s20, v28, 0
    v_readlane_b32 s21, v28, 16
    v_readlane_b32 s22, v28, 32
    v_readlane_b32 s23, v28, 48
    s_max_u32 s20, s20, s21
    s_max_u32 s22, s22, s23
    s_max_u32 s20, s20, s22
    s_mov_b32 s58, s20
    v_cmp_eq_u32 vcc, s58, v26
    s_nop 1
    v_cndmask_b32 v28, v26, v27, vcc
    s_nop 1
    v_max_u32_dpp v28, v28, v28 quad_perm:[1,0,3,2] row_mask:0xf bank_mask:0xf
    s_nop 1
    v_max_u32_dpp v28, v28, v28 quad_perm:[2,3,0,1] row_mask:0xf bank_mask:0xf
    s_nop 1
    v_max_u32_dpp v28, v28, v28 row_half_mirror row_mask:0xf bank_mask:0xf
    s_nop 1
    v_max_u32_dpp v28, v28, v28 row_mirror row_mask:0xf bank_mask:0xf
    s_nop 0
    v_readlane_b32 s20, v28, 0
    v_readlane_b32 s21, v28, 16
    v_readlane_b32 s22, v28, 32
    v_readlane_b32 s23, v28, 48
    s_max_u32 s20, s20, s21
    s_max_u32 s22, s22, s23
    s_max_u32 s20, s20, s22
    s_mov_b32 s59, s20
    s_and_b32 s36, s58, 0xffff
    s_sub_u32 s56, 0xffff, s36
    s_and_b32 s36, s59, 0xffff
    s_sub_u32 s57, 0xffff, s36
    v_and_b32 v26, 1, v1
    v_mov_b32 v27, s56
    v_mov_b32 v28, s57
    v_cmp_eq_u32 vcc, 1, v26
    s_nop 1
    v_cndmask_b32 v27, v27, v28, vcc
    v_lshrrev_b32 v28, 4, v27
    v_lshlrev_b32 v28, 15, v28
    v_and_b32 v27, 15, v27
    v_lshl_add_u32 v28, v27, 4, v28
    v_lshrrev_b32 v29, 4, v1
    v_lshl_add_u32 v28, v29, 8, v28
    s_and_b32 s36, s3, 3
    s_lshl_b32 s36, s36, 13
    s_add_u32 s37, s36, 4096
    s_mov_b32 exec_lo, 0x00030003
    s_mov_b32 exec_hi, 0x00030003
    buffer_load_dwordx4 v[160:163], v28, s[24:27], s36 offen offset:0 sc1
    buffer_load_dwordx4 v[164:167], v28, s[24:27], s36 offen offset:1024 sc1
    buffer_load_dwordx4 v[168:171], v28, s[24:27], s36 offen offset:2048 sc1
    buffer_load_dwordx4 v[172:175], v28, s[24:27], s36 offen offset:3072 sc1
    buffer_load_dwordx4 v[176:179], v28, s[24:27], s37 offen offset:0 sc1
    buffer_load_dwordx4 v[180:183], v28, s[24:27], s37 offen offset:1024 sc1
    buffer_load_dwordx4 v[184:187], v28, s[24:27], s37 offen offset:2048 sc1
    buffer_load_dwordx4 v[188:191], v28, s[24:27], s37 offen offset:3072 sc1
    s_mov_b64 exec, -1
    s_branch L_recurrent_scan__compressed_kv_cla__moe_arch_mod__prompt_kernel_swend_85
L_recurrent_scan__compressed_kv_cla__moe_arch_mod__prompt_kernel_swn_88:
    s_sub_u32 s38, s40, s60
    s_cmp_eq_u32 s38, 0
    s_cbranch_scc0 L_recurrent_scan__compressed_kv_cla__moe_arch_mod__prompt_kernel_swn_77
    s_and_b32 s20, s3, 3
    s_lshl_b32 s20, s20, 8
    s_lshl_b32 s21, s28, 5
    s_add_u32 s20, s20, s21
    s_lshr_b32 s21, s3, 2
    s_lshl_b32 s21, s21, 7
    v_lshrrev_b32 v27, 3, v1
    s_lshl_b32 s36, s28, 5
    s_add_u32 s36, s36, s20
    v_add_u32 v27, s36, v27
    v_mul_u32_u24 v27, 7168, v27
    v_add_u32 v27, s21, v27
    v_bfe_u32 v28, v1, 4, 1
    v_lshlrev_b32 v28, 1, v28
    v_and_b32 v29, 7, v1
    v_xor_b32 v28, v28, v29
    v_lshl_add_u32 v26, v28, 4, v27
    v_xor_b32 v28, 4, v28
    v_lshl_add_u32 v27, v28, 4, v27
    v_add_u32 v27, 56320, v27
    v_add_u32 v28, 112640, v26
    v_add_u32 v29, 112640, v27
    s_lshl_b32 s36, s28, 13
    s_add_u32 m0, s36, 131072
    s_mov_b32 s37, 229376
    buffer_load_dwordx4 v26, s[4:7], 0 offen offset:0 nt lds
    buffer_load_dwordx4 v27, s[4:7], 0 offen offset:1024 nt lds
    buffer_load_dwordx4 v28, s[4:7], 0 offen offset:2048 nt lds
    buffer_load_dwordx4 v29, s[4:7], 0 offen offset:3072 nt lds
    s_add_u32 m0, s36, 135168
    s_nop 0
    buffer_load_dwordx4 v26, s[4:7], s37 offen offset:0 nt lds
    buffer_load_dwordx4 v27, s[4:7], s37 offen offset:1024 nt lds
    buffer_load_dwordx4 v28, s[4:7], s37 offen offset:2048 nt lds
    buffer_load_dwordx4 v29, s[4:7], s37 offen offset:3072 nt lds
    s_branch L_recurrent_scan__compressed_kv_cla__moe_arch_mod__prompt_kernel_swend_76
L_recurrent_scan__compressed_kv_cla__moe_arch_mod__prompt_kernel_swn_77:
    s_cmp_eq_u32 s38, 2
    s_cbranch_scc0 L_recurrent_scan__compressed_kv_cla__moe_arch_mod__prompt_kernel_swn_78
    v_lshrrev_b32 v8, 4, v1
    v_bfe_u32 v20, v1, 2, 2
    v_lshl_add_u32 v20, v8, 3, v20
    v_lshlrev_b32 v20, 7, v20
    v_and_b32 v21, 3, v1
    v_lshl_add_u32 v20, v21, 3, v20
    v_bfe_u32 v21, v1, 3, 2
    v_xor_b32 v21, s28, v21
    v_lshl_add_u32 v20, v21, 5, v20
    v_add_u32 v20, 131072, v20
    ds_read_b64_tr_b16 v[22:23], v20 offset:0
    ds_read_b64_tr_b16 v[24:25], v20 offset:512
    ds_read_b64_tr_b16 v[26:27], v20 offset:4096
    ds_read_b64_tr_b16 v[28:29], v20 offset:4608
    ds_read_b64_tr_b16 v[30:31], v20 offset:8192
    ds_read_b64_tr_b16 v[32:33], v20 offset:8704
    ds_read_b64_tr_b16 v[34:35], v20 offset:12288
    ds_read_b64_tr_b16 v[36:37], v20 offset:12800
    s_and_b32 s36, s3, 3
    s_lshl_b32 s36, s36, 6
    s_lshr_b32 s37, s3, 2
    s_lshl_b32 s37, s37, 12
    s_add_u32 s36, s36, s37
    s_lshl_b32 s37, s28, 10
    s_add_u32 s36, s36, s37
    s_add_u32 s36, s36, 58720256
    v_and_b32 v9, 1, v1
    v_lshlrev_b32 v9, 4, v9
    v_lshl_add_u32 v9, v8, 8, v9
    s_waitcnt lgkmcnt(0)
    v_mfma_f32_16x16x32_bf16 v[10:13], v[22:25], v[160:163], 0
    v_mfma_f32_16x16x32_bf16 v[10:13], v[26:29], v[164:167], v[10:13]
    v_mfma_f32_16x16x32_bf16 v[10:13], v[30:33], v[168:171], v[10:13]
    v_mfma_f32_16x16x32_bf16 v[10:13], v[34:37], v[172:175], v[10:13]
    ds_read_b64_tr_b16 v[22:23], v20 offset:16384
    ds_read_b64_tr_b16 v[24:25], v20 offset:16896
    ds_read_b64_tr_b16 v[26:27], v20 offset:20480
    ds_read_b64_tr_b16 v[28:29], v20 offset:20992
    ds_read_b64_tr_b16 v[30:31], v20 offset:24576
    ds_read_b64_tr_b16 v[32:33], v20 offset:25088
    ds_read_b64_tr_b16 v[34:35], v20 offset:28672
    ds_read_b64_tr_b16 v[36:37], v20 offset:29184
    s_waitcnt lgkmcnt(0)
    v_mfma_f32_16x16x32_bf16 v[10:13], v[22:25], v[176:179], v[10:13]
    v_mfma_f32_16x16x32_bf16 v[10:13], v[26:29], v[180:183], v[10:13]
    v_mfma_f32_16x16x32_bf16 v[10:13], v[30:33], v[184:187], v[10:13]
    v_mfma_f32_16x16x32_bf16 v[10:13], v[34:37], v[188:191], v[10:13]
    s_nop 5
    s_mov_b32 exec_lo, 0x00030003
    s_mov_b32 exec_hi, 0x00030003
    buffer_store_dwordx4 v[10:13], v9, s[24:27], s36 offen sc1
    s_mov_b64 exec, -1
    s_nop 1
    s_branch L_recurrent_scan__compressed_kv_cla__moe_arch_mod__prompt_kernel_swend_76
L_recurrent_scan__compressed_kv_cla__moe_arch_mod__prompt_kernel_swn_78:
    s_cmp_eq_u32 s38, 3
    s_cbranch_scc0 L_recurrent_scan__compressed_kv_cla__moe_arch_mod__prompt_kernel_swn_79
    s_and_b32 s20, s3, 3
    s_lshl_b32 s20, s20, 8
    s_lshl_b32 s21, s28, 5
    s_add_u32 s20, s20, s21
    s_lshr_b32 s21, s3, 2
    s_lshl_b32 s21, s21, 7
    v_lshrrev_b32 v27, 3, v1
    s_lshl_b32 s36, s28, 5
    s_add_u32 s36, s36, s20
    v_add_u32 v27, s36, v27
    v_mul_u32_u24 v27, 7168, v27
    v_add_u32 v27, s21, v27
    v_bfe_u32 v28, v1, 4, 1
    v_lshlrev_b32 v28, 1, v28
    v_and_b32 v29, 7, v1
    v_xor_b32 v28, v28, v29
    v_lshl_add_u32 v26, v28, 4, v27
    v_xor_b32 v28, 4, v28
    v_lshl_add_u32 v27, v28, 4, v27
    v_add_u32 v27, 56320, v27
    v_add_u32 v28, 112640, v26
    v_add_u32 v29, 112640, v27
    s_lshl_b32 s36, s28, 13
    s_add_u32 m0, s36, 131072
    s_mov_b32 s37, 229376
    buffer_load_dwordx4 v26, s[8:11], 0 offen offset:0 nt lds
    buffer_load_dwordx4 v27, s[8:11], 0 offen offset:1024 nt lds
    buffer_load_dwordx4 v28, s[8:11], 0 offen offset:2048 nt lds
    buffer_load_dwordx4 v29, s[8:11], 0 offen offset:3072 nt lds
    s_add_u32 m0, s36, 135168
    s_nop 0
    buffer_load_dwordx4 v26, s[8:11], s37 offen offset:0 nt lds
    buffer_load_dwordx4 v27, s[8:11], s37 offen offset:1024 nt lds
    buffer_load_dwordx4 v28, s[8:11], s37 offen offset:2048 nt lds
    buffer_load_dwordx4 v29, s[8:11], s37 offen offset:3072 nt lds
    s_branch L_recurrent_scan__compressed_kv_cla__moe_arch_mod__prompt_kernel_swend_76
L_recurrent_scan__compressed_kv_cla__moe_arch_mod__prompt_kernel_swn_79:
    s_cmp_eq_u32 s38, 5
    s_cbranch_scc0 L_recurrent_scan__compressed_kv_cla__moe_arch_mod__prompt_kernel_swn_80
    v_lshrrev_b32 v8, 4, v1
    v_bfe_u32 v20, v1, 2, 2
    v_lshl_add_u32 v20, v8, 3, v20
    v_lshlrev_b32 v20, 7, v20
    v_and_b32 v21, 3, v1
    v_lshl_add_u32 v20, v21, 3, v20
    v_bfe_u32 v21, v1, 3, 2
    v_xor_b32 v21, s28, v21
    v_lshl_add_u32 v20, v21, 5, v20
    v_add_u32 v20, 131072, v20
    ds_read_b64_tr_b16 v[22:23], v20 offset:0
    ds_read_b64_tr_b16 v[24:25], v20 offset:512
    ds_read_b64_tr_b16 v[26:27], v20 offset:4096
    ds_read_b64_tr_b16 v[28:29], v20 offset:4608
    ds_read_b64_tr_b16 v[30:31], v20 offset:8192
    ds_read_b64_tr_b16 v[32:33], v20 offset:8704
    ds_read_b64_tr_b16 v[34:35], v20 offset:12288
    ds_read_b64_tr_b16 v[36:37], v20 offset:12800
    s_and_b32 s36, s3, 3
    s_lshl_b32 s36, s36, 6
    s_lshr_b32 s37, s3, 2
    s_lshl_b32 s37, s37, 12
    s_add_u32 s36, s36, s37
    s_lshl_b32 s37, s28, 10
    s_add_u32 s36, s36, s37
    s_add_u32 s36, s36, 58720288
    v_and_b32 v9, 1, v1
    v_lshlrev_b32 v9, 4, v9
    v_lshl_add_u32 v9, v8, 8, v9
    s_waitcnt lgkmcnt(0)
    v_mfma_f32_16x16x32_bf16 v[10:13], v[22:25], v[160:163], 0
    v_mfma_f32_16x16x32_bf16 v[10:13], v[26:29], v[164:167], v[10:13]
    v_mfma_f32_16x16x32_bf16 v[10:13], v[30:33], v[168:171], v[10:13]
    v_mfma_f32_16x16x32_bf16 v[10:13], v[34:37], v[172:175], v[10:13]
    ds_read_b64_tr_b16 v[22:23], v20 offset:16384
    ds_read_b64_tr_b16 v[24:25], v20 offset:16896
    ds_read_b64_tr_b16 v[26:27], v20 offset:20480
    ds_read_b64_tr_b16 v[28:29], v20 offset:20992
    ds_read_b64_tr_b16 v[30:31], v20 offset:24576
    ds_read_b64_tr_b16 v[32:33], v20 offset:25088
    ds_read_b64_tr_b16 v[34:35], v20 offset:28672
    ds_read_b64_tr_b16 v[36:37], v20 offset:29184
    s_waitcnt lgkmcnt(0)
    v_mfma_f32_16x16x32_bf16 v[10:13], v[22:25], v[176:179], v[10:13]
    v_mfma_f32_16x16x32_bf16 v[10:13], v[26:29], v[180:183], v[10:13]
    v_mfma_f32_16x16x32_bf16 v[10:13], v[30:33], v[184:187], v[10:13]
    v_mfma_f32_16x16x32_bf16 v[10:13], v[34:37], v[188:191], v[10:13]
    s_nop 5
    s_mov_b32 exec_lo, 0x00030003
    s_mov_b32 exec_hi, 0x00030003
    buffer_store_dwordx4 v[10:13], v9, s[24:27], s36 offen sc1
    s_mov_b64 exec, -1
    s_nop 1
    s_branch L_recurrent_scan__compressed_kv_cla__moe_arch_mod__prompt_kernel_swend_76
L_recurrent_scan__compressed_kv_cla__moe_arch_mod__prompt_kernel_swn_80:
    s_mul_i32 s36, s3, 2341
    s_lshr_b32 s36, s36, 16
    s_add_u32 s36, s36, 48
    s_lshl_b32 s36, s36, 7
    v_mov_b32 v20, s36
    v_mov_b32 v21, 1
    s_mov_b64 exec, 1
    global_atomic_add v20, v21, s[90:91]
    s_mov_b64 exec, -1
    s_nop 3
L_recurrent_scan__compressed_kv_cla__moe_arch_mod__prompt_kernel_swend_76:
L_recurrent_scan__compressed_kv_cla__moe_arch_mod__prompt_kernel_swend_85:
    s_branch L_recurrent_scan__compressed_kv_cla__moe_arch_mod__prompt_kernel_back_90
L_recurrent_scan__compressed_kv_cla__moe_arch_mod__prompt_kernel_rare_99:
    v_mov_b32 v20, 4048155338
    v_subrev_u32 v21, s49, v18
    v_cmp_gt_i32 s[20:21], 0, v21
    v_cmp_gt_i32 s[22:23], 1, v21
    v_cmp_gt_i32 s[62:63], 2, v21
    v_cmp_gt_i32 vcc, 3, v21
    v_cndmask_b32 v112, v112, v20, s[20:21]
    v_cndmask_b32 v113, v113, v20, s[22:23]
    v_cndmask_b32 v114, v114, v20, s[62:63]
    v_cndmask_b32 v115, v115, v20, vcc
    v_cmp_gt_i32 s[20:21], 16, v21
    v_cmp_gt_i32 s[22:23], 17, v21
    v_cmp_gt_i32 s[62:63], 18, v21
    v_cmp_gt_i32 vcc, 19, v21
    v_cndmask_b32 v116, v116, v20, s[20:21]
    v_cndmask_b32 v117, v117, v20, s[22:23]
    v_cndmask_b32 v118, v118, v20, s[62:63]
    v_cndmask_b32 v119, v119, v20, vcc
    v_cmp_gt_i32 s[20:21], -16, v21
    v_cmp_gt_i32 s[22:23], -15, v21
    v_cmp_gt_i32 s[62:63], -14, v21
    v_cmp_gt_i32 vcc, -13, v21
    v_cndmask_b32 v120, v120, v20, s[20:21]
    v_cndmask_b32 v121, v121, v20, s[22:23]
    v_cndmask_b32 v122, v122, v20, s[62:63]
    v_cndmask_b32 v123, v123, v20, vcc
    v_cmp_gt_i32 s[20:21], 0, v21
    v_cmp_gt_i32 s[22:23], 1, v21
    v_cmp_gt_i32 s[62:63], 2, v21
    v_cmp_gt_i32 vcc, 3, v21
    v_cndmask_b32 v124, v124, v20, s[20:21]
    v_cndmask_b32 v125, v125, v20, s[22:23]
    v_cndmask_b32 v126, v126, v20, s[62:63]
    v_cndmask_b32 v127, v127, v20, vcc
    s_branch L_recurrent_scan__compressed_kv_cla__moe_arch_mod__prompt_kernel_back_100
L_recurrent_scan__compressed_kv_cla__moe_arch_mod__prompt_kernel_rare_103:
    s_mov_b32 s61, 0x40000
L_recurrent_scan__compressed_kv_cla__moe_arch_mod__prompt_kernel_spin_101:
    s_sub_u32 s61, s61, 1
    s_cbranch_scc1 L_recurrent_scan__compressed_kv_cla__moe_arch_mod__prompt_kernel_spinx_102
    s_sleep 8
    global_load_dword v11, v12, s[90:91] sc1
    s_waitcnt vmcnt(0)
    v_readfirstlane_b32 s36, v11
    s_nop 0
    s_cmp_lt_u32 s36, 28
    s_cbranch_scc1 L_recurrent_scan__compressed_kv_cla__moe_arch_mod__prompt_kernel_spin_101
L_recurrent_scan__compressed_kv_cla__moe_arch_mod__prompt_kernel_spinx_102:
    s_branch L_recurrent_scan__compressed_kv_cla__moe_arch_mod__prompt_kernel_back_104
L_recurrent_scan__compressed_kv_cla__moe_arch_mod__prompt_kernel_rare_108:
    v_mov_b32 v20, 4048155338
    v_subrev_u32 v21, s50, v18
    v_cmp_gt_i32 s[20:21], 0, v21
    v_cmp_gt_i32 s[22:23], 1, v21
    v_cmp_gt_i32 s[62:63], 2, v21
    v_cmp_gt_i32 vcc, 3, v21
    v_cndmask_b32 v96, v96, v20, s[20:21]
    v_cndmask_b32 v97, v97, v20, s[22:23]
    v_cndmask_b32 v98, v98, v20, s[62:63]
    v_cndmask_b32 v99, v99, v20, vcc
    v_cmp_gt_i32 s[20:21], 16, v21
    v_cmp_gt_i32 s[22:23], 17, v21
    v_cmp_gt_i32 s[62:63], 18, v21
    v_cmp_gt_i32 vcc, 19, v21
    v_cndmask_b32 v100, v100, v20, s[20:21]
    v_cndmask_b32 v101, v101, v20, s[22:23]
    v_cndmask_b32 v102, v102, v20, s[62:63]
    v_cndmask_b32 v103, v103, v20, vcc
    v_cmp_gt_i32 s[20:21], -16, v21
    v_cmp_gt_i32 s[22:23], -15, v21
    v_cmp_gt_i32 s[62:63], -14, v21
    v_cmp_gt_i32 vcc, -13, v21
    v_cndmask_b32 v104, v104, v20, s[20:21]
    v_cndmask_b32 v105, v105, v20, s[22:23]
    v_cndmask_b32 v106, v106, v20, s[62:63]
    v_cndmask_b32 v107, v107, v20, vcc
    v_cmp_gt_i32 s[20:21], 0, v21
    v_cmp_gt_i32 s[22:23], 1, v21
    v_cmp_gt_i32 s[62:63], 2, v21
    v_cmp_gt_i32 vcc, 3, v21
    v_cndmask_b32 v108, v108, v20, s[20:21]
    v_cndmask_b32 v109, v109, v20, s[22:23]
    v_cndmask_b32 v110, v110, v20, s[62:63]
    v_cndmask_b32 v111, v111, v20, vcc
    s_branch L_recurrent_scan__compressed_kv_cla__moe_arch_mod__prompt_kernel_back_109
L_grp1:
    v_mov_b32 v20, 1040356334
    s_and_b32 s37, s28, 3
    s_lshl_b32 s37, s37, 13
    v_lshlrev_b32 v7, 4, v1
    v_add_u32 v4, s37, v7
    v_add_u32 v6, 4096, v4
    v_add_u32 v19, 131072, v4
    s_mov_b32 s43, s37
    s_add_u32 s44, s37, 98304
    s_waitcnt vmcnt(4) lgkmcnt(0)
    v_pk_mul_f32 v[192:193], v[192:193], v[20:21] op_sel:[0,0] op_sel_hi:[1,0]
    v_pk_mul_f32 v[194:195], v[194:195], v[20:21] op_sel:[0,0] op_sel_hi:[1,0]
    v_pk_mul_f32 v[196:197], v[196:197], v[20:21] op_sel:[0,0] op_sel_hi:[1,0]
    v_pk_mul_f32 v[198:199], v[198:199], v[20:21] op_sel:[0,0] op_sel_hi:[1,0]
    v_cvt_pk_bf16_f32 v128, v192, v193
    v_cvt_pk_bf16_f32 v129, v194, v195
    v_cvt_pk_bf16_f32 v130, v196, v197
    v_cvt_pk_bf16_f32 v131, v198, v199
    v_pk_mul_f32 v[200:201], v[200:201], v[20:21] op_sel:[0,0] op_sel_hi:[1,0]
    v_pk_mul_f32 v[202:203], v[202:203], v[20:21] op_sel:[0,0] op_sel_hi:[1,0]
    v_pk_mul_f32 v[204:205], v[204:205], v[20:21] op_sel:[0,0] op_sel_hi:[1,0]
    v_pk_mul_f32 v[206:207], v[206:207], v[20:21] op_sel:[0,0] op_sel_hi:[1,0]
    v_cvt_pk_bf16_f32 v132, v200, v201
    v_cvt_pk_bf16_f32 v133, v202, v203
    v_cvt_pk_bf16_f32 v134, v204, v205
    v_cvt_pk_bf16_f32 v135, v206, v207
    v_pk_mul_f32 v[208:209], v[208:209], v[20:21] op_sel:[0,0] op_sel_hi:[1,0]
    v_pk_mul_f32 v[210:211], v[210:211], v[20:21] op_sel:[0,0] op_sel_hi:[1,0]
    v_pk_mul_f32 v[212:213], v[212:213], v[20:21] op_sel:[0,0] op_sel_hi:[1,0]
    v_pk_mul_f32 v[214:215], v[214:215], v[20:21] op_sel:[0,0] op_sel_hi:[1,0]
    v_cvt_pk_bf16_f32 v136, v208, v209
    v_cvt_pk_bf16_f32 v137, v210, v211
    v_cvt_pk_bf16_f32 v138, v212, v213
    v_cvt_pk_bf16_f32 v139, v214, v215
    v_pk_mul_f32 v[216:217], v[216:217], v[20:21] op_sel:[0,0] op_sel_hi:[1,0]
    v_pk_mul_f32 v[218:219], v[218:219], v[20:21] op_sel:[0,0] op_sel_hi:[1,0]
    v_pk_mul_f32 v[220:221], v[220:221], v[20:21] op_sel:[0,0] op_sel_hi:[1,0]
    v_pk_mul_f32 v[222:223], v[222:223], v[20:21] op_sel:[0,0] op_sel_hi:[1,0]
    v_cvt_pk_bf16_f32 v140, v216, v217
    v_cvt_pk_bf16_f32 v141, v218, v219
    v_cvt_pk_bf16_f32 v142, v220, v221
    v_cvt_pk_bf16_f32 v143, v222, v223
    v_pk_mul_f32 v[224:225], v[224:225], v[20:21] op_sel:[0,0] op_sel_hi:[1,0]
    v_pk_mul_f32 v[226:227], v[226:227], v[20:21] op_sel:[0,0] op_sel_hi:[1,0]
    v_pk_mul_f32 v[228:229], v[228:229], v[20:21] op_sel:[0,0] op_sel_hi:[1,0]
    v_pk_mul_f32 v[230:231], v[230:231], v[20:21] op_sel:[0,0] op_sel_hi:[1,0]
    v_cvt_pk_bf16_f32 v144, v224, v225
    v_cvt_pk_bf16_f32 v145, v226, v227
    v_cvt_pk_bf16_f32 v146, v228, v229
    v_cvt_pk_bf16_f32 v147, v230, v231
    v_pk_mul_f32 v[232:233], v[232:233], v[20:21] op_sel:[0,0] op_sel_hi:[1,0]
    v_pk_mul_f32 v[234:235], v[234:235], v[20:21] op_sel:[0,0] op_sel_hi:[1,0]
    v_pk_mul_f32 v[236:237], v[236:237], v[20:21] op_sel:[0,0] op_sel_hi:[1,0]
    v_pk_mul_f32 v[238:239], v[238:239], v[20:21] op_sel:[0,0] op_sel_hi:[1,0]
    v_cvt_pk_bf16_f32 v148, v232, v233
    v_cvt_pk_bf16_f32 v149, v234, v235
    v_cvt_pk_bf16_f32 v150, v236, v237
    v_cvt_pk_bf16_f32 v151, v238, v239
    v_pk_mul_f32 v[240:241], v[240:241], v[20:21] op_sel:[0,0] op_sel_hi:[1,0]
    v_pk_mul_f32 v[242:243], v[242:243], v[20:21] op_sel:[0,0] op_sel_hi:[1,0]
    v_pk_mul_f32 v[244:245], v[244:245], v[20:21] op_sel:[0,0] op_sel_hi:[1,0]
    v_pk_mul_f32 v[246:247], v[246:247], v[20:21] op_sel:[0,0] op_sel_hi:[1,0]
    v_cvt_pk_bf16_f32 v152, v240, v241
    v_cvt_pk_bf16_f32 v153, v242, v243
    v_cvt_pk_bf16_f32 v154, v244, v245
    v_cvt_pk_bf16_f32 v155, v246, v247
    v_pk_mul_f32 v[248:249], v[248:249], v[20:21] op_sel:[0,0] op_sel_hi:[1,0]
    v_pk_mul_f32 v[250:251], v[250:251], v[20:21] op_sel:[0,0] op_sel_hi:[1,0]
    v_pk_mul_f32 v[252:253], v[252:253], v[20:21] op_sel:[0,0] op_sel_hi:[1,0]
    v_pk_mul_f32 v[254:255], v[254:255], v[20:21] op_sel:[0,0] op_sel_hi:[1,0]
    v_cvt_pk_bf16_f32 v156, v248, v249
    v_cvt_pk_bf16_f32 v157, v250, v251
    v_cvt_pk_bf16_f32 v158, v252, v253
    v_cvt_pk_bf16_f32 v159, v254, v255
    v_mov_b32 v2, v7
    v_and_b32 v21, 15, v1
    v_lshrrev_b32 v22, 4, v1
    v_lshlrev_b32 v22, 2, v22
    v_sub_u32 v18, v21, v22
    s_mov_b32 s40, 0
    s_mov_b32 s41, 0
    s_lshl_b32 s51, s30, 1
    s_add_u32 s51, s51, 1
    s_and_b32 s36, s28, 3
    s_lshl_b32 s36, s36, 5
    s_lshl_b32 s37, s30, 7
    s_add_u32 s36, s36, s37
    s_sub_u32 s50, 0, s36
    s_lshl_b32 s42, s30, 8
    s_sub_u32 s42, s42, 1792
    s_mov_b64 s[52:53], 0
    s_mov_b32 s31, 0x3f803f80
    s_waitcnt lgkmcnt(0)
    s_barrier
    ds_read_b128 v[160:163], v19 offset:0
    ds_read_b128 v[164:167], v19 offset:1024
    ds_read_b128 v[168:171], v19 offset:2048
    ds_read_b128 v[172:175], v19 offset:3072
    ds_read_b128 v[176:179], v19 offset:4096
    ds_read_b128 v[180:183], v19 offset:5120
    ds_read_b128 v[184:187], v19 offset:6144
    ds_read_b128 v[188:191], v19 offset:7168
    s_add_u32 s16, s54, 41943040
    s_addc_u32 s17, s55, 0
    s_and_b32 s17, s17, 0xffff
    s_mov_b32 s18, 16777216
    s_mov_b32 s19, 0x20000
    s_cmp_eq_u32 s28, 4
    s_cbranch_scc1 L_recurrent_scan__compressed_kv_cla__moe_arch_mod__prompt_kernel_rare_110
L_recurrent_scan__compressed_kv_cla__moe_arch_mod__prompt_kernel_back_111:
    s_sub_u32 s36, s2, 128
    s_lshl_b32 s36, s36, 2
    s_and_b32 s37, s28, 3
    s_add_u32 s36, s36, s37
    s_lshl_b32 s36, s36, 14
    v_lshl_add_u32 v13, v1, 7, s36
    s_cmp_ge_u32 s2, 128
    s_cselect_b32 s39, 510, 2
    ds_read_b128 v[64:67], v2 offset:0
    ds_read_b128 v[68:71], v2 offset:1024
    ds_read_b128 v[72:75], v2 offset:2048
    ds_read_b128 v[76:79], v2 offset:3072
    ds_read_b128 v[80:83], v2 offset:4096
    ds_read_b128 v[84:87], v2 offset:5120
    ds_read_b128 v[88:91], v2 offset:6144
    ds_read_b128 v[92:95], v2 offset:7168
    s_waitcnt lgkmcnt(7)
    v_mfma_f32_16x16x32_bf16 v[96:99], v[64:67], v[128:131], 0
    v_mov_b64 v[192:193], 0
    v_mov_b64 v[194:195], 0
    v_mfma_f32_16x16x32_bf16 v[104:107], v[64:67], v[144:147], 0
    ds_read_b128 v[64:67], v2 offset:8192
    v_mov_b64 v[196:197], 0
    s_waitcnt lgkmcnt(7)
    v_mfma_f32_16x16x32_bf16 v[96:99], v[68:71], v[132:135], v[96:99]
    v_mov_b64 v[198:199], 0
    v_mfma_f32_16x16x32_bf16 v[104:107], v[68:71], v[148:151], v[104:107]
    ds_read_b128 v[68:71], v2 offset:9216
    v_mov_b64 v[200:201], 0
    s_waitcnt lgkmcnt(7)
    v_mfma_f32_16x16x32_bf16 v[96:99], v[72:75], v[136:139], v[96:99]
    v_mov_b64 v[202:203], 0
    v_mfma_f32_16x16x32_bf16 v[104:107], v[72:75], v[152:155], v[104:107]
    ds_read_b128 v[72:75], v2 offset:10240
    v_mov_b64 v[204:205], 0
    s_waitcnt lgkmcnt(7)
    v_mfma_f32_16x16x32_bf16 v[96:99], v[76:79], v[140:143], v[96:99]
    v_mov_b64 v[206:207], 0
    v_mfma_f32_16x16x32_bf16 v[104:107], v[76:79], v[156:159], v[104:107]
    ds_read_b128 v[76:79], v2 offset:11264
    v_mov_b64 v[208:209], 0
    s_waitcnt lgkmcnt(7)
    v_mfma_f32_16x16x32_bf16 v[100:103], v[80:83], v[128:131], 0
    v_mov_b64 v[210:211], 0
    v_mfma_f32_16x16x32_bf16 v[108:111], v[80:83], v[144:147], 0
    ds_read_b128 v[80:83], v2 offset:12288
    v_mov_b64 v[212:213], 0
    s_waitcnt lgkmcnt(7)
    v_mfma_f32_16x16x32_bf16 v[100:103], v[84:87], v[132:135], v[100:103]
    v_mov_b64 v[214:215], 0
    v_mfma_f32_16x16x32_bf16 v[108:111], v[84:87], v[148:151], v[108:111]
    ds_read_b128 v[84:87], v2 offset:13312
    v_mov_b64 v[216:217], 0
    s_waitcnt lgkmcnt(7)
    v_mfma_f32_16x16x32_bf16 v[100:103], v[88:91], v[136:139], v[100:103]
    v_mov_b64 v[218:219], 0
    v_mfma_f32_16x16x32_bf16 v[108:111], v[88:91], v[152:155], v[108:111]
    ds_read_b128 v[88:91], v2 offset:14336
    v_mov_b64 v[220:221], 0
    s_waitcnt lgkmcnt(7)
    v_mfma_f32_16x16x32_bf16 v[100:103], v[92:95], v[140:143], v[100:103]
    v_mov_b64 v[222:223], 0
    v_mfma_f32_16x16x32_bf16 v[108:111], v[92:95], v[156:159], v[108:111]
    ds_read_b128 v[92:95], v2 offset:15360
    v_mov_b64 v[224:225], 0
    s_waitcnt lgkmcnt(7)
    v_mfma_f32_16x16x32_bf16 v[112:115], v[64:67], v[128:131], 0
    v_mov_b64 v[226:227], 0
    v_mfma_f32_16x16x32_bf16 v[120:123], v[64:67], v[144:147], 0
    v_mov_b64 v[228:229], 0
    s_waitcnt lgkmcnt(6)
    v_mfma_f32_16x16x32_bf16 v[112:115], v[68:71], v[132:135], v[112:115]
    v_mov_b64 v[230:231], 0
    v_mfma_f32_16x16x32_bf16 v[120:123], v[68:71], v[148:151], v[120:123]
    v_mov_b64 v[232:233], 0
    s_waitcnt lgkmcnt(5)
    v_mfma_f32_16x16x32_bf16 v[112:115], v[72:75], v[136:139], v[112:115]
    v_mov_b64 v[234:235], 0
    v_mfma_f32_16x16x32_bf16 v[120:123], v[72:75], v[152:155], v[120:123]
    v_mov_b64 v[236:237], 0
    s_waitcnt lgkmcnt(4)
    v_mfma_f32_16x16x32_bf16 v[112:115], v[76:79], v[140:143], v[112:115]
    v_mov_b64 v[238:239], 0
    v_mfma_f32_16x16x32_bf16 v[120:123], v[76:79], v[156:159], v[120:123]
    v_mov_b64 v[240:241], 0
    s_waitcnt lgkmcnt(3)
    v_mfma_f32_16x16x32_bf16 v[116:119], v[80:83], v[128:131], 0
    v_mov_b64 v[242:243], 0
    v_mfma_f32_16x16x32_bf16 v[124:127], v[80:83], v[144:147], 0
    v_mov_b64 v[244:245], 0
    s_waitcnt lgkmcnt(2)
    v_mfma_f32_16x16x32_bf16 v[116:119], v[84:87], v[132:135], v[116:119]
    v_mov_b64 v[246:247], 0
    v_mfma_f32_16x16x32_bf16 v[124:127], v[84:87], v[148:151], v[124:127]
    v_mov_b64 v[248:249], 0
    s_waitcnt lgkmcnt(1)
    v_mfma_f32_16x16x32_bf16 v[116:119], v[88:91], v[136:139], v[116:119]
    v_mov_b64 v[250:251], 0
    v_mfma_f32_16x16x32_bf16 v[124:127], v[88:91], v[152:155], v[124:127]
    v_mov_b64 v[252:253], 0
    s_waitcnt lgkmcnt(0)
    v_mfma_f32_16x16x32_bf16 v[116:119], v[92:95], v[140:143], v[116:119]
    v_mov_b64 v[254:255], 0
    v_mfma_f32_16x16x32_bf16 v[124:127], v[92:95], v[156:159], v[124:127]
    v_mov_b64 v[38:39], 0
    s_cmp_lt_i32 s50, 0
    s_cbranch_scc0 L_recurrent_scan__compressed_kv_cla__moe_arch_mod__prompt_kernel_rare_112
L_recurrent_scan__compressed_kv_cla__moe_arch_mod__prompt_kernel_back_113:
    s_add_u32 s49, s50, 32
    v_add_u32 v24, 65536, v2
    s_cmp_lt_u32 s40, s51
    s_cselect_b32 s36, 64, 128
    s_add_u32 s41, s41, s36
    s_cmp_eq_u32 s40, s51
    s_cselect_b32 s36, s42, s36
    s_add_u32 s50, s50, s36
    s_and_b32 s36, s41, 0xff
    v_lshl_add_u32 v2, s36, 8, v7
    s_cmp_eq_u32 s40, 16
    s_cselect_b64 s[20:21], -1, 0
    v_cndmask_b32 v5, v2, v24, s[20:21]
    v_mov_b32 v3, v24
    s_waitcnt vmcnt(1)
    s_cmp_eq_u32 s28, 4
    s_cbranch_scc1 L_recurrent_scan__compressed_kv_cla__moe_arch_mod__prompt_kernel_pw_114
    s_waitcnt vmcnt(0)
L_recurrent_scan__compressed_kv_cla__moe_arch_mod__prompt_kernel_pw_114:
    s_barrier
    ds_read_b128 v[64:67], v5 offset:0
    ds_read_b128 v[68:71], v5 offset:1024
    ds_read_b128 v[72:75], v5 offset:2048
    ds_read_b128 v[76:79], v5 offset:3072
    ds_read_b128 v[80:83], v5 offset:4096
    ds_read_b128 v[84:87], v5 offset:5120
    ds_read_b128 v[88:91], v5 offset:6144
    v_max3_f32 v21, v96, v97, v98
    v_max3_f32 v21, v21, v99, v100
    v_max3_f32 v21, v21, v101, v102
    v_max_f32 v21, v21, v103
    v_max3_f32 v22, v104, v105, v106
    v_max3_f32 v22, v22, v107, v108
    v_max3_f32 v22, v22, v109, v110
    v_max_f32 v22, v22, v111
    v_mov_b32 v23, v21
    s_nop 1
    v_permlane16_swap_b32 v21, v23
    s_nop 1
    v_max_f32 v21, v21, v23
    v_mov_b32 v23, v21
    s_nop 1
    v_permlane32_swap_b32 v21, v23
    s_nop 1
    v_max_f32 v21, v21, v23
    v_mov_b32 v23, v22
    s_nop 1
    v_permlane16_swap_b32 v22, v23
    s_nop 1
    v_max_f32 v22, v22, v23
    v_mov_b32 v23, v22
    s_nop 1
    v_permlane32_swap_b32 v22, v23
    s_nop 1
    v_max_f32 v22, v22, v23
    v_sub_f32 v40, 0, v21
    v_sub_f32 v41, 0, v21
    v_sub_f32 v42, 0, v21
    v_sub_f32 v43, 0, v21
    v_sub_f32 v44, 0, v22
    v_sub_f32 v45, 0, v22
    v_sub_f32 v46, 0, v22
    v_sub_f32 v47, 0, v22
    v_pk_add_f32 v[96:97], v[96:97], v[40:41]
    v_pk_add_f32 v[98:99], v[98:99], v[40:41]
    v_pk_add_f32 v[100:101], v[100:101], v[40:41]
    v_pk_add_f32 v[102:103], v[102:103], v[40:41]
    v_pk_add_f32 v[104:105], v[104:105], v[44:45]
    v_pk_add_f32 v[106:107], v[106:107], v[44:45]
    v_pk_add_f32 v[108:109], v[108:109], v[44:45]
    v_pk_add_f32 v[110:111], v[110:111], v[44:45]
    v_pk_add_f32 v[112:113], v[112:113], v[40:41]
    v_pk_add_f32 v[114:115], v[114:115], v[40:41]
    v_pk_add_f32 v[116:117], v[116:117], v[40:41]
    v_pk_add_f32 v[118:119], v[118:119], v[40:41]
    v_pk_add_f32 v[120:121], v[120:121], v[44:45]
    v_pk_add_f32 v[122:123], v[122:123], v[44:45]
    v_pk_add_f32 v[124:125], v[124:125], v[44:45]
    v_pk_add_f32 v[126:127], v[126:127], v[44:45]
    v_exp_f32 v96, v96
    v_exp_f32 v97, v97
    v_add_f32 v38, v38, v96
    v_exp_f32 v98, v98
    v_add_f32 v38, v38, v97
    v_cvt_pk_bf16_f32 v48, v96, v97
    v_exp_f32 v99, v99
    v_add_f32 v38, v38, v98
    v_exp_f32 v104, v104
    v_add_f32 v38, v38, v99
    v_cvt_pk_bf16_f32 v49, v98, v99
    v_exp_f32 v105, v105
    v_add_f32 v39, v39, v104
    v_exp_f32 v106, v106
    v_add_f32 v39, v39, v105
    v_cvt_pk_bf16_f32 v52, v104, v105
    v_exp_f32 v107, v107
    v_add_f32 v39, v39, v106
    v_exp_f32 v100, v100
    v_add_f32 v39, v39, v107
    v_cvt_pk_bf16_f32 v53, v106, v107
    v_exp_f32 v101, v101
    v_add_f32 v38, v38, v100
    v_exp_f32 v102, v102
    v_add_f32 v38, v38, v101
    v_cvt_pk_bf16_f32 v50, v100, v101
    v_exp_f32 v103, v103
    v_add_f32 v38, v38, v102
    v_exp_f32 v108, v108
    v_add_f32 v38, v38, v103
    v_cvt_pk_bf16_f32 v51, v102, v103
    v_exp_f32 v109, v109
    v_add_f32 v39, v39, v108
    v_exp_f32 v110, v110
    v_add_f32 v39, v39, v109
    v_cvt_pk_bf16_f32 v54, v108, v109
    v_exp_f32 v111, v111
    v_add_f32 v39, v39, v110
    s_nop 0
    v_add_f32 v39, v39, v111
    v_cvt_pk_bf16_f32 v55, v110, v111
    .p2align 6
L_body1:
    s_cmp_lt_i32 s49, 0
    s_cbranch_scc0 L_recurrent_scan__compressed_kv_cla__moe_arch_mod__prompt_kernel_rare_115
L_recurrent_scan__compressed_kv_cla__moe_arch_mod__prompt_kernel_back_116:
    s_waitcnt lgkmcnt(3)
    v_mfma_f32_16x16x32_bf16 v[96:99], v[64:67], v[128:131], v[40:43]
    v_exp_f32 v112, v112
    v_mfma_f32_16x16x32_bf16 v[104:107], v[64:67], v[144:147], v[44:47]
    ds_read_b128 v[92:95], v2 offset:7168
    v_mfma_f32_16x16x32_bf16 v[96:99], v[68:71], v[132:135], v[96:99]
    v_exp_f32 v113, v113
    v_mfma_f32_16x16x32_bf16 v[104:107], v[68:71], v[148:151], v[104:107]
    ds_read_b128 v[64:67], v3 offset:0
    v_add_f32 v38, v38, v112
    v_mfma_f32_16x16x32_bf16 v[96:99], v[72:75], v[136:139], v[96:99]
    v_exp_f32 v114, v114
    v_mfma_f32_16x16x32_bf16 v[104:107], v[72:75], v[152:155], v[104:107]
    ds_read_b128 v[68:71], v3 offset:1024
    v_add_f32 v38, v38, v113
    v_cvt_pk_bf16_f32 v56, v112, v113
    v_mfma_f32_16x16x32_bf16 v[96:99], v[76:79], v[140:143], v[96:99]
    v_exp_f32 v115, v115
    v_mfma_f32_16x16x32_bf16 v[104:107], v[76:79], v[156:159], v[104:107]
    ds_read_b128 v[72:75], v3 offset:2048
    v_add_f32 v38, v38, v114
    s_waitcnt lgkmcnt(3)
    v_mfma_f32_16x16x32_bf16 v[100:103], v[80:83], v[128:131], v[40:43]
    v_exp_f32 v120, v120
    v_mfma_f32_16x16x32_bf16 v[108:111], v[80:83], v[144:147], v[44:47]
    ds_read_b128 v[76:79], v3 offset:3072
    v_add_f32 v38, v38, v115
    v_cvt_pk_bf16_f32 v57, v114, v115
    v_mfma_f32_16x16x32_bf16 v[100:103], v[84:87], v[132:135], v[100:103]
    v_exp_f32 v121, v121
    v_mfma_f32_16x16x32_bf16 v[108:111], v[84:87], v[148:151], v[108:111]
    ds_read_b128 v[80:83], v3 offset:4096
    v_add_f32 v39, v39, v120
    v_mfma_f32_16x16x32_bf16 v[100:103], v[88:91], v[136:139], v[100:103]
    v_exp_f32 v122, v122
    v_mfma_f32_16x16x32_bf16 v[108:111], v[88:91], v[152:155], v[108:111]
    ds_read_b128 v[84:87], v3 offset:5120
    v_add_f32 v39, v39, v121
    v_cvt_pk_bf16_f32 v60, v120, v121
    v_mfma_f32_16x16x32_bf16 v[100:103], v[92:95], v[140:143], v[100:103]
    v_exp_f32 v123, v123
    v_mfma_f32_16x16x32_bf16 v[108:111], v[92:95], v[156:159], v[108:111]
    ds_read_b128 v[88:91], v3 offset:6144
    v_add_f32 v39, v39, v122
    s_waitcnt lgkmcnt(3)
    v_mfma_f32_16x16x32_bf16 v[192:195], v[64:67], v[48:51], v[192:195]
    v_exp_f32 v116, v116
    v_mfma_f32_16x16x32_bf16 v[224:227], v[64:67], v[52:55], v[224:227]
    ds_read_b128 v[92:95], v3 offset:7168
    v_add_f32 v39, v39, v123
    v_cvt_pk_bf16_f32 v61, v122, v123
    v_mfma_f32_16x16x32_bf16 v[196:199], v[68:71], v[48:51], v[196:199]
    v_exp_f32 v117, v117
    v_mfma_f32_16x16x32_bf16 v[228:231], v[68:71], v[52:55], v[228:231]
    ds_read_b128 v[64:67], v2 offset:8192
    v_add_f32 v38, v38, v116
    v_mfma_f32_16x16x32_bf16 v[200:203], v[72:75], v[48:51], v[200:203]
    v_exp_f32 v118, v118
    v_mfma_f32_16x16x32_bf16 v[232:235], v[72:75], v[52:55], v[232:235]
    ds_read_b128 v[68:71], v2 offset:9216
    v_add_f32 v38, v38, v117
    v_cvt_pk_bf16_f32 v58, v116, v117
    v_mfma_f32_16x16x32_bf16 v[204:207], v[76:79], v[48:51], v[204:207]
    v_exp_f32 v119, v119
    v_mfma_f32_16x16x32_bf16 v[236:239], v[76:79], v[52:55], v[236:239]
    ds_read_b128 v[72:75], v2 offset:10240
    v_add_f32 v38, v38, v118
    s_waitcnt lgkmcnt(3)
    v_mfma_f32_16x16x32_bf16 v[208:211], v[80:83], v[48:51], v[208:211]
    v_exp_f32 v124, v124
    v_mfma_f32_16x16x32_bf16 v[240:243], v[80:83], v[52:55], v[240:243]
    ds_read_b128 v[76:79], v2 offset:11264
    v_add_f32 v38, v38, v119
    v_cvt_pk_bf16_f32 v59, v118, v119
    v_mfma_f32_16x16x32_bf16 v[212:215], v[84:87], v[48:51], v[212:215]
    v_exp_f32 v125, v125
    v_mfma_f32_16x16x32_bf16 v[244:247], v[84:87], v[52:55], v[244:247]
    ds_read_b128 v[80:83], v2 offset:12288
    v_add_f32 v39, v39, v124
    v_mfma_f32_16x16x32_bf16 v[216:219], v[88:91], v[48:51], v[216:219]
    v_exp_f32 v126, v126
    v_mfma_f32_16x16x32_bf16 v[248:251], v[88:91], v[52:55], v[248:251]
    ds_read_b128 v[84:87], v2 offset:13312
    v_add_f32 v39, v39, v125
    v_cvt_pk_bf16_f32 v62, v124, v125
    v_mfma_f32_16x16x32_bf16 v[220:223], v[92:95], v[48:51], v[220:223]
    v_exp_f32 v127, v127
    v_mfma_f32_16x16x32_bf16 v[252:255], v[92:95], v[52:55], v[252:255]
    ds_read_b128 v[88:91], v2 offset:14336
    v_add_f32 v39, v39, v126
    v_add_f32 v39, v39, v127
    v_cvt_pk_bf16_f32 v63, v126, v127
    s_cmp_eq_u32 s40, s51
    s_cbranch_scc1 L_recurrent_scan__compressed_kv_cla__moe_arch_mod__prompt_kernel_rare_117
L_recurrent_scan__compressed_kv_cla__moe_arch_mod__prompt_kernel_back_118:
    s_cmp_lt_i32 s50, 0
    s_cbranch_scc0 L_recurrent_scan__compressed_kv_cla__moe_arch_mod__prompt_kernel_rare_119
L_recurrent_scan__compressed_kv_cla__moe_arch_mod__prompt_kernel_back_120:
    s_waitcnt lgkmcnt(3)
    v_mfma_f32_16x16x32_bf16 v[112:115], v[64:67], v[128:131], v[40:43]
    v_exp_f32 v96, v96
    v_mfma_f32_16x16x32_bf16 v[120:123], v[64:67], v[144:147], v[44:47]
    ds_read_b128 v[92:95], v2 offset:15360
    v_mfma_f32_16x16x32_bf16 v[112:115], v[68:71], v[132:135], v[112:115]
    v_exp_f32 v97, v97
    s_add_u32 s40, s40, 1
    v_mfma_f32_16x16x32_bf16 v[120:123], v[68:71], v[148:151], v[120:123]
    ds_read_b128 v[64:67], v3 offset:8192
    v_add_f32 v38, v38, v96
    s_add_u32 s49, s50, 32
    v_add_u32 v24, 65536, v2
    v_mfma_f32_16x16x32_bf16 v[112:115], v[72:75], v[136:139], v[112:115]
    v_exp_f32 v98, v98
    v_mfma_f32_16x16x32_bf16 v[120:123], v[72:75], v[152:155], v[120:123]
    ds_read_b128 v[68:71], v3 offset:9216
    v_add_f32 v38, v38, v97
    v_cvt_pk_bf16_f32 v48, v96, v97
    s_cmp_lt_u32 s40, s51
    s_cselect_b32 s36, 64, 128
    v_mfma_f32_16x16x32_bf16 v[112:115], v[76:79], v[140:143], v[112:115]
    v_exp_f32 v99, v99
    v_mfma_f32_16x16x32_bf16 v[120:123], v[76:79], v[156:159], v[120:123]
    ds_read_b128 v[72:75], v3 offset:10240
    v_add_f32 v38, v38, v98
    s_add_u32 s41, s41, s36
    s_waitcnt lgkmcnt(3)
    v_mfma_f32_16x16x32_bf16 v[116:119], v[80:83], v[128:131], v[40:43]
    v_exp_f32 v104, v104
    v_mfma_f32_16x16x32_bf16 v[124:127], v[80:83], v[144:147], v[44:47]
    ds_read_b128 v[76:79], v3 offset:11264
    v_add_f32 v38, v38, v99
    v_cvt_pk_bf16_f32 v49, v98, v99
    s_cmp_eq_u32 s40, s51
    s_cselect_b32 s36, s42, s36
    v_mfma_f32_16x16x32_bf16 v[116:119], v[84:87], v[132:135], v[116:119]
    v_exp_f32 v105, v105
    v_mfma_f32_16x16x32_bf16 v[124:127], v[84:87], v[148:151], v[124:127]
    ds_read_b128 v[80:83], v3 offset:12288
    v_add_f32 v39, v39, v104
    s_add_u32 s50, s50, s36
    v_mfma_f32_16x16x32_bf16 v[116:119], v[88:91], v[136:139], v[116:119]
    v_exp_f32 v106, v106
    v_mfma_f32_16x16x32_bf16 v[124:127], v[88:91], v[152:155], v[124:127]
    ds_read_b128 v[84:87], v3 offset:13312
    v_add_f32 v39, v39, v105
    v_cvt_pk_bf16_f32 v52, v104, v105
    s_and_b32 s36, s41, 0xff
    v_lshl_add_u32 v2, s36, 8, v7
    v_mfma_f32_16x16x32_bf16 v[116:119], v[92:95], v[140:143], v[116:119]
    v_exp_f32 v107, v107
    v_mfma_f32_16x16x32_bf16 v[124:127], v[92:95], v[156:159], v[124:127]
    ds_read_b128 v[88:91], v3 offset:14336
    v_add_f32 v39, v39, v106
    s_cmp_eq_u32 s40, 16
    s_cselect_b64 s[20:21], -1, 0
    s_waitcnt lgkmcnt(3)
    v_mfma_f32_16x16x32_bf16 v[192:195], v[64:67], v[56:59], v[192:195]
    v_exp_f32 v100, v100
    v_mfma_f32_16x16x32_bf16 v[224:227], v[64:67], v[60:63], v[224:227]
    ds_read_b128 v[92:95], v3 offset:15360
    v_add_f32 v39, v39, v107
    v_cvt_pk_bf16_f32 v53, v106, v107
    v_cndmask_b32 v5, v2, v24, s[20:21]
    v_mfma_f32_16x16x32_bf16 v[196:199], v[68:71], v[56:59], v[196:199]
    v_exp_f32 v101, v101
    v_mfma_f32_16x16x32_bf16 v[228:231], v[68:71], v[60:63], v[228:231]
    v_add_f32 v38, v38, v100
    v_mov_b32 v3, v24
    v_mfma_f32_16x16x32_bf16 v[200:203], v[72:75], v[56:59], v[200:203]
    v_exp_f32 v102, v102
    v_mfma_f32_16x16x32_bf16 v[232:235], v[72:75], v[60:63], v[232:235]
    v_add_f32 v38, v38, v101
    v_cvt_pk_bf16_f32 v50, v100, v101
    s_waitcnt lgkmcnt(0)
    s_barrier
    v_mfma_f32_16x16x32_bf16 v[204:207], v[76:79], v[56:59], v[204:207]
    v_exp_f32 v103, v103
    v_mfma_f32_16x16x32_bf16 v[236:239], v[76:79], v[60:63], v[236:239]
    ds_read_b128 v[68:71], v5 offset:1024
    ds_read_b128 v[64:67], v5 offset:0
    v_add_f32 v38, v38, v102
    v_mfma_f32_16x16x32_bf16 v[208:211], v[80:83], v[56:59], v[208:211]
    v_exp_f32 v108, v108
    v_mfma_f32_16x16x32_bf16 v[240:243], v[80:83], v[60:63], v[240:243]
    ds_read_b128 v[76:79], v5 offset:3072
    ds_read_b128 v[72:75], v5 offset:2048
    v_add_f32 v38, v38, v103
    v_cvt_pk_bf16_f32 v51, v102, v103
    v_mfma_f32_16x16x32_bf16 v[212:215], v[84:87], v[56:59], v[212:215]
    v_exp_f32 v109, v109
    v_mfma_f32_16x16x32_bf16 v[244:247], v[84:87], v[60:63], v[244:247]
    ds_read_b128 v[80:83], v5 offset:4096
    v_add_f32 v39, v39, v108
    v_mfma_f32_16x16x32_bf16 v[216:219], v[88:91], v[56:59], v[216:219]
    v_exp_f32 v110, v110
    v_mfma_f32_16x16x32_bf16 v[248:251], v[88:91], v[60:63], v[248:251]
    ds_read_b128 v[84:87], v5 offset:5120
    v_add_f32 v39, v39, v109
    v_cvt_pk_bf16_f32 v54, v108, v109
    v_mfma_f32_16x16x32_bf16 v[220:223], v[92:95], v[56:59], v[220:223]
    v_exp_f32 v111, v111
    v_mfma_f32_16x16x32_bf16 v[252:255], v[92:95], v[60:63], v[252:255]
    ds_read_b128 v[88:91], v5 offset:6144
    v_add_f32 v39, v39, v110
    v_add_f32 v39, v39, v111
    v_cvt_pk_bf16_f32 v55, v110, v111
    s_bitcmp1_b32 s39, s40
    s_cbranch_scc1 L_recurrent_scan__compressed_kv_cla__moe_arch_mod__prompt_kernel_rare_137
L_recurrent_scan__compressed_kv_cla__moe_arch_mod__prompt_kernel_back_138:
    s_sub_u32 s36, s40, s51
    s_cmp_lt_u32 s36, 2
    s_cbranch_scc1 L_recurrent_scan__compressed_kv_cla__moe_arch_mod__prompt_kernel_rare_124
L_recurrent_scan__compressed_kv_cla__moe_arch_mod__prompt_kernel_back_125:
    s_cmp_lg_u32 s40, 16
    s_cbranch_scc1 L_body1
    s_mov_b32 s4, s34
    s_and_b32 s5, s35, 0xffff
    s_mov_b32 s6, 7340032
    s_mov_b32 s7, 0x20000
    s_mov_b32 s8, s32
    s_and_b32 s9, s33, 0xffff
    s_mov_b32 s10, 8388608
    s_mov_b32 s11, 0x20000
    s_lshr_b32 s38, s2, 4
    s_mul_i32 s38, s38, 224
    s_and_b32 s39, s2, 15
    s_lshl_b32 s39, s39, 7
    v_lshrrev_b32 v27, 3, v1
    s_lshl_b32 s36, s28, 5
    s_add_u32 s36, s36, s38
    v_add_u32 v27, s36, v27
    v_mul_u32_u24 v27, 2048, v27
    v_add_u32 v27, s39, v27
    v_bfe_u32 v28, v1, 4, 1
    v_lshlrev_b32 v28, 1, v28
    v_and_b32 v29, 7, v1
    v_xor_b32 v28, v28, v29
    v_lshl_add_u32 v26, v28, 4, v27
    v_xor_b32 v28, 4, v28
    v_lshl_add_u32 v27, v28, 4, v27
    v_add_u32 v27, 15360, v27
    v_add_u32 v28, 30720, v26
    v_add_u32 v29, 30720, v27
    s_lshl_b32 s36, s28, 12
    s_add_u32 s36, s36, 131072
    s_cmp_lt_u32 s28, 7
    s_cselect_b32 m0, s36, 0x30000
    s_cselect_b32 s6, 7340032, 0
    buffer_load_dwordx4 v26, s[4:7], 0 offen offset:0 lds
    buffer_load_dwordx4 v27, s[4:7], 0 offen offset:1024 lds
    buffer_load_dwordx4 v28, s[4:7], 0 offen offset:2048 lds
    buffer_load_dwordx4 v29, s[4:7], 0 offen offset:3072 lds
    s_lshr_b32 s36, s2, 5
    s_add_u32 s36, s36, 48
    s_lshl_b32 s36, s36, 7
    v_mov_b32 v12, s36
    global_load_dword v11, v12, s[90:91] sc1
    s_cmp_lt_i32 s49, 0
    s_cbranch_scc0 L_recurrent_scan__compressed_kv_cla__moe_arch_mod__prompt_kernel_rare_122
L_recurrent_scan__compressed_kv_cla__moe_arch_mod__prompt_kernel_back_123:
    s_waitcnt lgkmcnt(5)
    v_mfma_f32_16x16x32_bf16 v[192:195], v[64:67], v[48:51], v[192:195]
    v_exp_f32 v112, v112
    v_mfma_f32_16x16x32_bf16 v[224:227], v[64:67], v[52:55], v[224:227]
    ds_read_b128 v[92:95], v3 offset:7168
    v_add_f32 v38, v38, v112
    v_exp_f32 v113, v113
    v_mfma_f32_16x16x32_bf16 v[196:199], v[68:71], v[48:51], v[196:199]
    v_add_f32 v38, v38, v113
    v_cvt_pk_bf16_f32 v56, v112, v113
    v_exp_f32 v114, v114
    v_mfma_f32_16x16x32_bf16 v[228:231], v[68:71], v[52:55], v[228:231]
    ds_read_b128 v[64:67], v3 offset:8192
    v_add_f32 v38, v38, v114
    v_exp_f32 v115, v115
    s_waitcnt lgkmcnt(5)
    v_mfma_f32_16x16x32_bf16 v[200:203], v[72:75], v[48:51], v[200:203]
    v_add_f32 v38, v38, v115
    v_cvt_pk_bf16_f32 v57, v114, v115
    v_exp_f32 v120, v120
    v_mfma_f32_16x16x32_bf16 v[232:235], v[72:75], v[52:55], v[232:235]
    ds_read_b128 v[68:71], v3 offset:9216
    v_add_f32 v39, v39, v120
    v_exp_f32 v121, v121
    v_mfma_f32_16x16x32_bf16 v[204:207], v[76:79], v[48:51], v[204:207]
    v_add_f32 v39, v39, v121
    v_cvt_pk_bf16_f32 v60, v120, v121
    v_exp_f32 v122, v122
    v_mfma_f32_16x16x32_bf16 v[236:239], v[76:79], v[52:55], v[236:239]
    ds_read_b128 v[72:75], v3 offset:10240
    v_add_f32 v39, v39, v122
    v_exp_f32 v123, v123
    s_waitcnt lgkmcnt(6)
    v_mfma_f32_16x16x32_bf16 v[208:211], v[80:83], v[48:51], v[208:211]
    v_add_f32 v39, v39, v123
    v_cvt_pk_bf16_f32 v61, v122, v123
    v_exp_f32 v116, v116
    v_mfma_f32_16x16x32_bf16 v[240:243], v[80:83], v[52:55], v[240:243]
    ds_read_b128 v[76:79], v3 offset:11264
    v_add_f32 v38, v38, v116
    v_exp_f32 v117, v117
    s_waitcnt lgkmcnt(6)
    v_mfma_f32_16x16x32_bf16 v[212:215], v[84:87], v[48:51], v[212:215]
    v_add_f32 v38, v38, v117
    v_cvt_pk_bf16_f32 v58, v116, v117
    v_exp_f32 v118, v118
    v_mfma_f32_16x16x32_bf16 v[244:247], v[84:87], v[52:55], v[244:247]
    ds_read_b128 v[80:83], v3 offset:12288
    v_add_f32 v38, v38, v118
    v_exp_f32 v119, v119
    s_waitcnt lgkmcnt(6)
    v_mfma_f32_16x16x32_bf16 v[216:219], v[88:91], v[48:51], v[216:219]
    v_add_f32 v38, v38, v119
    v_cvt_pk_bf16_f32 v59, v118, v119
    v_exp_f32 v124, v124
    v_mfma_f32_16x16x32_bf16 v[248:251], v[88:91], v[52:55], v[248:251]
    ds_read_b128 v[84:87], v3 offset:13312
    v_add_f32 v39, v39, v124
    v_exp_f32 v125, v125
    s_waitcnt lgkmcnt(6)
    v_mfma_f32_16x16x32_bf16 v[220:223], v[92:95], v[48:51], v[220:223]
    v_add_f32 v39, v39, v125
    v_cvt_pk_bf16_f32 v62, v124, v125
    v_exp_f32 v126, v126
    v_mfma_f32_16x16x32_bf16 v[252:255], v[92:95], v[52:55], v[252:255]
    ds_read_b128 v[88:91], v3 offset:14336
    v_add_f32 v39, v39, v126
    v_exp_f32 v127, v127
    s_nop 0
    v_add_f32 v39, v39, v127
    v_cvt_pk_bf16_f32 v63, v126, v127
    s_nop 1
    s_waitcnt lgkmcnt(6)
    v_mfma_f32_16x16x32_bf16 v[192:195], v[64:67], v[56:59], v[192:195]
    v_mfma_f32_16x16x32_bf16 v[224:227], v[64:67], v[60:63], v[224:227]
    ds_read_b128 v[92:95], v3 offset:15360
    s_waitcnt lgkmcnt(6)
    v_mfma_f32_16x16x32_bf16 v[196:199], v[68:71], v[56:59], v[196:199]
    v_mfma_f32_16x16x32_bf16 v[228:231], v[68:71], v[60:63], v[228:231]
    s_waitcnt lgkmcnt(5)
    v_mfma_f32_16x16x32_bf16 v[200:203], v[72:75], v[56:59], v[200:203]
    v_mfma_f32_16x16x32_bf16 v[232:235], v[72:75], v[60:63], v[232:235]
    s_waitcnt lgkmcnt(4)
    v_mfma_f32_16x16x32_bf16 v[204:207], v[76:79], v[56:59], v[204:207]
    v_mfma_f32_16x16x32_bf16 v[236:239], v[76:79], v[60:63], v[236:239]
    s_waitcnt lgkmcnt(3)
    v_mfma_f32_16x16x32_bf16 v[208:211], v[80:83], v[56:59], v[208:211]
    v_mfma_f32_16x16x32_bf16 v[240:243], v[80:83], v[60:63], v[240:243]
    s_waitcnt lgkmcnt(2)
    v_mfma_f32_16x16x32_bf16 v[212:215], v[84:87], v[56:59], v[212:215]
    v_mfma_f32_16x16x32_bf16 v[244:247], v[84:87], v[60:63], v[244:247]
    s_waitcnt lgkmcnt(1)
    v_mfma_f32_16x16x32_bf16 v[216:219], v[88:91], v[56:59], v[216:219]
    v_mfma_f32_16x16x32_bf16 v[248:251], v[88:91], v[60:63], v[248:251]
    s_waitcnt lgkmcnt(0)
    v_mfma_f32_16x16x32_bf16 v[220:223], v[92:95], v[56:59], v[220:223]
    v_mfma_f32_16x16x32_bf16 v[252:255], v[92:95], v[60:63], v[252:255]
    s_waitcnt vmcnt(0)
    v_readfirstlane_b32 s36, v11
    s_nop 0
    s_cmp_lt_u32 s36, 28
    s_cbranch_scc1 L_recurrent_scan__compressed_kv_cla__moe_arch_mod__prompt_kernel_rare_141
L_recurrent_scan__compressed_kv_cla__moe_arch_mod__prompt_kernel_back_142:
    s_lshr_b32 s36, s2, 4
    s_mul_i32 s36, s36, 7
    s_min_u32 s37, s28, 6
    s_add_u32 s36, s36, s37
    s_lshl_b32 s36, s36, 11
    s_add_u32 s36, s36, 58720256
    v_and_b32 v11, 15, v1
    v_lshlrev_b32 v11, 4, v11
    v_lshrrev_b32 v12, 4, v1
    v_lshl_add_u32 v11, v12, 9, v11
    buffer_load_dwordx4 v[96:99], v11, s[24:27], s36 offen offset:0 sc1
    buffer_load_dwordx4 v[100:103], v11, s[24:27], s36 offen offset:256 sc1
    s_lshl_b32 s37, s28, 13
    v_add_u32 v21, s37, v7
    v_xor_b32 v22, 32768, v21
    s_lshl_b32 s37, s28, 8
    s_add_u32 s37, s37, 159744
    v_lshl_add_u32 v23, v1, 2, s37
    v_xor_b32 v24, 1024, v23
    ds_write_b32 v23, v38
    s_mov_b32 s36, 0x5d800000
    v_cmp_nge_f32 vcc, s36, v38
    s_nop 0
    s_or_b64 s[52:53], s[52:53], vcc
    v_cmp_nge_f32 vcc, s36, v39
    s_nop 0
    s_or_b64 s[52:53], s[52:53], vcc
    s_or_b32 s36, s52, s53
    v_mov_b32 v26, s36
    s_lshl_b32 s37, s28, 2
    s_add_u32 s37, s37, 161792
    v_mov_b32 v27, s37
    ds_write_b32 v27, v26
    ds_write_b128 v21, v[192:195] offset:0
    ds_write_b128 v21, v[196:199] offset:1024
    ds_write_b128 v21, v[200:203] offset:2048
    ds_write_b128 v21, v[204:207] offset:3072
    ds_write_b128 v21, v[208:211] offset:4096
    ds_write_b128 v21, v[212:215] offset:5120
    ds_write_b128 v21, v[216:219] offset:6144
    ds_write_b128 v21, v[220:223] offset:7168
    v_mov_b32 v28, 161856
    v_and_b32 v27, 7, v1
    v_lshlrev_b32 v27, 2, v27
    v_add_u32 v27, 161792, v27
    s_sub_u32 s36, 15, s30
    s_lshl_b32 s38, s36, 3
    s_and_b32 s37, s28, 3
    s_lshl_b32 s37, s37, 1
    s_add_u32 s38, s38, s37
    s_add_u32 s38, s38, 1
    s_lshl_b32 s38, s38, 17
    s_lshl_b32 s37, s29, 12
    s_add_u32 s38, s38, s37
    s_waitcnt lgkmcnt(0)
    s_barrier
    ds_read_b128 v[30:33], v28
    ds_read_b32 v26, v27
    ds_read_b32 v25, v24
    ds_read_b128 v[64:67], v22 offset:0
    ds_read_b128 v[68:71], v22 offset:1024
    ds_read_b128 v[72:75], v22 offset:2048
    ds_read_b128 v[76:79], v22 offset:3072
    ds_read_b128 v[80:83], v22 offset:4096
    ds_read_b128 v[84:87], v22 offset:5120
    ds_read_b128 v[88:91], v22 offset:6144
    ds_read_b128 v[92:95], v22 offset:7168
    s_waitcnt lgkmcnt(8)
    v_add_f32 v25, v25, v39
    v_mov_b32 v20, v25
    s_nop 1
    v_permlane16_swap_b32 v25, v20
    s_nop 1
    v_add_f32 v25, v25, v20
    v_mov_b32 v20, v25
    s_nop 1
    v_permlane32_swap_b32 v25, v20
    s_nop 1
    v_add_f32 v25, v25, v20
    v_cmp_ne_u32 s[52:53], 0, v26
    v_readfirstlane_b32 s56, v30
    v_readfirstlane_b32 s57, v31
    v_readfirstlane_b32 s58, v32
    v_readfirstlane_b32 s59, v33
    v_rcp_f32 v25, v25
    s_waitcnt lgkmcnt(6)
    v_pk_add_f32 v[224:225], v[224:225], v[64:65]
    v_pk_add_f32 v[226:227], v[226:227], v[66:67]
    v_pk_add_f32 v[228:229], v[228:229], v[68:69]
    v_pk_add_f32 v[230:231], v[230:231], v[70:71]
    v_pk_mul_f32 v[224:225], v[224:225], v[24:25] op_sel:[0,1] op_sel_hi:[1,1]
    v_pk_mul_f32 v[226:227], v[226:227], v[24:25] op_sel:[0,1] op_sel_hi:[1,1]
    v_pk_mul_f32 v[228:229], v[228:229], v[24:25] op_sel:[0,1] op_sel_hi:[1,1]
    v_pk_mul_f32 v[230:231], v[230:231], v[24:25] op_sel:[0,1] op_sel_hi:[1,1]
    v_cvt_pk_bf16_f32 v48, v224, v225
    v_cvt_pk_bf16_f32 v49, v226, v227
    v_cvt_pk_bf16_f32 v50, v228, v229
    v_cvt_pk_bf16_f32 v51, v230, v231
    buffer_store_dwordx4 v[48:51], v7, s[16:19], s38 offen offset:0 sc1
    s_waitcnt lgkmcnt(4)
    v_pk_add_f32 v[232:233], v[232:233], v[72:73]
    v_pk_add_f32 v[234:235], v[234:235], v[74:75]
    v_pk_add_f32 v[236:237], v[236:237], v[76:77]
    v_pk_add_f32 v[238:239], v[238:239], v[78:79]
    v_pk_mul_f32 v[232:233], v[232:233], v[24:25] op_sel:[0,1] op_sel_hi:[1,1]
    v_pk_mul_f32 v[234:235], v[234:235], v[24:25] op_sel:[0,1] op_sel_hi:[1,1]
    v_pk_mul_f32 v[236:237], v[236:237], v[24:25] op_sel:[0,1] op_sel_hi:[1,1]
    v_pk_mul_f32 v[238:239], v[238:239], v[24:25] op_sel:[0,1] op_sel_hi:[1,1]
    v_cvt_pk_bf16_f32 v52, v232, v233
    v_cvt_pk_bf16_f32 v53, v234, v235
    v_cvt_pk_bf16_f32 v54, v236, v237
    v_cvt_pk_bf16_f32 v55, v238, v239
    buffer_store_dwordx4 v[52:55], v7, s[16:19], s38 offen offset:1024 sc1
    s_waitcnt lgkmcnt(2)
    v_pk_add_f32 v[240:241], v[240:241], v[80:81]
    v_pk_add_f32 v[242:243], v[242:243], v[82:83]
    v_pk_add_f32 v[244:245], v[244:245], v[84:85]
    v_pk_add_f32 v[246:247], v[246:247], v[86:87]
    v_pk_mul_f32 v[240:241], v[240:241], v[24:25] op_sel:[0,1] op_sel_hi:[1,1]
    v_pk_mul_f32 v[242:243], v[242:243], v[24:25] op_sel:[0,1] op_sel_hi:[1,1]
    v_pk_mul_f32 v[244:245], v[244:245], v[24:25] op_sel:[0,1] op_sel_hi:[1,1]
    v_pk_mul_f32 v[246:247], v[246:247], v[24:25] op_sel:[0,1] op_sel_hi:[1,1]
    v_cvt_pk_bf16_f32 v56, v240, v241
    v_cvt_pk_bf16_f32 v57, v242, v243
    v_cvt_pk_bf16_f32 v58, v244, v245
    v_cvt_pk_bf16_f32 v59, v246, v247
    buffer_store_dwordx4 v[56:59], v7, s[16:19], s38 offen offset:2048 sc1
    s_waitcnt lgkmcnt(0)
    v_pk_add_f32 v[248:249], v[248:249], v[88:89]
    v_pk_add_f32 v[250:251], v[250:251], v[90:91]
    v_pk_add_f32 v[252:253], v[252:253], v[92:93]
    v_pk_add_f32 v[254:255], v[254:255], v[94:95]
    v_pk_mul_f32 v[248:249], v[248:249], v[24:25] op_sel:[0,1] op_sel_hi:[1,1]
    v_pk_mul_f32 v[250:251], v[250:251], v[24:25] op_sel:[0,1] op_sel_hi:[1,1]
    v_pk_mul_f32 v[252:253], v[252:253], v[24:25] op_sel:[0,1] op_sel_hi:[1,1]
    v_pk_mul_f32 v[254:255], v[254:255], v[24:25] op_sel:[0,1] op_sel_hi:[1,1]
    v_cvt_pk_bf16_f32 v60, v248, v249
    v_cvt_pk_bf16_f32 v61, v250, v251
    v_cvt_pk_bf16_f32 v62, v252, v253
    v_cvt_pk_bf16_f32 v63, v254, v255
    buffer_store_dwordx4 v[60:63], v7, s[16:19], s38 offen offset:3072 sc1
    s_cmp_eq_u64 s[52:53], 0
    s_cbranch_scc1 L_p3_done
    s_waitcnt vmcnt(0)
    v_mov_b32 v112, v96
    v_mov_b32 v113, v97
    v_mov_b32 v114, v98
    v_mov_b32 v115, v99
    v_mov_b32 v116, v100
    v_mov_b32 v117, v101
    v_mov_b32 v118, v102
    v_mov_b32 v119, v103
    v_swap_b32 v128, v160
    v_swap_b32 v129, v161
    v_swap_b32 v130, v162
    v_swap_b32 v131, v163
    v_swap_b32 v132, v164
    v_swap_b32 v133, v165
    v_swap_b32 v134, v166
    v_swap_b32 v135, v167
    v_swap_b32 v136, v168
    v_swap_b32 v137, v169
    v_swap_b32 v138, v170
    v_swap_b32 v139, v171
    v_swap_b32 v140, v172
    v_swap_b32 v141, v173
    v_swap_b32 v142, v174
    v_swap_b32 v143, v175
    v_swap_b32 v144, v176
    v_swap_b32 v145, v177
    v_swap_b32 v146, v178
    v_swap_b32 v147, v179
    v_swap_b32 v148, v180
    v_swap_b32 v149, v181
    v_swap_b32 v150, v182
    v_swap_b32 v151, v183
    v_swap_b32 v152, v184
    v_swap_b32 v153, v185
    v_swap_b32 v154, v186
    v_swap_b32 v155, v187
    v_swap_b32 v156, v188
    v_swap_b32 v157, v189
    v_swap_b32 v158, v190
    v_swap_b32 v159, v191
    v_mov_b32 v192, 0
    v_mov_b32 v193, 0
    v_mov_b32 v194, 0
    v_mov_b32 v195, 0
    v_mov_b32 v196, 0
    v_mov_b32 v197, 0
    v_mov_b32 v198, 0
    v_mov_b32 v199, 0
    v_mov_b32 v200, 0
    v_mov_b32 v201, 0
    v_mov_b32 v202, 0
    v_mov_b32 v203, 0
    v_mov_b32 v204, 0
    v_mov_b32 v205, 0
    v_mov_b32 v206, 0
    v_mov_b32 v207, 0
    v_mov_b32 v208, 0
    v_mov_b32 v209, 0
    v_mov_b32 v210, 0
    v_mov_b32 v211, 0
    v_mov_b32 v212, 0
    v_mov_b32 v213, 0
    v_mov_b32 v214, 0
    v_mov_b32 v215, 0
    v_mov_b32 v216, 0
    v_mov_b32 v217, 0
    v_mov_b32 v218, 0
    v_mov_b32 v219, 0
    v_mov_b32 v220, 0
    v_mov_b32 v221, 0
    v_mov_b32 v222, 0
    v_mov_b32 v223, 0
    v_mov_b32 v224, 0
    v_mov_b32 v225, 0
    v_mov_b32 v226, 0
    v_mov_b32 v227, 0
    v_mov_b32 v228, 0
    v_mov_b32 v229, 0
    v_mov_b32 v230, 0
    v_mov_b32 v231, 0
    v_mov_b32 v232, 0
    v_mov_b32 v233, 0
    v_mov_b32 v234, 0
    v_mov_b32 v235, 0
    v_mov_b32 v236, 0
    v_mov_b32 v237, 0
    v_mov_b32 v238, 0
    v_mov_b32 v239, 0
    v_mov_b32 v240, 0
    v_mov_b32 v241, 0
    v_mov_b32 v242, 0
    v_mov_b32 v243, 0
    v_mov_b32 v244, 0
    v_mov_b32 v245, 0
    v_mov_b32 v246, 0
    v_mov_b32 v247, 0
    v_mov_b32 v248, 0
    v_mov_b32 v249, 0
    v_mov_b32 v250, 0
    v_mov_b32 v251, 0
    v_mov_b32 v252, 0
    v_mov_b32 v253, 0
    v_mov_b32 v254, 0
    v_mov_b32 v255, 0
    v_mov_b32 v38, 0
    v_mov_b32 v40, 4048155338
    v_mov_b32 v39, 0
    v_mov_b32 v41, 4048155338
    s_lshl_b32 s43, s28, 12
    v_add_u32 v4, s43, v7
    s_mov_b32 s46, s45
    s_sub_u32 s40, 16, s30
    s_mov_b32 s39, s30
    s_lshl_b32 s37, s39, 7
    s_and_b32 s36, s28, 3
    s_lshl_b32 s36, s36, 5
    s_add_u32 s36, s36, s37
    s_sub_u32 s50, 0, s36
L_recurrent_scan__compressed_kv_cla__moe_arch_mod__prompt_kernel_stile_143:
    s_waitcnt vmcnt(0) lgkmcnt(0)
    s_barrier
    s_mov_b32 m0, s43
    s_add_u32 s47, s46, 32768
    buffer_load_dwordx4 v4, s[12:15], s46 offen offset:0 sc1 lds
    buffer_load_dwordx4 v4, s[12:15], s46 offen offset:1024 sc1 lds
    buffer_load_dwordx4 v4, s[12:15], s46 offen offset:2048 sc1 lds
    buffer_load_dwordx4 v4, s[12:15], s46 offen offset:3072 sc1 lds
    s_add_u32 m0, s43, 32768
    s_add_u32 s46, s46, 65536
    buffer_load_dwordx4 v4, s[12:15], s47 offen offset:0 sc1 lds
    buffer_load_dwordx4 v4, s[12:15], s47 offen offset:1024 sc1 lds
    buffer_load_dwordx4 v4, s[12:15], s47 offen offset:2048 sc1 lds
    buffer_load_dwordx4 v4, s[12:15], s47 offen offset:3072 sc1 lds
    v_mov_b32 v2, v7
    s_mov_b32 s41, 4
    s_waitcnt vmcnt(0)
    s_barrier
L_recurrent_scan__compressed_kv_cla__moe_arch_mod__prompt_kernel_sunit_144:
    s_cmp_gt_i32 s50, 0
    s_cbranch_scc1 L_recurrent_scan__compressed_kv_cla__moe_arch_mod__prompt_kernel_snext_145
    ds_read_b128 v[64:67], v2 offset:0
    ds_read_b128 v[68:71], v2 offset:1024
    ds_read_b128 v[72:75], v2 offset:2048
    ds_read_b128 v[76:79], v2 offset:3072
    ds_read_b128 v[80:83], v2 offset:4096
    ds_read_b128 v[84:87], v2 offset:5120
    ds_read_b128 v[88:91], v2 offset:6144
    ds_read_b128 v[92:95], v2 offset:7168
    s_waitcnt lgkmcnt(0)
    v_mfma_f32_16x16x32_bf16 v[96:99], v[64:67], v[128:131], 0
    v_mfma_f32_16x16x32_bf16 v[104:107], v[64:67], v[144:147], 0
    v_mfma_f32_16x16x32_bf16 v[96:99], v[68:71], v[132:135], v[96:99]
    v_mfma_f32_16x16x32_bf16 v[104:107], v[68:71], v[148:151], v[104:107]
    v_mfma_f32_16x16x32_bf16 v[96:99], v[72:75], v[136:139], v[96:99]
    v_mfma_f32_16x16x32_bf16 v[104:107], v[72:75], v[152:155], v[104:107]
    v_mfma_f32_16x16x32_bf16 v[96:99], v[76:79], v[140:143], v[96:99]
    v_mfma_f32_16x16x32_bf16 v[104:107], v[76:79], v[156:159], v[104:107]
    v_mfma_f32_16x16x32_bf16 v[100:103], v[80:83], v[128:131], 0
    v_mfma_f32_16x16x32_bf16 v[108:111], v[80:83], v[144:147], 0
    v_mfma_f32_16x16x32_bf16 v[100:103], v[84:87], v[132:135], v[100:103]
    v_mfma_f32_16x16x32_bf16 v[108:111], v[84:87], v[148:151], v[108:111]
    v_mfma_f32_16x16x32_bf16 v[100:103], v[88:91], v[136:139], v[100:103]
    v_mfma_f32_16x16x32_bf16 v[108:111], v[88:91], v[152:155], v[108:111]
    v_mfma_f32_16x16x32_bf16 v[100:103], v[92:95], v[140:143], v[100:103]
    v_mfma_f32_16x16x32_bf16 v[108:111], v[92:95], v[156:159], v[108:111]
    ds_read_b128 v[64:67], v2 offset:32768
    ds_read_b128 v[68:71], v2 offset:33792
    ds_read_b128 v[72:75], v2 offset:34816
    ds_read_b128 v[76:79], v2 offset:35840
    ds_read_b128 v[80:83], v2 offset:36864
    ds_read_b128 v[84:87], v2 offset:37888
    ds_read_b128 v[88:91], v2 offset:38912
    ds_read_b128 v[92:95], v2 offset:39936
    s_nop 1
    s_cmp_lt_i32 s50, 0
    s_cbranch_scc0 L_recurrent_scan__compressed_kv_cla__moe_arch_mod__prompt_kernel_rare_146
L_recurrent_scan__compressed_kv_cla__moe_arch_mod__prompt_kernel_back_147:
    v_max3_f32 v22, v96, v97, v98
    v_max3_f32 v22, v22, v99, v100
    v_max3_f32 v22, v22, v101, v102
    v_max3_f32 v22, v22, v103, v40
    v_mov_b32 v24, v22
    s_nop 1
    v_permlane16_swap_b32 v22, v24
    s_nop 1
    v_max_f32 v22, v22, v24
    v_mov_b32 v24, v22
    s_nop 1
    v_permlane32_swap_b32 v22, v24
    s_nop 1
    v_max_f32 v22, v22, v24
    v_sub_f32 v25, v40, v22
    v_exp_f32 v25, v25
    v_mov_b32 v40, v22
    v_mul_f32 v38, v38, v25
    v_mul_f32 v192, v192, v25
    v_mul_f32 v193, v193, v25
    v_mul_f32 v194, v194, v25
    v_mul_f32 v195, v195, v25
    v_mul_f32 v196, v196, v25
    v_mul_f32 v197, v197, v25
    v_mul_f32 v198, v198, v25
    v_mul_f32 v199, v199, v25
    v_mul_f32 v200, v200, v25
    v_mul_f32 v201, v201, v25
    v_mul_f32 v202, v202, v25
    v_mul_f32 v203, v203, v25
    v_mul_f32 v204, v204, v25
    v_mul_f32 v205, v205, v25
    v_mul_f32 v206, v206, v25
    v_mul_f32 v207, v207, v25
    v_mul_f32 v208, v208, v25
    v_mul_f32 v209, v209, v25
    v_mul_f32 v210, v210, v25
    v_mul_f32 v211, v211, v25
    v_mul_f32 v212, v212, v25
    v_mul_f32 v213, v213, v25
    v_mul_f32 v214, v214, v25
    v_mul_f32 v215, v215, v25
    v_mul_f32 v216, v216, v25
    v_mul_f32 v217, v217, v25
    v_mul_f32 v218, v218, v25
    v_mul_f32 v219, v219, v25
    v_mul_f32 v220, v220, v25
    v_mul_f32 v221, v221, v25
    v_mul_f32 v222, v222, v25
    v_mul_f32 v223, v223, v25
    v_sub_f32 v96, v96, v22
    v_sub_f32 v97, v97, v22
    v_sub_f32 v98, v98, v22
    v_sub_f32 v99, v99, v22
    v_sub_f32 v100, v100, v22
    v_sub_f32 v101, v101, v22
    v_sub_f32 v102, v102, v22
    v_sub_f32 v103, v103, v22
    v_max3_f32 v23, v104, v105, v106
    v_max3_f32 v23, v23, v107, v108
    v_max3_f32 v23, v23, v109, v110
    v_max3_f32 v23, v23, v111, v41
    v_mov_b32 v24, v23
    s_nop 1
    v_permlane16_swap_b32 v23, v24
    s_nop 1
    v_max_f32 v23, v23, v24
    v_mov_b32 v24, v23
    s_nop 1
    v_permlane32_swap_b32 v23, v24
    s_nop 1
    v_max_f32 v23, v23, v24
    v_sub_f32 v25, v41, v23
    v_exp_f32 v25, v25
    v_mov_b32 v41, v23
    v_mul_f32 v39, v39, v25
    v_mul_f32 v224, v224, v25
    v_mul_f32 v225, v225, v25
    v_mul_f32 v226, v226, v25
    v_mul_f32 v227, v227, v25
    v_mul_f32 v228, v228, v25
    v_mul_f32 v229, v229, v25
    v_mul_f32 v230, v230, v25
    v_mul_f32 v231, v231, v25
    v_mul_f32 v232, v232, v25
    v_mul_f32 v233, v233, v25
    v_mul_f32 v234, v234, v25
    v_mul_f32 v235, v235, v25
    v_mul_f32 v236, v236, v25
    v_mul_f32 v237, v237, v25
    v_mul_f32 v238, v238, v25
    v_mul_f32 v239, v239, v25
    v_mul_f32 v240, v240, v25
    v_mul_f32 v241, v241, v25
    v_mul_f32 v242, v242, v25
    v_mul_f32 v243, v243, v25
    v_mul_f32 v244, v244, v25
    v_mul_f32 v245, v245, v25
    v_mul_f32 v246, v246, v25
    v_mul_f32 v247, v247, v25
    v_mul_f32 v248, v248, v25
    v_mul_f32 v249, v249, v25
    v_mul_f32 v250, v250, v25
    v_mul_f32 v251, v251, v25
    v_mul_f32 v252, v252, v25
    v_mul_f32 v253, v253, v25
    v_mul_f32 v254, v254, v25
    v_mul_f32 v255, v255, v25
    v_sub_f32 v104, v104, v23
    v_sub_f32 v105, v105, v23
    v_sub_f32 v106, v106, v23
    v_sub_f32 v107, v107, v23
    v_sub_f32 v108, v108, v23
    v_sub_f32 v109, v109, v23
    v_sub_f32 v110, v110, v23
    v_sub_f32 v111, v111, v23
    v_exp_f32 v96, v96
    v_exp_f32 v97, v97
    v_exp_f32 v98, v98
    v_exp_f32 v99, v99
    v_exp_f32 v104, v104
    v_exp_f32 v105, v105
    v_exp_f32 v106, v106
    v_exp_f32 v107, v107
    v_exp_f32 v100, v100
    v_exp_f32 v101, v101
    v_exp_f32 v102, v102
    v_exp_f32 v103, v103
    v_exp_f32 v108, v108
    v_exp_f32 v109, v109
    v_exp_f32 v110, v110
    v_exp_f32 v111, v111
    v_add_f32 v38, v38, v96
    v_add_f32 v38, v38, v97
    v_cvt_pk_bf16_f32 v48, v96, v97
    v_add_f32 v38, v38, v98
    v_add_f32 v38, v38, v99
    v_cvt_pk_bf16_f32 v49, v98, v99
    v_add_f32 v39, v39, v104
    v_add_f32 v39, v39, v105
    v_cvt_pk_bf16_f32 v52, v104, v105
    v_add_f32 v39, v39, v106
    v_add_f32 v39, v39, v107
    v_cvt_pk_bf16_f32 v53, v106, v107
    v_add_f32 v38, v38, v100
    v_add_f32 v38, v38, v101
    v_cvt_pk_bf16_f32 v50, v100, v101
    v_add_f32 v38, v38, v102
    v_add_f32 v38, v38, v103
    v_cvt_pk_bf16_f32 v51, v102, v103
    v_add_f32 v39, v39, v108
    v_add_f32 v39, v39, v109
    v_cvt_pk_bf16_f32 v54, v108, v109
    v_add_f32 v39, v39, v110
    v_add_f32 v39, v39, v111
    v_cvt_pk_bf16_f32 v55, v110, v111
    s_waitcnt lgkmcnt(0)
    s_nop 0
    v_mfma_f32_16x16x32_bf16 v[192:195], v[64:67], v[48:51], v[192:195]
    v_mfma_f32_16x16x32_bf16 v[224:227], v[64:67], v[52:55], v[224:227]
    v_mfma_f32_16x16x32_bf16 v[196:199], v[68:71], v[48:51], v[196:199]
    v_mfma_f32_16x16x32_bf16 v[228:231], v[68:71], v[52:55], v[228:231]
    v_mfma_f32_16x16x32_bf16 v[200:203], v[72:75], v[48:51], v[200:203]
    v_mfma_f32_16x16x32_bf16 v[232:235], v[72:75], v[52:55], v[232:235]
    v_mfma_f32_16x16x32_bf16 v[204:207], v[76:79], v[48:51], v[204:207]
    v_mfma_f32_16x16x32_bf16 v[236:239], v[76:79], v[52:55], v[236:239]
    v_mfma_f32_16x16x32_bf16 v[208:211], v[80:83], v[48:51], v[208:211]
    v_mfma_f32_16x16x32_bf16 v[240:243], v[80:83], v[52:55], v[240:243]
    v_mfma_f32_16x16x32_bf16 v[212:215], v[84:87], v[48:51], v[212:215]
    v_mfma_f32_16x16x32_bf16 v[244:247], v[84:87], v[52:55], v[244:247]
    v_mfma_f32_16x16x32_bf16 v[216:219], v[88:91], v[48:51], v[216:219]
    v_mfma_f32_16x16x32_bf16 v[248:251], v[88:91], v[52:55], v[248:251]
    v_mfma_f32_16x16x32_bf16 v[220:223], v[92:95], v[48:51], v[220:223]
    v_mfma_f32_16x16x32_bf16 v[252:255], v[92:95], v[52:55], v[252:255]
L_recurrent_scan__compressed_kv_cla__moe_arch_mod__prompt_kernel_snext_145:
    v_add_u32 v2, 8192, v2
    s_add_u32 s50, s50, 32
    s_sub_u32 s41, s41, 1
    s_cmp_lg_u32 s41, 0
    s_cbranch_scc1 L_recurrent_scan__compressed_kv_cla__moe_arch_mod__prompt_kernel_sunit_144
    s_sub_u32 s40, s40, 1
    s_cmp_lg_u32 s40, 0
    s_cbranch_scc1 L_recurrent_scan__compressed_kv_cla__moe_arch_mod__prompt_kernel_stile_143
    v_mov_b32 v20, v38
    s_nop 1
    v_permlane16_swap_b32 v38, v20
    s_nop 1
    v_add_f32 v38, v38, v20
    v_mov_b32 v20, v38
    s_nop 1
    v_permlane32_swap_b32 v38, v20
    s_nop 1
    v_add_f32 v38, v38, v20
    v_mov_b32 v20, v39
    s_nop 1
    v_permlane16_swap_b32 v39, v20
    s_nop 1
    v_add_f32 v39, v39, v20
    v_mov_b32 v20, v39
    s_nop 1
    v_permlane32_swap_b32 v39, v20
    s_nop 1
    v_add_f32 v39, v39, v20
    s_mov_b32 s36, 0x5d800000
    v_cmp_nge_f32 vcc, s36, v38
    s_nop 0
    s_or_b64 s[52:53], s[52:53], vcc
    v_cmp_nge_f32 vcc, s36, v39
    s_nop 0
    s_or_b64 s[52:53], s[52:53], vcc
    v_rcp_f32 v38, v38
    v_rcp_f32 v39, v39
    s_lshl_b32 s38, s39, 3
    s_and_b32 s37, s28, 3
    s_lshl_b32 s37, s37, 1
    s_add_u32 s38, s38, s37
    s_lshl_b32 s38, s38, 17
    s_lshl_b32 s37, s29, 12
    s_add_u32 s38, s38, s37
    v_pk_mul_f32 v[192:193], v[192:193], v[38:39] op_sel:[0,0] op_sel_hi:[1,0]
    v_pk_mul_f32 v[194:195], v[194:195], v[38:39] op_sel:[0,0] op_sel_hi:[1,0]
    v_pk_mul_f32 v[196:197], v[196:197], v[38:39] op_sel:[0,0] op_sel_hi:[1,0]
    v_pk_mul_f32 v[198:199], v[198:199], v[38:39] op_sel:[0,0] op_sel_hi:[1,0]
    v_cvt_pk_bf16_f32 v22, v192, v193
    v_cvt_pk_bf16_f32 v23, v194, v195
    v_cvt_pk_bf16_f32 v24, v196, v197
    v_cvt_pk_bf16_f32 v25, v198, v199
    buffer_store_dwordx4 v[22:25], v7, s[16:19], s38 offen offset:0 sc1
    v_pk_mul_f32 v[200:201], v[200:201], v[38:39] op_sel:[0,0] op_sel_hi:[1,0]
    v_pk_mul_f32 v[202:203], v[202:203], v[38:39] op_sel:[0,0] op_sel_hi:[1,0]
    v_pk_mul_f32 v[204:205], v[204:205], v[38:39] op_sel:[0,0] op_sel_hi:[1,0]
    v_pk_mul_f32 v[206:207], v[206:207], v[38:39] op_sel:[0,0] op_sel_hi:[1,0]
    v_cvt_pk_bf16_f32 v26, v200, v201
    v_cvt_pk_bf16_f32 v27, v202, v203
    v_cvt_pk_bf16_f32 v28, v204, v205
    v_cvt_pk_bf16_f32 v29, v206, v207
    buffer_store_dwordx4 v[26:29], v7, s[16:19], s38 offen offset:1024 sc1
    v_pk_mul_f32 v[208:209], v[208:209], v[38:39] op_sel:[0,0] op_sel_hi:[1,0]
    v_pk_mul_f32 v[210:211], v[210:211], v[38:39] op_sel:[0,0] op_sel_hi:[1,0]
    v_pk_mul_f32 v[212:213], v[212:213], v[38:39] op_sel:[0,0] op_sel_hi:[1,0]
    v_pk_mul_f32 v[214:215], v[214:215], v[38:39] op_sel:[0,0] op_sel_hi:[1,0]
    v_cvt_pk_bf16_f32 v30, v208, v209
    v_cvt_pk_bf16_f32 v31, v210, v211
    v_cvt_pk_bf16_f32 v32, v212, v213
    v_cvt_pk_bf16_f32 v33, v214, v215
    buffer_store_dwordx4 v[30:33], v7, s[16:19], s38 offen offset:2048 sc1
    v_pk_mul_f32 v[216:217], v[216:217], v[38:39] op_sel:[0,0] op_sel_hi:[1,0]
    v_pk_mul_f32 v[218:219], v[218:219], v[38:39] op_sel:[0,0] op_sel_hi:[1,0]
    v_pk_mul_f32 v[220:221], v[220:221], v[38:39] op_sel:[0,0] op_sel_hi:[1,0]
    v_pk_mul_f32 v[222:223], v[222:223], v[38:39] op_sel:[0,0] op_sel_hi:[1,0]
    v_cvt_pk_bf16_f32 v34, v216, v217
    v_cvt_pk_bf16_f32 v35, v218, v219
    v_cvt_pk_bf16_f32 v36, v220, v221
    v_cvt_pk_bf16_f32 v37, v222, v223
    buffer_store_dwordx4 v[34:37], v7, s[16:19], s38 offen offset:3072 sc1
    s_add_u32 s38, s38, 131072
    v_pk_mul_f32 v[224:225], v[224:225], v[38:39] op_sel:[0,1] op_sel_hi:[1,1]
    v_pk_mul_f32 v[226:227], v[226:227], v[38:39] op_sel:[0,1] op_sel_hi:[1,1]
    v_pk_mul_f32 v[228:229], v[228:229], v[38:39] op_sel:[0,1] op_sel_hi:[1,1]
    v_pk_mul_f32 v[230:231], v[230:231], v[38:39] op_sel:[0,1] op_sel_hi:[1,1]
    v_cvt_pk_bf16_f32 v22, v224, v225
    v_cvt_pk_bf16_f32 v23, v226, v227
    v_cvt_pk_bf16_f32 v24, v228, v229
    v_cvt_pk_bf16_f32 v25, v230, v231
    buffer_store_dwordx4 v[22:25], v7, s[16:19], s38 offen offset:0 sc1
    v_pk_mul_f32 v[232:233], v[232:233], v[38:39] op_sel:[0,1] op_sel_hi:[1,1]
    v_pk_mul_f32 v[234:235], v[234:235], v[38:39] op_sel:[0,1] op_sel_hi:[1,1]
    v_pk_mul_f32 v[236:237], v[236:237], v[38:39] op_sel:[0,1] op_sel_hi:[1,1]
    v_pk_mul_f32 v[238:239], v[238:239], v[38:39] op_sel:[0,1] op_sel_hi:[1,1]
    v_cvt_pk_bf16_f32 v26, v232, v233
    v_cvt_pk_bf16_f32 v27, v234, v235
    v_cvt_pk_bf16_f32 v28, v236, v237
    v_cvt_pk_bf16_f32 v29, v238, v239
    buffer_store_dwordx4 v[26:29], v7, s[16:19], s38 offen offset:1024 sc1
    v_pk_mul_f32 v[240:241], v[240:241], v[38:39] op_sel:[0,1] op_sel_hi:[1,1]
    v_pk_mul_f32 v[242:243], v[242:243], v[38:39] op_sel:[0,1] op_sel_hi:[1,1]
    v_pk_mul_f32 v[244:245], v[244:245], v[38:39] op_sel:[0,1] op_sel_hi:[1,1]
    v_pk_mul_f32 v[246:247], v[246:247], v[38:39] op_sel:[0,1] op_sel_hi:[1,1]
    v_cvt_pk_bf16_f32 v30, v240, v241
    v_cvt_pk_bf16_f32 v31, v242, v243
    v_cvt_pk_bf16_f32 v32, v244, v245
    v_cvt_pk_bf16_f32 v33, v246, v247
    buffer_store_dwordx4 v[30:33], v7, s[16:19], s38 offen offset:2048 sc1
    v_pk_mul_f32 v[248:249], v[248:249], v[38:39] op_sel:[0,1] op_sel_hi:[1,1]
    v_pk_mul_f32 v[250:251], v[250:251], v[38:39] op_sel:[0,1] op_sel_hi:[1,1]
    v_pk_mul_f32 v[252:253], v[252:253], v[38:39] op_sel:[0,1] op_sel_hi:[1,1]
    v_pk_mul_f32 v[254:255], v[254:255], v[38:39] op_sel:[0,1] op_sel_hi:[1,1]
    v_cvt_pk_bf16_f32 v34, v248, v249
    v_cvt_pk_bf16_f32 v35, v250, v251
    v_cvt_pk_bf16_f32 v36, v252, v253
    v_cvt_pk_bf16_f32 v37, v254, v255
    buffer_store_dwordx4 v[34:37], v7, s[16:19], s38 offen offset:3072 sc1
    v_mov_b32 v96, v112
    v_mov_b32 v97, v113
    v_mov_b32 v98, v114
    v_mov_b32 v99, v115
    v_mov_b32 v100, v116
    v_mov_b32 v101, v117
    v_mov_b32 v102, v118
    v_mov_b32 v103, v119
    s_branch L_p3_done
L_recurrent_scan__compressed_kv_cla__moe_arch_mod__prompt_kernel_rare_110:
    s_lshl_b32 s36, s29, 7
    v_mov_b32 v20, s36
    v_mov_b32 v21, 1
    s_mov_b64 exec, 1
    global_atomic_add v20, v21, s[90:91]
    s_mov_b64 exec, -1
    s_nop 3
    s_branch L_recurrent_scan__compressed_kv_cla__moe_arch_mod__prompt_kernel_back_111
L_recurrent_scan__compressed_kv_cla__moe_arch_mod__prompt_kernel_rare_112:
    v_mov_b32 v20, 4048155338
    v_subrev_u32 v21, s50, v18
    v_cmp_gt_i32 s[20:21], 0, v21
    v_cmp_gt_i32 s[22:23], 1, v21
    v_cmp_gt_i32 s[62:63], 2, v21
    v_cmp_gt_i32 vcc, 3, v21
    v_cndmask_b32 v96, v96, v20, s[20:21]
    v_cndmask_b32 v97, v97, v20, s[22:23]
    v_cndmask_b32 v98, v98, v20, s[62:63]
    v_cndmask_b32 v99, v99, v20, vcc
    v_cmp_gt_i32 s[20:21], 16, v21
    v_cmp_gt_i32 s[22:23], 17, v21
    v_cmp_gt_i32 s[62:63], 18, v21
    v_cmp_gt_i32 vcc, 19, v21
    v_cndmask_b32 v100, v100, v20, s[20:21]
    v_cndmask_b32 v101, v101, v20, s[22:23]
    v_cndmask_b32 v102, v102, v20, s[62:63]
    v_cndmask_b32 v103, v103, v20, vcc
    v_cmp_gt_i32 s[20:21], -16, v21
    v_cmp_gt_i32 s[22:23], -15, v21
    v_cmp_gt_i32 s[62:63], -14, v21
    v_cmp_gt_i32 vcc, -13, v21
    v_cndmask_b32 v104, v104, v20, s[20:21]
    v_cndmask_b32 v105, v105, v20, s[22:23]
    v_cndmask_b32 v106, v106, v20, s[62:63]
    v_cndmask_b32 v107, v107, v20, vcc
    v_cmp_gt_i32 s[20:21], 0, v21
    v_cmp_gt_i32 s[22:23], 1, v21
    v_cmp_gt_i32 s[62:63], 2, v21
    v_cmp_gt_i32 vcc, 3, v21
    v_cndmask_b32 v108, v108, v20, s[20:21]
    v_cndmask_b32 v109, v109, v20, s[22:23]
    v_cndmask_b32 v110, v110, v20, s[62:63]
    v_cndmask_b32 v111, v111, v20, vcc
    s_branch L_recurrent_scan__compressed_kv_cla__moe_arch_mod__prompt_kernel_back_113
L_recurrent_scan__compressed_kv_cla__moe_arch_mod__prompt_kernel_rare_115:
    v_mov_b32 v20, 4048155338
    v_subrev_u32 v21, s49, v18
    v_cmp_gt_i32 s[20:21], 0, v21
    v_cmp_gt_i32 s[22:23], 1, v21
    v_cmp_gt_i32 s[62:63], 2, v21
    v_cmp_gt_i32 vcc, 3, v21
    v_cndmask_b32 v112, v112, v20, s[20:21]
    v_cndmask_b32 v113, v113, v20, s[22:23]
    v_cndmask_b32 v114, v114, v20, s[62:63]
    v_cndmask_b32 v115, v115, v20, vcc
    v_cmp_gt_i32 s[20:21], 16, v21
    v_cmp_gt_i32 s[22:23], 17, v21
    v_cmp_gt_i32 s[62:63], 18, v21
    v_cmp_gt_i32 vcc, 19, v21
    v_cndmask_b32 v116, v116, v20, s[20:21]
    v_cndmask_b32 v117, v117, v20, s[22:23]
    v_cndmask_b32 v118, v118, v20, s[62:63]
    v_cndmask_b32 v119, v119, v20, vcc
    v_cmp_gt_i32 s[20:21], -16, v21
    v_cmp_gt_i32 s[22:23], -15, v21
    v_cmp_gt_i32 s[62:63], -14, v21
    v_cmp_gt_i32 vcc, -13, v21
    v_cndmask_b32 v120, v120, v20, s[20:21]
    v_cndmask_b32 v121, v121, v20, s[22:23]
    v_cndmask_b32 v122, v122, v20, s[62:63]
    v_cndmask_b32 v123, v123, v20, vcc
    v_cmp_gt_i32 s[20:21], 0, v21
    v_cmp_gt_i32 s[22:23], 1, v21
    v_cmp_gt_i32 s[62:63], 2, v21
    v_cmp_gt_i32 vcc, 3, v21
    v_cndmask_b32 v124, v124, v20, s[20:21]
    v_cndmask_b32 v125, v125, v20, s[22:23]
    v_cndmask_b32 v126, v126, v20, s[62:63]
    v_cndmask_b32 v127, v127, v20, vcc
    s_branch L_recurrent_scan__compressed_kv_cla__moe_arch_mod__prompt_kernel_back_116
L_recurrent_scan__compressed_kv_cla__moe_arch_mod__prompt_kernel_rare_117:
    v_mov_b32 v8, v38
    v_mov_b32 v9, v39
    v_mov_b32 v38, 0
    v_mov_b32 v39, 0
    s_branch L_recurrent_scan__compressed_kv_cla__moe_arch_mod__prompt_kernel_back_118
L_recurrent_scan__compressed_kv_cla__moe_arch_mod__prompt_kernel_rare_119:
    v_mov_b32 v20, 4048155338
    v_subrev_u32 v21, s50, v18
    v_cmp_gt_i32 s[20:21], 0, v21
    v_cmp_gt_i32 s[22:23], 1, v21
    v_cmp_gt_i32 s[62:63], 2, v21
    v_cmp_gt_i32 vcc, 3, v21
    v_cndmask_b32 v96, v96, v20, s[20:21]
    v_cndmask_b32 v97, v97, v20, s[22:23]
    v_cndmask_b32 v98, v98, v20, s[62:63]
    v_cndmask_b32 v99, v99, v20, vcc
    v_cmp_gt_i32 s[20:21], 16, v21
    v_cmp_gt_i32 s[22:23], 17, v21
    v_cmp_gt_i32 s[62:63], 18, v21
    v_cmp_gt_i32 vcc, 19, v21
    v_cndmask_b32 v100, v100, v20, s[20:21]
    v_cndmask_b32 v101, v101, v20, s[22:23]
    v_cndmask_b32 v102, v102, v20, s[62:63]
    v_cndmask_b32 v103, v103, v20, vcc
    v_cmp_gt_i32 s[20:21], -16, v21
    v_cmp_gt_i32 s[22:23], -15, v21
    v_cmp_gt_i32 s[62:63], -14, v21
    v_cmp_gt_i32 vcc, -13, v21
    v_cndmask_b32 v104, v104, v20, s[20:21]
    v_cndmask_b32 v105, v105, v20, s[22:23]
    v_cndmask_b32 v106, v106, v20, s[62:63]
    v_cndmask_b32 v107, v107, v20, vcc
    v_cmp_gt_i32 s[20:21], 0, v21
    v_cmp_gt_i32 s[22:23], 1, v21
    v_cmp_gt_i32 s[62:63], 2, v21
    v_cmp_gt_i32 vcc, 3, v21
    v_cndmask_b32 v108, v108, v20, s[20:21]
    v_cndmask_b32 v109, v109, v20, s[22:23]
    v_cndmask_b32 v110, v110, v20, s[62:63]
    v_cndmask_b32 v111, v111, v20, vcc
    s_branch L_recurrent_scan__compressed_kv_cla__moe_arch_mod__prompt_kernel_back_120
L_recurrent_scan__compressed_kv_cla__moe_arch_mod__prompt_kernel_rare_122:
    v_mov_b32 v20, 4048155338
    v_subrev_u32 v21, s49, v18
    v_cmp_gt_i32 s[20:21], 0, v21
    v_cmp_gt_i32 s[22:23], 1, v21
    v_cmp_gt_i32 s[62:63], 2, v21
    v_cmp_gt_i32 vcc, 3, v21
    v_cndmask_b32 v112, v112, v20, s[20:21]
    v_cndmask_b32 v113, v113, v20, s[22:23]
    v_cndmask_b32 v114, v114, v20, s[62:63]
    v_cndmask_b32 v115, v115, v20, vcc
    v_cmp_gt_i32 s[20:21], 16, v21
    v_cmp_gt_i32 s[22:23], 17, v21
    v_cmp_gt_i32 s[62:63], 18, v21
    v_cmp_gt_i32 vcc, 19, v21
    v_cndmask_b32 v116, v116, v20, s[20:21]
    v_cndmask_b32 v117, v117, v20, s[22:23]
    v_cndmask_b32 v118, v118, v20, s[62:63]
    v_cndmask_b32 v119, v119, v20, vcc
    v_cmp_gt_i32 s[20:21], -16, v21
    v_cmp_gt_i32 s[22:23], -15, v21
    v_cmp_gt_i32 s[62:63], -14, v21
    v_cmp_gt_i32 vcc, -13, v21
    v_cndmask_b32 v120, v120, v20, s[20:21]
    v_cndmask_b32 v121, v121, v20, s[22:23]
    v_cndmask_b32 v122, v122, v20, s[62:63]
    v_cndmask_b32 v123, v123, v20, vcc
    v_cmp_gt_i32 s[20:21], 0, v21
    v_cmp_gt_i32 s[22:23], 1, v21
    v_cmp_gt_i32 s[62:63], 2, v21
    v_cmp_gt_i32 vcc, 3, v21
    v_cndmask_b32 v124, v124, v20, s[20:21]
    v_cndmask_b32 v125, v125, v20, s[22:23]
    v_cndmask_b32 v126, v126, v20, s[62:63]
    v_cndmask_b32 v127, v127, v20, vcc
    s_branch L_recurrent_scan__compressed_kv_cla__moe_arch_mod__prompt_kernel_back_123
L_recurrent_scan__compressed_kv_cla__moe_arch_mod__prompt_kernel_rare_124:
    s_cmp_lg_u32 s40, s51
    s_cbranch_scc1 L_recurrent_scan__compressed_kv_cla__moe_arch_mod__prompt_kernel_epi_126
    v_swap_b32 v128, v160
    v_swap_b32 v129, v161
    v_swap_b32 v130, v162
    v_swap_b32 v131, v163
    v_swap_b32 v132, v164
    v_swap_b32 v133, v165
    v_swap_b32 v134, v166
    v_swap_b32 v135, v167
    v_swap_b32 v136, v168
    v_swap_b32 v137, v169
    v_swap_b32 v138, v170
    v_swap_b32 v139, v171
    v_swap_b32 v140, v172
    v_swap_b32 v141, v173
    v_swap_b32 v142, v174
    v_swap_b32 v143, v175
    v_swap_b32 v144, v176
    v_swap_b32 v145, v177
    v_swap_b32 v146, v178
    v_swap_b32 v147, v179
    v_swap_b32 v148, v180
    v_swap_b32 v149, v181
    v_swap_b32 v150, v182
    v_swap_b32 v151, v183
    v_swap_b32 v152, v184
    v_swap_b32 v153, v185
    v_swap_b32 v154, v186
    v_swap_b32 v155, v187
    v_swap_b32 v156, v188
    v_swap_b32 v157, v189
    v_swap_b32 v158, v190
    v_swap_b32 v159, v191
    v_mov_b32 v40, v14
    v_mov_b32 v41, v14
    v_mov_b32 v42, v14
    v_mov_b32 v43, v14
    v_mov_b32 v44, v15
    v_mov_b32 v45, v15
    v_mov_b32 v46, v15
    v_mov_b32 v47, v15
    s_nop 1
    s_branch L_recurrent_scan__compressed_kv_cla__moe_arch_mod__prompt_kernel_back_125
L_recurrent_scan__compressed_kv_cla__moe_arch_mod__prompt_kernel_epi_126:
    v_mov_b32 v20, v8
    s_nop 1
    v_permlane16_swap_b32 v8, v20
    s_nop 1
    v_add_f32 v8, v8, v20
    v_mov_b32 v20, v8
    s_nop 1
    v_permlane32_swap_b32 v8, v20
    s_nop 1
    v_add_f32 v8, v8, v20
    v_mov_b32 v20, v9
    s_nop 1
    v_permlane16_swap_b32 v9, v20
    s_nop 1
    v_add_f32 v9, v9, v20
    v_mov_b32 v20, v9
    s_nop 1
    v_permlane32_swap_b32 v9, v20
    s_nop 1
    v_add_f32 v9, v9, v20
    s_mov_b32 s36, 0x5d800000
    v_cmp_nge_f32 vcc, s36, v8
    s_nop 0
    s_or_b64 s[52:53], s[52:53], vcc
    v_cmp_nge_f32 vcc, s36, v9
    s_nop 0
    s_or_b64 s[52:53], s[52:53], vcc
    v_rcp_f32 v8, v8
    v_rcp_f32 v9, v9
    s_lshl_b32 s38, s30, 3
    s_and_b32 s37, s28, 3
    s_lshl_b32 s37, s37, 1
    s_add_u32 s38, s38, s37
    s_lshl_b32 s38, s38, 17
    s_lshl_b32 s37, s29, 12
    s_add_u32 s38, s38, s37
    v_pk_mul_f32 v[192:193], v[192:193], v[8:9] op_sel:[0,0] op_sel_hi:[1,0]
    v_pk_mul_f32 v[194:195], v[194:195], v[8:9] op_sel:[0,0] op_sel_hi:[1,0]
    v_pk_mul_f32 v[196:197], v[196:197], v[8:9] op_sel:[0,0] op_sel_hi:[1,0]
    v_pk_mul_f32 v[198:199], v[198:199], v[8:9] op_sel:[0,0] op_sel_hi:[1,0]
    v_cvt_pk_bf16_f32 v22, v192, v193
    v_cvt_pk_bf16_f32 v23, v194, v195
    v_cvt_pk_bf16_f32 v24, v196, v197
    v_cvt_pk_bf16_f32 v25, v198, v199
    buffer_store_dwordx4 v[22:25], v7, s[16:19], s38 offen offset:0 sc1
    v_mov_b64 v[192:193], 0
    v_mov_b64 v[194:195], 0
    v_mov_b64 v[196:197], 0
    v_mov_b64 v[198:199], 0
    v_pk_mul_f32 v[200:201], v[200:201], v[8:9] op_sel:[0,0] op_sel_hi:[1,0]
    v_pk_mul_f32 v[202:203], v[202:203], v[8:9] op_sel:[0,0] op_sel_hi:[1,0]
    v_pk_mul_f32 v[204:205], v[204:205], v[8:9] op_sel:[0,0] op_sel_hi:[1,0]
    v_pk_mul_f32 v[206:207], v[206:207], v[8:9] op_sel:[0,0] op_sel_hi:[1,0]
    v_cvt_pk_bf16_f32 v26, v200, v201
    v_cvt_pk_bf16_f32 v27, v202, v203
    v_cvt_pk_bf16_f32 v28, v204, v205
    v_cvt_pk_bf16_f32 v29, v206, v207
    buffer_store_dwordx4 v[26:29], v7, s[16:19], s38 offen offset:1024 sc1
    v_mov_b64 v[200:201], 0
    v_mov_b64 v[202:203], 0
    v_mov_b64 v[204:205], 0
    v_mov_b64 v[206:207], 0
    v_pk_mul_f32 v[208:209], v[208:209], v[8:9] op_sel:[0,0] op_sel_hi:[1,0]
    v_pk_mul_f32 v[210:211], v[210:211], v[8:9] op_sel:[0,0] op_sel_hi:[1,0]
    v_pk_mul_f32 v[212:213], v[212:213], v[8:9] op_sel:[0,0] op_sel_hi:[1,0]
    v_pk_mul_f32 v[214:215], v[214:215], v[8:9] op_sel:[0,0] op_sel_hi:[1,0]
    v_cvt_pk_bf16_f32 v30, v208, v209
    v_cvt_pk_bf16_f32 v31, v210, v211
    v_cvt_pk_bf16_f32 v32, v212, v213
    v_cvt_pk_bf16_f32 v33, v214, v215
    buffer_store_dwordx4 v[30:33], v7, s[16:19], s38 offen offset:2048 sc1
    v_mov_b64 v[208:209], 0
    v_mov_b64 v[210:211], 0
    v_mov_b64 v[212:213], 0
    v_mov_b64 v[214:215], 0
    v_pk_mul_f32 v[216:217], v[216:217], v[8:9] op_sel:[0,0] op_sel_hi:[1,0]
    v_pk_mul_f32 v[218:219], v[218:219], v[8:9] op_sel:[0,0] op_sel_hi:[1,0]
    v_pk_mul_f32 v[220:221], v[220:221], v[8:9] op_sel:[0,0] op_sel_hi:[1,0]
    v_pk_mul_f32 v[222:223], v[222:223], v[8:9] op_sel:[0,0] op_sel_hi:[1,0]
    v_cvt_pk_bf16_f32 v34, v216, v217
    v_cvt_pk_bf16_f32 v35, v218, v219
    v_cvt_pk_bf16_f32 v36, v220, v221
    v_cvt_pk_bf16_f32 v37, v222, v223
    buffer_store_dwordx4 v[34:37], v7, s[16:19], s38 offen offset:3072 sc1
    v_mov_b64 v[216:217], 0
    v_mov_b64 v[218:219], 0
    v_mov_b64 v[220:221], 0
    v_mov_b64 v[222:223], 0
    s_add_u32 s38, s38, 131072
    v_pk_mul_f32 v[224:225], v[224:225], v[8:9] op_sel:[0,1] op_sel_hi:[1,1]
    v_pk_mul_f32 v[226:227], v[226:227], v[8:9] op_sel:[0,1] op_sel_hi:[1,1]
    v_pk_mul_f32 v[228:229], v[228:229], v[8:9] op_sel:[0,1] op_sel_hi:[1,1]
    v_pk_mul_f32 v[230:231], v[230:231], v[8:9] op_sel:[0,1] op_sel_hi:[1,1]
    v_cvt_pk_bf16_f32 v22, v224, v225
    v_cvt_pk_bf16_f32 v23, v226, v227
    v_cvt_pk_bf16_f32 v24, v228, v229
    v_cvt_pk_bf16_f32 v25, v230, v231
    buffer_store_dwordx4 v[22:25], v7, s[16:19], s38 offen offset:0 sc1
    v_mov_b64 v[224:225], 0
    v_mov_b64 v[226:227], 0
    v_mov_b64 v[228:229], 0
    v_mov_b64 v[230:231], 0
    v_pk_mul_f32 v[232:233], v[232:233], v[8:9] op_sel:[0,1] op_sel_hi:[1,1]
    v_pk_mul_f32 v[234:235], v[234:235], v[8:9] op_sel:[0,1] op_sel_hi:[1,1]
    v_pk_mul_f32 v[236:237], v[236:237], v[8:9] op_sel:[0,1] op_sel_hi:[1,1]
    v_pk_mul_f32 v[238:239], v[238:239], v[8:9] op_sel:[0,1] op_sel_hi:[1,1]
    v_cvt_pk_bf16_f32 v26, v232, v233
    v_cvt_pk_bf16_f32 v27, v234, v235
    v_cvt_pk_bf16_f32 v28, v236, v237
    v_cvt_pk_bf16_f32 v29, v238, v239
    buffer_store_dwordx4 v[26:29], v7, s[16:19], s38 offen offset:1024 sc1
    v_mov_b64 v[232:233], 0
    v_mov_b64 v[234:235], 0
    v_mov_b64 v[236:237], 0
    v_mov_b64 v[238:239], 0
    v_pk_mul_f32 v[240:241], v[240:241], v[8:9] op_sel:[0,1] op_sel_hi:[1,1]
    v_pk_mul_f32 v[242:243], v[242:243], v[8:9] op_sel:[0,1] op_sel_hi:[1,1]
    v_pk_mul_f32 v[244:245], v[244:245], v[8:9] op_sel:[0,1] op_sel_hi:[1,1]
    v_pk_mul_f32 v[246:247], v[246:247], v[8:9] op_sel:[0,1] op_sel_hi:[1,1]
    v_cvt_pk_bf16_f32 v30, v240, v241
    v_cvt_pk_bf16_f32 v31, v242, v243
    v_cvt_pk_bf16_f32 v32, v244, v245
    v_cvt_pk_bf16_f32 v33, v246, v247
    buffer_store_dwordx4 v[30:33], v7, s[16:19], s38 offen offset:2048 sc1
    v_mov_b64 v[240:241], 0
    v_mov_b64 v[242:243], 0
    v_mov_b64 v[244:245], 0
    v_mov_b64 v[246:247], 0
    v_pk_mul_f32 v[248:249], v[248:249], v[8:9] op_sel:[0,1] op_sel_hi:[1,1]
    v_pk_mul_f32 v[250:251], v[250:251], v[8:9] op_sel:[0,1] op_sel_hi:[1,1]
    v_pk_mul_f32 v[252:253], v[252:253], v[8:9] op_sel:[0,1] op_sel_hi:[1,1]
    v_pk_mul_f32 v[254:255], v[254:255], v[8:9] op_sel:[0,1] op_sel_hi:[1,1]
    v_cvt_pk_bf16_f32 v34, v248, v249
    v_cvt_pk_bf16_f32 v35, v250, v251
    v_cvt_pk_bf16_f32 v36, v252, v253
    v_cvt_pk_bf16_f32 v37, v254, v255
    buffer_store_dwordx4 v[34:37], v7, s[16:19], s38 offen offset:3072 sc1
    v_mov_b64 v[248:249], 0
    v_mov_b64 v[250:251], 0
    v_mov_b64 v[252:253], 0
    v_mov_b64 v[254:255], 0
    s_branch L_recurrent_scan__compressed_kv_cla__moe_arch_mod__prompt_kernel_back_125
L_recurrent_scan__compressed_kv_cla__moe_arch_mod__prompt_kernel_rare_137:
    s_cmp_eq_u32 s40, 1
    s_cbranch_scc0 L_recurrent_scan__compressed_kv_cla__moe_arch_mod__prompt_kernel_nm_127
    ds_read_b64 v[14:15], v19
    s_waitcnt lgkmcnt(0)
L_recurrent_scan__compressed_kv_cla__moe_arch_mod__prompt_kernel_nm_127:
    s_cmp_eq_u32 s40, 1
    s_cbranch_scc0 L_recurrent_scan__compressed_kv_cla__moe_arch_mod__prompt_kernel_swn_130
    s_cmp_lt_u32 s2, 128
    s_cbranch_scc1 L_recurrent_scan__compressed_kv_cla__moe_arch_mod__prompt_kernel_bt_128
    v_add_u32 v11, 0, v13
    v_min_u32 v11, 7339904, v11
    s_waitcnt vmcnt(3)
    s_mov_b32 exec_hi, 0
    global_load_dword v10, v11, s[34:35]
    s_mov_b32 exec_hi, -1
    s_nop 1
L_recurrent_scan__compressed_kv_cla__moe_arch_mod__prompt_kernel_bt_128:
    s_branch L_recurrent_scan__compressed_kv_cla__moe_arch_mod__prompt_kernel_swend_129
L_recurrent_scan__compressed_kv_cla__moe_arch_mod__prompt_kernel_swn_130:
    s_cmp_eq_u32 s40, 2
    s_cbranch_scc0 L_recurrent_scan__compressed_kv_cla__moe_arch_mod__prompt_kernel_swn_131
    v_add_u32 v11, 4096, v13
    v_min_u32 v11, 7339904, v11
    s_waitcnt vmcnt(3)
    s_mov_b32 exec_hi, 0
    global_load_dword v16, v11, s[34:35]
    s_mov_b32 exec_hi, -1
    s_nop 1
    s_branch L_recurrent_scan__compressed_kv_cla__moe_arch_mod__prompt_kernel_swend_129
L_recurrent_scan__compressed_kv_cla__moe_arch_mod__prompt_kernel_swn_131:
    s_cmp_eq_u32 s40, 3
    s_cbranch_scc0 L_recurrent_scan__compressed_kv_cla__moe_arch_mod__prompt_kernel_swn_132
    v_add_u32 v11, 8192, v13
    v_min_u32 v11, 7339904, v11
    s_waitcnt vmcnt(3)
    s_mov_b32 exec_hi, 0
    global_load_dword v17, v11, s[34:35]
    s_mov_b32 exec_hi, -1
    s_nop 1
    s_branch L_recurrent_scan__compressed_kv_cla__moe_arch_mod__prompt_kernel_swend_129
L_recurrent_scan__compressed_kv_cla__moe_arch_mod__prompt_kernel_swn_132:
    s_cmp_eq_u32 s40, 4
    s_cbranch_scc0 L_recurrent_scan__compressed_kv_cla__moe_arch_mod__prompt_kernel_swn_133
    v_add_u32 v11, 12288, v13
    v_min_u32 v11, 7339904, v11
    s_waitcnt vmcnt(3)
    s_mov_b32 exec_hi, 0
    global_load_dword v0, v11, s[34:35]
    s_mov_b32 exec_hi, -1
    s_nop 1
    s_branch L_recurrent_scan__compressed_kv_cla__moe_arch_mod__prompt_kernel_swend_129
L_recurrent_scan__compressed_kv_cla__moe_arch_mod__prompt_kernel_swn_133:
    s_cmp_eq_u32 s40, 5
    s_cbranch_scc0 L_recurrent_scan__compressed_kv_cla__moe_arch_mod__prompt_kernel_swn_134
    v_add_u32 v11, 0, v13
    v_min_u32 v11, 8388480, v11
    s_waitcnt vmcnt(3)
    s_mov_b32 exec_hi, 0
    global_load_dword v10, v11, s[32:33]
    s_mov_b32 exec_hi, -1
    s_nop 1
    s_branch L_recurrent_scan__compressed_kv_cla__moe_arch_mod__prompt_kernel_swend_129
L_recurrent_scan__compressed_kv_cla__moe_arch_mod__prompt_kernel_swn_134:
    s_cmp_eq_u32 s40, 6
    s_cbranch_scc0 L_recurrent_scan__compressed_kv_cla__moe_arch_mod__prompt_kernel_swn_135
    v_add_u32 v11, 4096, v13
    v_min_u32 v11, 8388480, v11
    s_waitcnt vmcnt(3)
    s_mov_b32 exec_hi, 0
    global_load_dword v16, v11, s[32:33]
    s_mov_b32 exec_hi, -1
    s_nop 1
    s_branch L_recurrent_scan__compressed_kv_cla__moe_arch_mod__prompt_kernel_swend_129
L_recurrent_scan__compressed_kv_cla__moe_arch_mod__prompt_kernel_swn_135:
    s_cmp_eq_u32 s40, 7
    s_cbranch_scc0 L_recurrent_scan__compressed_kv_cla__moe_arch_mod__prompt_kernel_swn_136
    v_add_u32 v11, 8192, v13
    v_min_u32 v11, 8388480, v11
    s_waitcnt vmcnt(3)
    s_mov_b32 exec_hi, 0
    global_load_dword v17, v11, s[32:33]
    s_mov_b32 exec_hi, -1
    s_nop 1
    s_branch L_recurrent_scan__compressed_kv_cla__moe_arch_mod__prompt_kernel_swend_129
L_recurrent_scan__compressed_kv_cla__moe_arch_mod__prompt_kernel_swn_136:
    v_add_u32 v11, 12288, v13
    v_min_u32 v11, 8388480, v11
    s_waitcnt vmcnt(3)
    s_mov_b32 exec_hi, 0
    global_load_dword v0, v11, s[32:33]
    s_mov_b32 exec_hi, -1
    s_nop 1
L_recurrent_scan__compressed_kv_cla__moe_arch_mod__prompt_kernel_swend_129:
    s_branch L_recurrent_scan__compressed_kv_cla__moe_arch_mod__prompt_kernel_back_138
L_recurrent_scan__compressed_kv_cla__moe_arch_mod__prompt_kernel_rare_141:
    s_mov_b32 s61, 0x40000
L_recurrent_scan__compressed_kv_cla__moe_arch_mod__prompt_kernel_spin_139:
    s_sub_u32 s61, s61, 1
    s_cbranch_scc1 L_recurrent_scan__compressed_kv_cla__moe_arch_mod__prompt_kernel_spinx_140
    s_sleep 8
    global_load_dword v11, v12, s[90:91] sc1
    s_waitcnt vmcnt(0)
    v_readfirstlane_b32 s36, v11
    s_nop 0
    s_cmp_lt_u32 s36, 28
    s_cbranch_scc1 L_recurrent_scan__compressed_kv_cla__moe_arch_mod__prompt_kernel_spin_139
L_recurrent_scan__compressed_kv_cla__moe_arch_mod__prompt_kernel_spinx_140:
    s_branch L_recurrent_scan__compressed_kv_cla__moe_arch_mod__prompt_kernel_back_142
L_recurrent_scan__compressed_kv_cla__moe_arch_mod__prompt_kernel_rare_146:
    v_mov_b32 v20, 4048155338
    v_subrev_u32 v21, s50, v18
    v_cmp_gt_i32 s[20:21], 0, v21
    v_cmp_gt_i32 s[22:23], 1, v21
    v_cmp_gt_i32 s[62:63], 2, v21
    v_cmp_gt_i32 vcc, 3, v21
    v_cndmask_b32 v96, v96, v20, s[20:21]
    v_cndmask_b32 v97, v97, v20, s[22:23]
    v_cndmask_b32 v98, v98, v20, s[62:63]
    v_cndmask_b32 v99, v99, v20, vcc
    v_cmp_gt_i32 s[20:21], 16, v21
    v_cmp_gt_i32 s[22:23], 17, v21
    v_cmp_gt_i32 s[62:63], 18, v21
    v_cmp_gt_i32 vcc, 19, v21
    v_cndmask_b32 v100, v100, v20, s[20:21]
    v_cndmask_b32 v101, v101, v20, s[22:23]
    v_cndmask_b32 v102, v102, v20, s[62:63]
    v_cndmask_b32 v103, v103, v20, vcc
    v_cmp_gt_i32 s[20:21], -16, v21
    v_cmp_gt_i32 s[22:23], -15, v21
    v_cmp_gt_i32 s[62:63], -14, v21
    v_cmp_gt_i32 vcc, -13, v21
    v_cndmask_b32 v104, v104, v20, s[20:21]
    v_cndmask_b32 v105, v105, v20, s[22:23]
    v_cndmask_b32 v106, v106, v20, s[62:63]
    v_cndmask_b32 v107, v107, v20, vcc
    v_cmp_gt_i32 s[20:21], 0, v21
    v_cmp_gt_i32 s[22:23], 1, v21
    v_cmp_gt_i32 s[62:63], 2, v21
    v_cmp_gt_i32 vcc, 3, v21
    v_cndmask_b32 v108, v108, v20, s[20:21]
    v_cndmask_b32 v109, v109, v20, s[22:23]
    v_cndmask_b32 v110, v110, v20, s[62:63]
    v_cndmask_b32 v111, v111, v20, vcc
    s_branch L_recurrent_scan__compressed_kv_cla__moe_arch_mod__prompt_kernel_back_147
L_p3_done:
    s_waitcnt vmcnt(4)
    s_and_b32 s36, s2, 7
    s_lshl_b32 s36, s36, 2
    s_sub_u32 s40, 47, s30
    s_lshl_b32 s40, s40, 7
    s_add_u32 s40, s40, s36
    s_add_u32 s41, s30, 32
    s_lshl_b32 s41, s41, 7
    s_add_u32 s41, s41, s36
    s_and_b32 s63, s30, 1
    s_bfe_u32 s36, s2, 0x10002
    s_lshl_b32 s36, s36, 3
    s_add_u32 s30, s30, s36
    s_and_b32 s29, s29, 15
    s_and_b32 s36, s28, 3
    s_lshl_b32 s37, s29, 2
    s_add_u32 s36, s36, s37
    s_lshl_b32 s36, s36, 18
    s_lshr_b32 s37, s28, 2
    s_lshl_b32 s37, s37, 12
    s_add_u32 s36, s36, s37
    s_lshl_b32 s37, s63, 16
    s_add_u32 s36, s36, s37
    v_lshl_add_u32 v2, v1, 4, s36
    v_add_u32 v3, 131072, v2
    v_lshrrev_b32 v19, 4, v1
    s_lshr_b32 s36, s28, 2
    s_lshl_b32 s36, s36, 7
    s_and_b32 s37, s28, 3
    s_lshl_b32 s37, s37, 4
    s_add_u32 s36, s36, s37
    s_lshl_b32 s33, s36, 8
    s_lshl_b32 s37, s63, 11
    s_add_u32 s36, s36, s37
    v_add_u32 v18, s36, v19
    v_lshlrev_b32 v18, 11, v18
    s_lshr_b32 s36, s30, 1
    s_lshl_b32 s36, s36, 8
    v_add_u32 v18, s36, v18
    v_lshlrev_b32 v20, 1, v19
    v_and_b32 v21, 15, v1
    v_xor_b32 v20, v20, v21
    v_lshl_add_u32 v6, v20, 4, v18
    v_xor_b32 v20, 8, v20
    v_lshl_add_u32 v7, v20, 4, v18
    v_add_u32 v7, 7168, v7
    v_add_u32 v8, 14336, v6
    v_add_u32 v9, 14336, v7
    s_add_u32 s36, s2, 1
    s_and_b32 s62, s36, 3
    s_lshl_b32 s31, s62, 14
    s_lshl_b32 s32, s62, 20
    s_waitcnt vmcnt(0)
    s_barrier
    s_cmp_eq_u32 s28, 0
    s_cbranch_scc1 L_recurrent_scan__compressed_kv_cla__moe_arch_mod__prompt_kernel_rare_148
L_recurrent_scan__compressed_kv_cla__moe_arch_mod__prompt_kernel_back_149:
    s_bitcmp1_b32 0x70, s28
    s_cbranch_scc1 L_recurrent_scan__compressed_kv_cla__moe_arch_mod__prompt_kernel_f2m_175
L_recurrent_scan__compressed_kv_cla__moe_arch_mod__prompt_kernel_f2a_176:
    s_mov_b32 s34, s33
    s_add_u32 m0, s34, 65536
    s_nop 0
    buffer_load_dwordx4 v6, s[8:11], s32 offen offset:0 lds
    buffer_load_dwordx4 v7, s[8:11], s32 offen offset:1024 lds
    buffer_load_dwordx4 v8, s[8:11], s32 offen offset:2048 lds
    buffer_load_dwordx4 v9, s[8:11], s32 offen offset:3072 lds
    s_add_u32 s32, s32, 131072
    s_add_u32 m0, s34, 81920
    s_nop 0
    buffer_load_dwordx4 v6, s[8:11], s32 offen offset:0 lds
    buffer_load_dwordx4 v7, s[8:11], s32 offen offset:1024 lds
    buffer_load_dwordx4 v8, s[8:11], s32 offen offset:2048 lds
    buffer_load_dwordx4 v9, s[8:11], s32 offen offset:3072 lds
    s_add_u32 s32, s32, 393216
    s_and_b32 s32, s32, 0x3fffff
    s_add_u32 m0, s34, 0
    s_nop 0
    buffer_load_dwordx4 v6, s[8:11], s32 offen offset:0 lds
    buffer_load_dwordx4 v7, s[8:11], s32 offen offset:1024 lds
    buffer_load_dwordx4 v8, s[8:11], s32 offen offset:2048 lds
    buffer_load_dwordx4 v9, s[8:11], s32 offen offset:3072 lds
    s_add_u32 s32, s32, 131072
    s_add_u32 m0, s34, 16384
    s_nop 0
    buffer_load_dwordx4 v6, s[8:11], s32 offen offset:0 lds
    buffer_load_dwordx4 v7, s[8:11], s32 offen offset:1024 lds
    buffer_load_dwordx4 v8, s[8:11], s32 offen offset:2048 lds
    buffer_load_dwordx4 v9, s[8:11], s32 offen offset:3072 lds
    s_add_u32 s32, s32, 393216
    s_and_b32 s32, s32, 0x3fffff
    s_cmp_lt_u32 s28, 4
    s_cbranch_scc1 L_recurrent_scan__compressed_kv_cla__moe_arch_mod__prompt_kernel_f2m_175
L_recurrent_scan__compressed_kv_cla__moe_arch_mod__prompt_kernel_f2b_177:
    s_add_u32 s4, s54, 41943040
    s_addc_u32 s5, s55, 0
    s_and_b32 s5, s5, 0xffff
    s_mov_b32 s6, 16777216
    s_mov_b32 s7, 0x20000
    s_mov_b32 s16, s96
    s_and_b32 s17, s97, 0xffff
    s_mov_b32 s18, 4194304
    s_mov_b32 s19, 0x20000
    s_mov_b32 s20, s98
    s_and_b32 s21, s99, 0xffff
    s_mov_b32 s22, 4194304
    s_mov_b32 s23, 0x20000
    s_lshl_b32 s36, s29, 7
    s_and_b32 s37, s28, 3
    s_lshl_b32 s37, s37, 5
    s_add_u32 s36, s36, s37
    s_lshr_b32 s37, s28, 2
    s_lshl_b32 s37, s37, 4
    s_add_u32 s38, s36, s37
    v_and_b32 v17, 15, v1
    v_add_u32 v14, s38, v17
    v_lshlrev_b32 v16, 3, v14
    v_lshrrev_b32 v15, 3, v1
    v_add_u32 v15, s38, v15
    v_lshlrev_b32 v15, 11, v15
    v_and_b32 v4, 7, v1
    v_lshl_add_u32 v15, v4, 4, v15
    s_lshl_b32 s36, s30, 7
    v_add_u32 v15, s36, v15
    s_lshl_b32 s36, s28, 12
    s_add_u32 s42, s36, 131072
    v_lshl_add_u32 v17, v17, 7, s42
    v_lshl_add_u32 v17, v19, 3, v17
    v_bfe_u32 v20, v1, 2, 2
    v_lshl_add_u32 v18, v19, 2, v20
    v_and_b32 v20, 7, v18
    v_lshlrev_b32 v18, 8, v18
    s_lshr_b32 s36, s28, 2
    s_lshl_b32 s36, s36, 15
    s_add_u32 s36, s36, 65536
    v_add_u32 v18, s36, v18
    v_and_b32 v21, 3, v1
    v_lshl_add_u32 v18, v21, 3, v18
    v_xor_b32 v21, 0, v20
    v_lshl_add_u32 v50, v21, 5, v18
    v_xor_b32 v21, 1, v20
    v_lshl_add_u32 v51, v21, 5, v18
    v_xor_b32 v21, 2, v20
    v_lshl_add_u32 v52, v21, 5, v18
    v_xor_b32 v21, 3, v20
    v_lshl_add_u32 v53, v21, 5, v18
    v_xor_b32 v21, 4, v20
    v_lshl_add_u32 v54, v21, 5, v18
    v_xor_b32 v21, 5, v20
    v_lshl_add_u32 v55, v21, 5, v18
    v_xor_b32 v21, 6, v20
    v_lshl_add_u32 v56, v21, 5, v18
    v_xor_b32 v21, 7, v20
    v_lshl_add_u32 v57, v21, 5, v18
    v_mov_b64 v[192:193], 0
    v_mov_b64 v[194:195], 0
    v_mov_b64 v[196:197], 0
    v_mov_b64 v[198:199], 0
    v_mov_b64 v[200:201], 0
    v_mov_b64 v[202:203], 0
    v_mov_b64 v[204:205], 0
    v_mov_b64 v[206:207], 0
    v_mov_b64 v[208:209], 0
    v_mov_b64 v[210:211], 0
    v_mov_b64 v[212:213], 0
    v_mov_b64 v[214:215], 0
    v_mov_b64 v[216:217], 0
    v_mov_b64 v[218:219], 0
    v_mov_b64 v[220:221], 0
    v_mov_b64 v[222:223], 0
    v_mov_b64 v[224:225], 0
    v_mov_b64 v[226:227], 0
    v_mov_b64 v[228:229], 0
    v_mov_b64 v[230:231], 0
    v_mov_b64 v[232:233], 0
    v_mov_b64 v[234:235], 0
    v_mov_b64 v[236:237], 0
    v_mov_b64 v[238:239], 0
    v_mov_b64 v[240:241], 0
    v_mov_b64 v[242:243], 0
    v_mov_b64 v[244:245], 0
    v_mov_b64 v[246:247], 0
    v_mov_b64 v[248:249], 0
    v_mov_b64 v[250:251], 0
    v_mov_b64 v[252:253], 0
    v_mov_b64 v[254:255], 0
    s_mov_b32 s60, 15
    s_cmp_eq_u32 s28, 3
    s_cbranch_scc0 L_recurrent_scan__compressed_kv_cla__moe_arch_mod__prompt_kernel_w7j_178
    v_add_u32 v58, s62, v1
    v_and_b32 v58, 3, v58
    s_add_u32 s36, s29, 32
    s_lshl_b32 s36, s36, 7
    s_lshl_b32 s37, s63, 4
    s_add_u32 s36, s36, s37
    v_lshl_add_u32 v58, v58, 2, s36
    s_mov_b32 s61, 0x40000
L_recurrent_scan__compressed_kv_cla__moe_arch_mod__prompt_kernel_cspin_179:
    s_sub_u32 s61, s61, 1
    s_cbranch_scc1 L_recurrent_scan__compressed_kv_cla__moe_arch_mod__prompt_kernel_cspinx_180
    global_load_dword v59, v58, s[90:91] sc1
    s_waitcnt vmcnt(0)
L_recurrent_scan__compressed_kv_cla__moe_arch_mod__prompt_kernel_cchk_181:
    v_cmp_le_u32 vcc, 4, v59
    s_nop 0
    s_and_b32 s60, vcc_lo, 15
    s_and_b32 s36, s60, 3
    s_cmp_eq_u32 s36, 3
    s_cbranch_scc1 L_recurrent_scan__compressed_kv_cla__moe_arch_mod__prompt_kernel_cspinx_180
    s_sleep 6
    s_branch L_recurrent_scan__compressed_kv_cla__moe_arch_mod__prompt_kernel_cspin_179
L_recurrent_scan__compressed_kv_cla__moe_arch_mod__prompt_kernel_cspinx_180:
L_recurrent_scan__compressed_kv_cla__moe_arch_mod__prompt_kernel_w7j_178:
    s_waitcnt vmcnt(12)
    s_waitcnt lgkmcnt(0)
    s_barrier
    buffer_load_dwordx4 v[128:131], v2, s[4:7], s31 offen offset:0 sc1
    buffer_load_dwordx4 v[132:135], v3, s[4:7], s31 offen offset:0 sc1
    buffer_load_dwordx4 v[136:139], v2, s[4:7], s31 offen offset:1024 sc1
    buffer_load_dwordx4 v[140:143], v3, s[4:7], s31 offen offset:1024 sc1
    buffer_load_dwordx4 v[144:147], v2, s[4:7], s31 offen offset:2048 sc1
    buffer_load_dwordx4 v[148:151], v3, s[4:7], s31 offen offset:2048 sc1
    buffer_load_dwordx4 v[152:155], v2, s[4:7], s31 offen offset:3072 sc1
    buffer_load_dwordx4 v[156:159], v3, s[4:7], s31 offen offset:3072 sc1
    s_add_u32 s31, s31, 8192
    s_and_b32 s31, s31, 0xffff
    s_cmp_lt_u32 s28, 4
    s_cbranch_scc0 L_recurrent_scan__compressed_kv_cla__moe_arch_mod__prompt_kernel_g_150
    s_lshl_b32 s36, s28, 10
    s_add_u32 s36, s36, 131072
    v_lshl_add_u32 v28, v1, 4, s36
    ds_read_b128 v[96:99], v28 offset:0
    ds_read_b128 v[100:103], v28 offset:4096
    ds_read_b128 v[104:107], v28 offset:8192
    ds_read_b128 v[108:111], v28 offset:12288
    ds_read_b128 v[112:115], v28 offset:16384
    ds_read_b128 v[116:119], v28 offset:20480
    ds_read_b128 v[120:123], v28 offset:24576
    s_lshr_b32 s36, s2, 4
    s_lshl_b32 s36, s36, 13
    s_and_b32 s37, s2, 15
    s_lshl_b32 s37, s37, 8
    s_add_u32 s36, s36, s37
    s_lshl_b32 s37, s28, 6
    s_add_u32 s36, s36, s37
    s_add_u32 s36, s36, 59768832
    v_and_b32 v28, 1, v1
    v_lshlrev_b32 v28, 12, v28
    v_lshl_add_u32 v28, v19, 4, v28
    s_waitcnt lgkmcnt(0)
    v_add_f32 v96, v96, v100
    v_add_f32 v97, v97, v101
    v_add_f32 v98, v98, v102
    v_add_f32 v99, v99, v103
    v_add_f32 v96, v96, v104
    v_add_f32 v97, v97, v105
    v_add_f32 v98, v98, v106
    v_add_f32 v99, v99, v107
    v_add_f32 v96, v96, v108
    v_add_f32 v97, v97, v109
    v_add_f32 v98, v98, v110
    v_add_f32 v99, v99, v111
    v_add_f32 v96, v96, v112
    v_add_f32 v97, v97, v113
    v_add_f32 v98, v98, v114
    v_add_f32 v99, v99, v115
    v_add_f32 v96, v96, v116
    v_add_f32 v97, v97, v117
    v_add_f32 v98, v98, v118
    v_add_f32 v99, v99, v119
    v_add_f32 v96, v96, v120
    v_add_f32 v97, v97, v121
    v_add_f32 v98, v98, v122
    v_add_f32 v99, v99, v123
    s_mov_b32 exec_lo, 0x00030003
    s_mov_b32 exec_hi, 0x00030003
    buffer_store_dwordx4 v[96:99], v28, s[24:27], s36 offen sc1
    s_mov_b64 exec, -1
    s_nop 3
L_recurrent_scan__compressed_kv_cla__moe_arch_mod__prompt_kernel_g_150:
    s_lshl_b32 s36, s28, 13
    s_add_u32 s36, s36, 65536
    v_lshl_add_u32 v20, v1, 4, s36
    v_xor_b32 v21, 32768, v20
    ds_read_b64_tr_b16 v[64:65], v50 offset:0
    ds_read_b64_tr_b16 v[66:67], v50 offset:4096
    ds_read_b64_tr_b16 v[68:69], v51 offset:0
    ds_read_b64_tr_b16 v[70:71], v51 offset:4096
    ds_read_b64_tr_b16 v[72:73], v52 offset:0
    ds_read_b64_tr_b16 v[74:75], v52 offset:4096
    ds_read_b64_tr_b16 v[76:77], v53 offset:0
    ds_read_b64_tr_b16 v[78:79], v53 offset:4096
    ds_read_b64_tr_b16 v[80:81], v54 offset:0
    ds_read_b64_tr_b16 v[82:83], v54 offset:4096
    ds_read_b64_tr_b16 v[84:85], v55 offset:0
    ds_read_b64_tr_b16 v[86:87], v55 offset:4096
    s_mov_b32 s35, 0
    s_waitcnt vmcnt(0)
    buffer_load_dwordx4 v[160:163], v2, s[4:7], s31 offen offset:0 sc1
    buffer_load_dwordx4 v[164:167], v3, s[4:7], s31 offen offset:0 sc1
    buffer_load_dwordx4 v[168:171], v2, s[4:7], s31 offen offset:1024 sc1
    buffer_load_dwordx4 v[172:175], v3, s[4:7], s31 offen offset:1024 sc1
    buffer_load_dwordx4 v[176:179], v2, s[4:7], s31 offen offset:2048 sc1
    buffer_load_dwordx4 v[180:183], v3, s[4:7], s31 offen offset:2048 sc1
    .p2align 6
L_p4_loop:
    s_cmp_lg_u32 s35, 0
    s_cbranch_scc1 L_recurrent_scan__compressed_kv_cla__moe_arch_mod__prompt_kernel_rare_158
L_recurrent_scan__compressed_kv_cla__moe_arch_mod__prompt_kernel_back_159:
    s_waitcnt lgkmcnt(8)
    v_mfma_f32_16x16x32_bf16 v[192:195], v[64:67], v[128:131], v[192:195]
    ds_read_b64_tr_b16 v[88:89], v56 offset:0
    v_mfma_f32_16x16x32_bf16 v[224:227], v[64:67], v[132:135], v[224:227]
    ds_read_b64_tr_b16 v[90:91], v56 offset:4096
    v_mfma_f32_16x16x32_bf16 v[196:199], v[68:71], v[128:131], v[196:199]
    ds_read_b64_tr_b16 v[92:93], v57 offset:0
    v_mfma_f32_16x16x32_bf16 v[228:231], v[68:71], v[132:135], v[228:231]
    ds_read_b64_tr_b16 v[94:95], v57 offset:4096
    buffer_load_dwordx4 v[184:187], v2, s[4:7], s31 offen offset:3072 sc1
    s_waitcnt lgkmcnt(8)
    v_mfma_f32_16x16x32_bf16 v[200:203], v[72:75], v[128:131], v[200:203]
    ds_read_b64_tr_b16 v[64:65], v50 offset:8192
    v_mfma_f32_16x16x32_bf16 v[232:235], v[72:75], v[132:135], v[232:235]
    ds_read_b64_tr_b16 v[66:67], v50 offset:12288
    v_mfma_f32_16x16x32_bf16 v[204:207], v[76:79], v[128:131], v[204:207]
    ds_read_b64_tr_b16 v[68:69], v51 offset:8192
    v_mfma_f32_16x16x32_bf16 v[236:239], v[76:79], v[132:135], v[236:239]
    ds_read_b64_tr_b16 v[70:71], v51 offset:12288
    s_waitcnt lgkmcnt(8)
    v_mfma_f32_16x16x32_bf16 v[208:211], v[80:83], v[128:131], v[208:211]
    ds_read_b64_tr_b16 v[72:73], v52 offset:8192
    v_mfma_f32_16x16x32_bf16 v[240:243], v[80:83], v[132:135], v[240:243]
    ds_read_b64_tr_b16 v[74:75], v52 offset:12288
    buffer_load_dwordx4 v[188:191], v3, s[4:7], s31 offen offset:3072 sc1
    s_add_u32 s31, s31, 8192
    s_and_b32 s31, s31, 0xffff
    v_mfma_f32_16x16x32_bf16 v[212:215], v[84:87], v[128:131], v[212:215]
    ds_read_b64_tr_b16 v[76:77], v53 offset:8192
    s_cmp_lt_u32 s35, 3
    s_cselect_b32 s6, 16777216, 0
    s_cselect_b32 s10, 8388608, 0
    v_mfma_f32_16x16x32_bf16 v[244:247], v[84:87], v[132:135], v[244:247]
    ds_read_b64_tr_b16 v[78:79], v53 offset:12288
    s_cmp_lt_u32 s35, 3
    s_cselect_b32 s34, s33, 0x20000
    s_waitcnt lgkmcnt(8)
    v_mfma_f32_16x16x32_bf16 v[216:219], v[88:91], v[128:131], v[216:219]
    ds_read_b64_tr_b16 v[80:81], v54 offset:8192
    v_mfma_f32_16x16x32_bf16 v[248:251], v[88:91], v[132:135], v[248:251]
    ds_read_b64_tr_b16 v[82:83], v54 offset:12288
    v_mfma_f32_16x16x32_bf16 v[220:223], v[92:95], v[128:131], v[220:223]
    ds_read_b64_tr_b16 v[84:85], v55 offset:8192
    v_mfma_f32_16x16x32_bf16 v[252:255], v[92:95], v[132:135], v[252:255]
    ds_read_b64_tr_b16 v[86:87], v55 offset:12288
    s_waitcnt lgkmcnt(8)
    s_waitcnt vmcnt(24)
    v_mfma_f32_16x16x32_bf16 v[192:195], v[64:67], v[136:139], v[192:195]
    ds_read_b64_tr_b16 v[88:89], v56 offset:8192
    v_mfma_f32_16x16x32_bf16 v[224:227], v[64:67], v[140:143], v[224:227]
    ds_read_b64_tr_b16 v[90:91], v56 offset:12288
    buffer_load_dwordx4 v[128:131], v2, s[4:7], s31 offen offset:0 sc1
    v_mfma_f32_16x16x32_bf16 v[196:199], v[68:71], v[136:139], v[196:199]
    ds_read_b64_tr_b16 v[92:93], v57 offset:8192
    v_mfma_f32_16x16x32_bf16 v[228:231], v[68:71], v[140:143], v[228:231]
    ds_read_b64_tr_b16 v[94:95], v57 offset:12288
    s_waitcnt lgkmcnt(8)
    v_mfma_f32_16x16x32_bf16 v[200:203], v[72:75], v[136:139], v[200:203]
    v_mfma_f32_16x16x32_bf16 v[232:235], v[72:75], v[140:143], v[232:235]
    buffer_load_dwordx4 v[132:135], v3, s[4:7], s31 offen offset:0 sc1
    v_mfma_f32_16x16x32_bf16 v[204:207], v[76:79], v[136:139], v[204:207]
    v_mfma_f32_16x16x32_bf16 v[236:239], v[76:79], v[140:143], v[236:239]
    s_waitcnt lgkmcnt(0)
    s_waitcnt vmcnt(20)
    s_barrier
    v_mfma_f32_16x16x32_bf16 v[208:211], v[80:83], v[136:139], v[208:211]
    ds_read_b64_tr_b16 v[64:65], v50 offset:16384
    ds_read_b64_tr_b16 v[66:67], v50 offset:20480
    v_mfma_f32_16x16x32_bf16 v[240:243], v[80:83], v[140:143], v[240:243]
    ds_read_b64_tr_b16 v[68:69], v51 offset:16384
    ds_read_b64_tr_b16 v[70:71], v51 offset:20480
    s_add_u32 m0, s34, 65536
    v_mfma_f32_16x16x32_bf16 v[212:215], v[84:87], v[136:139], v[212:215]
    ds_read_b64_tr_b16 v[72:73], v52 offset:16384
    ds_read_b64_tr_b16 v[74:75], v52 offset:20480
    buffer_load_dwordx4 v6, s[8:11], s32 offen offset:0 lds
    v_mfma_f32_16x16x32_bf16 v[244:247], v[84:87], v[140:143], v[244:247]
    ds_read_b64_tr_b16 v[76:77], v53 offset:16384
    ds_read_b64_tr_b16 v[78:79], v53 offset:20480
    v_mfma_f32_16x16x32_bf16 v[216:219], v[88:91], v[136:139], v[216:219]
    ds_read_b64_tr_b16 v[80:81], v54 offset:16384
    ds_read_b64_tr_b16 v[82:83], v54 offset:20480
    buffer_load_dwordx4 v7, s[8:11], s32 offen offset:1024 lds
    v_mfma_f32_16x16x32_bf16 v[248:251], v[88:91], v[140:143], v[248:251]
    v_mfma_f32_16x16x32_bf16 v[220:223], v[92:95], v[136:139], v[220:223]
    ds_read_b64_tr_b16 v[84:85], v55 offset:16384
    ds_read_b64_tr_b16 v[86:87], v55 offset:20480
    buffer_load_dwordx4 v8, s[8:11], s32 offen offset:2048 lds
    v_mfma_f32_16x16x32_bf16 v[252:255], v[92:95], v[140:143], v[252:255]
    buffer_load_dwordx4 v9, s[8:11], s32 offen offset:3072 lds
    s_add_u32 s32, s32, 131072
    s_waitcnt lgkmcnt(8)
    v_mfma_f32_16x16x32_bf16 v[192:195], v[64:67], v[144:147], v[192:195]
    ds_read_b64_tr_b16 v[88:89], v56 offset:16384
    v_mfma_f32_16x16x32_bf16 v[224:227], v[64:67], v[148:151], v[224:227]
    ds_read_b64_tr_b16 v[90:91], v56 offset:20480
    v_mfma_f32_16x16x32_bf16 v[196:199], v[68:71], v[144:147], v[196:199]
    ds_read_b64_tr_b16 v[92:93], v57 offset:16384
    v_mfma_f32_16x16x32_bf16 v[228:231], v[68:71], v[148:151], v[228:231]
    ds_read_b64_tr_b16 v[94:95], v57 offset:20480
    buffer_load_dwordx4 v[136:139], v2, s[4:7], s31 offen offset:1024 sc1
    s_waitcnt lgkmcnt(8)
    v_mfma_f32_16x16x32_bf16 v[200:203], v[72:75], v[144:147], v[200:203]
    ds_read_b64_tr_b16 v[64:65], v50 offset:24576
    v_mfma_f32_16x16x32_bf16 v[232:235], v[72:75], v[148:151], v[232:235]
    ds_read_b64_tr_b16 v[66:67], v50 offset:28672
    v_xor_b32 v50, 65536, v50
    v_mfma_f32_16x16x32_bf16 v[204:207], v[76:79], v[144:147], v[204:207]
    ds_read_b64_tr_b16 v[68:69], v51 offset:24576
    v_mfma_f32_16x16x32_bf16 v[236:239], v[76:79], v[148:151], v[236:239]
    ds_read_b64_tr_b16 v[70:71], v51 offset:28672
    v_xor_b32 v51, 65536, v51
    s_waitcnt lgkmcnt(8)
    v_mfma_f32_16x16x32_bf16 v[208:211], v[80:83], v[144:147], v[208:211]
    ds_read_b64_tr_b16 v[72:73], v52 offset:24576
    v_mfma_f32_16x16x32_bf16 v[240:243], v[80:83], v[148:151], v[240:243]
    ds_read_b64_tr_b16 v[74:75], v52 offset:28672
    v_xor_b32 v52, 65536, v52
    buffer_load_dwordx4 v[140:143], v3, s[4:7], s31 offen offset:1024 sc1
    v_mfma_f32_16x16x32_bf16 v[212:215], v[84:87], v[144:147], v[212:215]
    ds_read_b64_tr_b16 v[76:77], v53 offset:24576
    v_mfma_f32_16x16x32_bf16 v[244:247], v[84:87], v[148:151], v[244:247]
    ds_read_b64_tr_b16 v[78:79], v53 offset:28672
    v_xor_b32 v53, 65536, v53
    s_waitcnt lgkmcnt(8)
    v_mfma_f32_16x16x32_bf16 v[216:219], v[88:91], v[144:147], v[216:219]
    ds_read_b64_tr_b16 v[80:81], v54 offset:24576
    v_mfma_f32_16x16x32_bf16 v[248:251], v[88:91], v[148:151], v[248:251]
    ds_read_b64_tr_b16 v[82:83], v54 offset:28672
    v_xor_b32 v54, 65536, v54
    v_mfma_f32_16x16x32_bf16 v[220:223], v[92:95], v[144:147], v[220:223]
    ds_read_b64_tr_b16 v[84:85], v55 offset:24576
    v_mfma_f32_16x16x32_bf16 v[252:255], v[92:95], v[148:151], v[252:255]
    ds_read_b64_tr_b16 v[86:87], v55 offset:28672
    v_xor_b32 v55, 65536, v55
    s_waitcnt lgkmcnt(8)
    s_waitcnt vmcnt(24)
    v_mfma_f32_16x16x32_bf16 v[192:195], v[64:67], v[152:155], v[192:195]
    ds_read_b64_tr_b16 v[88:89], v56 offset:24576
    v_mfma_f32_16x16x32_bf16 v[224:227], v[64:67], v[156:159], v[224:227]
    ds_read_b64_tr_b16 v[90:91], v56 offset:28672
    v_xor_b32 v56, 65536, v56
    buffer_load_dwordx4 v[144:147], v2, s[4:7], s31 offen offset:2048 sc1
    v_mfma_f32_16x16x32_bf16 v[196:199], v[68:71], v[152:155], v[196:199]
    ds_read_b64_tr_b16 v[92:93], v57 offset:24576
    v_mfma_f32_16x16x32_bf16 v[228:231], v[68:71], v[156:159], v[228:231]
    ds_read_b64_tr_b16 v[94:95], v57 offset:28672
    v_xor_b32 v57, 65536, v57
    s_waitcnt lgkmcnt(8)
    v_mfma_f32_16x16x32_bf16 v[200:203], v[72:75], v[152:155], v[200:203]
    v_mfma_f32_16x16x32_bf16 v[232:235], v[72:75], v[156:159], v[232:235]
    buffer_load_dwordx4 v[148:151], v3, s[4:7], s31 offen offset:2048 sc1
    v_mfma_f32_16x16x32_bf16 v[204:207], v[76:79], v[152:155], v[204:207]
    v_mfma_f32_16x16x32_bf16 v[236:239], v[76:79], v[156:159], v[236:239]
    s_waitcnt lgkmcnt(0)
    s_waitcnt vmcnt(20)
    s_barrier
    v_mfma_f32_16x16x32_bf16 v[208:211], v[80:83], v[152:155], v[208:211]
    ds_read_b64_tr_b16 v[64:65], v50 offset:0
    ds_read_b64_tr_b16 v[66:67], v50 offset:4096
    v_mfma_f32_16x16x32_bf16 v[240:243], v[80:83], v[156:159], v[240:243]
    ds_read_b64_tr_b16 v[68:69], v51 offset:0
    ds_read_b64_tr_b16 v[70:71], v51 offset:4096
    s_add_u32 m0, s34, 81920
    v_mfma_f32_16x16x32_bf16 v[212:215], v[84:87], v[152:155], v[212:215]
    ds_read_b64_tr_b16 v[72:73], v52 offset:0
    ds_read_b64_tr_b16 v[74:75], v52 offset:4096
    buffer_load_dwordx4 v6, s[8:11], s32 offen offset:0 lds
    v_mfma_f32_16x16x32_bf16 v[244:247], v[84:87], v[156:159], v[244:247]
    ds_read_b64_tr_b16 v[76:77], v53 offset:0
    ds_read_b64_tr_b16 v[78:79], v53 offset:4096
    v_mfma_f32_16x16x32_bf16 v[216:219], v[88:91], v[152:155], v[216:219]
    ds_read_b64_tr_b16 v[80:81], v54 offset:0
    ds_read_b64_tr_b16 v[82:83], v54 offset:4096
    buffer_load_dwordx4 v7, s[8:11], s32 offen offset:1024 lds
    v_mfma_f32_16x16x32_bf16 v[248:251], v[88:91], v[156:159], v[248:251]
    v_mfma_f32_16x16x32_bf16 v[220:223], v[92:95], v[152:155], v[220:223]
    ds_read_b64_tr_b16 v[84:85], v55 offset:0
    ds_read_b64_tr_b16 v[86:87], v55 offset:4096
    buffer_load_dwordx4 v8, s[8:11], s32 offen offset:2048 lds
    v_mfma_f32_16x16x32_bf16 v[252:255], v[92:95], v[156:159], v[252:255]
    buffer_load_dwordx4 v9, s[8:11], s32 offen offset:3072 lds
    s_add_u32 s32, s32, 393216
    s_and_b32 s32, s32, 0x3fffff
    s_cmp_eq_u32 s35, 2
    s_cbranch_scc1 L_recurrent_scan__compressed_kv_cla__moe_arch_mod__prompt_kernel_rare_161
L_recurrent_scan__compressed_kv_cla__moe_arch_mod__prompt_kernel_back_162:
    s_waitcnt lgkmcnt(8)
    s_waitcnt vmcnt(20)
    v_mfma_f32_16x16x32_bf16 v[192:195], v[64:67], v[160:163], v[192:195]
    ds_read_b64_tr_b16 v[88:89], v56 offset:0
    v_mfma_f32_16x16x32_bf16 v[224:227], v[64:67], v[164:167], v[224:227]
    ds_read_b64_tr_b16 v[90:91], v56 offset:4096
    v_mfma_f32_16x16x32_bf16 v[196:199], v[68:71], v[160:163], v[196:199]
    ds_read_b64_tr_b16 v[92:93], v57 offset:0
    v_mfma_f32_16x16x32_bf16 v[228:231], v[68:71], v[164:167], v[228:231]
    ds_read_b64_tr_b16 v[94:95], v57 offset:4096
    buffer_load_dwordx4 v[152:155], v2, s[4:7], s31 offen offset:3072 sc1
    s_waitcnt lgkmcnt(8)
    v_mfma_f32_16x16x32_bf16 v[200:203], v[72:75], v[160:163], v[200:203]
    ds_read_b64_tr_b16 v[64:65], v50 offset:8192
    v_mfma_f32_16x16x32_bf16 v[232:235], v[72:75], v[164:167], v[232:235]
    ds_read_b64_tr_b16 v[66:67], v50 offset:12288
    v_mfma_f32_16x16x32_bf16 v[204:207], v[76:79], v[160:163], v[204:207]
    ds_read_b64_tr_b16 v[68:69], v51 offset:8192
    v_mfma_f32_16x16x32_bf16 v[236:239], v[76:79], v[164:167], v[236:239]
    ds_read_b64_tr_b16 v[70:71], v51 offset:12288
    s_waitcnt lgkmcnt(8)
    v_mfma_f32_16x16x32_bf16 v[208:211], v[80:83], v[160:163], v[208:211]
    ds_read_b64_tr_b16 v[72:73], v52 offset:8192
    v_mfma_f32_16x16x32_bf16 v[240:243], v[80:83], v[164:167], v[240:243]
    ds_read_b64_tr_b16 v[74:75], v52 offset:12288
    buffer_load_dwordx4 v[156:159], v3, s[4:7], s31 offen offset:3072 sc1
    s_add_u32 s31, s31, 8192
    s_and_b32 s31, s31, 0xffff
    v_mfma_f32_16x16x32_bf16 v[212:215], v[84:87], v[160:163], v[212:215]
    ds_read_b64_tr_b16 v[76:77], v53 offset:8192
    v_mfma_f32_16x16x32_bf16 v[244:247], v[84:87], v[164:167], v[244:247]
    ds_read_b64_tr_b16 v[78:79], v53 offset:12288
    s_cmp_lt_u32 s35, 3
    s_cselect_b32 s34, s33, 0x30000
    s_waitcnt lgkmcnt(8)
    v_mfma_f32_16x16x32_bf16 v[216:219], v[88:91], v[160:163], v[216:219]
    ds_read_b64_tr_b16 v[80:81], v54 offset:8192
    v_mfma_f32_16x16x32_bf16 v[248:251], v[88:91], v[164:167], v[248:251]
    ds_read_b64_tr_b16 v[82:83], v54 offset:12288
    v_mfma_f32_16x16x32_bf16 v[220:223], v[92:95], v[160:163], v[220:223]
    ds_read_b64_tr_b16 v[84:85], v55 offset:8192
    v_mfma_f32_16x16x32_bf16 v[252:255], v[92:95], v[164:167], v[252:255]
    ds_read_b64_tr_b16 v[86:87], v55 offset:12288
    s_waitcnt lgkmcnt(8)
    s_waitcnt vmcnt(20)
    v_mfma_f32_16x16x32_bf16 v[192:195], v[64:67], v[168:171], v[192:195]
    ds_read_b64_tr_b16 v[88:89], v56 offset:8192
    v_mfma_f32_16x16x32_bf16 v[224:227], v[64:67], v[172:175], v[224:227]
    ds_read_b64_tr_b16 v[90:91], v56 offset:12288
    buffer_load_dwordx4 v[160:163], v2, s[4:7], s31 offen offset:0 sc1
    v_mfma_f32_16x16x32_bf16 v[196:199], v[68:71], v[168:171], v[196:199]
    ds_read_b64_tr_b16 v[92:93], v57 offset:8192
    v_mfma_f32_16x16x32_bf16 v[228:231], v[68:71], v[172:175], v[228:231]
    ds_read_b64_tr_b16 v[94:95], v57 offset:12288
    s_waitcnt lgkmcnt(8)
    v_mfma_f32_16x16x32_bf16 v[200:203], v[72:75], v[168:171], v[200:203]
    v_mfma_f32_16x16x32_bf16 v[232:235], v[72:75], v[172:175], v[232:235]
    buffer_load_dwordx4 v[164:167], v3, s[4:7], s31 offen offset:0 sc1
    v_mfma_f32_16x16x32_bf16 v[204:207], v[76:79], v[168:171], v[204:207]
    v_mfma_f32_16x16x32_bf16 v[236:239], v[76:79], v[172:175], v[236:239]
    s_cmp_lt_u32 s60, 15
    s_cbranch_scc1 L_recurrent_scan__compressed_kv_cla__moe_arch_mod__prompt_kernel_rare_163
L_recurrent_scan__compressed_kv_cla__moe_arch_mod__prompt_kernel_back_164:
    s_waitcnt lgkmcnt(0)
    s_waitcnt vmcnt(20)
    s_barrier
    v_mfma_f32_16x16x32_bf16 v[208:211], v[80:83], v[168:171], v[208:211]
    ds_read_b64_tr_b16 v[64:65], v50 offset:16384
    ds_read_b64_tr_b16 v[66:67], v50 offset:20480
    v_mfma_f32_16x16x32_bf16 v[240:243], v[80:83], v[172:175], v[240:243]
    ds_read_b64_tr_b16 v[68:69], v51 offset:16384
    ds_read_b64_tr_b16 v[70:71], v51 offset:20480
    s_add_u32 m0, s34, 0
    v_mfma_f32_16x16x32_bf16 v[212:215], v[84:87], v[168:171], v[212:215]
    ds_read_b64_tr_b16 v[72:73], v52 offset:16384
    ds_read_b64_tr_b16 v[74:75], v52 offset:20480
    buffer_load_dwordx4 v6, s[8:11], s32 offen offset:0 lds
    v_mfma_f32_16x16x32_bf16 v[244:247], v[84:87], v[172:175], v[244:247]
    ds_read_b64_tr_b16 v[76:77], v53 offset:16384
    ds_read_b64_tr_b16 v[78:79], v53 offset:20480
    v_mfma_f32_16x16x32_bf16 v[216:219], v[88:91], v[168:171], v[216:219]
    ds_read_b64_tr_b16 v[80:81], v54 offset:16384
    ds_read_b64_tr_b16 v[82:83], v54 offset:20480
    buffer_load_dwordx4 v7, s[8:11], s32 offen offset:1024 lds
    v_mfma_f32_16x16x32_bf16 v[248:251], v[88:91], v[172:175], v[248:251]
    v_mfma_f32_16x16x32_bf16 v[220:223], v[92:95], v[168:171], v[220:223]
    ds_read_b64_tr_b16 v[84:85], v55 offset:16384
    ds_read_b64_tr_b16 v[86:87], v55 offset:20480
    buffer_load_dwordx4 v8, s[8:11], s32 offen offset:2048 lds
    v_mfma_f32_16x16x32_bf16 v[252:255], v[92:95], v[172:175], v[252:255]
    buffer_load_dwordx4 v9, s[8:11], s32 offen offset:3072 lds
    s_add_u32 s32, s32, 131072
    s_waitcnt lgkmcnt(8)
    s_waitcnt vmcnt(24)
    v_mfma_f32_16x16x32_bf16 v[192:195], v[64:67], v[176:179], v[192:195]
    ds_read_b64_tr_b16 v[88:89], v56 offset:16384
    v_mfma_f32_16x16x32_bf16 v[224:227], v[64:67], v[180:183], v[224:227]
    ds_read_b64_tr_b16 v[90:91], v56 offset:20480
    v_mfma_f32_16x16x32_bf16 v[196:199], v[68:71], v[176:179], v[196:199]
    ds_read_b64_tr_b16 v[92:93], v57 offset:16384
    v_mfma_f32_16x16x32_bf16 v[228:231], v[68:71], v[180:183], v[228:231]
    ds_read_b64_tr_b16 v[94:95], v57 offset:20480
    buffer_load_dwordx4 v[168:171], v2, s[4:7], s31 offen offset:1024 sc1
    s_waitcnt lgkmcnt(8)
    v_mfma_f32_16x16x32_bf16 v[200:203], v[72:75], v[176:179], v[200:203]
    ds_read_b64_tr_b16 v[64:65], v50 offset:24576
    v_mfma_f32_16x16x32_bf16 v[232:235], v[72:75], v[180:183], v[232:235]
    ds_read_b64_tr_b16 v[66:67], v50 offset:28672
    v_xor_b32 v50, 65536, v50
    v_mfma_f32_16x16x32_bf16 v[204:207], v[76:79], v[176:179], v[204:207]
    ds_read_b64_tr_b16 v[68:69], v51 offset:24576
    v_mfma_f32_16x16x32_bf16 v[236:239], v[76:79], v[180:183], v[236:239]
    ds_read_b64_tr_b16 v[70:71], v51 offset:28672
    v_xor_b32 v51, 65536, v51
    s_waitcnt lgkmcnt(8)
    v_mfma_f32_16x16x32_bf16 v[208:211], v[80:83], v[176:179], v[208:211]
    ds_read_b64_tr_b16 v[72:73], v52 offset:24576
    v_mfma_f32_16x16x32_bf16 v[240:243], v[80:83], v[180:183], v[240:243]
    ds_read_b64_tr_b16 v[74:75], v52 offset:28672
    v_xor_b32 v52, 65536, v52
    buffer_load_dwordx4 v[172:175], v3, s[4:7], s31 offen offset:1024 sc1
    v_mfma_f32_16x16x32_bf16 v[212:215], v[84:87], v[176:179], v[212:215]
    ds_read_b64_tr_b16 v[76:77], v53 offset:24576
    v_mfma_f32_16x16x32_bf16 v[244:247], v[84:87], v[180:183], v[244:247]
    ds_read_b64_tr_b16 v[78:79], v53 offset:28672
    v_xor_b32 v53, 65536, v53
    s_waitcnt lgkmcnt(8)
    v_mfma_f32_16x16x32_bf16 v[216:219], v[88:91], v[176:179], v[216:219]
    ds_read_b64_tr_b16 v[80:81], v54 offset:24576
    v_mfma_f32_16x16x32_bf16 v[248:251], v[88:91], v[180:183], v[248:251]
    ds_read_b64_tr_b16 v[82:83], v54 offset:28672
    v_xor_b32 v54, 65536, v54
    v_mfma_f32_16x16x32_bf16 v[220:223], v[92:95], v[176:179], v[220:223]
    ds_read_b64_tr_b16 v[84:85], v55 offset:24576
    v_mfma_f32_16x16x32_bf16 v[252:255], v[92:95], v[180:183], v[252:255]
    ds_read_b64_tr_b16 v[86:87], v55 offset:28672
    v_xor_b32 v55, 65536, v55
    s_waitcnt lgkmcnt(8)
    s_waitcnt vmcnt(24)
    v_mfma_f32_16x16x32_bf16 v[192:195], v[64:67], v[184:187], v[192:195]
    ds_read_b64_tr_b16 v[88:89], v56 offset:24576
    v_mfma_f32_16x16x32_bf16 v[224:227], v[64:67], v[188:191], v[224:227]
    ds_read_b64_tr_b16 v[90:91], v56 offset:28672
    v_xor_b32 v56, 65536, v56
    buffer_load_dwordx4 v[176:179], v2, s[4:7], s31 offen offset:2048 sc1
    v_mfma_f32_16x16x32_bf16 v[196:199], v[68:71], v[184:187], v[196:199]
    ds_read_b64_tr_b16 v[92:93], v57 offset:24576
    v_mfma_f32_16x16x32_bf16 v[228:231], v[68:71], v[188:191], v[228:231]
    ds_read_b64_tr_b16 v[94:95], v57 offset:28672
    v_xor_b32 v57, 65536, v57
    s_waitcnt lgkmcnt(8)
    v_mfma_f32_16x16x32_bf16 v[200:203], v[72:75], v[184:187], v[200:203]
    v_mfma_f32_16x16x32_bf16 v[232:235], v[72:75], v[188:191], v[232:235]
    buffer_load_dwordx4 v[180:183], v3, s[4:7], s31 offen offset:2048 sc1
    v_mfma_f32_16x16x32_bf16 v[204:207], v[76:79], v[184:187], v[204:207]
    v_mfma_f32_16x16x32_bf16 v[236:239], v[76:79], v[188:191], v[236:239]
    s_cmp_lt_u32 s60, 15
    s_cbranch_scc1 L_recurrent_scan__compressed_kv_cla__moe_arch_mod__prompt_kernel_rare_173
L_recurrent_scan__compressed_kv_cla__moe_arch_mod__prompt_kernel_back_174:
    s_waitcnt lgkmcnt(0)
    s_waitcnt vmcnt(20)
    s_barrier
    v_mfma_f32_16x16x32_bf16 v[208:211], v[80:83], v[184:187], v[208:211]
    ds_read_b64_tr_b16 v[64:65], v50 offset:0
    ds_read_b64_tr_b16 v[66:67], v50 offset:4096
    v_mfma_f32_16x16x32_bf16 v[240:243], v[80:83], v[188:191], v[240:243]
    ds_read_b64_tr_b16 v[68:69], v51 offset:0
    ds_read_b64_tr_b16 v[70:71], v51 offset:4096
    s_add_u32 m0, s34, 16384
    v_mfma_f32_16x16x32_bf16 v[212:215], v[84:87], v[184:187], v[212:215]
    ds_read_b64_tr_b16 v[72:73], v52 offset:0
    ds_read_b64_tr_b16 v[74:75], v52 offset:4096
    buffer_load_dwordx4 v6, s[8:11], s32 offen offset:0 lds
    v_mfma_f32_16x16x32_bf16 v[244:247], v[84:87], v[188:191], v[244:247]
    ds_read_b64_tr_b16 v[76:77], v53 offset:0
    ds_read_b64_tr_b16 v[78:79], v53 offset:4096
    v_mfma_f32_16x16x32_bf16 v[216:219], v[88:91], v[184:187], v[216:219]
    ds_read_b64_tr_b16 v[80:81], v54 offset:0
    ds_read_b64_tr_b16 v[82:83], v54 offset:4096
    buffer_load_dwordx4 v7, s[8:11], s32 offen offset:1024 lds
    v_mfma_f32_16x16x32_bf16 v[248:251], v[88:91], v[188:191], v[248:251]
    v_mfma_f32_16x16x32_bf16 v[220:223], v[92:95], v[184:187], v[220:223]
    ds_read_b64_tr_b16 v[84:85], v55 offset:0
    ds_read_b64_tr_b16 v[86:87], v55 offset:4096
    buffer_load_dwordx4 v8, s[8:11], s32 offen offset:2048 lds
    v_mfma_f32_16x16x32_bf16 v[252:255], v[92:95], v[188:191], v[252:255]
    buffer_load_dwordx4 v9, s[8:11], s32 offen offset:3072 lds
    s_add_u32 s32, s32, 393216
    s_and_b32 s32, s32, 0x3fffff
    s_add_u32 s35, s35, 1
    s_cmp_lt_u32 s35, 4
    s_cbranch_scc1 L_p4_loop
    s_waitcnt vmcnt(0) lgkmcnt(0)
    s_nop 3
    s_cmp_lt_u32 s28, 4
    s_cbranch_scc0 L_p4_e1
    ds_read_b64 v[40:41], v17 offset:0
    ds_read_b64 v[42:43], v17 offset:32
    ds_read_b64 v[44:45], v17 offset:64
    ds_read_b64 v[46:47], v17 offset:96
    ds_write_b128 v20, v[224:227] offset:0
    ds_write_b128 v20, v[228:231] offset:1024
    ds_write_b128 v20, v[232:235] offset:2048
    ds_write_b128 v20, v[236:239] offset:3072
    ds_write_b128 v20, v[240:243] offset:4096
    ds_write_b128 v20, v[244:247] offset:5120
    ds_write_b128 v20, v[248:251] offset:6144
    ds_write_b128 v20, v[252:255] offset:7168
    s_waitcnt lgkmcnt(0)
    s_barrier
    ds_read_b128 v[128:131], v21 offset:0
    ds_read_b128 v[132:135], v21 offset:1024
    ds_read_b128 v[136:139], v21 offset:2048
    ds_read_b128 v[140:143], v21 offset:3072
    ds_read_b128 v[144:147], v21 offset:4096
    ds_read_b128 v[148:151], v21 offset:5120
    ds_read_b128 v[152:155], v21 offset:6144
    ds_read_b128 v[156:159], v21 offset:7168
    s_waitcnt lgkmcnt(7)
    v_pk_add_f32 v[128:129], v[128:129], v[192:193]
    v_pk_add_f32 v[130:131], v[130:131], v[194:195]
    s_waitcnt lgkmcnt(6)
    v_pk_add_f32 v[132:133], v[132:133], v[196:197]
    v_pk_add_f32 v[134:135], v[134:135], v[198:199]
    s_waitcnt lgkmcnt(5)
    v_pk_add_f32 v[136:137], v[136:137], v[200:201]
    v_pk_add_f32 v[138:139], v[138:139], v[202:203]
    s_waitcnt lgkmcnt(4)
    v_pk_add_f32 v[140:141], v[140:141], v[204:205]
    v_pk_add_f32 v[142:143], v[142:143], v[206:207]
    s_waitcnt lgkmcnt(3)
    v_pk_add_f32 v[144:145], v[144:145], v[208:209]
    v_pk_add_f32 v[146:147], v[146:147], v[210:211]
    s_waitcnt lgkmcnt(2)
    v_pk_add_f32 v[148:149], v[148:149], v[212:213]
    v_pk_add_f32 v[150:151], v[150:151], v[214:215]
    s_waitcnt lgkmcnt(1)
    v_pk_add_f32 v[152:153], v[152:153], v[216:217]
    v_pk_add_f32 v[154:155], v[154:155], v[218:219]
    s_waitcnt lgkmcnt(0)
    v_pk_add_f32 v[156:157], v[156:157], v[220:221]
    v_pk_add_f32 v[158:159], v[158:159], v[222:223]
    s_branch L_p4_done
L_p4_e1:
    ds_read_b64 v[40:41], v17 offset:0
    ds_read_b64 v[42:43], v17 offset:32
    ds_read_b64 v[44:45], v17 offset:64
    ds_read_b64 v[46:47], v17 offset:96
    ds_write_b128 v20, v[192:195] offset:0
    ds_write_b128 v20, v[196:199] offset:1024
    ds_write_b128 v20, v[200:203] offset:2048
    ds_write_b128 v20, v[204:207] offset:3072
    ds_write_b128 v20, v[208:211] offset:4096
    ds_write_b128 v20, v[212:215] offset:5120
    ds_write_b128 v20, v[216:219] offset:6144
    ds_write_b128 v20, v[220:223] offset:7168
    s_waitcnt lgkmcnt(0)
    s_barrier
    ds_read_b128 v[128:131], v21 offset:0
    ds_read_b128 v[132:135], v21 offset:1024
    ds_read_b128 v[136:139], v21 offset:2048
    ds_read_b128 v[140:143], v21 offset:3072
    ds_read_b128 v[144:147], v21 offset:4096
    ds_read_b128 v[148:151], v21 offset:5120
    ds_read_b128 v[152:155], v21 offset:6144
    ds_read_b128 v[156:159], v21 offset:7168
    s_waitcnt lgkmcnt(7)
    v_pk_add_f32 v[128:129], v[128:129], v[224:225]
    v_pk_add_f32 v[130:131], v[130:131], v[226:227]
    s_waitcnt lgkmcnt(6)
    v_pk_add_f32 v[132:133], v[132:133], v[228:229]
    v_pk_add_f32 v[134:135], v[134:135], v[230:231]
    s_waitcnt lgkmcnt(5)
    v_pk_add_f32 v[136:137], v[136:137], v[232:233]
    v_pk_add_f32 v[138:139], v[138:139], v[234:235]
    s_waitcnt lgkmcnt(4)
    v_pk_add_f32 v[140:141], v[140:141], v[236:237]
    v_pk_add_f32 v[142:143], v[142:143], v[238:239]
    s_waitcnt lgkmcnt(3)
    v_pk_add_f32 v[144:145], v[144:145], v[240:241]
    v_pk_add_f32 v[146:147], v[146:147], v[242:243]
    s_waitcnt lgkmcnt(2)
    v_pk_add_f32 v[148:149], v[148:149], v[244:245]
    v_pk_add_f32 v[150:151], v[150:151], v[246:247]
    s_waitcnt lgkmcnt(1)
    v_pk_add_f32 v[152:153], v[152:153], v[248:249]
    v_pk_add_f32 v[154:155], v[154:155], v[250:251]
    s_waitcnt lgkmcnt(0)
    v_pk_add_f32 v[156:157], v[156:157], v[252:253]
    v_pk_add_f32 v[158:159], v[158:159], v[254:255]
L_p4_done:
    s_cmp_eq_u32 s63, 0
    s_cbranch_scc1 L_recurrent_scan__compressed_kv_cla__moe_arch_mod__prompt_kernel_p1_182
    v_swap_b32 v128, v144
    v_swap_b32 v129, v145
    v_swap_b32 v130, v146
    v_swap_b32 v131, v147
    v_swap_b32 v132, v148
    v_swap_b32 v133, v149
    v_swap_b32 v134, v150
    v_swap_b32 v135, v151
    v_swap_b32 v136, v152
    v_swap_b32 v137, v153
    v_swap_b32 v138, v154
    v_swap_b32 v139, v155
    v_swap_b32 v140, v156
    v_swap_b32 v141, v157
    v_swap_b32 v142, v158
    v_swap_b32 v143, v159
L_recurrent_scan__compressed_kv_cla__moe_arch_mod__prompt_kernel_p1_182:
    s_lshl_b32 s36, s2, 15
    s_lshl_b32 s37, s28, 12
    s_add_u32 s36, s36, s37
    s_add_u32 s36, s36, 67108864
    s_xor_b32 s39, s36, 1048576
    v_lshlrev_b32 v22, 4, v1
    buffer_store_dwordx4 v[144:147], v22, s[24:27], s36 offen offset:0 sc1
    buffer_store_dwordx4 v[148:151], v22, s[24:27], s36 offen offset:1024 sc1
    buffer_store_dwordx4 v[152:155], v22, s[24:27], s36 offen offset:2048 sc1
    buffer_store_dwordx4 v[156:159], v22, s[24:27], s36 offen offset:3072 sc1
    s_add_u32 s40, s2, 128
    s_lshl_b32 s40, s40, 7
    s_xor_b32 s37, s40, 4096
    v_mov_b32 v5, s37
    s_sub_u32 s36, s56, s38
    s_sub_u32 s37, s57, s38
    s_min_u32 s36, s36, s37
    s_cmp_lt_u32 s36, 16
    s_cbranch_scc1 L_recurrent_scan__compressed_kv_cla__moe_arch_mod__prompt_kernel_gy_183
    v_lshlrev_b32 v96, 16, v40
    v_and_b32 v97, 0xffff0000, v40
    v_sub_f32 v112, v96, v48
    v_sub_f32 v113, v97, v48
    v_cvt_pk_bf16_f32 v10, v112, v113
    v_lshlrev_b32 v112, 16, v10
    v_and_b32 v113, 0xffff0000, v10
    v_mul_f32 v112, v112, v49
    v_mul_f32 v113, v113, v49
    v_cvt_pk_bf16_f32 v10, v112, v113
    v_lshlrev_b32 v112, 16, v10
    v_and_b32 v113, 0xffff0000, v10
    v_mul_f32 v11, 0xbfb8aa3b, v112
    v_mul_f32 v12, 0xbfb8aa3b, v113
    v_exp_f32 v11, v11
    v_exp_f32 v12, v12
    s_nop 0
    v_add_f32 v11, 1.0, v11
    v_add_f32 v12, 1.0, v12
    v_rcp_f32 v11, v11
    v_rcp_f32 v12, v12
    s_nop 0
    v_mul_f32 v112, v112, v11
    v_mul_f32 v113, v113, v12
    v_cvt_pk_bf16_f32 v10, v112, v113
    v_lshlrev_b32 v112, 16, v10
    v_and_b32 v113, 0xffff0000, v10
    v_lshlrev_b32 v98, 16, v41
    v_and_b32 v99, 0xffff0000, v41
    v_sub_f32 v114, v98, v48
    v_sub_f32 v115, v99, v48
    v_cvt_pk_bf16_f32 v10, v114, v115
    v_lshlrev_b32 v114, 16, v10
    v_and_b32 v115, 0xffff0000, v10
    v_mul_f32 v114, v114, v49
    v_mul_f32 v115, v115, v49
    v_cvt_pk_bf16_f32 v10, v114, v115
    v_lshlrev_b32 v114, 16, v10
    v_and_b32 v115, 0xffff0000, v10
    v_mul_f32 v11, 0xbfb8aa3b, v114
    v_mul_f32 v12, 0xbfb8aa3b, v115
    v_exp_f32 v11, v11
    v_exp_f32 v12, v12
    s_nop 0
    v_add_f32 v11, 1.0, v11
    v_add_f32 v12, 1.0, v12
    v_rcp_f32 v11, v11
    v_rcp_f32 v12, v12
    s_nop 0
    v_mul_f32 v114, v114, v11
    v_mul_f32 v115, v115, v12
    v_cvt_pk_bf16_f32 v10, v114, v115
    v_lshlrev_b32 v114, 16, v10
    v_and_b32 v115, 0xffff0000, v10
    v_lshlrev_b32 v100, 16, v42
    v_and_b32 v101, 0xffff0000, v42
    v_sub_f32 v116, v100, v48
    v_sub_f32 v117, v101, v48
    v_cvt_pk_bf16_f32 v10, v116, v117
    v_lshlrev_b32 v116, 16, v10
    v_and_b32 v117, 0xffff0000, v10
    v_mul_f32 v116, v116, v49
    v_mul_f32 v117, v117, v49
    v_cvt_pk_bf16_f32 v10, v116, v117
    v_lshlrev_b32 v116, 16, v10
    v_and_b32 v117, 0xffff0000, v10
    v_mul_f32 v11, 0xbfb8aa3b, v116
    v_mul_f32 v12, 0xbfb8aa3b, v117
    v_exp_f32 v11, v11
    v_exp_f32 v12, v12
    s_nop 0
    v_add_f32 v11, 1.0, v11
    v_add_f32 v12, 1.0, v12
    v_rcp_f32 v11, v11
    v_rcp_f32 v12, v12
    s_nop 0
    v_mul_f32 v116, v116, v11
    v_mul_f32 v117, v117, v12
    v_cvt_pk_bf16_f32 v10, v116, v117
    v_lshlrev_b32 v116, 16, v10
    v_and_b32 v117, 0xffff0000, v10
    v_lshlrev_b32 v102, 16, v43
    v_and_b32 v103, 0xffff0000, v43
    v_sub_f32 v118, v102, v48
    v_sub_f32 v119, v103, v48
    v_cvt_pk_bf16_f32 v10, v118, v119
    v_lshlrev_b32 v118, 16, v10
    v_and_b32 v119, 0xffff0000, v10
    v_mul_f32 v118, v118, v49
    v_mul_f32 v119, v119, v49
    v_cvt_pk_bf16_f32 v10, v118, v119
    v_lshlrev_b32 v118, 16, v10
    v_and_b32 v119, 0xffff0000, v10
    v_mul_f32 v11, 0xbfb8aa3b, v118
    v_mul_f32 v12, 0xbfb8aa3b, v119
    v_exp_f32 v11, v11
    v_exp_f32 v12, v12
    s_nop 0
    v_add_f32 v11, 1.0, v11
    v_add_f32 v12, 1.0, v12
    v_rcp_f32 v11, v11
    v_rcp_f32 v12, v12
    s_nop 0
    v_mul_f32 v118, v118, v11
    v_mul_f32 v119, v119, v12
    v_cvt_pk_bf16_f32 v10, v118, v119
    v_lshlrev_b32 v118, 16, v10
    v_and_b32 v119, 0xffff0000, v10
    s_waitcnt vmcnt(0)
    v_mov_b32 v4, s40
    v_mov_b32 v13, 1
    s_mov_b64 exec, 1
    global_atomic_add v4, v13, s[90:91]
    s_mov_b64 exec, -1
    v_lshlrev_b32 v104, 16, v44
    v_and_b32 v105, 0xffff0000, v44
    v_sub_f32 v120, v104, v48
    v_sub_f32 v121, v105, v48
    v_cvt_pk_bf16_f32 v10, v120, v121
    v_lshlrev_b32 v120, 16, v10
    v_and_b32 v121, 0xffff0000, v10
    v_mul_f32 v120, v120, v49
    v_mul_f32 v121, v121, v49
    v_cvt_pk_bf16_f32 v10, v120, v121
    v_lshlrev_b32 v120, 16, v10
    v_and_b32 v121, 0xffff0000, v10
    v_mul_f32 v11, 0xbfb8aa3b, v120
    v_mul_f32 v12, 0xbfb8aa3b, v121
    v_exp_f32 v11, v11
    v_exp_f32 v12, v12
    s_nop 0
    v_add_f32 v11, 1.0, v11
    v_add_f32 v12, 1.0, v12
    v_rcp_f32 v11, v11
    v_rcp_f32 v12, v12
    s_nop 0
    v_mul_f32 v120, v120, v11
    v_mul_f32 v121, v121, v12
    v_cvt_pk_bf16_f32 v10, v120, v121
    v_lshlrev_b32 v120, 16, v10
    v_and_b32 v121, 0xffff0000, v10
    v_lshlrev_b32 v106, 16, v45
    v_and_b32 v107, 0xffff0000, v45
    v_sub_f32 v122, v106, v48
    v_sub_f32 v123, v107, v48
    v_cvt_pk_bf16_f32 v10, v122, v123
    v_lshlrev_b32 v122, 16, v10
    v_and_b32 v123, 0xffff0000, v10
    v_mul_f32 v122, v122, v49
    v_mul_f32 v123, v123, v49
    v_cvt_pk_bf16_f32 v10, v122, v123
    v_lshlrev_b32 v122, 16, v10
    v_and_b32 v123, 0xffff0000, v10
    v_mul_f32 v11, 0xbfb8aa3b, v122
    v_mul_f32 v12, 0xbfb8aa3b, v123
    v_exp_f32 v11, v11
    v_exp_f32 v12, v12
    s_nop 0
    v_add_f32 v11, 1.0, v11
    v_add_f32 v12, 1.0, v12
    v_rcp_f32 v11, v11
    v_rcp_f32 v12, v12
    s_nop 0
    v_mul_f32 v122, v122, v11
    v_mul_f32 v123, v123, v12
    v_cvt_pk_bf16_f32 v10, v122, v123
    v_lshlrev_b32 v122, 16, v10
    v_and_b32 v123, 0xffff0000, v10
    v_lshlrev_b32 v108, 16, v46
    v_and_b32 v109, 0xffff0000, v46
    v_sub_f32 v124, v108, v48
    v_sub_f32 v125, v109, v48
    v_cvt_pk_bf16_f32 v10, v124, v125
    v_lshlrev_b32 v124, 16, v10
    v_and_b32 v125, 0xffff0000, v10
    v_mul_f32 v124, v124, v49
    v_mul_f32 v125, v125, v49
    v_cvt_pk_bf16_f32 v10, v124, v125
    v_lshlrev_b32 v124, 16, v10
    v_and_b32 v125, 0xffff0000, v10
    v_mul_f32 v11, 0xbfb8aa3b, v124
    v_mul_f32 v12, 0xbfb8aa3b, v125
    v_exp_f32 v11, v11
    v_exp_f32 v12, v12
    s_nop 0
    v_add_f32 v11, 1.0, v11
    v_add_f32 v12, 1.0, v12
    v_rcp_f32 v11, v11
    v_rcp_f32 v12, v12
    s_nop 0
    v_mul_f32 v124, v124, v11
    v_mul_f32 v125, v125, v12
    v_cvt_pk_bf16_f32 v10, v124, v125
    v_lshlrev_b32 v124, 16, v10
    v_and_b32 v125, 0xffff0000, v10
    v_lshlrev_b32 v110, 16, v47
    v_and_b32 v111, 0xffff0000, v47
    v_sub_f32 v126, v110, v48
    v_sub_f32 v127, v111, v48
    v_cvt_pk_bf16_f32 v10, v126, v127
    v_lshlrev_b32 v126, 16, v10
    v_and_b32 v127, 0xffff0000, v10
    v_mul_f32 v126, v126, v49
    v_mul_f32 v127, v127, v49
    v_cvt_pk_bf16_f32 v10, v126, v127
    v_lshlrev_b32 v126, 16, v10
    v_and_b32 v127, 0xffff0000, v10
    v_mul_f32 v11, 0xbfb8aa3b, v126
    v_mul_f32 v12, 0xbfb8aa3b, v127
    v_exp_f32 v11, v11
    v_exp_f32 v12, v12
    s_nop 0
    v_add_f32 v11, 1.0, v11
    v_add_f32 v12, 1.0, v12
    v_rcp_f32 v11, v11
    v_rcp_f32 v12, v12
    s_nop 0
    v_mul_f32 v126, v126, v11
    v_mul_f32 v127, v127, v12
    v_cvt_pk_bf16_f32 v10, v126, v127
    v_lshlrev_b32 v126, 16, v10
    v_and_b32 v127, 0xffff0000, v10
L_recurrent_scan__compressed_kv_cla__moe_arch_mod__prompt_kernel_gyb_184:
    s_cmp_eq_u32 s28, 7
    s_cbranch_scc1 L_recurrent_scan__compressed_kv_cla__moe_arch_mod__prompt_kernel_rare_187
L_recurrent_scan__compressed_kv_cla__moe_arch_mod__prompt_kernel_back_188:
    s_barrier
    buffer_load_dwordx4 v[64:67], v22, s[24:27], s39 offen offset:0 sc1
    buffer_load_dwordx4 v[68:71], v22, s[24:27], s39 offen offset:1024 sc1
    buffer_load_dwordx4 v[72:75], v22, s[24:27], s39 offen offset:2048 sc1
    buffer_load_dwordx4 v[76:79], v22, s[24:27], s39 offen offset:3072 sc1
    s_waitcnt vmcnt(3)
    v_pk_add_f32 v[128:129], v[128:129], v[64:65]
    v_cvt_pk_bf16_f32 v23, v128, v129
    v_lshlrev_b32 v128, 16, v23
    v_and_b32 v129, 0xffff0000, v23
    v_pk_mul_f32 v[128:129], v[128:129], v[112:113]
    v_cvt_pk_bf16_f32 v23, v128, v129
    v_lshlrev_b32 v128, 16, v23
    v_and_b32 v129, 0xffff0000, v23
    v_pk_add_f32 v[128:129], v[128:129], v[96:97]
    v_cvt_pk_bf16_f32 v80, v128, v129
    v_pk_add_f32 v[130:131], v[130:131], v[66:67]
    v_cvt_pk_bf16_f32 v23, v130, v131
    v_lshlrev_b32 v130, 16, v23
    v_and_b32 v131, 0xffff0000, v23
    v_pk_mul_f32 v[130:131], v[130:131], v[114:115]
    v_cvt_pk_bf16_f32 v23, v130, v131
    v_lshlrev_b32 v130, 16, v23
    v_and_b32 v131, 0xffff0000, v23
    v_pk_add_f32 v[130:131], v[130:131], v[98:99]
    v_cvt_pk_bf16_f32 v81, v130, v131
    ds_write_b64 v17, v[80:81] offset:0
    s_waitcnt vmcnt(2)
    v_pk_add_f32 v[132:133], v[132:133], v[68:69]
    v_cvt_pk_bf16_f32 v23, v132, v133
    v_lshlrev_b32 v132, 16, v23
    v_and_b32 v133, 0xffff0000, v23
    v_pk_mul_f32 v[132:133], v[132:133], v[116:117]
    v_cvt_pk_bf16_f32 v23, v132, v133
    v_lshlrev_b32 v132, 16, v23
    v_and_b32 v133, 0xffff0000, v23
    v_pk_add_f32 v[132:133], v[132:133], v[100:101]
    v_cvt_pk_bf16_f32 v82, v132, v133
    v_pk_add_f32 v[134:135], v[134:135], v[70:71]
    v_cvt_pk_bf16_f32 v23, v134, v135
    v_lshlrev_b32 v134, 16, v23
    v_and_b32 v135, 0xffff0000, v23
    v_pk_mul_f32 v[134:135], v[134:135], v[118:119]
    v_cvt_pk_bf16_f32 v23, v134, v135
    v_lshlrev_b32 v134, 16, v23
    v_and_b32 v135, 0xffff0000, v23
    v_pk_add_f32 v[134:135], v[134:135], v[102:103]
    v_cvt_pk_bf16_f32 v83, v134, v135
    ds_write_b64 v17, v[82:83] offset:32
    s_waitcnt vmcnt(1)
    v_pk_add_f32 v[136:137], v[136:137], v[72:73]
    v_cvt_pk_bf16_f32 v23, v136, v137
    v_lshlrev_b32 v136, 16, v23
    v_and_b32 v137, 0xffff0000, v23
    v_pk_mul_f32 v[136:137], v[136:137], v[120:121]
    v_cvt_pk_bf16_f32 v23, v136, v137
    v_lshlrev_b32 v136, 16, v23
    v_and_b32 v137, 0xffff0000, v23
    v_pk_add_f32 v[136:137], v[136:137], v[104:105]
    v_cvt_pk_bf16_f32 v84, v136, v137
    v_pk_add_f32 v[138:139], v[138:139], v[74:75]
    v_cvt_pk_bf16_f32 v23, v138, v139
    v_lshlrev_b32 v138, 16, v23
    v_and_b32 v139, 0xffff0000, v23
    v_pk_mul_f32 v[138:139], v[138:139], v[122:123]
    v_cvt_pk_bf16_f32 v23, v138, v139
    v_lshlrev_b32 v138, 16, v23
    v_and_b32 v139, 0xffff0000, v23
    v_pk_add_f32 v[138:139], v[138:139], v[106:107]
    v_cvt_pk_bf16_f32 v85, v138, v139
    ds_write_b64 v17, v[84:85] offset:64
    s_waitcnt vmcnt(0)
    v_pk_add_f32 v[140:141], v[140:141], v[76:77]
    v_cvt_pk_bf16_f32 v23, v140, v141
    v_lshlrev_b32 v140, 16, v23
    v_and_b32 v141, 0xffff0000, v23
    v_pk_mul_f32 v[140:141], v[140:141], v[124:125]
    v_cvt_pk_bf16_f32 v23, v140, v141
    v_lshlrev_b32 v140, 16, v23
    v_and_b32 v141, 0xffff0000, v23
    v_pk_add_f32 v[140:141], v[140:141], v[108:109]
    v_cvt_pk_bf16_f32 v86, v140, v141
    v_pk_add_f32 v[142:143], v[142:143], v[78:79]
    v_cvt_pk_bf16_f32 v23, v142, v143
    v_lshlrev_b32 v142, 16, v23
    v_and_b32 v143, 0xffff0000, v23
    v_pk_mul_f32 v[142:143], v[142:143], v[126:127]
    v_cvt_pk_bf16_f32 v23, v142, v143
    v_lshlrev_b32 v142, 16, v23
    v_and_b32 v143, 0xffff0000, v23
    v_pk_add_f32 v[142:143], v[142:143], v[110:111]
    v_cvt_pk_bf16_f32 v87, v142, v143
    ds_write_b64 v17, v[86:87] offset:96
    v_add_u32 v22, s42, v22
    s_mov_b32 s36, 16384
    s_waitcnt lgkmcnt(0)
    ds_read_b128 v[64:67], v22
    ds_read_b128 v[68:71], v22 offset:1024
    s_waitcnt lgkmcnt(1)
    buffer_store_dwordx4 v[64:67], v15, s[20:23], 0 offen
    s_waitcnt lgkmcnt(0)
    buffer_store_dwordx4 v[68:71], v15, s[20:23], s36 offen
    s_endpgm
L_recurrent_scan__compressed_kv_cla__moe_arch_mod__prompt_kernel_rare_148:
    v_mov_b32 v26, s40
    v_mov_b32 v28, 1
    v_writelane_b32 v26, s41, 1
    s_mov_b64 exec, 3
    global_atomic_add v26, v28, s[90:91]
    s_mov_b64 exec, -1
    s_branch L_recurrent_scan__compressed_kv_cla__moe_arch_mod__prompt_kernel_back_149
L_recurrent_scan__compressed_kv_cla__moe_arch_mod__prompt_kernel_rt1_rare_3:
    s_mov_b32 s61, 0x40000
L_recurrent_scan__compressed_kv_cla__moe_arch_mod__prompt_kernel_rt1_spin_1:
    s_sub_u32 s61, s61, 1
    s_cbranch_scc1 L_recurrent_scan__compressed_kv_cla__moe_arch_mod__prompt_kernel_rt1_spinx_2
    s_sleep 1
    global_load_dword v61, v60, s[90:91] sc1
    s_waitcnt vmcnt(0)
    v_readfirstlane_b32 s36, v61
    s_nop 0
    s_cmp_lt_u32 s36, 16
    s_cbranch_scc1 L_recurrent_scan__compressed_kv_cla__moe_arch_mod__prompt_kernel_rt1_spin_1
L_recurrent_scan__compressed_kv_cla__moe_arch_mod__prompt_kernel_rt1_spinx_2:
    s_branch L_recurrent_scan__compressed_kv_cla__moe_arch_mod__prompt_kernel_rt1_back_4
L_recurrent_scan__compressed_kv_cla__moe_arch_mod__prompt_kernel_rare_158:
    s_cmp_eq_u32 s35, 1
    s_cbranch_scc0 L_recurrent_scan__compressed_kv_cla__moe_arch_mod__prompt_kernel_swn_156
    s_cmp_eq_u32 s28, 0
    s_cbranch_scc0 L_recurrent_scan__compressed_kv_cla__moe_arch_mod__prompt_kernel_g_151
    s_and_b32 s36, s2, 15
    s_add_u32 s36, s36, 96
    s_lshl_b32 s36, s36, 7
    v_mov_b32 v26, s36
    v_mov_b32 v27, 1
    s_mov_b64 exec, 1
    global_atomic_add v26, v27, s[90:91]
    s_mov_b64 exec, -1
    s_nop 3
L_recurrent_scan__compressed_kv_cla__moe_arch_mod__prompt_kernel_g_151:
    s_branch L_recurrent_scan__compressed_kv_cla__moe_arch_mod__prompt_kernel_swend_155
L_recurrent_scan__compressed_kv_cla__moe_arch_mod__prompt_kernel_swn_156:
    s_cmp_eq_u32 s35, 2
    s_cbranch_scc0 L_recurrent_scan__compressed_kv_cla__moe_arch_mod__prompt_kernel_swn_157
    s_sub_u32 s36, s56, s38
    s_sub_u32 s37, s57, s38
    s_min_u32 s36, s36, s37
    s_cmp_lt_u32 s36, 16
    s_cbranch_scc0 L_recurrent_scan__compressed_kv_cla__moe_arch_mod__prompt_kernel_nrt_152
    s_add_u32 s36, s30, 96
    s_lshl_b32 s36, s36, 7
    v_mov_b32 v60, s36
    global_load_dword v61, v60, s[90:91] sc1
L_recurrent_scan__compressed_kv_cla__moe_arch_mod__prompt_kernel_nrt_152:
    s_branch L_recurrent_scan__compressed_kv_cla__moe_arch_mod__prompt_kernel_swend_155
L_recurrent_scan__compressed_kv_cla__moe_arch_mod__prompt_kernel_swn_157:
    s_sub_u32 s36, s56, s38
    s_sub_u32 s37, s57, s38
    s_min_u32 s36, s36, s37
    s_cmp_lt_u32 s36, 16
    s_cbranch_scc0 L_recurrent_scan__compressed_kv_cla__moe_arch_mod__prompt_kernel_nrt_153
    v_mov_b64 v[24:25], 0
    v_mov_b64 v[26:27], 0
    v_mov_b64 v[28:29], 0
    v_mov_b64 v[30:31], 0
    v_mov_b64 v[32:33], 0
    v_mov_b64 v[34:35], 0
    v_mov_b64 v[36:37], 0
    v_mov_b64 v[38:39], 0
    s_waitcnt vmcnt(16)
    s_sub_u32 s36, s56, s38
    s_cmp_lt_u32 s36, 16
    s_cbranch_scc0 L_recurrent_scan__compressed_kv_cla__moe_arch_mod__prompt_kernel_rt2_noy_1
    s_and_b32 s36, s58, 0xffff0000
    s_cmp_lt_i32 s36, 0
    s_cselect_b32 s37, 0x80000000, -1
    s_xor_b32 s36, s36, s37
    s_and_b32 s36, s36, 0xffff0000
    v_mov_b32 v62, s36
    v_mul_f32 v62, 0xbfb8aa3b, v62
    v_exp_f32 v62, v62
    s_nop 0
    v_add_f32 v62, 1.0, v62
    v_rcp_f32 v62, v62
    s_nop 0
    v_cvt_pk_bf16_f32 v62, v62, v62
    v_lshlrev_b32 v62, 16, v62
    v_add_f32_dpp v96, v96, v96 quad_perm:[1,0,3,2] row_mask:0xf bank_mask:0xf
    v_add_f32_dpp v97, v97, v97 quad_perm:[1,0,3,2] row_mask:0xf bank_mask:0xf
    v_add_f32_dpp v98, v98, v98 quad_perm:[1,0,3,2] row_mask:0xf bank_mask:0xf
    v_add_f32_dpp v99, v99, v99 quad_perm:[1,0,3,2] row_mask:0xf bank_mask:0xf
    v_add_f32_dpp v100, v100, v100 quad_perm:[1,0,3,2] row_mask:0xf bank_mask:0xf
    v_add_f32_dpp v101, v101, v101 quad_perm:[1,0,3,2] row_mask:0xf bank_mask:0xf
    v_add_f32_dpp v102, v102, v102 quad_perm:[1,0,3,2] row_mask:0xf bank_mask:0xf
    v_add_f32_dpp v103, v103, v103 quad_perm:[1,0,3,2] row_mask:0xf bank_mask:0xf
    v_add_f32_dpp v104, v104, v104 quad_perm:[1,0,3,2] row_mask:0xf bank_mask:0xf
    v_add_f32_dpp v105, v105, v105 quad_perm:[1,0,3,2] row_mask:0xf bank_mask:0xf
    v_add_f32_dpp v106, v106, v106 quad_perm:[1,0,3,2] row_mask:0xf bank_mask:0xf
    v_add_f32_dpp v107, v107, v107 quad_perm:[1,0,3,2] row_mask:0xf bank_mask:0xf
    v_add_f32_dpp v108, v108, v108 quad_perm:[1,0,3,2] row_mask:0xf bank_mask:0xf
    v_add_f32_dpp v109, v109, v109 quad_perm:[1,0,3,2] row_mask:0xf bank_mask:0xf
    v_add_f32_dpp v110, v110, v110 quad_perm:[1,0,3,2] row_mask:0xf bank_mask:0xf
    v_add_f32_dpp v111, v111, v111 quad_perm:[1,0,3,2] row_mask:0xf bank_mask:0xf
    v_add_f32_dpp v96, v96, v96 quad_perm:[2,3,0,1] row_mask:0xf bank_mask:0xf
    v_add_f32_dpp v97, v97, v97 quad_perm:[2,3,0,1] row_mask:0xf bank_mask:0xf
    v_add_f32_dpp v98, v98, v98 quad_perm:[2,3,0,1] row_mask:0xf bank_mask:0xf
    v_add_f32_dpp v99, v99, v99 quad_perm:[2,3,0,1] row_mask:0xf bank_mask:0xf
    v_add_f32_dpp v100, v100, v100 quad_perm:[2,3,0,1] row_mask:0xf bank_mask:0xf
    v_add_f32_dpp v101, v101, v101 quad_perm:[2,3,0,1] row_mask:0xf bank_mask:0xf
    v_add_f32_dpp v102, v102, v102 quad_perm:[2,3,0,1] row_mask:0xf bank_mask:0xf
    v_add_f32_dpp v103, v103, v103 quad_perm:[2,3,0,1] row_mask:0xf bank_mask:0xf
    v_add_f32_dpp v104, v104, v104 quad_perm:[2,3,0,1] row_mask:0xf bank_mask:0xf
    v_add_f32_dpp v105, v105, v105 quad_perm:[2,3,0,1] row_mask:0xf bank_mask:0xf
    v_add_f32_dpp v106, v106, v106 quad_perm:[2,3,0,1] row_mask:0xf bank_mask:0xf
    v_add_f32_dpp v107, v107, v107 quad_perm:[2,3,0,1] row_mask:0xf bank_mask:0xf
    v_add_f32_dpp v108, v108, v108 quad_perm:[2,3,0,1] row_mask:0xf bank_mask:0xf
    v_add_f32_dpp v109, v109, v109 quad_perm:[2,3,0,1] row_mask:0xf bank_mask:0xf
    v_add_f32_dpp v110, v110, v110 quad_perm:[2,3,0,1] row_mask:0xf bank_mask:0xf
    v_add_f32_dpp v111, v111, v111 quad_perm:[2,3,0,1] row_mask:0xf bank_mask:0xf
    v_add_f32_dpp v96, v96, v96 row_half_mirror row_mask:0xf bank_mask:0xf
    v_add_f32_dpp v97, v97, v97 row_half_mirror row_mask:0xf bank_mask:0xf
    v_add_f32_dpp v98, v98, v98 row_half_mirror row_mask:0xf bank_mask:0xf
    v_add_f32_dpp v99, v99, v99 row_half_mirror row_mask:0xf bank_mask:0xf
    v_add_f32_dpp v100, v100, v100 row_half_mirror row_mask:0xf bank_mask:0xf
    v_add_f32_dpp v101, v101, v101 row_half_mirror row_mask:0xf bank_mask:0xf
    v_add_f32_dpp v102, v102, v102 row_half_mirror row_mask:0xf bank_mask:0xf
    v_add_f32_dpp v103, v103, v103 row_half_mirror row_mask:0xf bank_mask:0xf
    v_add_f32_dpp v104, v104, v104 row_half_mirror row_mask:0xf bank_mask:0xf
    v_add_f32_dpp v105, v105, v105 row_half_mirror row_mask:0xf bank_mask:0xf
    v_add_f32_dpp v106, v106, v106 row_half_mirror row_mask:0xf bank_mask:0xf
    v_add_f32_dpp v107, v107, v107 row_half_mirror row_mask:0xf bank_mask:0xf
    v_add_f32_dpp v108, v108, v108 row_half_mirror row_mask:0xf bank_mask:0xf
    v_add_f32_dpp v109, v109, v109 row_half_mirror row_mask:0xf bank_mask:0xf
    v_add_f32_dpp v110, v110, v110 row_half_mirror row_mask:0xf bank_mask:0xf
    v_add_f32_dpp v111, v111, v111 row_half_mirror row_mask:0xf bank_mask:0xf
    v_add_f32_dpp v96, v96, v96 row_mirror row_mask:0xf bank_mask:0xf
    v_add_f32_dpp v97, v97, v97 row_mirror row_mask:0xf bank_mask:0xf
    v_add_f32_dpp v98, v98, v98 row_mirror row_mask:0xf bank_mask:0xf
    v_add_f32_dpp v99, v99, v99 row_mirror row_mask:0xf bank_mask:0xf
    v_add_f32_dpp v100, v100, v100 row_mirror row_mask:0xf bank_mask:0xf
    v_add_f32_dpp v101, v101, v101 row_mirror row_mask:0xf bank_mask:0xf
    v_add_f32_dpp v102, v102, v102 row_mirror row_mask:0xf bank_mask:0xf
    v_add_f32_dpp v103, v103, v103 row_mirror row_mask:0xf bank_mask:0xf
    v_add_f32_dpp v104, v104, v104 row_mirror row_mask:0xf bank_mask:0xf
    v_add_f32_dpp v105, v105, v105 row_mirror row_mask:0xf bank_mask:0xf
    v_add_f32_dpp v106, v106, v106 row_mirror row_mask:0xf bank_mask:0xf
    v_add_f32_dpp v107, v107, v107 row_mirror row_mask:0xf bank_mask:0xf
    v_add_f32_dpp v108, v108, v108 row_mirror row_mask:0xf bank_mask:0xf
    v_add_f32_dpp v109, v109, v109 row_mirror row_mask:0xf bank_mask:0xf
    v_add_f32_dpp v110, v110, v110 row_mirror row_mask:0xf bank_mask:0xf
    v_add_f32_dpp v111, v111, v111 row_mirror row_mask:0xf bank_mask:0xf
    v_cmp_eq_u32 vcc, s56, v14
    v_cvt_pk_bf16_f32 v63, v96, v97
    v_lshlrev_b32 v96, 16, v63
    v_and_b32 v97, 0xffff0000, v63
    v_pk_mul_f32 v[96:97], v[96:97], v[62:63] op_sel:[0,0] op_sel_hi:[1,0]
    v_cvt_pk_bf16_f32 v63, v96, v97
    v_lshlrev_b32 v96, 16, v63
    v_and_b32 v97, 0xffff0000, v63
    v_cndmask_b32 v24, v24, v96, vcc
    v_cndmask_b32 v25, v25, v97, vcc
    v_cvt_pk_bf16_f32 v63, v98, v99
    v_lshlrev_b32 v98, 16, v63
    v_and_b32 v99, 0xffff0000, v63
    v_pk_mul_f32 v[98:99], v[98:99], v[62:63] op_sel:[0,0] op_sel_hi:[1,0]
    v_cvt_pk_bf16_f32 v63, v98, v99
    v_lshlrev_b32 v98, 16, v63
    v_and_b32 v99, 0xffff0000, v63
    v_cndmask_b32 v26, v26, v98, vcc
    v_cndmask_b32 v27, v27, v99, vcc
    v_cvt_pk_bf16_f32 v63, v100, v101
    v_lshlrev_b32 v100, 16, v63
    v_and_b32 v101, 0xffff0000, v63
    v_pk_mul_f32 v[100:101], v[100:101], v[62:63] op_sel:[0,0] op_sel_hi:[1,0]
    v_cvt_pk_bf16_f32 v63, v100, v101
    v_lshlrev_b32 v100, 16, v63
    v_and_b32 v101, 0xffff0000, v63
    v_cndmask_b32 v28, v28, v100, vcc
    v_cndmask_b32 v29, v29, v101, vcc
    v_cvt_pk_bf16_f32 v63, v102, v103
    v_lshlrev_b32 v102, 16, v63
    v_and_b32 v103, 0xffff0000, v63
    v_pk_mul_f32 v[102:103], v[102:103], v[62:63] op_sel:[0,0] op_sel_hi:[1,0]
    v_cvt_pk_bf16_f32 v63, v102, v103
    v_lshlrev_b32 v102, 16, v63
    v_and_b32 v103, 0xffff0000, v63
    v_cndmask_b32 v30, v30, v102, vcc
    v_cndmask_b32 v31, v31, v103, vcc
    v_cvt_pk_bf16_f32 v63, v104, v105
    v_lshlrev_b32 v104, 16, v63
    v_and_b32 v105, 0xffff0000, v63
    v_pk_mul_f32 v[104:105], v[104:105], v[62:63] op_sel:[0,0] op_sel_hi:[1,0]
    v_cvt_pk_bf16_f32 v63, v104, v105
    v_lshlrev_b32 v104, 16, v63
    v_and_b32 v105, 0xffff0000, v63
    v_cndmask_b32 v32, v32, v104, vcc
    v_cndmask_b32 v33, v33, v105, vcc
    v_cvt_pk_bf16_f32 v63, v106, v107
    v_lshlrev_b32 v106, 16, v63
    v_and_b32 v107, 0xffff0000, v63
    v_pk_mul_f32 v[106:107], v[106:107], v[62:63] op_sel:[0,0] op_sel_hi:[1,0]
    v_cvt_pk_bf16_f32 v63, v106, v107
    v_lshlrev_b32 v106, 16, v63
    v_and_b32 v107, 0xffff0000, v63
    v_cndmask_b32 v34, v34, v106, vcc
    v_cndmask_b32 v35, v35, v107, vcc
    v_cvt_pk_bf16_f32 v63, v108, v109
    v_lshlrev_b32 v108, 16, v63
    v_and_b32 v109, 0xffff0000, v63
    v_pk_mul_f32 v[108:109], v[108:109], v[62:63] op_sel:[0,0] op_sel_hi:[1,0]
    v_cvt_pk_bf16_f32 v63, v108, v109
    v_lshlrev_b32 v108, 16, v63
    v_and_b32 v109, 0xffff0000, v63
    v_cndmask_b32 v36, v36, v108, vcc
    v_cndmask_b32 v37, v37, v109, vcc
    v_cvt_pk_bf16_f32 v63, v110, v111
    v_lshlrev_b32 v110, 16, v63
    v_and_b32 v111, 0xffff0000, v63
    v_pk_mul_f32 v[110:111], v[110:111], v[62:63] op_sel:[0,0] op_sel_hi:[1,0]
    v_cvt_pk_bf16_f32 v63, v110, v111
    v_lshlrev_b32 v110, 16, v63
    v_and_b32 v111, 0xffff0000, v63
    v_cndmask_b32 v38, v38, v110, vcc
    v_cndmask_b32 v39, v39, v111, vcc
L_recurrent_scan__compressed_kv_cla__moe_arch_mod__prompt_kernel_rt2_noy_1:
    s_sub_u32 s36, s57, s38
    s_cmp_lt_u32 s36, 16
    s_cbranch_scc0 L_recurrent_scan__compressed_kv_cla__moe_arch_mod__prompt_kernel_rt2_noy_2
    s_and_b32 s36, s59, 0xffff0000
    s_cmp_lt_i32 s36, 0
    s_cselect_b32 s37, 0x80000000, -1
    s_xor_b32 s36, s36, s37
    s_and_b32 s36, s36, 0xffff0000
    v_mov_b32 v62, s36
    v_mul_f32 v62, 0xbfb8aa3b, v62
    v_exp_f32 v62, v62
    s_nop 0
    v_add_f32 v62, 1.0, v62
    v_rcp_f32 v62, v62
    s_nop 0
    v_cvt_pk_bf16_f32 v62, v62, v62
    v_lshlrev_b32 v62, 16, v62
    v_add_f32_dpp v112, v112, v112 quad_perm:[1,0,3,2] row_mask:0xf bank_mask:0xf
    v_add_f32_dpp v113, v113, v113 quad_perm:[1,0,3,2] row_mask:0xf bank_mask:0xf
    v_add_f32_dpp v114, v114, v114 quad_perm:[1,0,3,2] row_mask:0xf bank_mask:0xf
    v_add_f32_dpp v115, v115, v115 quad_perm:[1,0,3,2] row_mask:0xf bank_mask:0xf
    v_add_f32_dpp v116, v116, v116 quad_perm:[1,0,3,2] row_mask:0xf bank_mask:0xf
    v_add_f32_dpp v117, v117, v117 quad_perm:[1,0,3,2] row_mask:0xf bank_mask:0xf
    v_add_f32_dpp v118, v118, v118 quad_perm:[1,0,3,2] row_mask:0xf bank_mask:0xf
    v_add_f32_dpp v119, v119, v119 quad_perm:[1,0,3,2] row_mask:0xf bank_mask:0xf
    v_add_f32_dpp v120, v120, v120 quad_perm:[1,0,3,2] row_mask:0xf bank_mask:0xf
    v_add_f32_dpp v121, v121, v121 quad_perm:[1,0,3,2] row_mask:0xf bank_mask:0xf
    v_add_f32_dpp v122, v122, v122 quad_perm:[1,0,3,2] row_mask:0xf bank_mask:0xf
    v_add_f32_dpp v123, v123, v123 quad_perm:[1,0,3,2] row_mask:0xf bank_mask:0xf
    v_add_f32_dpp v124, v124, v124 quad_perm:[1,0,3,2] row_mask:0xf bank_mask:0xf
    v_add_f32_dpp v125, v125, v125 quad_perm:[1,0,3,2] row_mask:0xf bank_mask:0xf
    v_add_f32_dpp v126, v126, v126 quad_perm:[1,0,3,2] row_mask:0xf bank_mask:0xf
    v_add_f32_dpp v127, v127, v127 quad_perm:[1,0,3,2] row_mask:0xf bank_mask:0xf
    v_add_f32_dpp v112, v112, v112 quad_perm:[2,3,0,1] row_mask:0xf bank_mask:0xf
    v_add_f32_dpp v113, v113, v113 quad_perm:[2,3,0,1] row_mask:0xf bank_mask:0xf
    v_add_f32_dpp v114, v114, v114 quad_perm:[2,3,0,1] row_mask:0xf bank_mask:0xf
    v_add_f32_dpp v115, v115, v115 quad_perm:[2,3,0,1] row_mask:0xf bank_mask:0xf
    v_add_f32_dpp v116, v116, v116 quad_perm:[2,3,0,1] row_mask:0xf bank_mask:0xf
    v_add_f32_dpp v117, v117, v117 quad_perm:[2,3,0,1] row_mask:0xf bank_mask:0xf
    v_add_f32_dpp v118, v118, v118 quad_perm:[2,3,0,1] row_mask:0xf bank_mask:0xf
    v_add_f32_dpp v119, v119, v119 quad_perm:[2,3,0,1] row_mask:0xf bank_mask:0xf
    v_add_f32_dpp v120, v120, v120 quad_perm:[2,3,0,1] row_mask:0xf bank_mask:0xf
    v_add_f32_dpp v121, v121, v121 quad_perm:[2,3,0,1] row_mask:0xf bank_mask:0xf
    v_add_f32_dpp v122, v122, v122 quad_perm:[2,3,0,1] row_mask:0xf bank_mask:0xf
    v_add_f32_dpp v123, v123, v123 quad_perm:[2,3,0,1] row_mask:0xf bank_mask:0xf
    v_add_f32_dpp v124, v124, v124 quad_perm:[2,3,0,1] row_mask:0xf bank_mask:0xf
    v_add_f32_dpp v125, v125, v125 quad_perm:[2,3,0,1] row_mask:0xf bank_mask:0xf
    v_add_f32_dpp v126, v126, v126 quad_perm:[2,3,0,1] row_mask:0xf bank_mask:0xf
    v_add_f32_dpp v127, v127, v127 quad_perm:[2,3,0,1] row_mask:0xf bank_mask:0xf
    v_add_f32_dpp v112, v112, v112 row_half_mirror row_mask:0xf bank_mask:0xf
    v_add_f32_dpp v113, v113, v113 row_half_mirror row_mask:0xf bank_mask:0xf
    v_add_f32_dpp v114, v114, v114 row_half_mirror row_mask:0xf bank_mask:0xf
    v_add_f32_dpp v115, v115, v115 row_half_mirror row_mask:0xf bank_mask:0xf
    v_add_f32_dpp v116, v116, v116 row_half_mirror row_mask:0xf bank_mask:0xf
    v_add_f32_dpp v117, v117, v117 row_half_mirror row_mask:0xf bank_mask:0xf
    v_add_f32_dpp v118, v118, v118 row_half_mirror row_mask:0xf bank_mask:0xf
    v_add_f32_dpp v119, v119, v119 row_half_mirror row_mask:0xf bank_mask:0xf
    v_add_f32_dpp v120, v120, v120 row_half_mirror row_mask:0xf bank_mask:0xf
    v_add_f32_dpp v121, v121, v121 row_half_mirror row_mask:0xf bank_mask:0xf
    v_add_f32_dpp v122, v122, v122 row_half_mirror row_mask:0xf bank_mask:0xf
    v_add_f32_dpp v123, v123, v123 row_half_mirror row_mask:0xf bank_mask:0xf
    v_add_f32_dpp v124, v124, v124 row_half_mirror row_mask:0xf bank_mask:0xf
    v_add_f32_dpp v125, v125, v125 row_half_mirror row_mask:0xf bank_mask:0xf
    v_add_f32_dpp v126, v126, v126 row_half_mirror row_mask:0xf bank_mask:0xf
    v_add_f32_dpp v127, v127, v127 row_half_mirror row_mask:0xf bank_mask:0xf
    v_add_f32_dpp v112, v112, v112 row_mirror row_mask:0xf bank_mask:0xf
    v_add_f32_dpp v113, v113, v113 row_mirror row_mask:0xf bank_mask:0xf
    v_add_f32_dpp v114, v114, v114 row_mirror row_mask:0xf bank_mask:0xf
    v_add_f32_dpp v115, v115, v115 row_mirror row_mask:0xf bank_mask:0xf
    v_add_f32_dpp v116, v116, v116 row_mirror row_mask:0xf bank_mask:0xf
    v_add_f32_dpp v117, v117, v117 row_mirror row_mask:0xf bank_mask:0xf
    v_add_f32_dpp v118, v118, v118 row_mirror row_mask:0xf bank_mask:0xf
    v_add_f32_dpp v119, v119, v119 row_mirror row_mask:0xf bank_mask:0xf
    v_add_f32_dpp v120, v120, v120 row_mirror row_mask:0xf bank_mask:0xf
    v_add_f32_dpp v121, v121, v121 row_mirror row_mask:0xf bank_mask:0xf
    v_add_f32_dpp v122, v122, v122 row_mirror row_mask:0xf bank_mask:0xf
    v_add_f32_dpp v123, v123, v123 row_mirror row_mask:0xf bank_mask:0xf
    v_add_f32_dpp v124, v124, v124 row_mirror row_mask:0xf bank_mask:0xf
    v_add_f32_dpp v125, v125, v125 row_mirror row_mask:0xf bank_mask:0xf
    v_add_f32_dpp v126, v126, v126 row_mirror row_mask:0xf bank_mask:0xf
    v_add_f32_dpp v127, v127, v127 row_mirror row_mask:0xf bank_mask:0xf
    v_cmp_eq_u32 vcc, s57, v14
    v_cvt_pk_bf16_f32 v63, v112, v113
    v_lshlrev_b32 v112, 16, v63
    v_and_b32 v113, 0xffff0000, v63
    v_pk_mul_f32 v[112:113], v[112:113], v[62:63] op_sel:[0,0] op_sel_hi:[1,0]
    v_cvt_pk_bf16_f32 v63, v112, v113
    v_lshlrev_b32 v112, 16, v63
    v_and_b32 v113, 0xffff0000, v63
    v_cndmask_b32 v24, v24, v112, vcc
    v_cndmask_b32 v25, v25, v113, vcc
    v_cvt_pk_bf16_f32 v63, v114, v115
    v_lshlrev_b32 v114, 16, v63
    v_and_b32 v115, 0xffff0000, v63
    v_pk_mul_f32 v[114:115], v[114:115], v[62:63] op_sel:[0,0] op_sel_hi:[1,0]
    v_cvt_pk_bf16_f32 v63, v114, v115
    v_lshlrev_b32 v114, 16, v63
    v_and_b32 v115, 0xffff0000, v63
    v_cndmask_b32 v26, v26, v114, vcc
    v_cndmask_b32 v27, v27, v115, vcc
    v_cvt_pk_bf16_f32 v63, v116, v117
    v_lshlrev_b32 v116, 16, v63
    v_and_b32 v117, 0xffff0000, v63
    v_pk_mul_f32 v[116:117], v[116:117], v[62:63] op_sel:[0,0] op_sel_hi:[1,0]
    v_cvt_pk_bf16_f32 v63, v116, v117
    v_lshlrev_b32 v116, 16, v63
    v_and_b32 v117, 0xffff0000, v63
    v_cndmask_b32 v28, v28, v116, vcc
    v_cndmask_b32 v29, v29, v117, vcc
    v_cvt_pk_bf16_f32 v63, v118, v119
    v_lshlrev_b32 v118, 16, v63
    v_and_b32 v119, 0xffff0000, v63
    v_pk_mul_f32 v[118:119], v[118:119], v[62:63] op_sel:[0,0] op_sel_hi:[1,0]
    v_cvt_pk_bf16_f32 v63, v118, v119
    v_lshlrev_b32 v118, 16, v63
    v_and_b32 v119, 0xffff0000, v63
    v_cndmask_b32 v30, v30, v118, vcc
    v_cndmask_b32 v31, v31, v119, vcc
    v_cvt_pk_bf16_f32 v63, v120, v121
    v_lshlrev_b32 v120, 16, v63
    v_and_b32 v121, 0xffff0000, v63
    v_pk_mul_f32 v[120:121], v[120:121], v[62:63] op_sel:[0,0] op_sel_hi:[1,0]
    v_cvt_pk_bf16_f32 v63, v120, v121
    v_lshlrev_b32 v120, 16, v63
    v_and_b32 v121, 0xffff0000, v63
    v_cndmask_b32 v32, v32, v120, vcc
    v_cndmask_b32 v33, v33, v121, vcc
    v_cvt_pk_bf16_f32 v63, v122, v123
    v_lshlrev_b32 v122, 16, v63
    v_and_b32 v123, 0xffff0000, v63
    v_pk_mul_f32 v[122:123], v[122:123], v[62:63] op_sel:[0,0] op_sel_hi:[1,0]
    v_cvt_pk_bf16_f32 v63, v122, v123
    v_lshlrev_b32 v122, 16, v63
    v_and_b32 v123, 0xffff0000, v63
    v_cndmask_b32 v34, v34, v122, vcc
    v_cndmask_b32 v35, v35, v123, vcc
    v_cvt_pk_bf16_f32 v63, v124, v125
    v_lshlrev_b32 v124, 16, v63
    v_and_b32 v125, 0xffff0000, v63
    v_pk_mul_f32 v[124:125], v[124:125], v[62:63] op_sel:[0,0] op_sel_hi:[1,0]
    v_cvt_pk_bf16_f32 v63, v124, v125
    v_lshlrev_b32 v124, 16, v63
    v_and_b32 v125, 0xffff0000, v63
    v_cndmask_b32 v36, v36, v124, vcc
    v_cndmask_b32 v37, v37, v125, vcc
    v_cvt_pk_bf16_f32 v63, v126, v127
    v_lshlrev_b32 v126, 16, v63
    v_and_b32 v127, 0xffff0000, v63
    v_pk_mul_f32 v[126:127], v[126:127], v[62:63] op_sel:[0,0] op_sel_hi:[1,0]
    v_cvt_pk_bf16_f32 v63, v126, v127
    v_lshlrev_b32 v126, 16, v63
    v_and_b32 v127, 0xffff0000, v63
    v_cndmask_b32 v38, v38, v126, vcc
    v_cndmask_b32 v39, v39, v127, vcc
L_recurrent_scan__compressed_kv_cla__moe_arch_mod__prompt_kernel_rt2_noy_2:
L_recurrent_scan__compressed_kv_cla__moe_arch_mod__prompt_kernel_nrt_153:
    s_mov_b32 m0, s42
    s_mov_b32 s36, 15360
    buffer_load_dwordx4 v15, s[16:19], 0 offen lds
    buffer_load_dwordx4 v15, s[16:19], s36 offen offset:1024 lds
    s_mov_b32 s36, 4194304
    buffer_load_dwordx2 v[48:49], v16, s[24:27], s36 offen sc1
L_recurrent_scan__compressed_kv_cla__moe_arch_mod__prompt_kernel_swend_155:
    s_branch L_recurrent_scan__compressed_kv_cla__moe_arch_mod__prompt_kernel_back_159
L_recurrent_scan__compressed_kv_cla__moe_arch_mod__prompt_kernel_rare_161:
    s_sub_u32 s36, s56, s38
    s_sub_u32 s37, s57, s38
    s_min_u32 s36, s36, s37
    s_cmp_lt_u32 s36, 16
    s_cbranch_scc0 L_recurrent_scan__compressed_kv_cla__moe_arch_mod__prompt_kernel_nrt_154
    s_waitcnt vmcnt(16)
    v_readfirstlane_b32 s36, v61
    s_nop 0
    s_cmp_lt_u32 s36, 16
    s_cbranch_scc1 L_recurrent_scan__compressed_kv_cla__moe_arch_mod__prompt_kernel_rt1_rare_3
L_recurrent_scan__compressed_kv_cla__moe_arch_mod__prompt_kernel_rt1_back_4:
    s_lshl_b32 s37, s30, 8
    s_add_u32 s36, s37, 59768832
    s_add_u32 s37, s36, 4096
    v_and_b32 v60, 15, v1
    v_lshlrev_b32 v60, 13, v60
    v_lshl_add_u32 v60, v19, 4, v60
    buffer_load_dwordx4 v[96:99], v60, s[24:27], s36 offen offset:0 sc1
    buffer_load_dwordx4 v[100:103], v60, s[24:27], s36 offen offset:64 sc1
    buffer_load_dwordx4 v[104:107], v60, s[24:27], s36 offen offset:128 sc1
    buffer_load_dwordx4 v[108:111], v60, s[24:27], s36 offen offset:192 sc1
    buffer_load_dwordx4 v[112:115], v60, s[24:27], s37 offen offset:0 sc1
    buffer_load_dwordx4 v[116:119], v60, s[24:27], s37 offen offset:64 sc1
    buffer_load_dwordx4 v[120:123], v60, s[24:27], s37 offen offset:128 sc1
    buffer_load_dwordx4 v[124:127], v60, s[24:27], s37 offen offset:192 sc1
L_recurrent_scan__compressed_kv_cla__moe_arch_mod__prompt_kernel_nrt_154:
L_recurrent_scan__compressed_kv_cla__moe_arch_mod__prompt_kernel_swend_160:
    s_branch L_recurrent_scan__compressed_kv_cla__moe_arch_mod__prompt_kernel_back_162
L_recurrent_scan__compressed_kv_cla__moe_arch_mod__prompt_kernel_rare_163:
    global_load_dword v59, v58, s[90:91] sc1
    s_branch L_recurrent_scan__compressed_kv_cla__moe_arch_mod__prompt_kernel_back_164
L_recurrent_scan__compressed_kv_cla__moe_arch_mod__prompt_kernel_rare_173:
    s_cmp_eq_u32 s35, 0
    s_cbranch_scc0 L_recurrent_scan__compressed_kv_cla__moe_arch_mod__prompt_kernel_swn_172
    s_mov_b32 s61, 0x40000
    s_waitcnt vmcnt(8)
    s_branch L_recurrent_scan__compressed_kv_cla__moe_arch_mod__prompt_kernel_cchk_167
L_recurrent_scan__compressed_kv_cla__moe_arch_mod__prompt_kernel_cspin_165:
    s_sub_u32 s61, s61, 1
    s_cbranch_scc1 L_recurrent_scan__compressed_kv_cla__moe_arch_mod__prompt_kernel_cspinx_166
    global_load_dword v59, v58, s[90:91] sc1
    s_waitcnt vmcnt(0)
L_recurrent_scan__compressed_kv_cla__moe_arch_mod__prompt_kernel_cchk_167:
    v_cmp_le_u32 vcc, 4, v59
    s_nop 0
    s_and_b32 s60, vcc_lo, 15
    s_and_b32 s36, s60, 7
    s_cmp_eq_u32 s36, 7
    s_cbranch_scc1 L_recurrent_scan__compressed_kv_cla__moe_arch_mod__prompt_kernel_cspinx_166
    s_sleep 6
    s_branch L_recurrent_scan__compressed_kv_cla__moe_arch_mod__prompt_kernel_cspin_165
L_recurrent_scan__compressed_kv_cla__moe_arch_mod__prompt_kernel_cspinx_166:
    s_branch L_recurrent_scan__compressed_kv_cla__moe_arch_mod__prompt_kernel_swend_171
L_recurrent_scan__compressed_kv_cla__moe_arch_mod__prompt_kernel_swn_172:
    s_mov_b32 s61, 0x40000
    s_waitcnt vmcnt(8)
    s_branch L_recurrent_scan__compressed_kv_cla__moe_arch_mod__prompt_kernel_cchk_170
L_recurrent_scan__compressed_kv_cla__moe_arch_mod__prompt_kernel_cspin_168:
    s_sub_u32 s61, s61, 1
    s_cbranch_scc1 L_recurrent_scan__compressed_kv_cla__moe_arch_mod__prompt_kernel_cspinx_169
    global_load_dword v59, v58, s[90:91] sc1
    s_waitcnt vmcnt(0)
L_recurrent_scan__compressed_kv_cla__moe_arch_mod__prompt_kernel_cchk_170:
    v_cmp_le_u32 vcc, 4, v59
    s_nop 0
    s_and_b32 s60, vcc_lo, 15
    s_and_b32 s36, s60, 15
    s_cmp_eq_u32 s36, 15
    s_cbranch_scc1 L_recurrent_scan__compressed_kv_cla__moe_arch_mod__prompt_kernel_cspinx_169
    s_sleep 6
    s_branch L_recurrent_scan__compressed_kv_cla__moe_arch_mod__prompt_kernel_cspin_168
L_recurrent_scan__compressed_kv_cla__moe_arch_mod__prompt_kernel_cspinx_169:
L_recurrent_scan__compressed_kv_cla__moe_arch_mod__prompt_kernel_swend_171:
    s_branch L_recurrent_scan__compressed_kv_cla__moe_arch_mod__prompt_kernel_back_174
L_recurrent_scan__compressed_kv_cla__moe_arch_mod__prompt_kernel_f2m_175:
    v_lshrrev_b32 v28, 4, v1
    v_bfe_u32 v26, v1, 2, 2
    v_lshl_add_u32 v26, v28, 3, v26
    v_lshlrev_b32 v26, 7, v26
    v_and_b32 v27, 3, v1
    v_lshl_add_u32 v26, v27, 3, v26
    v_bfe_u32 v27, v1, 3, 2
    s_lshl_b32 s36, s28, 12
    s_add_u32 s36, s36, 131072
    v_add_u32 v26, s36, v26
    v_xor_b32 v28, 0, v27
    v_lshl_add_u32 v28, v28, 5, v26
    ds_read_b64_tr_b16 v[112:113], v28 offset:0
    ds_read_b64_tr_b16 v[114:115], v28 offset:512
    v_xor_b32 v28, 1, v27
    v_lshl_add_u32 v28, v28, 5, v26
    ds_read_b64_tr_b16 v[116:117], v28 offset:0
    ds_read_b64_tr_b16 v[118:119], v28 offset:512
    v_xor_b32 v28, 2, v27
    v_lshl_add_u32 v28, v28, 5, v26
    ds_read_b64_tr_b16 v[120:121], v28 offset:0
    ds_read_b64_tr_b16 v[122:123], v28 offset:512
    v_xor_b32 v28, 3, v27
    v_lshl_add_u32 v28, v28, 5, v26
    ds_read_b64_tr_b16 v[124:125], v28 offset:0
    ds_read_b64_tr_b16 v[126:127], v28 offset:512
    v_add_f32_dpp v96, v96, v96 row_ror:4 row_mask:0xf bank_mask:0xf
    v_add_f32_dpp v97, v97, v97 row_ror:4 row_mask:0xf bank_mask:0xf
    v_add_f32_dpp v98, v98, v98 row_ror:4 row_mask:0xf bank_mask:0xf
    v_add_f32_dpp v99, v99, v99 row_ror:4 row_mask:0xf bank_mask:0xf
    v_add_f32_dpp v100, v100, v100 row_ror:4 row_mask:0xf bank_mask:0xf
    v_add_f32_dpp v101, v101, v101 row_ror:4 row_mask:0xf bank_mask:0xf
    v_add_f32_dpp v102, v102, v102 row_ror:4 row_mask:0xf bank_mask:0xf
    v_add_f32_dpp v103, v103, v103 row_ror:4 row_mask:0xf bank_mask:0xf
    v_add_f32_dpp v96, v96, v96 row_ror:8 row_mask:0xf bank_mask:0xf
    v_add_f32_dpp v97, v97, v97 row_ror:8 row_mask:0xf bank_mask:0xf
    v_add_f32_dpp v98, v98, v98 row_ror:8 row_mask:0xf bank_mask:0xf
    v_add_f32_dpp v99, v99, v99 row_ror:8 row_mask:0xf bank_mask:0xf
    v_add_f32_dpp v100, v100, v100 row_ror:8 row_mask:0xf bank_mask:0xf
    v_add_f32_dpp v101, v101, v101 row_ror:8 row_mask:0xf bank_mask:0xf
    v_add_f32_dpp v102, v102, v102 row_ror:8 row_mask:0xf bank_mask:0xf
    v_add_f32_dpp v103, v103, v103 row_ror:8 row_mask:0xf bank_mask:0xf
    v_cvt_pk_bf16_f32 v29, v96, v97
    v_lshlrev_b32 v96, 16, v29
    v_and_b32 v97, 0xffff0000, v29
    v_cvt_pk_bf16_f32 v29, v98, v99
    v_lshlrev_b32 v98, 16, v29
    v_and_b32 v99, 0xffff0000, v29
    v_cvt_pk_bf16_f32 v29, v100, v101
    v_lshlrev_b32 v100, 16, v29
    v_and_b32 v101, 0xffff0000, v29
    v_cvt_pk_bf16_f32 v29, v102, v103
    v_lshlrev_b32 v102, 16, v29
    v_and_b32 v103, 0xffff0000, v29
    v_mul_f32 v104, 0xbfb8aa3b, v96
    v_mul_f32 v105, 0xbfb8aa3b, v97
    v_mul_f32 v106, 0xbfb8aa3b, v98
    v_mul_f32 v107, 0xbfb8aa3b, v99
    v_mul_f32 v108, 0xbfb8aa3b, v100
    v_mul_f32 v109, 0xbfb8aa3b, v101
    v_mul_f32 v110, 0xbfb8aa3b, v102
    v_mul_f32 v111, 0xbfb8aa3b, v103
    v_exp_f32 v104, v104
    v_exp_f32 v105, v105
    v_exp_f32 v106, v106
    v_exp_f32 v107, v107
    v_exp_f32 v108, v108
    v_exp_f32 v109, v109
    v_exp_f32 v110, v110
    v_exp_f32 v111, v111
    v_add_f32 v104, 1.0, v104
    v_add_f32 v105, 1.0, v105
    v_add_f32 v106, 1.0, v106
    v_add_f32 v107, 1.0, v107
    v_add_f32 v108, 1.0, v108
    v_add_f32 v109, 1.0, v109
    v_add_f32 v110, 1.0, v110
    v_add_f32 v111, 1.0, v111
    v_rcp_f32 v104, v104
    v_rcp_f32 v105, v105
    v_rcp_f32 v106, v106
    v_rcp_f32 v107, v107
    v_rcp_f32 v108, v108
    v_rcp_f32 v109, v109
    v_rcp_f32 v110, v110
    v_rcp_f32 v111, v111
    v_mul_f32 v104, v96, v104
    v_mul_f32 v105, v97, v105
    v_mul_f32 v106, v98, v106
    v_mul_f32 v107, v99, v107
    v_mul_f32 v108, v100, v108
    v_mul_f32 v109, v101, v109
    v_mul_f32 v110, v102, v110
    v_mul_f32 v111, v103, v111
    v_cvt_pk_bf16_f32 v29, v104, v105
    v_lshlrev_b32 v104, 16, v29
    v_and_b32 v105, 0xffff0000, v29
    v_cvt_pk_bf16_f32 v29, v106, v107
    v_lshlrev_b32 v106, 16, v29
    v_and_b32 v107, 0xffff0000, v29
    v_cvt_pk_bf16_f32 v29, v108, v109
    v_lshlrev_b32 v108, 16, v29
    v_and_b32 v109, 0xffff0000, v29
    v_cvt_pk_bf16_f32 v29, v110, v111
    v_lshlrev_b32 v110, 16, v29
    v_and_b32 v111, 0xffff0000, v29
    v_mul_f32_dpp v96, v96, v104 quad_perm:[2,3,0,1] row_mask:0xf bank_mask:0xf
    v_mul_f32_dpp v97, v97, v105 quad_perm:[2,3,0,1] row_mask:0xf bank_mask:0xf
    v_mul_f32_dpp v98, v98, v106 quad_perm:[2,3,0,1] row_mask:0xf bank_mask:0xf
    v_mul_f32_dpp v99, v99, v107 quad_perm:[2,3,0,1] row_mask:0xf bank_mask:0xf
    v_mul_f32_dpp v100, v100, v108 quad_perm:[2,3,0,1] row_mask:0xf bank_mask:0xf
    v_mul_f32_dpp v101, v101, v109 quad_perm:[2,3,0,1] row_mask:0xf bank_mask:0xf
    v_mul_f32_dpp v102, v102, v110 quad_perm:[2,3,0,1] row_mask:0xf bank_mask:0xf
    v_mul_f32_dpp v103, v103, v111 quad_perm:[2,3,0,1] row_mask:0xf bank_mask:0xf
    v_cvt_pk_bf16_f32 v36, v96, v97
    v_cvt_pk_bf16_f32 v37, v98, v99
    v_cvt_pk_bf16_f32 v38, v100, v101
    v_cvt_pk_bf16_f32 v39, v102, v103
    s_waitcnt lgkmcnt(0)
    v_lshl_add_u32 v28, v1, 4, s36
    v_mfma_f32_16x16x32_bf16 v[96:99], v[112:115], v[36:39], 0
    v_mfma_f32_16x16x32_bf16 v[100:103], v[116:119], v[36:39], 0
    v_mfma_f32_16x16x32_bf16 v[104:107], v[120:123], v[36:39], 0
    v_mfma_f32_16x16x32_bf16 v[108:111], v[124:127], v[36:39], 0
    s_nop 7
    ds_write_b128 v28, v[96:99] offset:0
    ds_write_b128 v28, v[100:103] offset:1024
    ds_write_b128 v28, v[104:107] offset:2048
    ds_write_b128 v28, v[108:111] offset:3072
    s_cmp_lt_u32 s28, 4
    s_cbranch_scc1 L_recurrent_scan__compressed_kv_cla__moe_arch_mod__prompt_kernel_f2b_177
    s_branch L_recurrent_scan__compressed_kv_cla__moe_arch_mod__prompt_kernel_f2a_176
L_recurrent_scan__compressed_kv_cla__moe_arch_mod__prompt_kernel_gy_183:
    v_lshlrev_b32 v96, 16, v40
    v_and_b32 v97, 0xffff0000, v40
    v_sub_f32 v112, v96, v48
    v_sub_f32 v113, v97, v48
    v_cvt_pk_bf16_f32 v10, v112, v113
    v_lshlrev_b32 v112, 16, v10
    v_and_b32 v113, 0xffff0000, v10
    v_mul_f32 v112, v112, v49
    v_mul_f32 v113, v113, v49
    v_cvt_pk_bf16_f32 v10, v112, v113
    v_lshlrev_b32 v112, 16, v10
    v_and_b32 v113, 0xffff0000, v10
    v_add_f32 v112, v112, v24
    v_add_f32 v113, v113, v25
    v_cvt_pk_bf16_f32 v10, v112, v113
    v_lshlrev_b32 v112, 16, v10
    v_and_b32 v113, 0xffff0000, v10
    v_mul_f32 v11, 0xbfb8aa3b, v112
    v_mul_f32 v12, 0xbfb8aa3b, v113
    v_exp_f32 v11, v11
    v_exp_f32 v12, v12
    s_nop 0
    v_add_f32 v11, 1.0, v11
    v_add_f32 v12, 1.0, v12
    v_rcp_f32 v11, v11
    v_rcp_f32 v12, v12
    s_nop 0
    v_mul_f32 v112, v112, v11
    v_mul_f32 v113, v113, v12
    v_cvt_pk_bf16_f32 v10, v112, v113
    v_lshlrev_b32 v112, 16, v10
    v_and_b32 v113, 0xffff0000, v10
    v_lshlrev_b32 v98, 16, v41
    v_and_b32 v99, 0xffff0000, v41
    v_sub_f32 v114, v98, v48
    v_sub_f32 v115, v99, v48
    v_cvt_pk_bf16_f32 v10, v114, v115
    v_lshlrev_b32 v114, 16, v10
    v_and_b32 v115, 0xffff0000, v10
    v_mul_f32 v114, v114, v49
    v_mul_f32 v115, v115, v49
    v_cvt_pk_bf16_f32 v10, v114, v115
    v_lshlrev_b32 v114, 16, v10
    v_and_b32 v115, 0xffff0000, v10
    v_add_f32 v114, v114, v26
    v_add_f32 v115, v115, v27
    v_cvt_pk_bf16_f32 v10, v114, v115
    v_lshlrev_b32 v114, 16, v10
    v_and_b32 v115, 0xffff0000, v10
    v_mul_f32 v11, 0xbfb8aa3b, v114
    v_mul_f32 v12, 0xbfb8aa3b, v115
    v_exp_f32 v11, v11
    v_exp_f32 v12, v12
    s_nop 0
    v_add_f32 v11, 1.0, v11
    v_add_f32 v12, 1.0, v12
    v_rcp_f32 v11, v11
    v_rcp_f32 v12, v12
    s_nop 0
    v_mul_f32 v114, v114, v11
    v_mul_f32 v115, v115, v12
    v_cvt_pk_bf16_f32 v10, v114, v115
    v_lshlrev_b32 v114, 16, v10
    v_and_b32 v115, 0xffff0000, v10
    v_lshlrev_b32 v100, 16, v42
    v_and_b32 v101, 0xffff0000, v42
    v_sub_f32 v116, v100, v48
    v_sub_f32 v117, v101, v48
    v_cvt_pk_bf16_f32 v10, v116, v117
    v_lshlrev_b32 v116, 16, v10
    v_and_b32 v117, 0xffff0000, v10
    v_mul_f32 v116, v116, v49
    v_mul_f32 v117, v117, v49
    v_cvt_pk_bf16_f32 v10, v116, v117
    v_lshlrev_b32 v116, 16, v10
    v_and_b32 v117, 0xffff0000, v10
    v_add_f32 v116, v116, v28
    v_add_f32 v117, v117, v29
    v_cvt_pk_bf16_f32 v10, v116, v117
    v_lshlrev_b32 v116, 16, v10
    v_and_b32 v117, 0xffff0000, v10
    v_mul_f32 v11, 0xbfb8aa3b, v116
    v_mul_f32 v12, 0xbfb8aa3b, v117
    v_exp_f32 v11, v11
    v_exp_f32 v12, v12
    s_nop 0
    v_add_f32 v11, 1.0, v11
    v_add_f32 v12, 1.0, v12
    v_rcp_f32 v11, v11
    v_rcp_f32 v12, v12
    s_nop 0
    v_mul_f32 v116, v116, v11
    v_mul_f32 v117, v117, v12
    v_cvt_pk_bf16_f32 v10, v116, v117
    v_lshlrev_b32 v116, 16, v10
    v_and_b32 v117, 0xffff0000, v10
    v_lshlrev_b32 v102, 16, v43
    v_and_b32 v103, 0xffff0000, v43
    v_sub_f32 v118, v102, v48
    v_sub_f32 v119, v103, v48
    v_cvt_pk_bf16_f32 v10, v118, v119
    v_lshlrev_b32 v118, 16, v10
    v_and_b32 v119, 0xffff0000, v10
    v_mul_f32 v118, v118, v49
    v_mul_f32 v119, v119, v49
    v_cvt_pk_bf16_f32 v10, v118, v119
    v_lshlrev_b32 v118, 16, v10
    v_and_b32 v119, 0xffff0000, v10
    v_add_f32 v118, v118, v30
    v_add_f32 v119, v119, v31
    v_cvt_pk_bf16_f32 v10, v118, v119
    v_lshlrev_b32 v118, 16, v10
    v_and_b32 v119, 0xffff0000, v10
    v_mul_f32 v11, 0xbfb8aa3b, v118
    v_mul_f32 v12, 0xbfb8aa3b, v119
    v_exp_f32 v11, v11
    v_exp_f32 v12, v12
    s_nop 0
    v_add_f32 v11, 1.0, v11
    v_add_f32 v12, 1.0, v12
    v_rcp_f32 v11, v11
    v_rcp_f32 v12, v12
    s_nop 0
    v_mul_f32 v118, v118, v11
    v_mul_f32 v119, v119, v12
    v_cvt_pk_bf16_f32 v10, v118, v119
    v_lshlrev_b32 v118, 16, v10
    v_and_b32 v119, 0xffff0000, v10
    s_waitcnt vmcnt(0)
    v_mov_b32 v4, s40
    v_mov_b32 v13, 1
    s_mov_b64 exec, 1
    global_atomic_add v4, v13, s[90:91]
    s_mov_b64 exec, -1
    v_lshlrev_b32 v104, 16, v44
    v_and_b32 v105, 0xffff0000, v44
    v_sub_f32 v120, v104, v48
    v_sub_f32 v121, v105, v48
    v_cvt_pk_bf16_f32 v10, v120, v121
    v_lshlrev_b32 v120, 16, v10
    v_and_b32 v121, 0xffff0000, v10
    v_mul_f32 v120, v120, v49
    v_mul_f32 v121, v121, v49
    v_cvt_pk_bf16_f32 v10, v120, v121
    v_lshlrev_b32 v120, 16, v10
    v_and_b32 v121, 0xffff0000, v10
    v_add_f32 v120, v120, v32
    v_add_f32 v121, v121, v33
    v_cvt_pk_bf16_f32 v10, v120, v121
    v_lshlrev_b32 v120, 16, v10
    v_and_b32 v121, 0xffff0000, v10
    v_mul_f32 v11, 0xbfb8aa3b, v120
    v_mul_f32 v12, 0xbfb8aa3b, v121
    v_exp_f32 v11, v11
    v_exp_f32 v12, v12
    s_nop 0
    v_add_f32 v11, 1.0, v11
    v_add_f32 v12, 1.0, v12
    v_rcp_f32 v11, v11
    v_rcp_f32 v12, v12
    s_nop 0
    v_mul_f32 v120, v120, v11
    v_mul_f32 v121, v121, v12
    v_cvt_pk_bf16_f32 v10, v120, v121
    v_lshlrev_b32 v120, 16, v10
    v_and_b32 v121, 0xffff0000, v10
    v_lshlrev_b32 v106, 16, v45
    v_and_b32 v107, 0xffff0000, v45
    v_sub_f32 v122, v106, v48
    v_sub_f32 v123, v107, v48
    v_cvt_pk_bf16_f32 v10, v122, v123
    v_lshlrev_b32 v122, 16, v10
    v_and_b32 v123, 0xffff0000, v10
    v_mul_f32 v122, v122, v49
    v_mul_f32 v123, v123, v49
    v_cvt_pk_bf16_f32 v10, v122, v123
    v_lshlrev_b32 v122, 16, v10
    v_and_b32 v123, 0xffff0000, v10
    v_add_f32 v122, v122, v34
    v_add_f32 v123, v123, v35
    v_cvt_pk_bf16_f32 v10, v122, v123
    v_lshlrev_b32 v122, 16, v10
    v_and_b32 v123, 0xffff0000, v10
    v_mul_f32 v11, 0xbfb8aa3b, v122
    v_mul_f32 v12, 0xbfb8aa3b, v123
    v_exp_f32 v11, v11
    v_exp_f32 v12, v12
    s_nop 0
    v_add_f32 v11, 1.0, v11
    v_add_f32 v12, 1.0, v12
    v_rcp_f32 v11, v11
    v_rcp_f32 v12, v12
    s_nop 0
    v_mul_f32 v122, v122, v11
    v_mul_f32 v123, v123, v12
    v_cvt_pk_bf16_f32 v10, v122, v123
    v_lshlrev_b32 v122, 16, v10
    v_and_b32 v123, 0xffff0000, v10
    v_lshlrev_b32 v108, 16, v46
    v_and_b32 v109, 0xffff0000, v46
    v_sub_f32 v124, v108, v48
    v_sub_f32 v125, v109, v48
    v_cvt_pk_bf16_f32 v10, v124, v125
    v_lshlrev_b32 v124, 16, v10
    v_and_b32 v125, 0xffff0000, v10
    v_mul_f32 v124, v124, v49
    v_mul_f32 v125, v125, v49
    v_cvt_pk_bf16_f32 v10, v124, v125
    v_lshlrev_b32 v124, 16, v10
    v_and_b32 v125, 0xffff0000, v10
    v_add_f32 v124, v124, v36
    v_add_f32 v125, v125, v37
    v_cvt_pk_bf16_f32 v10, v124, v125
    v_lshlrev_b32 v124, 16, v10
    v_and_b32 v125, 0xffff0000, v10
    v_mul_f32 v11, 0xbfb8aa3b, v124
    v_mul_f32 v12, 0xbfb8aa3b, v125
    v_exp_f32 v11, v11
    v_exp_f32 v12, v12
    s_nop 0
    v_add_f32 v11, 1.0, v11
    v_add_f32 v12, 1.0, v12
    v_rcp_f32 v11, v11
    v_rcp_f32 v12, v12
    s_nop 0
    v_mul_f32 v124, v124, v11
    v_mul_f32 v125, v125, v12
    v_cvt_pk_bf16_f32 v10, v124, v125
    v_lshlrev_b32 v124, 16, v10
    v_and_b32 v125, 0xffff0000, v10
    v_lshlrev_b32 v110, 16, v47
    v_and_b32 v111, 0xffff0000, v47
    v_sub_f32 v126, v110, v48
    v_sub_f32 v127, v111, v48
    v_cvt_pk_bf16_f32 v10, v126, v127
    v_lshlrev_b32 v126, 16, v10
    v_and_b32 v127, 0xffff0000, v10
    v_mul_f32 v126, v126, v49
    v_mul_f32 v127, v127, v49
    v_cvt_pk_bf16_f32 v10, v126, v127
    v_lshlrev_b32 v126, 16, v10
    v_and_b32 v127, 0xffff0000, v10
    v_add_f32 v126, v126, v38
    v_add_f32 v127, v127, v39
    v_cvt_pk_bf16_f32 v10, v126, v127
    v_lshlrev_b32 v126, 16, v10
    v_and_b32 v127, 0xffff0000, v10
    v_mul_f32 v11, 0xbfb8aa3b, v126
    v_mul_f32 v12, 0xbfb8aa3b, v127
    v_exp_f32 v11, v11
    v_exp_f32 v12, v12
    s_nop 0
    v_add_f32 v11, 1.0, v11
    v_add_f32 v12, 1.0, v12
    v_rcp_f32 v11, v11
    v_rcp_f32 v12, v12
    s_nop 0
    v_mul_f32 v126, v126, v11
    v_mul_f32 v127, v127, v12
    v_cvt_pk_bf16_f32 v10, v126, v127
    v_lshlrev_b32 v126, 16, v10
    v_and_b32 v127, 0xffff0000, v10
    s_branch L_recurrent_scan__compressed_kv_cla__moe_arch_mod__prompt_kernel_gyb_184
L_recurrent_scan__compressed_kv_cla__moe_arch_mod__prompt_kernel_rare_187:
    s_mov_b32 s61, 0x40000
L_recurrent_scan__compressed_kv_cla__moe_arch_mod__prompt_kernel_spin_185:
    s_sub_u32 s61, s61, 1
    s_cbranch_scc1 L_recurrent_scan__compressed_kv_cla__moe_arch_mod__prompt_kernel_spinx_186
    s_sleep 1
    global_load_dword v23, v5, s[90:91] sc1
    s_waitcnt vmcnt(0)
    v_readfirstlane_b32 s36, v23
    s_nop 0
    s_cmp_lt_u32 s36, 8
    s_cbranch_scc1 L_recurrent_scan__compressed_kv_cla__moe_arch_mod__prompt_kernel_spin_185
L_recurrent_scan__compressed_kv_cla__moe_arch_mod__prompt_kernel_spinx_186:
    s_branch L_recurrent_scan__compressed_kv_cla__moe_arch_mod__prompt_kernel_back_188
L_end:
    s_endpgm
.section .rodata,"a"
.p2align 6
.amdhsa_kernel recurrent_scan__compressed_kv_cla__moe_arch_mod__prompt_kernel
  .amdhsa_next_free_vgpr 256
  .amdhsa_next_free_sgpr 102
  .amdhsa_accum_offset 256
  .amdhsa_group_segment_fixed_size 0
  .amdhsa_kernarg_size 112
  .amdhsa_user_sgpr_count 2
  .amdhsa_user_sgpr_kernarg_segment_ptr 1
  .amdhsa_system_sgpr_workgroup_id_x 1
.end_amdhsa_kernel
```

```asm
; @launch kernel=recurrent_scan__compressed_kv_cla__moe_arch_mod__prompt_kernel grid=(256,1,1) block=(512,1,1) lds=163840
.amdgcn_target "amdgcn-amd-amdhsa--gfx950"
.text
.globl recurrent_scan__compressed_kv_cla__moe_arch_mod__prompt_kernel
.p2align 8
.type recurrent_scan__compressed_kv_cla__moe_arch_mod__prompt_kernel,@function
recurrent_scan__compressed_kv_cla__moe_arch_mod__prompt_kernel:
    s_cmp_ge_u32 s2, 256
    s_cbranch_scc1 L_end
    s_load_dwordx4 s[44:47], s[0:1], 0
    s_load_dwordx2 s[52:53], s[0:1], 56
    s_load_dwordx4 s[48:51], s[0:1], 24
    s_getpc_b64 s[36:37]
L_pc:
    s_lshr_b32 s38, s2, 3
    s_lshl_b32 s38, s38, 7
    v_lshl_add_u32 v16, v0, 12, s38
    v_cmp_gt_u32 vcc, L_end-L_pc-4, v16
    v_mov_b32 v17, s37
    s_and_b64 exec, exec, vcc
    s_cbranch_execz L_nocpf
    v_add_co_u32 v16, vcc, s36, v16
    s_nop 1
    v_addc_co_u32 v17, vcc, 0, v17, vcc
    global_load_dword v119, v[16:17], off
L_nocpf:
    s_mov_b64 exec, -1
    v_lshrrev_b32 v16, 6, v0
    v_and_b32 v1, 63, v0
    v_readfirstlane_b32 s28, v16
    v_lshlrev_b32 v116, 4, v1
    s_lshl_b32 s42, s2, 3
    s_cmp_lt_u32 s28, 4
    s_cbranch_scc1 L_nox
    s_add_u32 s43, s42, s28
    s_sub_u32 s42, s43, 4
    v_lshl_add_u32 v18, s42, 11, v116
    v_add_u32 v19, 8192, v18
    s_waitcnt lgkmcnt(0)
    global_load_dwordx4 v[20:23], v18, s[44:45]
    global_load_dwordx4 v[24:27], v18, s[44:45] offset:1024
    global_load_dwordx4 v[28:31], v19, s[44:45]
    global_load_dwordx4 v[32:35], v19, s[44:45] offset:1024
    global_load_dwordx4 v[36:39], v116, s[52:53]
    global_load_dwordx4 v[40:43], v116, s[52:53] offset:1024
    s_barrier
L_nox:
    s_load_dwordx4 s[88:91], s[0:1], 96
    s_load_dwordx4 s[92:95], s[0:1], 64
    s_load_dwordx2 s[96:97], s[0:1], 16
    s_and_b32 s29, s2, 7
    s_lshl_b32 s29, s29, 2
    s_bfe_u32 s36, s2, 0x20003
    s_add_u32 s29, s29, s36
    s_lshr_b32 s30, s2, 5
    v_lshrrev_b32 v16, 3, v1
    s_lshl_b32 s36, s30, 8
    s_lshl_b32 s37, s28, 5
    s_add_u32 s36, s36, s37
    v_add_u32 v16, s36, v16
    v_lshlrev_b32 v16, 10, v16
    v_lshrrev_b32 v18, 4, v1
    v_and_b32 v19, 7, v1
    v_xor_b32 v19, v19, v18
    v_lshl_add_u32 v2, v19, 4, v16
    v_xor_b32 v19, 4, v19
    v_lshl_add_u32 v3, v19, 4, v16
    v_add_u32 v3, 7168, v3
    v_add_u32 v4, 14336, v2
    v_add_u32 v5, 14336, v3
    s_and_b32 s36, s28, 3
    s_lshl_b32 s37, s36, 4
    v_add_u32 v16, s37, v18
    v_lshlrev_b32 v16, 13, v16
    s_lshl_b32 s37, s29, 8
    v_add_u32 v16, s37, v16
    v_and_b32 v19, 15, v1
    v_lshlrev_b32 v18, 1, v18
    v_xor_b32 v19, v19, v18
    v_lshl_add_u32 v6, v19, 4, v16
    v_add_u32 v7, 31744, v6
    v_xor_b32 v19, 8, v19
    v_lshl_add_u32 v8, v19, 4, v16
    v_add_u32 v8, 63488, v8
    v_add_u32 v9, 31744, v8
    s_lshl_b32 s33, s28, 12
    s_add_u32 s34, s33, 65536
    s_mov_b32 s31, 0
    s_mov_b32 s32, 0
    s_mov_b32 s40, 128
    s_mov_b32 s41, 524288
    s_waitcnt lgkmcnt(0)
    s_mov_b32 s4, s46
    s_and_b32 s5, s47, 0xffff
    s_mov_b32 s6, 2097152
    s_mov_b32 s7, 0x20000
    s_mov_b32 s8, s48
    s_and_b32 s9, s49, 0xffff
    s_mov_b32 s10, 4194304
    s_mov_b32 s11, 0x20000
    s_mov_b32 s20, s50
    s_and_b32 s21, s51, 0xffff
    s_mov_b32 s22, 4194304
    s_mov_b32 s23, 0x20000
    s_cmp_lt_u32 s28, 4
    s_cbranch_scc0 L_pro_s
    s_barrier
    s_cmp_eq_u32 s2, 0
    s_cbranch_scc1 L_recurrent_scan__compressed_kv_cla__moe_arch_mod__prompt_kernel_rare_1
L_recurrent_scan__compressed_kv_cla__moe_arch_mod__prompt_kernel_back_2:
    s_add_u32 m0, s33, 0
    s_add_u32 s36, s31, 131072
    buffer_load_dwordx4 v2, s[4:7], s31 offen offset:0 lds
    buffer_load_dwordx4 v3, s[4:7], s31 offen offset:1024 lds
    buffer_load_dwordx4 v4, s[4:7], s31 offen offset:2048 lds
    buffer_load_dwordx4 v5, s[4:7], s31 offen offset:3072 lds
    s_add_u32 m0, s34, 0
    s_nop 0
    buffer_load_dwordx4 v6, s[8:11], s32 offen offset:0 nt lds
    buffer_load_dwordx4 v7, s[8:11], s32 offen offset:1024 nt lds
    buffer_load_dwordx4 v8, s[8:11], s32 offen offset:2048 nt lds
    buffer_load_dwordx4 v9, s[8:11], s32 offen offset:3072 nt lds
    s_add_u32 m0, s33, 16384
    s_nop 0
    buffer_load_dwordx4 v2, s[4:7], s36 offen offset:0 lds
    buffer_load_dwordx4 v3, s[4:7], s36 offen offset:1024 lds
    buffer_load_dwordx4 v4, s[4:7], s36 offen offset:2048 lds
    buffer_load_dwordx4 v5, s[4:7], s36 offen offset:3072 lds
    s_add_u32 m0, s34, 16384
    s_nop 0
    buffer_load_dwordx4 v6, s[20:23], s32 offen offset:0 nt lds
    buffer_load_dwordx4 v7, s[20:23], s32 offen offset:1024 nt lds
    buffer_load_dwordx4 v8, s[20:23], s32 offen offset:2048 nt lds
    buffer_load_dwordx4 v9, s[20:23], s32 offen offset:3072 nt lds
    s_add_u32 s31, s31, s40
    s_add_u32 s32, s32, s41
L_pro_s:
    s_add_u32 s54, s90, 0
    s_addc_u32 s55, s91, 0
    s_add_u32 s12, s54, 8388608
    s_addc_u32 s13, s55, 0
    s_and_b32 s13, s13, 0xffff
    s_mov_b32 s14, 33554432
    s_mov_b32 s15, 0x20000
    s_mov_b32 s24, s54
    s_and_b32 s25, s55, 0xffff
    s_mov_b32 s26, 83886080
    s_mov_b32 s27, 0x20000
    s_add_u32 s90, s54, 61865984
    s_addc_u32 s91, s55, 0
    v_and_b32 v16, 15, v1
    v_lshrrev_b32 v17, 4, v1
    s_bfe_u32 s36, s28, 0x10001
    s_lshl_b32 s36, s36, 14
    v_lshl_add_u32 v18, v16, 7, s36
    v_lshrrev_b32 v19, 1, v16
    v_xor_b32 v19, v19, v17
    v_lshl_add_u32 v10, v19, 4, v18
    v_xor_b32 v19, 4, v19
    v_lshl_add_u32 v11, v19, 4, v18
    v_lshrrev_b32 v16, 2, v16
    v_lshl_add_u32 v18, v17, 3, v16
    v_lshlrev_b32 v18, 8, v18
    s_lshr_b32 s36, s28, 2
    s_lshl_b32 s36, s36, 14
    s_add_u32 s36, s36, 65536
    v_add_u32 v18, s36, v18
    v_and_b32 v19, 3, v1
    v_lshl_add_u32 v18, v19, 3, v18
    v_and_b32 v17, 1, v17
    v_lshl_add_u32 v16, v17, 2, v16
    s_and_b32 s36, s28, 1
    s_lshl_b32 s36, s36, 2
    s_add_u32 s37, s36, 0
    v_xor_b32 v19, s37, v16
    v_lshl_add_u32 v12, v19, 5, v18
    s_add_u32 s37, s36, 1
    v_xor_b32 v19, s37, v16
    v_lshl_add_u32 v13, v19, 5, v18
    s_add_u32 s37, s36, 2
    v_xor_b32 v19, s37, v16
    v_lshl_add_u32 v14, v19, 5, v18
    s_add_u32 s37, s36, 3
    v_xor_b32 v19, s37, v16
    v_lshl_add_u32 v15, v19, 5, v18
    v_mov_b64 v[128:129], 0
    v_mov_b64 v[130:131], 0
    v_mov_b64 v[132:133], 0
    v_mov_b64 v[134:135], 0
    v_mov_b64 v[136:137], 0
    v_mov_b64 v[138:139], 0
    v_mov_b64 v[140:141], 0
    v_mov_b64 v[142:143], 0
    v_mov_b64 v[144:145], 0
    v_mov_b64 v[146:147], 0
    v_mov_b64 v[148:149], 0
    v_mov_b64 v[150:151], 0
    v_mov_b64 v[152:153], 0
    v_mov_b64 v[154:155], 0
    v_mov_b64 v[156:157], 0
    v_mov_b64 v[158:159], 0
    v_mov_b64 v[160:161], 0
    v_mov_b64 v[162:163], 0
    v_mov_b64 v[164:165], 0
    v_mov_b64 v[166:167], 0
    v_mov_b64 v[168:169], 0
    v_mov_b64 v[170:171], 0
    v_mov_b64 v[172:173], 0
    v_mov_b64 v[174:175], 0
    v_mov_b64 v[176:177], 0
    v_mov_b64 v[178:179], 0
    v_mov_b64 v[180:181], 0
    v_mov_b64 v[182:183], 0
    v_mov_b64 v[184:185], 0
    v_mov_b64 v[186:187], 0
    v_mov_b64 v[188:189], 0
    v_mov_b64 v[190:191], 0
    v_mov_b64 v[192:193], 0
    v_mov_b64 v[194:195], 0
    v_mov_b64 v[196:197], 0
    v_mov_b64 v[198:199], 0
    v_mov_b64 v[200:201], 0
    v_mov_b64 v[202:203], 0
    v_mov_b64 v[204:205], 0
    v_mov_b64 v[206:207], 0
    v_mov_b64 v[208:209], 0
    v_mov_b64 v[210:211], 0
    v_mov_b64 v[212:213], 0
    v_mov_b64 v[214:215], 0
    v_mov_b64 v[216:217], 0
    v_mov_b64 v[218:219], 0
    v_mov_b64 v[220:221], 0
    v_mov_b64 v[222:223], 0
    v_mov_b64 v[224:225], 0
    v_mov_b64 v[226:227], 0
    v_mov_b64 v[228:229], 0
    v_mov_b64 v[230:231], 0
    v_mov_b64 v[232:233], 0
    v_mov_b64 v[234:235], 0
    v_mov_b64 v[236:237], 0
    v_mov_b64 v[238:239], 0
    v_mov_b64 v[240:241], 0
    v_mov_b64 v[242:243], 0
    v_mov_b64 v[244:245], 0
    v_mov_b64 v[246:247], 0
    v_mov_b64 v[248:249], 0
    v_mov_b64 v[250:251], 0
    v_mov_b64 v[252:253], 0
    v_mov_b64 v[254:255], 0
    v_mov_b32 v118, 0
    v_mov_b32 v117, 0
    s_lshl_b32 s36, s30, 7
    s_lshl_b32 s37, s28, 4
    s_add_u32 s36, s36, s37
    v_bfe_u32 v17, v1, 1, 3
    v_add_u32 v17, s36, v17
    v_lshlrev_b32 v17, 13, v17
    v_and_b32 v19, 1, v1
    v_lshl_add_u32 v17, v19, 7, v17
    s_lshl_b32 s36, s29, 8
    v_add_u32 v17, s36, v17
    s_mov_b32 s45, 32768
    s_cmp_lt_u32 s28, 4
    s_cbranch_scc0 L_pro_b
    s_add_u32 m0, s33, 32768
    s_add_u32 s36, s31, 131072
    buffer_load_dwordx4 v2, s[4:7], s31 offen offset:0 lds
    buffer_load_dwordx4 v3, s[4:7], s31 offen offset:1024 lds
    buffer_load_dwordx4 v4, s[4:7], s31 offen offset:2048 lds
    buffer_load_dwordx4 v5, s[4:7], s31 offen offset:3072 lds
    s_add_u32 m0, s34, 32768
    s_nop 0
    buffer_load_dwordx4 v6, s[8:11], s32 offen offset:0 nt lds
    buffer_load_dwordx4 v7, s[8:11], s32 offen offset:1024 nt lds
    buffer_load_dwordx4 v8, s[8:11], s32 offen offset:2048 nt lds
    buffer_load_dwordx4 v9, s[8:11], s32 offen offset:3072 nt lds
    s_add_u32 m0, s33, 49152
    s_nop 0
    buffer_load_dwordx4 v2, s[4:7], s36 offen offset:0 lds
    buffer_load_dwordx4 v3, s[4:7], s36 offen offset:1024 lds
    buffer_load_dwordx4 v4, s[4:7], s36 offen offset:2048 lds
    buffer_load_dwordx4 v5, s[4:7], s36 offen offset:3072 lds
    s_add_u32 m0, s34, 49152
    s_nop 0
    buffer_load_dwordx4 v6, s[20:23], s32 offen offset:0 nt lds
    buffer_load_dwordx4 v7, s[20:23], s32 offen offset:1024 nt lds
    buffer_load_dwordx4 v8, s[20:23], s32 offen offset:2048 nt lds
    buffer_load_dwordx4 v9, s[20:23], s32 offen offset:3072 nt lds
    s_add_u32 s31, s31, s40
    s_add_u32 s32, s32, s41
    s_waitcnt vmcnt(16)
    s_branch L_pro_j
L_pro_b:
    s_mov_b64 s[8:9], s[20:21]
    s_mov_b32 s31, 256
    s_mov_b32 s32, 1048576
    s_and_b32 s60, s28, 3
    s_waitcnt vmcnt(0)
    s_mov_b32 s3, 0
L_ln:
    v_lshlrev_b32 v44, 16, v36
    v_and_b32 v45, 0xffff0000, v36
    v_lshlrev_b32 v46, 16, v37
    v_and_b32 v47, 0xffff0000, v37
    v_lshlrev_b32 v48, 16, v38
    v_and_b32 v49, 0xffff0000, v38
    v_lshlrev_b32 v50, 16, v39
    v_and_b32 v51, 0xffff0000, v39
    v_lshlrev_b32 v52, 16, v40
    v_and_b32 v53, 0xffff0000, v40
    v_lshlrev_b32 v54, 16, v41
    v_and_b32 v55, 0xffff0000, v41
    v_lshlrev_b32 v56, 16, v42
    v_and_b32 v57, 0xffff0000, v42
    v_lshlrev_b32 v58, 16, v43
    v_and_b32 v59, 0xffff0000, v43
    v_lshlrev_b32 v60, 16, v20
    v_lshlrev_b32 v76, 16, v28
    v_and_b32 v61, 0xffff0000, v20
    v_and_b32 v77, 0xffff0000, v28
    v_lshlrev_b32 v62, 16, v21
    v_lshlrev_b32 v78, 16, v29
    v_and_b32 v63, 0xffff0000, v21
    v_and_b32 v79, 0xffff0000, v29
    v_lshlrev_b32 v64, 16, v22
    v_lshlrev_b32 v80, 16, v30
    v_and_b32 v65, 0xffff0000, v22
    v_and_b32 v81, 0xffff0000, v30
    v_lshlrev_b32 v66, 16, v23
    v_lshlrev_b32 v82, 16, v31
    v_and_b32 v67, 0xffff0000, v23
    v_and_b32 v83, 0xffff0000, v31
    v_lshlrev_b32 v68, 16, v24
    v_lshlrev_b32 v84, 16, v32
    v_and_b32 v69, 0xffff0000, v24
    v_and_b32 v85, 0xffff0000, v32
    v_lshlrev_b32 v70, 16, v25
    v_lshlrev_b32 v86, 16, v33
    v_and_b32 v71, 0xffff0000, v25
    v_and_b32 v87, 0xffff0000, v33
    v_lshlrev_b32 v72, 16, v26
    v_lshlrev_b32 v88, 16, v34
    v_and_b32 v73, 0xffff0000, v26
    v_and_b32 v89, 0xffff0000, v34
    v_lshlrev_b32 v74, 16, v27
    v_lshlrev_b32 v90, 16, v35
    v_and_b32 v75, 0xffff0000, v27
    v_and_b32 v91, 0xffff0000, v35
    v_add_f32 v92, v60, v61
    v_add_f32 v100, v76, v77
    v_add_f32 v92, v92, v62
    v_add_f32 v100, v100, v78
    v_add_f32 v92, v92, v63
    v_add_f32 v100, v100, v79
    v_add_f32 v92, v92, v64
    v_add_f32 v100, v100, v80
    v_add_f32 v92, v92, v65
    v_add_f32 v100, v100, v81
    v_add_f32 v92, v92, v66
    v_add_f32 v100, v100, v82
    v_add_f32 v92, v92, v67
    v_add_f32 v100, v100, v83
    v_add_f32 v92, v92, v68
    v_add_f32 v100, v100, v84
    v_add_f32 v92, v92, v69
    v_add_f32 v100, v100, v85
    v_add_f32 v92, v92, v70
    v_add_f32 v100, v100, v86
    v_add_f32 v92, v92, v71
    v_add_f32 v100, v100, v87
    v_add_f32 v92, v92, v72
    v_add_f32 v100, v100, v88
    v_add_f32 v92, v92, v73
    v_add_f32 v100, v100, v89
    v_add_f32 v92, v92, v74
    v_add_f32 v100, v100, v90
    v_add_f32 v92, v92, v75
    v_add_f32 v100, v100, v91
    s_nop 0
    v_add_f32_dpp v92, v92, v92 quad_perm:[1,0,3,2] row_mask:0xf bank_mask:0xf
    v_add_f32_dpp v100, v100, v100 quad_perm:[1,0,3,2] row_mask:0xf bank_mask:0xf
    s_nop 0
    v_add_f32_dpp v92, v92, v92 quad_perm:[2,3,0,1] row_mask:0xf bank_mask:0xf
    v_add_f32_dpp v100, v100, v100 quad_perm:[2,3,0,1] row_mask:0xf bank_mask:0xf
    s_nop 0
    v_add_f32_dpp v92, v92, v92 row_half_mirror row_mask:0xf bank_mask:0xf
    v_add_f32_dpp v100, v100, v100 row_half_mirror row_mask:0xf bank_mask:0xf
    s_nop 0
    v_add_f32_dpp v92, v92, v92 row_mirror row_mask:0xf bank_mask:0xf
    v_add_f32_dpp v100, v100, v100 row_mirror row_mask:0xf bank_mask:0xf
    v_readlane_b32 s36, v92, 0
    v_readlane_b32 s56, v100, 0
    v_readlane_b32 s37, v92, 16
    v_readlane_b32 s57, v100, 16
    v_readlane_b32 s38, v92, 32
    v_readlane_b32 s58, v100, 32
    v_readlane_b32 s39, v92, 48
    v_readlane_b32 s59, v100, 48
    v_mov_b32 v93, s36
    v_mov_b32 v101, s56
    v_add_f32 v93, s37, v93
    v_add_f32 v101, s57, v101
    v_add_f32 v93, s38, v93
    v_add_f32 v101, s58, v101
    v_add_f32 v93, s39, v93
    v_add_f32 v101, s59, v101
    v_mul_f32 v93, 0x3a800000, v93
    v_mul_f32 v101, 0x3a800000, v101
    v_sub_f32 v94, v60, v93
    v_sub_f32 v102, v76, v101
    v_mul_f32 v92, v94, v94
    v_mul_f32 v100, v102, v102
    v_sub_f32 v94, v61, v93
    v_sub_f32 v102, v77, v101
    v_fmac_f32 v92, v94, v94
    v_fmac_f32 v100, v102, v102
    v_sub_f32 v94, v62, v93
    v_sub_f32 v102, v78, v101
    v_fmac_f32 v92, v94, v94
    v_fmac_f32 v100, v102, v102
    v_sub_f32 v94, v63, v93
    v_sub_f32 v102, v79, v101
    v_fmac_f32 v92, v94, v94
    v_fmac_f32 v100, v102, v102
    v_sub_f32 v94, v64, v93
    v_sub_f32 v102, v80, v101
    v_fmac_f32 v92, v94, v94
    v_fmac_f32 v100, v102, v102
    v_sub_f32 v94, v65, v93
    v_sub_f32 v102, v81, v101
    v_fmac_f32 v92, v94, v94
    v_fmac_f32 v100, v102, v102
    v_sub_f32 v94, v66, v93
    v_sub_f32 v102, v82, v101
    v_fmac_f32 v92, v94, v94
    v_fmac_f32 v100, v102, v102
    v_sub_f32 v94, v67, v93
    v_sub_f32 v102, v83, v101
    v_fmac_f32 v92, v94, v94
    v_fmac_f32 v100, v102, v102
    v_sub_f32 v94, v68, v93
    v_sub_f32 v102, v84, v101
    v_fmac_f32 v92, v94, v94
    v_fmac_f32 v100, v102, v102
    v_sub_f32 v94, v69, v93
    v_sub_f32 v102, v85, v101
    v_fmac_f32 v92, v94, v94
    v_fmac_f32 v100, v102, v102
    v_sub_f32 v94, v70, v93
    v_sub_f32 v102, v86, v101
    v_fmac_f32 v92, v94, v94
    v_fmac_f32 v100, v102, v102
    v_sub_f32 v94, v71, v93
    v_sub_f32 v102, v87, v101
    v_fmac_f32 v92, v94, v94
    v_fmac_f32 v100, v102, v102
    v_sub_f32 v94, v72, v93
    v_sub_f32 v102, v88, v101
    v_fmac_f32 v92, v94, v94
    v_fmac_f32 v100, v102, v102
    v_sub_f32 v94, v73, v93
    v_sub_f32 v102, v89, v101
    v_fmac_f32 v92, v94, v94
    v_fmac_f32 v100, v102, v102
    v_sub_f32 v94, v74, v93
    v_sub_f32 v102, v90, v101
    v_fmac_f32 v92, v94, v94
    v_fmac_f32 v100, v102, v102
    v_sub_f32 v94, v75, v93
    v_sub_f32 v102, v91, v101
    v_fmac_f32 v92, v94, v94
    v_fmac_f32 v100, v102, v102
    s_nop 0
    v_add_f32_dpp v92, v92, v92 quad_perm:[1,0,3,2] row_mask:0xf bank_mask:0xf
    v_add_f32_dpp v100, v100, v100 quad_perm:[1,0,3,2] row_mask:0xf bank_mask:0xf
    s_nop 0
    v_add_f32_dpp v92, v92, v92 quad_perm:[2,3,0,1] row_mask:0xf bank_mask:0xf
    v_add_f32_dpp v100, v100, v100 quad_perm:[2,3,0,1] row_mask:0xf bank_mask:0xf
    s_nop 0
    v_add_f32_dpp v92, v92, v92 row_half_mirror row_mask:0xf bank_mask:0xf
    v_add_f32_dpp v100, v100, v100 row_half_mirror row_mask:0xf bank_mask:0xf
    s_nop 0
    v_add_f32_dpp v92, v92, v92 row_mirror row_mask:0xf bank_mask:0xf
    v_add_f32_dpp v100, v100, v100 row_mirror row_mask:0xf bank_mask:0xf
    v_readlane_b32 s36, v92, 0
    v_readlane_b32 s56, v100, 0
    v_readlane_b32 s37, v92, 16
    v_readlane_b32 s57, v100, 16
    v_readlane_b32 s38, v92, 32
    v_readlane_b32 s58, v100, 32
    v_readlane_b32 s39, v92, 48
    v_readlane_b32 s59, v100, 48
    v_mov_b32 v94, s36
    v_mov_b32 v102, s56
    v_add_f32 v94, s37, v94
    v_add_f32 v102, s57, v102
    v_add_f32 v94, s38, v94
    v_add_f32 v102, s58, v102
    v_add_f32 v94, s39, v94
    v_add_f32 v102, s59, v102
    v_mul_f32 v94, 0x3a800000, v94
    v_mul_f32 v102, 0x3a800000, v102
    v_cvt_pk_bf16_f32 v95, v93, v94
    v_cvt_pk_bf16_f32 v103, v101, v102
    v_lshlrev_b32 v98, 16, v95
    v_lshlrev_b32 v106, 16, v103
    v_and_b32 v94, 0xffff0000, v95
    v_and_b32 v102, 0xffff0000, v103
    v_add_f32 v94, 0x3727c5ac, v94
    v_add_f32 v102, 0x3727c5ac, v102
    v_cvt_pk_bf16_f32 v94, v94, v94
    v_cvt_pk_bf16_f32 v102, v102, v102
    v_lshlrev_b32 v94, 16, v94
    v_lshlrev_b32 v102, 16, v102
    v_sqrt_f32 v94, v94
    v_sqrt_f32 v102, v102
    v_cvt_pk_bf16_f32 v94, v94, v94
    v_cvt_pk_bf16_f32 v102, v102, v102
    v_lshlrev_b32 v94, 16, v94
    v_lshlrev_b32 v102, 16, v102
    v_rcp_f32 v99, v94
    v_rcp_f32 v107, v102
    v_fma_f32 v96, -v94, v99, 1.0
    v_fma_f32 v104, -v102, v107, 1.0
    v_fma_f32 v99, v96, v99, v99
    v_fma_f32 v107, v104, v107, v107
    v_sub_f32 v60, v60, v98
    v_sub_f32 v76, v76, v106
    v_sub_f32 v61, v61, v98
    v_sub_f32 v77, v77, v106
    v_cvt_pk_bf16_f32 v96, v60, v61
    v_cvt_pk_bf16_f32 v104, v76, v77
    v_lshlrev_b32 v60, 16, v96
    v_lshlrev_b32 v76, 16, v104
    v_and_b32 v61, 0xffff0000, v96
    v_and_b32 v77, 0xffff0000, v104
    v_mul_f32 v60, v60, v99
    v_mul_f32 v76, v76, v107
    v_mul_f32 v61, v61, v99
    v_mul_f32 v77, v77, v107
    v_cvt_pk_bf16_f32 v108, v60, v61
    v_cvt_pk_bf16_f32 v120, v76, v77
    v_lshlrev_b32 v60, 16, v108
    v_lshlrev_b32 v76, 16, v120
    v_and_b32 v61, 0xffff0000, v108
    v_and_b32 v77, 0xffff0000, v120
    v_mul_f32 v92, v60, v44
    v_mul_f32 v100, v76, v44
    v_fmac_f32 v92, v61, v45
    v_fmac_f32 v100, v77, v45
    v_sub_f32 v62, v62, v98
    v_sub_f32 v78, v78, v106
    v_sub_f32 v63, v63, v98
    v_sub_f32 v79, v79, v106
    v_cvt_pk_bf16_f32 v96, v62, v63
    v_cvt_pk_bf16_f32 v104, v78, v79
    v_lshlrev_b32 v62, 16, v96
    v_lshlrev_b32 v78, 16, v104
    v_and_b32 v63, 0xffff0000, v96
    v_and_b32 v79, 0xffff0000, v104
    v_mul_f32 v62, v62, v99
    v_mul_f32 v78, v78, v107
    v_mul_f32 v63, v63, v99
    v_mul_f32 v79, v79, v107
    v_cvt_pk_bf16_f32 v109, v62, v63
    v_cvt_pk_bf16_f32 v121, v78, v79
    v_lshlrev_b32 v62, 16, v109
    v_lshlrev_b32 v78, 16, v121
    v_and_b32 v63, 0xffff0000, v109
    v_and_b32 v79, 0xffff0000, v121
    v_fmac_f32 v92, v62, v46
    v_fmac_f32 v100, v78, v46
    v_fmac_f32 v92, v63, v47
    v_fmac_f32 v100, v79, v47
    v_sub_f32 v64, v64, v98
    v_sub_f32 v80, v80, v106
    v_sub_f32 v65, v65, v98
    v_sub_f32 v81, v81, v106
    v_cvt_pk_bf16_f32 v96, v64, v65
    v_cvt_pk_bf16_f32 v104, v80, v81
    v_lshlrev_b32 v64, 16, v96
    v_lshlrev_b32 v80, 16, v104
    v_and_b32 v65, 0xffff0000, v96
    v_and_b32 v81, 0xffff0000, v104
    v_mul_f32 v64, v64, v99
    v_mul_f32 v80, v80, v107
    v_mul_f32 v65, v65, v99
    v_mul_f32 v81, v81, v107
    v_cvt_pk_bf16_f32 v110, v64, v65
    v_cvt_pk_bf16_f32 v122, v80, v81
    v_lshlrev_b32 v64, 16, v110
    v_lshlrev_b32 v80, 16, v122
    v_and_b32 v65, 0xffff0000, v110
    v_and_b32 v81, 0xffff0000, v122
    v_fmac_f32 v92, v64, v48
    v_fmac_f32 v100, v80, v48
    v_fmac_f32 v92, v65, v49
    v_fmac_f32 v100, v81, v49
    v_sub_f32 v66, v66, v98
    v_sub_f32 v82, v82, v106
    v_sub_f32 v67, v67, v98
    v_sub_f32 v83, v83, v106
    v_cvt_pk_bf16_f32 v96, v66, v67
    v_cvt_pk_bf16_f32 v104, v82, v83
    v_lshlrev_b32 v66, 16, v96
    v_lshlrev_b32 v82, 16, v104
    v_and_b32 v67, 0xffff0000, v96
    v_and_b32 v83, 0xffff0000, v104
    v_mul_f32 v66, v66, v99
    v_mul_f32 v82, v82, v107
    v_mul_f32 v67, v67, v99
    v_mul_f32 v83, v83, v107
    v_cvt_pk_bf16_f32 v111, v66, v67
    v_cvt_pk_bf16_f32 v123, v82, v83
    v_lshlrev_b32 v66, 16, v111
    v_lshlrev_b32 v82, 16, v123
    v_and_b32 v67, 0xffff0000, v111
    v_and_b32 v83, 0xffff0000, v123
    v_fmac_f32 v92, v66, v50
    v_fmac_f32 v100, v82, v50
    v_fmac_f32 v92, v67, v51
    v_fmac_f32 v100, v83, v51
    v_sub_f32 v68, v68, v98
    v_sub_f32 v84, v84, v106
    v_sub_f32 v69, v69, v98
    v_sub_f32 v85, v85, v106
    v_cvt_pk_bf16_f32 v96, v68, v69
    v_cvt_pk_bf16_f32 v104, v84, v85
    v_lshlrev_b32 v68, 16, v96
    v_lshlrev_b32 v84, 16, v104
    v_and_b32 v69, 0xffff0000, v96
    v_and_b32 v85, 0xffff0000, v104
    v_mul_f32 v68, v68, v99
    v_mul_f32 v84, v84, v107
    v_mul_f32 v69, v69, v99
    v_mul_f32 v85, v85, v107
    v_cvt_pk_bf16_f32 v112, v68, v69
    v_cvt_pk_bf16_f32 v124, v84, v85
    v_lshlrev_b32 v68, 16, v112
    v_lshlrev_b32 v84, 16, v124
    v_and_b32 v69, 0xffff0000, v112
    v_and_b32 v85, 0xffff0000, v124
    v_fmac_f32 v92, v68, v52
    v_fmac_f32 v100, v84, v52
    v_fmac_f32 v92, v69, v53
    v_fmac_f32 v100, v85, v53
    v_sub_f32 v70, v70, v98
    v_sub_f32 v86, v86, v106
    v_sub_f32 v71, v71, v98
    v_sub_f32 v87, v87, v106
    v_cvt_pk_bf16_f32 v96, v70, v71
    v_cvt_pk_bf16_f32 v104, v86, v87
    v_lshlrev_b32 v70, 16, v96
    v_lshlrev_b32 v86, 16, v104
    v_and_b32 v71, 0xffff0000, v96
    v_and_b32 v87, 0xffff0000, v104
    v_mul_f32 v70, v70, v99
    v_mul_f32 v86, v86, v107
    v_mul_f32 v71, v71, v99
    v_mul_f32 v87, v87, v107
    v_cvt_pk_bf16_f32 v113, v70, v71
    v_cvt_pk_bf16_f32 v125, v86, v87
    v_lshlrev_b32 v70, 16, v113
    v_lshlrev_b32 v86, 16, v125
    v_and_b32 v71, 0xffff0000, v113
    v_and_b32 v87, 0xffff0000, v125
    v_fmac_f32 v92, v70, v54
    v_fmac_f32 v100, v86, v54
    v_fmac_f32 v92, v71, v55
    v_fmac_f32 v100, v87, v55
    v_sub_f32 v72, v72, v98
    v_sub_f32 v88, v88, v106
    v_sub_f32 v73, v73, v98
    v_sub_f32 v89, v89, v106
    v_cvt_pk_bf16_f32 v96, v72, v73
    v_cvt_pk_bf16_f32 v104, v88, v89
    v_lshlrev_b32 v72, 16, v96
    v_lshlrev_b32 v88, 16, v104
    v_and_b32 v73, 0xffff0000, v96
    v_and_b32 v89, 0xffff0000, v104
    v_mul_f32 v72, v72, v99
    v_mul_f32 v88, v88, v107
    v_mul_f32 v73, v73, v99
    v_mul_f32 v89, v89, v107
    v_cvt_pk_bf16_f32 v114, v72, v73
    v_cvt_pk_bf16_f32 v126, v88, v89
    v_lshlrev_b32 v72, 16, v114
    v_lshlrev_b32 v88, 16, v126
    v_and_b32 v73, 0xffff0000, v114
    v_and_b32 v89, 0xffff0000, v126
    v_fmac_f32 v92, v72, v56
    v_fmac_f32 v100, v88, v56
    v_fmac_f32 v92, v73, v57
    v_fmac_f32 v100, v89, v57
    v_sub_f32 v74, v74, v98
    v_sub_f32 v90, v90, v106
    v_sub_f32 v75, v75, v98
    v_sub_f32 v91, v91, v106
    v_cvt_pk_bf16_f32 v96, v74, v75
    v_cvt_pk_bf16_f32 v104, v90, v91
    v_lshlrev_b32 v74, 16, v96
    v_lshlrev_b32 v90, 16, v104
    v_and_b32 v75, 0xffff0000, v96
    v_and_b32 v91, 0xffff0000, v104
    v_mul_f32 v74, v74, v99
    v_mul_f32 v90, v90, v107
    v_mul_f32 v75, v75, v99
    v_mul_f32 v91, v91, v107
    v_cvt_pk_bf16_f32 v115, v74, v75
    v_cvt_pk_bf16_f32 v127, v90, v91
    v_lshlrev_b32 v74, 16, v115
    v_lshlrev_b32 v90, 16, v127
    v_and_b32 v75, 0xffff0000, v115
    v_and_b32 v91, 0xffff0000, v127
    v_fmac_f32 v92, v74, v58
    v_fmac_f32 v100, v90, v58
    v_fmac_f32 v92, v75, v59
    v_fmac_f32 v100, v91, v59
    s_mul_i32 s36, s60, 2064
    s_mul_i32 s56, s28, 2064
    s_add_u32 s36, s36, 131072
    s_add_u32 s56, s56, 131072
    v_lshl_add_u32 v95, v1, 4, s36
    v_lshl_add_u32 v103, v1, 4, s56
    ds_write_b128 v95, v[108:111]
    ds_write_b128 v103, v[120:123]
    ds_write_b128 v95, v[112:115] offset:1024
    ds_write_b128 v103, v[124:127] offset:1024
    s_nop 0
    v_add_f32_dpp v92, v92, v92 quad_perm:[1,0,3,2] row_mask:0xf bank_mask:0xf
    v_add_f32_dpp v100, v100, v100 quad_perm:[1,0,3,2] row_mask:0xf bank_mask:0xf
    s_nop 0
    v_add_f32_dpp v92, v92, v92 quad_perm:[2,3,0,1] row_mask:0xf bank_mask:0xf
    v_add_f32_dpp v100, v100, v100 quad_perm:[2,3,0,1] row_mask:0xf bank_mask:0xf
    s_nop 0
    v_add_f32_dpp v92, v92, v92 row_half_mirror row_mask:0xf bank_mask:0xf
    v_add_f32_dpp v100, v100, v100 row_half_mirror row_mask:0xf bank_mask:0xf
    s_nop 0
    v_add_f32_dpp v92, v92, v92 row_mirror row_mask:0xf bank_mask:0xf
    v_add_f32_dpp v100, v100, v100 row_mirror row_mask:0xf bank_mask:0xf
    v_readlane_b32 s36, v92, 0
    v_readlane_b32 s56, v100, 0
    v_readlane_b32 s37, v92, 16
    v_readlane_b32 s57, v100, 16
    v_readlane_b32 s38, v92, 32
    v_readlane_b32 s58, v100, 32
    v_readlane_b32 s39, v92, 48
    v_readlane_b32 s59, v100, 48
    v_mov_b32 v93, s36
    v_mov_b32 v101, s56
    v_add_f32 v93, s37, v93
    v_add_f32 v101, s57, v101
    v_add_f32 v93, s38, v93
    v_add_f32 v101, s58, v101
    v_add_f32 v93, s39, v93
    v_add_f32 v101, s59, v101
    v_cvt_pk_bf16_f32 v93, v93, v93
    v_cvt_pk_bf16_f32 v101, v101, v101
    v_lshlrev_b32 v93, 16, v93
    v_lshlrev_b32 v101, 16, v101
    v_ashrrev_i32 v95, 31, v93
    v_ashrrev_i32 v103, 31, v101
    v_or_b32 v95, 0x80000000, v95
    v_or_b32 v103, 0x80000000, v103
    v_xor_b32 v95, v93, v95
    v_xor_b32 v103, v101, v103
    v_and_b32 v95, 0xffff0000, v95
    v_and_b32 v103, 0xffff0000, v103
    s_sub_u32 s36, 0xffff, s42
    s_sub_u32 s56, 0xffff, s43
    v_or_b32 v95, s36, v95
    v_or_b32 v103, s56, v103
    s_lshl_b32 s37, s60, 3
    s_lshl_b32 s57, s28, 3
    s_add_u32 s37, s37, 147712
    s_add_u32 s57, s57, 147712
    v_mov_b32 v94, s37
    v_mov_b32 v102, s57
    ds_write_b64 v94, v[98:99]
    ds_write_b64 v102, v[106:107]
    ds_write_b32 v94, v95 offset:64
    ds_write_b32 v102, v103 offset:64
    s_waitcnt vmcnt(0) lgkmcnt(0)
    s_cmp_eq_u32 s3, 0
    s_mov_b32 s3, 0
    s_cbranch_scc0 L_ln
L_pro_j:
    s_barrier
    ds_read_b128 v[20:23], v10 offset:0
    ds_read_b64_tr_b16 v[52:53], v12 offset:0
    ds_read_b64_tr_b16 v[54:55], v12 offset:1024
    ds_read_b64_tr_b16 v[56:57], v13 offset:0
    ds_read_b64_tr_b16 v[58:59], v13 offset:1024
    ds_read_b64_tr_b16 v[60:61], v14 offset:0
    ds_read_b64_tr_b16 v[62:63], v14 offset:1024
    ds_read_b64_tr_b16 v[64:65], v15 offset:0
    ds_read_b64_tr_b16 v[66:67], v15 offset:1024
    ds_read_b128 v[24:27], v10 offset:2048
    ds_read_b128 v[28:31], v10 offset:4096
    ds_read_b128 v[32:35], v10 offset:6144
    ds_read_b128 v[36:39], v10 offset:8192
    ds_read_b128 v[40:43], v10 offset:10240
    ds_read_b128 v[44:47], v10 offset:12288
    ds_read_b128 v[48:51], v10 offset:14336
    s_add_u32 s36, s2, s28
    s_cmp_eq_u32 s36, 0
    s_cbranch_scc1 L_recurrent_scan__compressed_kv_cla__moe_arch_mod__prompt_kernel_rare_3
L_recurrent_scan__compressed_kv_cla__moe_arch_mod__prompt_kernel_back_4:
    v_and_b32 v100, 7, v1
    v_lshrrev_b32 v101, 3, v1
    v_mul_u32_u24 v102, 2064, v100
    v_lshl_add_u32 v102, v101, 4, v102
    s_lshl_b32 s36, s28, 8
    s_add_u32 s36, s36, 131072
    v_add_u32 v102, s36, v102
    ds_read_b128 v[120:123], v102
    ds_read_b128 v[124:127], v102 offset:128
    v_lshlrev_b32 v100, 4, v100
    v_lshl_add_u32 v100, v101, 8, v100
    s_lshr_b32 s36, s2, 1
    s_lshl_b32 s36, s36, 15
    s_and_b32 s37, s2, 1
    s_lshl_b32 s37, s37, 7
    s_add_u32 s36, s36, s37
    s_lshl_b32 s37, s28, 12
    s_add_u32 s36, s36, s37
    s_waitcnt lgkmcnt(0)
    buffer_store_dwordx4 v[120:123], v100, s[24:27], s36 offen sc1
    buffer_store_dwordx4 v[124:127], v100, s[24:27], s36 offen offset:2048 sc1
    s_cmp_eq_u32 s28, 7
    s_cbranch_scc1 L_recurrent_scan__compressed_kv_cla__moe_arch_mod__prompt_kernel_rare_5
L_recurrent_scan__compressed_kv_cla__moe_arch_mod__prompt_kernel_back_6:
    s_mov_b32 s35, 0
    s_cmp_eq_u32 s28, 0
    s_cselect_b32 s43, 9, 0
    s_cselect_b32 s44, 2, 1
    s_cmp_lt_u32 s28, 4
    s_cbranch_scc0 L_kv_vloop
    .p2align 6
L_kv_kloop:
    s_waitcnt lgkmcnt(0)
    v_mfma_f32_16x16x32_bf16 v[128:131], v[52:55], v[20:23], v[128:131]
    ds_read_b128 v[68:71], v11 offset:0
    v_mfma_f32_16x16x32_bf16 v[132:135], v[56:59], v[20:23], v[132:135]
    ds_read_b64_tr_b16 v[100:101], v12 offset:8192
    v_mfma_f32_16x16x32_bf16 v[136:139], v[60:63], v[20:23], v[136:139]
    ds_read_b64_tr_b16 v[102:103], v12 offset:9216
    v_mfma_f32_16x16x32_bf16 v[140:143], v[64:67], v[20:23], v[140:143]
    ds_read_b64_tr_b16 v[104:105], v13 offset:8192
    v_mfma_f32_16x16x32_bf16 v[144:147], v[52:55], v[24:27], v[144:147]
    ds_read_b64_tr_b16 v[106:107], v13 offset:9216
    v_mfma_f32_16x16x32_bf16 v[148:151], v[56:59], v[24:27], v[148:151]
    ds_read_b64_tr_b16 v[108:109], v14 offset:8192
    v_mfma_f32_16x16x32_bf16 v[152:155], v[60:63], v[24:27], v[152:155]
    ds_read_b64_tr_b16 v[110:111], v14 offset:9216
    v_mfma_f32_16x16x32_bf16 v[156:159], v[64:67], v[24:27], v[156:159]
    ds_read_b64_tr_b16 v[112:113], v15 offset:8192
    v_mfma_f32_16x16x32_bf16 v[160:163], v[52:55], v[28:31], v[160:163]
    ds_read_b64_tr_b16 v[114:115], v15 offset:9216
    v_mfma_f32_16x16x32_bf16 v[164:167], v[56:59], v[28:31], v[164:167]
    ds_read_b128 v[72:75], v11 offset:2048
    v_mfma_f32_16x16x32_bf16 v[168:171], v[60:63], v[28:31], v[168:171]
    ds_read_b128 v[76:79], v11 offset:4096
    v_mfma_f32_16x16x32_bf16 v[172:175], v[64:67], v[28:31], v[172:175]
    ds_read_b128 v[80:83], v11 offset:6144
    v_mfma_f32_16x16x32_bf16 v[176:179], v[52:55], v[32:35], v[176:179]
    ds_read_b128 v[84:87], v11 offset:8192
    v_mfma_f32_16x16x32_bf16 v[180:183], v[56:59], v[32:35], v[180:183]
    ds_read_b128 v[88:91], v11 offset:10240
    v_mfma_f32_16x16x32_bf16 v[184:187], v[60:63], v[32:35], v[184:187]
    ds_read_b128 v[92:95], v11 offset:12288
    v_mfma_f32_16x16x32_bf16 v[188:191], v[64:67], v[32:35], v[188:191]
    ds_read_b128 v[96:99], v11 offset:14336
    v_mfma_f32_16x16x32_bf16 v[192:195], v[52:55], v[36:39], v[192:195]
    v_mfma_f32_16x16x32_bf16 v[196:199], v[56:59], v[36:39], v[196:199]
    v_mfma_f32_16x16x32_bf16 v[200:203], v[60:63], v[36:39], v[200:203]
    v_mfma_f32_16x16x32_bf16 v[204:207], v[64:67], v[36:39], v[204:207]
    v_mfma_f32_16x16x32_bf16 v[208:211], v[52:55], v[40:43], v[208:211]
    v_mfma_f32_16x16x32_bf16 v[212:215], v[56:59], v[40:43], v[212:215]
    v_mfma_f32_16x16x32_bf16 v[216:219], v[60:63], v[40:43], v[216:219]
    v_mfma_f32_16x16x32_bf16 v[220:223], v[64:67], v[40:43], v[220:223]
    v_mfma_f32_16x16x32_bf16 v[224:227], v[52:55], v[44:47], v[224:227]
    v_mfma_f32_16x16x32_bf16 v[228:231], v[56:59], v[44:47], v[228:231]
    v_mfma_f32_16x16x32_bf16 v[232:235], v[60:63], v[44:47], v[232:235]
    v_mfma_f32_16x16x32_bf16 v[236:239], v[64:67], v[44:47], v[236:239]
    v_mfma_f32_16x16x32_bf16 v[240:243], v[52:55], v[48:51], v[240:243]
    v_mfma_f32_16x16x32_bf16 v[244:247], v[56:59], v[48:51], v[244:247]
    v_mfma_f32_16x16x32_bf16 v[248:251], v[60:63], v[48:51], v[248:251]
    v_mfma_f32_16x16x32_bf16 v[252:255], v[64:67], v[48:51], v[252:255]
    s_cmp_eq_u32 s35, 3
    s_cbranch_scc1 L_recurrent_scan__compressed_kv_cla__moe_arch_mod__prompt_kernel_rare_7
L_recurrent_scan__compressed_kv_cla__moe_arch_mod__prompt_kernel_back_8:
    s_cmp_lt_u32 s35, s44
    s_cbranch_scc1 L_recurrent_scan__compressed_kv_cla__moe_arch_mod__prompt_kernel_w0_9
    s_waitcnt vmcnt(1)
L_recurrent_scan__compressed_kv_cla__moe_arch_mod__prompt_kernel_w0b_10:
    s_waitcnt lgkmcnt(0)
    s_barrier
    v_mfma_f32_16x16x32_bf16 v[128:131], v[100:103], v[68:71], v[128:131]
    ds_read_b128 v[20:23], v10 offset:32768
    s_add_u32 m0, s33, 0
    v_mfma_f32_16x16x32_bf16 v[132:135], v[104:107], v[68:71], v[132:135]
    ds_read_b64_tr_b16 v[52:53], v12 offset:32768
    buffer_load_dwordx4 v2, s[4:7], s31 offen offset:0 lds
    v_mfma_f32_16x16x32_bf16 v[136:139], v[108:111], v[68:71], v[136:139]
    ds_read_b64_tr_b16 v[54:55], v12 offset:33792
    v_mfma_f32_16x16x32_bf16 v[140:143], v[112:115], v[68:71], v[140:143]
    ds_read_b64_tr_b16 v[56:57], v13 offset:32768
    v_mfma_f32_16x16x32_bf16 v[144:147], v[100:103], v[72:75], v[144:147]
    ds_read_b64_tr_b16 v[58:59], v13 offset:33792
    buffer_load_dwordx4 v3, s[4:7], s31 offen offset:1024 lds
    v_mfma_f32_16x16x32_bf16 v[148:151], v[104:107], v[72:75], v[148:151]
    ds_read_b64_tr_b16 v[60:61], v14 offset:32768
    v_mfma_f32_16x16x32_bf16 v[152:155], v[108:111], v[72:75], v[152:155]
    ds_read_b64_tr_b16 v[62:63], v14 offset:33792
    v_mfma_f32_16x16x32_bf16 v[156:159], v[112:115], v[72:75], v[156:159]
    ds_read_b64_tr_b16 v[64:65], v15 offset:32768
    buffer_load_dwordx4 v4, s[4:7], s31 offen offset:2048 lds
    v_mfma_f32_16x16x32_bf16 v[160:163], v[100:103], v[76:79], v[160:163]
    ds_read_b64_tr_b16 v[66:67], v15 offset:33792
    v_mfma_f32_16x16x32_bf16 v[164:167], v[104:107], v[76:79], v[164:167]
    ds_read_b128 v[24:27], v10 offset:34816
    v_mfma_f32_16x16x32_bf16 v[168:171], v[108:111], v[76:79], v[168:171]
    ds_read_b128 v[28:31], v10 offset:36864
    buffer_load_dwordx4 v5, s[4:7], s31 offen offset:3072 lds
    v_mfma_f32_16x16x32_bf16 v[172:175], v[112:115], v[76:79], v[172:175]
    ds_read_b128 v[32:35], v10 offset:38912
    v_mfma_f32_16x16x32_bf16 v[176:179], v[100:103], v[80:83], v[176:179]
    ds_read_b128 v[36:39], v10 offset:40960
    s_add_u32 m0, s34, 0
    v_mfma_f32_16x16x32_bf16 v[180:183], v[104:107], v[80:83], v[180:183]
    ds_read_b128 v[40:43], v10 offset:43008
    buffer_load_dwordx4 v6, s[8:11], s32 offen offset:0 nt lds
    v_mfma_f32_16x16x32_bf16 v[184:187], v[108:111], v[80:83], v[184:187]
    ds_read_b128 v[44:47], v10 offset:45056
    v_mfma_f32_16x16x32_bf16 v[188:191], v[112:115], v[80:83], v[188:191]
    ds_read_b128 v[48:51], v10 offset:47104
    v_mfma_f32_16x16x32_bf16 v[192:195], v[100:103], v[84:87], v[192:195]
    buffer_load_dwordx4 v7, s[8:11], s32 offen offset:1024 nt lds
    v_mfma_f32_16x16x32_bf16 v[196:199], v[104:107], v[84:87], v[196:199]
    v_mfma_f32_16x16x32_bf16 v[200:203], v[108:111], v[84:87], v[200:203]
    v_mfma_f32_16x16x32_bf16 v[204:207], v[112:115], v[84:87], v[204:207]
    buffer_load_dwordx4 v8, s[8:11], s32 offen offset:2048 nt lds
    v_mfma_f32_16x16x32_bf16 v[208:211], v[100:103], v[88:91], v[208:211]
    v_mfma_f32_16x16x32_bf16 v[212:215], v[104:107], v[88:91], v[212:215]
    v_mfma_f32_16x16x32_bf16 v[216:219], v[108:111], v[88:91], v[216:219]
    buffer_load_dwordx4 v9, s[8:11], s32 offen offset:3072 nt lds
    v_mfma_f32_16x16x32_bf16 v[220:223], v[112:115], v[88:91], v[220:223]
    v_mfma_f32_16x16x32_bf16 v[224:227], v[100:103], v[92:95], v[224:227]
    v_mfma_f32_16x16x32_bf16 v[228:231], v[104:107], v[92:95], v[228:231]
    v_mfma_f32_16x16x32_bf16 v[232:235], v[108:111], v[92:95], v[232:235]
    v_mfma_f32_16x16x32_bf16 v[236:239], v[112:115], v[92:95], v[236:239]
    v_mfma_f32_16x16x32_bf16 v[240:243], v[100:103], v[96:99], v[240:243]
    v_mfma_f32_16x16x32_bf16 v[244:247], v[104:107], v[96:99], v[244:247]
    v_mfma_f32_16x16x32_bf16 v[248:251], v[108:111], v[96:99], v[248:251]
    v_mfma_f32_16x16x32_bf16 v[252:255], v[112:115], v[96:99], v[252:255]
    s_mov_b64 exec, 255
    global_load_dword v119, v17, s[96:97]
    s_mov_b64 exec, -1
    v_add_u32 v17, s45, v17
    v_min_u32 v17, 8388480, v17
    s_nop 1
    s_add_u32 s31, s31, s40
    s_add_u32 s32, s32, s41
    s_waitcnt lgkmcnt(0)
    v_mfma_f32_16x16x32_bf16 v[128:131], v[52:55], v[20:23], v[128:131]
    ds_read_b128 v[68:71], v11 offset:32768
    v_mfma_f32_16x16x32_bf16 v[132:135], v[56:59], v[20:23], v[132:135]
    ds_read_b64_tr_b16 v[100:101], v12 offset:40960
    v_mfma_f32_16x16x32_bf16 v[136:139], v[60:63], v[20:23], v[136:139]
    ds_read_b64_tr_b16 v[102:103], v12 offset:41984
    v_mfma_f32_16x16x32_bf16 v[140:143], v[64:67], v[20:23], v[140:143]
    ds_read_b64_tr_b16 v[104:105], v13 offset:40960
    v_mfma_f32_16x16x32_bf16 v[144:147], v[52:55], v[24:27], v[144:147]
    ds_read_b64_tr_b16 v[106:107], v13 offset:41984
    v_mfma_f32_16x16x32_bf16 v[148:151], v[56:59], v[24:27], v[148:151]
    ds_read_b64_tr_b16 v[108:109], v14 offset:40960
    v_mfma_f32_16x16x32_bf16 v[152:155], v[60:63], v[24:27], v[152:155]
    ds_read_b64_tr_b16 v[110:111], v14 offset:41984
    v_mfma_f32_16x16x32_bf16 v[156:159], v[64:67], v[24:27], v[156:159]
    ds_read_b64_tr_b16 v[112:113], v15 offset:40960
    v_mfma_f32_16x16x32_bf16 v[160:163], v[52:55], v[28:31], v[160:163]
    ds_read_b64_tr_b16 v[114:115], v15 offset:41984
    v_mfma_f32_16x16x32_bf16 v[164:167], v[56:59], v[28:31], v[164:167]
    ds_read_b128 v[72:75], v11 offset:34816
    v_mfma_f32_16x16x32_bf16 v[168:171], v[60:63], v[28:31], v[168:171]
    ds_read_b128 v[76:79], v11 offset:36864
    v_mfma_f32_16x16x32_bf16 v[172:175], v[64:67], v[28:31], v[172:175]
    ds_read_b128 v[80:83], v11 offset:38912
    v_mfma_f32_16x16x32_bf16 v[176:179], v[52:55], v[32:35], v[176:179]
    ds_read_b128 v[84:87], v11 offset:40960
    v_mfma_f32_16x16x32_bf16 v[180:183], v[56:59], v[32:35], v[180:183]
    ds_read_b128 v[88:91], v11 offset:43008
    v_mfma_f32_16x16x32_bf16 v[184:187], v[60:63], v[32:35], v[184:187]
    ds_read_b128 v[92:95], v11 offset:45056
    v_mfma_f32_16x16x32_bf16 v[188:191], v[64:67], v[32:35], v[188:191]
    ds_read_b128 v[96:99], v11 offset:47104
    v_mfma_f32_16x16x32_bf16 v[192:195], v[52:55], v[36:39], v[192:195]
    v_mfma_f32_16x16x32_bf16 v[196:199], v[56:59], v[36:39], v[196:199]
    v_mfma_f32_16x16x32_bf16 v[200:203], v[60:63], v[36:39], v[200:203]
    v_mfma_f32_16x16x32_bf16 v[204:207], v[64:67], v[36:39], v[204:207]
    v_mfma_f32_16x16x32_bf16 v[208:211], v[52:55], v[40:43], v[208:211]
    s_bitcmp1_b32 s43, s35
    s_cbranch_scc1 L_recurrent_scan__compressed_kv_cla__moe_arch_mod__prompt_kernel_rare_15
L_recurrent_scan__compressed_kv_cla__moe_arch_mod__prompt_kernel_back_16:
    v_mfma_f32_16x16x32_bf16 v[212:215], v[56:59], v[40:43], v[212:215]
    v_mfma_f32_16x16x32_bf16 v[216:219], v[60:63], v[40:43], v[216:219]
    v_mfma_f32_16x16x32_bf16 v[220:223], v[64:67], v[40:43], v[220:223]
    v_mfma_f32_16x16x32_bf16 v[224:227], v[52:55], v[44:47], v[224:227]
    v_mfma_f32_16x16x32_bf16 v[228:231], v[56:59], v[44:47], v[228:231]
    v_mfma_f32_16x16x32_bf16 v[232:235], v[60:63], v[44:47], v[232:235]
    v_mfma_f32_16x16x32_bf16 v[236:239], v[64:67], v[44:47], v[236:239]
    v_mfma_f32_16x16x32_bf16 v[240:243], v[52:55], v[48:51], v[240:243]
    v_mfma_f32_16x16x32_bf16 v[244:247], v[56:59], v[48:51], v[244:247]
    v_mfma_f32_16x16x32_bf16 v[248:251], v[60:63], v[48:51], v[248:251]
    v_mfma_f32_16x16x32_bf16 v[252:255], v[64:67], v[48:51], v[252:255]
    s_bitcmp1_b32 s43, s35
    s_cbranch_scc1 L_recurrent_scan__compressed_kv_cla__moe_arch_mod__prompt_kernel_w0_17
    s_waitcnt vmcnt(1)
L_recurrent_scan__compressed_kv_cla__moe_arch_mod__prompt_kernel_w0b_18:
    s_waitcnt lgkmcnt(0)
    s_cmp_eq_u32 s35, 3
    s_barrier
    s_cbranch_scc1 L_p1_fin0
    v_mfma_f32_16x16x32_bf16 v[128:131], v[100:103], v[68:71], v[128:131]
    ds_read_b128 v[20:23], v10 offset:0
    s_add_u32 m0, s33, 32768
    v_mfma_f32_16x16x32_bf16 v[132:135], v[104:107], v[68:71], v[132:135]
    ds_read_b64_tr_b16 v[52:53], v12 offset:0
    buffer_load_dwordx4 v2, s[4:7], s31 offen offset:0 lds
    v_mfma_f32_16x16x32_bf16 v[136:139], v[108:111], v[68:71], v[136:139]
    ds_read_b64_tr_b16 v[54:55], v12 offset:1024
    v_mfma_f32_16x16x32_bf16 v[140:143], v[112:115], v[68:71], v[140:143]
    ds_read_b64_tr_b16 v[56:57], v13 offset:0
    v_mfma_f32_16x16x32_bf16 v[144:147], v[100:103], v[72:75], v[144:147]
    ds_read_b64_tr_b16 v[58:59], v13 offset:1024
    buffer_load_dwordx4 v3, s[4:7], s31 offen offset:1024 lds
    v_mfma_f32_16x16x32_bf16 v[148:151], v[104:107], v[72:75], v[148:151]
    ds_read_b64_tr_b16 v[60:61], v14 offset:0
    v_mfma_f32_16x16x32_bf16 v[152:155], v[108:111], v[72:75], v[152:155]
    ds_read_b64_tr_b16 v[62:63], v14 offset:1024
    v_mfma_f32_16x16x32_bf16 v[156:159], v[112:115], v[72:75], v[156:159]
    ds_read_b64_tr_b16 v[64:65], v15 offset:0
    buffer_load_dwordx4 v4, s[4:7], s31 offen offset:2048 lds
    v_mfma_f32_16x16x32_bf16 v[160:163], v[100:103], v[76:79], v[160:163]
    ds_read_b64_tr_b16 v[66:67], v15 offset:1024
    v_mfma_f32_16x16x32_bf16 v[164:167], v[104:107], v[76:79], v[164:167]
    ds_read_b128 v[24:27], v10 offset:2048
    v_mfma_f32_16x16x32_bf16 v[168:171], v[108:111], v[76:79], v[168:171]
    ds_read_b128 v[28:31], v10 offset:4096
    buffer_load_dwordx4 v5, s[4:7], s31 offen offset:3072 lds
    v_mfma_f32_16x16x32_bf16 v[172:175], v[112:115], v[76:79], v[172:175]
    ds_read_b128 v[32:35], v10 offset:6144
    v_mfma_f32_16x16x32_bf16 v[176:179], v[100:103], v[80:83], v[176:179]
    ds_read_b128 v[36:39], v10 offset:8192
    s_add_u32 m0, s34, 32768
    v_mfma_f32_16x16x32_bf16 v[180:183], v[104:107], v[80:83], v[180:183]
    ds_read_b128 v[40:43], v10 offset:10240
    buffer_load_dwordx4 v6, s[8:11], s32 offen offset:0 nt lds
    v_mfma_f32_16x16x32_bf16 v[184:187], v[108:111], v[80:83], v[184:187]
    ds_read_b128 v[44:47], v10 offset:12288
    v_mfma_f32_16x16x32_bf16 v[188:191], v[112:115], v[80:83], v[188:191]
    ds_read_b128 v[48:51], v10 offset:14336
    v_mfma_f32_16x16x32_bf16 v[192:195], v[100:103], v[84:87], v[192:195]
    buffer_load_dwordx4 v7, s[8:11], s32 offen offset:1024 nt lds
    v_mfma_f32_16x16x32_bf16 v[196:199], v[104:107], v[84:87], v[196:199]
    v_mfma_f32_16x16x32_bf16 v[200:203], v[108:111], v[84:87], v[200:203]
    v_mfma_f32_16x16x32_bf16 v[204:207], v[112:115], v[84:87], v[204:207]
    buffer_load_dwordx4 v8, s[8:11], s32 offen offset:2048 nt lds
    v_mfma_f32_16x16x32_bf16 v[208:211], v[100:103], v[88:91], v[208:211]
    v_mfma_f32_16x16x32_bf16 v[212:215], v[104:107], v[88:91], v[212:215]
    v_mfma_f32_16x16x32_bf16 v[216:219], v[108:111], v[88:91], v[216:219]
    buffer_load_dwordx4 v9, s[8:11], s32 offen offset:3072 nt lds
    v_mfma_f32_16x16x32_bf16 v[220:223], v[112:115], v[88:91], v[220:223]
    v_mfma_f32_16x16x32_bf16 v[224:227], v[100:103], v[92:95], v[224:227]
    v_mfma_f32_16x16x32_bf16 v[228:231], v[104:107], v[92:95], v[228:231]
    v_mfma_f32_16x16x32_bf16 v[232:235], v[108:111], v[92:95], v[232:235]
    v_mfma_f32_16x16x32_bf16 v[236:239], v[112:115], v[92:95], v[236:239]
    v_mfma_f32_16x16x32_bf16 v[240:243], v[100:103], v[96:99], v[240:243]
    v_mfma_f32_16x16x32_bf16 v[244:247], v[104:107], v[96:99], v[244:247]
    v_mfma_f32_16x16x32_bf16 v[248:251], v[108:111], v[96:99], v[248:251]
    s_add_u32 s36, s35, s28
    s_cmp_eq_u32 s36, 0
    s_cbranch_scc1 L_recurrent_scan__compressed_kv_cla__moe_arch_mod__prompt_kernel_rare_27
L_recurrent_scan__compressed_kv_cla__moe_arch_mod__prompt_kernel_back_28:
    v_mfma_f32_16x16x32_bf16 v[252:255], v[112:115], v[96:99], v[252:255]
    s_mov_b64 exec, 255
    global_load_dword v0, v17, s[96:97]
    s_mov_b64 exec, -1
    s_cmp_lt_u32 s35, 1
    s_cselect_b32 s45, s45, 0
    v_add_u32 v17, s45, v17
    v_min_u32 v17, 8388480, v17
    s_nop 1
    s_add_u32 s31, s31, s40
    s_add_u32 s32, s32, s41
    s_add_u32 s35, s35, 1
    s_branch L_kv_kloop
L_p1_fin0:
    v_mfma_f32_16x16x32_bf16 v[128:131], v[100:103], v[68:71], v[128:131]
    s_and_b32 s36, s28, 3
    s_sub_u32 s37, 15, s30
    s_cmp_lt_u32 s28, 4
    s_cselect_b32 s37, s37, s30
    s_lshl_b32 s37, s37, 2
    s_add_u32 s37, s37, s36
    s_lshl_b32 s37, s37, 16
    v_lshl_add_u32 v6, v1, 4, s37
    v_add_u32 v7, 32768, v6
    s_mov_b32 s32, 0
    s_mov_b32 s8, s54
    s_and_b32 s9, s55, 0xffff
    s_mov_b32 s10, 4194304
    s_mov_b32 s11, 0x20000
    v_mfma_f32_16x16x32_bf16 v[132:135], v[104:107], v[68:71], v[132:135]
    buffer_load_dwordx4 v[24:27], v6, s[8:11], s32 offen offset:0 sc1
    v_mfma_f32_16x16x32_bf16 v[136:139], v[108:111], v[68:71], v[136:139]
    v_lshrrev_b32 v18, 4, v1
    v_mfma_f32_16x16x32_bf16 v[140:143], v[112:115], v[68:71], v[140:143]
    v_bfe_u32 v20, v1, 2, 2
    v_mfma_f32_16x16x32_bf16 v[144:147], v[100:103], v[72:75], v[144:147]
    v_lshl_add_u32 v19, v18, 3, v20
    v_mfma_f32_16x16x32_bf16 v[148:151], v[104:107], v[72:75], v[148:151]
    buffer_load_dwordx4 v[28:31], v7, s[8:11], s32 offen offset:0 sc1
    v_lshlrev_b32 v19, 8, v19
    v_mfma_f32_16x16x32_bf16 v[152:155], v[108:111], v[72:75], v[152:155]
    v_and_b32 v21, 3, v1
    v_mfma_f32_16x16x32_bf16 v[156:159], v[112:115], v[72:75], v[156:159]
    v_lshl_add_u32 v19, v21, 3, v19
    v_mfma_f32_16x16x32_bf16 v[160:163], v[100:103], v[76:79], v[160:163]
    v_and_b32 v21, 1, v18
    v_mfma_f32_16x16x32_bf16 v[164:167], v[104:107], v[76:79], v[164:167]
    buffer_load_dwordx4 v[32:35], v6, s[8:11], s32 offen offset:1024 sc1
    v_lshl_add_u32 v20, v21, 2, v20
    v_mfma_f32_16x16x32_bf16 v[168:171], v[108:111], v[76:79], v[168:171]
    v_xor_b32 v21, 0, v20
    v_mfma_f32_16x16x32_bf16 v[172:175], v[112:115], v[76:79], v[172:175]
    v_lshl_add_u32 v10, v21, 5, v19
    v_mfma_f32_16x16x32_bf16 v[176:179], v[100:103], v[80:83], v[176:179]
    v_xor_b32 v21, 1, v20
    v_mfma_f32_16x16x32_bf16 v[180:183], v[104:107], v[80:83], v[180:183]
    buffer_load_dwordx4 v[36:39], v7, s[8:11], s32 offen offset:1024 sc1
    v_lshl_add_u32 v11, v21, 5, v19
    v_mfma_f32_16x16x32_bf16 v[184:187], v[108:111], v[80:83], v[184:187]
    v_xor_b32 v21, 2, v20
    v_mfma_f32_16x16x32_bf16 v[188:191], v[112:115], v[80:83], v[188:191]
    v_lshl_add_u32 v12, v21, 5, v19
    v_mfma_f32_16x16x32_bf16 v[192:195], v[100:103], v[84:87], v[192:195]
    v_xor_b32 v21, 3, v20
    v_mfma_f32_16x16x32_bf16 v[196:199], v[104:107], v[84:87], v[196:199]
    buffer_load_dwordx4 v[40:43], v6, s[8:11], s32 offen offset:2048 sc1
    v_lshl_add_u32 v13, v21, 5, v19
    v_mfma_f32_16x16x32_bf16 v[200:203], v[108:111], v[84:87], v[200:203]
    v_xor_b32 v21, 4, v20
    v_mfma_f32_16x16x32_bf16 v[204:207], v[112:115], v[84:87], v[204:207]
    v_lshl_add_u32 v14, v21, 5, v19
    v_mfma_f32_16x16x32_bf16 v[208:211], v[100:103], v[88:91], v[208:211]
    v_xor_b32 v21, 5, v20
    v_mfma_f32_16x16x32_bf16 v[212:215], v[104:107], v[88:91], v[212:215]
    buffer_load_dwordx4 v[44:47], v7, s[8:11], s32 offen offset:2048 sc1
    v_lshl_add_u32 v15, v21, 5, v19
    v_mfma_f32_16x16x32_bf16 v[216:219], v[108:111], v[88:91], v[216:219]
    v_xor_b32 v21, 6, v20
    v_mfma_f32_16x16x32_bf16 v[220:223], v[112:115], v[88:91], v[220:223]
    v_lshl_add_u32 v16, v21, 5, v19
    v_mfma_f32_16x16x32_bf16 v[224:227], v[100:103], v[92:95], v[224:227]
    v_xor_b32 v21, 7, v20
    v_mfma_f32_16x16x32_bf16 v[228:231], v[104:107], v[92:95], v[228:231]
    buffer_load_dwordx4 v[48:51], v6, s[8:11], s32 offen offset:3072 sc1
    v_lshl_add_u32 v17, v21, 5, v19
    v_mfma_f32_16x16x32_bf16 v[232:235], v[108:111], v[92:95], v[232:235]
    s_lshl_b32 s45, s29, 20
    v_mfma_f32_16x16x32_bf16 v[236:239], v[112:115], v[92:95], v[236:239]
    v_mfma_f32_16x16x32_bf16 v[240:243], v[100:103], v[96:99], v[240:243]
    v_mfma_f32_16x16x32_bf16 v[244:247], v[104:107], v[96:99], v[244:247]
    buffer_load_dwordx4 v[52:55], v7, s[8:11], s32 offen offset:3072 sc1
    v_mfma_f32_16x16x32_bf16 v[248:251], v[108:111], v[96:99], v[248:251]
    v_mfma_f32_16x16x32_bf16 v[252:255], v[112:115], v[96:99], v[252:255]
    s_branch L_p1_done
    .p2align 6
L_kv_vloop:
    s_waitcnt lgkmcnt(0)
    v_mfma_f32_16x16x32_bf16 v[128:131], v[20:23], v[52:55], v[128:131]
    ds_read_b128 v[68:71], v11 offset:0
    v_mfma_f32_16x16x32_bf16 v[160:163], v[20:23], v[56:59], v[160:163]
    ds_read_b64_tr_b16 v[100:101], v12 offset:8192
    v_mfma_f32_16x16x32_bf16 v[192:195], v[20:23], v[60:63], v[192:195]
    ds_read_b64_tr_b16 v[102:103], v12 offset:9216
    v_mfma_f32_16x16x32_bf16 v[224:227], v[20:23], v[64:67], v[224:227]
    ds_read_b64_tr_b16 v[104:105], v13 offset:8192
    v_mfma_f32_16x16x32_bf16 v[132:135], v[24:27], v[52:55], v[132:135]
    ds_read_b64_tr_b16 v[106:107], v13 offset:9216
    v_mfma_f32_16x16x32_bf16 v[164:167], v[24:27], v[56:59], v[164:167]
    ds_read_b64_tr_b16 v[108:109], v14 offset:8192
    v_mfma_f32_16x16x32_bf16 v[196:199], v[24:27], v[60:63], v[196:199]
    ds_read_b64_tr_b16 v[110:111], v14 offset:9216
    v_mfma_f32_16x16x32_bf16 v[228:231], v[24:27], v[64:67], v[228:231]
    ds_read_b64_tr_b16 v[112:113], v15 offset:8192
    v_mfma_f32_16x16x32_bf16 v[136:139], v[28:31], v[52:55], v[136:139]
    ds_read_b64_tr_b16 v[114:115], v15 offset:9216
    v_mfma_f32_16x16x32_bf16 v[168:171], v[28:31], v[56:59], v[168:171]
    ds_read_b128 v[72:75], v11 offset:2048
    v_mfma_f32_16x16x32_bf16 v[200:203], v[28:31], v[60:63], v[200:203]
    ds_read_b128 v[76:79], v11 offset:4096
    v_mfma_f32_16x16x32_bf16 v[232:235], v[28:31], v[64:67], v[232:235]
    ds_read_b128 v[80:83], v11 offset:6144
    v_mfma_f32_16x16x32_bf16 v[140:143], v[32:35], v[52:55], v[140:143]
    ds_read_b128 v[84:87], v11 offset:8192
    v_mfma_f32_16x16x32_bf16 v[172:175], v[32:35], v[56:59], v[172:175]
    ds_read_b128 v[88:91], v11 offset:10240
    v_mfma_f32_16x16x32_bf16 v[204:207], v[32:35], v[60:63], v[204:207]
    ds_read_b128 v[92:95], v11 offset:12288
    v_mfma_f32_16x16x32_bf16 v[236:239], v[32:35], v[64:67], v[236:239]
    ds_read_b128 v[96:99], v11 offset:14336
    v_mfma_f32_16x16x32_bf16 v[144:147], v[36:39], v[52:55], v[144:147]
    v_mfma_f32_16x16x32_bf16 v[176:179], v[36:39], v[56:59], v[176:179]
    v_mfma_f32_16x16x32_bf16 v[208:211], v[36:39], v[60:63], v[208:211]
    v_mfma_f32_16x16x32_bf16 v[240:243], v[36:39], v[64:67], v[240:243]
    v_mfma_f32_16x16x32_bf16 v[148:151], v[40:43], v[52:55], v[148:151]
    v_mfma_f32_16x16x32_bf16 v[180:183], v[40:43], v[56:59], v[180:183]
    v_mfma_f32_16x16x32_bf16 v[212:215], v[40:43], v[60:63], v[212:215]
    v_mfma_f32_16x16x32_bf16 v[244:247], v[40:43], v[64:67], v[244:247]
    v_mfma_f32_16x16x32_bf16 v[152:155], v[44:47], v[52:55], v[152:155]
    v_mfma_f32_16x16x32_bf16 v[184:187], v[44:47], v[56:59], v[184:187]
    v_mfma_f32_16x16x32_bf16 v[216:219], v[44:47], v[60:63], v[216:219]
    v_mfma_f32_16x16x32_bf16 v[248:251], v[44:47], v[64:67], v[248:251]
    v_mfma_f32_16x16x32_bf16 v[156:159], v[48:51], v[52:55], v[156:159]
    v_mfma_f32_16x16x32_bf16 v[188:191], v[48:51], v[56:59], v[188:191]
    v_mfma_f32_16x16x32_bf16 v[220:223], v[48:51], v[60:63], v[220:223]
    v_mfma_f32_16x16x32_bf16 v[252:255], v[48:51], v[64:67], v[252:255]
    s_cmp_lt_u32 s35, s44
    s_cbranch_scc1 L_recurrent_scan__compressed_kv_cla__moe_arch_mod__prompt_kernel_w0_29
    s_waitcnt vmcnt(1)
L_recurrent_scan__compressed_kv_cla__moe_arch_mod__prompt_kernel_w0b_30:
    s_waitcnt lgkmcnt(0)
    s_barrier
    s_add_u32 m0, s33, 0
    s_nop 0
    buffer_load_dwordx4 v2, s[4:7], s31 offen offset:0 lds
    buffer_load_dwordx4 v3, s[4:7], s31 offen offset:1024 lds
    buffer_load_dwordx4 v4, s[4:7], s31 offen offset:2048 lds
    buffer_load_dwordx4 v5, s[4:7], s31 offen offset:3072 lds
    s_add_u32 m0, s34, 0
    s_nop 0
    buffer_load_dwordx4 v6, s[8:11], s32 offen offset:0 nt lds
    buffer_load_dwordx4 v7, s[8:11], s32 offen offset:1024 nt lds
    buffer_load_dwordx4 v8, s[8:11], s32 offen offset:2048 nt lds
    buffer_load_dwordx4 v9, s[8:11], s32 offen offset:3072 nt lds
    s_add_u32 s31, s31, s40
    s_add_u32 s32, s32, s41
    v_mfma_f32_16x16x32_bf16 v[128:131], v[68:71], v[100:103], v[128:131]
    ds_read_b128 v[20:23], v10 offset:32768
    v_mfma_f32_16x16x32_bf16 v[160:163], v[68:71], v[104:107], v[160:163]
    ds_read_b64_tr_b16 v[52:53], v12 offset:32768
    v_mfma_f32_16x16x32_bf16 v[192:195], v[68:71], v[108:111], v[192:195]
    ds_read_b64_tr_b16 v[54:55], v12 offset:33792
    v_mfma_f32_16x16x32_bf16 v[224:227], v[68:71], v[112:115], v[224:227]
    ds_read_b64_tr_b16 v[56:57], v13 offset:32768
    v_mfma_f32_16x16x32_bf16 v[132:135], v[72:75], v[100:103], v[132:135]
    ds_read_b64_tr_b16 v[58:59], v13 offset:33792
    v_mfma_f32_16x16x32_bf16 v[164:167], v[72:75], v[104:107], v[164:167]
    ds_read_b64_tr_b16 v[60:61], v14 offset:32768
    v_mfma_f32_16x16x32_bf16 v[196:199], v[72:75], v[108:111], v[196:199]
    ds_read_b64_tr_b16 v[62:63], v14 offset:33792
    v_mfma_f32_16x16x32_bf16 v[228:231], v[72:75], v[112:115], v[228:231]
    ds_read_b64_tr_b16 v[64:65], v15 offset:32768
    v_mfma_f32_16x16x32_bf16 v[136:139], v[76:79], v[100:103], v[136:139]
    ds_read_b64_tr_b16 v[66:67], v15 offset:33792
    v_mfma_f32_16x16x32_bf16 v[168:171], v[76:79], v[104:107], v[168:171]
    ds_read_b128 v[24:27], v10 offset:34816
    v_mfma_f32_16x16x32_bf16 v[200:203], v[76:79], v[108:111], v[200:203]
    ds_read_b128 v[28:31], v10 offset:36864
    v_mfma_f32_16x16x32_bf16 v[232:235], v[76:79], v[112:115], v[232:235]
    ds_read_b128 v[32:35], v10 offset:38912
    v_mfma_f32_16x16x32_bf16 v[140:143], v[80:83], v[100:103], v[140:143]
    ds_read_b128 v[36:39], v10 offset:40960
    v_mfma_f32_16x16x32_bf16 v[172:175], v[80:83], v[104:107], v[172:175]
    ds_read_b128 v[40:43], v10 offset:43008
    v_mfma_f32_16x16x32_bf16 v[204:207], v[80:83], v[108:111], v[204:207]
    ds_read_b128 v[44:47], v10 offset:45056
    v_mfma_f32_16x16x32_bf16 v[236:239], v[80:83], v[112:115], v[236:239]
    ds_read_b128 v[48:51], v10 offset:47104
    v_mfma_f32_16x16x32_bf16 v[144:147], v[84:87], v[100:103], v[144:147]
    v_mfma_f32_16x16x32_bf16 v[176:179], v[84:87], v[104:107], v[176:179]
    v_mfma_f32_16x16x32_bf16 v[208:211], v[84:87], v[108:111], v[208:211]
    v_mfma_f32_16x16x32_bf16 v[240:243], v[84:87], v[112:115], v[240:243]
    v_mfma_f32_16x16x32_bf16 v[148:151], v[88:91], v[100:103], v[148:151]
    v_mfma_f32_16x16x32_bf16 v[180:183], v[88:91], v[104:107], v[180:183]
    v_mfma_f32_16x16x32_bf16 v[212:215], v[88:91], v[108:111], v[212:215]
    v_mfma_f32_16x16x32_bf16 v[244:247], v[88:91], v[112:115], v[244:247]
    v_mfma_f32_16x16x32_bf16 v[152:155], v[92:95], v[100:103], v[152:155]
    v_mfma_f32_16x16x32_bf16 v[184:187], v[92:95], v[104:107], v[184:187]
    v_mfma_f32_16x16x32_bf16 v[216:219], v[92:95], v[108:111], v[216:219]
    v_mfma_f32_16x16x32_bf16 v[248:251], v[92:95], v[112:115], v[248:251]
    v_mfma_f32_16x16x32_bf16 v[156:159], v[96:99], v[100:103], v[156:159]
    v_mfma_f32_16x16x32_bf16 v[188:191], v[96:99], v[104:107], v[188:191]
    v_mfma_f32_16x16x32_bf16 v[220:223], v[96:99], v[108:111], v[220:223]
    v_mfma_f32_16x16x32_bf16 v[252:255], v[96:99], v[112:115], v[252:255]
    s_mov_b64 exec, 255
    global_load_dword v119, v17, s[96:97]
    s_mov_b64 exec, -1
    v_add_u32 v17, s45, v17
    v_min_u32 v17, 8388480, v17
    s_nop 1
    s_waitcnt lgkmcnt(0)
    v_mfma_f32_16x16x32_bf16 v[128:131], v[20:23], v[52:55], v[128:131]
    ds_read_b128 v[68:71], v11 offset:32768
    v_mfma_f32_16x16x32_bf16 v[160:163], v[20:23], v[56:59], v[160:163]
    ds_read_b64_tr_b16 v[100:101], v12 offset:40960
    v_mfma_f32_16x16x32_bf16 v[192:195], v[20:23], v[60:63], v[192:195]
    ds_read_b64_tr_b16 v[102:103], v12 offset:41984
    v_mfma_f32_16x16x32_bf16 v[224:227], v[20:23], v[64:67], v[224:227]
    ds_read_b64_tr_b16 v[104:105], v13 offset:40960
    v_mfma_f32_16x16x32_bf16 v[132:135], v[24:27], v[52:55], v[132:135]
    ds_read_b64_tr_b16 v[106:107], v13 offset:41984
    v_mfma_f32_16x16x32_bf16 v[164:167], v[24:27], v[56:59], v[164:167]
    ds_read_b64_tr_b16 v[108:109], v14 offset:40960
    v_mfma_f32_16x16x32_bf16 v[196:199], v[24:27], v[60:63], v[196:199]
    ds_read_b64_tr_b16 v[110:111], v14 offset:41984
    v_mfma_f32_16x16x32_bf16 v[228:231], v[24:27], v[64:67], v[228:231]
    ds_read_b64_tr_b16 v[112:113], v15 offset:40960
    v_mfma_f32_16x16x32_bf16 v[136:139], v[28:31], v[52:55], v[136:139]
    ds_read_b64_tr_b16 v[114:115], v15 offset:41984
    v_mfma_f32_16x16x32_bf16 v[168:171], v[28:31], v[56:59], v[168:171]
    ds_read_b128 v[72:75], v11 offset:34816
    v_mfma_f32_16x16x32_bf16 v[200:203], v[28:31], v[60:63], v[200:203]
    ds_read_b128 v[76:79], v11 offset:36864
    v_mfma_f32_16x16x32_bf16 v[232:235], v[28:31], v[64:67], v[232:235]
    ds_read_b128 v[80:83], v11 offset:38912
    v_mfma_f32_16x16x32_bf16 v[140:143], v[32:35], v[52:55], v[140:143]
    ds_read_b128 v[84:87], v11 offset:40960
    v_mfma_f32_16x16x32_bf16 v[172:175], v[32:35], v[56:59], v[172:175]
    ds_read_b128 v[88:91], v11 offset:43008
    v_mfma_f32_16x16x32_bf16 v[204:207], v[32:35], v[60:63], v[204:207]
    ds_read_b128 v[92:95], v11 offset:45056
    v_mfma_f32_16x16x32_bf16 v[236:239], v[32:35], v[64:67], v[236:239]
    ds_read_b128 v[96:99], v11 offset:47104
    v_mfma_f32_16x16x32_bf16 v[144:147], v[36:39], v[52:55], v[144:147]
    v_mfma_f32_16x16x32_bf16 v[176:179], v[36:39], v[56:59], v[176:179]
    v_mfma_f32_16x16x32_bf16 v[208:211], v[36:39], v[60:63], v[208:211]
    v_mfma_f32_16x16x32_bf16 v[240:243], v[36:39], v[64:67], v[240:243]
    v_mfma_f32_16x16x32_bf16 v[148:151], v[40:43], v[52:55], v[148:151]
    v_mfma_f32_16x16x32_bf16 v[180:183], v[40:43], v[56:59], v[180:183]
    v_mfma_f32_16x16x32_bf16 v[212:215], v[40:43], v[60:63], v[212:215]
    v_mfma_f32_16x16x32_bf16 v[244:247], v[40:43], v[64:67], v[244:247]
    v_mfma_f32_16x16x32_bf16 v[152:155], v[44:47], v[52:55], v[152:155]
    v_mfma_f32_16x16x32_bf16 v[184:187], v[44:47], v[56:59], v[184:187]
    v_mfma_f32_16x16x32_bf16 v[216:219], v[44:47], v[60:63], v[216:219]
    v_mfma_f32_16x16x32_bf16 v[248:251], v[44:47], v[64:67], v[248:251]
    v_mfma_f32_16x16x32_bf16 v[156:159], v[48:51], v[52:55], v[156:159]
    v_mfma_f32_16x16x32_bf16 v[188:191], v[48:51], v[56:59], v[188:191]
    v_mfma_f32_16x16x32_bf16 v[220:223], v[48:51], v[60:63], v[220:223]
    v_mfma_f32_16x16x32_bf16 v[252:255], v[48:51], v[64:67], v[252:255]
    s_waitcnt vmcnt(1) lgkmcnt(0)
    s_cmp_eq_u32 s35, 3
    s_barrier
    s_cbranch_scc1 L_p1_fin1
    s_add_u32 m0, s33, 32768
    s_nop 0
    buffer_load_dwordx4 v2, s[4:7], s31 offen offset:0 lds
    buffer_load_dwordx4 v3, s[4:7], s31 offen offset:1024 lds
    buffer_load_dwordx4 v4, s[4:7], s31 offen offset:2048 lds
    buffer_load_dwordx4 v5, s[4:7], s31 offen offset:3072 lds
    s_add_u32 m0, s34, 32768
    s_nop 0
    buffer_load_dwordx4 v6, s[8:11], s32 offen offset:0 nt lds
    buffer_load_dwordx4 v7, s[8:11], s32 offen offset:1024 nt lds
    buffer_load_dwordx4 v8, s[8:11], s32 offen offset:2048 nt lds
    buffer_load_dwordx4 v9, s[8:11], s32 offen offset:3072 nt lds
    s_add_u32 s31, s31, s40
    s_add_u32 s32, s32, s41
    s_cmp_eq_u32 s35, 2
    s_cbranch_scc1 L_recurrent_scan__compressed_kv_cla__moe_arch_mod__prompt_kernel_rare_35
L_recurrent_scan__compressed_kv_cla__moe_arch_mod__prompt_kernel_back_36:
    v_mfma_f32_16x16x32_bf16 v[128:131], v[68:71], v[100:103], v[128:131]
    ds_read_b128 v[20:23], v10 offset:0
    v_mfma_f32_16x16x32_bf16 v[160:163], v[68:71], v[104:107], v[160:163]
    ds_read_b64_tr_b16 v[52:53], v12 offset:0
    v_mfma_f32_16x16x32_bf16 v[192:195], v[68:71], v[108:111], v[192:195]
    ds_read_b64_tr_b16 v[54:55], v12 offset:1024
    v_mfma_f32_16x16x32_bf16 v[224:227], v[68:71], v[112:115], v[224:227]
    ds_read_b64_tr_b16 v[56:57], v13 offset:0
    v_mfma_f32_16x16x32_bf16 v[132:135], v[72:75], v[100:103], v[132:135]
    ds_read_b64_tr_b16 v[58:59], v13 offset:1024
    v_mfma_f32_16x16x32_bf16 v[164:167], v[72:75], v[104:107], v[164:167]
    ds_read_b64_tr_b16 v[60:61], v14 offset:0
    v_mfma_f32_16x16x32_bf16 v[196:199], v[72:75], v[108:111], v[196:199]
    ds_read_b64_tr_b16 v[62:63], v14 offset:1024
    v_mfma_f32_16x16x32_bf16 v[228:231], v[72:75], v[112:115], v[228:231]
    ds_read_b64_tr_b16 v[64:65], v15 offset:0
    v_mfma_f32_16x16x32_bf16 v[136:139], v[76:79], v[100:103], v[136:139]
    ds_read_b64_tr_b16 v[66:67], v15 offset:1024
    v_mfma_f32_16x16x32_bf16 v[168:171], v[76:79], v[104:107], v[168:171]
    ds_read_b128 v[24:27], v10 offset:2048
    v_mfma_f32_16x16x32_bf16 v[200:203], v[76:79], v[108:111], v[200:203]
    ds_read_b128 v[28:31], v10 offset:4096
    v_mfma_f32_16x16x32_bf16 v[232:235], v[76:79], v[112:115], v[232:235]
    ds_read_b128 v[32:35], v10 offset:6144
    v_mfma_f32_16x16x32_bf16 v[140:143], v[80:83], v[100:103], v[140:143]
    ds_read_b128 v[36:39], v10 offset:8192
    v_mfma_f32_16x16x32_bf16 v[172:175], v[80:83], v[104:107], v[172:175]
    ds_read_b128 v[40:43], v10 offset:10240
    v_mfma_f32_16x16x32_bf16 v[204:207], v[80:83], v[108:111], v[204:207]
    ds_read_b128 v[44:47], v10 offset:12288
    v_mfma_f32_16x16x32_bf16 v[236:239], v[80:83], v[112:115], v[236:239]
    ds_read_b128 v[48:51], v10 offset:14336
    v_mfma_f32_16x16x32_bf16 v[144:147], v[84:87], v[100:103], v[144:147]
    v_mfma_f32_16x16x32_bf16 v[176:179], v[84:87], v[104:107], v[176:179]
    v_mfma_f32_16x16x32_bf16 v[208:211], v[84:87], v[108:111], v[208:211]
    v_mfma_f32_16x16x32_bf16 v[240:243], v[84:87], v[112:115], v[240:243]
    v_mfma_f32_16x16x32_bf16 v[148:151], v[88:91], v[100:103], v[148:151]
    v_mfma_f32_16x16x32_bf16 v[180:183], v[88:91], v[104:107], v[180:183]
    v_mfma_f32_16x16x32_bf16 v[212:215], v[88:91], v[108:111], v[212:215]
    v_mfma_f32_16x16x32_bf16 v[244:247], v[88:91], v[112:115], v[244:247]
    v_mfma_f32_16x16x32_bf16 v[152:155], v[92:95], v[100:103], v[152:155]
    v_mfma_f32_16x16x32_bf16 v[184:187], v[92:95], v[104:107], v[184:187]
    v_mfma_f32_16x16x32_bf16 v[216:219], v[92:95], v[108:111], v[216:219]
    v_mfma_f32_16x16x32_bf16 v[248:251], v[92:95], v[112:115], v[248:251]
    v_mfma_f32_16x16x32_bf16 v[156:159], v[96:99], v[100:103], v[156:159]
    v_mfma_f32_16x16x32_bf16 v[188:191], v[96:99], v[104:107], v[188:191]
    v_mfma_f32_16x16x32_bf16 v[220:223], v[96:99], v[108:111], v[220:223]
    v_mfma_f32_16x16x32_bf16 v[252:255], v[96:99], v[112:115], v[252:255]
    s_mov_b64 exec, 255
    global_load_dword v0, v17, s[96:97]
    s_mov_b64 exec, -1
    s_cmp_lt_u32 s35, 1
    s_cselect_b32 s45, s45, 0
    v_add_u32 v17, s45, v17
    v_min_u32 v17, 8388480, v17
    s_nop 1
    s_add_u32 s35, s35, 1
    s_branch L_kv_vloop
L_p1_fin1:
    s_and_b32 s36, s28, 3
    s_sub_u32 s37, 15, s30
    s_cmp_lt_u32 s28, 4
    s_cselect_b32 s37, s37, s30
    s_lshl_b32 s37, s37, 2
    s_add_u32 s37, s37, s36
    s_lshl_b32 s37, s37, 16
    v_lshl_add_u32 v6, v1, 4, s37
    v_add_u32 v7, 32768, v6
    s_mov_b32 s32, 0
    s_mov_b32 s8, s54
    s_and_b32 s9, s55, 0xffff
    s_mov_b32 s10, 4194304
    s_mov_b32 s11, 0x20000
    v_mfma_f32_16x16x32_bf16 v[128:131], v[68:71], v[100:103], v[128:131]
    v_mfma_f32_16x16x32_bf16 v[160:163], v[68:71], v[104:107], v[160:163]
    buffer_load_dwordx4 v[24:27], v6, s[8:11], s32 offen offset:0 sc1
    v_mfma_f32_16x16x32_bf16 v[192:195], v[68:71], v[108:111], v[192:195]
    v_lshrrev_b32 v18, 4, v1
    v_mfma_f32_16x16x32_bf16 v[224:227], v[68:71], v[112:115], v[224:227]
    v_bfe_u32 v20, v1, 2, 2
    v_mfma_f32_16x16x32_bf16 v[132:135], v[72:75], v[100:103], v[132:135]
    v_lshl_add_u32 v19, v18, 3, v20
    v_mfma_f32_16x16x32_bf16 v[164:167], v[72:75], v[104:107], v[164:167]
    buffer_load_dwordx4 v[28:31], v7, s[8:11], s32 offen offset:0 sc1
    v_lshlrev_b32 v19, 8, v19
    v_mfma_f32_16x16x32_bf16 v[196:199], v[72:75], v[108:111], v[196:199]
    v_and_b32 v21, 3, v1
    v_mfma_f32_16x16x32_bf16 v[228:231], v[72:75], v[112:115], v[228:231]
    v_lshl_add_u32 v19, v21, 3, v19
    v_mfma_f32_16x16x32_bf16 v[136:139], v[76:79], v[100:103], v[136:139]
    v_and_b32 v21, 1, v18
    v_mfma_f32_16x16x32_bf16 v[168:171], v[76:79], v[104:107], v[168:171]
    buffer_load_dwordx4 v[32:35], v6, s[8:11], s32 offen offset:1024 sc1
    v_lshl_add_u32 v20, v21, 2, v20
    v_mfma_f32_16x16x32_bf16 v[200:203], v[76:79], v[108:111], v[200:203]
    v_xor_b32 v21, 0, v20
    v_mfma_f32_16x16x32_bf16 v[232:235], v[76:79], v[112:115], v[232:235]
    v_lshl_add_u32 v10, v21, 5, v19
    v_mfma_f32_16x16x32_bf16 v[140:143], v[80:83], v[100:103], v[140:143]
    v_xor_b32 v21, 1, v20
    v_mfma_f32_16x16x32_bf16 v[172:175], v[80:83], v[104:107], v[172:175]
    buffer_load_dwordx4 v[36:39], v7, s[8:11], s32 offen offset:1024 sc1
    v_lshl_add_u32 v11, v21, 5, v19
    v_mfma_f32_16x16x32_bf16 v[204:207], v[80:83], v[108:111], v[204:207]
    v_xor_b32 v21, 2, v20
    v_mfma_f32_16x16x32_bf16 v[236:239], v[80:83], v[112:115], v[236:239]
    v_lshl_add_u32 v12, v21, 5, v19
    v_mfma_f32_16x16x32_bf16 v[144:147], v[84:87], v[100:103], v[144:147]
    v_xor_b32 v21, 3, v20
    v_mfma_f32_16x16x32_bf16 v[176:179], v[84:87], v[104:107], v[176:179]
    buffer_load_dwordx4 v[40:43], v6, s[8:11], s32 offen offset:2048 sc1
    v_lshl_add_u32 v13, v21, 5, v19
    v_mfma_f32_16x16x32_bf16 v[208:211], v[84:87], v[108:111], v[208:211]
    v_xor_b32 v21, 4, v20
    v_mfma_f32_16x16x32_bf16 v[240:243], v[84:87], v[112:115], v[240:243]
    v_lshl_add_u32 v14, v21, 5, v19
    v_mfma_f32_16x16x32_bf16 v[148:151], v[88:91], v[100:103], v[148:151]
    v_xor_b32 v21, 5, v20
    v_mfma_f32_16x16x32_bf16 v[180:183], v[88:91], v[104:107], v[180:183]
    buffer_load_dwordx4 v[44:47], v7, s[8:11], s32 offen offset:2048 sc1
    v_lshl_add_u32 v15, v21, 5, v19
    v_mfma_f32_16x16x32_bf16 v[212:215], v[88:91], v[108:111], v[212:215]
    v_xor_b32 v21, 6, v20
    v_mfma_f32_16x16x32_bf16 v[244:247], v[88:91], v[112:115], v[244:247]
    v_lshl_add_u32 v16, v21, 5, v19
    v_mfma_f32_16x16x32_bf16 v[152:155], v[92:95], v[100:103], v[152:155]
    v_xor_b32 v21, 7, v20
    v_mfma_f32_16x16x32_bf16 v[184:187], v[92:95], v[104:107], v[184:187]
    buffer_load_dwordx4 v[48:51], v6, s[8:11], s32 offen offset:3072 sc1
    v_lshl_add_u32 v17, v21, 5, v19
    v_mfma_f32_16x16x32_bf16 v[216:219], v[92:95], v[108:111], v[216:219]
    s_lshl_b32 s45, s29, 20
    v_mfma_f32_16x16x32_bf16 v[248:251], v[92:95], v[112:115], v[248:251]
    v_mfma_f32_16x16x32_bf16 v[156:159], v[96:99], v[100:103], v[156:159]
    v_mfma_f32_16x16x32_bf16 v[188:191], v[96:99], v[104:107], v[188:191]
    buffer_load_dwordx4 v[52:55], v7, s[8:11], s32 offen offset:3072 sc1
    v_mfma_f32_16x16x32_bf16 v[220:223], v[96:99], v[108:111], v[220:223]
    v_mfma_f32_16x16x32_bf16 v[252:255], v[96:99], v[112:115], v[252:255]
L_p1_done:
    s_waitcnt vmcnt(8)
    ds_read_b64_tr_b16 v[64:65], v10 offset:0
    ds_read_b64_tr_b16 v[66:67], v10 offset:1024
    ds_read_b64_tr_b16 v[68:69], v11 offset:0
    ds_read_b64_tr_b16 v[70:71], v11 offset:1024
    ds_read_b64_tr_b16 v[72:73], v12 offset:0
    ds_read_b64_tr_b16 v[74:75], v12 offset:1024
    ds_read_b64_tr_b16 v[76:77], v13 offset:0
    ds_read_b64_tr_b16 v[78:79], v13 offset:1024
    ds_read_b64_tr_b16 v[80:81], v14 offset:0
    ds_read_b64_tr_b16 v[82:83], v14 offset:1024
    ds_read_b64_tr_b16 v[84:85], v15 offset:0
    ds_read_b64_tr_b16 v[86:87], v15 offset:1024
    s_add_u32 m0, s33, 32768
    s_add_u32 s32, s32, 4096
    v_cvt_pk_bf16_f32 v128, v128, v129
    v_cvt_pk_bf16_f32 v129, v130, v131
    v_cvt_pk_bf16_f32 v130, v132, v133
    v_cvt_pk_bf16_f32 v131, v134, v135
    buffer_load_dwordx4 v2, s[4:7], s31 offen offset:0 lds
    v_cvt_pk_bf16_f32 v132, v136, v137
    v_cvt_pk_bf16_f32 v133, v138, v139
    v_cvt_pk_bf16_f32 v134, v140, v141
    v_cvt_pk_bf16_f32 v135, v142, v143
    buffer_load_dwordx4 v3, s[4:7], s31 offen offset:1024 lds
    v_cvt_pk_bf16_f32 v136, v144, v145
    v_cvt_pk_bf16_f32 v137, v146, v147
    v_cvt_pk_bf16_f32 v138, v148, v149
    v_cvt_pk_bf16_f32 v139, v150, v151
    buffer_load_dwordx4 v4, s[4:7], s31 offen offset:2048 lds
    v_cvt_pk_bf16_f32 v140, v152, v153
    v_cvt_pk_bf16_f32 v141, v154, v155
    v_cvt_pk_bf16_f32 v142, v156, v157
    v_cvt_pk_bf16_f32 v143, v158, v159
    buffer_load_dwordx4 v5, s[4:7], s31 offen offset:3072 lds
    v_cvt_pk_bf16_f32 v144, v160, v161
    v_cvt_pk_bf16_f32 v145, v162, v163
    v_cvt_pk_bf16_f32 v146, v164, v165
    v_cvt_pk_bf16_f32 v147, v166, v167
    s_add_u32 m0, s34, 32768
    s_mov_b32 s31, 3145728
    v_cvt_pk_bf16_f32 v148, v168, v169
    v_cvt_pk_bf16_f32 v149, v170, v171
    v_cvt_pk_bf16_f32 v150, v172, v173
    v_cvt_pk_bf16_f32 v151, v174, v175
    buffer_load_dwordx4 v2, s[4:7], s31 offen offset:0 lds
    v_cvt_pk_bf16_f32 v152, v176, v177
    v_cvt_pk_bf16_f32 v153, v178, v179
    v_cvt_pk_bf16_f32 v154, v180, v181
    v_cvt_pk_bf16_f32 v155, v182, v183
    buffer_load_dwordx4 v3, s[4:7], s31 offen offset:1024 lds
    v_cvt_pk_bf16_f32 v156, v184, v185
    v_cvt_pk_bf16_f32 v157, v186, v187
    v_cvt_pk_bf16_f32 v158, v188, v189
    v_cvt_pk_bf16_f32 v159, v190, v191
    buffer_load_dwordx4 v4, s[4:7], s31 offen offset:2048 lds
    v_cvt_pk_bf16_f32 v160, v192, v193
    v_cvt_pk_bf16_f32 v161, v194, v195
    v_cvt_pk_bf16_f32 v162, v196, v197
    v_cvt_pk_bf16_f32 v163, v198, v199
    buffer_load_dwordx4 v5, s[4:7], s31 offen offset:3072 lds
    v_cvt_pk_bf16_f32 v164, v200, v201
    v_cvt_pk_bf16_f32 v165, v202, v203
    v_cvt_pk_bf16_f32 v166, v204, v205
    v_cvt_pk_bf16_f32 v167, v206, v207
    s_add_u32 s31, s31, s40
    s_mov_b32 s34, s33
    v_cvt_pk_bf16_f32 v168, v208, v209
    v_cvt_pk_bf16_f32 v169, v210, v211
    v_cvt_pk_bf16_f32 v170, v212, v213
    v_cvt_pk_bf16_f32 v171, v214, v215
    buffer_load_dwordx4 v[96:99], v6, s[8:11], s32 offen offset:0 sc1
    v_cvt_pk_bf16_f32 v172, v216, v217
    v_cvt_pk_bf16_f32 v173, v218, v219
    v_cvt_pk_bf16_f32 v174, v220, v221
    v_cvt_pk_bf16_f32 v175, v222, v223
    buffer_load_dwordx4 v[100:103], v7, s[8:11], s32 offen offset:0 sc1
    v_cvt_pk_bf16_f32 v176, v224, v225
    v_cvt_pk_bf16_f32 v177, v226, v227
    v_cvt_pk_bf16_f32 v178, v228, v229
    v_cvt_pk_bf16_f32 v179, v230, v231
    buffer_load_dwordx4 v[104:107], v6, s[8:11], s32 offen offset:1024 sc1
    v_cvt_pk_bf16_f32 v180, v232, v233
    v_cvt_pk_bf16_f32 v181, v234, v235
    v_cvt_pk_bf16_f32 v182, v236, v237
    v_cvt_pk_bf16_f32 v183, v238, v239
    buffer_load_dwordx4 v[108:111], v7, s[8:11], s32 offen offset:1024 sc1
    v_cvt_pk_bf16_f32 v184, v240, v241
    v_cvt_pk_bf16_f32 v185, v242, v243
    v_cvt_pk_bf16_f32 v186, v244, v245
    v_cvt_pk_bf16_f32 v187, v246, v247
    buffer_load_dwordx4 v[112:115], v6, s[8:11], s32 offen offset:2048 sc1
    v_cvt_pk_bf16_f32 v188, v248, v249
    v_cvt_pk_bf16_f32 v189, v250, v251
    v_cvt_pk_bf16_f32 v190, v252, v253
    v_cvt_pk_bf16_f32 v191, v254, v255
    s_lshl_b32 s38, s29, 20
    s_lshl_b32 s37, s30, 17
    s_add_u32 s38, s38, s37
    s_bfe_u32 s37, s28, 0x10001
    s_lshl_b32 s37, s37, 16
    s_add_u32 s38, s38, s37
    s_lshr_b32 s36, s28, 2
    s_lshl_b32 s37, s36, 15
    s_add_u32 s38, s38, s37
    s_and_b32 s37, s28, 1
    s_add_u32 s36, s36, 11
    s_lshl_b32 s37, s37, s36
    s_add_u32 s38, s38, s37
    s_cmp_lt_u32 s28, 4
    s_cselect_b32 s36, 4, 32
    s_cselect_b32 s37, 16, 64
    s_cselect_b32 s39, 32, 4
    s_lshl_b32 s36, s36, 8
    s_lshl_b32 s37, s37, 8
    s_lshl_b32 s39, s39, 8
    s_mov_b64 s[16:17], s[12:13]
    s_mov_b64 s[18:19], s[14:15]
    s_cmp_eq_u32 s30, 0
    s_cselect_b32 s52, 2, 4
    v_lshlrev_b32 v58, 4, v1
    v_add_u32 v59, s36, v58
    v_add_u32 v60, s37, v58
    v_add_u32 v61, s36, v60
    v_mov_b64 v[192:193], 0
    v_mov_b64 v[194:195], 0
    v_mov_b64 v[196:197], 0
    v_mov_b64 v[198:199], 0
    v_mov_b64 v[200:201], 0
    v_mov_b64 v[202:203], 0
    v_mov_b64 v[204:205], 0
    v_mov_b64 v[206:207], 0
    v_mov_b64 v[208:209], 0
    v_mov_b64 v[210:211], 0
    v_mov_b64 v[212:213], 0
    v_mov_b64 v[214:215], 0
    v_mov_b64 v[216:217], 0
    v_mov_b64 v[218:219], 0
    v_mov_b64 v[220:221], 0
    v_mov_b64 v[222:223], 0
    v_mov_b64 v[224:225], 0
    v_mov_b64 v[226:227], 0
    v_mov_b64 v[228:229], 0
    v_mov_b64 v[230:231], 0
    v_mov_b64 v[232:233], 0
    v_mov_b64 v[234:235], 0
    v_mov_b64 v[236:237], 0
    v_mov_b64 v[238:239], 0
    v_mov_b64 v[240:241], 0
    v_mov_b64 v[242:243], 0
    v_mov_b64 v[244:245], 0
    v_mov_b64 v[246:247], 0
    v_mov_b64 v[248:249], 0
    v_mov_b64 v[250:251], 0
    v_mov_b64 v[252:253], 0
    v_mov_b64 v[254:255], 0
    buffer_load_dwordx4 v[116:119], v7, s[8:11], s32 offen offset:2048 sc1
    s_mov_b32 s35, 0
    s_waitcnt vmcnt(14)
    s_cmp_eq_u32 s30, 0
    s_cbranch_scc1 L_recurrent_scan__compressed_kv_cla__moe_arch_mod__prompt_kernel_rare_63
L_recurrent_scan__compressed_kv_cla__moe_arch_mod__prompt_kernel_back_64:
    .p2align 6
L_p2_loop:
    s_cmp_ge_u32 s35, 2
    s_cbranch_scc1 L_recurrent_scan__compressed_kv_cla__moe_arch_mod__prompt_kernel_rare_53
L_recurrent_scan__compressed_kv_cla__moe_arch_mod__prompt_kernel_back_54:
    s_waitcnt lgkmcnt(8)
    s_waitcnt vmcnt(23)
    v_mfma_f32_16x16x32_bf16 v[192:195], v[64:67], v[24:27], v[192:195]
    ds_read_b64_tr_b16 v[88:89], v16 offset:0
    v_mfma_f32_16x16x32_bf16 v[224:227], v[64:67], v[28:31], v[224:227]
    ds_read_b64_tr_b16 v[90:91], v16 offset:1024
    v_mfma_f32_16x16x32_bf16 v[196:199], v[68:71], v[24:27], v[196:199]
    ds_read_b64_tr_b16 v[92:93], v17 offset:0
    buffer_load_dwordx4 v[120:123], v6, s[8:11], s32 offen offset:3072 sc1
    v_mfma_f32_16x16x32_bf16 v[228:231], v[68:71], v[28:31], v[228:231]
    ds_read_b64_tr_b16 v[94:95], v17 offset:1024
    s_waitcnt lgkmcnt(8)
    v_mfma_f32_16x16x32_bf16 v[200:203], v[72:75], v[24:27], v[200:203]
    ds_read_b64_tr_b16 v[64:65], v10 offset:8192
    v_mfma_f32_16x16x32_bf16 v[232:235], v[72:75], v[28:31], v[232:235]
    ds_read_b64_tr_b16 v[66:67], v10 offset:9216
    v_mfma_f32_16x16x32_bf16 v[204:207], v[76:79], v[24:27], v[204:207]
    ds_read_b64_tr_b16 v[68:69], v11 offset:8192
    buffer_load_dwordx4 v[124:127], v7, s[8:11], s32 offen offset:3072 sc1
    v_mfma_f32_16x16x32_bf16 v[236:239], v[76:79], v[28:31], v[236:239]
    ds_read_b64_tr_b16 v[70:71], v11 offset:9216
    s_add_u32 s32, s32, 4096
    s_waitcnt lgkmcnt(8)
    v_mfma_f32_16x16x32_bf16 v[208:211], v[80:83], v[24:27], v[208:211]
    ds_read_b64_tr_b16 v[72:73], v12 offset:8192
    s_cmp_lt_u32 s35, 3
    s_cselect_b32 s10, 4194304, 0
    v_mfma_f32_16x16x32_bf16 v[240:243], v[80:83], v[28:31], v[240:243]
    ds_read_b64_tr_b16 v[74:75], v12 offset:9216
    s_cmp_lt_u32 s35, s52
    s_cselect_b32 s18, s18, 0
    v_mfma_f32_16x16x32_bf16 v[212:215], v[84:87], v[24:27], v[212:215]
    ds_read_b64_tr_b16 v[76:77], v13 offset:8192
    buffer_store_dwordx4 v[128:131], v58, s[16:19], s38 offen sc1
    v_mfma_f32_16x16x32_bf16 v[244:247], v[84:87], v[28:31], v[244:247]
    ds_read_b64_tr_b16 v[78:79], v13 offset:9216
    s_waitcnt lgkmcnt(8)
    v_mfma_f32_16x16x32_bf16 v[216:219], v[88:91], v[24:27], v[216:219]
    ds_read_b64_tr_b16 v[80:81], v14 offset:8192
    v_mov_b64 v[128:129], v[144:145]
    v_mfma_f32_16x16x32_bf16 v[248:251], v[88:91], v[28:31], v[248:251]
    ds_read_b64_tr_b16 v[82:83], v14 offset:9216
    v_mfma_f32_16x16x32_bf16 v[220:223], v[92:95], v[24:27], v[220:223]
    ds_read_b64_tr_b16 v[84:85], v15 offset:8192
    v_mov_b64 v[130:131], v[146:147]
    v_mfma_f32_16x16x32_bf16 v[252:255], v[92:95], v[28:31], v[252:255]
    ds_read_b64_tr_b16 v[86:87], v15 offset:9216
    s_waitcnt lgkmcnt(8)
    s_waitcnt vmcnt(23)
    v_mfma_f32_16x16x32_bf16 v[192:195], v[64:67], v[32:35], v[192:195]
    ds_read_b64_tr_b16 v[88:89], v16 offset:8192
    v_mov_b64 v[144:145], v[160:161]
    v_mfma_f32_16x16x32_bf16 v[224:227], v[64:67], v[36:39], v[224:227]
    ds_read_b64_tr_b16 v[90:91], v16 offset:9216
    v_mfma_f32_16x16x32_bf16 v[196:199], v[68:71], v[32:35], v[196:199]
    ds_read_b64_tr_b16 v[92:93], v17 offset:8192
    buffer_load_dwordx4 v[24:27], v6, s[8:11], s32 offen offset:0 sc1
    v_mov_b64 v[146:147], v[162:163]
    v_mfma_f32_16x16x32_bf16 v[228:231], v[68:71], v[36:39], v[228:231]
    ds_read_b64_tr_b16 v[94:95], v17 offset:9216
    s_waitcnt lgkmcnt(8)
    v_mfma_f32_16x16x32_bf16 v[200:203], v[72:75], v[32:35], v[200:203]
    ds_read_b64_tr_b16 v[64:65], v10 offset:16384
    v_mov_b64 v[160:161], v[176:177]
    v_mfma_f32_16x16x32_bf16 v[232:235], v[72:75], v[36:39], v[232:235]
    ds_read_b64_tr_b16 v[66:67], v10 offset:17408
    v_mfma_f32_16x16x32_bf16 v[204:207], v[76:79], v[32:35], v[204:207]
    ds_read_b64_tr_b16 v[68:69], v11 offset:16384
    buffer_load_dwordx4 v[28:31], v7, s[8:11], s32 offen offset:0 sc1
    v_mov_b64 v[162:163], v[178:179]
    v_mfma_f32_16x16x32_bf16 v[236:239], v[76:79], v[36:39], v[236:239]
    ds_read_b64_tr_b16 v[70:71], v11 offset:17408
    s_waitcnt lgkmcnt(8)
    v_mfma_f32_16x16x32_bf16 v[208:211], v[80:83], v[32:35], v[208:211]
    ds_read_b64_tr_b16 v[72:73], v12 offset:16384
    v_mfma_f32_16x16x32_bf16 v[240:243], v[80:83], v[36:39], v[240:243]
    ds_read_b64_tr_b16 v[74:75], v12 offset:17408
    v_mfma_f32_16x16x32_bf16 v[212:215], v[84:87], v[32:35], v[212:215]
    ds_read_b64_tr_b16 v[76:77], v13 offset:16384
    v_mfma_f32_16x16x32_bf16 v[244:247], v[84:87], v[36:39], v[244:247]
    ds_read_b64_tr_b16 v[78:79], v13 offset:17408
    s_waitcnt lgkmcnt(8)
    v_mfma_f32_16x16x32_bf16 v[216:219], v[88:91], v[32:35], v[216:219]
    ds_read_b64_tr_b16 v[80:81], v14 offset:16384
    v_mfma_f32_16x16x32_bf16 v[248:251], v[88:91], v[36:39], v[248:251]
    ds_read_b64_tr_b16 v[82:83], v14 offset:17408
    v_mfma_f32_16x16x32_bf16 v[220:223], v[92:95], v[32:35], v[220:223]
    ds_read_b64_tr_b16 v[84:85], v15 offset:16384
    buffer_store_dwordx4 v[132:135], v59, s[16:19], s38 offen sc1
    v_mfma_f32_16x16x32_bf16 v[252:255], v[92:95], v[36:39], v[252:255]
    ds_read_b64_tr_b16 v[86:87], v15 offset:17408
    s_waitcnt lgkmcnt(8)
    s_waitcnt vmcnt(24)
    v_mfma_f32_16x16x32_bf16 v[192:195], v[64:67], v[40:43], v[192:195]
    ds_read_b64_tr_b16 v[88:89], v16 offset:16384
    v_mov_b64 v[132:133], v[148:149]
    v_mfma_f32_16x16x32_bf16 v[224:227], v[64:67], v[44:47], v[224:227]
    ds_read_b64_tr_b16 v[90:91], v16 offset:17408
    v_mfma_f32_16x16x32_bf16 v[196:199], v[68:71], v[40:43], v[196:199]
    ds_read_b64_tr_b16 v[92:93], v17 offset:16384
    buffer_load_dwordx4 v[32:35], v6, s[8:11], s32 offen offset:1024 sc1
    v_mov_b64 v[134:135], v[150:151]
    v_mfma_f32_16x16x32_bf16 v[228:231], v[68:71], v[44:47], v[228:231]
    ds_read_b64_tr_b16 v[94:95], v17 offset:17408
    s_waitcnt lgkmcnt(8)
    v_mfma_f32_16x16x32_bf16 v[200:203], v[72:75], v[40:43], v[200:203]
    ds_read_b64_tr_b16 v[64:65], v10 offset:24576
    v_mov_b64 v[148:149], v[164:165]
    v_mfma_f32_16x16x32_bf16 v[232:235], v[72:75], v[44:47], v[232:235]
    ds_read_b64_tr_b16 v[66:67], v10 offset:25600
    v_mfma_f32_16x16x32_bf16 v[204:207], v[76:79], v[40:43], v[204:207]
    ds_read_b64_tr_b16 v[68:69], v11 offset:24576
    buffer_load_dwordx4 v[36:39], v7, s[8:11], s32 offen offset:1024 sc1
    v_mov_b64 v[150:151], v[166:167]
    v_mfma_f32_16x16x32_bf16 v[236:239], v[76:79], v[44:47], v[236:239]
    ds_read_b64_tr_b16 v[70:71], v11 offset:25600
    s_waitcnt lgkmcnt(8)
    v_mfma_f32_16x16x32_bf16 v[208:211], v[80:83], v[40:43], v[208:211]
    ds_read_b64_tr_b16 v[72:73], v12 offset:24576
    v_mov_b64 v[164:165], v[180:181]
    v_mfma_f32_16x16x32_bf16 v[240:243], v[80:83], v[44:47], v[240:243]
    ds_read_b64_tr_b16 v[74:75], v12 offset:25600
    v_mfma_f32_16x16x32_bf16 v[212:215], v[84:87], v[40:43], v[212:215]
    ds_read_b64_tr_b16 v[76:77], v13 offset:24576
    v_mov_b64 v[166:167], v[182:183]
    v_mfma_f32_16x16x32_bf16 v[244:247], v[84:87], v[44:47], v[244:247]
    ds_read_b64_tr_b16 v[78:79], v13 offset:25600
    s_waitcnt lgkmcnt(8)
    v_mfma_f32_16x16x32_bf16 v[216:219], v[88:91], v[40:43], v[216:219]
    ds_read_b64_tr_b16 v[80:81], v14 offset:24576
    v_mfma_f32_16x16x32_bf16 v[248:251], v[88:91], v[44:47], v[248:251]
    ds_read_b64_tr_b16 v[82:83], v14 offset:25600
    v_mfma_f32_16x16x32_bf16 v[220:223], v[92:95], v[40:43], v[220:223]
    ds_read_b64_tr_b16 v[84:85], v15 offset:24576
    v_mfma_f32_16x16x32_bf16 v[252:255], v[92:95], v[44:47], v[252:255]
    ds_read_b64_tr_b16 v[86:87], v15 offset:25600
    s_waitcnt lgkmcnt(8)
    s_waitcnt vmcnt(20)
    v_mfma_f32_16x16x32_bf16 v[192:195], v[64:67], v[48:51], v[192:195]
    ds_read_b64_tr_b16 v[88:89], v16 offset:24576
    v_mfma_f32_16x16x32_bf16 v[224:227], v[64:67], v[52:55], v[224:227]
    ds_read_b64_tr_b16 v[90:91], v16 offset:25600
    v_mfma_f32_16x16x32_bf16 v[196:199], v[68:71], v[48:51], v[196:199]
    ds_read_b64_tr_b16 v[92:93], v17 offset:24576
    buffer_load_dwordx4 v[40:43], v6, s[8:11], s32 offen offset:2048 sc1
    v_mfma_f32_16x16x32_bf16 v[228:231], v[68:71], v[52:55], v[228:231]
    ds_read_b64_tr_b16 v[94:95], v17 offset:25600
    s_waitcnt lgkmcnt(8)
    v_mfma_f32_16x16x32_bf16 v[200:203], v[72:75], v[48:51], v[200:203]
    v_mfma_f32_16x16x32_bf16 v[232:235], v[72:75], v[52:55], v[232:235]
    v_mfma_f32_16x16x32_bf16 v[204:207], v[76:79], v[48:51], v[204:207]
    buffer_load_dwordx4 v[44:47], v7, s[8:11], s32 offen offset:2048 sc1
    v_mfma_f32_16x16x32_bf16 v[236:239], v[76:79], v[52:55], v[236:239]
    s_cmp_ge_u32 s35, 2
    s_cbranch_scc1 L_recurrent_scan__compressed_kv_cla__moe_arch_mod__prompt_kernel_rare_47
L_recurrent_scan__compressed_kv_cla__moe_arch_mod__prompt_kernel_back_48:
    s_waitcnt lgkmcnt(0)
    s_waitcnt vmcnt(20)
    s_cmp_eq_u32 s35, s52
    s_cbranch_scc1 L_recurrent_scan__compressed_kv_cla__moe_arch_mod__prompt_kernel_rare_61
L_recurrent_scan__compressed_kv_cla__moe_arch_mod__prompt_kernel_back_62:
    s_barrier
    v_mfma_f32_16x16x32_bf16 v[208:211], v[80:83], v[48:51], v[208:211]
    ds_read_b64_tr_b16 v[64:65], v10 offset:32768
    ds_read_b64_tr_b16 v[66:67], v10 offset:33792
    v_mfma_f32_16x16x32_bf16 v[240:243], v[80:83], v[52:55], v[240:243]
    ds_read_b64_tr_b16 v[68:69], v11 offset:32768
    ds_read_b64_tr_b16 v[70:71], v11 offset:33792
    v_mfma_f32_16x16x32_bf16 v[212:215], v[84:87], v[48:51], v[212:215]
    ds_read_b64_tr_b16 v[72:73], v12 offset:32768
    ds_read_b64_tr_b16 v[74:75], v12 offset:33792
    v_mfma_f32_16x16x32_bf16 v[244:247], v[84:87], v[52:55], v[244:247]
    ds_read_b64_tr_b16 v[76:77], v13 offset:32768
    ds_read_b64_tr_b16 v[78:79], v13 offset:33792
    s_add_u32 m0, s34, 0
    v_mfma_f32_16x16x32_bf16 v[216:219], v[88:91], v[48:51], v[216:219]
    ds_read_b64_tr_b16 v[80:81], v14 offset:32768
    ds_read_b64_tr_b16 v[82:83], v14 offset:33792
    buffer_load_dwordx4 v2, s[4:7], s31 offen offset:0 sc1 lds
    v_mfma_f32_16x16x32_bf16 v[248:251], v[88:91], v[52:55], v[248:251]
    buffer_load_dwordx4 v3, s[4:7], s31 offen offset:1024 sc1 lds
    v_mfma_f32_16x16x32_bf16 v[220:223], v[92:95], v[48:51], v[220:223]
    ds_read_b64_tr_b16 v[84:85], v15 offset:32768
    ds_read_b64_tr_b16 v[86:87], v15 offset:33792
    buffer_load_dwordx4 v4, s[4:7], s31 offen offset:2048 sc1 lds
    v_mfma_f32_16x16x32_bf16 v[252:255], v[92:95], v[52:55], v[252:255]
    buffer_load_dwordx4 v5, s[4:7], s31 offen offset:3072 sc1 lds
    s_add_u32 s31, s31, s40
    s_cmp_ge_u32 s35, 2
    s_cbranch_scc1 L_recurrent_scan__compressed_kv_cla__moe_arch_mod__prompt_kernel_rare_59
L_recurrent_scan__compressed_kv_cla__moe_arch_mod__prompt_kernel_back_60:
    s_waitcnt lgkmcnt(8)
    s_waitcnt vmcnt(18)
    v_mfma_f32_16x16x32_bf16 v[192:195], v[64:67], v[96:99], v[192:195]
    ds_read_b64_tr_b16 v[88:89], v16 offset:32768
    v_mfma_f32_16x16x32_bf16 v[224:227], v[64:67], v[100:103], v[224:227]
    ds_read_b64_tr_b16 v[90:91], v16 offset:33792
    v_mfma_f32_16x16x32_bf16 v[196:199], v[68:71], v[96:99], v[196:199]
    ds_read_b64_tr_b16 v[92:93], v17 offset:32768
    buffer_load_dwordx4 v[48:51], v6, s[8:11], s32 offen offset:3072 sc1
    v_mfma_f32_16x16x32_bf16 v[228:231], v[68:71], v[100:103], v[228:231]
    ds_read_b64_tr_b16 v[94:95], v17 offset:33792
    s_waitcnt lgkmcnt(8)
    v_mfma_f32_16x16x32_bf16 v[200:203], v[72:75], v[96:99], v[200:203]
    ds_read_b64_tr_b16 v[64:65], v10 offset:40960
    v_mfma_f32_16x16x32_bf16 v[232:235], v[72:75], v[100:103], v[232:235]
    ds_read_b64_tr_b16 v[66:67], v10 offset:41984
    v_mfma_f32_16x16x32_bf16 v[204:207], v[76:79], v[96:99], v[204:207]
    ds_read_b64_tr_b16 v[68:69], v11 offset:40960
    buffer_load_dwordx4 v[52:55], v7, s[8:11], s32 offen offset:3072 sc1
    v_mfma_f32_16x16x32_bf16 v[236:239], v[76:79], v[100:103], v[236:239]
    ds_read_b64_tr_b16 v[70:71], v11 offset:41984
    s_add_u32 s32, s32, 4096
    s_waitcnt lgkmcnt(8)
    v_mfma_f32_16x16x32_bf16 v[208:211], v[80:83], v[96:99], v[208:211]
    ds_read_b64_tr_b16 v[72:73], v12 offset:40960
    v_mfma_f32_16x16x32_bf16 v[240:243], v[80:83], v[100:103], v[240:243]
    ds_read_b64_tr_b16 v[74:75], v12 offset:41984
    v_mfma_f32_16x16x32_bf16 v[212:215], v[84:87], v[96:99], v[212:215]
    ds_read_b64_tr_b16 v[76:77], v13 offset:40960
    buffer_store_dwordx4 v[136:139], v60, s[16:19], s38 offen sc1
    v_mfma_f32_16x16x32_bf16 v[244:247], v[84:87], v[100:103], v[244:247]
    ds_read_b64_tr_b16 v[78:79], v13 offset:41984
    s_waitcnt lgkmcnt(8)
    v_mfma_f32_16x16x32_bf16 v[216:219], v[88:91], v[96:99], v[216:219]
    ds_read_b64_tr_b16 v[80:81], v14 offset:40960
    v_mov_b64 v[136:137], v[152:153]
    v_mfma_f32_16x16x32_bf16 v[248:251], v[88:91], v[100:103], v[248:251]
    ds_read_b64_tr_b16 v[82:83], v14 offset:41984
    v_mfma_f32_16x16x32_bf16 v[220:223], v[92:95], v[96:99], v[220:223]
    ds_read_b64_tr_b16 v[84:85], v15 offset:40960
    v_mov_b64 v[138:139], v[154:155]
    v_mfma_f32_16x16x32_bf16 v[252:255], v[92:95], v[100:103], v[252:255]
    ds_read_b64_tr_b16 v[86:87], v15 offset:41984
    s_waitcnt lgkmcnt(8)
    s_waitcnt vmcnt(19)
    v_mfma_f32_16x16x32_bf16 v[192:195], v[64:67], v[104:107], v[192:195]
    ds_read_b64_tr_b16 v[88:89], v16 offset:40960
    v_mov_b64 v[152:153], v[168:169]
    v_mfma_f32_16x16x32_bf16 v[224:227], v[64:67], v[108:111], v[224:227]
    ds_read_b64_tr_b16 v[90:91], v16 offset:41984
    v_mfma_f32_16x16x32_bf16 v[196:199], v[68:71], v[104:107], v[196:199]
    ds_read_b64_tr_b16 v[92:93], v17 offset:40960
    buffer_load_dwordx4 v[96:99], v6, s[8:11], s32 offen offset:0 sc1
    v_mov_b64 v[154:155], v[170:171]
    v_mfma_f32_16x16x32_bf16 v[228:231], v[68:71], v[108:111], v[228:231]
    ds_read_b64_tr_b16 v[94:95], v17 offset:41984
    s_waitcnt lgkmcnt(8)
    v_mfma_f32_16x16x32_bf16 v[200:203], v[72:75], v[104:107], v[200:203]
    ds_read_b64_tr_b16 v[64:65], v10 offset:49152
    v_mov_b64 v[168:169], v[184:185]
    v_mfma_f32_16x16x32_bf16 v[232:235], v[72:75], v[108:111], v[232:235]
    ds_read_b64_tr_b16 v[66:67], v10 offset:50176
    v_mfma_f32_16x16x32_bf16 v[204:207], v[76:79], v[104:107], v[204:207]
    ds_read_b64_tr_b16 v[68:69], v11 offset:49152
    buffer_load_dwordx4 v[100:103], v7, s[8:11], s32 offen offset:0 sc1
    v_mov_b64 v[170:171], v[186:187]
    v_mfma_f32_16x16x32_bf16 v[236:239], v[76:79], v[108:111], v[236:239]
    ds_read_b64_tr_b16 v[70:71], v11 offset:50176
    s_waitcnt lgkmcnt(8)
    v_mfma_f32_16x16x32_bf16 v[208:211], v[80:83], v[104:107], v[208:211]
    ds_read_b64_tr_b16 v[72:73], v12 offset:49152
    v_mfma_f32_16x16x32_bf16 v[240:243], v[80:83], v[108:111], v[240:243]
    ds_read_b64_tr_b16 v[74:75], v12 offset:50176
    v_mfma_f32_16x16x32_bf16 v[212:215], v[84:87], v[104:107], v[212:215]
    ds_read_b64_tr_b16 v[76:77], v13 offset:49152
    v_mfma_f32_16x16x32_bf16 v[244:247], v[84:87], v[108:111], v[244:247]
    ds_read_b64_tr_b16 v[78:79], v13 offset:50176
    s_waitcnt lgkmcnt(8)
    v_mfma_f32_16x16x32_bf16 v[216:219], v[88:91], v[104:107], v[216:219]
    ds_read_b64_tr_b16 v[80:81], v14 offset:49152
    v_mfma_f32_16x16x32_bf16 v[248:251], v[88:91], v[108:111], v[248:251]
    ds_read_b64_tr_b16 v[82:83], v14 offset:50176
    v_mfma_f32_16x16x32_bf16 v[220:223], v[92:95], v[104:107], v[220:223]
    ds_read_b64_tr_b16 v[84:85], v15 offset:49152
    buffer_store_dwordx4 v[140:143], v61, s[16:19], s38 offen sc1
    v_mfma_f32_16x16x32_bf16 v[252:255], v[92:95], v[108:111], v[252:255]
    ds_read_b64_tr_b16 v[86:87], v15 offset:50176
    s_add_u32 s38, s38, s39
    s_waitcnt lgkmcnt(8)
    s_waitcnt vmcnt(20)
    v_mfma_f32_16x16x32_bf16 v[192:195], v[64:67], v[112:115], v[192:195]
    ds_read_b64_tr_b16 v[88:89], v16 offset:49152
    v_mov_b64 v[140:141], v[156:157]
    v_mfma_f32_16x16x32_bf16 v[224:227], v[64:67], v[116:119], v[224:227]
    ds_read_b64_tr_b16 v[90:91], v16 offset:50176
    v_mfma_f32_16x16x32_bf16 v[196:199], v[68:71], v[112:115], v[196:199]
    ds_read_b64_tr_b16 v[92:93], v17 offset:49152
    buffer_load_dwordx4 v[104:107], v6, s[8:11], s32 offen offset:1024 sc1
    v_mov_b64 v[142:143], v[158:159]
    v_mfma_f32_16x16x32_bf16 v[228:231], v[68:71], v[116:119], v[228:231]
    ds_read_b64_tr_b16 v[94:95], v17 offset:50176
    s_waitcnt lgkmcnt(8)
    v_mfma_f32_16x16x32_bf16 v[200:203], v[72:75], v[112:115], v[200:203]
    ds_read_b64_tr_b16 v[64:65], v10 offset:57344
    v_mov_b64 v[156:157], v[172:173]
    v_mfma_f32_16x16x32_bf16 v[232:235], v[72:75], v[116:119], v[232:235]
    ds_read_b64_tr_b16 v[66:67], v10 offset:58368
    v_xor_b32 v10, 65536, v10
    v_mfma_f32_16x16x32_bf16 v[204:207], v[76:79], v[112:115], v[204:207]
    ds_read_b64_tr_b16 v[68:69], v11 offset:57344
    buffer_load_dwordx4 v[108:111], v7, s[8:11], s32 offen offset:1024 sc1
    v_mov_b64 v[158:159], v[174:175]
    v_mfma_f32_16x16x32_bf16 v[236:239], v[76:79], v[116:119], v[236:239]
    ds_read_b64_tr_b16 v[70:71], v11 offset:58368
    v_xor_b32 v11, 65536, v11
    s_waitcnt lgkmcnt(8)
    v_mfma_f32_16x16x32_bf16 v[208:211], v[80:83], v[112:115], v[208:211]
    ds_read_b64_tr_b16 v[72:73], v12 offset:57344
    v_mov_b64 v[172:173], v[188:189]
    v_mfma_f32_16x16x32_bf16 v[240:243], v[80:83], v[116:119], v[240:243]
    ds_read_b64_tr_b16 v[74:75], v12 offset:58368
    v_xor_b32 v12, 65536, v12
    v_mfma_f32_16x16x32_bf16 v[212:215], v[84:87], v[112:115], v[212:215]
    ds_read_b64_tr_b16 v[76:77], v13 offset:57344
    v_mov_b64 v[174:175], v[190:191]
    v_mfma_f32_16x16x32_bf16 v[244:247], v[84:87], v[116:119], v[244:247]
    ds_read_b64_tr_b16 v[78:79], v13 offset:58368
    v_xor_b32 v13, 65536, v13
    s_waitcnt lgkmcnt(8)
    v_mfma_f32_16x16x32_bf16 v[216:219], v[88:91], v[112:115], v[216:219]
    ds_read_b64_tr_b16 v[80:81], v14 offset:57344
    v_mfma_f32_16x16x32_bf16 v[248:251], v[88:91], v[116:119], v[248:251]
    ds_read_b64_tr_b16 v[82:83], v14 offset:58368
    v_xor_b32 v14, 65536, v14
    v_mfma_f32_16x16x32_bf16 v[220:223], v[92:95], v[112:115], v[220:223]
    ds_read_b64_tr_b16 v[84:85], v15 offset:57344
    v_mfma_f32_16x16x32_bf16 v[252:255], v[92:95], v[116:119], v[252:255]
    ds_read_b64_tr_b16 v[86:87], v15 offset:58368
    v_xor_b32 v15, 65536, v15
    s_waitcnt lgkmcnt(8)
    s_waitcnt vmcnt(20)
    v_mfma_f32_16x16x32_bf16 v[192:195], v[64:67], v[120:123], v[192:195]
    ds_read_b64_tr_b16 v[88:89], v16 offset:57344
    v_mfma_f32_16x16x32_bf16 v[224:227], v[64:67], v[124:127], v[224:227]
    ds_read_b64_tr_b16 v[90:91], v16 offset:58368
    v_xor_b32 v16, 65536, v16
    v_mfma_f32_16x16x32_bf16 v[196:199], v[68:71], v[120:123], v[196:199]
    ds_read_b64_tr_b16 v[92:93], v17 offset:57344
    buffer_load_dwordx4 v[112:115], v6, s[8:11], s32 offen offset:2048 sc1
    v_mfma_f32_16x16x32_bf16 v[228:231], v[68:71], v[124:127], v[228:231]
    ds_read_b64_tr_b16 v[94:95], v17 offset:58368
    v_xor_b32 v17, 65536, v17
    s_waitcnt lgkmcnt(8)
    v_mfma_f32_16x16x32_bf16 v[200:203], v[72:75], v[120:123], v[200:203]
    v_mfma_f32_16x16x32_bf16 v[232:235], v[72:75], v[124:127], v[232:235]
    v_mfma_f32_16x16x32_bf16 v[204:207], v[76:79], v[120:123], v[204:207]
    buffer_load_dwordx4 v[116:119], v7, s[8:11], s32 offen offset:2048 sc1
    v_mfma_f32_16x16x32_bf16 v[236:239], v[76:79], v[124:127], v[236:239]
    s_waitcnt lgkmcnt(0)
    s_barrier
    v_mfma_f32_16x16x32_bf16 v[208:211], v[80:83], v[120:123], v[208:211]
    ds_read_b64_tr_b16 v[64:65], v10 offset:0
    ds_read_b64_tr_b16 v[66:67], v10 offset:1024
    v_mfma_f32_16x16x32_bf16 v[240:243], v[80:83], v[124:127], v[240:243]
    ds_read_b64_tr_b16 v[68:69], v11 offset:0
    ds_read_b64_tr_b16 v[70:71], v11 offset:1024
    v_mfma_f32_16x16x32_bf16 v[212:215], v[84:87], v[120:123], v[212:215]
    ds_read_b64_tr_b16 v[72:73], v12 offset:0
    ds_read_b64_tr_b16 v[74:75], v12 offset:1024
    v_mfma_f32_16x16x32_bf16 v[244:247], v[84:87], v[124:127], v[244:247]
    ds_read_b64_tr_b16 v[76:77], v13 offset:0
    ds_read_b64_tr_b16 v[78:79], v13 offset:1024
    s_add_u32 m0, s34, 32768
    v_mfma_f32_16x16x32_bf16 v[216:219], v[88:91], v[120:123], v[216:219]
    ds_read_b64_tr_b16 v[80:81], v14 offset:0
    ds_read_b64_tr_b16 v[82:83], v14 offset:1024
    buffer_load_dwordx4 v2, s[4:7], s31 offen offset:0 sc1 lds
    v_mfma_f32_16x16x32_bf16 v[248:251], v[88:91], v[124:127], v[248:251]
    buffer_load_dwordx4 v3, s[4:7], s31 offen offset:1024 sc1 lds
    v_mfma_f32_16x16x32_bf16 v[220:223], v[92:95], v[120:123], v[220:223]
    ds_read_b64_tr_b16 v[84:85], v15 offset:0
    ds_read_b64_tr_b16 v[86:87], v15 offset:1024
    buffer_load_dwordx4 v4, s[4:7], s31 offen offset:2048 sc1 lds
    v_mfma_f32_16x16x32_bf16 v[252:255], v[92:95], v[124:127], v[252:255]
    buffer_load_dwordx4 v5, s[4:7], s31 offen offset:3072 sc1 lds
    s_add_u32 s31, s31, s40
    s_xor_b32 s34, s34, 65536
    s_add_u32 s35, s35, 1
    s_cmp_lt_u32 s35, 4
    s_cbranch_scc1 L_p2_loop
    s_load_dwordx2 s[32:33], s[0:1], 40
    s_load_dwordx2 s[34:35], s[0:1], 80
    s_load_dwordx2 s[96:97], s[0:1], 0
    s_load_dwordx2 s[98:99], s[0:1], 88
    s_cmp_lt_u32 s28, 4
    s_cbranch_scc0 L_grp1
    v_mov_b32 v20, 1040356334
    v_mov_b32 v21, v20
    s_and_b32 s37, s28, 3
    s_lshl_b32 s37, s37, 13
    v_lshlrev_b32 v7, 4, v1
    v_add_u32 v4, s37, v7
    v_add_u32 v6, 4096, v4
    v_add_u32 v19, 131072, v4
    s_add_u32 s43, s37, 32768
    s_add_u32 s44, s37, 98304
    s_waitcnt vmcnt(4) lgkmcnt(0)
    v_pk_mul_f32 v[192:193], v[192:193], v[20:21]
    v_pk_mul_f32 v[194:195], v[194:195], v[20:21]
    v_pk_mul_f32 v[196:197], v[196:197], v[20:21]
    v_pk_mul_f32 v[198:199], v[198:199], v[20:21]
    v_cvt_pk_bf16_f32 v128, v192, v193
    v_cvt_pk_bf16_f32 v129, v194, v195
    v_cvt_pk_bf16_f32 v130, v196, v197
    v_cvt_pk_bf16_f32 v131, v198, v199
    ds_write_b128 v19, v[128:131] offset:0
    v_pk_mul_f32 v[200:201], v[200:201], v[20:21]
    v_pk_mul_f32 v[202:203], v[202:203], v[20:21]
    v_pk_mul_f32 v[204:205], v[204:205], v[20:21]
    v_pk_mul_f32 v[206:207], v[206:207], v[20:21]
    v_cvt_pk_bf16_f32 v132, v200, v201
    v_cvt_pk_bf16_f32 v133, v202, v203
    v_cvt_pk_bf16_f32 v134, v204, v205
    v_cvt_pk_bf16_f32 v135, v206, v207
    ds_write_b128 v19, v[132:135] offset:1024
    v_pk_mul_f32 v[208:209], v[208:209], v[20:21]
    v_pk_mul_f32 v[210:211], v[210:211], v[20:21]
    v_pk_mul_f32 v[212:213], v[212:213], v[20:21]
    v_pk_mul_f32 v[214:215], v[214:215], v[20:21]
    v_cvt_pk_bf16_f32 v136, v208, v209
    v_cvt_pk_bf16_f32 v137, v210, v211
    v_cvt_pk_bf16_f32 v138, v212, v213
    v_cvt_pk_bf16_f32 v139, v214, v215
    ds_write_b128 v19, v[136:139] offset:2048
    v_pk_mul_f32 v[216:217], v[216:217], v[20:21]
    v_pk_mul_f32 v[218:219], v[218:219], v[20:21]
    v_pk_mul_f32 v[220:221], v[220:221], v[20:21]
    v_pk_mul_f32 v[222:223], v[222:223], v[20:21]
    v_cvt_pk_bf16_f32 v140, v216, v217
    v_cvt_pk_bf16_f32 v141, v218, v219
    v_cvt_pk_bf16_f32 v142, v220, v221
    v_cvt_pk_bf16_f32 v143, v222, v223
    ds_write_b128 v19, v[140:143] offset:3072
    v_pk_mul_f32 v[224:225], v[224:225], v[20:21]
    v_pk_mul_f32 v[226:227], v[226:227], v[20:21]
    v_pk_mul_f32 v[228:229], v[228:229], v[20:21]
    v_pk_mul_f32 v[230:231], v[230:231], v[20:21]
    v_cvt_pk_bf16_f32 v144, v224, v225
    v_cvt_pk_bf16_f32 v145, v226, v227
    v_cvt_pk_bf16_f32 v146, v228, v229
    v_cvt_pk_bf16_f32 v147, v230, v231
    ds_write_b128 v19, v[144:147] offset:4096
    v_pk_mul_f32 v[232:233], v[232:233], v[20:21]
    v_pk_mul_f32 v[234:235], v[234:235], v[20:21]
    v_pk_mul_f32 v[236:237], v[236:237], v[20:21]
    v_pk_mul_f32 v[238:239], v[238:239], v[20:21]
    v_cvt_pk_bf16_f32 v148, v232, v233
    v_cvt_pk_bf16_f32 v149, v234, v235
    v_cvt_pk_bf16_f32 v150, v236, v237
    v_cvt_pk_bf16_f32 v151, v238, v239
    ds_write_b128 v19, v[148:151] offset:5120
    v_pk_mul_f32 v[240:241], v[240:241], v[20:21]
    v_pk_mul_f32 v[242:243], v[242:243], v[20:21]
    v_pk_mul_f32 v[244:245], v[244:245], v[20:21]
    v_pk_mul_f32 v[246:247], v[246:247], v[20:21]
    v_cvt_pk_bf16_f32 v152, v240, v241
    v_cvt_pk_bf16_f32 v153, v242, v243
    v_cvt_pk_bf16_f32 v154, v244, v245
    v_cvt_pk_bf16_f32 v155, v246, v247
    ds_write_b128 v19, v[152:155] offset:6144
    v_pk_mul_f32 v[248:249], v[248:249], v[20:21]
    v_pk_mul_f32 v[250:251], v[250:251], v[20:21]
    v_pk_mul_f32 v[252:253], v[252:253], v[20:21]
    v_pk_mul_f32 v[254:255], v[254:255], v[20:21]
    v_cvt_pk_bf16_f32 v156, v248, v249
    v_cvt_pk_bf16_f32 v157, v250, v251
    v_cvt_pk_bf16_f32 v158, v252, v253
    v_cvt_pk_bf16_f32 v159, v254, v255
    ds_write_b128 v19, v[156:159] offset:7168
    v_mov_b32 v2, v7
    v_and_b32 v21, 15, v1
    v_lshrrev_b32 v22, 4, v1
    v_lshlrev_b32 v22, 2, v22
    v_sub_u32 v18, v21, v22
    s_mov_b32 s40, 0
    s_mov_b32 s41, 0
    s_lshl_b32 s51, s30, 1
    s_add_u32 s51, s51, 1
    s_and_b32 s36, s28, 3
    s_lshl_b32 s36, s36, 5
    s_sub_u32 s37, 15, s30
    s_lshl_b32 s37, s37, 7
    s_add_u32 s36, s36, s37
    s_sub_u32 s50, 0, s36
    s_add_u32 s36, s51, 1
    s_lshl_b32 s36, -1, s36
    s_or_b32 s48, s36, 0xaaaaaaab
    s_and_b32 s48, s48, 0x7fff
    s_or_b32 s39, s36, 0x55555555
    s_and_b32 s39, s39, 0xffff
    s_add_u32 s46, s45, 65536
    s_add_u32 s47, s45, 98304
    s_mov_b64 s[52:53], 0
    s_mov_b32 s31, 0x3f803f80
    s_waitcnt lgkmcnt(0)
    s_barrier
    s_add_u32 s16, s54, 41943040
    s_addc_u32 s17, s55, 0
    s_and_b32 s17, s17, 0xffff
    s_mov_b32 s18, 16777216
    s_mov_b32 s19, 0x20000
    s_mov_b32 s4, s92
    s_and_b32 s5, s93, 0xffff
    s_mov_b32 s6, 7340032
    s_mov_b32 s7, 0x20000
    s_mov_b32 s8, s94
    s_and_b32 s9, s95, 0xffff
    s_mov_b32 s10, 7340032
    s_mov_b32 s11, 0x20000
    s_and_b32 s60, s29, 3
    s_add_u32 s60, s60, 4
    s_sub_u32 s3, s2, 32
    s_cmp_eq_u32 s28, 0
    s_cselect_b32 s36, 0xad, 0x2d
    s_cselect_b32 s42, 14, 12
    s_cmp_lt_u32 s3, 224
    s_cselect_b32 s36, s36, 0
    s_cselect_b32 s31, 9, 0
    s_lshl_b32 s31, s31, s60
    s_lshl_b32 s36, s36, s60
    s_or_b32 s42, s42, s36
    ds_read_b128 v[64:67], v2 offset:0
    ds_read_b128 v[68:71], v2 offset:1024
    ds_read_b128 v[72:75], v2 offset:2048
    ds_read_b128 v[76:79], v2 offset:3072
    ds_read_b128 v[80:83], v2 offset:4096
    ds_read_b128 v[84:87], v2 offset:5120
    ds_read_b128 v[88:91], v2 offset:6144
    ds_read_b128 v[92:95], v2 offset:7168
    s_waitcnt lgkmcnt(7)
    v_mfma_f32_16x16x32_bf16 v[96:99], v[64:67], v[128:131], 0
    v_mov_b64 v[192:193], 0
    v_mov_b64 v[194:195], 0
    v_mfma_f32_16x16x32_bf16 v[104:107], v[64:67], v[144:147], 0
    ds_read_b128 v[64:67], v2 offset:8192
    v_mov_b64 v[196:197], 0
    s_waitcnt lgkmcnt(7)
    v_mfma_f32_16x16x32_bf16 v[96:99], v[68:71], v[132:135], v[96:99]
    v_mov_b64 v[198:199], 0
    v_mfma_f32_16x16x32_bf16 v[104:107], v[68:71], v[148:151], v[104:107]
    ds_read_b128 v[68:71], v2 offset:9216
    v_mov_b64 v[200:201], 0
    s_waitcnt lgkmcnt(7)
    v_mfma_f32_16x16x32_bf16 v[96:99], v[72:75], v[136:139], v[96:99]
    v_mov_b64 v[202:203], 0
    v_mfma_f32_16x16x32_bf16 v[104:107], v[72:75], v[152:155], v[104:107]
    ds_read_b128 v[72:75], v2 offset:10240
    v_mov_b64 v[204:205], 0
    s_waitcnt lgkmcnt(7)
    v_mfma_f32_16x16x32_bf16 v[96:99], v[76:79], v[140:143], v[96:99]
    v_mov_b64 v[206:207], 0
    v_mfma_f32_16x16x32_bf16 v[104:107], v[76:79], v[156:159], v[104:107]
    ds_read_b128 v[76:79], v2 offset:11264
    v_mov_b64 v[208:209], 0
    s_waitcnt lgkmcnt(7)
    v_mfma_f32_16x16x32_bf16 v[100:103], v[80:83], v[128:131], 0
    v_mov_b64 v[210:211], 0
    v_mfma_f32_16x16x32_bf16 v[108:111], v[80:83], v[144:147], 0
    ds_read_b128 v[80:83], v2 offset:12288
    v_mov_b64 v[212:213], 0
    s_waitcnt lgkmcnt(7)
    v_mfma_f32_16x16x32_bf16 v[100:103], v[84:87], v[132:135], v[100:103]
    v_mov_b64 v[214:215], 0
    v_mfma_f32_16x16x32_bf16 v[108:111], v[84:87], v[148:151], v[108:111]
    ds_read_b128 v[84:87], v2 offset:13312
    v_mov_b64 v[216:217], 0
    s_waitcnt lgkmcnt(7)
    v_mfma_f32_16x16x32_bf16 v[100:103], v[88:91], v[136:139], v[100:103]
    v_mov_b64 v[218:219], 0
    v_mfma_f32_16x16x32_bf16 v[108:111], v[88:91], v[152:155], v[108:111]
    ds_read_b128 v[88:91], v2 offset:14336
    v_mov_b64 v[220:221], 0
    s_waitcnt lgkmcnt(7)
    v_mfma_f32_16x16x32_bf16 v[100:103], v[92:95], v[140:143], v[100:103]
    v_mov_b64 v[222:223], 0
    v_mfma_f32_16x16x32_bf16 v[108:111], v[92:95], v[156:159], v[108:111]
    ds_read_b128 v[92:95], v2 offset:15360
    v_mov_b64 v[224:225], 0
    s_waitcnt lgkmcnt(7)
    v_mfma_f32_16x16x32_bf16 v[112:115], v[64:67], v[128:131], 0
    v_mov_b64 v[226:227], 0
    v_mfma_f32_16x16x32_bf16 v[120:123], v[64:67], v[144:147], 0
    v_mov_b64 v[228:229], 0
    s_waitcnt lgkmcnt(6)
    v_mfma_f32_16x16x32_bf16 v[112:115], v[68:71], v[132:135], v[112:115]
    v_mov_b64 v[230:231], 0
    v_mfma_f32_16x16x32_bf16 v[120:123], v[68:71], v[148:151], v[120:123]
    v_mov_b64 v[232:233], 0
    s_waitcnt lgkmcnt(5)
    v_mfma_f32_16x16x32_bf16 v[112:115], v[72:75], v[136:139], v[112:115]
    v_mov_b64 v[234:235], 0
    v_mfma_f32_16x16x32_bf16 v[120:123], v[72:75], v[152:155], v[120:123]
    v_mov_b64 v[236:237], 0
    s_waitcnt lgkmcnt(4)
    v_mfma_f32_16x16x32_bf16 v[112:115], v[76:79], v[140:143], v[112:115]
    v_mov_b64 v[238:239], 0
    v_mfma_f32_16x16x32_bf16 v[120:123], v[76:79], v[156:159], v[120:123]
    v_mov_b64 v[240:241], 0
    s_waitcnt lgkmcnt(3)
    v_mfma_f32_16x16x32_bf16 v[116:119], v[80:83], v[128:131], 0
    v_mov_b64 v[242:243], 0
    v_mfma_f32_16x16x32_bf16 v[124:127], v[80:83], v[144:147], 0
    v_mov_b64 v[244:245], 0
    s_waitcnt lgkmcnt(2)
    v_mfma_f32_16x16x32_bf16 v[116:119], v[84:87], v[132:135], v[116:119]
    v_mov_b64 v[246:247], 0
    v_mfma_f32_16x16x32_bf16 v[124:127], v[84:87], v[148:151], v[124:127]
    v_mov_b64 v[248:249], 0
    s_waitcnt lgkmcnt(1)
    v_mfma_f32_16x16x32_bf16 v[116:119], v[88:91], v[136:139], v[116:119]
    v_mov_b64 v[250:251], 0
    v_mfma_f32_16x16x32_bf16 v[124:127], v[88:91], v[152:155], v[124:127]
    v_mov_b64 v[252:253], 0
    s_waitcnt lgkmcnt(0)
    v_mfma_f32_16x16x32_bf16 v[116:119], v[92:95], v[140:143], v[116:119]
    v_mov_b64 v[254:255], 0
    v_mfma_f32_16x16x32_bf16 v[124:127], v[92:95], v[156:159], v[124:127]
    v_mov_b64 v[38:39], 0
    s_cmp_lt_i32 s50, 0
    s_cbranch_scc0 L_recurrent_scan__compressed_kv_cla__moe_arch_mod__prompt_kernel_rare_65
L_recurrent_scan__compressed_kv_cla__moe_arch_mod__prompt_kernel_back_66:
    s_add_u32 s49, s50, 32
    v_add_u32 v24, 65536, v2
    s_cmp_le_u32 s40, s51
    s_cselect_b32 s36, 64, 128
    s_add_u32 s41, s41, s36
    s_add_u32 s50, s50, s36
    s_and_b32 s36, s41, 0xff
    v_lshl_add_u32 v2, s36, 8, v7
    s_cmp_eq_u32 s40, 16
    s_cselect_b64 s[20:21], -1, 0
    v_cndmask_b32 v5, v2, v24, s[20:21]
    v_mov_b32 v3, v24
    s_waitcnt vmcnt(0)
    s_barrier
    s_cmp_eq_u32 s28, 0
    s_cbranch_scc1 L_recurrent_scan__compressed_kv_cla__moe_arch_mod__prompt_kernel_rare_67
L_recurrent_scan__compressed_kv_cla__moe_arch_mod__prompt_kernel_back_68:
    ds_read_b128 v[64:67], v5 offset:0
    ds_read_b128 v[68:71], v5 offset:1024
    ds_read_b128 v[72:75], v5 offset:2048
    ds_read_b128 v[76:79], v5 offset:3072
    ds_read_b128 v[80:83], v5 offset:4096
    ds_read_b128 v[84:87], v5 offset:5120
    ds_read_b128 v[88:91], v5 offset:6144
    v_max3_f32 v21, v96, v97, v98
    v_max3_f32 v21, v21, v99, v100
    v_max3_f32 v21, v21, v101, v102
    v_max_f32 v21, v21, v103
    v_max3_f32 v22, v104, v105, v106
    v_max3_f32 v22, v22, v107, v108
    v_max3_f32 v22, v22, v109, v110
    v_max_f32 v22, v22, v111
    v_mov_b32 v23, v21
    s_nop 1
    v_permlane16_swap_b32 v21, v23
    s_nop 1
    v_max_f32 v21, v21, v23
    v_mov_b32 v23, v21
    s_nop 1
    v_permlane32_swap_b32 v21, v23
    s_nop 1
    v_max_f32 v21, v21, v23
    v_mov_b32 v23, v22
    s_nop 1
    v_permlane16_swap_b32 v22, v23
    s_nop 1
    v_max_f32 v22, v22, v23
    v_mov_b32 v23, v22
    s_nop 1
    v_permlane32_swap_b32 v22, v23
    s_nop 1
    v_max_f32 v22, v22, v23
    v_sub_f32 v40, 0, v21
    v_sub_f32 v41, 0, v21
    v_sub_f32 v42, 0, v21
    v_sub_f32 v43, 0, v21
    v_sub_f32 v44, 0, v22
    v_sub_f32 v45, 0, v22
    v_sub_f32 v46, 0, v22
    v_sub_f32 v47, 0, v22
    ds_write_b32 v19, v40
    ds_write_b32 v19, v44 offset:4
    v_pk_add_f32 v[96:97], v[96:97], v[40:41]
    v_pk_add_f32 v[98:99], v[98:99], v[40:41]
    v_pk_add_f32 v[100:101], v[100:101], v[40:41]
    v_pk_add_f32 v[102:103], v[102:103], v[40:41]
    v_pk_add_f32 v[104:105], v[104:105], v[44:45]
    v_pk_add_f32 v[106:107], v[106:107], v[44:45]
    v_pk_add_f32 v[108:109], v[108:109], v[44:45]
    v_pk_add_f32 v[110:111], v[110:111], v[44:45]
    v_pk_add_f32 v[112:113], v[112:113], v[40:41]
    v_pk_add_f32 v[114:115], v[114:115], v[40:41]
    v_pk_add_f32 v[116:117], v[116:117], v[40:41]
    v_pk_add_f32 v[118:119], v[118:119], v[40:41]
    v_pk_add_f32 v[120:121], v[120:121], v[44:45]
    v_pk_add_f32 v[122:123], v[122:123], v[44:45]
    v_pk_add_f32 v[124:125], v[124:125], v[44:45]
    v_pk_add_f32 v[126:127], v[126:127], v[44:45]
    v_exp_f32 v96, v96
    v_exp_f32 v97, v97
    v_add_f32 v38, v38, v96
    v_exp_f32 v98, v98
    v_add_f32 v38, v38, v97
    v_cvt_pk_bf16_f32 v48, v96, v97
    v_exp_f32 v99, v99
    v_add_f32 v38, v38, v98
    v_exp_f32 v104, v104
    v_add_f32 v38, v38, v99
    v_cvt_pk_bf16_f32 v49, v98, v99
    v_exp_f32 v105, v105
    v_add_f32 v39, v39, v104
    v_exp_f32 v106, v106
    v_add_f32 v39, v39, v105
    v_cvt_pk_bf16_f32 v52, v104, v105
    v_exp_f32 v107, v107
    v_add_f32 v39, v39, v106
    v_exp_f32 v100, v100
    v_add_f32 v39, v39, v107
    v_cvt_pk_bf16_f32 v53, v106, v107
    v_exp_f32 v101, v101
    v_add_f32 v38, v38, v100
    v_exp_f32 v102, v102
    v_add_f32 v38, v38, v101
    v_cvt_pk_bf16_f32 v50, v100, v101
    v_exp_f32 v103, v103
    v_add_f32 v38, v38, v102
    v_exp_f32 v108, v108
    v_add_f32 v38, v38, v103
    v_cvt_pk_bf16_f32 v51, v102, v103
    v_exp_f32 v109, v109
    v_add_f32 v39, v39, v108
    v_exp_f32 v110, v110
    v_add_f32 v39, v39, v109
    v_cvt_pk_bf16_f32 v54, v108, v109
    v_exp_f32 v111, v111
    v_add_f32 v39, v39, v110
    s_nop 0
    v_add_f32 v39, v39, v111
    v_cvt_pk_bf16_f32 v55, v110, v111
    .p2align 6
L_body0:
    s_cmp_lt_i32 s49, 0
    s_cbranch_scc0 L_recurrent_scan__compressed_kv_cla__moe_arch_mod__prompt_kernel_rare_69
L_recurrent_scan__compressed_kv_cla__moe_arch_mod__prompt_kernel_back_70:
    s_waitcnt lgkmcnt(3)
    v_mfma_f32_16x16x32_bf16 v[96:99], v[64:67], v[128:131], v[40:43]
    v_exp_f32 v112, v112
    v_mfma_f32_16x16x32_bf16 v[104:107], v[64:67], v[144:147], v[44:47]
    ds_read_b128 v[92:95], v2 offset:7168
    s_bitcmp1_b32 s48, s40
    s_cbranch_scc0 L_recurrent_scan__compressed_kv_cla__moe_arch_mod__prompt_kernel_nodma_89
    s_add_u32 m0, s43, 0
    s_nop 0
    buffer_load_dwordx4 v4, s[12:15], s46 offen offset:0 sc1 lds
    buffer_load_dwordx4 v4, s[12:15], s46 offen offset:1024 sc1 lds
L_recurrent_scan__compressed_kv_cla__moe_arch_mod__prompt_kernel_nodma_89:
    v_mfma_f32_16x16x32_bf16 v[96:99], v[68:71], v[132:135], v[96:99]
    v_exp_f32 v113, v113
    v_mfma_f32_16x16x32_bf16 v[104:107], v[68:71], v[148:151], v[104:107]
    ds_read_b128 v[64:67], v3 offset:0
    v_add_f32 v38, v38, v112
    v_mfma_f32_16x16x32_bf16 v[96:99], v[72:75], v[136:139], v[96:99]
    v_exp_f32 v114, v114
    v_mfma_f32_16x16x32_bf16 v[104:107], v[72:75], v[152:155], v[104:107]
    ds_read_b128 v[68:71], v3 offset:1024
    v_add_f32 v38, v38, v113
    v_cvt_pk_bf16_f32 v56, v112, v113
    s_bitcmp1_b32 s48, s40
    s_cbranch_scc0 L_recurrent_scan__compressed_kv_cla__moe_arch_mod__prompt_kernel_nodma_90
    s_add_u32 m0, s43, 0
    s_nop 0
    buffer_load_dwordx4 v4, s[12:15], s46 offen offset:2048 sc1 lds
    buffer_load_dwordx4 v4, s[12:15], s46 offen offset:3072 sc1 lds
L_recurrent_scan__compressed_kv_cla__moe_arch_mod__prompt_kernel_nodma_90:
    v_mfma_f32_16x16x32_bf16 v[96:99], v[76:79], v[140:143], v[96:99]
    v_exp_f32 v115, v115
    v_mfma_f32_16x16x32_bf16 v[104:107], v[76:79], v[156:159], v[104:107]
    ds_read_b128 v[72:75], v3 offset:2048
    v_add_f32 v38, v38, v114
    s_waitcnt lgkmcnt(3)
    v_mfma_f32_16x16x32_bf16 v[100:103], v[80:83], v[128:131], v[40:43]
    v_exp_f32 v120, v120
    v_mfma_f32_16x16x32_bf16 v[108:111], v[80:83], v[144:147], v[44:47]
    ds_read_b128 v[76:79], v3 offset:3072
    v_add_f32 v38, v38, v115
    v_cvt_pk_bf16_f32 v57, v114, v115
    s_bitcmp1_b32 s48, s40
    s_cbranch_scc0 L_recurrent_scan__compressed_kv_cla__moe_arch_mod__prompt_kernel_nodma_91
    s_add_u32 m0, s43, 4096
    s_nop 0
    buffer_load_dwordx4 v6, s[12:15], s46 offen offset:0 sc1 lds
    buffer_load_dwordx4 v6, s[12:15], s46 offen offset:1024 sc1 lds
L_recurrent_scan__compressed_kv_cla__moe_arch_mod__prompt_kernel_nodma_91:
    v_mfma_f32_16x16x32_bf16 v[100:103], v[84:87], v[132:135], v[100:103]
    v_exp_f32 v121, v121
    v_mfma_f32_16x16x32_bf16 v[108:111], v[84:87], v[148:151], v[108:111]
    ds_read_b128 v[80:83], v3 offset:4096
    v_add_f32 v39, v39, v120
    v_mfma_f32_16x16x32_bf16 v[100:103], v[88:91], v[136:139], v[100:103]
    v_exp_f32 v122, v122
    v_mfma_f32_16x16x32_bf16 v[108:111], v[88:91], v[152:155], v[108:111]
    ds_read_b128 v[84:87], v3 offset:5120
    v_add_f32 v39, v39, v121
    v_cvt_pk_bf16_f32 v60, v120, v121
    s_bitcmp1_b32 s48, s40
    s_cbranch_scc0 L_recurrent_scan__compressed_kv_cla__moe_arch_mod__prompt_kernel_nodma_92
    s_add_u32 m0, s43, 4096
    s_nop 0
    buffer_load_dwordx4 v6, s[12:15], s46 offen offset:2048 sc1 lds
    buffer_load_dwordx4 v6, s[12:15], s46 offen offset:3072 sc1 lds
    s_add_u32 s46, s46, 65536
    s_xor_b32 s43, s43, 32768
L_recurrent_scan__compressed_kv_cla__moe_arch_mod__prompt_kernel_nodma_92:
    v_mfma_f32_16x16x32_bf16 v[100:103], v[92:95], v[140:143], v[100:103]
    v_exp_f32 v123, v123
    v_mfma_f32_16x16x32_bf16 v[108:111], v[92:95], v[156:159], v[108:111]
    ds_read_b128 v[88:91], v3 offset:6144
    v_add_f32 v39, v39, v122
    s_waitcnt lgkmcnt(3)
    v_mfma_f32_16x16x32_bf16 v[192:195], v[64:67], v[48:51], v[192:195]
    v_exp_f32 v116, v116
    v_mfma_f32_16x16x32_bf16 v[224:227], v[64:67], v[52:55], v[224:227]
    ds_read_b128 v[92:95], v3 offset:7168
    v_add_f32 v39, v39, v123
    v_cvt_pk_bf16_f32 v61, v122, v123
    s_bitcmp1_b32 s39, s40
    s_cbranch_scc0 L_recurrent_scan__compressed_kv_cla__moe_arch_mod__prompt_kernel_nodma_93
    s_add_u32 m0, s44, 0
    s_nop 0
    buffer_load_dwordx4 v4, s[12:15], s47 offen offset:0 sc1 lds
    buffer_load_dwordx4 v4, s[12:15], s47 offen offset:1024 sc1 lds
L_recurrent_scan__compressed_kv_cla__moe_arch_mod__prompt_kernel_nodma_93:
    v_mfma_f32_16x16x32_bf16 v[196:199], v[68:71], v[48:51], v[196:199]
    v_exp_f32 v117, v117
    v_mfma_f32_16x16x32_bf16 v[228:231], v[68:71], v[52:55], v[228:231]
    ds_read_b128 v[64:67], v2 offset:8192
    v_add_f32 v38, v38, v116
    v_mfma_f32_16x16x32_bf16 v[200:203], v[72:75], v[48:51], v[200:203]
    v_exp_f32 v118, v118
    v_mfma_f32_16x16x32_bf16 v[232:235], v[72:75], v[52:55], v[232:235]
    ds_read_b128 v[68:71], v2 offset:9216
    v_add_f32 v38, v38, v117
    v_cvt_pk_bf16_f32 v58, v116, v117
    s_bitcmp1_b32 s39, s40
    s_cbranch_scc0 L_recurrent_scan__compressed_kv_cla__moe_arch_mod__prompt_kernel_nodma_94
    s_add_u32 m0, s44, 0
    s_nop 0
    buffer_load_dwordx4 v4, s[12:15], s47 offen offset:2048 sc1 lds
    buffer_load_dwordx4 v4, s[12:15], s47 offen offset:3072 sc1 lds
L_recurrent_scan__compressed_kv_cla__moe_arch_mod__prompt_kernel_nodma_94:
    v_mfma_f32_16x16x32_bf16 v[204:207], v[76:79], v[48:51], v[204:207]
    v_exp_f32 v119, v119
    v_mfma_f32_16x16x32_bf16 v[236:239], v[76:79], v[52:55], v[236:239]
    ds_read_b128 v[72:75], v2 offset:10240
    v_add_f32 v38, v38, v118
    s_waitcnt lgkmcnt(3)
    v_mfma_f32_16x16x32_bf16 v[208:211], v[80:83], v[48:51], v[208:211]
    v_exp_f32 v124, v124
    v_mfma_f32_16x16x32_bf16 v[240:243], v[80:83], v[52:55], v[240:243]
    ds_read_b128 v[76:79], v2 offset:11264
    v_add_f32 v38, v38, v119
    v_cvt_pk_bf16_f32 v59, v118, v119
    s_bitcmp1_b32 s39, s40
    s_cbranch_scc0 L_recurrent_scan__compressed_kv_cla__moe_arch_mod__prompt_kernel_nodma_95
    s_add_u32 m0, s44, 4096
    s_nop 0
    buffer_load_dwordx4 v6, s[12:15], s47 offen offset:0 sc1 lds
    buffer_load_dwordx4 v6, s[12:15], s47 offen offset:1024 sc1 lds
L_recurrent_scan__compressed_kv_cla__moe_arch_mod__prompt_kernel_nodma_95:
    v_mfma_f32_16x16x32_bf16 v[212:215], v[84:87], v[48:51], v[212:215]
    v_exp_f32 v125, v125
    v_mfma_f32_16x16x32_bf16 v[244:247], v[84:87], v[52:55], v[244:247]
    ds_read_b128 v[80:83], v2 offset:12288
    v_add_f32 v39, v39, v124
    v_mfma_f32_16x16x32_bf16 v[216:219], v[88:91], v[48:51], v[216:219]
    v_exp_f32 v126, v126
    v_mfma_f32_16x16x32_bf16 v[248:251], v[88:91], v[52:55], v[248:251]
    ds_read_b128 v[84:87], v2 offset:13312
    v_add_f32 v39, v39, v125
    v_cvt_pk_bf16_f32 v62, v124, v125
    s_bitcmp1_b32 s39, s40
    s_cbranch_scc0 L_recurrent_scan__compressed_kv_cla__moe_arch_mod__prompt_kernel_nodma_96
    s_add_u32 m0, s44, 4096
    s_nop 0
    buffer_load_dwordx4 v6, s[12:15], s47 offen offset:2048 sc1 lds
    buffer_load_dwordx4 v6, s[12:15], s47 offen offset:3072 sc1 lds
    s_add_u32 s47, s47, 65536
    s_xor_b32 s44, s44, 32768
L_recurrent_scan__compressed_kv_cla__moe_arch_mod__prompt_kernel_nodma_96:
    v_mfma_f32_16x16x32_bf16 v[220:223], v[92:95], v[48:51], v[220:223]
    v_exp_f32 v127, v127
    v_mfma_f32_16x16x32_bf16 v[252:255], v[92:95], v[52:55], v[252:255]
    ds_read_b128 v[88:91], v2 offset:14336
    v_add_f32 v39, v39, v126
    v_add_f32 v39, v39, v127
    v_cvt_pk_bf16_f32 v63, v126, v127
    s_cmp_lt_i32 s50, 0
    s_cbranch_scc0 L_recurrent_scan__compressed_kv_cla__moe_arch_mod__prompt_kernel_rare_71
L_recurrent_scan__compressed_kv_cla__moe_arch_mod__prompt_kernel_back_72:
    s_waitcnt lgkmcnt(3)
    v_mfma_f32_16x16x32_bf16 v[112:115], v[64:67], v[128:131], v[40:43]
    v_exp_f32 v96, v96
    v_mfma_f32_16x16x32_bf16 v[120:123], v[64:67], v[144:147], v[44:47]
    ds_read_b128 v[92:95], v2 offset:15360
    v_mfma_f32_16x16x32_bf16 v[112:115], v[68:71], v[132:135], v[112:115]
    v_exp_f32 v97, v97
    s_add_u32 s40, s40, 1
    v_mfma_f32_16x16x32_bf16 v[120:123], v[68:71], v[148:151], v[120:123]
    ds_read_b128 v[64:67], v3 offset:8192
    v_add_f32 v38, v38, v96
    s_add_u32 s49, s50, 32
    v_add_u32 v24, 65536, v2
    v_mfma_f32_16x16x32_bf16 v[112:115], v[72:75], v[136:139], v[112:115]
    v_exp_f32 v98, v98
    v_mfma_f32_16x16x32_bf16 v[120:123], v[72:75], v[152:155], v[120:123]
    ds_read_b128 v[68:71], v3 offset:9216
    v_add_f32 v38, v38, v97
    v_cvt_pk_bf16_f32 v48, v96, v97
    s_cmp_le_u32 s40, s51
    s_cselect_b32 s36, 64, 128
    v_mfma_f32_16x16x32_bf16 v[112:115], v[76:79], v[140:143], v[112:115]
    v_exp_f32 v99, v99
    v_mfma_f32_16x16x32_bf16 v[120:123], v[76:79], v[156:159], v[120:123]
    ds_read_b128 v[72:75], v3 offset:10240
    v_add_f32 v38, v38, v98
    s_add_u32 s41, s41, s36
    s_add_u32 s50, s50, s36
    s_waitcnt lgkmcnt(3)
    v_mfma_f32_16x16x32_bf16 v[116:119], v[80:83], v[128:131], v[40:43]
    v_exp_f32 v104, v104
    v_mfma_f32_16x16x32_bf16 v[124:127], v[80:83], v[144:147], v[44:47]
    ds_read_b128 v[76:79], v3 offset:11264
    v_add_f32 v38, v38, v99
    v_cvt_pk_bf16_f32 v49, v98, v99
    s_and_b32 s36, s41, 0xff
    v_lshl_add_u32 v2, s36, 8, v7
    v_mfma_f32_16x16x32_bf16 v[116:119], v[84:87], v[132:135], v[116:119]
    v_exp_f32 v105, v105
    v_mfma_f32_16x16x32_bf16 v[124:127], v[84:87], v[148:151], v[124:127]
    ds_read_b128 v[80:83], v3 offset:12288
    v_add_f32 v39, v39, v104
    s_cmp_eq_u32 s40, 16
    s_cselect_b64 s[20:21], -1, 0
    v_mfma_f32_16x16x32_bf16 v[116:119], v[88:91], v[136:139], v[116:119]
    v_exp_f32 v106, v106
    v_mfma_f32_16x16x32_bf16 v[124:127], v[88:91], v[152:155], v[124:127]
    ds_read_b128 v[84:87], v3 offset:13312
    v_add_f32 v39, v39, v105
    v_cvt_pk_bf16_f32 v52, v104, v105
    v_cndmask_b32 v5, v2, v24, s[20:21]
    v_mfma_f32_16x16x32_bf16 v[116:119], v[92:95], v[140:143], v[116:119]
    v_exp_f32 v107, v107
    v_mfma_f32_16x16x32_bf16 v[124:127], v[92:95], v[156:159], v[124:127]
    ds_read_b128 v[88:91], v3 offset:14336
    v_add_f32 v39, v39, v106
    s_waitcnt lgkmcnt(3)
    v_mfma_f32_16x16x32_bf16 v[192:195], v[64:67], v[56:59], v[192:195]
    v_exp_f32 v100, v100
    v_mfma_f32_16x16x32_bf16 v[224:227], v[64:67], v[60:63], v[224:227]
    ds_read_b128 v[92:95], v3 offset:15360
    v_add_f32 v39, v39, v107
    v_cvt_pk_bf16_f32 v53, v106, v107
    v_mfma_f32_16x16x32_bf16 v[196:199], v[68:71], v[56:59], v[196:199]
    v_exp_f32 v101, v101
    v_mfma_f32_16x16x32_bf16 v[228:231], v[68:71], v[60:63], v[228:231]
    v_add_f32 v38, v38, v100
    v_mov_b32 v3, v24
    v_mfma_f32_16x16x32_bf16 v[200:203], v[72:75], v[56:59], v[200:203]
    v_exp_f32 v102, v102
    v_mfma_f32_16x16x32_bf16 v[232:235], v[72:75], v[60:63], v[232:235]
    v_add_f32 v38, v38, v101
    v_cvt_pk_bf16_f32 v50, v100, v101
    s_waitcnt vmcnt(8) lgkmcnt(0)
    s_cmp_le_u32 s40, s51
    s_cbranch_scc1 L_recurrent_scan__compressed_kv_cla__moe_arch_mod__prompt_kernel_rlx_73
    s_waitcnt vmcnt(0)
L_recurrent_scan__compressed_kv_cla__moe_arch_mod__prompt_kernel_rlx_73:
    s_bitcmp1_b32 s42, s40
    s_cbranch_scc1 L_recurrent_scan__compressed_kv_cla__moe_arch_mod__prompt_kernel_rare_87
L_recurrent_scan__compressed_kv_cla__moe_arch_mod__prompt_kernel_back_88:
    s_barrier
    v_mfma_f32_16x16x32_bf16 v[204:207], v[76:79], v[56:59], v[204:207]
    v_exp_f32 v103, v103
    v_mfma_f32_16x16x32_bf16 v[236:239], v[76:79], v[60:63], v[236:239]
    ds_read_b128 v[68:71], v5 offset:1024
    ds_read_b128 v[64:67], v5 offset:0
    v_add_f32 v38, v38, v102
    v_mfma_f32_16x16x32_bf16 v[208:211], v[80:83], v[56:59], v[208:211]
    v_exp_f32 v108, v108
    v_mfma_f32_16x16x32_bf16 v[240:243], v[80:83], v[60:63], v[240:243]
    ds_read_b128 v[76:79], v5 offset:3072
    ds_read_b128 v[72:75], v5 offset:2048
    v_add_f32 v38, v38, v103
    v_cvt_pk_bf16_f32 v51, v102, v103
    v_mfma_f32_16x16x32_bf16 v[212:215], v[84:87], v[56:59], v[212:215]
    v_exp_f32 v109, v109
    v_mfma_f32_16x16x32_bf16 v[244:247], v[84:87], v[60:63], v[244:247]
    ds_read_b128 v[80:83], v5 offset:4096
    v_add_f32 v39, v39, v108
    v_mfma_f32_16x16x32_bf16 v[216:219], v[88:91], v[56:59], v[216:219]
    v_exp_f32 v110, v110
    v_mfma_f32_16x16x32_bf16 v[248:251], v[88:91], v[60:63], v[248:251]
    ds_read_b128 v[84:87], v5 offset:5120
    v_add_f32 v39, v39, v109
    v_cvt_pk_bf16_f32 v54, v108, v109
    v_mfma_f32_16x16x32_bf16 v[220:223], v[92:95], v[56:59], v[220:223]
    v_exp_f32 v111, v111
    v_mfma_f32_16x16x32_bf16 v[252:255], v[92:95], v[60:63], v[252:255]
    ds_read_b128 v[88:91], v5 offset:6144
    v_add_f32 v39, v39, v110
    v_add_f32 v39, v39, v111
    v_cvt_pk_bf16_f32 v55, v110, v111
    s_cmp_lg_u32 s40, 16
    s_cbranch_scc1 L_body0
    s_mov_b32 s4, s34
    s_and_b32 s5, s35, 0xffff
    s_mov_b32 s6, 7340032
    s_mov_b32 s7, 0x20000
    s_mov_b32 s8, s32
    s_and_b32 s9, s33, 0xffff
    s_mov_b32 s10, 8388608
    s_mov_b32 s11, 0x20000
    s_lshr_b32 s38, s2, 4
    s_mul_i32 s38, s38, 224
    s_and_b32 s39, s2, 15
    s_lshl_b32 s39, s39, 7
    v_lshrrev_b32 v27, 3, v1
    s_lshl_b32 s36, s28, 5
    s_add_u32 s36, s36, s38
    v_add_u32 v27, s36, v27
    v_mul_u32_u24 v27, 2048, v27
    v_add_u32 v27, s39, v27
    v_bfe_u32 v28, v1, 4, 1
    v_lshlrev_b32 v28, 1, v28
    v_and_b32 v29, 7, v1
    v_xor_b32 v28, v28, v29
    v_lshl_add_u32 v26, v28, 4, v27
    v_xor_b32 v28, 4, v28
    v_lshl_add_u32 v27, v28, 4, v27
    v_add_u32 v27, 15360, v27
    v_add_u32 v28, 30720, v26
    v_add_u32 v29, 30720, v27
    s_lshl_b32 s36, s28, 12
    s_add_u32 s36, s36, 131072
    s_cmp_lt_u32 s28, 7
    s_cselect_b32 m0, s36, 0x30000
    s_cselect_b32 s6, 7340032, 0
    buffer_load_dwordx4 v26, s[4:7], 0 offen offset:0 lds
    buffer_load_dwordx4 v27, s[4:7], 0 offen offset:1024 lds
    buffer_load_dwordx4 v28, s[4:7], 0 offen offset:2048 lds
    buffer_load_dwordx4 v29, s[4:7], 0 offen offset:3072 lds
    s_lshr_b32 s36, s2, 5
    s_add_u32 s36, s36, 48
    s_lshl_b32 s36, s36, 7
    v_mov_b32 v12, s36
    global_load_dword v11, v12, s[90:91] sc1
    s_cmp_lt_i32 s49, 0
    s_cbranch_scc0 L_recurrent_scan__compressed_kv_cla__moe_arch_mod__prompt_kernel_rare_97
L_recurrent_scan__compressed_kv_cla__moe_arch_mod__prompt_kernel_back_98:
    s_waitcnt lgkmcnt(5)
    v_mfma_f32_16x16x32_bf16 v[192:195], v[64:67], v[48:51], v[192:195]
    v_exp_f32 v112, v112
    v_mfma_f32_16x16x32_bf16 v[224:227], v[64:67], v[52:55], v[224:227]
    ds_read_b128 v[92:95], v3 offset:7168
    v_add_f32 v38, v38, v112
    v_exp_f32 v113, v113
    v_mfma_f32_16x16x32_bf16 v[196:199], v[68:71], v[48:51], v[196:199]
    v_add_f32 v38, v38, v113
    v_cvt_pk_bf16_f32 v56, v112, v113
    v_exp_f32 v114, v114
    v_mfma_f32_16x16x32_bf16 v[228:231], v[68:71], v[52:55], v[228:231]
    ds_read_b128 v[64:67], v3 offset:8192
    v_add_f32 v38, v38, v114
    v_exp_f32 v115, v115
    s_waitcnt lgkmcnt(5)
    v_mfma_f32_16x16x32_bf16 v[200:203], v[72:75], v[48:51], v[200:203]
    v_add_f32 v38, v38, v115
    v_cvt_pk_bf16_f32 v57, v114, v115
    v_exp_f32 v120, v120
    v_mfma_f32_16x16x32_bf16 v[232:235], v[72:75], v[52:55], v[232:235]
    ds_read_b128 v[68:71], v3 offset:9216
    v_add_f32 v39, v39, v120
    v_exp_f32 v121, v121
    v_mfma_f32_16x16x32_bf16 v[204:207], v[76:79], v[48:51], v[204:207]
    v_add_f32 v39, v39, v121
    v_cvt_pk_bf16_f32 v60, v120, v121
    v_exp_f32 v122, v122
    v_mfma_f32_16x16x32_bf16 v[236:239], v[76:79], v[52:55], v[236:239]
    ds_read_b128 v[72:75], v3 offset:10240
    v_add_f32 v39, v39, v122
    v_exp_f32 v123, v123
    s_waitcnt lgkmcnt(6)
    v_mfma_f32_16x16x32_bf16 v[208:211], v[80:83], v[48:51], v[208:211]
    v_add_f32 v39, v39, v123
    v_cvt_pk_bf16_f32 v61, v122, v123
    v_exp_f32 v116, v116
    v_mfma_f32_16x16x32_bf16 v[240:243], v[80:83], v[52:55], v[240:243]
    ds_read_b128 v[76:79], v3 offset:11264
    v_add_f32 v38, v38, v116
    v_exp_f32 v117, v117
    s_waitcnt lgkmcnt(6)
    v_mfma_f32_16x16x32_bf16 v[212:215], v[84:87], v[48:51], v[212:215]
    v_add_f32 v38, v38, v117
    v_cvt_pk_bf16_f32 v58, v116, v117
    v_exp_f32 v118, v118
    v_mfma_f32_16x16x32_bf16 v[244:247], v[84:87], v[52:55], v[244:247]
    ds_read_b128 v[80:83], v3 offset:12288
    v_add_f32 v38, v38, v118
    v_exp_f32 v119, v119
    s_waitcnt lgkmcnt(6)
    v_mfma_f32_16x16x32_bf16 v[216:219], v[88:91], v[48:51], v[216:219]
    v_add_f32 v38, v38, v119
    v_cvt_pk_bf16_f32 v59, v118, v119
    v_exp_f32 v124, v124
    v_mfma_f32_16x16x32_bf16 v[248:251], v[88:91], v[52:55], v[248:251]
    ds_read_b128 v[84:87], v3 offset:13312
    v_add_f32 v39, v39, v124
    v_exp_f32 v125, v125
    s_waitcnt lgkmcnt(6)
    v_mfma_f32_16x16x32_bf16 v[220:223], v[92:95], v[48:51], v[220:223]
    v_add_f32 v39, v39, v125
    v_cvt_pk_bf16_f32 v62, v124, v125
    v_exp_f32 v126, v126
    v_mfma_f32_16x16x32_bf16 v[252:255], v[92:95], v[52:55], v[252:255]
    ds_read_b128 v[88:91], v3 offset:14336
    v_add_f32 v39, v39, v126
    v_exp_f32 v127, v127
    s_nop 0
    v_add_f32 v39, v39, v127
    v_cvt_pk_bf16_f32 v63, v126, v127
    s_nop 1
    s_waitcnt lgkmcnt(6)
    v_mfma_f32_16x16x32_bf16 v[192:195], v[64:67], v[56:59], v[192:195]
    v_mfma_f32_16x16x32_bf16 v[224:227], v[64:67], v[60:63], v[224:227]
    ds_read_b128 v[92:95], v3 offset:15360
    s_waitcnt lgkmcnt(6)
    v_mfma_f32_16x16x32_bf16 v[196:199], v[68:71], v[56:59], v[196:199]
    v_mfma_f32_16x16x32_bf16 v[228:231], v[68:71], v[60:63], v[228:231]
    s_waitcnt lgkmcnt(5)
    v_mfma_f32_16x16x32_bf16 v[200:203], v[72:75], v[56:59], v[200:203]
    v_mfma_f32_16x16x32_bf16 v[232:235], v[72:75], v[60:63], v[232:235]
    s_waitcnt lgkmcnt(4)
    v_mfma_f32_16x16x32_bf16 v[204:207], v[76:79], v[56:59], v[204:207]
    v_mfma_f32_16x16x32_bf16 v[236:239], v[76:79], v[60:63], v[236:239]
    s_waitcnt lgkmcnt(3)
    v_mfma_f32_16x16x32_bf16 v[208:211], v[80:83], v[56:59], v[208:211]
    v_mfma_f32_16x16x32_bf16 v[240:243], v[80:83], v[60:63], v[240:243]
    s_waitcnt lgkmcnt(2)
    v_mfma_f32_16x16x32_bf16 v[212:215], v[84:87], v[56:59], v[212:215]
    v_mfma_f32_16x16x32_bf16 v[244:247], v[84:87], v[60:63], v[244:247]
    s_waitcnt lgkmcnt(1)
    v_mfma_f32_16x16x32_bf16 v[216:219], v[88:91], v[56:59], v[216:219]
    v_mfma_f32_16x16x32_bf16 v[248:251], v[88:91], v[60:63], v[248:251]
    s_waitcnt lgkmcnt(0)
    v_mfma_f32_16x16x32_bf16 v[220:223], v[92:95], v[56:59], v[220:223]
    v_mfma_f32_16x16x32_bf16 v[252:255], v[92:95], v[60:63], v[252:255]
    s_waitcnt vmcnt(0)
    v_readfirstlane_b32 s36, v11
    s_nop 0
    s_cmp_lt_u32 s36, 28
    s_cbranch_scc1 L_recurrent_scan__compressed_kv_cla__moe_arch_mod__prompt_kernel_rare_101
L_recurrent_scan__compressed_kv_cla__moe_arch_mod__prompt_kernel_back_102:
    s_lshr_b32 s36, s2, 4
    s_mul_i32 s36, s36, 7
    s_min_u32 s37, s28, 6
    s_add_u32 s36, s36, s37
    s_lshl_b32 s36, s36, 11
    s_add_u32 s36, s36, 58720256
    v_and_b32 v11, 15, v1
    v_lshlrev_b32 v11, 4, v11
    v_lshrrev_b32 v12, 4, v1
    v_lshl_add_u32 v11, v12, 9, v11
    buffer_load_dwordx4 v[96:99], v11, s[24:27], s36 offen offset:0 sc1
    buffer_load_dwordx4 v[100:103], v11, s[24:27], s36 offen offset:256 sc1
    s_lshl_b32 s37, s28, 13
    v_add_u32 v21, s37, v7
    v_xor_b32 v22, 32768, v21
    s_lshl_b32 s37, s28, 8
    s_add_u32 s37, s37, 159744
    v_lshl_add_u32 v23, v1, 2, s37
    v_xor_b32 v24, 1024, v23
    ds_write_b32 v23, v39
    s_mov_b32 s36, 0x5d800000
    v_cmp_nge_f32 vcc, s36, v38
    s_nop 0
    s_or_b64 s[52:53], s[52:53], vcc
    v_cmp_nge_f32 vcc, s36, v39
    s_nop 0
    s_or_b64 s[52:53], s[52:53], vcc
    s_or_b32 s36, s52, s53
    v_mov_b32 v26, s36
    s_lshl_b32 s37, s28, 2
    s_add_u32 s37, s37, 161792
    v_mov_b32 v27, s37
    ds_write_b32 v27, v26
    ds_write_b128 v21, v[224:227] offset:0
    ds_write_b128 v21, v[228:231] offset:1024
    ds_write_b128 v21, v[232:235] offset:2048
    ds_write_b128 v21, v[236:239] offset:3072
    ds_write_b128 v21, v[240:243] offset:4096
    ds_write_b128 v21, v[244:247] offset:5120
    ds_write_b128 v21, v[248:251] offset:6144
    ds_write_b128 v21, v[252:255] offset:7168
    v_mov_b32 v28, 161856
    v_mov_b32 v30, s56
    v_mov_b32 v31, s57
    v_mov_b32 v32, s58
    v_mov_b32 v33, s59
    ds_write_b128 v28, v[30:33]
    v_and_b32 v27, 7, v1
    v_lshlrev_b32 v27, 2, v27
    v_add_u32 v27, 161792, v27
    s_sub_u32 s36, 15, s30
    s_lshl_b32 s38, s36, 3
    s_and_b32 s37, s28, 3
    s_lshl_b32 s37, s37, 1
    s_add_u32 s38, s38, s37
    s_lshl_b32 s38, s38, 17
    s_lshl_b32 s37, s29, 12
    s_add_u32 s38, s38, s37
    s_waitcnt lgkmcnt(0)
    s_barrier
    ds_read_b32 v26, v27
    ds_read_b32 v25, v24
    ds_read_b128 v[64:67], v22 offset:0
    ds_read_b128 v[68:71], v22 offset:1024
    ds_read_b128 v[72:75], v22 offset:2048
    ds_read_b128 v[76:79], v22 offset:3072
    ds_read_b128 v[80:83], v22 offset:4096
    ds_read_b128 v[84:87], v22 offset:5120
    ds_read_b128 v[88:91], v22 offset:6144
    ds_read_b128 v[92:95], v22 offset:7168
    s_waitcnt lgkmcnt(8)
    v_add_f32 v25, v25, v38
    v_mov_b32 v20, v25
    s_nop 1
    v_permlane16_swap_b32 v25, v20
    s_nop 1
    v_add_f32 v25, v25, v20
    v_mov_b32 v20, v25
    s_nop 1
    v_permlane32_swap_b32 v25, v20
    s_nop 1
    v_add_f32 v25, v25, v20
    v_cmp_ne_u32 s[52:53], 0, v26
    v_rcp_f32 v25, v25
    s_nop 0
    v_mov_b32 v24, v25
    s_waitcnt lgkmcnt(6)
    v_pk_add_f32 v[192:193], v[192:193], v[64:65]
    v_pk_add_f32 v[194:195], v[194:195], v[66:67]
    v_pk_add_f32 v[196:197], v[196:197], v[68:69]
    v_pk_add_f32 v[198:199], v[198:199], v[70:71]
    v_pk_mul_f32 v[192:193], v[192:193], v[24:25]
    v_pk_mul_f32 v[194:195], v[194:195], v[24:25]
    v_pk_mul_f32 v[196:197], v[196:197], v[24:25]
    v_pk_mul_f32 v[198:199], v[198:199], v[24:25]
    v_cvt_pk_bf16_f32 v48, v192, v193
    v_cvt_pk_bf16_f32 v49, v194, v195
    v_cvt_pk_bf16_f32 v50, v196, v197
    v_cvt_pk_bf16_f32 v51, v198, v199
    buffer_store_dwordx4 v[48:51], v7, s[16:19], s38 offen offset:0 sc1
    s_waitcnt lgkmcnt(4)
    v_pk_add_f32 v[200:201], v[200:201], v[72:73]
    v_pk_add_f32 v[202:203], v[202:203], v[74:75]
    v_pk_add_f32 v[204:205], v[204:205], v[76:77]
    v_pk_add_f32 v[206:207], v[206:207], v[78:79]
    v_pk_mul_f32 v[200:201], v[200:201], v[24:25]
    v_pk_mul_f32 v[202:203], v[202:203], v[24:25]
    v_pk_mul_f32 v[204:205], v[204:205], v[24:25]
    v_pk_mul_f32 v[206:207], v[206:207], v[24:25]
    v_cvt_pk_bf16_f32 v52, v200, v201
    v_cvt_pk_bf16_f32 v53, v202, v203
    v_cvt_pk_bf16_f32 v54, v204, v205
    v_cvt_pk_bf16_f32 v55, v206, v207
    buffer_store_dwordx4 v[52:55], v7, s[16:19], s38 offen offset:1024 sc1
    s_waitcnt lgkmcnt(2)
    v_pk_add_f32 v[208:209], v[208:209], v[80:81]
    v_pk_add_f32 v[210:211], v[210:211], v[82:83]
    v_pk_add_f32 v[212:213], v[212:213], v[84:85]
    v_pk_add_f32 v[214:215], v[214:215], v[86:87]
    v_pk_mul_f32 v[208:209], v[208:209], v[24:25]
    v_pk_mul_f32 v[210:211], v[210:211], v[24:25]
    v_pk_mul_f32 v[212:213], v[212:213], v[24:25]
    v_pk_mul_f32 v[214:215], v[214:215], v[24:25]
    v_cvt_pk_bf16_f32 v56, v208, v209
    v_cvt_pk_bf16_f32 v57, v210, v211
    v_cvt_pk_bf16_f32 v58, v212, v213
    v_cvt_pk_bf16_f32 v59, v214, v215
    buffer_store_dwordx4 v[56:59], v7, s[16:19], s38 offen offset:2048 sc1
    s_waitcnt lgkmcnt(0)
    v_pk_add_f32 v[216:217], v[216:217], v[88:89]
    v_pk_add_f32 v[218:219], v[218:219], v[90:91]
    v_pk_add_f32 v[220:221], v[220:221], v[92:93]
    v_pk_add_f32 v[222:223], v[222:223], v[94:95]
    v_pk_mul_f32 v[216:217], v[216:217], v[24:25]
    v_pk_mul_f32 v[218:219], v[218:219], v[24:25]
    v_pk_mul_f32 v[220:221], v[220:221], v[24:25]
    v_pk_mul_f32 v[222:223], v[222:223], v[24:25]
    v_cvt_pk_bf16_f32 v60, v216, v217
    v_cvt_pk_bf16_f32 v61, v218, v219
    v_cvt_pk_bf16_f32 v62, v220, v221
    v_cvt_pk_bf16_f32 v63, v222, v223
    buffer_store_dwordx4 v[60:63], v7, s[16:19], s38 offen offset:3072 sc1
    s_cmp_eq_u64 s[52:53], 0
    s_cbranch_scc1 L_p3_done
    s_waitcnt vmcnt(0)
    v_mov_b32 v112, v96
    v_mov_b32 v113, v97
    v_mov_b32 v114, v98
    v_mov_b32 v115, v99
    v_mov_b32 v116, v100
    v_mov_b32 v117, v101
    v_mov_b32 v118, v102
    v_mov_b32 v119, v103
    v_mov_b32 v192, 0
    v_mov_b32 v193, 0
    v_mov_b32 v194, 0
    v_mov_b32 v195, 0
    v_mov_b32 v196, 0
    v_mov_b32 v197, 0
    v_mov_b32 v198, 0
    v_mov_b32 v199, 0
    v_mov_b32 v200, 0
    v_mov_b32 v201, 0
    v_mov_b32 v202, 0
    v_mov_b32 v203, 0
    v_mov_b32 v204, 0
    v_mov_b32 v205, 0
    v_mov_b32 v206, 0
    v_mov_b32 v207, 0
    v_mov_b32 v208, 0
    v_mov_b32 v209, 0
    v_mov_b32 v210, 0
    v_mov_b32 v211, 0
    v_mov_b32 v212, 0
    v_mov_b32 v213, 0
    v_mov_b32 v214, 0
    v_mov_b32 v215, 0
    v_mov_b32 v216, 0
    v_mov_b32 v217, 0
    v_mov_b32 v218, 0
    v_mov_b32 v219, 0
    v_mov_b32 v220, 0
    v_mov_b32 v221, 0
    v_mov_b32 v222, 0
    v_mov_b32 v223, 0
    v_mov_b32 v224, 0
    v_mov_b32 v225, 0
    v_mov_b32 v226, 0
    v_mov_b32 v227, 0
    v_mov_b32 v228, 0
    v_mov_b32 v229, 0
    v_mov_b32 v230, 0
    v_mov_b32 v231, 0
    v_mov_b32 v232, 0
    v_mov_b32 v233, 0
    v_mov_b32 v234, 0
    v_mov_b32 v235, 0
    v_mov_b32 v236, 0
    v_mov_b32 v237, 0
    v_mov_b32 v238, 0
    v_mov_b32 v239, 0
    v_mov_b32 v240, 0
    v_mov_b32 v241, 0
    v_mov_b32 v242, 0
    v_mov_b32 v243, 0
    v_mov_b32 v244, 0
    v_mov_b32 v245, 0
    v_mov_b32 v246, 0
    v_mov_b32 v247, 0
    v_mov_b32 v248, 0
    v_mov_b32 v249, 0
    v_mov_b32 v250, 0
    v_mov_b32 v251, 0
    v_mov_b32 v252, 0
    v_mov_b32 v253, 0
    v_mov_b32 v254, 0
    v_mov_b32 v255, 0
    v_mov_b32 v38, 0
    v_mov_b32 v40, 4048155338
    v_mov_b32 v39, 0
    v_mov_b32 v41, 4048155338
    s_lshl_b32 s43, s28, 12
    v_add_u32 v4, s43, v7
    s_mov_b32 s46, s45
    s_sub_u32 s40, 16, s30
    s_sub_u32 s39, 15, s30
    s_lshl_b32 s37, s39, 7
    s_and_b32 s36, s28, 3
    s_lshl_b32 s36, s36, 5
    s_add_u32 s36, s36, s37
    s_sub_u32 s50, 0, s36
L_recurrent_scan__compressed_kv_cla__moe_arch_mod__prompt_kernel_stile_103:
    s_waitcnt vmcnt(0) lgkmcnt(0)
    s_barrier
    s_mov_b32 m0, s43
    s_add_u32 s47, s46, 32768
    buffer_load_dwordx4 v4, s[12:15], s46 offen offset:0 sc1 lds
    buffer_load_dwordx4 v4, s[12:15], s46 offen offset:1024 sc1 lds
    buffer_load_dwordx4 v4, s[12:15], s46 offen offset:2048 sc1 lds
    buffer_load_dwordx4 v4, s[12:15], s46 offen offset:3072 sc1 lds
    s_add_u32 m0, s43, 32768
    s_add_u32 s46, s46, 65536
    buffer_load_dwordx4 v4, s[12:15], s47 offen offset:0 sc1 lds
    buffer_load_dwordx4 v4, s[12:15], s47 offen offset:1024 sc1 lds
    buffer_load_dwordx4 v4, s[12:15], s47 offen offset:2048 sc1 lds
    buffer_load_dwordx4 v4, s[12:15], s47 offen offset:3072 sc1 lds
    v_mov_b32 v2, v7
    s_mov_b32 s41, 4
    s_waitcnt vmcnt(0)
    s_barrier
L_recurrent_scan__compressed_kv_cla__moe_arch_mod__prompt_kernel_sunit_104:
    s_cmp_gt_i32 s50, 0
    s_cbranch_scc1 L_recurrent_scan__compressed_kv_cla__moe_arch_mod__prompt_kernel_snext_105
    ds_read_b128 v[64:67], v2 offset:0
    ds_read_b128 v[68:71], v2 offset:1024
    ds_read_b128 v[72:75], v2 offset:2048
    ds_read_b128 v[76:79], v2 offset:3072
    ds_read_b128 v[80:83], v2 offset:4096
    ds_read_b128 v[84:87], v2 offset:5120
    ds_read_b128 v[88:91], v2 offset:6144
    ds_read_b128 v[92:95], v2 offset:7168
    s_waitcnt lgkmcnt(0)
    v_mfma_f32_16x16x32_bf16 v[96:99], v[64:67], v[128:131], 0
    v_mfma_f32_16x16x32_bf16 v[104:107], v[64:67], v[144:147], 0
    v_mfma_f32_16x16x32_bf16 v[96:99], v[68:71], v[132:135], v[96:99]
    v_mfma_f32_16x16x32_bf16 v[104:107], v[68:71], v[148:151], v[104:107]
    v_mfma_f32_16x16x32_bf16 v[96:99], v[72:75], v[136:139], v[96:99]
    v_mfma_f32_16x16x32_bf16 v[104:107], v[72:75], v[152:155], v[104:107]
    v_mfma_f32_16x16x32_bf16 v[96:99], v[76:79], v[140:143], v[96:99]
    v_mfma_f32_16x16x32_bf16 v[104:107], v[76:79], v[156:159], v[104:107]
    v_mfma_f32_16x16x32_bf16 v[100:103], v[80:83], v[128:131], 0
    v_mfma_f32_16x16x32_bf16 v[108:111], v[80:83], v[144:147], 0
    v_mfma_f32_16x16x32_bf16 v[100:103], v[84:87], v[132:135], v[100:103]
    v_mfma_f32_16x16x32_bf16 v[108:111], v[84:87], v[148:151], v[108:111]
    v_mfma_f32_16x16x32_bf16 v[100:103], v[88:91], v[136:139], v[100:103]
    v_mfma_f32_16x16x32_bf16 v[108:111], v[88:91], v[152:155], v[108:111]
    v_mfma_f32_16x16x32_bf16 v[100:103], v[92:95], v[140:143], v[100:103]
    v_mfma_f32_16x16x32_bf16 v[108:111], v[92:95], v[156:159], v[108:111]
    ds_read_b128 v[64:67], v2 offset:32768
    ds_read_b128 v[68:71], v2 offset:33792
    ds_read_b128 v[72:75], v2 offset:34816
    ds_read_b128 v[76:79], v2 offset:35840
    ds_read_b128 v[80:83], v2 offset:36864
    ds_read_b128 v[84:87], v2 offset:37888
    ds_read_b128 v[88:91], v2 offset:38912
    ds_read_b128 v[92:95], v2 offset:39936
    s_nop 1
    s_cmp_lt_i32 s50, 0
    s_cbranch_scc0 L_recurrent_scan__compressed_kv_cla__moe_arch_mod__prompt_kernel_rare_106
L_recurrent_scan__compressed_kv_cla__moe_arch_mod__prompt_kernel_back_107:
    v_max3_f32 v22, v96, v97, v98
    v_max3_f32 v22, v22, v99, v100
    v_max3_f32 v22, v22, v101, v102
    v_max3_f32 v22, v22, v103, v40
    v_mov_b32 v24, v22
    s_nop 1
    v_permlane16_swap_b32 v22, v24
    s_nop 1
    v_max_f32 v22, v22, v24
    v_mov_b32 v24, v22
    s_nop 1
    v_permlane32_swap_b32 v22, v24
    s_nop 1
    v_max_f32 v22, v22, v24
    v_sub_f32 v25, v40, v22
    v_exp_f32 v25, v25
    v_mov_b32 v40, v22
    v_mul_f32 v38, v38, v25
    v_mul_f32 v192, v192, v25
    v_mul_f32 v193, v193, v25
    v_mul_f32 v194, v194, v25
    v_mul_f32 v195, v195, v25
    v_mul_f32 v196, v196, v25
    v_mul_f32 v197, v197, v25
    v_mul_f32 v198, v198, v25
    v_mul_f32 v199, v199, v25
    v_mul_f32 v200, v200, v25
    v_mul_f32 v201, v201, v25
    v_mul_f32 v202, v202, v25
    v_mul_f32 v203, v203, v25
    v_mul_f32 v204, v204, v25
    v_mul_f32 v205, v205, v25
    v_mul_f32 v206, v206, v25
    v_mul_f32 v207, v207, v25
    v_mul_f32 v208, v208, v25
    v_mul_f32 v209, v209, v25
    v_mul_f32 v210, v210, v25
    v_mul_f32 v211, v211, v25
    v_mul_f32 v212, v212, v25
    v_mul_f32 v213, v213, v25
    v_mul_f32 v214, v214, v25
    v_mul_f32 v215, v215, v25
    v_mul_f32 v216, v216, v25
    v_mul_f32 v217, v217, v25
    v_mul_f32 v218, v218, v25
    v_mul_f32 v219, v219, v25
    v_mul_f32 v220, v220, v25
    v_mul_f32 v221, v221, v25
    v_mul_f32 v222, v222, v25
    v_mul_f32 v223, v223, v25
    v_sub_f32 v96, v96, v22
    v_sub_f32 v97, v97, v22
    v_sub_f32 v98, v98, v22
    v_sub_f32 v99, v99, v22
    v_sub_f32 v100, v100, v22
    v_sub_f32 v101, v101, v22
    v_sub_f32 v102, v102, v22
    v_sub_f32 v103, v103, v22
    v_max3_f32 v23, v104, v105, v106
    v_max3_f32 v23, v23, v107, v108
    v_max3_f32 v23, v23, v109, v110
    v_max3_f32 v23, v23, v111, v41
    v_mov_b32 v24, v23
    s_nop 1
    v_permlane16_swap_b32 v23, v24
    s_nop 1
    v_max_f32 v23, v23, v24
    v_mov_b32 v24, v23
    s_nop 1
    v_permlane32_swap_b32 v23, v24
    s_nop 1
    v_max_f32 v23, v23, v24
    v_sub_f32 v25, v41, v23
    v_exp_f32 v25, v25
    v_mov_b32 v41, v23
    v_mul_f32 v39, v39, v25
    v_mul_f32 v224, v224, v25
    v_mul_f32 v225, v225, v25
    v_mul_f32 v226, v226, v25
    v_mul_f32 v227, v227, v25
    v_mul_f32 v228, v228, v25
    v_mul_f32 v229, v229, v25
    v_mul_f32 v230, v230, v25
    v_mul_f32 v231, v231, v25
    v_mul_f32 v232, v232, v25
    v_mul_f32 v233, v233, v25
    v_mul_f32 v234, v234, v25
    v_mul_f32 v235, v235, v25
    v_mul_f32 v236, v236, v25
    v_mul_f32 v237, v237, v25
    v_mul_f32 v238, v238, v25
    v_mul_f32 v239, v239, v25
    v_mul_f32 v240, v240, v25
    v_mul_f32 v241, v241, v25
    v_mul_f32 v242, v242, v25
    v_mul_f32 v243, v243, v25
    v_mul_f32 v244, v244, v25
    v_mul_f32 v245, v245, v25
    v_mul_f32 v246, v246, v25
    v_mul_f32 v247, v247, v25
    v_mul_f32 v248, v248, v25
    v_mul_f32 v249, v249, v25
    v_mul_f32 v250, v250, v25
    v_mul_f32 v251, v251, v25
    v_mul_f32 v252, v252, v25
    v_mul_f32 v253, v253, v25
    v_mul_f32 v254, v254, v25
    v_mul_f32 v255, v255, v25
    v_sub_f32 v104, v104, v23
    v_sub_f32 v105, v105, v23
    v_sub_f32 v106, v106, v23
    v_sub_f32 v107, v107, v23
    v_sub_f32 v108, v108, v23
    v_sub_f32 v109, v109, v23
    v_sub_f32 v110, v110, v23
    v_sub_f32 v111, v111, v23
    v_exp_f32 v96, v96
    v_exp_f32 v97, v97
    v_exp_f32 v98, v98
    v_exp_f32 v99, v99
    v_exp_f32 v104, v104
    v_exp_f32 v105, v105
    v_exp_f32 v106, v106
    v_exp_f32 v107, v107
    v_exp_f32 v100, v100
    v_exp_f32 v101, v101
    v_exp_f32 v102, v102
    v_exp_f32 v103, v103
    v_exp_f32 v108, v108
    v_exp_f32 v109, v109
    v_exp_f32 v110, v110
    v_exp_f32 v111, v111
    v_add_f32 v38, v38, v96
    v_add_f32 v38, v38, v97
    v_cvt_pk_bf16_f32 v48, v96, v97
    v_add_f32 v38, v38, v98
    v_add_f32 v38, v38, v99
    v_cvt_pk_bf16_f32 v49, v98, v99
    v_add_f32 v39, v39, v104
    v_add_f32 v39, v39, v105
    v_cvt_pk_bf16_f32 v52, v104, v105
    v_add_f32 v39, v39, v106
    v_add_f32 v39, v39, v107
    v_cvt_pk_bf16_f32 v53, v106, v107
    v_add_f32 v38, v38, v100
    v_add_f32 v38, v38, v101
    v_cvt_pk_bf16_f32 v50, v100, v101
    v_add_f32 v38, v38, v102
    v_add_f32 v38, v38, v103
    v_cvt_pk_bf16_f32 v51, v102, v103
    v_add_f32 v39, v39, v108
    v_add_f32 v39, v39, v109
    v_cvt_pk_bf16_f32 v54, v108, v109
    v_add_f32 v39, v39, v110
    v_add_f32 v39, v39, v111
    v_cvt_pk_bf16_f32 v55, v110, v111
    s_waitcnt lgkmcnt(0)
    s_nop 0
    v_mfma_f32_16x16x32_bf16 v[192:195], v[64:67], v[48:51], v[192:195]
    v_mfma_f32_16x16x32_bf16 v[224:227], v[64:67], v[52:55], v[224:227]
    v_mfma_f32_16x16x32_bf16 v[196:199], v[68:71], v[48:51], v[196:199]
    v_mfma_f32_16x16x32_bf16 v[228:231], v[68:71], v[52:55], v[228:231]
    v_mfma_f32_16x16x32_bf16 v[200:203], v[72:75], v[48:51], v[200:203]
    v_mfma_f32_16x16x32_bf16 v[232:235], v[72:75], v[52:55], v[232:235]
    v_mfma_f32_16x16x32_bf16 v[204:207], v[76:79], v[48:51], v[204:207]
    v_mfma_f32_16x16x32_bf16 v[236:239], v[76:79], v[52:55], v[236:239]
    v_mfma_f32_16x16x32_bf16 v[208:211], v[80:83], v[48:51], v[208:211]
    v_mfma_f32_16x16x32_bf16 v[240:243], v[80:83], v[52:55], v[240:243]
    v_mfma_f32_16x16x32_bf16 v[212:215], v[84:87], v[48:51], v[212:215]
    v_mfma_f32_16x16x32_bf16 v[244:247], v[84:87], v[52:55], v[244:247]
    v_mfma_f32_16x16x32_bf16 v[216:219], v[88:91], v[48:51], v[216:219]
    v_mfma_f32_16x16x32_bf16 v[248:251], v[88:91], v[52:55], v[248:251]
    v_mfma_f32_16x16x32_bf16 v[220:223], v[92:95], v[48:51], v[220:223]
    v_mfma_f32_16x16x32_bf16 v[252:255], v[92:95], v[52:55], v[252:255]
L_recurrent_scan__compressed_kv_cla__moe_arch_mod__prompt_kernel_snext_105:
    v_add_u32 v2, 8192, v2
    s_add_u32 s50, s50, 32
    s_sub_u32 s41, s41, 1
    s_cmp_lg_u32 s41, 0
    s_cbranch_scc1 L_recurrent_scan__compressed_kv_cla__moe_arch_mod__prompt_kernel_sunit_104
    s_sub_u32 s40, s40, 1
    s_cmp_lg_u32 s40, 0
    s_cbranch_scc1 L_recurrent_scan__compressed_kv_cla__moe_arch_mod__prompt_kernel_stile_103
    v_mov_b32 v20, v38
    s_nop 1
    v_permlane16_swap_b32 v38, v20
    s_nop 1
    v_add_f32 v38, v38, v20
    v_mov_b32 v20, v38
    s_nop 1
    v_permlane32_swap_b32 v38, v20
    s_nop 1
    v_add_f32 v38, v38, v20
    v_mov_b32 v20, v39
    s_nop 1
    v_permlane16_swap_b32 v39, v20
    s_nop 1
    v_add_f32 v39, v39, v20
    v_mov_b32 v20, v39
    s_nop 1
    v_permlane32_swap_b32 v39, v20
    s_nop 1
    v_add_f32 v39, v39, v20
    s_mov_b32 s36, 0x5d800000
    v_cmp_nge_f32 vcc, s36, v38
    s_nop 0
    s_or_b64 s[52:53], s[52:53], vcc
    v_cmp_nge_f32 vcc, s36, v39
    s_nop 0
    s_or_b64 s[52:53], s[52:53], vcc
    v_rcp_f32 v38, v38
    v_rcp_f32 v39, v39
    s_lshl_b32 s38, s39, 3
    s_and_b32 s37, s28, 3
    s_lshl_b32 s37, s37, 1
    s_add_u32 s38, s38, s37
    s_lshl_b32 s38, s38, 17
    s_lshl_b32 s37, s29, 12
    s_add_u32 s38, s38, s37
    v_mov_b32 v20, v38
    v_mov_b32 v21, v38
    v_pk_mul_f32 v[192:193], v[192:193], v[20:21]
    v_pk_mul_f32 v[194:195], v[194:195], v[20:21]
    v_pk_mul_f32 v[196:197], v[196:197], v[20:21]
    v_pk_mul_f32 v[198:199], v[198:199], v[20:21]
    v_cvt_pk_bf16_f32 v22, v192, v193
    v_cvt_pk_bf16_f32 v23, v194, v195
    v_cvt_pk_bf16_f32 v24, v196, v197
    v_cvt_pk_bf16_f32 v25, v198, v199
    buffer_store_dwordx4 v[22:25], v7, s[16:19], s38 offen offset:0 sc1
    v_pk_mul_f32 v[200:201], v[200:201], v[20:21]
    v_pk_mul_f32 v[202:203], v[202:203], v[20:21]
    v_pk_mul_f32 v[204:205], v[204:205], v[20:21]
    v_pk_mul_f32 v[206:207], v[206:207], v[20:21]
    v_cvt_pk_bf16_f32 v26, v200, v201
    v_cvt_pk_bf16_f32 v27, v202, v203
    v_cvt_pk_bf16_f32 v28, v204, v205
    v_cvt_pk_bf16_f32 v29, v206, v207
    buffer_store_dwordx4 v[26:29], v7, s[16:19], s38 offen offset:1024 sc1
    v_pk_mul_f32 v[208:209], v[208:209], v[20:21]
    v_pk_mul_f32 v[210:211], v[210:211], v[20:21]
    v_pk_mul_f32 v[212:213], v[212:213], v[20:21]
    v_pk_mul_f32 v[214:215], v[214:215], v[20:21]
    v_cvt_pk_bf16_f32 v30, v208, v209
    v_cvt_pk_bf16_f32 v31, v210, v211
    v_cvt_pk_bf16_f32 v32, v212, v213
    v_cvt_pk_bf16_f32 v33, v214, v215
    buffer_store_dwordx4 v[30:33], v7, s[16:19], s38 offen offset:2048 sc1
    v_pk_mul_f32 v[216:217], v[216:217], v[20:21]
    v_pk_mul_f32 v[218:219], v[218:219], v[20:21]
    v_pk_mul_f32 v[220:221], v[220:221], v[20:21]
    v_pk_mul_f32 v[222:223], v[222:223], v[20:21]
    v_cvt_pk_bf16_f32 v34, v216, v217
    v_cvt_pk_bf16_f32 v35, v218, v219
    v_cvt_pk_bf16_f32 v36, v220, v221
    v_cvt_pk_bf16_f32 v37, v222, v223
    buffer_store_dwordx4 v[34:37], v7, s[16:19], s38 offen offset:3072 sc1
    s_add_u32 s38, s38, 131072
    v_mov_b32 v20, v39
    v_mov_b32 v21, v39
    v_pk_mul_f32 v[224:225], v[224:225], v[20:21]
    v_pk_mul_f32 v[226:227], v[226:227], v[20:21]
    v_pk_mul_f32 v[228:229], v[228:229], v[20:21]
    v_pk_mul_f32 v[230:231], v[230:231], v[20:21]
    v_cvt_pk_bf16_f32 v22, v224, v225
    v_cvt_pk_bf16_f32 v23, v226, v227
    v_cvt_pk_bf16_f32 v24, v228, v229
    v_cvt_pk_bf16_f32 v25, v230, v231
    buffer_store_dwordx4 v[22:25], v7, s[16:19], s38 offen offset:0 sc1
    v_pk_mul_f32 v[232:233], v[232:233], v[20:21]
    v_pk_mul_f32 v[234:235], v[234:235], v[20:21]
    v_pk_mul_f32 v[236:237], v[236:237], v[20:21]
    v_pk_mul_f32 v[238:239], v[238:239], v[20:21]
    v_cvt_pk_bf16_f32 v26, v232, v233
    v_cvt_pk_bf16_f32 v27, v234, v235
    v_cvt_pk_bf16_f32 v28, v236, v237
    v_cvt_pk_bf16_f32 v29, v238, v239
    buffer_store_dwordx4 v[26:29], v7, s[16:19], s38 offen offset:1024 sc1
    v_pk_mul_f32 v[240:241], v[240:241], v[20:21]
    v_pk_mul_f32 v[242:243], v[242:243], v[20:21]
    v_pk_mul_f32 v[244:245], v[244:245], v[20:21]
    v_pk_mul_f32 v[246:247], v[246:247], v[20:21]
    v_cvt_pk_bf16_f32 v30, v240, v241
    v_cvt_pk_bf16_f32 v31, v242, v243
    v_cvt_pk_bf16_f32 v32, v244, v245
    v_cvt_pk_bf16_f32 v33, v246, v247
    buffer_store_dwordx4 v[30:33], v7, s[16:19], s38 offen offset:2048 sc1
    v_pk_mul_f32 v[248:249], v[248:249], v[20:21]
    v_pk_mul_f32 v[250:251], v[250:251], v[20:21]
    v_pk_mul_f32 v[252:253], v[252:253], v[20:21]
    v_pk_mul_f32 v[254:255], v[254:255], v[20:21]
    v_cvt_pk_bf16_f32 v34, v248, v249
    v_cvt_pk_bf16_f32 v35, v250, v251
    v_cvt_pk_bf16_f32 v36, v252, v253
    v_cvt_pk_bf16_f32 v37, v254, v255
    buffer_store_dwordx4 v[34:37], v7, s[16:19], s38 offen offset:3072 sc1
    v_mov_b32 v96, v112
    v_mov_b32 v97, v113
    v_mov_b32 v98, v114
    v_mov_b32 v99, v115
    v_mov_b32 v100, v116
    v_mov_b32 v101, v117
    v_mov_b32 v102, v118
    v_mov_b32 v103, v119
    s_branch L_p3_done
L_recurrent_scan__compressed_kv_cla__moe_arch_mod__prompt_kernel_rare_1:
    s_mul_i32 s36, s28, 12288
    s_add_u32 s36, s36, 61865984
    v_lshl_add_u32 v16, v1, 4, s36
    v_mov_b32 v108, 0
    v_mov_b32 v109, 0
    v_mov_b32 v110, 0
    v_mov_b32 v111, 0
    global_store_dwordx4 v16, v[108:111], s[90:91] sc1
    v_add_u32 v16, 1024, v16
    global_store_dwordx4 v16, v[108:111], s[90:91] sc1
    v_add_u32 v16, 1024, v16
    global_store_dwordx4 v16, v[108:111], s[90:91] sc1
    v_add_u32 v16, 1024, v16
    global_store_dwordx4 v16, v[108:111], s[90:91] sc1
    v_add_u32 v16, 1024, v16
    global_store_dwordx4 v16, v[108:111], s[90:91] sc1
    v_add_u32 v16, 1024, v16
    global_store_dwordx4 v16, v[108:111], s[90:91] sc1
    v_add_u32 v16, 1024, v16
    global_store_dwordx4 v16, v[108:111], s[90:91] sc1
    v_add_u32 v16, 1024, v16
    global_store_dwordx4 v16, v[108:111], s[90:91] sc1
    v_add_u32 v16, 1024, v16
    global_store_dwordx4 v16, v[108:111], s[90:91] sc1
    v_add_u32 v16, 1024, v16
    global_store_dwordx4 v16, v[108:111], s[90:91] sc1
    v_add_u32 v16, 1024, v16
    global_store_dwordx4 v16, v[108:111], s[90:91] sc1
    v_add_u32 v16, 1024, v16
    global_store_dwordx4 v16, v[108:111], s[90:91] sc1
    v_add_u32 v16, 1024, v16
    s_branch L_recurrent_scan__compressed_kv_cla__moe_arch_mod__prompt_kernel_back_2
L_recurrent_scan__compressed_kv_cla__moe_arch_mod__prompt_kernel_rare_3:
    v_mov_b32 v19, 1
    s_mov_b64 exec, 1
    global_store_dword v118, v19, s[88:89] sc1
    s_mov_b64 exec, -1
    s_branch L_recurrent_scan__compressed_kv_cla__moe_arch_mod__prompt_kernel_back_4
L_recurrent_scan__compressed_kv_cla__moe_arch_mod__prompt_kernel_rare_5:
    v_and_b32 v108, 7, v1
    v_lshlrev_b32 v108, 3, v108
    v_add_u32 v109, 147712, v108
    ds_read_b64 v[110:111], v109
    ds_read_b32 v112, v109 offset:64
    s_lshl_b32 s36, s2, 6
    s_add_u32 s36, s36, 4194304
    s_lshl_b32 s37, s2, 3
    s_add_u32 s37, s37, 4276224
    s_waitcnt lgkmcnt(0)
    v_mov_b32 v114, v112
    s_nop 1
    v_max_u32_dpp v114, v114, v114 quad_perm:[1,0,3,2] row_mask:0xf bank_mask:0xf
    s_nop 1
    v_max_u32_dpp v114, v114, v114 quad_perm:[2,3,0,1] row_mask:0xf bank_mask:0xf
    s_nop 1
    v_max_u32_dpp v114, v114, v114 row_half_mirror row_mask:0xf bank_mask:0xf
    v_cmp_eq_u32 vcc, v114, v112
    s_nop 1
    v_cndmask_b32 v115, v112, v118, vcc
    s_nop 1
    v_max_u32_dpp v115, v115, v115 quad_perm:[1,0,3,2] row_mask:0xf bank_mask:0xf
    s_nop 1
    v_max_u32_dpp v115, v115, v115 quad_perm:[2,3,0,1] row_mask:0xf bank_mask:0xf
    s_nop 1
    v_max_u32_dpp v115, v115, v115 row_half_mirror row_mask:0xf bank_mask:0xf
    s_mov_b64 exec, 0xff
    buffer_store_dwordx2 v[110:111], v108, s[24:27], s36 offen sc1
    s_mov_b64 exec, 1
    buffer_store_dwordx2 v[114:115], v108, s[24:27], s37 offen sc1
    s_mov_b64 exec, -1
    s_nop 3
    s_branch L_recurrent_scan__compressed_kv_cla__moe_arch_mod__prompt_kernel_back_6
L_recurrent_scan__compressed_kv_cla__moe_arch_mod__prompt_kernel_rare_7:
    v_lshrrev_b32 v3, 4, v1
    s_lshl_b32 s37, s28, 4
    v_add_u32 v19, s37, v3
    v_lshlrev_b32 v19, 13, v19
    s_lshl_b32 s37, s29, 8
    v_add_u32 v19, s37, v19
    v_and_b32 v16, 15, v1
    v_lshlrev_b32 v3, 1, v3
    v_xor_b32 v16, v16, v3
    v_lshl_add_u32 v2, v16, 4, v19
    v_add_u32 v3, 31744, v2
    v_xor_b32 v16, 8, v16
    v_lshl_add_u32 v4, v16, 4, v19
    v_add_u32 v4, 63488, v4
    v_add_u32 v5, 31744, v4
    s_mov_b32 s4, s96
    s_and_b32 s5, s97, 0xffff
    s_mov_b32 s6, 8388608
    s_mov_b32 s7, 0x20000
    s_mov_b32 s31, 0
    s_mov_b32 s40, 1048576
    s_mov_b64 s[8:9], s[4:5]
    s_mov_b32 s10, s6
    s_mov_b32 s32, 2097152
    v_mov_b32 v6, v2
    v_mov_b32 v7, v3
    v_mov_b32 v8, v4
    v_mov_b32 v9, v5
    s_branch L_recurrent_scan__compressed_kv_cla__moe_arch_mod__prompt_kernel_back_8
L_recurrent_scan__compressed_kv_cla__moe_arch_mod__prompt_kernel_w0_9:
    s_cmp_eq_u32 s35, 0
    s_cbranch_scc0 L_recurrent_scan__compressed_kv_cla__moe_arch_mod__prompt_kernel_swn_12
    s_waitcnt vmcnt(2)
    s_branch L_recurrent_scan__compressed_kv_cla__moe_arch_mod__prompt_kernel_swend_11
L_recurrent_scan__compressed_kv_cla__moe_arch_mod__prompt_kernel_swn_12:
    s_waitcnt vmcnt(2)
L_recurrent_scan__compressed_kv_cla__moe_arch_mod__prompt_kernel_swend_11:
    s_branch L_recurrent_scan__compressed_kv_cla__moe_arch_mod__prompt_kernel_w0b_10
L_recurrent_scan__compressed_kv_cla__moe_arch_mod__prompt_kernel_rare_15:
    s_cmp_eq_u32 s35, 0
    s_cbranch_scc0 L_recurrent_scan__compressed_kv_cla__moe_arch_mod__prompt_kernel_swn_14
    global_load_dword v116, v118, s[88:89] sc1
    s_branch L_recurrent_scan__compressed_kv_cla__moe_arch_mod__prompt_kernel_swend_13
L_recurrent_scan__compressed_kv_cla__moe_arch_mod__prompt_kernel_swn_14:
    v_and_b32 v117, 15, v1
    v_add_u32 v117, 112, v117
    v_lshlrev_b32 v117, 7, v117
    global_load_dword v116, v117, s[90:91] sc1
L_recurrent_scan__compressed_kv_cla__moe_arch_mod__prompt_kernel_swend_13:
    s_branch L_recurrent_scan__compressed_kv_cla__moe_arch_mod__prompt_kernel_back_16
L_recurrent_scan__compressed_kv_cla__moe_arch_mod__prompt_kernel_rare_21:
    s_mov_b32 s61, 0x40000
L_recurrent_scan__compressed_kv_cla__moe_arch_mod__prompt_kernel_spin_19:
    s_sub_u32 s61, s61, 1
    s_cbranch_scc1 L_recurrent_scan__compressed_kv_cla__moe_arch_mod__prompt_kernel_spinx_20
    s_sleep 8
    global_load_dword v116, v118, s[88:89] sc1
    s_waitcnt vmcnt(0)
    v_readfirstlane_b32 s36, v116
    s_nop 0
    s_cmp_lt_u32 s36, 1
    s_cbranch_scc1 L_recurrent_scan__compressed_kv_cla__moe_arch_mod__prompt_kernel_spin_19
L_recurrent_scan__compressed_kv_cla__moe_arch_mod__prompt_kernel_spinx_20:
    s_branch L_recurrent_scan__compressed_kv_cla__moe_arch_mod__prompt_kernel_back_22
L_recurrent_scan__compressed_kv_cla__moe_arch_mod__prompt_kernel_w0_17:
    s_waitcnt vmcnt(0)
    s_cmp_eq_u32 s35, 0
    s_cbranch_scc0 L_recurrent_scan__compressed_kv_cla__moe_arch_mod__prompt_kernel_swn_26
    v_readfirstlane_b32 s36, v116
    s_nop 0
    s_cmp_lt_u32 s36, 1
    s_cbranch_scc1 L_recurrent_scan__compressed_kv_cla__moe_arch_mod__prompt_kernel_rare_21
L_recurrent_scan__compressed_kv_cla__moe_arch_mod__prompt_kernel_back_22:
    s_branch L_recurrent_scan__compressed_kv_cla__moe_arch_mod__prompt_kernel_swend_25
L_recurrent_scan__compressed_kv_cla__moe_arch_mod__prompt_kernel_swn_26:
    s_mov_b32 s61, 0x40000
L_recurrent_scan__compressed_kv_cla__moe_arch_mod__prompt_kernel_lspin_23:
    v_cmp_gt_u32 vcc, 16, v116
    s_nop 0
    s_cmp_eq_u64 vcc, 0
    s_cbranch_scc1 L_recurrent_scan__compressed_kv_cla__moe_arch_mod__prompt_kernel_lspinx_24
    s_sub_u32 s61, s61, 1
    s_cbranch_scc1 L_recurrent_scan__compressed_kv_cla__moe_arch_mod__prompt_kernel_lspinx_24
    s_sleep 8
    global_load_dword v116, v117, s[90:91] sc1
    s_waitcnt vmcnt(0)
    s_branch L_recurrent_scan__compressed_kv_cla__moe_arch_mod__prompt_kernel_lspin_23
L_recurrent_scan__compressed_kv_cla__moe_arch_mod__prompt_kernel_lspinx_24:
L_recurrent_scan__compressed_kv_cla__moe_arch_mod__prompt_kernel_swend_25:
    s_branch L_recurrent_scan__compressed_kv_cla__moe_arch_mod__prompt_kernel_w0b_18
L_recurrent_scan__compressed_kv_cla__moe_arch_mod__prompt_kernel_rare_27:
    s_lshr_b32 s36, s2, 4
    s_add_u32 s36, s36, 112
    s_lshl_b32 s36, s36, 7
    v_mov_b32 v16, s36
    v_mov_b32 v19, 1
    s_mov_b64 exec, 1
    global_atomic_add v16, v19, s[90:91]
    s_mov_b64 exec, -1
    s_nop 3
    s_branch L_recurrent_scan__compressed_kv_cla__moe_arch_mod__prompt_kernel_back_28
L_recurrent_scan__compressed_kv_cla__moe_arch_mod__prompt_kernel_w0_29:
    s_cmp_eq_u32 s35, 0
    s_cbranch_scc0 L_recurrent_scan__compressed_kv_cla__moe_arch_mod__prompt_kernel_swn_32
    s_waitcnt vmcnt(2)
    s_branch L_recurrent_scan__compressed_kv_cla__moe_arch_mod__prompt_kernel_swend_31
L_recurrent_scan__compressed_kv_cla__moe_arch_mod__prompt_kernel_swn_32:
    s_waitcnt vmcnt(2)
L_recurrent_scan__compressed_kv_cla__moe_arch_mod__prompt_kernel_swend_31:
    s_branch L_recurrent_scan__compressed_kv_cla__moe_arch_mod__prompt_kernel_w0b_30
L_recurrent_scan__compressed_kv_cla__moe_arch_mod__prompt_kernel_rare_35:
    v_lshrrev_b32 v3, 4, v1
    s_lshl_b32 s37, s28, 4
    v_add_u32 v19, s37, v3
    v_lshlrev_b32 v19, 13, v19
    s_lshl_b32 s37, s29, 8
    v_add_u32 v19, s37, v19
    v_and_b32 v16, 15, v1
    v_lshlrev_b32 v3, 1, v3
    v_xor_b32 v16, v16, v3
    v_lshl_add_u32 v2, v16, 4, v19
    v_add_u32 v3, 31744, v2
    v_xor_b32 v16, 8, v16
    v_lshl_add_u32 v4, v16, 4, v19
    v_add_u32 v4, 63488, v4
    v_add_u32 v5, 31744, v4
    s_mov_b32 s4, s96
    s_and_b32 s5, s97, 0xffff
    s_mov_b32 s6, 8388608
    s_mov_b32 s7, 0x20000
    s_mov_b32 s31, 0
    s_mov_b32 s40, 1048576
    s_mov_b64 s[8:9], s[4:5]
    s_mov_b32 s10, s6
    s_mov_b32 s32, 2097152
    v_mov_b32 v6, v2
    v_mov_b32 v7, v3
    v_mov_b32 v8, v4
    v_mov_b32 v9, v5
    s_branch L_recurrent_scan__compressed_kv_cla__moe_arch_mod__prompt_kernel_back_36
L_recurrent_scan__compressed_kv_cla__moe_arch_mod__prompt_kernel_rare_41:
    s_mov_b32 s61, 0x40000
L_recurrent_scan__compressed_kv_cla__moe_arch_mod__prompt_kernel_spin_39:
    s_sub_u32 s61, s61, 1
    s_cbranch_scc1 L_recurrent_scan__compressed_kv_cla__moe_arch_mod__prompt_kernel_spinx_40
    s_sleep 8
    global_load_dword v56, v57, s[90:91] sc1
    s_waitcnt vmcnt(0)
    v_readfirstlane_b32 s36, v56
    s_nop 0
    s_cmp_lt_u32 s36, 1
    s_cbranch_scc1 L_recurrent_scan__compressed_kv_cla__moe_arch_mod__prompt_kernel_spin_39
L_recurrent_scan__compressed_kv_cla__moe_arch_mod__prompt_kernel_spinx_40:
    s_branch L_recurrent_scan__compressed_kv_cla__moe_arch_mod__prompt_kernel_back_42
L_recurrent_scan__compressed_kv_cla__moe_arch_mod__prompt_kernel_rare_47:
    s_cmp_lt_u32 s28, 4
    s_cbranch_scc0 L_recurrent_scan__compressed_kv_cla__moe_arch_mod__prompt_kernel_ng_44
    s_cmp_eq_u32 s35, 2
    s_cbranch_scc0 L_recurrent_scan__compressed_kv_cla__moe_arch_mod__prompt_kernel_swn_46
    s_mov_b32 s6, 0
    s_mov_b32 s34, 0x30000
    s_branch L_recurrent_scan__compressed_kv_cla__moe_arch_mod__prompt_kernel_swend_45
L_recurrent_scan__compressed_kv_cla__moe_arch_mod__prompt_kernel_swn_46:
    s_mov_b64 s[4:5], s[12:13]
    s_mov_b32 s6, s14
    s_mov_b32 s31, s45
    s_mov_b32 s40, 32768
    s_mov_b32 s34, s33
    v_add_u32 v2, s33, v58
    v_mov_b32 v3, v2
    v_mov_b32 v4, v2
    v_mov_b32 v5, v2
    s_cmp_eq_u32 s28, 0
    s_cbranch_scc0 L_recurrent_scan__compressed_kv_cla__moe_arch_mod__prompt_kernel_g_43
    s_waitcnt vmcnt(10)
    v_readfirstlane_b32 s36, v56
    s_nop 0
    s_cmp_lt_u32 s36, 1
    s_cbranch_scc1 L_recurrent_scan__compressed_kv_cla__moe_arch_mod__prompt_kernel_rare_41
L_recurrent_scan__compressed_kv_cla__moe_arch_mod__prompt_kernel_back_42:
L_recurrent_scan__compressed_kv_cla__moe_arch_mod__prompt_kernel_g_43:
L_recurrent_scan__compressed_kv_cla__moe_arch_mod__prompt_kernel_swend_45:
L_recurrent_scan__compressed_kv_cla__moe_arch_mod__prompt_kernel_ng_44:
    s_branch L_recurrent_scan__compressed_kv_cla__moe_arch_mod__prompt_kernel_back_48
L_recurrent_scan__compressed_kv_cla__moe_arch_mod__prompt_kernel_rare_53:
    s_cmp_eq_u32 s35, 3
    s_cbranch_scc0 L_recurrent_scan__compressed_kv_cla__moe_arch_mod__prompt_kernel_nv0_49
    s_cmp_eq_u32 s28, 0
    s_cbranch_scc0 L_recurrent_scan__compressed_kv_cla__moe_arch_mod__prompt_kernel_g_38
    s_add_u32 s36, s29, 64
    s_lshl_b32 s36, s36, 7
    v_mov_b32 v57, s36
    global_load_dword v56, v57, s[90:91] sc1
L_recurrent_scan__compressed_kv_cla__moe_arch_mod__prompt_kernel_g_38:
L_recurrent_scan__compressed_kv_cla__moe_arch_mod__prompt_kernel_nv0_49:
    s_cmp_ge_u32 s28, 4
    s_cbranch_scc0 L_recurrent_scan__compressed_kv_cla__moe_arch_mod__prompt_kernel_ng_50
    s_cmp_eq_u32 s35, 2
    s_cbranch_scc0 L_recurrent_scan__compressed_kv_cla__moe_arch_mod__prompt_kernel_swn_52
    s_mov_b32 s6, 0
    s_mov_b32 s34, 0x30000
    s_branch L_recurrent_scan__compressed_kv_cla__moe_arch_mod__prompt_kernel_swend_51
L_recurrent_scan__compressed_kv_cla__moe_arch_mod__prompt_kernel_swn_52:
    s_mov_b64 s[4:5], s[12:13]
    s_mov_b32 s6, s14
    s_mov_b32 s31, s45
    s_mov_b32 s40, 32768
    s_mov_b32 s34, s33
    v_add_u32 v2, s33, v58
    v_mov_b32 v3, v2
    v_mov_b32 v4, v2
    v_mov_b32 v5, v2
L_recurrent_scan__compressed_kv_cla__moe_arch_mod__prompt_kernel_swend_51:
L_recurrent_scan__compressed_kv_cla__moe_arch_mod__prompt_kernel_ng_50:
    s_branch L_recurrent_scan__compressed_kv_cla__moe_arch_mod__prompt_kernel_back_54
L_recurrent_scan__compressed_kv_cla__moe_arch_mod__prompt_kernel_rare_59:
    s_cmp_eq_u32 s35, 3
    s_cbranch_scc0 L_recurrent_scan__compressed_kv_cla__moe_arch_mod__prompt_kernel_nv0_55
    s_add_u32 s34, s33, 32768
L_recurrent_scan__compressed_kv_cla__moe_arch_mod__prompt_kernel_nv0_55:
    s_cmp_ge_u32 s28, 4
    s_cbranch_scc0 L_recurrent_scan__compressed_kv_cla__moe_arch_mod__prompt_kernel_ng_56
    s_cmp_eq_u32 s35, 2
    s_cbranch_scc0 L_recurrent_scan__compressed_kv_cla__moe_arch_mod__prompt_kernel_swn_58
    s_add_u32 s36, s28, s30
    s_cmp_eq_u32 s36, 4
    s_cbranch_scc0 L_recurrent_scan__compressed_kv_cla__moe_arch_mod__prompt_kernel_g_37
    s_add_u32 s36, s29, 64
    s_lshl_b32 s36, s36, 7
    v_mov_b32 v62, s36
    v_mov_b32 v63, 1
    s_mov_b64 exec, 1
    global_atomic_add v62, v63, s[90:91]
    s_mov_b64 exec, -1
    s_nop 3
L_recurrent_scan__compressed_kv_cla__moe_arch_mod__prompt_kernel_g_37:
    s_branch L_recurrent_scan__compressed_kv_cla__moe_arch_mod__prompt_kernel_swend_57
L_recurrent_scan__compressed_kv_cla__moe_arch_mod__prompt_kernel_swn_58:
L_recurrent_scan__compressed_kv_cla__moe_arch_mod__prompt_kernel_swend_57:
L_recurrent_scan__compressed_kv_cla__moe_arch_mod__prompt_kernel_ng_56:
    s_branch L_recurrent_scan__compressed_kv_cla__moe_arch_mod__prompt_kernel_back_60
L_recurrent_scan__compressed_kv_cla__moe_arch_mod__prompt_kernel_rare_61:
    s_waitcnt vmcnt(18)
    s_branch L_recurrent_scan__compressed_kv_cla__moe_arch_mod__prompt_kernel_back_62
L_recurrent_scan__compressed_kv_cla__moe_arch_mod__prompt_kernel_rare_63:
    s_lshl_b32 s36, s39, 1
    s_add_u32 s36, s36, s38
    s_add_u32 s37, s36, s39
    buffer_store_dwordx4 v[160:163], v58, s[16:19], s36 offen sc1
    buffer_store_dwordx4 v[164:167], v59, s[16:19], s36 offen sc1
    buffer_store_dwordx4 v[168:171], v60, s[16:19], s36 offen sc1
    buffer_store_dwordx4 v[172:175], v61, s[16:19], s36 offen sc1
    buffer_store_dwordx4 v[176:179], v58, s[16:19], s37 offen sc1
    buffer_store_dwordx4 v[180:183], v59, s[16:19], s37 offen sc1
    buffer_store_dwordx4 v[184:187], v60, s[16:19], s37 offen sc1
    buffer_store_dwordx4 v[188:191], v61, s[16:19], s37 offen sc1
    s_branch L_recurrent_scan__compressed_kv_cla__moe_arch_mod__prompt_kernel_back_64
L_recurrent_scan__compressed_kv_cla__moe_arch_mod__prompt_kernel_rare_65:
    v_mov_b32 v20, 4048155338
    v_subrev_u32 v21, s50, v18
    v_cmp_gt_i32 s[20:21], 0, v21
    v_cmp_gt_i32 s[22:23], 1, v21
    v_cmp_gt_i32 s[62:63], 2, v21
    v_cmp_gt_i32 vcc, 3, v21
    v_cndmask_b32 v96, v96, v20, s[20:21]
    v_cndmask_b32 v97, v97, v20, s[22:23]
    v_cndmask_b32 v98, v98, v20, s[62:63]
    v_cndmask_b32 v99, v99, v20, vcc
    v_cmp_gt_i32 s[20:21], 16, v21
    v_cmp_gt_i32 s[22:23], 17, v21
    v_cmp_gt_i32 s[62:63], 18, v21
    v_cmp_gt_i32 vcc, 19, v21
    v_cndmask_b32 v100, v100, v20, s[20:21]
    v_cndmask_b32 v101, v101, v20, s[22:23]
    v_cndmask_b32 v102, v102, v20, s[62:63]
    v_cndmask_b32 v103, v103, v20, vcc
    v_cmp_gt_i32 s[20:21], -16, v21
    v_cmp_gt_i32 s[22:23], -15, v21
    v_cmp_gt_i32 s[62:63], -14, v21
    v_cmp_gt_i32 vcc, -13, v21
    v_cndmask_b32 v104, v104, v20, s[20:21]
    v_cndmask_b32 v105, v105, v20, s[22:23]
    v_cndmask_b32 v106, v106, v20, s[62:63]
    v_cndmask_b32 v107, v107, v20, vcc
    v_cmp_gt_i32 s[20:21], 0, v21
    v_cmp_gt_i32 s[22:23], 1, v21
    v_cmp_gt_i32 s[62:63], 2, v21
    v_cmp_gt_i32 vcc, 3, v21
    v_cndmask_b32 v108, v108, v20, s[20:21]
    v_cndmask_b32 v109, v109, v20, s[22:23]
    v_cndmask_b32 v110, v110, v20, s[62:63]
    v_cndmask_b32 v111, v111, v20, vcc
    s_branch L_recurrent_scan__compressed_kv_cla__moe_arch_mod__prompt_kernel_back_66
L_recurrent_scan__compressed_kv_cla__moe_arch_mod__prompt_kernel_rare_67:
    s_lshl_b32 s36, s29, 7
    v_mov_b32 v13, s36
    global_load_dword v14, v13, s[90:91] sc1
    s_branch L_recurrent_scan__compressed_kv_cla__moe_arch_mod__prompt_kernel_back_68
L_recurrent_scan__compressed_kv_cla__moe_arch_mod__prompt_kernel_rare_69:
    v_mov_b32 v20, 4048155338
    v_subrev_u32 v21, s49, v18
    v_cmp_gt_i32 s[20:21], 0, v21
    v_cmp_gt_i32 s[22:23], 1, v21
    v_cmp_gt_i32 s[62:63], 2, v21
    v_cmp_gt_i32 vcc, 3, v21
    v_cndmask_b32 v112, v112, v20, s[20:21]
    v_cndmask_b32 v113, v113, v20, s[22:23]
    v_cndmask_b32 v114, v114, v20, s[62:63]
    v_cndmask_b32 v115, v115, v20, vcc
    v_cmp_gt_i32 s[20:21], 16, v21
    v_cmp_gt_i32 s[22:23], 17, v21
    v_cmp_gt_i32 s[62:63], 18, v21
    v_cmp_gt_i32 vcc, 19, v21
    v_cndmask_b32 v116, v116, v20, s[20:21]
    v_cndmask_b32 v117, v117, v20, s[22:23]
    v_cndmask_b32 v118, v118, v20, s[62:63]
    v_cndmask_b32 v119, v119, v20, vcc
    v_cmp_gt_i32 s[20:21], -16, v21
    v_cmp_gt_i32 s[22:23], -15, v21
    v_cmp_gt_i32 s[62:63], -14, v21
    v_cmp_gt_i32 vcc, -13, v21
    v_cndmask_b32 v120, v120, v20, s[20:21]
    v_cndmask_b32 v121, v121, v20, s[22:23]
    v_cndmask_b32 v122, v122, v20, s[62:63]
    v_cndmask_b32 v123, v123, v20, vcc
    v_cmp_gt_i32 s[20:21], 0, v21
    v_cmp_gt_i32 s[22:23], 1, v21
    v_cmp_gt_i32 s[62:63], 2, v21
    v_cmp_gt_i32 vcc, 3, v21
    v_cndmask_b32 v124, v124, v20, s[20:21]
    v_cndmask_b32 v125, v125, v20, s[22:23]
    v_cndmask_b32 v126, v126, v20, s[62:63]
    v_cndmask_b32 v127, v127, v20, vcc
    s_branch L_recurrent_scan__compressed_kv_cla__moe_arch_mod__prompt_kernel_back_70
L_recurrent_scan__compressed_kv_cla__moe_arch_mod__prompt_kernel_rare_71:
    v_mov_b32 v20, 4048155338
    v_subrev_u32 v21, s50, v18
    v_cmp_gt_i32 s[20:21], 0, v21
    v_cmp_gt_i32 s[22:23], 1, v21
    v_cmp_gt_i32 s[62:63], 2, v21
    v_cmp_gt_i32 vcc, 3, v21
    v_cndmask_b32 v96, v96, v20, s[20:21]
    v_cndmask_b32 v97, v97, v20, s[22:23]
    v_cndmask_b32 v98, v98, v20, s[62:63]
    v_cndmask_b32 v99, v99, v20, vcc
    v_cmp_gt_i32 s[20:21], 16, v21
    v_cmp_gt_i32 s[22:23], 17, v21
    v_cmp_gt_i32 s[62:63], 18, v21
    v_cmp_gt_i32 vcc, 19, v21
    v_cndmask_b32 v100, v100, v20, s[20:21]
    v_cndmask_b32 v101, v101, v20, s[22:23]
    v_cndmask_b32 v102, v102, v20, s[62:63]
    v_cndmask_b32 v103, v103, v20, vcc
    v_cmp_gt_i32 s[20:21], -16, v21
    v_cmp_gt_i32 s[22:23], -15, v21
    v_cmp_gt_i32 s[62:63], -14, v21
    v_cmp_gt_i32 vcc, -13, v21
    v_cndmask_b32 v104, v104, v20, s[20:21]
    v_cndmask_b32 v105, v105, v20, s[22:23]
    v_cndmask_b32 v106, v106, v20, s[62:63]
    v_cndmask_b32 v107, v107, v20, vcc
    v_cmp_gt_i32 s[20:21], 0, v21
    v_cmp_gt_i32 s[22:23], 1, v21
    v_cmp_gt_i32 s[62:63], 2, v21
    v_cmp_gt_i32 vcc, 3, v21
    v_cndmask_b32 v108, v108, v20, s[20:21]
    v_cndmask_b32 v109, v109, v20, s[22:23]
    v_cndmask_b32 v110, v110, v20, s[62:63]
    v_cndmask_b32 v111, v111, v20, vcc
    s_branch L_recurrent_scan__compressed_kv_cla__moe_arch_mod__prompt_kernel_back_72
L_recurrent_scan__compressed_kv_cla__moe_arch_mod__prompt_kernel_rare_81:
    s_mov_b32 s61, 0x40000
L_recurrent_scan__compressed_kv_cla__moe_arch_mod__prompt_kernel_spin_79:
    s_sub_u32 s61, s61, 1
    s_cbranch_scc1 L_recurrent_scan__compressed_kv_cla__moe_arch_mod__prompt_kernel_spinx_80
    s_sleep 8
    global_load_dword v14, v13, s[90:91] sc1
    s_waitcnt vmcnt(0)
    v_readfirstlane_b32 s36, v14
    s_nop 0
    s_cmp_lt_u32 s36, 8
    s_cbranch_scc1 L_recurrent_scan__compressed_kv_cla__moe_arch_mod__prompt_kernel_spin_79
L_recurrent_scan__compressed_kv_cla__moe_arch_mod__prompt_kernel_spinx_80:
    s_branch L_recurrent_scan__compressed_kv_cla__moe_arch_mod__prompt_kernel_back_82
L_recurrent_scan__compressed_kv_cla__moe_arch_mod__prompt_kernel_rare_87:
    s_cmp_eq_u32 s40, 1
    s_cbranch_scc0 L_recurrent_scan__compressed_kv_cla__moe_arch_mod__prompt_kernel_swn_84
    v_readfirstlane_b32 s36, v14
    s_nop 0
    s_cmp_lt_u32 s36, 8
    s_cbranch_scc1 L_recurrent_scan__compressed_kv_cla__moe_arch_mod__prompt_kernel_rare_81
L_recurrent_scan__compressed_kv_cla__moe_arch_mod__prompt_kernel_back_82:
    s_branch L_recurrent_scan__compressed_kv_cla__moe_arch_mod__prompt_kernel_swend_83
L_recurrent_scan__compressed_kv_cla__moe_arch_mod__prompt_kernel_swn_84:
    s_cmp_eq_u32 s40, 2
    s_cbranch_scc0 L_recurrent_scan__compressed_kv_cla__moe_arch_mod__prompt_kernel_swn_85
    s_mov_b32 s36, 4276224
    buffer_load_dwordx4 v[160:163], v7, s[24:27], s36 offen offset:0 sc1
    buffer_load_dwordx4 v[164:167], v7, s[24:27], s36 offen offset:1024 sc1
    s_branch L_recurrent_scan__compressed_kv_cla__moe_arch_mod__prompt_kernel_swend_83
L_recurrent_scan__compressed_kv_cla__moe_arch_mod__prompt_kernel_swn_85:
    s_cmp_eq_u32 s40, 3
    s_cbranch_scc0 L_recurrent_scan__compressed_kv_cla__moe_arch_mod__prompt_kernel_swn_86
    v_max_u32 v26, v160, v161
    v_min_u32 v27, v160, v161
    v_med3_u32 v27, v26, v27, v162
    v_max_u32 v26, v26, v162
    v_med3_u32 v27, v26, v27, v163
    v_max_u32 v26, v26, v163
    v_med3_u32 v27, v26, v27, v164
    v_max_u32 v26, v26, v164
    v_med3_u32 v27, v26, v27, v165
    v_max_u32 v26, v26, v165
    v_med3_u32 v27, v26, v27, v166
    v_max_u32 v26, v26, v166
    v_med3_u32 v27, v26, v27, v167
    v_max_u32 v26, v26, v167
    v_mov_b32 v28, v26
    s_nop 1
    v_max_u32_dpp v28, v28, v28 quad_perm:[1,0,3,2] row_mask:0xf bank_mask:0xf
    s_nop 1
    v_max_u32_dpp v28, v28, v28 quad_perm:[2,3,0,1] row_mask:0xf bank_mask:0xf
    s_nop 1
    v_max_u32_dpp v28, v28, v28 row_half_mirror row_mask:0xf bank_mask:0xf
    s_nop 1
    v_max_u32_dpp v28, v28, v28 row_mirror row_mask:0xf bank_mask:0xf
    s_nop 0
    v_readlane_b32 s20, v28, 0
    v_readlane_b32 s21, v28, 16
    v_readlane_b32 s22, v28, 32
    v_readlane_b32 s23, v28, 48
    s_max_u32 s20, s20, s21
    s_max_u32 s22, s22, s23
    s_max_u32 s20, s20, s22
    s_mov_b32 s58, s20
    v_cmp_eq_u32 vcc, s58, v26
    s_nop 1
    v_cndmask_b32 v28, v26, v27, vcc
    s_nop 1
    v_max_u32_dpp v28, v28, v28 quad_perm:[1,0,3,2] row_mask:0xf bank_mask:0xf
    s_nop 1
    v_max_u32_dpp v28, v28, v28 quad_perm:[2,3,0,1] row_mask:0xf bank_mask:0xf
    s_nop 1
    v_max_u32_dpp v28, v28, v28 row_half_mirror row_mask:0xf bank_mask:0xf
    s_nop 1
    v_max_u32_dpp v28, v28, v28 row_mirror row_mask:0xf bank_mask:0xf
    s_nop 0
    v_readlane_b32 s20, v28, 0
    v_readlane_b32 s21, v28, 16
    v_readlane_b32 s22, v28, 32
    v_readlane_b32 s23, v28, 48
    s_max_u32 s20, s20, s21
    s_max_u32 s22, s22, s23
    s_max_u32 s20, s20, s22
    s_mov_b32 s59, s20
    s_and_b32 s36, s58, 0xffff
    s_sub_u32 s56, 0xffff, s36
    s_and_b32 s36, s59, 0xffff
    s_sub_u32 s57, 0xffff, s36
    v_and_b32 v26, 1, v1
    v_mov_b32 v27, s56
    v_mov_b32 v28, s57
    v_cmp_eq_u32 vcc, 1, v26
    s_nop 1
    v_cndmask_b32 v27, v27, v28, vcc
    v_lshrrev_b32 v28, 4, v27
    v_lshlrev_b32 v28, 15, v28
    v_and_b32 v27, 15, v27
    v_lshl_add_u32 v28, v27, 4, v28
    v_lshrrev_b32 v29, 4, v1
    v_lshl_add_u32 v28, v29, 8, v28
    s_and_b32 s36, s3, 3
    s_lshl_b32 s36, s36, 13
    s_add_u32 s37, s36, 4096
    s_mov_b32 exec_lo, 0x00030003
    s_mov_b32 exec_hi, 0x00030003
    buffer_load_dwordx4 v[160:163], v28, s[24:27], s36 offen offset:0 sc1
    buffer_load_dwordx4 v[164:167], v28, s[24:27], s36 offen offset:1024 sc1
    buffer_load_dwordx4 v[168:171], v28, s[24:27], s36 offen offset:2048 sc1
    buffer_load_dwordx4 v[172:175], v28, s[24:27], s36 offen offset:3072 sc1
    buffer_load_dwordx4 v[176:179], v28, s[24:27], s37 offen offset:0 sc1
    buffer_load_dwordx4 v[180:183], v28, s[24:27], s37 offen offset:1024 sc1
    buffer_load_dwordx4 v[184:187], v28, s[24:27], s37 offen offset:2048 sc1
    buffer_load_dwordx4 v[188:191], v28, s[24:27], s37 offen offset:3072 sc1
    s_mov_b64 exec, -1
    s_branch L_recurrent_scan__compressed_kv_cla__moe_arch_mod__prompt_kernel_swend_83
L_recurrent_scan__compressed_kv_cla__moe_arch_mod__prompt_kernel_swn_86:
    s_sub_u32 s38, s40, s60
    s_cmp_eq_u32 s38, 0
    s_cbranch_scc0 L_recurrent_scan__compressed_kv_cla__moe_arch_mod__prompt_kernel_swn_75
    s_and_b32 s20, s3, 3
    s_lshl_b32 s20, s20, 8
    s_lshl_b32 s21, s28, 5
    s_add_u32 s20, s20, s21
    s_lshr_b32 s21, s3, 2
    s_lshl_b32 s21, s21, 7
    v_lshrrev_b32 v27, 3, v1
    s_lshl_b32 s36, s28, 5
    s_add_u32 s36, s36, s20
    v_add_u32 v27, s36, v27
    v_mul_u32_u24 v27, 7168, v27
    v_add_u32 v27, s21, v27
    v_bfe_u32 v28, v1, 4, 1
    v_lshlrev_b32 v28, 1, v28
    v_and_b32 v29, 7, v1
    v_xor_b32 v28, v28, v29
    v_lshl_add_u32 v26, v28, 4, v27
    v_xor_b32 v28, 4, v28
    v_lshl_add_u32 v27, v28, 4, v27
    v_add_u32 v27, 56320, v27
    v_add_u32 v28, 112640, v26
    v_add_u32 v29, 112640, v27
    s_lshl_b32 s36, s28, 13
    s_add_u32 m0, s36, 131072
    s_mov_b32 s37, 229376
    buffer_load_dwordx4 v26, s[4:7], 0 offen offset:0 nt lds
    buffer_load_dwordx4 v27, s[4:7], 0 offen offset:1024 nt lds
    buffer_load_dwordx4 v28, s[4:7], 0 offen offset:2048 nt lds
    buffer_load_dwordx4 v29, s[4:7], 0 offen offset:3072 nt lds
    s_add_u32 m0, s36, 135168
    s_nop 0
    buffer_load_dwordx4 v26, s[4:7], s37 offen offset:0 nt lds
    buffer_load_dwordx4 v27, s[4:7], s37 offen offset:1024 nt lds
    buffer_load_dwordx4 v28, s[4:7], s37 offen offset:2048 nt lds
    buffer_load_dwordx4 v29, s[4:7], s37 offen offset:3072 nt lds
    s_branch L_recurrent_scan__compressed_kv_cla__moe_arch_mod__prompt_kernel_swend_74
L_recurrent_scan__compressed_kv_cla__moe_arch_mod__prompt_kernel_swn_75:
    s_cmp_eq_u32 s38, 2
    s_cbranch_scc0 L_recurrent_scan__compressed_kv_cla__moe_arch_mod__prompt_kernel_swn_76
    v_lshrrev_b32 v8, 4, v1
    v_bfe_u32 v20, v1, 2, 2
    v_lshl_add_u32 v20, v8, 3, v20
    v_lshlrev_b32 v20, 7, v20
    v_and_b32 v21, 3, v1
    v_lshl_add_u32 v20, v21, 3, v20
    v_bfe_u32 v21, v1, 3, 2
    v_xor_b32 v21, s28, v21
    v_lshl_add_u32 v20, v21, 5, v20
    v_add_u32 v20, 131072, v20
    ds_read_b64_tr_b16 v[22:23], v20 offset:0
    ds_read_b64_tr_b16 v[24:25], v20 offset:512
    ds_read_b64_tr_b16 v[26:27], v20 offset:4096
    ds_read_b64_tr_b16 v[28:29], v20 offset:4608
    ds_read_b64_tr_b16 v[30:31], v20 offset:8192
    ds_read_b64_tr_b16 v[32:33], v20 offset:8704
    ds_read_b64_tr_b16 v[34:35], v20 offset:12288
    ds_read_b64_tr_b16 v[36:37], v20 offset:12800
    s_and_b32 s36, s3, 3
    s_lshl_b32 s36, s36, 6
    s_lshr_b32 s37, s3, 2
    s_lshl_b32 s37, s37, 12
    s_add_u32 s36, s36, s37
    s_lshl_b32 s37, s28, 10
    s_add_u32 s36, s36, s37
    s_add_u32 s36, s36, 58720256
    v_and_b32 v9, 1, v1
    v_lshlrev_b32 v9, 4, v9
    v_lshl_add_u32 v9, v8, 8, v9
    s_waitcnt lgkmcnt(0)
    v_mfma_f32_16x16x32_bf16 v[10:13], v[22:25], v[160:163], 0
    v_mfma_f32_16x16x32_bf16 v[10:13], v[26:29], v[164:167], v[10:13]
    v_mfma_f32_16x16x32_bf16 v[10:13], v[30:33], v[168:171], v[10:13]
    v_mfma_f32_16x16x32_bf16 v[10:13], v[34:37], v[172:175], v[10:13]
    ds_read_b64_tr_b16 v[22:23], v20 offset:16384
    ds_read_b64_tr_b16 v[24:25], v20 offset:16896
    ds_read_b64_tr_b16 v[26:27], v20 offset:20480
    ds_read_b64_tr_b16 v[28:29], v20 offset:20992
    ds_read_b64_tr_b16 v[30:31], v20 offset:24576
    ds_read_b64_tr_b16 v[32:33], v20 offset:25088
    ds_read_b64_tr_b16 v[34:35], v20 offset:28672
    ds_read_b64_tr_b16 v[36:37], v20 offset:29184
    s_waitcnt lgkmcnt(0)
    v_mfma_f32_16x16x32_bf16 v[10:13], v[22:25], v[176:179], v[10:13]
    v_mfma_f32_16x16x32_bf16 v[10:13], v[26:29], v[180:183], v[10:13]
    v_mfma_f32_16x16x32_bf16 v[10:13], v[30:33], v[184:187], v[10:13]
    v_mfma_f32_16x16x32_bf16 v[10:13], v[34:37], v[188:191], v[10:13]
    s_nop 5
    s_mov_b32 exec_lo, 0x00030003
    s_mov_b32 exec_hi, 0x00030003
    buffer_store_dwordx4 v[10:13], v9, s[24:27], s36 offen sc1
    s_mov_b64 exec, -1
    s_nop 1
    s_branch L_recurrent_scan__compressed_kv_cla__moe_arch_mod__prompt_kernel_swend_74
L_recurrent_scan__compressed_kv_cla__moe_arch_mod__prompt_kernel_swn_76:
    s_cmp_eq_u32 s38, 3
    s_cbranch_scc0 L_recurrent_scan__compressed_kv_cla__moe_arch_mod__prompt_kernel_swn_77
    s_and_b32 s20, s3, 3
    s_lshl_b32 s20, s20, 8
    s_lshl_b32 s21, s28, 5
    s_add_u32 s20, s20, s21
    s_lshr_b32 s21, s3, 2
    s_lshl_b32 s21, s21, 7
    v_lshrrev_b32 v27, 3, v1
    s_lshl_b32 s36, s28, 5
    s_add_u32 s36, s36, s20
    v_add_u32 v27, s36, v27
    v_mul_u32_u24 v27, 7168, v27
    v_add_u32 v27, s21, v27
    v_bfe_u32 v28, v1, 4, 1
    v_lshlrev_b32 v28, 1, v28
    v_and_b32 v29, 7, v1
    v_xor_b32 v28, v28, v29
    v_lshl_add_u32 v26, v28, 4, v27
    v_xor_b32 v28, 4, v28
    v_lshl_add_u32 v27, v28, 4, v27
    v_add_u32 v27, 56320, v27
    v_add_u32 v28, 112640, v26
    v_add_u32 v29, 112640, v27
    s_lshl_b32 s36, s28, 13
    s_add_u32 m0, s36, 131072
    s_mov_b32 s37, 229376
    buffer_load_dwordx4 v26, s[8:11], 0 offen offset:0 nt lds
    buffer_load_dwordx4 v27, s[8:11], 0 offen offset:1024 nt lds
    buffer_load_dwordx4 v28, s[8:11], 0 offen offset:2048 nt lds
    buffer_load_dwordx4 v29, s[8:11], 0 offen offset:3072 nt lds
    s_add_u32 m0, s36, 135168
    s_nop 0
    buffer_load_dwordx4 v26, s[8:11], s37 offen offset:0 nt lds
    buffer_load_dwordx4 v27, s[8:11], s37 offen offset:1024 nt lds
    buffer_load_dwordx4 v28, s[8:11], s37 offen offset:2048 nt lds
    buffer_load_dwordx4 v29, s[8:11], s37 offen offset:3072 nt lds
    s_branch L_recurrent_scan__compressed_kv_cla__moe_arch_mod__prompt_kernel_swend_74
L_recurrent_scan__compressed_kv_cla__moe_arch_mod__prompt_kernel_swn_77:
    s_cmp_eq_u32 s38, 5
    s_cbranch_scc0 L_recurrent_scan__compressed_kv_cla__moe_arch_mod__prompt_kernel_swn_78
    v_lshrrev_b32 v8, 4, v1
    v_bfe_u32 v20, v1, 2, 2
    v_lshl_add_u32 v20, v8, 3, v20
    v_lshlrev_b32 v20, 7, v20
    v_and_b32 v21, 3, v1
    v_lshl_add_u32 v20, v21, 3, v20
    v_bfe_u32 v21, v1, 3, 2
    v_xor_b32 v21, s28, v21
    v_lshl_add_u32 v20, v21, 5, v20
    v_add_u32 v20, 131072, v20
    ds_read_b64_tr_b16 v[22:23], v20 offset:0
    ds_read_b64_tr_b16 v[24:25], v20 offset:512
    ds_read_b64_tr_b16 v[26:27], v20 offset:4096
    ds_read_b64_tr_b16 v[28:29], v20 offset:4608
    ds_read_b64_tr_b16 v[30:31], v20 offset:8192
    ds_read_b64_tr_b16 v[32:33], v20 offset:8704
    ds_read_b64_tr_b16 v[34:35], v20 offset:12288
    ds_read_b64_tr_b16 v[36:37], v20 offset:12800
    s_and_b32 s36, s3, 3
    s_lshl_b32 s36, s36, 6
    s_lshr_b32 s37, s3, 2
    s_lshl_b32 s37, s37, 12
    s_add_u32 s36, s36, s37
    s_lshl_b32 s37, s28, 10
    s_add_u32 s36, s36, s37
    s_add_u32 s36, s36, 58720288
    v_and_b32 v9, 1, v1
    v_lshlrev_b32 v9, 4, v9
    v_lshl_add_u32 v9, v8, 8, v9
    s_waitcnt lgkmcnt(0)
    v_mfma_f32_16x16x32_bf16 v[10:13], v[22:25], v[160:163], 0
    v_mfma_f32_16x16x32_bf16 v[10:13], v[26:29], v[164:167], v[10:13]
    v_mfma_f32_16x16x32_bf16 v[10:13], v[30:33], v[168:171], v[10:13]
    v_mfma_f32_16x16x32_bf16 v[10:13], v[34:37], v[172:175], v[10:13]
    ds_read_b64_tr_b16 v[22:23], v20 offset:16384
    ds_read_b64_tr_b16 v[24:25], v20 offset:16896
    ds_read_b64_tr_b16 v[26:27], v20 offset:20480
    ds_read_b64_tr_b16 v[28:29], v20 offset:20992
    ds_read_b64_tr_b16 v[30:31], v20 offset:24576
    ds_read_b64_tr_b16 v[32:33], v20 offset:25088
    ds_read_b64_tr_b16 v[34:35], v20 offset:28672
    ds_read_b64_tr_b16 v[36:37], v20 offset:29184
    s_waitcnt lgkmcnt(0)
    v_mfma_f32_16x16x32_bf16 v[10:13], v[22:25], v[176:179], v[10:13]
    v_mfma_f32_16x16x32_bf16 v[10:13], v[26:29], v[180:183], v[10:13]
    v_mfma_f32_16x16x32_bf16 v[10:13], v[30:33], v[184:187], v[10:13]
    v_mfma_f32_16x16x32_bf16 v[10:13], v[34:37], v[188:191], v[10:13]
    s_nop 5
    s_mov_b32 exec_lo, 0x00030003
    s_mov_b32 exec_hi, 0x00030003
    buffer_store_dwordx4 v[10:13], v9, s[24:27], s36 offen sc1
    s_mov_b64 exec, -1
    s_nop 1
    s_branch L_recurrent_scan__compressed_kv_cla__moe_arch_mod__prompt_kernel_swend_74
L_recurrent_scan__compressed_kv_cla__moe_arch_mod__prompt_kernel_swn_78:
    s_mul_i32 s36, s3, 2341
    s_lshr_b32 s36, s36, 16
    s_add_u32 s36, s36, 48
    s_lshl_b32 s36, s36, 7
    v_mov_b32 v20, s36
    v_mov_b32 v21, 1
    s_mov_b64 exec, 1
    global_atomic_add v20, v21, s[90:91]
    s_mov_b64 exec, -1
    s_nop 3
L_recurrent_scan__compressed_kv_cla__moe_arch_mod__prompt_kernel_swend_74:
L_recurrent_scan__compressed_kv_cla__moe_arch_mod__prompt_kernel_swend_83:
    s_branch L_recurrent_scan__compressed_kv_cla__moe_arch_mod__prompt_kernel_back_88
L_recurrent_scan__compressed_kv_cla__moe_arch_mod__prompt_kernel_rare_97:
    v_mov_b32 v20, 4048155338
    v_subrev_u32 v21, s49, v18
    v_cmp_gt_i32 s[20:21], 0, v21
    v_cmp_gt_i32 s[22:23], 1, v21
    v_cmp_gt_i32 s[62:63], 2, v21
    v_cmp_gt_i32 vcc, 3, v21
    v_cndmask_b32 v112, v112, v20, s[20:21]
    v_cndmask_b32 v113, v113, v20, s[22:23]
    v_cndmask_b32 v114, v114, v20, s[62:63]
    v_cndmask_b32 v115, v115, v20, vcc
    v_cmp_gt_i32 s[20:21], 16, v21
    v_cmp_gt_i32 s[22:23], 17, v21
    v_cmp_gt_i32 s[62:63], 18, v21
    v_cmp_gt_i32 vcc, 19, v21
    v_cndmask_b32 v116, v116, v20, s[20:21]
    v_cndmask_b32 v117, v117, v20, s[22:23]
    v_cndmask_b32 v118, v118, v20, s[62:63]
    v_cndmask_b32 v119, v119, v20, vcc
    v_cmp_gt_i32 s[20:21], -16, v21
    v_cmp_gt_i32 s[22:23], -15, v21
    v_cmp_gt_i32 s[62:63], -14, v21
    v_cmp_gt_i32 vcc, -13, v21
    v_cndmask_b32 v120, v120, v20, s[20:21]
    v_cndmask_b32 v121, v121, v20, s[22:23]
    v_cndmask_b32 v122, v122, v20, s[62:63]
    v_cndmask_b32 v123, v123, v20, vcc
    v_cmp_gt_i32 s[20:21], 0, v21
    v_cmp_gt_i32 s[22:23], 1, v21
    v_cmp_gt_i32 s[62:63], 2, v21
    v_cmp_gt_i32 vcc, 3, v21
    v_cndmask_b32 v124, v124, v20, s[20:21]
    v_cndmask_b32 v125, v125, v20, s[22:23]
    v_cndmask_b32 v126, v126, v20, s[62:63]
    v_cndmask_b32 v127, v127, v20, vcc
    s_branch L_recurrent_scan__compressed_kv_cla__moe_arch_mod__prompt_kernel_back_98
L_recurrent_scan__compressed_kv_cla__moe_arch_mod__prompt_kernel_rare_101:
    s_mov_b32 s61, 0x40000
L_recurrent_scan__compressed_kv_cla__moe_arch_mod__prompt_kernel_spin_99:
    s_sub_u32 s61, s61, 1
    s_cbranch_scc1 L_recurrent_scan__compressed_kv_cla__moe_arch_mod__prompt_kernel_spinx_100
    s_sleep 8
    global_load_dword v11, v12, s[90:91] sc1
    s_waitcnt vmcnt(0)
    v_readfirstlane_b32 s36, v11
    s_nop 0
    s_cmp_lt_u32 s36, 28
    s_cbranch_scc1 L_recurrent_scan__compressed_kv_cla__moe_arch_mod__prompt_kernel_spin_99
L_recurrent_scan__compressed_kv_cla__moe_arch_mod__prompt_kernel_spinx_100:
    s_branch L_recurrent_scan__compressed_kv_cla__moe_arch_mod__prompt_kernel_back_102
L_recurrent_scan__compressed_kv_cla__moe_arch_mod__prompt_kernel_rare_106:
    v_mov_b32 v20, 4048155338
    v_subrev_u32 v21, s50, v18
    v_cmp_gt_i32 s[20:21], 0, v21
    v_cmp_gt_i32 s[22:23], 1, v21
    v_cmp_gt_i32 s[62:63], 2, v21
    v_cmp_gt_i32 vcc, 3, v21
    v_cndmask_b32 v96, v96, v20, s[20:21]
    v_cndmask_b32 v97, v97, v20, s[22:23]
    v_cndmask_b32 v98, v98, v20, s[62:63]
    v_cndmask_b32 v99, v99, v20, vcc
    v_cmp_gt_i32 s[20:21], 16, v21
    v_cmp_gt_i32 s[22:23], 17, v21
    v_cmp_gt_i32 s[62:63], 18, v21
    v_cmp_gt_i32 vcc, 19, v21
    v_cndmask_b32 v100, v100, v20, s[20:21]
    v_cndmask_b32 v101, v101, v20, s[22:23]
    v_cndmask_b32 v102, v102, v20, s[62:63]
    v_cndmask_b32 v103, v103, v20, vcc
    v_cmp_gt_i32 s[20:21], -16, v21
    v_cmp_gt_i32 s[22:23], -15, v21
    v_cmp_gt_i32 s[62:63], -14, v21
    v_cmp_gt_i32 vcc, -13, v21
    v_cndmask_b32 v104, v104, v20, s[20:21]
    v_cndmask_b32 v105, v105, v20, s[22:23]
    v_cndmask_b32 v106, v106, v20, s[62:63]
    v_cndmask_b32 v107, v107, v20, vcc
    v_cmp_gt_i32 s[20:21], 0, v21
    v_cmp_gt_i32 s[22:23], 1, v21
    v_cmp_gt_i32 s[62:63], 2, v21
    v_cmp_gt_i32 vcc, 3, v21
    v_cndmask_b32 v108, v108, v20, s[20:21]
    v_cndmask_b32 v109, v109, v20, s[22:23]
    v_cndmask_b32 v110, v110, v20, s[62:63]
    v_cndmask_b32 v111, v111, v20, vcc
    s_branch L_recurrent_scan__compressed_kv_cla__moe_arch_mod__prompt_kernel_back_107
L_grp1:
    v_mov_b32 v20, 1040356334
    v_mov_b32 v21, v20
    s_and_b32 s37, s28, 3
    s_lshl_b32 s37, s37, 13
    v_lshlrev_b32 v7, 4, v1
    v_add_u32 v4, s37, v7
    v_add_u32 v6, 4096, v4
    v_add_u32 v19, 131072, v4
    s_add_u32 s43, s37, 32768
    s_add_u32 s44, s37, 98304
    s_waitcnt vmcnt(4) lgkmcnt(0)
    v_pk_mul_f32 v[192:193], v[192:193], v[20:21]
    v_pk_mul_f32 v[194:195], v[194:195], v[20:21]
    v_pk_mul_f32 v[196:197], v[196:197], v[20:21]
    v_pk_mul_f32 v[198:199], v[198:199], v[20:21]
    v_cvt_pk_bf16_f32 v128, v192, v193
    v_cvt_pk_bf16_f32 v129, v194, v195
    v_cvt_pk_bf16_f32 v130, v196, v197
    v_cvt_pk_bf16_f32 v131, v198, v199
    v_pk_mul_f32 v[200:201], v[200:201], v[20:21]
    v_pk_mul_f32 v[202:203], v[202:203], v[20:21]
    v_pk_mul_f32 v[204:205], v[204:205], v[20:21]
    v_pk_mul_f32 v[206:207], v[206:207], v[20:21]
    v_cvt_pk_bf16_f32 v132, v200, v201
    v_cvt_pk_bf16_f32 v133, v202, v203
    v_cvt_pk_bf16_f32 v134, v204, v205
    v_cvt_pk_bf16_f32 v135, v206, v207
    v_pk_mul_f32 v[208:209], v[208:209], v[20:21]
    v_pk_mul_f32 v[210:211], v[210:211], v[20:21]
    v_pk_mul_f32 v[212:213], v[212:213], v[20:21]
    v_pk_mul_f32 v[214:215], v[214:215], v[20:21]
    v_cvt_pk_bf16_f32 v136, v208, v209
    v_cvt_pk_bf16_f32 v137, v210, v211
    v_cvt_pk_bf16_f32 v138, v212, v213
    v_cvt_pk_bf16_f32 v139, v214, v215
    v_pk_mul_f32 v[216:217], v[216:217], v[20:21]
    v_pk_mul_f32 v[218:219], v[218:219], v[20:21]
    v_pk_mul_f32 v[220:221], v[220:221], v[20:21]
    v_pk_mul_f32 v[222:223], v[222:223], v[20:21]
    v_cvt_pk_bf16_f32 v140, v216, v217
    v_cvt_pk_bf16_f32 v141, v218, v219
    v_cvt_pk_bf16_f32 v142, v220, v221
    v_cvt_pk_bf16_f32 v143, v222, v223
    v_pk_mul_f32 v[224:225], v[224:225], v[20:21]
    v_pk_mul_f32 v[226:227], v[226:227], v[20:21]
    v_pk_mul_f32 v[228:229], v[228:229], v[20:21]
    v_pk_mul_f32 v[230:231], v[230:231], v[20:21]
    v_cvt_pk_bf16_f32 v144, v224, v225
    v_cvt_pk_bf16_f32 v145, v226, v227
    v_cvt_pk_bf16_f32 v146, v228, v229
    v_cvt_pk_bf16_f32 v147, v230, v231
    v_pk_mul_f32 v[232:233], v[232:233], v[20:21]
    v_pk_mul_f32 v[234:235], v[234:235], v[20:21]
    v_pk_mul_f32 v[236:237], v[236:237], v[20:21]
    v_pk_mul_f32 v[238:239], v[238:239], v[20:21]
    v_cvt_pk_bf16_f32 v148, v232, v233
    v_cvt_pk_bf16_f32 v149, v234, v235
    v_cvt_pk_bf16_f32 v150, v236, v237
    v_cvt_pk_bf16_f32 v151, v238, v239
    v_pk_mul_f32 v[240:241], v[240:241], v[20:21]
    v_pk_mul_f32 v[242:243], v[242:243], v[20:21]
    v_pk_mul_f32 v[244:245], v[244:245], v[20:21]
    v_pk_mul_f32 v[246:247], v[246:247], v[20:21]
    v_cvt_pk_bf16_f32 v152, v240, v241
    v_cvt_pk_bf16_f32 v153, v242, v243
    v_cvt_pk_bf16_f32 v154, v244, v245
    v_cvt_pk_bf16_f32 v155, v246, v247
    v_pk_mul_f32 v[248:249], v[248:249], v[20:21]
    v_pk_mul_f32 v[250:251], v[250:251], v[20:21]
    v_pk_mul_f32 v[252:253], v[252:253], v[20:21]
    v_pk_mul_f32 v[254:255], v[254:255], v[20:21]
    v_cvt_pk_bf16_f32 v156, v248, v249
    v_cvt_pk_bf16_f32 v157, v250, v251
    v_cvt_pk_bf16_f32 v158, v252, v253
    v_cvt_pk_bf16_f32 v159, v254, v255
    v_mov_b32 v2, v7
    v_and_b32 v21, 15, v1
    v_lshrrev_b32 v22, 4, v1
    v_lshlrev_b32 v22, 2, v22
    v_sub_u32 v18, v21, v22
    s_mov_b32 s40, 0
    s_mov_b32 s41, 0
    s_lshl_b32 s51, s30, 1
    s_add_u32 s51, s51, 1
    s_and_b32 s36, s28, 3
    s_lshl_b32 s36, s36, 5
    s_lshl_b32 s37, s30, 7
    s_add_u32 s36, s36, s37
    s_sub_u32 s50, 0, s36
    s_lshl_b32 s42, s30, 8
    s_sub_u32 s42, s42, 1792
    s_mov_b64 s[52:53], 0
    s_mov_b32 s31, 0x3f803f80
    s_waitcnt lgkmcnt(0)
    s_barrier
    ds_read_b128 v[160:163], v19 offset:0
    ds_read_b128 v[164:167], v19 offset:1024
    ds_read_b128 v[168:171], v19 offset:2048
    ds_read_b128 v[172:175], v19 offset:3072
    ds_read_b128 v[176:179], v19 offset:4096
    ds_read_b128 v[180:183], v19 offset:5120
    ds_read_b128 v[184:187], v19 offset:6144
    ds_read_b128 v[188:191], v19 offset:7168
    s_add_u32 s16, s54, 41943040
    s_addc_u32 s17, s55, 0
    s_and_b32 s17, s17, 0xffff
    s_mov_b32 s18, 16777216
    s_mov_b32 s19, 0x20000
    s_cmp_eq_u32 s28, 4
    s_cbranch_scc1 L_recurrent_scan__compressed_kv_cla__moe_arch_mod__prompt_kernel_rare_108
L_recurrent_scan__compressed_kv_cla__moe_arch_mod__prompt_kernel_back_109:
    s_sub_u32 s36, s2, 128
    s_lshl_b32 s36, s36, 1
    s_and_b32 s37, s28, 1
    s_add_u32 s36, s36, s37
    s_cmp_lt_u32 s28, 6
    s_cselect_b64 s[4:5], s[32:33], s[34:35]
    s_cselect_b32 s37, 32, 28
    s_lshl_b32 s37, s37, 3
    s_cmp_lt_u32 s36, s37
    s_cselect_b32 s6, 32768, 0
    s_cselect_b32 s36, s36, 0
    s_lshl_b32 s36, s36, 15
    s_add_u32 s4, s4, s36
    s_addc_u32 s5, s5, 0
    s_and_b32 s5, s5, 0xffff
    s_mov_b32 s7, 0x20000
    v_cmp_gt_u32 vcc, 32, v1
    v_lshlrev_b32 v13, 7, v1
    v_mov_b32 v12, 0x100000
    v_cndmask_b32 v13, v12, v13, vcc
    s_mov_b32 s48, 0
    s_mov_b32 s39, 2
    s_cmp_eq_u32 s28, 5
    s_cselect_b32 s36, 8192, 0
    s_or_b32 s39, s39, s36
    ds_read_b128 v[64:67], v2 offset:0
    ds_read_b128 v[68:71], v2 offset:1024
    ds_read_b128 v[72:75], v2 offset:2048
    ds_read_b128 v[76:79], v2 offset:3072
    ds_read_b128 v[80:83], v2 offset:4096
    ds_read_b128 v[84:87], v2 offset:5120
    ds_read_b128 v[88:91], v2 offset:6144
    ds_read_b128 v[92:95], v2 offset:7168
    s_waitcnt lgkmcnt(7)
    v_mfma_f32_16x16x32_bf16 v[96:99], v[64:67], v[128:131], 0
    v_mov_b64 v[192:193], 0
    v_mov_b64 v[194:195], 0
    v_mfma_f32_16x16x32_bf16 v[104:107], v[64:67], v[144:147], 0
    ds_read_b128 v[64:67], v2 offset:8192
    v_mov_b64 v[196:197], 0
    s_waitcnt lgkmcnt(7)
    v_mfma_f32_16x16x32_bf16 v[96:99], v[68:71], v[132:135], v[96:99]
    v_mov_b64 v[198:199], 0
    v_mfma_f32_16x16x32_bf16 v[104:107], v[68:71], v[148:151], v[104:107]
    ds_read_b128 v[68:71], v2 offset:9216
    v_mov_b64 v[200:201], 0
    s_waitcnt lgkmcnt(7)
    v_mfma_f32_16x16x32_bf16 v[96:99], v[72:75], v[136:139], v[96:99]
    v_mov_b64 v[202:203], 0
    v_mfma_f32_16x16x32_bf16 v[104:107], v[72:75], v[152:155], v[104:107]
    ds_read_b128 v[72:75], v2 offset:10240
    v_mov_b64 v[204:205], 0
    s_waitcnt lgkmcnt(7)
    v_mfma_f32_16x16x32_bf16 v[96:99], v[76:79], v[140:143], v[96:99]
    v_mov_b64 v[206:207], 0
    v_mfma_f32_16x16x32_bf16 v[104:107], v[76:79], v[156:159], v[104:107]
    ds_read_b128 v[76:79], v2 offset:11264
    v_mov_b64 v[208:209], 0
    s_waitcnt lgkmcnt(7)
    v_mfma_f32_16x16x32_bf16 v[100:103], v[80:83], v[128:131], 0
    v_mov_b64 v[210:211], 0
    v_mfma_f32_16x16x32_bf16 v[108:111], v[80:83], v[144:147], 0
    ds_read_b128 v[80:83], v2 offset:12288
    v_mov_b64 v[212:213], 0
    s_waitcnt lgkmcnt(7)
    v_mfma_f32_16x16x32_bf16 v[100:103], v[84:87], v[132:135], v[100:103]
    v_mov_b64 v[214:215], 0
    v_mfma_f32_16x16x32_bf16 v[108:111], v[84:87], v[148:151], v[108:111]
    ds_read_b128 v[84:87], v2 offset:13312
    v_mov_b64 v[216:217], 0
    s_waitcnt lgkmcnt(7)
    v_mfma_f32_16x16x32_bf16 v[100:103], v[88:91], v[136:139], v[100:103]
    v_mov_b64 v[218:219], 0
    v_mfma_f32_16x16x32_bf16 v[108:111], v[88:91], v[152:155], v[108:111]
    ds_read_b128 v[88:91], v2 offset:14336
    v_mov_b64 v[220:221], 0
    s_waitcnt lgkmcnt(7)
    v_mfma_f32_16x16x32_bf16 v[100:103], v[92:95], v[140:143], v[100:103]
    v_mov_b64 v[222:223], 0
    v_mfma_f32_16x16x32_bf16 v[108:111], v[92:95], v[156:159], v[108:111]
    ds_read_b128 v[92:95], v2 offset:15360
    v_mov_b64 v[224:225], 0
    s_waitcnt lgkmcnt(7)
    v_mfma_f32_16x16x32_bf16 v[112:115], v[64:67], v[128:131], 0
    v_mov_b64 v[226:227], 0
    v_mfma_f32_16x16x32_bf16 v[120:123], v[64:67], v[144:147], 0
    v_mov_b64 v[228:229], 0
    s_waitcnt lgkmcnt(6)
    v_mfma_f32_16x16x32_bf16 v[112:115], v[68:71], v[132:135], v[112:115]
    v_mov_b64 v[230:231], 0
    v_mfma_f32_16x16x32_bf16 v[120:123], v[68:71], v[148:151], v[120:123]
    v_mov_b64 v[232:233], 0
    s_waitcnt lgkmcnt(5)
    v_mfma_f32_16x16x32_bf16 v[112:115], v[72:75], v[136:139], v[112:115]
    v_mov_b64 v[234:235], 0
    v_mfma_f32_16x16x32_bf16 v[120:123], v[72:75], v[152:155], v[120:123]
    v_mov_b64 v[236:237], 0
    s_waitcnt lgkmcnt(4)
    v_mfma_f32_16x16x32_bf16 v[112:115], v[76:79], v[140:143], v[112:115]
    v_mov_b64 v[238:239], 0
    v_mfma_f32_16x16x32_bf16 v[120:123], v[76:79], v[156:159], v[120:123]
    v_mov_b64 v[240:241], 0
    s_waitcnt lgkmcnt(3)
    v_mfma_f32_16x16x32_bf16 v[116:119], v[80:83], v[128:131], 0
    v_mov_b64 v[242:243], 0
    v_mfma_f32_16x16x32_bf16 v[124:127], v[80:83], v[144:147], 0
    v_mov_b64 v[244:245], 0
    s_waitcnt lgkmcnt(2)
    v_mfma_f32_16x16x32_bf16 v[116:119], v[84:87], v[132:135], v[116:119]
    v_mov_b64 v[246:247], 0
    v_mfma_f32_16x16x32_bf16 v[124:127], v[84:87], v[148:151], v[124:127]
    v_mov_b64 v[248:249], 0
    s_waitcnt lgkmcnt(1)
    v_mfma_f32_16x16x32_bf16 v[116:119], v[88:91], v[136:139], v[116:119]
    v_mov_b64 v[250:251], 0
    v_mfma_f32_16x16x32_bf16 v[124:127], v[88:91], v[152:155], v[124:127]
    v_mov_b64 v[252:253], 0
    s_waitcnt lgkmcnt(0)
    v_mfma_f32_16x16x32_bf16 v[116:119], v[92:95], v[140:143], v[116:119]
    v_mov_b64 v[254:255], 0
    v_mfma_f32_16x16x32_bf16 v[124:127], v[92:95], v[156:159], v[124:127]
    v_mov_b64 v[38:39], 0
    s_cmp_lt_i32 s50, 0
    s_cbranch_scc0 L_recurrent_scan__compressed_kv_cla__moe_arch_mod__prompt_kernel_rare_110
L_recurrent_scan__compressed_kv_cla__moe_arch_mod__prompt_kernel_back_111:
    s_add_u32 s49, s50, 32
    v_add_u32 v24, 65536, v2
    s_cmp_lt_u32 s40, s51
    s_cselect_b32 s36, 64, 128
    s_add_u32 s41, s41, s36
    s_cmp_eq_u32 s40, s51
    s_cselect_b32 s36, s42, s36
    s_add_u32 s50, s50, s36
    s_and_b32 s36, s41, 0xff
    v_lshl_add_u32 v2, s36, 8, v7
    s_cmp_eq_u32 s40, 16
    s_cselect_b64 s[20:21], -1, 0
    v_cndmask_b32 v5, v2, v24, s[20:21]
    v_mov_b32 v3, v24
    s_waitcnt vmcnt(1)
    s_cmp_eq_u32 s28, 4
    s_cbranch_scc1 L_recurrent_scan__compressed_kv_cla__moe_arch_mod__prompt_kernel_pw_112
    s_waitcnt vmcnt(0)
L_recurrent_scan__compressed_kv_cla__moe_arch_mod__prompt_kernel_pw_112:
    s_barrier
    ds_read_b128 v[64:67], v5 offset:0
    ds_read_b128 v[68:71], v5 offset:1024
    ds_read_b128 v[72:75], v5 offset:2048
    ds_read_b128 v[76:79], v5 offset:3072
    ds_read_b128 v[80:83], v5 offset:4096
    ds_read_b128 v[84:87], v5 offset:5120
    ds_read_b128 v[88:91], v5 offset:6144
    v_max3_f32 v21, v96, v97, v98
    v_max3_f32 v21, v21, v99, v100
    v_max3_f32 v21, v21, v101, v102
    v_max_f32 v21, v21, v103
    v_max3_f32 v22, v104, v105, v106
    v_max3_f32 v22, v22, v107, v108
    v_max3_f32 v22, v22, v109, v110
    v_max_f32 v22, v22, v111
    v_mov_b32 v23, v21
    s_nop 1
    v_permlane16_swap_b32 v21, v23
    s_nop 1
    v_max_f32 v21, v21, v23
    v_mov_b32 v23, v21
    s_nop 1
    v_permlane32_swap_b32 v21, v23
    s_nop 1
    v_max_f32 v21, v21, v23
    v_mov_b32 v23, v22
    s_nop 1
    v_permlane16_swap_b32 v22, v23
    s_nop 1
    v_max_f32 v22, v22, v23
    v_mov_b32 v23, v22
    s_nop 1
    v_permlane32_swap_b32 v22, v23
    s_nop 1
    v_max_f32 v22, v22, v23
    v_sub_f32 v40, 0, v21
    v_sub_f32 v41, 0, v21
    v_sub_f32 v42, 0, v21
    v_sub_f32 v43, 0, v21
    v_sub_f32 v44, 0, v22
    v_sub_f32 v45, 0, v22
    v_sub_f32 v46, 0, v22
    v_sub_f32 v47, 0, v22
    v_pk_add_f32 v[96:97], v[96:97], v[40:41]
    v_pk_add_f32 v[98:99], v[98:99], v[40:41]
    v_pk_add_f32 v[100:101], v[100:101], v[40:41]
    v_pk_add_f32 v[102:103], v[102:103], v[40:41]
    v_pk_add_f32 v[104:105], v[104:105], v[44:45]
    v_pk_add_f32 v[106:107], v[106:107], v[44:45]
    v_pk_add_f32 v[108:109], v[108:109], v[44:45]
    v_pk_add_f32 v[110:111], v[110:111], v[44:45]
    v_pk_add_f32 v[112:113], v[112:113], v[40:41]
    v_pk_add_f32 v[114:115], v[114:115], v[40:41]
    v_pk_add_f32 v[116:117], v[116:117], v[40:41]
    v_pk_add_f32 v[118:119], v[118:119], v[40:41]
    v_pk_add_f32 v[120:121], v[120:121], v[44:45]
    v_pk_add_f32 v[122:123], v[122:123], v[44:45]
    v_pk_add_f32 v[124:125], v[124:125], v[44:45]
    v_pk_add_f32 v[126:127], v[126:127], v[44:45]
    v_exp_f32 v96, v96
    v_exp_f32 v97, v97
    v_add_f32 v38, v38, v96
    v_exp_f32 v98, v98
    v_add_f32 v38, v38, v97
    v_cvt_pk_bf16_f32 v48, v96, v97
    v_exp_f32 v99, v99
    v_add_f32 v38, v38, v98
    v_exp_f32 v104, v104
    v_add_f32 v38, v38, v99
    v_cvt_pk_bf16_f32 v49, v98, v99
    v_exp_f32 v105, v105
    v_add_f32 v39, v39, v104
    v_exp_f32 v106, v106
    v_add_f32 v39, v39, v105
    v_cvt_pk_bf16_f32 v52, v104, v105
    v_exp_f32 v107, v107
    v_add_f32 v39, v39, v106
    v_exp_f32 v100, v100
    v_add_f32 v39, v39, v107
    v_cvt_pk_bf16_f32 v53, v106, v107
    v_exp_f32 v101, v101
    v_add_f32 v38, v38, v100
    v_exp_f32 v102, v102
    v_add_f32 v38, v38, v101
    v_cvt_pk_bf16_f32 v50, v100, v101
    v_exp_f32 v103, v103
    v_add_f32 v38, v38, v102
    v_exp_f32 v108, v108
    v_add_f32 v38, v38, v103
    v_cvt_pk_bf16_f32 v51, v102, v103
    v_exp_f32 v109, v109
    v_add_f32 v39, v39, v108
    v_exp_f32 v110, v110
    v_add_f32 v39, v39, v109
    v_cvt_pk_bf16_f32 v54, v108, v109
    v_exp_f32 v111, v111
    v_add_f32 v39, v39, v110
    s_nop 0
    v_add_f32 v39, v39, v111
    v_cvt_pk_bf16_f32 v55, v110, v111
    .p2align 6
L_body1:
    s_cmp_lt_i32 s49, 0
    s_cbranch_scc0 L_recurrent_scan__compressed_kv_cla__moe_arch_mod__prompt_kernel_rare_113
L_recurrent_scan__compressed_kv_cla__moe_arch_mod__prompt_kernel_back_114:
    s_waitcnt lgkmcnt(3)
    v_mfma_f32_16x16x32_bf16 v[96:99], v[64:67], v[128:131], v[40:43]
    v_exp_f32 v112, v112
    v_mfma_f32_16x16x32_bf16 v[104:107], v[64:67], v[144:147], v[44:47]
    ds_read_b128 v[92:95], v2 offset:7168
    v_mfma_f32_16x16x32_bf16 v[96:99], v[68:71], v[132:135], v[96:99]
    v_exp_f32 v113, v113
    v_mfma_f32_16x16x32_bf16 v[104:107], v[68:71], v[148:151], v[104:107]
    ds_read_b128 v[64:67], v3 offset:0
    v_add_f32 v38, v38, v112
    v_mfma_f32_16x16x32_bf16 v[96:99], v[72:75], v[136:139], v[96:99]
    v_exp_f32 v114, v114
    v_mfma_f32_16x16x32_bf16 v[104:107], v[72:75], v[152:155], v[104:107]
    ds_read_b128 v[68:71], v3 offset:1024
    v_add_f32 v38, v38, v113
    v_cvt_pk_bf16_f32 v56, v112, v113
    v_mfma_f32_16x16x32_bf16 v[96:99], v[76:79], v[140:143], v[96:99]
    v_exp_f32 v115, v115
    v_mfma_f32_16x16x32_bf16 v[104:107], v[76:79], v[156:159], v[104:107]
    ds_read_b128 v[72:75], v3 offset:2048
    v_add_f32 v38, v38, v114
    s_waitcnt lgkmcnt(3)
    v_mfma_f32_16x16x32_bf16 v[100:103], v[80:83], v[128:131], v[40:43]
    v_exp_f32 v120, v120
    v_mfma_f32_16x16x32_bf16 v[108:111], v[80:83], v[144:147], v[44:47]
    ds_read_b128 v[76:79], v3 offset:3072
    v_add_f32 v38, v38, v115
    v_cvt_pk_bf16_f32 v57, v114, v115
    v_mfma_f32_16x16x32_bf16 v[100:103], v[84:87], v[132:135], v[100:103]
    v_exp_f32 v121, v121
    v_mfma_f32_16x16x32_bf16 v[108:111], v[84:87], v[148:151], v[108:111]
    ds_read_b128 v[80:83], v3 offset:4096
    v_add_f32 v39, v39, v120
    v_mfma_f32_16x16x32_bf16 v[100:103], v[88:91], v[136:139], v[100:103]
    v_exp_f32 v122, v122
    v_mfma_f32_16x16x32_bf16 v[108:111], v[88:91], v[152:155], v[108:111]
    ds_read_b128 v[84:87], v3 offset:5120
    v_add_f32 v39, v39, v121
    v_cvt_pk_bf16_f32 v60, v120, v121
    v_mfma_f32_16x16x32_bf16 v[100:103], v[92:95], v[140:143], v[100:103]
    v_exp_f32 v123, v123
    v_mfma_f32_16x16x32_bf16 v[108:111], v[92:95], v[156:159], v[108:111]
    ds_read_b128 v[88:91], v3 offset:6144
    v_add_f32 v39, v39, v122
    s_waitcnt lgkmcnt(3)
    v_mfma_f32_16x16x32_bf16 v[192:195], v[64:67], v[48:51], v[192:195]
    v_exp_f32 v116, v116
    v_mfma_f32_16x16x32_bf16 v[224:227], v[64:67], v[52:55], v[224:227]
    ds_read_b128 v[92:95], v3 offset:7168
    v_add_f32 v39, v39, v123
    v_cvt_pk_bf16_f32 v61, v122, v123
    v_mfma_f32_16x16x32_bf16 v[196:199], v[68:71], v[48:51], v[196:199]
    v_exp_f32 v117, v117
    v_mfma_f32_16x16x32_bf16 v[228:231], v[68:71], v[52:55], v[228:231]
    ds_read_b128 v[64:67], v2 offset:8192
    v_add_f32 v38, v38, v116
    v_mfma_f32_16x16x32_bf16 v[200:203], v[72:75], v[48:51], v[200:203]
    v_exp_f32 v118, v118
    v_mfma_f32_16x16x32_bf16 v[232:235], v[72:75], v[52:55], v[232:235]
    ds_read_b128 v[68:71], v2 offset:9216
    v_add_f32 v38, v38, v117
    v_cvt_pk_bf16_f32 v58, v116, v117
    v_mfma_f32_16x16x32_bf16 v[204:207], v[76:79], v[48:51], v[204:207]
    v_exp_f32 v119, v119
    v_mfma_f32_16x16x32_bf16 v[236:239], v[76:79], v[52:55], v[236:239]
    ds_read_b128 v[72:75], v2 offset:10240
    v_add_f32 v38, v38, v118
    s_waitcnt lgkmcnt(3)
    v_mfma_f32_16x16x32_bf16 v[208:211], v[80:83], v[48:51], v[208:211]
    v_exp_f32 v124, v124
    buffer_load_dword v0, v13, s[4:7], s48 offen
    s_add_u32 s48, s48, 4096
    v_mfma_f32_16x16x32_bf16 v[240:243], v[80:83], v[52:55], v[240:243]
    ds_read_b128 v[76:79], v2 offset:11264
    v_add_f32 v38, v38, v119
    v_cvt_pk_bf16_f32 v59, v118, v119
    v_mfma_f32_16x16x32_bf16 v[212:215], v[84:87], v[48:51], v[212:215]
    v_exp_f32 v125, v125
    v_mfma_f32_16x16x32_bf16 v[244:247], v[84:87], v[52:55], v[244:247]
    ds_read_b128 v[80:83], v2 offset:12288
    v_add_f32 v39, v39, v124
    v_mfma_f32_16x16x32_bf16 v[216:219], v[88:91], v[48:51], v[216:219]
    v_exp_f32 v126, v126
    v_mfma_f32_16x16x32_bf16 v[248:251], v[88:91], v[52:55], v[248:251]
    ds_read_b128 v[84:87], v2 offset:13312
    v_add_f32 v39, v39, v125
    v_cvt_pk_bf16_f32 v62, v124, v125
    v_mfma_f32_16x16x32_bf16 v[220:223], v[92:95], v[48:51], v[220:223]
    v_exp_f32 v127, v127
    v_mfma_f32_16x16x32_bf16 v[252:255], v[92:95], v[52:55], v[252:255]
    ds_read_b128 v[88:91], v2 offset:14336
    v_add_f32 v39, v39, v126
    v_add_f32 v39, v39, v127
    v_cvt_pk_bf16_f32 v63, v126, v127
    s_cmp_eq_u32 s40, s51
    s_cbranch_scc1 L_recurrent_scan__compressed_kv_cla__moe_arch_mod__prompt_kernel_rare_115
L_recurrent_scan__compressed_kv_cla__moe_arch_mod__prompt_kernel_back_116:
    s_cmp_lt_i32 s50, 0
    s_cbranch_scc0 L_recurrent_scan__compressed_kv_cla__moe_arch_mod__prompt_kernel_rare_117
L_recurrent_scan__compressed_kv_cla__moe_arch_mod__prompt_kernel_back_118:
    s_waitcnt lgkmcnt(3)
    v_mfma_f32_16x16x32_bf16 v[112:115], v[64:67], v[128:131], v[40:43]
    v_exp_f32 v96, v96
    v_mfma_f32_16x16x32_bf16 v[120:123], v[64:67], v[144:147], v[44:47]
    ds_read_b128 v[92:95], v2 offset:15360
    v_mfma_f32_16x16x32_bf16 v[112:115], v[68:71], v[132:135], v[112:115]
    v_exp_f32 v97, v97
    s_add_u32 s40, s40, 1
    v_mfma_f32_16x16x32_bf16 v[120:123], v[68:71], v[148:151], v[120:123]
    ds_read_b128 v[64:67], v3 offset:8192
    v_add_f32 v38, v38, v96
    s_add_u32 s49, s50, 32
    v_add_u32 v24, 65536, v2
    v_mfma_f32_16x16x32_bf16 v[112:115], v[72:75], v[136:139], v[112:115]
    v_exp_f32 v98, v98
    v_mfma_f32_16x16x32_bf16 v[120:123], v[72:75], v[152:155], v[120:123]
    ds_read_b128 v[68:71], v3 offset:9216
    v_add_f32 v38, v38, v97
    v_cvt_pk_bf16_f32 v48, v96, v97
    s_cmp_lt_u32 s40, s51
    s_cselect_b32 s36, 64, 128
    v_mfma_f32_16x16x32_bf16 v[112:115], v[76:79], v[140:143], v[112:115]
    v_exp_f32 v99, v99
    v_mfma_f32_16x16x32_bf16 v[120:123], v[76:79], v[156:159], v[120:123]
    ds_read_b128 v[72:75], v3 offset:10240
    v_add_f32 v38, v38, v98
    s_add_u32 s41, s41, s36
    s_waitcnt lgkmcnt(3)
    v_mfma_f32_16x16x32_bf16 v[116:119], v[80:83], v[128:131], v[40:43]
    v_exp_f32 v104, v104
    v_mfma_f32_16x16x32_bf16 v[124:127], v[80:83], v[144:147], v[44:47]
    ds_read_b128 v[76:79], v3 offset:11264
    v_add_f32 v38, v38, v99
    v_cvt_pk_bf16_f32 v49, v98, v99
    s_cmp_eq_u32 s40, s51
    s_cselect_b32 s36, s42, s36
    v_mfma_f32_16x16x32_bf16 v[116:119], v[84:87], v[132:135], v[116:119]
    v_exp_f32 v105, v105
    v_mfma_f32_16x16x32_bf16 v[124:127], v[84:87], v[148:151], v[124:127]
    ds_read_b128 v[80:83], v3 offset:12288
    v_add_f32 v39, v39, v104
    s_add_u32 s50, s50, s36
    v_mfma_f32_16x16x32_bf16 v[116:119], v[88:91], v[136:139], v[116:119]
    v_exp_f32 v106, v106
    v_mfma_f32_16x16x32_bf16 v[124:127], v[88:91], v[152:155], v[124:127]
    ds_read_b128 v[84:87], v3 offset:13312
    v_add_f32 v39, v39, v105
    v_cvt_pk_bf16_f32 v52, v104, v105
    s_and_b32 s36, s41, 0xff
    v_lshl_add_u32 v2, s36, 8, v7
    v_mfma_f32_16x16x32_bf16 v[116:119], v[92:95], v[140:143], v[116:119]
    v_exp_f32 v107, v107
    v_mfma_f32_16x16x32_bf16 v[124:127], v[92:95], v[156:159], v[124:127]
    ds_read_b128 v[88:91], v3 offset:14336
    v_add_f32 v39, v39, v106
    s_cmp_eq_u32 s40, 16
    s_cselect_b64 s[20:21], -1, 0
    s_waitcnt lgkmcnt(3)
    v_mfma_f32_16x16x32_bf16 v[192:195], v[64:67], v[56:59], v[192:195]
    v_exp_f32 v100, v100
    v_mfma_f32_16x16x32_bf16 v[224:227], v[64:67], v[60:63], v[224:227]
    ds_read_b128 v[92:95], v3 offset:15360
    v_add_f32 v39, v39, v107
    v_cvt_pk_bf16_f32 v53, v106, v107
    v_cndmask_b32 v5, v2, v24, s[20:21]
    v_mfma_f32_16x16x32_bf16 v[196:199], v[68:71], v[56:59], v[196:199]
    v_exp_f32 v101, v101
    v_mfma_f32_16x16x32_bf16 v[228:231], v[68:71], v[60:63], v[228:231]
    v_add_f32 v38, v38, v100
    v_mov_b32 v3, v24
    v_mfma_f32_16x16x32_bf16 v[200:203], v[72:75], v[56:59], v[200:203]
    v_exp_f32 v102, v102
    v_mfma_f32_16x16x32_bf16 v[232:235], v[72:75], v[60:63], v[232:235]
    v_add_f32 v38, v38, v101
    v_cvt_pk_bf16_f32 v50, v100, v101
    s_waitcnt lgkmcnt(0)
    s_barrier
    v_mfma_f32_16x16x32_bf16 v[204:207], v[76:79], v[56:59], v[204:207]
    v_exp_f32 v103, v103
    v_mfma_f32_16x16x32_bf16 v[236:239], v[76:79], v[60:63], v[236:239]
    ds_read_b128 v[68:71], v5 offset:1024
    ds_read_b128 v[64:67], v5 offset:0
    v_add_f32 v38, v38, v102
    v_mfma_f32_16x16x32_bf16 v[208:211], v[80:83], v[56:59], v[208:211]
    v_exp_f32 v108, v108
    v_mfma_f32_16x16x32_bf16 v[240:243], v[80:83], v[60:63], v[240:243]
    ds_read_b128 v[76:79], v5 offset:3072
    ds_read_b128 v[72:75], v5 offset:2048
    v_add_f32 v38, v38, v103
    v_cvt_pk_bf16_f32 v51, v102, v103
    v_mfma_f32_16x16x32_bf16 v[212:215], v[84:87], v[56:59], v[212:215]
    v_exp_f32 v109, v109
    v_mfma_f32_16x16x32_bf16 v[244:247], v[84:87], v[60:63], v[244:247]
    ds_read_b128 v[80:83], v5 offset:4096
    v_add_f32 v39, v39, v108
    v_mfma_f32_16x16x32_bf16 v[216:219], v[88:91], v[56:59], v[216:219]
    v_exp_f32 v110, v110
    v_mfma_f32_16x16x32_bf16 v[248:251], v[88:91], v[60:63], v[248:251]
    ds_read_b128 v[84:87], v5 offset:5120
    v_add_f32 v39, v39, v109
    v_cvt_pk_bf16_f32 v54, v108, v109
    v_mfma_f32_16x16x32_bf16 v[220:223], v[92:95], v[56:59], v[220:223]
    v_exp_f32 v111, v111
    v_mfma_f32_16x16x32_bf16 v[252:255], v[92:95], v[60:63], v[252:255]
    ds_read_b128 v[88:91], v5 offset:6144
    v_add_f32 v39, v39, v110
    v_add_f32 v39, v39, v111
    v_cvt_pk_bf16_f32 v55, v110, v111
    s_bitcmp1_b32 s39, s40
    s_cbranch_scc1 L_recurrent_scan__compressed_kv_cla__moe_arch_mod__prompt_kernel_rare_128
L_recurrent_scan__compressed_kv_cla__moe_arch_mod__prompt_kernel_back_129:
    s_sub_u32 s36, s40, s51
    s_cmp_lt_u32 s36, 2
    s_cbranch_scc1 L_recurrent_scan__compressed_kv_cla__moe_arch_mod__prompt_kernel_rare_122
L_recurrent_scan__compressed_kv_cla__moe_arch_mod__prompt_kernel_back_123:
    s_cmp_lg_u32 s40, 16
    s_cbranch_scc1 L_body1
    s_mov_b32 s4, s34
    s_and_b32 s5, s35, 0xffff
    s_mov_b32 s6, 7340032
    s_mov_b32 s7, 0x20000
    s_mov_b32 s8, s32
    s_and_b32 s9, s33, 0xffff
    s_mov_b32 s10, 8388608
    s_mov_b32 s11, 0x20000
    s_lshr_b32 s38, s2, 4
    s_mul_i32 s38, s38, 224
    s_and_b32 s39, s2, 15
    s_lshl_b32 s39, s39, 7
    v_lshrrev_b32 v27, 3, v1
    s_lshl_b32 s36, s28, 5
    s_add_u32 s36, s36, s38
    v_add_u32 v27, s36, v27
    v_mul_u32_u24 v27, 2048, v27
    v_add_u32 v27, s39, v27
    v_bfe_u32 v28, v1, 4, 1
    v_lshlrev_b32 v28, 1, v28
    v_and_b32 v29, 7, v1
    v_xor_b32 v28, v28, v29
    v_lshl_add_u32 v26, v28, 4, v27
    v_xor_b32 v28, 4, v28
    v_lshl_add_u32 v27, v28, 4, v27
    v_add_u32 v27, 15360, v27
    v_add_u32 v28, 30720, v26
    v_add_u32 v29, 30720, v27
    s_lshl_b32 s36, s28, 12
    s_add_u32 s36, s36, 131072
    s_cmp_lt_u32 s28, 7
    s_cselect_b32 m0, s36, 0x30000
    s_cselect_b32 s6, 7340032, 0
    buffer_load_dwordx4 v26, s[4:7], 0 offen offset:0 lds
    buffer_load_dwordx4 v27, s[4:7], 0 offen offset:1024 lds
    buffer_load_dwordx4 v28, s[4:7], 0 offen offset:2048 lds
    buffer_load_dwordx4 v29, s[4:7], 0 offen offset:3072 lds
    s_lshr_b32 s36, s2, 5
    s_add_u32 s36, s36, 48
    s_lshl_b32 s36, s36, 7
    v_mov_b32 v12, s36
    global_load_dword v11, v12, s[90:91] sc1
    s_cmp_lt_i32 s49, 0
    s_cbranch_scc0 L_recurrent_scan__compressed_kv_cla__moe_arch_mod__prompt_kernel_rare_120
L_recurrent_scan__compressed_kv_cla__moe_arch_mod__prompt_kernel_back_121:
    s_waitcnt lgkmcnt(5)
    v_mfma_f32_16x16x32_bf16 v[192:195], v[64:67], v[48:51], v[192:195]
    v_exp_f32 v112, v112
    v_mfma_f32_16x16x32_bf16 v[224:227], v[64:67], v[52:55], v[224:227]
    ds_read_b128 v[92:95], v3 offset:7168
    v_add_f32 v38, v38, v112
    v_exp_f32 v113, v113
    v_mfma_f32_16x16x32_bf16 v[196:199], v[68:71], v[48:51], v[196:199]
    v_add_f32 v38, v38, v113
    v_cvt_pk_bf16_f32 v56, v112, v113
    v_exp_f32 v114, v114
    v_mfma_f32_16x16x32_bf16 v[228:231], v[68:71], v[52:55], v[228:231]
    ds_read_b128 v[64:67], v3 offset:8192
    v_add_f32 v38, v38, v114
    v_exp_f32 v115, v115
    s_waitcnt lgkmcnt(5)
    v_mfma_f32_16x16x32_bf16 v[200:203], v[72:75], v[48:51], v[200:203]
    v_add_f32 v38, v38, v115
    v_cvt_pk_bf16_f32 v57, v114, v115
    v_exp_f32 v120, v120
    v_mfma_f32_16x16x32_bf16 v[232:235], v[72:75], v[52:55], v[232:235]
    ds_read_b128 v[68:71], v3 offset:9216
    v_add_f32 v39, v39, v120
    v_exp_f32 v121, v121
    v_mfma_f32_16x16x32_bf16 v[204:207], v[76:79], v[48:51], v[204:207]
    v_add_f32 v39, v39, v121
    v_cvt_pk_bf16_f32 v60, v120, v121
    v_exp_f32 v122, v122
    v_mfma_f32_16x16x32_bf16 v[236:239], v[76:79], v[52:55], v[236:239]
    ds_read_b128 v[72:75], v3 offset:10240
    v_add_f32 v39, v39, v122
    v_exp_f32 v123, v123
    s_waitcnt lgkmcnt(6)
    v_mfma_f32_16x16x32_bf16 v[208:211], v[80:83], v[48:51], v[208:211]
    v_add_f32 v39, v39, v123
    v_cvt_pk_bf16_f32 v61, v122, v123
    v_exp_f32 v116, v116
    v_mfma_f32_16x16x32_bf16 v[240:243], v[80:83], v[52:55], v[240:243]
    ds_read_b128 v[76:79], v3 offset:11264
    v_add_f32 v38, v38, v116
    v_exp_f32 v117, v117
    s_waitcnt lgkmcnt(6)
    v_mfma_f32_16x16x32_bf16 v[212:215], v[84:87], v[48:51], v[212:215]
    v_add_f32 v38, v38, v117
    v_cvt_pk_bf16_f32 v58, v116, v117
    v_exp_f32 v118, v118
    v_mfma_f32_16x16x32_bf16 v[244:247], v[84:87], v[52:55], v[244:247]
    ds_read_b128 v[80:83], v3 offset:12288
    v_add_f32 v38, v38, v118
    v_exp_f32 v119, v119
    s_waitcnt lgkmcnt(6)
    v_mfma_f32_16x16x32_bf16 v[216:219], v[88:91], v[48:51], v[216:219]
    v_add_f32 v38, v38, v119
    v_cvt_pk_bf16_f32 v59, v118, v119
    v_exp_f32 v124, v124
    v_mfma_f32_16x16x32_bf16 v[248:251], v[88:91], v[52:55], v[248:251]
    ds_read_b128 v[84:87], v3 offset:13312
    v_add_f32 v39, v39, v124
    v_exp_f32 v125, v125
    s_waitcnt lgkmcnt(6)
    v_mfma_f32_16x16x32_bf16 v[220:223], v[92:95], v[48:51], v[220:223]
    v_add_f32 v39, v39, v125
    v_cvt_pk_bf16_f32 v62, v124, v125
    v_exp_f32 v126, v126
    v_mfma_f32_16x16x32_bf16 v[252:255], v[92:95], v[52:55], v[252:255]
    ds_read_b128 v[88:91], v3 offset:14336
    v_add_f32 v39, v39, v126
    v_exp_f32 v127, v127
    s_nop 0
    v_add_f32 v39, v39, v127
    v_cvt_pk_bf16_f32 v63, v126, v127
    s_nop 1
    s_waitcnt lgkmcnt(6)
    v_mfma_f32_16x16x32_bf16 v[192:195], v[64:67], v[56:59], v[192:195]
    v_mfma_f32_16x16x32_bf16 v[224:227], v[64:67], v[60:63], v[224:227]
    ds_read_b128 v[92:95], v3 offset:15360
    s_waitcnt lgkmcnt(6)
    v_mfma_f32_16x16x32_bf16 v[196:199], v[68:71], v[56:59], v[196:199]
    v_mfma_f32_16x16x32_bf16 v[228:231], v[68:71], v[60:63], v[228:231]
    s_waitcnt lgkmcnt(5)
    v_mfma_f32_16x16x32_bf16 v[200:203], v[72:75], v[56:59], v[200:203]
    v_mfma_f32_16x16x32_bf16 v[232:235], v[72:75], v[60:63], v[232:235]
    s_waitcnt lgkmcnt(4)
    v_mfma_f32_16x16x32_bf16 v[204:207], v[76:79], v[56:59], v[204:207]
    v_mfma_f32_16x16x32_bf16 v[236:239], v[76:79], v[60:63], v[236:239]
    s_waitcnt lgkmcnt(3)
    v_mfma_f32_16x16x32_bf16 v[208:211], v[80:83], v[56:59], v[208:211]
    v_mfma_f32_16x16x32_bf16 v[240:243], v[80:83], v[60:63], v[240:243]
    s_waitcnt lgkmcnt(2)
    v_mfma_f32_16x16x32_bf16 v[212:215], v[84:87], v[56:59], v[212:215]
    v_mfma_f32_16x16x32_bf16 v[244:247], v[84:87], v[60:63], v[244:247]
    s_waitcnt lgkmcnt(1)
    v_mfma_f32_16x16x32_bf16 v[216:219], v[88:91], v[56:59], v[216:219]
    v_mfma_f32_16x16x32_bf16 v[248:251], v[88:91], v[60:63], v[248:251]
    s_waitcnt lgkmcnt(0)
    v_mfma_f32_16x16x32_bf16 v[220:223], v[92:95], v[56:59], v[220:223]
    v_mfma_f32_16x16x32_bf16 v[252:255], v[92:95], v[60:63], v[252:255]
    s_waitcnt vmcnt(0)
    v_readfirstlane_b32 s36, v11
    s_nop 0
    s_cmp_lt_u32 s36, 28
    s_cbranch_scc1 L_recurrent_scan__compressed_kv_cla__moe_arch_mod__prompt_kernel_rare_132
L_recurrent_scan__compressed_kv_cla__moe_arch_mod__prompt_kernel_back_133:
    s_lshr_b32 s36, s2, 4
    s_mul_i32 s36, s36, 7
    s_min_u32 s37, s28, 6
    s_add_u32 s36, s36, s37
    s_lshl_b32 s36, s36, 11
    s_add_u32 s36, s36, 58720256
    v_and_b32 v11, 15, v1
    v_lshlrev_b32 v11, 4, v11
    v_lshrrev_b32 v12, 4, v1
    v_lshl_add_u32 v11, v12, 9, v11
    buffer_load_dwordx4 v[96:99], v11, s[24:27], s36 offen offset:0 sc1
    buffer_load_dwordx4 v[100:103], v11, s[24:27], s36 offen offset:256 sc1
    s_lshl_b32 s37, s28, 13
    v_add_u32 v21, s37, v7
    v_xor_b32 v22, 32768, v21
    s_lshl_b32 s37, s28, 8
    s_add_u32 s37, s37, 159744
    v_lshl_add_u32 v23, v1, 2, s37
    v_xor_b32 v24, 1024, v23
    ds_write_b32 v23, v38
    s_mov_b32 s36, 0x5d800000
    v_cmp_nge_f32 vcc, s36, v38
    s_nop 0
    s_or_b64 s[52:53], s[52:53], vcc
    v_cmp_nge_f32 vcc, s36, v39
    s_nop 0
    s_or_b64 s[52:53], s[52:53], vcc
    s_or_b32 s36, s52, s53
    v_mov_b32 v26, s36
    s_lshl_b32 s37, s28, 2
    s_add_u32 s37, s37, 161792
    v_mov_b32 v27, s37
    ds_write_b32 v27, v26
    ds_write_b128 v21, v[192:195] offset:0
    ds_write_b128 v21, v[196:199] offset:1024
    ds_write_b128 v21, v[200:203] offset:2048
    ds_write_b128 v21, v[204:207] offset:3072
    ds_write_b128 v21, v[208:211] offset:4096
    ds_write_b128 v21, v[212:215] offset:5120
    ds_write_b128 v21, v[216:219] offset:6144
    ds_write_b128 v21, v[220:223] offset:7168
    v_mov_b32 v28, 161856
    v_and_b32 v27, 7, v1
    v_lshlrev_b32 v27, 2, v27
    v_add_u32 v27, 161792, v27
    s_sub_u32 s36, 15, s30
    s_lshl_b32 s38, s36, 3
    s_and_b32 s37, s28, 3
    s_lshl_b32 s37, s37, 1
    s_add_u32 s38, s38, s37
    s_add_u32 s38, s38, 1
    s_lshl_b32 s38, s38, 17
    s_lshl_b32 s37, s29, 12
    s_add_u32 s38, s38, s37
    s_waitcnt lgkmcnt(0)
    s_barrier
    ds_read_b128 v[30:33], v28
    ds_read_b32 v26, v27
    ds_read_b32 v25, v24
    ds_read_b128 v[64:67], v22 offset:0
    ds_read_b128 v[68:71], v22 offset:1024
    ds_read_b128 v[72:75], v22 offset:2048
    ds_read_b128 v[76:79], v22 offset:3072
    ds_read_b128 v[80:83], v22 offset:4096
    ds_read_b128 v[84:87], v22 offset:5120
    ds_read_b128 v[88:91], v22 offset:6144
    ds_read_b128 v[92:95], v22 offset:7168
    s_waitcnt lgkmcnt(8)
    v_add_f32 v25, v25, v39
    v_mov_b32 v20, v25
    s_nop 1
    v_permlane16_swap_b32 v25, v20
    s_nop 1
    v_add_f32 v25, v25, v20
    v_mov_b32 v20, v25
    s_nop 1
    v_permlane32_swap_b32 v25, v20
    s_nop 1
    v_add_f32 v25, v25, v20
    v_cmp_ne_u32 s[52:53], 0, v26
    v_readfirstlane_b32 s56, v30
    v_readfirstlane_b32 s57, v31
    v_readfirstlane_b32 s58, v32
    v_readfirstlane_b32 s59, v33
    v_rcp_f32 v25, v25
    s_nop 0
    v_mov_b32 v24, v25
    s_waitcnt lgkmcnt(6)
    v_pk_add_f32 v[224:225], v[224:225], v[64:65]
    v_pk_add_f32 v[226:227], v[226:227], v[66:67]
    v_pk_add_f32 v[228:229], v[228:229], v[68:69]
    v_pk_add_f32 v[230:231], v[230:231], v[70:71]
    v_pk_mul_f32 v[224:225], v[224:225], v[24:25]
    v_pk_mul_f32 v[226:227], v[226:227], v[24:25]
    v_pk_mul_f32 v[228:229], v[228:229], v[24:25]
    v_pk_mul_f32 v[230:231], v[230:231], v[24:25]
    v_cvt_pk_bf16_f32 v48, v224, v225
    v_cvt_pk_bf16_f32 v49, v226, v227
    v_cvt_pk_bf16_f32 v50, v228, v229
    v_cvt_pk_bf16_f32 v51, v230, v231
    buffer_store_dwordx4 v[48:51], v7, s[16:19], s38 offen offset:0 sc1
    s_waitcnt lgkmcnt(4)
    v_pk_add_f32 v[232:233], v[232:233], v[72:73]
    v_pk_add_f32 v[234:235], v[234:235], v[74:75]
    v_pk_add_f32 v[236:237], v[236:237], v[76:77]
    v_pk_add_f32 v[238:239], v[238:239], v[78:79]
    v_pk_mul_f32 v[232:233], v[232:233], v[24:25]
    v_pk_mul_f32 v[234:235], v[234:235], v[24:25]
    v_pk_mul_f32 v[236:237], v[236:237], v[24:25]
    v_pk_mul_f32 v[238:239], v[238:239], v[24:25]
    v_cvt_pk_bf16_f32 v52, v232, v233
    v_cvt_pk_bf16_f32 v53, v234, v235
    v_cvt_pk_bf16_f32 v54, v236, v237
    v_cvt_pk_bf16_f32 v55, v238, v239
    buffer_store_dwordx4 v[52:55], v7, s[16:19], s38 offen offset:1024 sc1
    s_waitcnt lgkmcnt(2)
    v_pk_add_f32 v[240:241], v[240:241], v[80:81]
    v_pk_add_f32 v[242:243], v[242:243], v[82:83]
    v_pk_add_f32 v[244:245], v[244:245], v[84:85]
    v_pk_add_f32 v[246:247], v[246:247], v[86:87]
    v_pk_mul_f32 v[240:241], v[240:241], v[24:25]
    v_pk_mul_f32 v[242:243], v[242:243], v[24:25]
    v_pk_mul_f32 v[244:245], v[244:245], v[24:25]
    v_pk_mul_f32 v[246:247], v[246:247], v[24:25]
    v_cvt_pk_bf16_f32 v56, v240, v241
    v_cvt_pk_bf16_f32 v57, v242, v243
    v_cvt_pk_bf16_f32 v58, v244, v245
    v_cvt_pk_bf16_f32 v59, v246, v247
    buffer_store_dwordx4 v[56:59], v7, s[16:19], s38 offen offset:2048 sc1
    s_waitcnt lgkmcnt(0)
    v_pk_add_f32 v[248:249], v[248:249], v[88:89]
    v_pk_add_f32 v[250:251], v[250:251], v[90:91]
    v_pk_add_f32 v[252:253], v[252:253], v[92:93]
    v_pk_add_f32 v[254:255], v[254:255], v[94:95]
    v_pk_mul_f32 v[248:249], v[248:249], v[24:25]
    v_pk_mul_f32 v[250:251], v[250:251], v[24:25]
    v_pk_mul_f32 v[252:253], v[252:253], v[24:25]
    v_pk_mul_f32 v[254:255], v[254:255], v[24:25]
    v_cvt_pk_bf16_f32 v60, v248, v249
    v_cvt_pk_bf16_f32 v61, v250, v251
    v_cvt_pk_bf16_f32 v62, v252, v253
    v_cvt_pk_bf16_f32 v63, v254, v255
    buffer_store_dwordx4 v[60:63], v7, s[16:19], s38 offen offset:3072 sc1
    s_cmp_eq_u64 s[52:53], 0
    s_cbranch_scc1 L_p3_done
    s_waitcnt vmcnt(0)
    v_mov_b32 v112, v96
    v_mov_b32 v113, v97
    v_mov_b32 v114, v98
    v_mov_b32 v115, v99
    v_mov_b32 v116, v100
    v_mov_b32 v117, v101
    v_mov_b32 v118, v102
    v_mov_b32 v119, v103
    v_swap_b32 v128, v160
    v_swap_b32 v129, v161
    v_swap_b32 v130, v162
    v_swap_b32 v131, v163
    v_swap_b32 v132, v164
    v_swap_b32 v133, v165
    v_swap_b32 v134, v166
    v_swap_b32 v135, v167
    v_swap_b32 v136, v168
    v_swap_b32 v137, v169
    v_swap_b32 v138, v170
    v_swap_b32 v139, v171
    v_swap_b32 v140, v172
    v_swap_b32 v141, v173
    v_swap_b32 v142, v174
    v_swap_b32 v143, v175
    v_swap_b32 v144, v176
    v_swap_b32 v145, v177
    v_swap_b32 v146, v178
    v_swap_b32 v147, v179
    v_swap_b32 v148, v180
    v_swap_b32 v149, v181
    v_swap_b32 v150, v182
    v_swap_b32 v151, v183
    v_swap_b32 v152, v184
    v_swap_b32 v153, v185
    v_swap_b32 v154, v186
    v_swap_b32 v155, v187
    v_swap_b32 v156, v188
    v_swap_b32 v157, v189
    v_swap_b32 v158, v190
    v_swap_b32 v159, v191
    v_mov_b32 v192, 0
    v_mov_b32 v193, 0
    v_mov_b32 v194, 0
    v_mov_b32 v195, 0
    v_mov_b32 v196, 0
    v_mov_b32 v197, 0
    v_mov_b32 v198, 0
    v_mov_b32 v199, 0
    v_mov_b32 v200, 0
    v_mov_b32 v201, 0
    v_mov_b32 v202, 0
    v_mov_b32 v203, 0
    v_mov_b32 v204, 0
    v_mov_b32 v205, 0
    v_mov_b32 v206, 0
    v_mov_b32 v207, 0
    v_mov_b32 v208, 0
    v_mov_b32 v209, 0
    v_mov_b32 v210, 0
    v_mov_b32 v211, 0
    v_mov_b32 v212, 0
    v_mov_b32 v213, 0
    v_mov_b32 v214, 0
    v_mov_b32 v215, 0
    v_mov_b32 v216, 0
    v_mov_b32 v217, 0
    v_mov_b32 v218, 0
    v_mov_b32 v219, 0
    v_mov_b32 v220, 0
    v_mov_b32 v221, 0
    v_mov_b32 v222, 0
    v_mov_b32 v223, 0
    v_mov_b32 v224, 0
    v_mov_b32 v225, 0
    v_mov_b32 v226, 0
    v_mov_b32 v227, 0
    v_mov_b32 v228, 0
    v_mov_b32 v229, 0
    v_mov_b32 v230, 0
    v_mov_b32 v231, 0
    v_mov_b32 v232, 0
    v_mov_b32 v233, 0
    v_mov_b32 v234, 0
    v_mov_b32 v235, 0
    v_mov_b32 v236, 0
    v_mov_b32 v237, 0
    v_mov_b32 v238, 0
    v_mov_b32 v239, 0
    v_mov_b32 v240, 0
    v_mov_b32 v241, 0
    v_mov_b32 v242, 0
    v_mov_b32 v243, 0
    v_mov_b32 v244, 0
    v_mov_b32 v245, 0
    v_mov_b32 v246, 0
    v_mov_b32 v247, 0
    v_mov_b32 v248, 0
    v_mov_b32 v249, 0
    v_mov_b32 v250, 0
    v_mov_b32 v251, 0
    v_mov_b32 v252, 0
    v_mov_b32 v253, 0
    v_mov_b32 v254, 0
    v_mov_b32 v255, 0
    v_mov_b32 v38, 0
    v_mov_b32 v40, 4048155338
    v_mov_b32 v39, 0
    v_mov_b32 v41, 4048155338
    s_lshl_b32 s43, s28, 12
    v_add_u32 v4, s43, v7
    s_mov_b32 s46, s45
    s_sub_u32 s40, 16, s30
    s_mov_b32 s39, s30
    s_lshl_b32 s37, s39, 7
    s_and_b32 s36, s28, 3
    s_lshl_b32 s36, s36, 5
    s_add_u32 s36, s36, s37
    s_sub_u32 s50, 0, s36
L_recurrent_scan__compressed_kv_cla__moe_arch_mod__prompt_kernel_stile_134:
    s_waitcnt vmcnt(0) lgkmcnt(0)
    s_barrier
    s_mov_b32 m0, s43
    s_add_u32 s47, s46, 32768
    buffer_load_dwordx4 v4, s[12:15], s46 offen offset:0 sc1 lds
    buffer_load_dwordx4 v4, s[12:15], s46 offen offset:1024 sc1 lds
    buffer_load_dwordx4 v4, s[12:15], s46 offen offset:2048 sc1 lds
    buffer_load_dwordx4 v4, s[12:15], s46 offen offset:3072 sc1 lds
    s_add_u32 m0, s43, 32768
    s_add_u32 s46, s46, 65536
    buffer_load_dwordx4 v4, s[12:15], s47 offen offset:0 sc1 lds
    buffer_load_dwordx4 v4, s[12:15], s47 offen offset:1024 sc1 lds
    buffer_load_dwordx4 v4, s[12:15], s47 offen offset:2048 sc1 lds
    buffer_load_dwordx4 v4, s[12:15], s47 offen offset:3072 sc1 lds
    v_mov_b32 v2, v7
    s_mov_b32 s41, 4
    s_waitcnt vmcnt(0)
    s_barrier
L_recurrent_scan__compressed_kv_cla__moe_arch_mod__prompt_kernel_sunit_135:
    s_cmp_gt_i32 s50, 0
    s_cbranch_scc1 L_recurrent_scan__compressed_kv_cla__moe_arch_mod__prompt_kernel_snext_136
    ds_read_b128 v[64:67], v2 offset:0
    ds_read_b128 v[68:71], v2 offset:1024
    ds_read_b128 v[72:75], v2 offset:2048
    ds_read_b128 v[76:79], v2 offset:3072
    ds_read_b128 v[80:83], v2 offset:4096
    ds_read_b128 v[84:87], v2 offset:5120
    ds_read_b128 v[88:91], v2 offset:6144
    ds_read_b128 v[92:95], v2 offset:7168
    s_waitcnt lgkmcnt(0)
    v_mfma_f32_16x16x32_bf16 v[96:99], v[64:67], v[128:131], 0
    v_mfma_f32_16x16x32_bf16 v[104:107], v[64:67], v[144:147], 0
    v_mfma_f32_16x16x32_bf16 v[96:99], v[68:71], v[132:135], v[96:99]
    v_mfma_f32_16x16x32_bf16 v[104:107], v[68:71], v[148:151], v[104:107]
    v_mfma_f32_16x16x32_bf16 v[96:99], v[72:75], v[136:139], v[96:99]
    v_mfma_f32_16x16x32_bf16 v[104:107], v[72:75], v[152:155], v[104:107]
    v_mfma_f32_16x16x32_bf16 v[96:99], v[76:79], v[140:143], v[96:99]
    v_mfma_f32_16x16x32_bf16 v[104:107], v[76:79], v[156:159], v[104:107]
    v_mfma_f32_16x16x32_bf16 v[100:103], v[80:83], v[128:131], 0
    v_mfma_f32_16x16x32_bf16 v[108:111], v[80:83], v[144:147], 0
    v_mfma_f32_16x16x32_bf16 v[100:103], v[84:87], v[132:135], v[100:103]
    v_mfma_f32_16x16x32_bf16 v[108:111], v[84:87], v[148:151], v[108:111]
    v_mfma_f32_16x16x32_bf16 v[100:103], v[88:91], v[136:139], v[100:103]
    v_mfma_f32_16x16x32_bf16 v[108:111], v[88:91], v[152:155], v[108:111]
    v_mfma_f32_16x16x32_bf16 v[100:103], v[92:95], v[140:143], v[100:103]
    v_mfma_f32_16x16x32_bf16 v[108:111], v[92:95], v[156:159], v[108:111]
    ds_read_b128 v[64:67], v2 offset:32768
    ds_read_b128 v[68:71], v2 offset:33792
    ds_read_b128 v[72:75], v2 offset:34816
    ds_read_b128 v[76:79], v2 offset:35840
    ds_read_b128 v[80:83], v2 offset:36864
    ds_read_b128 v[84:87], v2 offset:37888
    ds_read_b128 v[88:91], v2 offset:38912
    ds_read_b128 v[92:95], v2 offset:39936
    s_nop 1
    s_cmp_lt_i32 s50, 0
    s_cbranch_scc0 L_recurrent_scan__compressed_kv_cla__moe_arch_mod__prompt_kernel_rare_137
L_recurrent_scan__compressed_kv_cla__moe_arch_mod__prompt_kernel_back_138:
    v_max3_f32 v22, v96, v97, v98
    v_max3_f32 v22, v22, v99, v100
    v_max3_f32 v22, v22, v101, v102
    v_max3_f32 v22, v22, v103, v40
    v_mov_b32 v24, v22
    s_nop 1
    v_permlane16_swap_b32 v22, v24
    s_nop 1
    v_max_f32 v22, v22, v24
    v_mov_b32 v24, v22
    s_nop 1
    v_permlane32_swap_b32 v22, v24
    s_nop 1
    v_max_f32 v22, v22, v24
    v_sub_f32 v25, v40, v22
    v_exp_f32 v25, v25
    v_mov_b32 v40, v22
    v_mul_f32 v38, v38, v25
    v_mul_f32 v192, v192, v25
    v_mul_f32 v193, v193, v25
    v_mul_f32 v194, v194, v25
    v_mul_f32 v195, v195, v25
    v_mul_f32 v196, v196, v25
    v_mul_f32 v197, v197, v25
    v_mul_f32 v198, v198, v25
    v_mul_f32 v199, v199, v25
    v_mul_f32 v200, v200, v25
    v_mul_f32 v201, v201, v25
    v_mul_f32 v202, v202, v25
    v_mul_f32 v203, v203, v25
    v_mul_f32 v204, v204, v25
    v_mul_f32 v205, v205, v25
    v_mul_f32 v206, v206, v25
    v_mul_f32 v207, v207, v25
    v_mul_f32 v208, v208, v25
    v_mul_f32 v209, v209, v25
    v_mul_f32 v210, v210, v25
    v_mul_f32 v211, v211, v25
    v_mul_f32 v212, v212, v25
    v_mul_f32 v213, v213, v25
    v_mul_f32 v214, v214, v25
    v_mul_f32 v215, v215, v25
    v_mul_f32 v216, v216, v25
    v_mul_f32 v217, v217, v25
    v_mul_f32 v218, v218, v25
    v_mul_f32 v219, v219, v25
    v_mul_f32 v220, v220, v25
    v_mul_f32 v221, v221, v25
    v_mul_f32 v222, v222, v25
    v_mul_f32 v223, v223, v25
    v_sub_f32 v96, v96, v22
    v_sub_f32 v97, v97, v22
    v_sub_f32 v98, v98, v22
    v_sub_f32 v99, v99, v22
    v_sub_f32 v100, v100, v22
    v_sub_f32 v101, v101, v22
    v_sub_f32 v102, v102, v22
    v_sub_f32 v103, v103, v22
    v_max3_f32 v23, v104, v105, v106
    v_max3_f32 v23, v23, v107, v108
    v_max3_f32 v23, v23, v109, v110
    v_max3_f32 v23, v23, v111, v41
    v_mov_b32 v24, v23
    s_nop 1
    v_permlane16_swap_b32 v23, v24
    s_nop 1
    v_max_f32 v23, v23, v24
    v_mov_b32 v24, v23
    s_nop 1
    v_permlane32_swap_b32 v23, v24
    s_nop 1
    v_max_f32 v23, v23, v24
    v_sub_f32 v25, v41, v23
    v_exp_f32 v25, v25
    v_mov_b32 v41, v23
    v_mul_f32 v39, v39, v25
    v_mul_f32 v224, v224, v25
    v_mul_f32 v225, v225, v25
    v_mul_f32 v226, v226, v25
    v_mul_f32 v227, v227, v25
    v_mul_f32 v228, v228, v25
    v_mul_f32 v229, v229, v25
    v_mul_f32 v230, v230, v25
    v_mul_f32 v231, v231, v25
    v_mul_f32 v232, v232, v25
    v_mul_f32 v233, v233, v25
    v_mul_f32 v234, v234, v25
    v_mul_f32 v235, v235, v25
    v_mul_f32 v236, v236, v25
    v_mul_f32 v237, v237, v25
    v_mul_f32 v238, v238, v25
    v_mul_f32 v239, v239, v25
    v_mul_f32 v240, v240, v25
    v_mul_f32 v241, v241, v25
    v_mul_f32 v242, v242, v25
    v_mul_f32 v243, v243, v25
    v_mul_f32 v244, v244, v25
    v_mul_f32 v245, v245, v25
    v_mul_f32 v246, v246, v25
    v_mul_f32 v247, v247, v25
    v_mul_f32 v248, v248, v25
    v_mul_f32 v249, v249, v25
    v_mul_f32 v250, v250, v25
    v_mul_f32 v251, v251, v25
    v_mul_f32 v252, v252, v25
    v_mul_f32 v253, v253, v25
    v_mul_f32 v254, v254, v25
    v_mul_f32 v255, v255, v25
    v_sub_f32 v104, v104, v23
    v_sub_f32 v105, v105, v23
    v_sub_f32 v106, v106, v23
    v_sub_f32 v107, v107, v23
    v_sub_f32 v108, v108, v23
    v_sub_f32 v109, v109, v23
    v_sub_f32 v110, v110, v23
    v_sub_f32 v111, v111, v23
    v_exp_f32 v96, v96
    v_exp_f32 v97, v97
    v_exp_f32 v98, v98
    v_exp_f32 v99, v99
    v_exp_f32 v104, v104
    v_exp_f32 v105, v105
    v_exp_f32 v106, v106
    v_exp_f32 v107, v107
    v_exp_f32 v100, v100
    v_exp_f32 v101, v101
    v_exp_f32 v102, v102
    v_exp_f32 v103, v103
    v_exp_f32 v108, v108
    v_exp_f32 v109, v109
    v_exp_f32 v110, v110
    v_exp_f32 v111, v111
    v_add_f32 v38, v38, v96
    v_add_f32 v38, v38, v97
    v_cvt_pk_bf16_f32 v48, v96, v97
    v_add_f32 v38, v38, v98
    v_add_f32 v38, v38, v99
    v_cvt_pk_bf16_f32 v49, v98, v99
    v_add_f32 v39, v39, v104
    v_add_f32 v39, v39, v105
    v_cvt_pk_bf16_f32 v52, v104, v105
    v_add_f32 v39, v39, v106
    v_add_f32 v39, v39, v107
    v_cvt_pk_bf16_f32 v53, v106, v107
    v_add_f32 v38, v38, v100
    v_add_f32 v38, v38, v101
    v_cvt_pk_bf16_f32 v50, v100, v101
    v_add_f32 v38, v38, v102
    v_add_f32 v38, v38, v103
    v_cvt_pk_bf16_f32 v51, v102, v103
    v_add_f32 v39, v39, v108
    v_add_f32 v39, v39, v109
    v_cvt_pk_bf16_f32 v54, v108, v109
    v_add_f32 v39, v39, v110
    v_add_f32 v39, v39, v111
    v_cvt_pk_bf16_f32 v55, v110, v111
    s_waitcnt lgkmcnt(0)
    s_nop 0
    v_mfma_f32_16x16x32_bf16 v[192:195], v[64:67], v[48:51], v[192:195]
    v_mfma_f32_16x16x32_bf16 v[224:227], v[64:67], v[52:55], v[224:227]
    v_mfma_f32_16x16x32_bf16 v[196:199], v[68:71], v[48:51], v[196:199]
    v_mfma_f32_16x16x32_bf16 v[228:231], v[68:71], v[52:55], v[228:231]
    v_mfma_f32_16x16x32_bf16 v[200:203], v[72:75], v[48:51], v[200:203]
    v_mfma_f32_16x16x32_bf16 v[232:235], v[72:75], v[52:55], v[232:235]
    v_mfma_f32_16x16x32_bf16 v[204:207], v[76:79], v[48:51], v[204:207]
    v_mfma_f32_16x16x32_bf16 v[236:239], v[76:79], v[52:55], v[236:239]
    v_mfma_f32_16x16x32_bf16 v[208:211], v[80:83], v[48:51], v[208:211]
    v_mfma_f32_16x16x32_bf16 v[240:243], v[80:83], v[52:55], v[240:243]
    v_mfma_f32_16x16x32_bf16 v[212:215], v[84:87], v[48:51], v[212:215]
    v_mfma_f32_16x16x32_bf16 v[244:247], v[84:87], v[52:55], v[244:247]
    v_mfma_f32_16x16x32_bf16 v[216:219], v[88:91], v[48:51], v[216:219]
    v_mfma_f32_16x16x32_bf16 v[248:251], v[88:91], v[52:55], v[248:251]
    v_mfma_f32_16x16x32_bf16 v[220:223], v[92:95], v[48:51], v[220:223]
    v_mfma_f32_16x16x32_bf16 v[252:255], v[92:95], v[52:55], v[252:255]
L_recurrent_scan__compressed_kv_cla__moe_arch_mod__prompt_kernel_snext_136:
    v_add_u32 v2, 8192, v2
    s_add_u32 s50, s50, 32
    s_sub_u32 s41, s41, 1
    s_cmp_lg_u32 s41, 0
    s_cbranch_scc1 L_recurrent_scan__compressed_kv_cla__moe_arch_mod__prompt_kernel_sunit_135
    s_sub_u32 s40, s40, 1
    s_cmp_lg_u32 s40, 0
    s_cbranch_scc1 L_recurrent_scan__compressed_kv_cla__moe_arch_mod__prompt_kernel_stile_134
    v_mov_b32 v20, v38
    s_nop 1
    v_permlane16_swap_b32 v38, v20
    s_nop 1
    v_add_f32 v38, v38, v20
    v_mov_b32 v20, v38
    s_nop 1
    v_permlane32_swap_b32 v38, v20
    s_nop 1
    v_add_f32 v38, v38, v20
    v_mov_b32 v20, v39
    s_nop 1
    v_permlane16_swap_b32 v39, v20
    s_nop 1
    v_add_f32 v39, v39, v20
    v_mov_b32 v20, v39
    s_nop 1
    v_permlane32_swap_b32 v39, v20
    s_nop 1
    v_add_f32 v39, v39, v20
    s_mov_b32 s36, 0x5d800000
    v_cmp_nge_f32 vcc, s36, v38
    s_nop 0
    s_or_b64 s[52:53], s[52:53], vcc
    v_cmp_nge_f32 vcc, s36, v39
    s_nop 0
    s_or_b64 s[52:53], s[52:53], vcc
    v_rcp_f32 v38, v38
    v_rcp_f32 v39, v39
    s_lshl_b32 s38, s39, 3
    s_and_b32 s37, s28, 3
    s_lshl_b32 s37, s37, 1
    s_add_u32 s38, s38, s37
    s_lshl_b32 s38, s38, 17
    s_lshl_b32 s37, s29, 12
    s_add_u32 s38, s38, s37
    v_mov_b32 v20, v38
    v_mov_b32 v21, v38
    v_pk_mul_f32 v[192:193], v[192:193], v[20:21]
    v_pk_mul_f32 v[194:195], v[194:195], v[20:21]
    v_pk_mul_f32 v[196:197], v[196:197], v[20:21]
    v_pk_mul_f32 v[198:199], v[198:199], v[20:21]
    v_cvt_pk_bf16_f32 v22, v192, v193
    v_cvt_pk_bf16_f32 v23, v194, v195
    v_cvt_pk_bf16_f32 v24, v196, v197
    v_cvt_pk_bf16_f32 v25, v198, v199
    buffer_store_dwordx4 v[22:25], v7, s[16:19], s38 offen offset:0 sc1
    v_pk_mul_f32 v[200:201], v[200:201], v[20:21]
    v_pk_mul_f32 v[202:203], v[202:203], v[20:21]
    v_pk_mul_f32 v[204:205], v[204:205], v[20:21]
    v_pk_mul_f32 v[206:207], v[206:207], v[20:21]
    v_cvt_pk_bf16_f32 v26, v200, v201
    v_cvt_pk_bf16_f32 v27, v202, v203
    v_cvt_pk_bf16_f32 v28, v204, v205
    v_cvt_pk_bf16_f32 v29, v206, v207
    buffer_store_dwordx4 v[26:29], v7, s[16:19], s38 offen offset:1024 sc1
    v_pk_mul_f32 v[208:209], v[208:209], v[20:21]
    v_pk_mul_f32 v[210:211], v[210:211], v[20:21]
    v_pk_mul_f32 v[212:213], v[212:213], v[20:21]
    v_pk_mul_f32 v[214:215], v[214:215], v[20:21]
    v_cvt_pk_bf16_f32 v30, v208, v209
    v_cvt_pk_bf16_f32 v31, v210, v211
    v_cvt_pk_bf16_f32 v32, v212, v213
    v_cvt_pk_bf16_f32 v33, v214, v215
    buffer_store_dwordx4 v[30:33], v7, s[16:19], s38 offen offset:2048 sc1
    v_pk_mul_f32 v[216:217], v[216:217], v[20:21]
    v_pk_mul_f32 v[218:219], v[218:219], v[20:21]
    v_pk_mul_f32 v[220:221], v[220:221], v[20:21]
    v_pk_mul_f32 v[222:223], v[222:223], v[20:21]
    v_cvt_pk_bf16_f32 v34, v216, v217
    v_cvt_pk_bf16_f32 v35, v218, v219
    v_cvt_pk_bf16_f32 v36, v220, v221
    v_cvt_pk_bf16_f32 v37, v222, v223
    buffer_store_dwordx4 v[34:37], v7, s[16:19], s38 offen offset:3072 sc1
    s_add_u32 s38, s38, 131072
    v_mov_b32 v20, v39
    v_mov_b32 v21, v39
    v_pk_mul_f32 v[224:225], v[224:225], v[20:21]
    v_pk_mul_f32 v[226:227], v[226:227], v[20:21]
    v_pk_mul_f32 v[228:229], v[228:229], v[20:21]
    v_pk_mul_f32 v[230:231], v[230:231], v[20:21]
    v_cvt_pk_bf16_f32 v22, v224, v225
    v_cvt_pk_bf16_f32 v23, v226, v227
    v_cvt_pk_bf16_f32 v24, v228, v229
    v_cvt_pk_bf16_f32 v25, v230, v231
    buffer_store_dwordx4 v[22:25], v7, s[16:19], s38 offen offset:0 sc1
    v_pk_mul_f32 v[232:233], v[232:233], v[20:21]
    v_pk_mul_f32 v[234:235], v[234:235], v[20:21]
    v_pk_mul_f32 v[236:237], v[236:237], v[20:21]
    v_pk_mul_f32 v[238:239], v[238:239], v[20:21]
    v_cvt_pk_bf16_f32 v26, v232, v233
    v_cvt_pk_bf16_f32 v27, v234, v235
    v_cvt_pk_bf16_f32 v28, v236, v237
    v_cvt_pk_bf16_f32 v29, v238, v239
    buffer_store_dwordx4 v[26:29], v7, s[16:19], s38 offen offset:1024 sc1
    v_pk_mul_f32 v[240:241], v[240:241], v[20:21]
    v_pk_mul_f32 v[242:243], v[242:243], v[20:21]
    v_pk_mul_f32 v[244:245], v[244:245], v[20:21]
    v_pk_mul_f32 v[246:247], v[246:247], v[20:21]
    v_cvt_pk_bf16_f32 v30, v240, v241
    v_cvt_pk_bf16_f32 v31, v242, v243
    v_cvt_pk_bf16_f32 v32, v244, v245
    v_cvt_pk_bf16_f32 v33, v246, v247
    buffer_store_dwordx4 v[30:33], v7, s[16:19], s38 offen offset:2048 sc1
    v_pk_mul_f32 v[248:249], v[248:249], v[20:21]
    v_pk_mul_f32 v[250:251], v[250:251], v[20:21]
    v_pk_mul_f32 v[252:253], v[252:253], v[20:21]
    v_pk_mul_f32 v[254:255], v[254:255], v[20:21]
    v_cvt_pk_bf16_f32 v34, v248, v249
    v_cvt_pk_bf16_f32 v35, v250, v251
    v_cvt_pk_bf16_f32 v36, v252, v253
    v_cvt_pk_bf16_f32 v37, v254, v255
    buffer_store_dwordx4 v[34:37], v7, s[16:19], s38 offen offset:3072 sc1
    v_mov_b32 v96, v112
    v_mov_b32 v97, v113
    v_mov_b32 v98, v114
    v_mov_b32 v99, v115
    v_mov_b32 v100, v116
    v_mov_b32 v101, v117
    v_mov_b32 v102, v118
    v_mov_b32 v103, v119
    s_branch L_p3_done
L_recurrent_scan__compressed_kv_cla__moe_arch_mod__prompt_kernel_rare_108:
    s_lshl_b32 s36, s29, 7
    v_mov_b32 v20, s36
    v_mov_b32 v21, 1
    s_mov_b64 exec, 1
    global_atomic_add v20, v21, s[90:91]
    s_mov_b64 exec, -1
    s_nop 3
    s_branch L_recurrent_scan__compressed_kv_cla__moe_arch_mod__prompt_kernel_back_109
L_recurrent_scan__compressed_kv_cla__moe_arch_mod__prompt_kernel_rare_110:
    v_mov_b32 v20, 4048155338
    v_subrev_u32 v21, s50, v18
    v_cmp_gt_i32 s[20:21], 0, v21
    v_cmp_gt_i32 s[22:23], 1, v21
    v_cmp_gt_i32 s[62:63], 2, v21
    v_cmp_gt_i32 vcc, 3, v21
    v_cndmask_b32 v96, v96, v20, s[20:21]
    v_cndmask_b32 v97, v97, v20, s[22:23]
    v_cndmask_b32 v98, v98, v20, s[62:63]
    v_cndmask_b32 v99, v99, v20, vcc
    v_cmp_gt_i32 s[20:21], 16, v21
    v_cmp_gt_i32 s[22:23], 17, v21
    v_cmp_gt_i32 s[62:63], 18, v21
    v_cmp_gt_i32 vcc, 19, v21
    v_cndmask_b32 v100, v100, v20, s[20:21]
    v_cndmask_b32 v101, v101, v20, s[22:23]
    v_cndmask_b32 v102, v102, v20, s[62:63]
    v_cndmask_b32 v103, v103, v20, vcc
    v_cmp_gt_i32 s[20:21], -16, v21
    v_cmp_gt_i32 s[22:23], -15, v21
    v_cmp_gt_i32 s[62:63], -14, v21
    v_cmp_gt_i32 vcc, -13, v21
    v_cndmask_b32 v104, v104, v20, s[20:21]
    v_cndmask_b32 v105, v105, v20, s[22:23]
    v_cndmask_b32 v106, v106, v20, s[62:63]
    v_cndmask_b32 v107, v107, v20, vcc
    v_cmp_gt_i32 s[20:21], 0, v21
    v_cmp_gt_i32 s[22:23], 1, v21
    v_cmp_gt_i32 s[62:63], 2, v21
    v_cmp_gt_i32 vcc, 3, v21
    v_cndmask_b32 v108, v108, v20, s[20:21]
    v_cndmask_b32 v109, v109, v20, s[22:23]
    v_cndmask_b32 v110, v110, v20, s[62:63]
    v_cndmask_b32 v111, v111, v20, vcc
    s_branch L_recurrent_scan__compressed_kv_cla__moe_arch_mod__prompt_kernel_back_111
L_recurrent_scan__compressed_kv_cla__moe_arch_mod__prompt_kernel_rare_113:
    v_mov_b32 v20, 4048155338
    v_subrev_u32 v21, s49, v18
    v_cmp_gt_i32 s[20:21], 0, v21
    v_cmp_gt_i32 s[22:23], 1, v21
    v_cmp_gt_i32 s[62:63], 2, v21
    v_cmp_gt_i32 vcc, 3, v21
    v_cndmask_b32 v112, v112, v20, s[20:21]
    v_cndmask_b32 v113, v113, v20, s[22:23]
    v_cndmask_b32 v114, v114, v20, s[62:63]
    v_cndmask_b32 v115, v115, v20, vcc
    v_cmp_gt_i32 s[20:21], 16, v21
    v_cmp_gt_i32 s[22:23], 17, v21
    v_cmp_gt_i32 s[62:63], 18, v21
    v_cmp_gt_i32 vcc, 19, v21
    v_cndmask_b32 v116, v116, v20, s[20:21]
    v_cndmask_b32 v117, v117, v20, s[22:23]
    v_cndmask_b32 v118, v118, v20, s[62:63]
    v_cndmask_b32 v119, v119, v20, vcc
    v_cmp_gt_i32 s[20:21], -16, v21
    v_cmp_gt_i32 s[22:23], -15, v21
    v_cmp_gt_i32 s[62:63], -14, v21
    v_cmp_gt_i32 vcc, -13, v21
    v_cndmask_b32 v120, v120, v20, s[20:21]
    v_cndmask_b32 v121, v121, v20, s[22:23]
    v_cndmask_b32 v122, v122, v20, s[62:63]
    v_cndmask_b32 v123, v123, v20, vcc
    v_cmp_gt_i32 s[20:21], 0, v21
    v_cmp_gt_i32 s[22:23], 1, v21
    v_cmp_gt_i32 s[62:63], 2, v21
    v_cmp_gt_i32 vcc, 3, v21
    v_cndmask_b32 v124, v124, v20, s[20:21]
    v_cndmask_b32 v125, v125, v20, s[22:23]
    v_cndmask_b32 v126, v126, v20, s[62:63]
    v_cndmask_b32 v127, v127, v20, vcc
    s_branch L_recurrent_scan__compressed_kv_cla__moe_arch_mod__prompt_kernel_back_114
L_recurrent_scan__compressed_kv_cla__moe_arch_mod__prompt_kernel_rare_115:
    v_mov_b32 v8, v38
    v_mov_b32 v9, v39
    v_mov_b32 v38, 0
    v_mov_b32 v39, 0
    s_branch L_recurrent_scan__compressed_kv_cla__moe_arch_mod__prompt_kernel_back_116
L_recurrent_scan__compressed_kv_cla__moe_arch_mod__prompt_kernel_rare_117:
    v_mov_b32 v20, 4048155338
    v_subrev_u32 v21, s50, v18
    v_cmp_gt_i32 s[20:21], 0, v21
    v_cmp_gt_i32 s[22:23], 1, v21
    v_cmp_gt_i32 s[62:63], 2, v21
    v_cmp_gt_i32 vcc, 3, v21
    v_cndmask_b32 v96, v96, v20, s[20:21]
    v_cndmask_b32 v97, v97, v20, s[22:23]
    v_cndmask_b32 v98, v98, v20, s[62:63]
    v_cndmask_b32 v99, v99, v20, vcc
    v_cmp_gt_i32 s[20:21], 16, v21
    v_cmp_gt_i32 s[22:23], 17, v21
    v_cmp_gt_i32 s[62:63], 18, v21
    v_cmp_gt_i32 vcc, 19, v21
    v_cndmask_b32 v100, v100, v20, s[20:21]
    v_cndmask_b32 v101, v101, v20, s[22:23]
    v_cndmask_b32 v102, v102, v20, s[62:63]
    v_cndmask_b32 v103, v103, v20, vcc
    v_cmp_gt_i32 s[20:21], -16, v21
    v_cmp_gt_i32 s[22:23], -15, v21
    v_cmp_gt_i32 s[62:63], -14, v21
    v_cmp_gt_i32 vcc, -13, v21
    v_cndmask_b32 v104, v104, v20, s[20:21]
    v_cndmask_b32 v105, v105, v20, s[22:23]
    v_cndmask_b32 v106, v106, v20, s[62:63]
    v_cndmask_b32 v107, v107, v20, vcc
    v_cmp_gt_i32 s[20:21], 0, v21
    v_cmp_gt_i32 s[22:23], 1, v21
    v_cmp_gt_i32 s[62:63], 2, v21
    v_cmp_gt_i32 vcc, 3, v21
    v_cndmask_b32 v108, v108, v20, s[20:21]
    v_cndmask_b32 v109, v109, v20, s[22:23]
    v_cndmask_b32 v110, v110, v20, s[62:63]
    v_cndmask_b32 v111, v111, v20, vcc
    s_branch L_recurrent_scan__compressed_kv_cla__moe_arch_mod__prompt_kernel_back_118
L_recurrent_scan__compressed_kv_cla__moe_arch_mod__prompt_kernel_rare_120:
    v_mov_b32 v20, 4048155338
    v_subrev_u32 v21, s49, v18
    v_cmp_gt_i32 s[20:21], 0, v21
    v_cmp_gt_i32 s[22:23], 1, v21
    v_cmp_gt_i32 s[62:63], 2, v21
    v_cmp_gt_i32 vcc, 3, v21
    v_cndmask_b32 v112, v112, v20, s[20:21]
    v_cndmask_b32 v113, v113, v20, s[22:23]
    v_cndmask_b32 v114, v114, v20, s[62:63]
    v_cndmask_b32 v115, v115, v20, vcc
    v_cmp_gt_i32 s[20:21], 16, v21
    v_cmp_gt_i32 s[22:23], 17, v21
    v_cmp_gt_i32 s[62:63], 18, v21
    v_cmp_gt_i32 vcc, 19, v21
    v_cndmask_b32 v116, v116, v20, s[20:21]
    v_cndmask_b32 v117, v117, v20, s[22:23]
    v_cndmask_b32 v118, v118, v20, s[62:63]
    v_cndmask_b32 v119, v119, v20, vcc
    v_cmp_gt_i32 s[20:21], -16, v21
    v_cmp_gt_i32 s[22:23], -15, v21
    v_cmp_gt_i32 s[62:63], -14, v21
    v_cmp_gt_i32 vcc, -13, v21
    v_cndmask_b32 v120, v120, v20, s[20:21]
    v_cndmask_b32 v121, v121, v20, s[22:23]
    v_cndmask_b32 v122, v122, v20, s[62:63]
    v_cndmask_b32 v123, v123, v20, vcc
    v_cmp_gt_i32 s[20:21], 0, v21
    v_cmp_gt_i32 s[22:23], 1, v21
    v_cmp_gt_i32 s[62:63], 2, v21
    v_cmp_gt_i32 vcc, 3, v21
    v_cndmask_b32 v124, v124, v20, s[20:21]
    v_cndmask_b32 v125, v125, v20, s[22:23]
    v_cndmask_b32 v126, v126, v20, s[62:63]
    v_cndmask_b32 v127, v127, v20, vcc
    s_branch L_recurrent_scan__compressed_kv_cla__moe_arch_mod__prompt_kernel_back_121
L_recurrent_scan__compressed_kv_cla__moe_arch_mod__prompt_kernel_rare_122:
    s_cmp_lg_u32 s40, s51
    s_cbranch_scc1 L_recurrent_scan__compressed_kv_cla__moe_arch_mod__prompt_kernel_epi_124
    v_swap_b32 v128, v160
    v_swap_b32 v129, v161
    v_swap_b32 v130, v162
    v_swap_b32 v131, v163
    v_swap_b32 v132, v164
    v_swap_b32 v133, v165
    v_swap_b32 v134, v166
    v_swap_b32 v135, v167
    v_swap_b32 v136, v168
    v_swap_b32 v137, v169
    v_swap_b32 v138, v170
    v_swap_b32 v139, v171
    v_swap_b32 v140, v172
    v_swap_b32 v141, v173
    v_swap_b32 v142, v174
    v_swap_b32 v143, v175
    v_swap_b32 v144, v176
    v_swap_b32 v145, v177
    v_swap_b32 v146, v178
    v_swap_b32 v147, v179
    v_swap_b32 v148, v180
    v_swap_b32 v149, v181
    v_swap_b32 v150, v182
    v_swap_b32 v151, v183
    v_swap_b32 v152, v184
    v_swap_b32 v153, v185
    v_swap_b32 v154, v186
    v_swap_b32 v155, v187
    v_swap_b32 v156, v188
    v_swap_b32 v157, v189
    v_swap_b32 v158, v190
    v_swap_b32 v159, v191
    v_mov_b32 v40, v14
    v_mov_b32 v41, v14
    v_mov_b32 v42, v14
    v_mov_b32 v43, v14
    v_mov_b32 v44, v15
    v_mov_b32 v45, v15
    v_mov_b32 v46, v15
    v_mov_b32 v47, v15
    s_nop 1
    s_branch L_recurrent_scan__compressed_kv_cla__moe_arch_mod__prompt_kernel_back_123
L_recurrent_scan__compressed_kv_cla__moe_arch_mod__prompt_kernel_epi_124:
    v_mov_b32 v20, v8
    s_nop 1
    v_permlane16_swap_b32 v8, v20
    s_nop 1
    v_add_f32 v8, v8, v20
    v_mov_b32 v20, v8
    s_nop 1
    v_permlane32_swap_b32 v8, v20
    s_nop 1
    v_add_f32 v8, v8, v20
    v_mov_b32 v20, v9
    s_nop 1
    v_permlane16_swap_b32 v9, v20
    s_nop 1
    v_add_f32 v9, v9, v20
    v_mov_b32 v20, v9
    s_nop 1
    v_permlane32_swap_b32 v9, v20
    s_nop 1
    v_add_f32 v9, v9, v20
    s_mov_b32 s36, 0x5d800000
    v_cmp_nge_f32 vcc, s36, v8
    s_nop 0
    s_or_b64 s[52:53], s[52:53], vcc
    v_cmp_nge_f32 vcc, s36, v9
    s_nop 0
    s_or_b64 s[52:53], s[52:53], vcc
    v_rcp_f32 v8, v8
    v_rcp_f32 v9, v9
    s_lshl_b32 s38, s30, 3
    s_and_b32 s37, s28, 3
    s_lshl_b32 s37, s37, 1
    s_add_u32 s38, s38, s37
    s_lshl_b32 s38, s38, 17
    s_lshl_b32 s37, s29, 12
    s_add_u32 s38, s38, s37
    v_mov_b32 v20, v8
    v_mov_b32 v21, v8
    v_pk_mul_f32 v[192:193], v[192:193], v[20:21]
    v_pk_mul_f32 v[194:195], v[194:195], v[20:21]
    v_pk_mul_f32 v[196:197], v[196:197], v[20:21]
    v_pk_mul_f32 v[198:199], v[198:199], v[20:21]
    v_cvt_pk_bf16_f32 v22, v192, v193
    v_cvt_pk_bf16_f32 v23, v194, v195
    v_cvt_pk_bf16_f32 v24, v196, v197
    v_cvt_pk_bf16_f32 v25, v198, v199
    buffer_store_dwordx4 v[22:25], v7, s[16:19], s38 offen offset:0 sc1
    v_pk_mul_f32 v[200:201], v[200:201], v[20:21]
    v_pk_mul_f32 v[202:203], v[202:203], v[20:21]
    v_pk_mul_f32 v[204:205], v[204:205], v[20:21]
    v_pk_mul_f32 v[206:207], v[206:207], v[20:21]
    v_cvt_pk_bf16_f32 v26, v200, v201
    v_cvt_pk_bf16_f32 v27, v202, v203
    v_cvt_pk_bf16_f32 v28, v204, v205
    v_cvt_pk_bf16_f32 v29, v206, v207
    buffer_store_dwordx4 v[26:29], v7, s[16:19], s38 offen offset:1024 sc1
    v_pk_mul_f32 v[208:209], v[208:209], v[20:21]
    v_pk_mul_f32 v[210:211], v[210:211], v[20:21]
    v_pk_mul_f32 v[212:213], v[212:213], v[20:21]
    v_pk_mul_f32 v[214:215], v[214:215], v[20:21]
    v_cvt_pk_bf16_f32 v30, v208, v209
    v_cvt_pk_bf16_f32 v31, v210, v211
    v_cvt_pk_bf16_f32 v32, v212, v213
    v_cvt_pk_bf16_f32 v33, v214, v215
    buffer_store_dwordx4 v[30:33], v7, s[16:19], s38 offen offset:2048 sc1
    v_pk_mul_f32 v[216:217], v[216:217], v[20:21]
    v_pk_mul_f32 v[218:219], v[218:219], v[20:21]
    v_pk_mul_f32 v[220:221], v[220:221], v[20:21]
    v_pk_mul_f32 v[222:223], v[222:223], v[20:21]
    v_cvt_pk_bf16_f32 v34, v216, v217
    v_cvt_pk_bf16_f32 v35, v218, v219
    v_cvt_pk_bf16_f32 v36, v220, v221
    v_cvt_pk_bf16_f32 v37, v222, v223
    buffer_store_dwordx4 v[34:37], v7, s[16:19], s38 offen offset:3072 sc1
    s_add_u32 s38, s38, 131072
    v_mov_b32 v20, v9
    v_mov_b32 v21, v9
    v_pk_mul_f32 v[224:225], v[224:225], v[20:21]
    v_pk_mul_f32 v[226:227], v[226:227], v[20:21]
    v_pk_mul_f32 v[228:229], v[228:229], v[20:21]
    v_pk_mul_f32 v[230:231], v[230:231], v[20:21]
    v_cvt_pk_bf16_f32 v22, v224, v225
    v_cvt_pk_bf16_f32 v23, v226, v227
    v_cvt_pk_bf16_f32 v24, v228, v229
    v_cvt_pk_bf16_f32 v25, v230, v231
    buffer_store_dwordx4 v[22:25], v7, s[16:19], s38 offen offset:0 sc1
    v_pk_mul_f32 v[232:233], v[232:233], v[20:21]
    v_pk_mul_f32 v[234:235], v[234:235], v[20:21]
    v_pk_mul_f32 v[236:237], v[236:237], v[20:21]
    v_pk_mul_f32 v[238:239], v[238:239], v[20:21]
    v_cvt_pk_bf16_f32 v26, v232, v233
    v_cvt_pk_bf16_f32 v27, v234, v235
    v_cvt_pk_bf16_f32 v28, v236, v237
    v_cvt_pk_bf16_f32 v29, v238, v239
    buffer_store_dwordx4 v[26:29], v7, s[16:19], s38 offen offset:1024 sc1
    v_pk_mul_f32 v[240:241], v[240:241], v[20:21]
    v_pk_mul_f32 v[242:243], v[242:243], v[20:21]
    v_pk_mul_f32 v[244:245], v[244:245], v[20:21]
    v_pk_mul_f32 v[246:247], v[246:247], v[20:21]
    v_cvt_pk_bf16_f32 v30, v240, v241
    v_cvt_pk_bf16_f32 v31, v242, v243
    v_cvt_pk_bf16_f32 v32, v244, v245
    v_cvt_pk_bf16_f32 v33, v246, v247
    buffer_store_dwordx4 v[30:33], v7, s[16:19], s38 offen offset:2048 sc1
    v_pk_mul_f32 v[248:249], v[248:249], v[20:21]
    v_pk_mul_f32 v[250:251], v[250:251], v[20:21]
    v_pk_mul_f32 v[252:253], v[252:253], v[20:21]
    v_pk_mul_f32 v[254:255], v[254:255], v[20:21]
    v_cvt_pk_bf16_f32 v34, v248, v249
    v_cvt_pk_bf16_f32 v35, v250, v251
    v_cvt_pk_bf16_f32 v36, v252, v253
    v_cvt_pk_bf16_f32 v37, v254, v255
    buffer_store_dwordx4 v[34:37], v7, s[16:19], s38 offen offset:3072 sc1
    v_mov_b64 v[192:193], 0
    v_mov_b64 v[194:195], 0
    v_mov_b64 v[196:197], 0
    v_mov_b64 v[198:199], 0
    v_mov_b64 v[200:201], 0
    v_mov_b64 v[202:203], 0
    v_mov_b64 v[204:205], 0
    v_mov_b64 v[206:207], 0
    v_mov_b64 v[208:209], 0
    v_mov_b64 v[210:211], 0
    v_mov_b64 v[212:213], 0
    v_mov_b64 v[214:215], 0
    v_mov_b64 v[216:217], 0
    v_mov_b64 v[218:219], 0
    v_mov_b64 v[220:221], 0
    v_mov_b64 v[222:223], 0
    v_mov_b64 v[224:225], 0
    v_mov_b64 v[226:227], 0
    v_mov_b64 v[228:229], 0
    v_mov_b64 v[230:231], 0
    v_mov_b64 v[232:233], 0
    v_mov_b64 v[234:235], 0
    v_mov_b64 v[236:237], 0
    v_mov_b64 v[238:239], 0
    v_mov_b64 v[240:241], 0
    v_mov_b64 v[242:243], 0
    v_mov_b64 v[244:245], 0
    v_mov_b64 v[246:247], 0
    v_mov_b64 v[248:249], 0
    v_mov_b64 v[250:251], 0
    v_mov_b64 v[252:253], 0
    v_mov_b64 v[254:255], 0
    s_branch L_recurrent_scan__compressed_kv_cla__moe_arch_mod__prompt_kernel_back_123
L_recurrent_scan__compressed_kv_cla__moe_arch_mod__prompt_kernel_rare_128:
    s_cmp_eq_u32 s40, 1
    s_cbranch_scc0 L_recurrent_scan__compressed_kv_cla__moe_arch_mod__prompt_kernel_nm_125
    ds_read_b64 v[14:15], v19
    s_waitcnt lgkmcnt(0)
L_recurrent_scan__compressed_kv_cla__moe_arch_mod__prompt_kernel_nm_125:
    s_cmp_eq_u32 s40, 1
    s_cbranch_scc1 L_recurrent_scan__compressed_kv_cla__moe_arch_mod__prompt_kernel_bh_126
    s_getpc_b64 s[36:37]
L_recurrent_scan__compressed_kv_cla__moe_arch_mod__prompt_kernel_pc_127:
    s_sub_u32 s36, s36, L_recurrent_scan__compressed_kv_cla__moe_arch_mod__prompt_kernel_pc_127-L_pc
    s_subb_u32 s37, s37, 0
    s_lshr_b32 s38, s2, 3
    s_lshl_b32 s38, s38, 7
    v_lshl_add_u32 v26, v1, 12, s38
    v_min_u32 v26, L_end-L_pc-4, v26
    v_mov_b32 v27, s37
    v_add_co_u32 v26, vcc, s36, v26
    s_mov_b64 exec, 0xffff
    s_nop 0
    v_addc_co_u32 v27, vcc, 0, v27, vcc
    global_load_dword v0, v[26:27], off
    s_mov_b64 exec, -1
    s_nop 1
L_recurrent_scan__compressed_kv_cla__moe_arch_mod__prompt_kernel_bh_126:
    s_branch L_recurrent_scan__compressed_kv_cla__moe_arch_mod__prompt_kernel_back_129
L_recurrent_scan__compressed_kv_cla__moe_arch_mod__prompt_kernel_rare_132:
    s_mov_b32 s61, 0x40000
L_recurrent_scan__compressed_kv_cla__moe_arch_mod__prompt_kernel_spin_130:
    s_sub_u32 s61, s61, 1
    s_cbranch_scc1 L_recurrent_scan__compressed_kv_cla__moe_arch_mod__prompt_kernel_spinx_131
    s_sleep 8
    global_load_dword v11, v12, s[90:91] sc1
    s_waitcnt vmcnt(0)
    v_readfirstlane_b32 s36, v11
    s_nop 0
    s_cmp_lt_u32 s36, 28
    s_cbranch_scc1 L_recurrent_scan__compressed_kv_cla__moe_arch_mod__prompt_kernel_spin_130
L_recurrent_scan__compressed_kv_cla__moe_arch_mod__prompt_kernel_spinx_131:
    s_branch L_recurrent_scan__compressed_kv_cla__moe_arch_mod__prompt_kernel_back_133
L_recurrent_scan__compressed_kv_cla__moe_arch_mod__prompt_kernel_rare_137:
    v_mov_b32 v20, 4048155338
    v_subrev_u32 v21, s50, v18
    v_cmp_gt_i32 s[20:21], 0, v21
    v_cmp_gt_i32 s[22:23], 1, v21
    v_cmp_gt_i32 s[62:63], 2, v21
    v_cmp_gt_i32 vcc, 3, v21
    v_cndmask_b32 v96, v96, v20, s[20:21]
    v_cndmask_b32 v97, v97, v20, s[22:23]
    v_cndmask_b32 v98, v98, v20, s[62:63]
    v_cndmask_b32 v99, v99, v20, vcc
    v_cmp_gt_i32 s[20:21], 16, v21
    v_cmp_gt_i32 s[22:23], 17, v21
    v_cmp_gt_i32 s[62:63], 18, v21
    v_cmp_gt_i32 vcc, 19, v21
    v_cndmask_b32 v100, v100, v20, s[20:21]
    v_cndmask_b32 v101, v101, v20, s[22:23]
    v_cndmask_b32 v102, v102, v20, s[62:63]
    v_cndmask_b32 v103, v103, v20, vcc
    v_cmp_gt_i32 s[20:21], -16, v21
    v_cmp_gt_i32 s[22:23], -15, v21
    v_cmp_gt_i32 s[62:63], -14, v21
    v_cmp_gt_i32 vcc, -13, v21
    v_cndmask_b32 v104, v104, v20, s[20:21]
    v_cndmask_b32 v105, v105, v20, s[22:23]
    v_cndmask_b32 v106, v106, v20, s[62:63]
    v_cndmask_b32 v107, v107, v20, vcc
    v_cmp_gt_i32 s[20:21], 0, v21
    v_cmp_gt_i32 s[22:23], 1, v21
    v_cmp_gt_i32 s[62:63], 2, v21
    v_cmp_gt_i32 vcc, 3, v21
    v_cndmask_b32 v108, v108, v20, s[20:21]
    v_cndmask_b32 v109, v109, v20, s[22:23]
    v_cndmask_b32 v110, v110, v20, s[62:63]
    v_cndmask_b32 v111, v111, v20, vcc
    s_branch L_recurrent_scan__compressed_kv_cla__moe_arch_mod__prompt_kernel_back_138
L_p3_done:
    s_waitcnt vmcnt(4)
    s_and_b32 s36, s2, 7
    s_lshl_b32 s36, s36, 2
    s_sub_u32 s40, 47, s30
    s_lshl_b32 s40, s40, 7
    s_add_u32 s40, s40, s36
    s_add_u32 s41, s30, 32
    s_lshl_b32 s41, s41, 7
    s_add_u32 s41, s41, s36
    s_and_b32 s63, s30, 1
    s_bfe_u32 s36, s2, 0x10002
    s_lshl_b32 s36, s36, 3
    s_add_u32 s30, s30, s36
    s_and_b32 s29, s29, 15
    s_and_b32 s36, s28, 3
    s_lshl_b32 s37, s29, 2
    s_add_u32 s36, s36, s37
    s_lshl_b32 s36, s36, 18
    s_lshr_b32 s37, s28, 2
    s_lshl_b32 s37, s37, 12
    s_add_u32 s36, s36, s37
    s_lshl_b32 s37, s63, 16
    s_add_u32 s36, s36, s37
    v_lshl_add_u32 v2, v1, 4, s36
    v_add_u32 v3, 131072, v2
    v_lshrrev_b32 v19, 4, v1
    s_lshr_b32 s36, s28, 2
    s_lshl_b32 s36, s36, 7
    s_and_b32 s37, s28, 3
    s_lshl_b32 s37, s37, 4
    s_add_u32 s36, s36, s37
    s_lshl_b32 s33, s36, 8
    s_lshl_b32 s37, s63, 11
    s_add_u32 s36, s36, s37
    v_add_u32 v18, s36, v19
    v_lshlrev_b32 v18, 11, v18
    s_lshr_b32 s36, s30, 1
    s_lshl_b32 s36, s36, 8
    v_add_u32 v18, s36, v18
    v_lshlrev_b32 v20, 1, v19
    v_and_b32 v21, 15, v1
    v_xor_b32 v20, v20, v21
    v_lshl_add_u32 v6, v20, 4, v18
    v_xor_b32 v20, 8, v20
    v_lshl_add_u32 v7, v20, 4, v18
    v_add_u32 v7, 7168, v7
    v_add_u32 v8, 14336, v6
    v_add_u32 v9, 14336, v7
    s_add_u32 s36, s2, 1
    s_and_b32 s62, s36, 3
    s_lshl_b32 s31, s62, 14
    s_lshl_b32 s32, s62, 20
    s_waitcnt vmcnt(0)
    s_barrier
    s_cmp_eq_u32 s28, 0
    s_cbranch_scc1 L_recurrent_scan__compressed_kv_cla__moe_arch_mod__prompt_kernel_rare_139
L_recurrent_scan__compressed_kv_cla__moe_arch_mod__prompt_kernel_back_140:
    s_bitcmp1_b32 0x70, s28
    s_cbranch_scc1 L_recurrent_scan__compressed_kv_cla__moe_arch_mod__prompt_kernel_f2m_168
L_recurrent_scan__compressed_kv_cla__moe_arch_mod__prompt_kernel_f2a_169:
    s_mov_b32 s34, s33
    s_add_u32 m0, s34, 65536
    s_nop 0
    buffer_load_dwordx4 v6, s[8:11], s32 offen offset:0 lds
    buffer_load_dwordx4 v7, s[8:11], s32 offen offset:1024 lds
    buffer_load_dwordx4 v8, s[8:11], s32 offen offset:2048 lds
    buffer_load_dwordx4 v9, s[8:11], s32 offen offset:3072 lds
    s_add_u32 s32, s32, 131072
    s_add_u32 m0, s34, 81920
    s_nop 0
    buffer_load_dwordx4 v6, s[8:11], s32 offen offset:0 lds
    buffer_load_dwordx4 v7, s[8:11], s32 offen offset:1024 lds
    buffer_load_dwordx4 v8, s[8:11], s32 offen offset:2048 lds
    buffer_load_dwordx4 v9, s[8:11], s32 offen offset:3072 lds
    s_add_u32 s32, s32, 393216
    s_and_b32 s32, s32, 0x3fffff
    s_add_u32 m0, s34, 0
    s_nop 0
    buffer_load_dwordx4 v6, s[8:11], s32 offen offset:0 lds
    buffer_load_dwordx4 v7, s[8:11], s32 offen offset:1024 lds
    buffer_load_dwordx4 v8, s[8:11], s32 offen offset:2048 lds
    buffer_load_dwordx4 v9, s[8:11], s32 offen offset:3072 lds
    s_add_u32 s32, s32, 131072
    s_add_u32 m0, s34, 16384
    s_nop 0
    buffer_load_dwordx4 v6, s[8:11], s32 offen offset:0 lds
    buffer_load_dwordx4 v7, s[8:11], s32 offen offset:1024 lds
    buffer_load_dwordx4 v8, s[8:11], s32 offen offset:2048 lds
    buffer_load_dwordx4 v9, s[8:11], s32 offen offset:3072 lds
    s_add_u32 s32, s32, 393216
    s_and_b32 s32, s32, 0x3fffff
    s_cmp_lt_u32 s28, 4
    s_cbranch_scc1 L_recurrent_scan__compressed_kv_cla__moe_arch_mod__prompt_kernel_f2m_168
L_recurrent_scan__compressed_kv_cla__moe_arch_mod__prompt_kernel_f2b_170:
    s_add_u32 s4, s54, 41943040
    s_addc_u32 s5, s55, 0
    s_and_b32 s5, s5, 0xffff
    s_mov_b32 s6, 16777216
    s_mov_b32 s7, 0x20000
    s_mov_b32 s16, s96
    s_and_b32 s17, s97, 0xffff
    s_mov_b32 s18, 4194304
    s_mov_b32 s19, 0x20000
    s_mov_b32 s20, s98
    s_and_b32 s21, s99, 0xffff
    s_mov_b32 s22, 4194304
    s_mov_b32 s23, 0x20000
    s_lshl_b32 s36, s29, 7
    s_and_b32 s37, s28, 3
    s_lshl_b32 s37, s37, 5
    s_add_u32 s36, s36, s37
    s_lshr_b32 s37, s28, 2
    s_lshl_b32 s37, s37, 4
    s_add_u32 s38, s36, s37
    v_and_b32 v17, 15, v1
    v_add_u32 v14, s38, v17
    v_lshlrev_b32 v16, 3, v14
    v_lshrrev_b32 v15, 3, v1
    v_add_u32 v15, s38, v15
    v_lshlrev_b32 v15, 11, v15
    v_and_b32 v4, 7, v1
    v_lshl_add_u32 v15, v4, 4, v15
    s_lshl_b32 s36, s30, 7
    v_add_u32 v15, s36, v15
    s_lshl_b32 s36, s28, 12
    s_add_u32 s42, s36, 131072
    v_lshl_add_u32 v17, v17, 7, s42
    v_lshl_add_u32 v17, v19, 3, v17
    v_bfe_u32 v20, v1, 2, 2
    v_lshl_add_u32 v18, v19, 2, v20
    v_and_b32 v20, 7, v18
    v_lshlrev_b32 v18, 8, v18
    s_lshr_b32 s36, s28, 2
    s_lshl_b32 s36, s36, 15
    s_add_u32 s36, s36, 65536
    v_add_u32 v18, s36, v18
    v_and_b32 v21, 3, v1
    v_lshl_add_u32 v18, v21, 3, v18
    v_xor_b32 v21, 0, v20
    v_lshl_add_u32 v50, v21, 5, v18
    v_xor_b32 v21, 1, v20
    v_lshl_add_u32 v51, v21, 5, v18
    v_xor_b32 v21, 2, v20
    v_lshl_add_u32 v52, v21, 5, v18
    v_xor_b32 v21, 3, v20
    v_lshl_add_u32 v53, v21, 5, v18
    v_xor_b32 v21, 4, v20
    v_lshl_add_u32 v54, v21, 5, v18
    v_xor_b32 v21, 5, v20
    v_lshl_add_u32 v55, v21, 5, v18
    v_xor_b32 v21, 6, v20
    v_lshl_add_u32 v56, v21, 5, v18
    v_xor_b32 v21, 7, v20
    v_lshl_add_u32 v57, v21, 5, v18
    v_mov_b64 v[192:193], 0
    v_mov_b64 v[194:195], 0
    v_mov_b64 v[196:197], 0
    v_mov_b64 v[198:199], 0
    v_mov_b64 v[200:201], 0
    v_mov_b64 v[202:203], 0
    v_mov_b64 v[204:205], 0
    v_mov_b64 v[206:207], 0
    v_mov_b64 v[208:209], 0
    v_mov_b64 v[210:211], 0
    v_mov_b64 v[212:213], 0
    v_mov_b64 v[214:215], 0
    v_mov_b64 v[216:217], 0
    v_mov_b64 v[218:219], 0
    v_mov_b64 v[220:221], 0
    v_mov_b64 v[222:223], 0
    v_mov_b64 v[224:225], 0
    v_mov_b64 v[226:227], 0
    v_mov_b64 v[228:229], 0
    v_mov_b64 v[230:231], 0
    v_mov_b64 v[232:233], 0
    v_mov_b64 v[234:235], 0
    v_mov_b64 v[236:237], 0
    v_mov_b64 v[238:239], 0
    v_mov_b64 v[240:241], 0
    v_mov_b64 v[242:243], 0
    v_mov_b64 v[244:245], 0
    v_mov_b64 v[246:247], 0
    v_mov_b64 v[248:249], 0
    v_mov_b64 v[250:251], 0
    v_mov_b64 v[252:253], 0
    v_mov_b64 v[254:255], 0
    s_mov_b32 s60, 15
    s_cmp_eq_u32 s28, 3
    s_cbranch_scc0 L_recurrent_scan__compressed_kv_cla__moe_arch_mod__prompt_kernel_w7j_171
    v_add_u32 v58, s62, v1
    v_and_b32 v58, 3, v58
    s_add_u32 s36, s29, 32
    s_lshl_b32 s36, s36, 7
    s_lshl_b32 s37, s63, 4
    s_add_u32 s36, s36, s37
    v_lshl_add_u32 v58, v58, 2, s36
    s_mov_b32 s61, 0x40000
L_recurrent_scan__compressed_kv_cla__moe_arch_mod__prompt_kernel_cspin_172:
    s_sub_u32 s61, s61, 1
    s_cbranch_scc1 L_recurrent_scan__compressed_kv_cla__moe_arch_mod__prompt_kernel_cspinx_173
    global_load_dword v59, v58, s[90:91] sc1
    s_waitcnt vmcnt(0)
L_recurrent_scan__compressed_kv_cla__moe_arch_mod__prompt_kernel_cchk_174:
    v_cmp_le_u32 vcc, 4, v59
    s_nop 0
    s_and_b32 s60, vcc_lo, 15
    s_and_b32 s36, s60, 3
    s_cmp_eq_u32 s36, 3
    s_cbranch_scc1 L_recurrent_scan__compressed_kv_cla__moe_arch_mod__prompt_kernel_cspinx_173
    s_sleep 6
    s_branch L_recurrent_scan__compressed_kv_cla__moe_arch_mod__prompt_kernel_cspin_172
L_recurrent_scan__compressed_kv_cla__moe_arch_mod__prompt_kernel_cspinx_173:
L_recurrent_scan__compressed_kv_cla__moe_arch_mod__prompt_kernel_w7j_171:
    s_waitcnt vmcnt(12)
    s_waitcnt lgkmcnt(0)
    s_barrier
    buffer_load_dwordx4 v[128:131], v2, s[4:7], s31 offen offset:0 sc1
    buffer_load_dwordx4 v[132:135], v3, s[4:7], s31 offen offset:0 sc1
    buffer_load_dwordx4 v[136:139], v2, s[4:7], s31 offen offset:1024 sc1
    buffer_load_dwordx4 v[140:143], v3, s[4:7], s31 offen offset:1024 sc1
    buffer_load_dwordx4 v[144:147], v2, s[4:7], s31 offen offset:2048 sc1
    buffer_load_dwordx4 v[148:151], v3, s[4:7], s31 offen offset:2048 sc1
    buffer_load_dwordx4 v[152:155], v2, s[4:7], s31 offen offset:3072 sc1
    buffer_load_dwordx4 v[156:159], v3, s[4:7], s31 offen offset:3072 sc1
    s_add_u32 s31, s31, 8192
    s_and_b32 s31, s31, 0xffff
    s_cmp_lt_u32 s28, 4
    s_cbranch_scc0 L_recurrent_scan__compressed_kv_cla__moe_arch_mod__prompt_kernel_g_141
    s_lshl_b32 s36, s28, 10
    s_add_u32 s36, s36, 131072
    v_lshl_add_u32 v28, v1, 4, s36
    ds_read_b128 v[96:99], v28 offset:0
    ds_read_b128 v[100:103], v28 offset:4096
    ds_read_b128 v[104:107], v28 offset:8192
    ds_read_b128 v[108:111], v28 offset:12288
    ds_read_b128 v[112:115], v28 offset:16384
    ds_read_b128 v[116:119], v28 offset:20480
    ds_read_b128 v[120:123], v28 offset:24576
    s_lshr_b32 s36, s2, 4
    s_lshl_b32 s36, s36, 13
    s_and_b32 s37, s2, 15
    s_lshl_b32 s37, s37, 8
    s_add_u32 s36, s36, s37
    s_lshl_b32 s37, s28, 6
    s_add_u32 s36, s36, s37
    s_add_u32 s36, s36, 59768832
    v_and_b32 v28, 1, v1
    v_lshlrev_b32 v28, 12, v28
    v_lshl_add_u32 v28, v19, 4, v28
    s_waitcnt lgkmcnt(0)
    v_add_f32 v96, v96, v100
    v_add_f32 v97, v97, v101
    v_add_f32 v98, v98, v102
    v_add_f32 v99, v99, v103
    v_add_f32 v96, v96, v104
    v_add_f32 v97, v97, v105
    v_add_f32 v98, v98, v106
    v_add_f32 v99, v99, v107
    v_add_f32 v96, v96, v108
    v_add_f32 v97, v97, v109
    v_add_f32 v98, v98, v110
    v_add_f32 v99, v99, v111
    v_add_f32 v96, v96, v112
    v_add_f32 v97, v97, v113
    v_add_f32 v98, v98, v114
    v_add_f32 v99, v99, v115
    v_add_f32 v96, v96, v116
    v_add_f32 v97, v97, v117
    v_add_f32 v98, v98, v118
    v_add_f32 v99, v99, v119
    v_add_f32 v96, v96, v120
    v_add_f32 v97, v97, v121
    v_add_f32 v98, v98, v122
    v_add_f32 v99, v99, v123
    s_mov_b32 exec_lo, 0x00030003
    s_mov_b32 exec_hi, 0x00030003
    buffer_store_dwordx4 v[96:99], v28, s[24:27], s36 offen sc1
    s_mov_b64 exec, -1
    s_nop 3
L_recurrent_scan__compressed_kv_cla__moe_arch_mod__prompt_kernel_g_141:
    s_lshl_b32 s36, s28, 13
    s_add_u32 s36, s36, 65536
    v_lshl_add_u32 v20, v1, 4, s36
    v_xor_b32 v21, 32768, v20
    ds_read_b64_tr_b16 v[64:65], v50 offset:0
    ds_read_b64_tr_b16 v[66:67], v50 offset:4096
    ds_read_b64_tr_b16 v[68:69], v51 offset:0
    ds_read_b64_tr_b16 v[70:71], v51 offset:4096
    ds_read_b64_tr_b16 v[72:73], v52 offset:0
    ds_read_b64_tr_b16 v[74:75], v52 offset:4096
    ds_read_b64_tr_b16 v[76:77], v53 offset:0
    ds_read_b64_tr_b16 v[78:79], v53 offset:4096
    ds_read_b64_tr_b16 v[80:81], v54 offset:0
    ds_read_b64_tr_b16 v[82:83], v54 offset:4096
    ds_read_b64_tr_b16 v[84:85], v55 offset:0
    ds_read_b64_tr_b16 v[86:87], v55 offset:4096
    s_mov_b32 s35, 0
    s_waitcnt vmcnt(0)
    buffer_load_dwordx4 v[160:163], v2, s[4:7], s31 offen offset:0 sc1
    buffer_load_dwordx4 v[164:167], v3, s[4:7], s31 offen offset:0 sc1
    buffer_load_dwordx4 v[168:171], v2, s[4:7], s31 offen offset:1024 sc1
    buffer_load_dwordx4 v[172:175], v3, s[4:7], s31 offen offset:1024 sc1
    buffer_load_dwordx4 v[176:179], v2, s[4:7], s31 offen offset:2048 sc1
    buffer_load_dwordx4 v[180:183], v3, s[4:7], s31 offen offset:2048 sc1
    .p2align 6
L_p4_loop:
    s_cmp_lg_u32 s35, 0
    s_cbranch_scc1 L_recurrent_scan__compressed_kv_cla__moe_arch_mod__prompt_kernel_rare_151
L_recurrent_scan__compressed_kv_cla__moe_arch_mod__prompt_kernel_back_152:
    s_waitcnt lgkmcnt(8)
    v_mfma_f32_16x16x32_bf16 v[192:195], v[64:67], v[128:131], v[192:195]
    ds_read_b64_tr_b16 v[88:89], v56 offset:0
    v_mfma_f32_16x16x32_bf16 v[224:227], v[64:67], v[132:135], v[224:227]
    ds_read_b64_tr_b16 v[90:91], v56 offset:4096
    v_mfma_f32_16x16x32_bf16 v[196:199], v[68:71], v[128:131], v[196:199]
    ds_read_b64_tr_b16 v[92:93], v57 offset:0
    v_mfma_f32_16x16x32_bf16 v[228:231], v[68:71], v[132:135], v[228:231]
    ds_read_b64_tr_b16 v[94:95], v57 offset:4096
    buffer_load_dwordx4 v[184:187], v2, s[4:7], s31 offen offset:3072 sc1
    s_waitcnt lgkmcnt(8)
    v_mfma_f32_16x16x32_bf16 v[200:203], v[72:75], v[128:131], v[200:203]
    ds_read_b64_tr_b16 v[64:65], v50 offset:8192
    v_mfma_f32_16x16x32_bf16 v[232:235], v[72:75], v[132:135], v[232:235]
    ds_read_b64_tr_b16 v[66:67], v50 offset:12288
    v_mfma_f32_16x16x32_bf16 v[204:207], v[76:79], v[128:131], v[204:207]
    ds_read_b64_tr_b16 v[68:69], v51 offset:8192
    v_mfma_f32_16x16x32_bf16 v[236:239], v[76:79], v[132:135], v[236:239]
    ds_read_b64_tr_b16 v[70:71], v51 offset:12288
    s_waitcnt lgkmcnt(8)
    v_mfma_f32_16x16x32_bf16 v[208:211], v[80:83], v[128:131], v[208:211]
    ds_read_b64_tr_b16 v[72:73], v52 offset:8192
    v_mfma_f32_16x16x32_bf16 v[240:243], v[80:83], v[132:135], v[240:243]
    ds_read_b64_tr_b16 v[74:75], v52 offset:12288
    buffer_load_dwordx4 v[188:191], v3, s[4:7], s31 offen offset:3072 sc1
    s_add_u32 s31, s31, 8192
    s_and_b32 s31, s31, 0xffff
    v_mfma_f32_16x16x32_bf16 v[212:215], v[84:87], v[128:131], v[212:215]
    ds_read_b64_tr_b16 v[76:77], v53 offset:8192
    s_cmp_lt_u32 s35, 3
    s_cselect_b32 s6, 16777216, 0
    s_cselect_b32 s10, 8388608, 0
    v_mfma_f32_16x16x32_bf16 v[244:247], v[84:87], v[132:135], v[244:247]
    ds_read_b64_tr_b16 v[78:79], v53 offset:12288
    s_cmp_lt_u32 s35, 3
    s_cselect_b32 s34, s33, 0x20000
    s_waitcnt lgkmcnt(8)
    v_mfma_f32_16x16x32_bf16 v[216:219], v[88:91], v[128:131], v[216:219]
    ds_read_b64_tr_b16 v[80:81], v54 offset:8192
    v_mfma_f32_16x16x32_bf16 v[248:251], v[88:91], v[132:135], v[248:251]
    ds_read_b64_tr_b16 v[82:83], v54 offset:12288
    v_mfma_f32_16x16x32_bf16 v[220:223], v[92:95], v[128:131], v[220:223]
    ds_read_b64_tr_b16 v[84:85], v55 offset:8192
    v_mfma_f32_16x16x32_bf16 v[252:255], v[92:95], v[132:135], v[252:255]
    ds_read_b64_tr_b16 v[86:87], v55 offset:12288
    s_waitcnt lgkmcnt(8)
    s_waitcnt vmcnt(24)
    v_mfma_f32_16x16x32_bf16 v[192:195], v[64:67], v[136:139], v[192:195]
    ds_read_b64_tr_b16 v[88:89], v56 offset:8192
    v_mfma_f32_16x16x32_bf16 v[224:227], v[64:67], v[140:143], v[224:227]
    ds_read_b64_tr_b16 v[90:91], v56 offset:12288
    buffer_load_dwordx4 v[128:131], v2, s[4:7], s31 offen offset:0 sc1
    v_mfma_f32_16x16x32_bf16 v[196:199], v[68:71], v[136:139], v[196:199]
    ds_read_b64_tr_b16 v[92:93], v57 offset:8192
    v_mfma_f32_16x16x32_bf16 v[228:231], v[68:71], v[140:143], v[228:231]
    ds_read_b64_tr_b16 v[94:95], v57 offset:12288
    s_waitcnt lgkmcnt(8)
    v_mfma_f32_16x16x32_bf16 v[200:203], v[72:75], v[136:139], v[200:203]
    v_mfma_f32_16x16x32_bf16 v[232:235], v[72:75], v[140:143], v[232:235]
    buffer_load_dwordx4 v[132:135], v3, s[4:7], s31 offen offset:0 sc1
    v_mfma_f32_16x16x32_bf16 v[204:207], v[76:79], v[136:139], v[204:207]
    v_mfma_f32_16x16x32_bf16 v[236:239], v[76:79], v[140:143], v[236:239]
    s_waitcnt lgkmcnt(0)
    s_waitcnt vmcnt(20)
    s_barrier
    v_mfma_f32_16x16x32_bf16 v[208:211], v[80:83], v[136:139], v[208:211]
    ds_read_b64_tr_b16 v[64:65], v50 offset:16384
    ds_read_b64_tr_b16 v[66:67], v50 offset:20480
    v_mfma_f32_16x16x32_bf16 v[240:243], v[80:83], v[140:143], v[240:243]
    ds_read_b64_tr_b16 v[68:69], v51 offset:16384
    ds_read_b64_tr_b16 v[70:71], v51 offset:20480
    s_add_u32 m0, s34, 65536
    v_mfma_f32_16x16x32_bf16 v[212:215], v[84:87], v[136:139], v[212:215]
    ds_read_b64_tr_b16 v[72:73], v52 offset:16384
    ds_read_b64_tr_b16 v[74:75], v52 offset:20480
    buffer_load_dwordx4 v6, s[8:11], s32 offen offset:0 lds
    v_mfma_f32_16x16x32_bf16 v[244:247], v[84:87], v[140:143], v[244:247]
    ds_read_b64_tr_b16 v[76:77], v53 offset:16384
    ds_read_b64_tr_b16 v[78:79], v53 offset:20480
    v_mfma_f32_16x16x32_bf16 v[216:219], v[88:91], v[136:139], v[216:219]
    ds_read_b64_tr_b16 v[80:81], v54 offset:16384
    ds_read_b64_tr_b16 v[82:83], v54 offset:20480
    buffer_load_dwordx4 v7, s[8:11], s32 offen offset:1024 lds
    v_mfma_f32_16x16x32_bf16 v[248:251], v[88:91], v[140:143], v[248:251]
    v_mfma_f32_16x16x32_bf16 v[220:223], v[92:95], v[136:139], v[220:223]
    ds_read_b64_tr_b16 v[84:85], v55 offset:16384
    ds_read_b64_tr_b16 v[86:87], v55 offset:20480
    buffer_load_dwordx4 v8, s[8:11], s32 offen offset:2048 lds
    v_mfma_f32_16x16x32_bf16 v[252:255], v[92:95], v[140:143], v[252:255]
    buffer_load_dwordx4 v9, s[8:11], s32 offen offset:3072 lds
    s_add_u32 s32, s32, 131072
    s_waitcnt lgkmcnt(8)
    v_mfma_f32_16x16x32_bf16 v[192:195], v[64:67], v[144:147], v[192:195]
    ds_read_b64_tr_b16 v[88:89], v56 offset:16384
    v_mfma_f32_16x16x32_bf16 v[224:227], v[64:67], v[148:151], v[224:227]
    ds_read_b64_tr_b16 v[90:91], v56 offset:20480
    v_mfma_f32_16x16x32_bf16 v[196:199], v[68:71], v[144:147], v[196:199]
    ds_read_b64_tr_b16 v[92:93], v57 offset:16384
    v_mfma_f32_16x16x32_bf16 v[228:231], v[68:71], v[148:151], v[228:231]
    ds_read_b64_tr_b16 v[94:95], v57 offset:20480
    buffer_load_dwordx4 v[136:139], v2, s[4:7], s31 offen offset:1024 sc1
    s_waitcnt lgkmcnt(8)
    v_mfma_f32_16x16x32_bf16 v[200:203], v[72:75], v[144:147], v[200:203]
    ds_read_b64_tr_b16 v[64:65], v50 offset:24576
    v_mfma_f32_16x16x32_bf16 v[232:235], v[72:75], v[148:151], v[232:235]
    ds_read_b64_tr_b16 v[66:67], v50 offset:28672
    v_xor_b32 v50, 65536, v50
    v_mfma_f32_16x16x32_bf16 v[204:207], v[76:79], v[144:147], v[204:207]
    ds_read_b64_tr_b16 v[68:69], v51 offset:24576
    v_mfma_f32_16x16x32_bf16 v[236:239], v[76:79], v[148:151], v[236:239]
    ds_read_b64_tr_b16 v[70:71], v51 offset:28672
    v_xor_b32 v51, 65536, v51
    s_waitcnt lgkmcnt(8)
    v_mfma_f32_16x16x32_bf16 v[208:211], v[80:83], v[144:147], v[208:211]
    ds_read_b64_tr_b16 v[72:73], v52 offset:24576
    v_mfma_f32_16x16x32_bf16 v[240:243], v[80:83], v[148:151], v[240:243]
    ds_read_b64_tr_b16 v[74:75], v52 offset:28672
    v_xor_b32 v52, 65536, v52
    buffer_load_dwordx4 v[140:143], v3, s[4:7], s31 offen offset:1024 sc1
    v_mfma_f32_16x16x32_bf16 v[212:215], v[84:87], v[144:147], v[212:215]
    ds_read_b64_tr_b16 v[76:77], v53 offset:24576
    v_mfma_f32_16x16x32_bf16 v[244:247], v[84:87], v[148:151], v[244:247]
    ds_read_b64_tr_b16 v[78:79], v53 offset:28672
    v_xor_b32 v53, 65536, v53
    s_waitcnt lgkmcnt(8)
    v_mfma_f32_16x16x32_bf16 v[216:219], v[88:91], v[144:147], v[216:219]
    ds_read_b64_tr_b16 v[80:81], v54 offset:24576
    v_mfma_f32_16x16x32_bf16 v[248:251], v[88:91], v[148:151], v[248:251]
    ds_read_b64_tr_b16 v[82:83], v54 offset:28672
    v_xor_b32 v54, 65536, v54
    v_mfma_f32_16x16x32_bf16 v[220:223], v[92:95], v[144:147], v[220:223]
    ds_read_b64_tr_b16 v[84:85], v55 offset:24576
    v_mfma_f32_16x16x32_bf16 v[252:255], v[92:95], v[148:151], v[252:255]
    ds_read_b64_tr_b16 v[86:87], v55 offset:28672
    v_xor_b32 v55, 65536, v55
    s_waitcnt lgkmcnt(8)
    s_waitcnt vmcnt(24)
    v_mfma_f32_16x16x32_bf16 v[192:195], v[64:67], v[152:155], v[192:195]
    ds_read_b64_tr_b16 v[88:89], v56 offset:24576
    v_mfma_f32_16x16x32_bf16 v[224:227], v[64:67], v[156:159], v[224:227]
    ds_read_b64_tr_b16 v[90:91], v56 offset:28672
    v_xor_b32 v56, 65536, v56
    buffer_load_dwordx4 v[144:147], v2, s[4:7], s31 offen offset:2048 sc1
    v_mfma_f32_16x16x32_bf16 v[196:199], v[68:71], v[152:155], v[196:199]
    ds_read_b64_tr_b16 v[92:93], v57 offset:24576
    v_mfma_f32_16x16x32_bf16 v[228:231], v[68:71], v[156:159], v[228:231]
    ds_read_b64_tr_b16 v[94:95], v57 offset:28672
    v_xor_b32 v57, 65536, v57
    s_waitcnt lgkmcnt(8)
    v_mfma_f32_16x16x32_bf16 v[200:203], v[72:75], v[152:155], v[200:203]
    v_mfma_f32_16x16x32_bf16 v[232:235], v[72:75], v[156:159], v[232:235]
    buffer_load_dwordx4 v[148:151], v3, s[4:7], s31 offen offset:2048 sc1
    v_mfma_f32_16x16x32_bf16 v[204:207], v[76:79], v[152:155], v[204:207]
    v_mfma_f32_16x16x32_bf16 v[236:239], v[76:79], v[156:159], v[236:239]
    s_waitcnt lgkmcnt(0)
    s_waitcnt vmcnt(20)
    s_barrier
    v_mfma_f32_16x16x32_bf16 v[208:211], v[80:83], v[152:155], v[208:211]
    ds_read_b64_tr_b16 v[64:65], v50 offset:0
    ds_read_b64_tr_b16 v[66:67], v50 offset:4096
    v_mfma_f32_16x16x32_bf16 v[240:243], v[80:83], v[156:159], v[240:243]
    ds_read_b64_tr_b16 v[68:69], v51 offset:0
    ds_read_b64_tr_b16 v[70:71], v51 offset:4096
    s_add_u32 m0, s34, 81920
    v_mfma_f32_16x16x32_bf16 v[212:215], v[84:87], v[152:155], v[212:215]
    ds_read_b64_tr_b16 v[72:73], v52 offset:0
    ds_read_b64_tr_b16 v[74:75], v52 offset:4096
    buffer_load_dwordx4 v6, s[8:11], s32 offen offset:0 lds
    v_mfma_f32_16x16x32_bf16 v[244:247], v[84:87], v[156:159], v[244:247]
    ds_read_b64_tr_b16 v[76:77], v53 offset:0
    ds_read_b64_tr_b16 v[78:79], v53 offset:4096
    v_mfma_f32_16x16x32_bf16 v[216:219], v[88:91], v[152:155], v[216:219]
    ds_read_b64_tr_b16 v[80:81], v54 offset:0
    ds_read_b64_tr_b16 v[82:83], v54 offset:4096
    buffer_load_dwordx4 v7, s[8:11], s32 offen offset:1024 lds
    v_mfma_f32_16x16x32_bf16 v[248:251], v[88:91], v[156:159], v[248:251]
    v_mfma_f32_16x16x32_bf16 v[220:223], v[92:95], v[152:155], v[220:223]
    ds_read_b64_tr_b16 v[84:85], v55 offset:0
    ds_read_b64_tr_b16 v[86:87], v55 offset:4096
    buffer_load_dwordx4 v8, s[8:11], s32 offen offset:2048 lds
    v_mfma_f32_16x16x32_bf16 v[252:255], v[92:95], v[156:159], v[252:255]
    buffer_load_dwordx4 v9, s[8:11], s32 offen offset:3072 lds
    s_add_u32 s32, s32, 393216
    s_and_b32 s32, s32, 0x3fffff
    s_cmp_eq_u32 s35, 2
    s_cbranch_scc1 L_recurrent_scan__compressed_kv_cla__moe_arch_mod__prompt_kernel_rare_154
L_recurrent_scan__compressed_kv_cla__moe_arch_mod__prompt_kernel_back_155:
    s_waitcnt lgkmcnt(8)
    s_waitcnt vmcnt(20)
    v_mfma_f32_16x16x32_bf16 v[192:195], v[64:67], v[160:163], v[192:195]
    ds_read_b64_tr_b16 v[88:89], v56 offset:0
    v_mfma_f32_16x16x32_bf16 v[224:227], v[64:67], v[164:167], v[224:227]
    ds_read_b64_tr_b16 v[90:91], v56 offset:4096
    v_mfma_f32_16x16x32_bf16 v[196:199], v[68:71], v[160:163], v[196:199]
    ds_read_b64_tr_b16 v[92:93], v57 offset:0
    v_mfma_f32_16x16x32_bf16 v[228:231], v[68:71], v[164:167], v[228:231]
    ds_read_b64_tr_b16 v[94:95], v57 offset:4096
    buffer_load_dwordx4 v[152:155], v2, s[4:7], s31 offen offset:3072 sc1
    s_waitcnt lgkmcnt(8)
    v_mfma_f32_16x16x32_bf16 v[200:203], v[72:75], v[160:163], v[200:203]
    ds_read_b64_tr_b16 v[64:65], v50 offset:8192
    v_mfma_f32_16x16x32_bf16 v[232:235], v[72:75], v[164:167], v[232:235]
    ds_read_b64_tr_b16 v[66:67], v50 offset:12288
    v_mfma_f32_16x16x32_bf16 v[204:207], v[76:79], v[160:163], v[204:207]
    ds_read_b64_tr_b16 v[68:69], v51 offset:8192
    v_mfma_f32_16x16x32_bf16 v[236:239], v[76:79], v[164:167], v[236:239]
    ds_read_b64_tr_b16 v[70:71], v51 offset:12288
    s_waitcnt lgkmcnt(8)
    v_mfma_f32_16x16x32_bf16 v[208:211], v[80:83], v[160:163], v[208:211]
    ds_read_b64_tr_b16 v[72:73], v52 offset:8192
    v_mfma_f32_16x16x32_bf16 v[240:243], v[80:83], v[164:167], v[240:243]
    ds_read_b64_tr_b16 v[74:75], v52 offset:12288
    buffer_load_dwordx4 v[156:159], v3, s[4:7], s31 offen offset:3072 sc1
    s_add_u32 s31, s31, 8192
    s_and_b32 s31, s31, 0xffff
    v_mfma_f32_16x16x32_bf16 v[212:215], v[84:87], v[160:163], v[212:215]
    ds_read_b64_tr_b16 v[76:77], v53 offset:8192
    v_mfma_f32_16x16x32_bf16 v[244:247], v[84:87], v[164:167], v[244:247]
    ds_read_b64_tr_b16 v[78:79], v53 offset:12288
    s_cmp_lt_u32 s35, 3
    s_cselect_b32 s34, s33, 0x30000
    s_waitcnt lgkmcnt(8)
    v_mfma_f32_16x16x32_bf16 v[216:219], v[88:91], v[160:163], v[216:219]
    ds_read_b64_tr_b16 v[80:81], v54 offset:8192
    v_mfma_f32_16x16x32_bf16 v[248:251], v[88:91], v[164:167], v[248:251]
    ds_read_b64_tr_b16 v[82:83], v54 offset:12288
    v_mfma_f32_16x16x32_bf16 v[220:223], v[92:95], v[160:163], v[220:223]
    ds_read_b64_tr_b16 v[84:85], v55 offset:8192
    v_mfma_f32_16x16x32_bf16 v[252:255], v[92:95], v[164:167], v[252:255]
    ds_read_b64_tr_b16 v[86:87], v55 offset:12288
    s_waitcnt lgkmcnt(8)
    s_waitcnt vmcnt(20)
    v_mfma_f32_16x16x32_bf16 v[192:195], v[64:67], v[168:171], v[192:195]
    ds_read_b64_tr_b16 v[88:89], v56 offset:8192
    v_mfma_f32_16x16x32_bf16 v[224:227], v[64:67], v[172:175], v[224:227]
    ds_read_b64_tr_b16 v[90:91], v56 offset:12288
    buffer_load_dwordx4 v[160:163], v2, s[4:7], s31 offen offset:0 sc1
    v_mfma_f32_16x16x32_bf16 v[196:199], v[68:71], v[168:171], v[196:199]
    ds_read_b64_tr_b16 v[92:93], v57 offset:8192
    v_mfma_f32_16x16x32_bf16 v[228:231], v[68:71], v[172:175], v[228:231]
    ds_read_b64_tr_b16 v[94:95], v57 offset:12288
    s_waitcnt lgkmcnt(8)
    v_mfma_f32_16x16x32_bf16 v[200:203], v[72:75], v[168:171], v[200:203]
    v_mfma_f32_16x16x32_bf16 v[232:235], v[72:75], v[172:175], v[232:235]
    buffer_load_dwordx4 v[164:167], v3, s[4:7], s31 offen offset:0 sc1
    v_mfma_f32_16x16x32_bf16 v[204:207], v[76:79], v[168:171], v[204:207]
    v_mfma_f32_16x16x32_bf16 v[236:239], v[76:79], v[172:175], v[236:239]
    s_cmp_lt_u32 s60, 15
    s_cbranch_scc1 L_recurrent_scan__compressed_kv_cla__moe_arch_mod__prompt_kernel_rare_156
L_recurrent_scan__compressed_kv_cla__moe_arch_mod__prompt_kernel_back_157:
    s_waitcnt lgkmcnt(0)
    s_waitcnt vmcnt(20)
    s_barrier
    v_mfma_f32_16x16x32_bf16 v[208:211], v[80:83], v[168:171], v[208:211]
    ds_read_b64_tr_b16 v[64:65], v50 offset:16384
    ds_read_b64_tr_b16 v[66:67], v50 offset:20480
    v_mfma_f32_16x16x32_bf16 v[240:243], v[80:83], v[172:175], v[240:243]
    ds_read_b64_tr_b16 v[68:69], v51 offset:16384
    ds_read_b64_tr_b16 v[70:71], v51 offset:20480
    s_add_u32 m0, s34, 0
    v_mfma_f32_16x16x32_bf16 v[212:215], v[84:87], v[168:171], v[212:215]
    ds_read_b64_tr_b16 v[72:73], v52 offset:16384
    ds_read_b64_tr_b16 v[74:75], v52 offset:20480
    buffer_load_dwordx4 v6, s[8:11], s32 offen offset:0 lds
    v_mfma_f32_16x16x32_bf16 v[244:247], v[84:87], v[172:175], v[244:247]
    ds_read_b64_tr_b16 v[76:77], v53 offset:16384
    ds_read_b64_tr_b16 v[78:79], v53 offset:20480
    v_mfma_f32_16x16x32_bf16 v[216:219], v[88:91], v[168:171], v[216:219]
    ds_read_b64_tr_b16 v[80:81], v54 offset:16384
    ds_read_b64_tr_b16 v[82:83], v54 offset:20480
    buffer_load_dwordx4 v7, s[8:11], s32 offen offset:1024 lds
    v_mfma_f32_16x16x32_bf16 v[248:251], v[88:91], v[172:175], v[248:251]
    v_mfma_f32_16x16x32_bf16 v[220:223], v[92:95], v[168:171], v[220:223]
    ds_read_b64_tr_b16 v[84:85], v55 offset:16384
    ds_read_b64_tr_b16 v[86:87], v55 offset:20480
    buffer_load_dwordx4 v8, s[8:11], s32 offen offset:2048 lds
    v_mfma_f32_16x16x32_bf16 v[252:255], v[92:95], v[172:175], v[252:255]
    buffer_load_dwordx4 v9, s[8:11], s32 offen offset:3072 lds
    s_add_u32 s32, s32, 131072
    s_waitcnt lgkmcnt(8)
    s_waitcnt vmcnt(24)
    v_mfma_f32_16x16x32_bf16 v[192:195], v[64:67], v[176:179], v[192:195]
    ds_read_b64_tr_b16 v[88:89], v56 offset:16384
    v_mfma_f32_16x16x32_bf16 v[224:227], v[64:67], v[180:183], v[224:227]
    ds_read_b64_tr_b16 v[90:91], v56 offset:20480
    v_mfma_f32_16x16x32_bf16 v[196:199], v[68:71], v[176:179], v[196:199]
    ds_read_b64_tr_b16 v[92:93], v57 offset:16384
    v_mfma_f32_16x16x32_bf16 v[228:231], v[68:71], v[180:183], v[228:231]
    ds_read_b64_tr_b16 v[94:95], v57 offset:20480
    buffer_load_dwordx4 v[168:171], v2, s[4:7], s31 offen offset:1024 sc1
    s_waitcnt lgkmcnt(8)
    v_mfma_f32_16x16x32_bf16 v[200:203], v[72:75], v[176:179], v[200:203]
    ds_read_b64_tr_b16 v[64:65], v50 offset:24576
    v_mfma_f32_16x16x32_bf16 v[232:235], v[72:75], v[180:183], v[232:235]
    ds_read_b64_tr_b16 v[66:67], v50 offset:28672
    v_xor_b32 v50, 65536, v50
    v_mfma_f32_16x16x32_bf16 v[204:207], v[76:79], v[176:179], v[204:207]
    ds_read_b64_tr_b16 v[68:69], v51 offset:24576
    v_mfma_f32_16x16x32_bf16 v[236:239], v[76:79], v[180:183], v[236:239]
    ds_read_b64_tr_b16 v[70:71], v51 offset:28672
    v_xor_b32 v51, 65536, v51
    s_waitcnt lgkmcnt(8)
    v_mfma_f32_16x16x32_bf16 v[208:211], v[80:83], v[176:179], v[208:211]
    ds_read_b64_tr_b16 v[72:73], v52 offset:24576
    v_mfma_f32_16x16x32_bf16 v[240:243], v[80:83], v[180:183], v[240:243]
    ds_read_b64_tr_b16 v[74:75], v52 offset:28672
    v_xor_b32 v52, 65536, v52
    buffer_load_dwordx4 v[172:175], v3, s[4:7], s31 offen offset:1024 sc1
    v_mfma_f32_16x16x32_bf16 v[212:215], v[84:87], v[176:179], v[212:215]
    ds_read_b64_tr_b16 v[76:77], v53 offset:24576
    v_mfma_f32_16x16x32_bf16 v[244:247], v[84:87], v[180:183], v[244:247]
    ds_read_b64_tr_b16 v[78:79], v53 offset:28672
    v_xor_b32 v53, 65536, v53
    s_waitcnt lgkmcnt(8)
    v_mfma_f32_16x16x32_bf16 v[216:219], v[88:91], v[176:179], v[216:219]
    ds_read_b64_tr_b16 v[80:81], v54 offset:24576
    v_mfma_f32_16x16x32_bf16 v[248:251], v[88:91], v[180:183], v[248:251]
    ds_read_b64_tr_b16 v[82:83], v54 offset:28672
    v_xor_b32 v54, 65536, v54
    v_mfma_f32_16x16x32_bf16 v[220:223], v[92:95], v[176:179], v[220:223]
    ds_read_b64_tr_b16 v[84:85], v55 offset:24576
    v_mfma_f32_16x16x32_bf16 v[252:255], v[92:95], v[180:183], v[252:255]
    ds_read_b64_tr_b16 v[86:87], v55 offset:28672
    v_xor_b32 v55, 65536, v55
    s_waitcnt lgkmcnt(8)
    s_waitcnt vmcnt(24)
    v_mfma_f32_16x16x32_bf16 v[192:195], v[64:67], v[184:187], v[192:195]
    ds_read_b64_tr_b16 v[88:89], v56 offset:24576
    v_mfma_f32_16x16x32_bf16 v[224:227], v[64:67], v[188:191], v[224:227]
    ds_read_b64_tr_b16 v[90:91], v56 offset:28672
    v_xor_b32 v56, 65536, v56
    buffer_load_dwordx4 v[176:179], v2, s[4:7], s31 offen offset:2048 sc1
    v_mfma_f32_16x16x32_bf16 v[196:199], v[68:71], v[184:187], v[196:199]
    ds_read_b64_tr_b16 v[92:93], v57 offset:24576
    v_mfma_f32_16x16x32_bf16 v[228:231], v[68:71], v[188:191], v[228:231]
    ds_read_b64_tr_b16 v[94:95], v57 offset:28672
    v_xor_b32 v57, 65536, v57
    s_waitcnt lgkmcnt(8)
    v_mfma_f32_16x16x32_bf16 v[200:203], v[72:75], v[184:187], v[200:203]
    v_mfma_f32_16x16x32_bf16 v[232:235], v[72:75], v[188:191], v[232:235]
    buffer_load_dwordx4 v[180:183], v3, s[4:7], s31 offen offset:2048 sc1
    v_mfma_f32_16x16x32_bf16 v[204:207], v[76:79], v[184:187], v[204:207]
    v_mfma_f32_16x16x32_bf16 v[236:239], v[76:79], v[188:191], v[236:239]
    s_cmp_lt_u32 s60, 15
    s_cbranch_scc1 L_recurrent_scan__compressed_kv_cla__moe_arch_mod__prompt_kernel_rare_166
L_recurrent_scan__compressed_kv_cla__moe_arch_mod__prompt_kernel_back_167:
    s_waitcnt lgkmcnt(0)
    s_waitcnt vmcnt(20)
    s_barrier
    v_mfma_f32_16x16x32_bf16 v[208:211], v[80:83], v[184:187], v[208:211]
    ds_read_b64_tr_b16 v[64:65], v50 offset:0
    ds_read_b64_tr_b16 v[66:67], v50 offset:4096
    v_mfma_f32_16x16x32_bf16 v[240:243], v[80:83], v[188:191], v[240:243]
    ds_read_b64_tr_b16 v[68:69], v51 offset:0
    ds_read_b64_tr_b16 v[70:71], v51 offset:4096
    s_add_u32 m0, s34, 16384
    v_mfma_f32_16x16x32_bf16 v[212:215], v[84:87], v[184:187], v[212:215]
    ds_read_b64_tr_b16 v[72:73], v52 offset:0
    ds_read_b64_tr_b16 v[74:75], v52 offset:4096
    buffer_load_dwordx4 v6, s[8:11], s32 offen offset:0 lds
    v_mfma_f32_16x16x32_bf16 v[244:247], v[84:87], v[188:191], v[244:247]
    ds_read_b64_tr_b16 v[76:77], v53 offset:0
    ds_read_b64_tr_b16 v[78:79], v53 offset:4096
    v_mfma_f32_16x16x32_bf16 v[216:219], v[88:91], v[184:187], v[216:219]
    ds_read_b64_tr_b16 v[80:81], v54 offset:0
    ds_read_b64_tr_b16 v[82:83], v54 offset:4096
    buffer_load_dwordx4 v7, s[8:11], s32 offen offset:1024 lds
    v_mfma_f32_16x16x32_bf16 v[248:251], v[88:91], v[188:191], v[248:251]
    v_mfma_f32_16x16x32_bf16 v[220:223], v[92:95], v[184:187], v[220:223]
    ds_read_b64_tr_b16 v[84:85], v55 offset:0
    ds_read_b64_tr_b16 v[86:87], v55 offset:4096
    buffer_load_dwordx4 v8, s[8:11], s32 offen offset:2048 lds
    v_mfma_f32_16x16x32_bf16 v[252:255], v[92:95], v[188:191], v[252:255]
    buffer_load_dwordx4 v9, s[8:11], s32 offen offset:3072 lds
    s_add_u32 s32, s32, 393216
    s_and_b32 s32, s32, 0x3fffff
    s_add_u32 s35, s35, 1
    s_cmp_lt_u32 s35, 4
    s_cbranch_scc1 L_p4_loop
    s_waitcnt vmcnt(0) lgkmcnt(0)
    s_nop 3
    s_cmp_lt_u32 s28, 4
    s_cbranch_scc0 L_p4_e1
    ds_read_b64 v[40:41], v17 offset:0
    ds_read_b64 v[42:43], v17 offset:32
    ds_read_b64 v[44:45], v17 offset:64
    ds_read_b64 v[46:47], v17 offset:96
    ds_write_b128 v20, v[224:227] offset:0
    ds_write_b128 v20, v[228:231] offset:1024
    ds_write_b128 v20, v[232:235] offset:2048
    ds_write_b128 v20, v[236:239] offset:3072
    ds_write_b128 v20, v[240:243] offset:4096
    ds_write_b128 v20, v[244:247] offset:5120
    ds_write_b128 v20, v[248:251] offset:6144
    ds_write_b128 v20, v[252:255] offset:7168
    s_waitcnt lgkmcnt(0)
    s_barrier
    ds_read_b128 v[128:131], v21 offset:0
    ds_read_b128 v[132:135], v21 offset:1024
    ds_read_b128 v[136:139], v21 offset:2048
    ds_read_b128 v[140:143], v21 offset:3072
    ds_read_b128 v[144:147], v21 offset:4096
    ds_read_b128 v[148:151], v21 offset:5120
    ds_read_b128 v[152:155], v21 offset:6144
    ds_read_b128 v[156:159], v21 offset:7168
    s_waitcnt lgkmcnt(7)
    v_pk_add_f32 v[128:129], v[128:129], v[192:193]
    v_pk_add_f32 v[130:131], v[130:131], v[194:195]
    s_waitcnt lgkmcnt(6)
    v_pk_add_f32 v[132:133], v[132:133], v[196:197]
    v_pk_add_f32 v[134:135], v[134:135], v[198:199]
    s_waitcnt lgkmcnt(5)
    v_pk_add_f32 v[136:137], v[136:137], v[200:201]
    v_pk_add_f32 v[138:139], v[138:139], v[202:203]
    s_waitcnt lgkmcnt(4)
    v_pk_add_f32 v[140:141], v[140:141], v[204:205]
    v_pk_add_f32 v[142:143], v[142:143], v[206:207]
    s_waitcnt lgkmcnt(3)
    v_pk_add_f32 v[144:145], v[144:145], v[208:209]
    v_pk_add_f32 v[146:147], v[146:147], v[210:211]
    s_waitcnt lgkmcnt(2)
    v_pk_add_f32 v[148:149], v[148:149], v[212:213]
    v_pk_add_f32 v[150:151], v[150:151], v[214:215]
    s_waitcnt lgkmcnt(1)
    v_pk_add_f32 v[152:153], v[152:153], v[216:217]
    v_pk_add_f32 v[154:155], v[154:155], v[218:219]
    s_waitcnt lgkmcnt(0)
    v_pk_add_f32 v[156:157], v[156:157], v[220:221]
    v_pk_add_f32 v[158:159], v[158:159], v[222:223]
    s_branch L_p4_done
L_p4_e1:
    ds_read_b64 v[40:41], v17 offset:0
    ds_read_b64 v[42:43], v17 offset:32
    ds_read_b64 v[44:45], v17 offset:64
    ds_read_b64 v[46:47], v17 offset:96
    ds_write_b128 v20, v[192:195] offset:0
    ds_write_b128 v20, v[196:199] offset:1024
    ds_write_b128 v20, v[200:203] offset:2048
    ds_write_b128 v20, v[204:207] offset:3072
    ds_write_b128 v20, v[208:211] offset:4096
    ds_write_b128 v20, v[212:215] offset:5120
    ds_write_b128 v20, v[216:219] offset:6144
    ds_write_b128 v20, v[220:223] offset:7168
    s_waitcnt lgkmcnt(0)
    s_barrier
    ds_read_b128 v[128:131], v21 offset:0
    ds_read_b128 v[132:135], v21 offset:1024
    ds_read_b128 v[136:139], v21 offset:2048
    ds_read_b128 v[140:143], v21 offset:3072
    ds_read_b128 v[144:147], v21 offset:4096
    ds_read_b128 v[148:151], v21 offset:5120
    ds_read_b128 v[152:155], v21 offset:6144
    ds_read_b128 v[156:159], v21 offset:7168
    s_waitcnt lgkmcnt(7)
    v_pk_add_f32 v[128:129], v[128:129], v[224:225]
    v_pk_add_f32 v[130:131], v[130:131], v[226:227]
    s_waitcnt lgkmcnt(6)
    v_pk_add_f32 v[132:133], v[132:133], v[228:229]
    v_pk_add_f32 v[134:135], v[134:135], v[230:231]
    s_waitcnt lgkmcnt(5)
    v_pk_add_f32 v[136:137], v[136:137], v[232:233]
    v_pk_add_f32 v[138:139], v[138:139], v[234:235]
    s_waitcnt lgkmcnt(4)
    v_pk_add_f32 v[140:141], v[140:141], v[236:237]
    v_pk_add_f32 v[142:143], v[142:143], v[238:239]
    s_waitcnt lgkmcnt(3)
    v_pk_add_f32 v[144:145], v[144:145], v[240:241]
    v_pk_add_f32 v[146:147], v[146:147], v[242:243]
    s_waitcnt lgkmcnt(2)
    v_pk_add_f32 v[148:149], v[148:149], v[244:245]
    v_pk_add_f32 v[150:151], v[150:151], v[246:247]
    s_waitcnt lgkmcnt(1)
    v_pk_add_f32 v[152:153], v[152:153], v[248:249]
    v_pk_add_f32 v[154:155], v[154:155], v[250:251]
    s_waitcnt lgkmcnt(0)
    v_pk_add_f32 v[156:157], v[156:157], v[252:253]
    v_pk_add_f32 v[158:159], v[158:159], v[254:255]
L_p4_done:
    s_cmp_eq_u32 s63, 0
    s_cbranch_scc1 L_recurrent_scan__compressed_kv_cla__moe_arch_mod__prompt_kernel_p1_175
    v_swap_b32 v128, v144
    v_swap_b32 v129, v145
    v_swap_b32 v130, v146
    v_swap_b32 v131, v147
    v_swap_b32 v132, v148
    v_swap_b32 v133, v149
    v_swap_b32 v134, v150
    v_swap_b32 v135, v151
    v_swap_b32 v136, v152
    v_swap_b32 v137, v153
    v_swap_b32 v138, v154
    v_swap_b32 v139, v155
    v_swap_b32 v140, v156
    v_swap_b32 v141, v157
    v_swap_b32 v142, v158
    v_swap_b32 v143, v159
L_recurrent_scan__compressed_kv_cla__moe_arch_mod__prompt_kernel_p1_175:
    s_lshl_b32 s36, s2, 15
    s_lshl_b32 s37, s28, 12
    s_add_u32 s36, s36, s37
    s_add_u32 s36, s36, 67108864
    s_xor_b32 s39, s36, 1048576
    v_lshlrev_b32 v22, 4, v1
    buffer_store_dwordx4 v[144:147], v22, s[24:27], s36 offen offset:0 sc1
    buffer_store_dwordx4 v[148:151], v22, s[24:27], s36 offen offset:1024 sc1
    buffer_store_dwordx4 v[152:155], v22, s[24:27], s36 offen offset:2048 sc1
    buffer_store_dwordx4 v[156:159], v22, s[24:27], s36 offen offset:3072 sc1
    s_add_u32 s40, s2, 128
    s_lshl_b32 s40, s40, 7
    s_xor_b32 s37, s40, 4096
    v_mov_b32 v5, s37
    s_sub_u32 s36, s56, s38
    s_sub_u32 s37, s57, s38
    s_min_u32 s36, s36, s37
    s_cmp_lt_u32 s36, 16
    s_cbranch_scc1 L_recurrent_scan__compressed_kv_cla__moe_arch_mod__prompt_kernel_gy_176
    v_lshlrev_b32 v96, 16, v40
    v_and_b32 v97, 0xffff0000, v40
    v_sub_f32 v112, v96, v48
    v_sub_f32 v113, v97, v48
    v_cvt_pk_bf16_f32 v10, v112, v113
    v_lshlrev_b32 v112, 16, v10
    v_and_b32 v113, 0xffff0000, v10
    v_mul_f32 v112, v112, v49
    v_mul_f32 v113, v113, v49
    v_cvt_pk_bf16_f32 v10, v112, v113
    v_lshlrev_b32 v112, 16, v10
    v_and_b32 v113, 0xffff0000, v10
    v_mul_f32 v11, 0xbfb8aa3b, v112
    v_mul_f32 v12, 0xbfb8aa3b, v113
    v_exp_f32 v11, v11
    v_exp_f32 v12, v12
    s_nop 0
    v_add_f32 v11, 1.0, v11
    v_add_f32 v12, 1.0, v12
    v_rcp_f32 v11, v11
    v_rcp_f32 v12, v12
    s_nop 0
    v_mul_f32 v112, v112, v11
    v_mul_f32 v113, v113, v12
    v_cvt_pk_bf16_f32 v10, v112, v113
    v_lshlrev_b32 v112, 16, v10
    v_and_b32 v113, 0xffff0000, v10
    v_lshlrev_b32 v98, 16, v41
    v_and_b32 v99, 0xffff0000, v41
    v_sub_f32 v114, v98, v48
    v_sub_f32 v115, v99, v48
    v_cvt_pk_bf16_f32 v10, v114, v115
    v_lshlrev_b32 v114, 16, v10
    v_and_b32 v115, 0xffff0000, v10
    v_mul_f32 v114, v114, v49
    v_mul_f32 v115, v115, v49
    v_cvt_pk_bf16_f32 v10, v114, v115
    v_lshlrev_b32 v114, 16, v10
    v_and_b32 v115, 0xffff0000, v10
    v_mul_f32 v11, 0xbfb8aa3b, v114
    v_mul_f32 v12, 0xbfb8aa3b, v115
    v_exp_f32 v11, v11
    v_exp_f32 v12, v12
    s_nop 0
    v_add_f32 v11, 1.0, v11
    v_add_f32 v12, 1.0, v12
    v_rcp_f32 v11, v11
    v_rcp_f32 v12, v12
    s_nop 0
    v_mul_f32 v114, v114, v11
    v_mul_f32 v115, v115, v12
    v_cvt_pk_bf16_f32 v10, v114, v115
    v_lshlrev_b32 v114, 16, v10
    v_and_b32 v115, 0xffff0000, v10
    v_lshlrev_b32 v100, 16, v42
    v_and_b32 v101, 0xffff0000, v42
    v_sub_f32 v116, v100, v48
    v_sub_f32 v117, v101, v48
    v_cvt_pk_bf16_f32 v10, v116, v117
    v_lshlrev_b32 v116, 16, v10
    v_and_b32 v117, 0xffff0000, v10
    v_mul_f32 v116, v116, v49
    v_mul_f32 v117, v117, v49
    v_cvt_pk_bf16_f32 v10, v116, v117
    v_lshlrev_b32 v116, 16, v10
    v_and_b32 v117, 0xffff0000, v10
    v_mul_f32 v11, 0xbfb8aa3b, v116
    v_mul_f32 v12, 0xbfb8aa3b, v117
    v_exp_f32 v11, v11
    v_exp_f32 v12, v12
    s_nop 0
    v_add_f32 v11, 1.0, v11
    v_add_f32 v12, 1.0, v12
    v_rcp_f32 v11, v11
    v_rcp_f32 v12, v12
    s_nop 0
    v_mul_f32 v116, v116, v11
    v_mul_f32 v117, v117, v12
    v_cvt_pk_bf16_f32 v10, v116, v117
    v_lshlrev_b32 v116, 16, v10
    v_and_b32 v117, 0xffff0000, v10
    v_lshlrev_b32 v102, 16, v43
    v_and_b32 v103, 0xffff0000, v43
    v_sub_f32 v118, v102, v48
    v_sub_f32 v119, v103, v48
    v_cvt_pk_bf16_f32 v10, v118, v119
    v_lshlrev_b32 v118, 16, v10
    v_and_b32 v119, 0xffff0000, v10
    v_mul_f32 v118, v118, v49
    v_mul_f32 v119, v119, v49
    v_cvt_pk_bf16_f32 v10, v118, v119
    v_lshlrev_b32 v118, 16, v10
    v_and_b32 v119, 0xffff0000, v10
    v_mul_f32 v11, 0xbfb8aa3b, v118
    v_mul_f32 v12, 0xbfb8aa3b, v119
    v_exp_f32 v11, v11
    v_exp_f32 v12, v12
    s_nop 0
    v_add_f32 v11, 1.0, v11
    v_add_f32 v12, 1.0, v12
    v_rcp_f32 v11, v11
    v_rcp_f32 v12, v12
    s_nop 0
    v_mul_f32 v118, v118, v11
    v_mul_f32 v119, v119, v12
    v_cvt_pk_bf16_f32 v10, v118, v119
    v_lshlrev_b32 v118, 16, v10
    v_and_b32 v119, 0xffff0000, v10
    s_waitcnt vmcnt(0)
    v_mov_b32 v4, s40
    v_mov_b32 v13, 1
    s_mov_b64 exec, 1
    global_atomic_add v4, v13, s[90:91]
    s_mov_b64 exec, -1
    v_lshlrev_b32 v104, 16, v44
    v_and_b32 v105, 0xffff0000, v44
    v_sub_f32 v120, v104, v48
    v_sub_f32 v121, v105, v48
    v_cvt_pk_bf16_f32 v10, v120, v121
    v_lshlrev_b32 v120, 16, v10
    v_and_b32 v121, 0xffff0000, v10
    v_mul_f32 v120, v120, v49
    v_mul_f32 v121, v121, v49
    v_cvt_pk_bf16_f32 v10, v120, v121
    v_lshlrev_b32 v120, 16, v10
    v_and_b32 v121, 0xffff0000, v10
    v_mul_f32 v11, 0xbfb8aa3b, v120
    v_mul_f32 v12, 0xbfb8aa3b, v121
    v_exp_f32 v11, v11
    v_exp_f32 v12, v12
    s_nop 0
    v_add_f32 v11, 1.0, v11
    v_add_f32 v12, 1.0, v12
    v_rcp_f32 v11, v11
    v_rcp_f32 v12, v12
    s_nop 0
    v_mul_f32 v120, v120, v11
    v_mul_f32 v121, v121, v12
    v_cvt_pk_bf16_f32 v10, v120, v121
    v_lshlrev_b32 v120, 16, v10
    v_and_b32 v121, 0xffff0000, v10
    v_lshlrev_b32 v106, 16, v45
    v_and_b32 v107, 0xffff0000, v45
    v_sub_f32 v122, v106, v48
    v_sub_f32 v123, v107, v48
    v_cvt_pk_bf16_f32 v10, v122, v123
    v_lshlrev_b32 v122, 16, v10
    v_and_b32 v123, 0xffff0000, v10
    v_mul_f32 v122, v122, v49
    v_mul_f32 v123, v123, v49
    v_cvt_pk_bf16_f32 v10, v122, v123
    v_lshlrev_b32 v122, 16, v10
    v_and_b32 v123, 0xffff0000, v10
    v_mul_f32 v11, 0xbfb8aa3b, v122
    v_mul_f32 v12, 0xbfb8aa3b, v123
    v_exp_f32 v11, v11
    v_exp_f32 v12, v12
    s_nop 0
    v_add_f32 v11, 1.0, v11
    v_add_f32 v12, 1.0, v12
    v_rcp_f32 v11, v11
    v_rcp_f32 v12, v12
    s_nop 0
    v_mul_f32 v122, v122, v11
    v_mul_f32 v123, v123, v12
    v_cvt_pk_bf16_f32 v10, v122, v123
    v_lshlrev_b32 v122, 16, v10
    v_and_b32 v123, 0xffff0000, v10
    v_lshlrev_b32 v108, 16, v46
    v_and_b32 v109, 0xffff0000, v46
    v_sub_f32 v124, v108, v48
    v_sub_f32 v125, v109, v48
    v_cvt_pk_bf16_f32 v10, v124, v125
    v_lshlrev_b32 v124, 16, v10
    v_and_b32 v125, 0xffff0000, v10
    v_mul_f32 v124, v124, v49
    v_mul_f32 v125, v125, v49
    v_cvt_pk_bf16_f32 v10, v124, v125
    v_lshlrev_b32 v124, 16, v10
    v_and_b32 v125, 0xffff0000, v10
    v_mul_f32 v11, 0xbfb8aa3b, v124
    v_mul_f32 v12, 0xbfb8aa3b, v125
    v_exp_f32 v11, v11
    v_exp_f32 v12, v12
    s_nop 0
    v_add_f32 v11, 1.0, v11
    v_add_f32 v12, 1.0, v12
    v_rcp_f32 v11, v11
    v_rcp_f32 v12, v12
    s_nop 0
    v_mul_f32 v124, v124, v11
    v_mul_f32 v125, v125, v12
    v_cvt_pk_bf16_f32 v10, v124, v125
    v_lshlrev_b32 v124, 16, v10
    v_and_b32 v125, 0xffff0000, v10
    v_lshlrev_b32 v110, 16, v47
    v_and_b32 v111, 0xffff0000, v47
    v_sub_f32 v126, v110, v48
    v_sub_f32 v127, v111, v48
    v_cvt_pk_bf16_f32 v10, v126, v127
    v_lshlrev_b32 v126, 16, v10
    v_and_b32 v127, 0xffff0000, v10
    v_mul_f32 v126, v126, v49
    v_mul_f32 v127, v127, v49
    v_cvt_pk_bf16_f32 v10, v126, v127
    v_lshlrev_b32 v126, 16, v10
    v_and_b32 v127, 0xffff0000, v10
    v_mul_f32 v11, 0xbfb8aa3b, v126
    v_mul_f32 v12, 0xbfb8aa3b, v127
    v_exp_f32 v11, v11
    v_exp_f32 v12, v12
    s_nop 0
    v_add_f32 v11, 1.0, v11
    v_add_f32 v12, 1.0, v12
    v_rcp_f32 v11, v11
    v_rcp_f32 v12, v12
    s_nop 0
    v_mul_f32 v126, v126, v11
    v_mul_f32 v127, v127, v12
    v_cvt_pk_bf16_f32 v10, v126, v127
    v_lshlrev_b32 v126, 16, v10
    v_and_b32 v127, 0xffff0000, v10
L_recurrent_scan__compressed_kv_cla__moe_arch_mod__prompt_kernel_gyb_177:
    s_cmp_eq_u32 s28, 7
    s_cbranch_scc1 L_recurrent_scan__compressed_kv_cla__moe_arch_mod__prompt_kernel_rare_180
L_recurrent_scan__compressed_kv_cla__moe_arch_mod__prompt_kernel_back_181:
    s_barrier
    buffer_load_dwordx4 v[64:67], v22, s[24:27], s39 offen offset:0 sc1
    buffer_load_dwordx4 v[68:71], v22, s[24:27], s39 offen offset:1024 sc1
    buffer_load_dwordx4 v[72:75], v22, s[24:27], s39 offen offset:2048 sc1
    buffer_load_dwordx4 v[76:79], v22, s[24:27], s39 offen offset:3072 sc1
    s_waitcnt vmcnt(3)
    v_pk_add_f32 v[128:129], v[128:129], v[64:65]
    v_cvt_pk_bf16_f32 v23, v128, v129
    v_lshlrev_b32 v128, 16, v23
    v_and_b32 v129, 0xffff0000, v23
    v_pk_mul_f32 v[128:129], v[128:129], v[112:113]
    v_cvt_pk_bf16_f32 v23, v128, v129
    v_lshlrev_b32 v128, 16, v23
    v_and_b32 v129, 0xffff0000, v23
    v_pk_add_f32 v[128:129], v[128:129], v[96:97]
    v_cvt_pk_bf16_f32 v80, v128, v129
    v_pk_add_f32 v[130:131], v[130:131], v[66:67]
    v_cvt_pk_bf16_f32 v23, v130, v131
    v_lshlrev_b32 v130, 16, v23
    v_and_b32 v131, 0xffff0000, v23
    v_pk_mul_f32 v[130:131], v[130:131], v[114:115]
    v_cvt_pk_bf16_f32 v23, v130, v131
    v_lshlrev_b32 v130, 16, v23
    v_and_b32 v131, 0xffff0000, v23
    v_pk_add_f32 v[130:131], v[130:131], v[98:99]
    v_cvt_pk_bf16_f32 v81, v130, v131
    ds_write_b64 v17, v[80:81] offset:0
    s_waitcnt vmcnt(2)
    v_pk_add_f32 v[132:133], v[132:133], v[68:69]
    v_cvt_pk_bf16_f32 v23, v132, v133
    v_lshlrev_b32 v132, 16, v23
    v_and_b32 v133, 0xffff0000, v23
    v_pk_mul_f32 v[132:133], v[132:133], v[116:117]
    v_cvt_pk_bf16_f32 v23, v132, v133
    v_lshlrev_b32 v132, 16, v23
    v_and_b32 v133, 0xffff0000, v23
    v_pk_add_f32 v[132:133], v[132:133], v[100:101]
    v_cvt_pk_bf16_f32 v82, v132, v133
    v_pk_add_f32 v[134:135], v[134:135], v[70:71]
    v_cvt_pk_bf16_f32 v23, v134, v135
    v_lshlrev_b32 v134, 16, v23
    v_and_b32 v135, 0xffff0000, v23
    v_pk_mul_f32 v[134:135], v[134:135], v[118:119]
    v_cvt_pk_bf16_f32 v23, v134, v135
    v_lshlrev_b32 v134, 16, v23
    v_and_b32 v135, 0xffff0000, v23
    v_pk_add_f32 v[134:135], v[134:135], v[102:103]
    v_cvt_pk_bf16_f32 v83, v134, v135
    ds_write_b64 v17, v[82:83] offset:32
    s_waitcnt vmcnt(1)
    v_pk_add_f32 v[136:137], v[136:137], v[72:73]
    v_cvt_pk_bf16_f32 v23, v136, v137
    v_lshlrev_b32 v136, 16, v23
    v_and_b32 v137, 0xffff0000, v23
    v_pk_mul_f32 v[136:137], v[136:137], v[120:121]
    v_cvt_pk_bf16_f32 v23, v136, v137
    v_lshlrev_b32 v136, 16, v23
    v_and_b32 v137, 0xffff0000, v23
    v_pk_add_f32 v[136:137], v[136:137], v[104:105]
    v_cvt_pk_bf16_f32 v84, v136, v137
    v_pk_add_f32 v[138:139], v[138:139], v[74:75]
    v_cvt_pk_bf16_f32 v23, v138, v139
    v_lshlrev_b32 v138, 16, v23
    v_and_b32 v139, 0xffff0000, v23
    v_pk_mul_f32 v[138:139], v[138:139], v[122:123]
    v_cvt_pk_bf16_f32 v23, v138, v139
    v_lshlrev_b32 v138, 16, v23
    v_and_b32 v139, 0xffff0000, v23
    v_pk_add_f32 v[138:139], v[138:139], v[106:107]
    v_cvt_pk_bf16_f32 v85, v138, v139
    ds_write_b64 v17, v[84:85] offset:64
    s_waitcnt vmcnt(0)
    v_pk_add_f32 v[140:141], v[140:141], v[76:77]
    v_cvt_pk_bf16_f32 v23, v140, v141
    v_lshlrev_b32 v140, 16, v23
    v_and_b32 v141, 0xffff0000, v23
    v_pk_mul_f32 v[140:141], v[140:141], v[124:125]
    v_cvt_pk_bf16_f32 v23, v140, v141
    v_lshlrev_b32 v140, 16, v23
    v_and_b32 v141, 0xffff0000, v23
    v_pk_add_f32 v[140:141], v[140:141], v[108:109]
    v_cvt_pk_bf16_f32 v86, v140, v141
    v_pk_add_f32 v[142:143], v[142:143], v[78:79]
    v_cvt_pk_bf16_f32 v23, v142, v143
    v_lshlrev_b32 v142, 16, v23
    v_and_b32 v143, 0xffff0000, v23
    v_pk_mul_f32 v[142:143], v[142:143], v[126:127]
    v_cvt_pk_bf16_f32 v23, v142, v143
    v_lshlrev_b32 v142, 16, v23
    v_and_b32 v143, 0xffff0000, v23
    v_pk_add_f32 v[142:143], v[142:143], v[110:111]
    v_cvt_pk_bf16_f32 v87, v142, v143
    ds_write_b64 v17, v[86:87] offset:96
    v_add_u32 v22, s42, v22
    s_mov_b32 s36, 16384
    s_waitcnt lgkmcnt(0)
    ds_read_b128 v[64:67], v22
    ds_read_b128 v[68:71], v22 offset:1024
    s_waitcnt lgkmcnt(1)
    buffer_store_dwordx4 v[64:67], v15, s[20:23], 0 offen sc1
    s_waitcnt lgkmcnt(0)
    buffer_store_dwordx4 v[68:71], v15, s[20:23], s36 offen sc1
    s_endpgm
L_recurrent_scan__compressed_kv_cla__moe_arch_mod__prompt_kernel_rare_139:
    v_mov_b32 v26, s40
    v_mov_b32 v28, 1
    v_writelane_b32 v26, s41, 1
    s_mov_b64 exec, 3
    global_atomic_add v26, v28, s[90:91]
    s_mov_b64 exec, -1
    s_branch L_recurrent_scan__compressed_kv_cla__moe_arch_mod__prompt_kernel_back_140
L_recurrent_scan__compressed_kv_cla__moe_arch_mod__prompt_kernel_rt1_rare_3:
    s_mov_b32 s61, 0x40000
L_recurrent_scan__compressed_kv_cla__moe_arch_mod__prompt_kernel_rt1_spin_1:
    s_sub_u32 s61, s61, 1
    s_cbranch_scc1 L_recurrent_scan__compressed_kv_cla__moe_arch_mod__prompt_kernel_rt1_spinx_2
    s_sleep 1
    global_load_dword v61, v60, s[90:91] sc1
    s_waitcnt vmcnt(0)
    v_readfirstlane_b32 s36, v61
    s_nop 0
    s_cmp_lt_u32 s36, 16
    s_cbranch_scc1 L_recurrent_scan__compressed_kv_cla__moe_arch_mod__prompt_kernel_rt1_spin_1
L_recurrent_scan__compressed_kv_cla__moe_arch_mod__prompt_kernel_rt1_spinx_2:
    s_branch L_recurrent_scan__compressed_kv_cla__moe_arch_mod__prompt_kernel_rt1_back_4
L_recurrent_scan__compressed_kv_cla__moe_arch_mod__prompt_kernel_rare_151:
    s_cmp_eq_u32 s35, 1
    s_cbranch_scc0 L_recurrent_scan__compressed_kv_cla__moe_arch_mod__prompt_kernel_swn_149
    s_cmp_eq_u32 s28, 0
    s_cbranch_scc0 L_recurrent_scan__compressed_kv_cla__moe_arch_mod__prompt_kernel_g_142
    s_and_b32 s36, s2, 15
    s_add_u32 s36, s36, 96
    s_lshl_b32 s36, s36, 7
    v_mov_b32 v26, s36
    v_mov_b32 v27, 1
    s_mov_b64 exec, 1
    global_atomic_add v26, v27, s[90:91]
    s_mov_b64 exec, -1
    s_nop 3
L_recurrent_scan__compressed_kv_cla__moe_arch_mod__prompt_kernel_g_142:
    s_branch L_recurrent_scan__compressed_kv_cla__moe_arch_mod__prompt_kernel_swend_148
L_recurrent_scan__compressed_kv_cla__moe_arch_mod__prompt_kernel_swn_149:
    s_cmp_eq_u32 s35, 2
    s_cbranch_scc0 L_recurrent_scan__compressed_kv_cla__moe_arch_mod__prompt_kernel_swn_150
    s_sub_u32 s36, s56, s38
    s_sub_u32 s37, s57, s38
    s_min_u32 s36, s36, s37
    s_cmp_lt_u32 s36, 16
    s_cbranch_scc0 L_recurrent_scan__compressed_kv_cla__moe_arch_mod__prompt_kernel_nrt_143
    s_add_u32 s36, s30, 96
    s_lshl_b32 s36, s36, 7
    v_mov_b32 v60, s36
    global_load_dword v61, v60, s[90:91] sc1
L_recurrent_scan__compressed_kv_cla__moe_arch_mod__prompt_kernel_nrt_143:
    s_branch L_recurrent_scan__compressed_kv_cla__moe_arch_mod__prompt_kernel_swend_148
L_recurrent_scan__compressed_kv_cla__moe_arch_mod__prompt_kernel_swn_150:
    s_sub_u32 s36, s56, s38
    s_sub_u32 s37, s57, s38
    s_min_u32 s36, s36, s37
    s_cmp_lt_u32 s36, 16
    s_cbranch_scc0 L_recurrent_scan__compressed_kv_cla__moe_arch_mod__prompt_kernel_nrt_144
    v_mov_b64 v[24:25], 0
    v_mov_b64 v[26:27], 0
    v_mov_b64 v[28:29], 0
    v_mov_b64 v[30:31], 0
    v_mov_b64 v[32:33], 0
    v_mov_b64 v[34:35], 0
    v_mov_b64 v[36:37], 0
    v_mov_b64 v[38:39], 0
    s_waitcnt vmcnt(16)
    s_sub_u32 s36, s56, s38
    s_cmp_lt_u32 s36, 16
    s_cbranch_scc0 L_recurrent_scan__compressed_kv_cla__moe_arch_mod__prompt_kernel_rt2_noy_1
    s_and_b32 s36, s58, 0xffff0000
    s_cmp_lt_i32 s36, 0
    s_cselect_b32 s37, 0x80000000, -1
    s_xor_b32 s36, s36, s37
    s_and_b32 s36, s36, 0xffff0000
    v_mov_b32 v62, s36
    v_mul_f32 v62, 0xbfb8aa3b, v62
    v_exp_f32 v62, v62
    s_nop 0
    v_add_f32 v62, 1.0, v62
    v_rcp_f32 v62, v62
    s_nop 0
    v_cvt_pk_bf16_f32 v62, v62, v62
    v_lshlrev_b32 v62, 16, v62
    v_add_f32_dpp v96, v96, v96 quad_perm:[1,0,3,2] row_mask:0xf bank_mask:0xf
    v_add_f32_dpp v97, v97, v97 quad_perm:[1,0,3,2] row_mask:0xf bank_mask:0xf
    v_add_f32_dpp v98, v98, v98 quad_perm:[1,0,3,2] row_mask:0xf bank_mask:0xf
    v_add_f32_dpp v99, v99, v99 quad_perm:[1,0,3,2] row_mask:0xf bank_mask:0xf
    v_add_f32_dpp v100, v100, v100 quad_perm:[1,0,3,2] row_mask:0xf bank_mask:0xf
    v_add_f32_dpp v101, v101, v101 quad_perm:[1,0,3,2] row_mask:0xf bank_mask:0xf
    v_add_f32_dpp v102, v102, v102 quad_perm:[1,0,3,2] row_mask:0xf bank_mask:0xf
    v_add_f32_dpp v103, v103, v103 quad_perm:[1,0,3,2] row_mask:0xf bank_mask:0xf
    v_add_f32_dpp v104, v104, v104 quad_perm:[1,0,3,2] row_mask:0xf bank_mask:0xf
    v_add_f32_dpp v105, v105, v105 quad_perm:[1,0,3,2] row_mask:0xf bank_mask:0xf
    v_add_f32_dpp v106, v106, v106 quad_perm:[1,0,3,2] row_mask:0xf bank_mask:0xf
    v_add_f32_dpp v107, v107, v107 quad_perm:[1,0,3,2] row_mask:0xf bank_mask:0xf
    v_add_f32_dpp v108, v108, v108 quad_perm:[1,0,3,2] row_mask:0xf bank_mask:0xf
    v_add_f32_dpp v109, v109, v109 quad_perm:[1,0,3,2] row_mask:0xf bank_mask:0xf
    v_add_f32_dpp v110, v110, v110 quad_perm:[1,0,3,2] row_mask:0xf bank_mask:0xf
    v_add_f32_dpp v111, v111, v111 quad_perm:[1,0,3,2] row_mask:0xf bank_mask:0xf
    v_add_f32_dpp v96, v96, v96 quad_perm:[2,3,0,1] row_mask:0xf bank_mask:0xf
    v_add_f32_dpp v97, v97, v97 quad_perm:[2,3,0,1] row_mask:0xf bank_mask:0xf
    v_add_f32_dpp v98, v98, v98 quad_perm:[2,3,0,1] row_mask:0xf bank_mask:0xf
    v_add_f32_dpp v99, v99, v99 quad_perm:[2,3,0,1] row_mask:0xf bank_mask:0xf
    v_add_f32_dpp v100, v100, v100 quad_perm:[2,3,0,1] row_mask:0xf bank_mask:0xf
    v_add_f32_dpp v101, v101, v101 quad_perm:[2,3,0,1] row_mask:0xf bank_mask:0xf
    v_add_f32_dpp v102, v102, v102 quad_perm:[2,3,0,1] row_mask:0xf bank_mask:0xf
    v_add_f32_dpp v103, v103, v103 quad_perm:[2,3,0,1] row_mask:0xf bank_mask:0xf
    v_add_f32_dpp v104, v104, v104 quad_perm:[2,3,0,1] row_mask:0xf bank_mask:0xf
    v_add_f32_dpp v105, v105, v105 quad_perm:[2,3,0,1] row_mask:0xf bank_mask:0xf
    v_add_f32_dpp v106, v106, v106 quad_perm:[2,3,0,1] row_mask:0xf bank_mask:0xf
    v_add_f32_dpp v107, v107, v107 quad_perm:[2,3,0,1] row_mask:0xf bank_mask:0xf
    v_add_f32_dpp v108, v108, v108 quad_perm:[2,3,0,1] row_mask:0xf bank_mask:0xf
    v_add_f32_dpp v109, v109, v109 quad_perm:[2,3,0,1] row_mask:0xf bank_mask:0xf
    v_add_f32_dpp v110, v110, v110 quad_perm:[2,3,0,1] row_mask:0xf bank_mask:0xf
    v_add_f32_dpp v111, v111, v111 quad_perm:[2,3,0,1] row_mask:0xf bank_mask:0xf
    v_add_f32_dpp v96, v96, v96 row_half_mirror row_mask:0xf bank_mask:0xf
    v_add_f32_dpp v97, v97, v97 row_half_mirror row_mask:0xf bank_mask:0xf
    v_add_f32_dpp v98, v98, v98 row_half_mirror row_mask:0xf bank_mask:0xf
    v_add_f32_dpp v99, v99, v99 row_half_mirror row_mask:0xf bank_mask:0xf
    v_add_f32_dpp v100, v100, v100 row_half_mirror row_mask:0xf bank_mask:0xf
    v_add_f32_dpp v101, v101, v101 row_half_mirror row_mask:0xf bank_mask:0xf
    v_add_f32_dpp v102, v102, v102 row_half_mirror row_mask:0xf bank_mask:0xf
    v_add_f32_dpp v103, v103, v103 row_half_mirror row_mask:0xf bank_mask:0xf
    v_add_f32_dpp v104, v104, v104 row_half_mirror row_mask:0xf bank_mask:0xf
    v_add_f32_dpp v105, v105, v105 row_half_mirror row_mask:0xf bank_mask:0xf
    v_add_f32_dpp v106, v106, v106 row_half_mirror row_mask:0xf bank_mask:0xf
    v_add_f32_dpp v107, v107, v107 row_half_mirror row_mask:0xf bank_mask:0xf
    v_add_f32_dpp v108, v108, v108 row_half_mirror row_mask:0xf bank_mask:0xf
    v_add_f32_dpp v109, v109, v109 row_half_mirror row_mask:0xf bank_mask:0xf
    v_add_f32_dpp v110, v110, v110 row_half_mirror row_mask:0xf bank_mask:0xf
    v_add_f32_dpp v111, v111, v111 row_half_mirror row_mask:0xf bank_mask:0xf
    v_add_f32_dpp v96, v96, v96 row_mirror row_mask:0xf bank_mask:0xf
    v_add_f32_dpp v97, v97, v97 row_mirror row_mask:0xf bank_mask:0xf
    v_add_f32_dpp v98, v98, v98 row_mirror row_mask:0xf bank_mask:0xf
    v_add_f32_dpp v99, v99, v99 row_mirror row_mask:0xf bank_mask:0xf
    v_add_f32_dpp v100, v100, v100 row_mirror row_mask:0xf bank_mask:0xf
    v_add_f32_dpp v101, v101, v101 row_mirror row_mask:0xf bank_mask:0xf
    v_add_f32_dpp v102, v102, v102 row_mirror row_mask:0xf bank_mask:0xf
    v_add_f32_dpp v103, v103, v103 row_mirror row_mask:0xf bank_mask:0xf
    v_add_f32_dpp v104, v104, v104 row_mirror row_mask:0xf bank_mask:0xf
    v_add_f32_dpp v105, v105, v105 row_mirror row_mask:0xf bank_mask:0xf
    v_add_f32_dpp v106, v106, v106 row_mirror row_mask:0xf bank_mask:0xf
    v_add_f32_dpp v107, v107, v107 row_mirror row_mask:0xf bank_mask:0xf
    v_add_f32_dpp v108, v108, v108 row_mirror row_mask:0xf bank_mask:0xf
    v_add_f32_dpp v109, v109, v109 row_mirror row_mask:0xf bank_mask:0xf
    v_add_f32_dpp v110, v110, v110 row_mirror row_mask:0xf bank_mask:0xf
    v_add_f32_dpp v111, v111, v111 row_mirror row_mask:0xf bank_mask:0xf
    v_cmp_eq_u32 vcc, s56, v14
    v_cvt_pk_bf16_f32 v63, v96, v97
    v_lshlrev_b32 v96, 16, v63
    v_and_b32 v97, 0xffff0000, v63
    v_mul_f32 v96, v62, v96
    v_mul_f32 v97, v62, v97
    v_cvt_pk_bf16_f32 v63, v96, v97
    v_lshlrev_b32 v96, 16, v63
    v_and_b32 v97, 0xffff0000, v63
    v_cndmask_b32 v24, v24, v96, vcc
    v_cndmask_b32 v25, v25, v97, vcc
    v_cvt_pk_bf16_f32 v63, v98, v99
    v_lshlrev_b32 v98, 16, v63
    v_and_b32 v99, 0xffff0000, v63
    v_mul_f32 v98, v62, v98
    v_mul_f32 v99, v62, v99
    v_cvt_pk_bf16_f32 v63, v98, v99
    v_lshlrev_b32 v98, 16, v63
    v_and_b32 v99, 0xffff0000, v63
    v_cndmask_b32 v26, v26, v98, vcc
    v_cndmask_b32 v27, v27, v99, vcc
    v_cvt_pk_bf16_f32 v63, v100, v101
    v_lshlrev_b32 v100, 16, v63
    v_and_b32 v101, 0xffff0000, v63
    v_mul_f32 v100, v62, v100
    v_mul_f32 v101, v62, v101
    v_cvt_pk_bf16_f32 v63, v100, v101
    v_lshlrev_b32 v100, 16, v63
    v_and_b32 v101, 0xffff0000, v63
    v_cndmask_b32 v28, v28, v100, vcc
    v_cndmask_b32 v29, v29, v101, vcc
    v_cvt_pk_bf16_f32 v63, v102, v103
    v_lshlrev_b32 v102, 16, v63
    v_and_b32 v103, 0xffff0000, v63
    v_mul_f32 v102, v62, v102
    v_mul_f32 v103, v62, v103
    v_cvt_pk_bf16_f32 v63, v102, v103
    v_lshlrev_b32 v102, 16, v63
    v_and_b32 v103, 0xffff0000, v63
    v_cndmask_b32 v30, v30, v102, vcc
    v_cndmask_b32 v31, v31, v103, vcc
    v_cvt_pk_bf16_f32 v63, v104, v105
    v_lshlrev_b32 v104, 16, v63
    v_and_b32 v105, 0xffff0000, v63
    v_mul_f32 v104, v62, v104
    v_mul_f32 v105, v62, v105
    v_cvt_pk_bf16_f32 v63, v104, v105
    v_lshlrev_b32 v104, 16, v63
    v_and_b32 v105, 0xffff0000, v63
    v_cndmask_b32 v32, v32, v104, vcc
    v_cndmask_b32 v33, v33, v105, vcc
    v_cvt_pk_bf16_f32 v63, v106, v107
    v_lshlrev_b32 v106, 16, v63
    v_and_b32 v107, 0xffff0000, v63
    v_mul_f32 v106, v62, v106
    v_mul_f32 v107, v62, v107
    v_cvt_pk_bf16_f32 v63, v106, v107
    v_lshlrev_b32 v106, 16, v63
    v_and_b32 v107, 0xffff0000, v63
    v_cndmask_b32 v34, v34, v106, vcc
    v_cndmask_b32 v35, v35, v107, vcc
    v_cvt_pk_bf16_f32 v63, v108, v109
    v_lshlrev_b32 v108, 16, v63
    v_and_b32 v109, 0xffff0000, v63
    v_mul_f32 v108, v62, v108
    v_mul_f32 v109, v62, v109
    v_cvt_pk_bf16_f32 v63, v108, v109
    v_lshlrev_b32 v108, 16, v63
    v_and_b32 v109, 0xffff0000, v63
    v_cndmask_b32 v36, v36, v108, vcc
    v_cndmask_b32 v37, v37, v109, vcc
    v_cvt_pk_bf16_f32 v63, v110, v111
    v_lshlrev_b32 v110, 16, v63
    v_and_b32 v111, 0xffff0000, v63
    v_mul_f32 v110, v62, v110
    v_mul_f32 v111, v62, v111
    v_cvt_pk_bf16_f32 v63, v110, v111
    v_lshlrev_b32 v110, 16, v63
    v_and_b32 v111, 0xffff0000, v63
    v_cndmask_b32 v38, v38, v110, vcc
    v_cndmask_b32 v39, v39, v111, vcc
L_recurrent_scan__compressed_kv_cla__moe_arch_mod__prompt_kernel_rt2_noy_1:
    s_sub_u32 s36, s57, s38
    s_cmp_lt_u32 s36, 16
    s_cbranch_scc0 L_recurrent_scan__compressed_kv_cla__moe_arch_mod__prompt_kernel_rt2_noy_2
    s_and_b32 s36, s59, 0xffff0000
    s_cmp_lt_i32 s36, 0
    s_cselect_b32 s37, 0x80000000, -1
    s_xor_b32 s36, s36, s37
    s_and_b32 s36, s36, 0xffff0000
    v_mov_b32 v62, s36
    v_mul_f32 v62, 0xbfb8aa3b, v62
    v_exp_f32 v62, v62
    s_nop 0
    v_add_f32 v62, 1.0, v62
    v_rcp_f32 v62, v62
    s_nop 0
    v_cvt_pk_bf16_f32 v62, v62, v62
    v_lshlrev_b32 v62, 16, v62
    v_add_f32_dpp v112, v112, v112 quad_perm:[1,0,3,2] row_mask:0xf bank_mask:0xf
    v_add_f32_dpp v113, v113, v113 quad_perm:[1,0,3,2] row_mask:0xf bank_mask:0xf
    v_add_f32_dpp v114, v114, v114 quad_perm:[1,0,3,2] row_mask:0xf bank_mask:0xf
    v_add_f32_dpp v115, v115, v115 quad_perm:[1,0,3,2] row_mask:0xf bank_mask:0xf
    v_add_f32_dpp v116, v116, v116 quad_perm:[1,0,3,2] row_mask:0xf bank_mask:0xf
    v_add_f32_dpp v117, v117, v117 quad_perm:[1,0,3,2] row_mask:0xf bank_mask:0xf
    v_add_f32_dpp v118, v118, v118 quad_perm:[1,0,3,2] row_mask:0xf bank_mask:0xf
    v_add_f32_dpp v119, v119, v119 quad_perm:[1,0,3,2] row_mask:0xf bank_mask:0xf
    v_add_f32_dpp v120, v120, v120 quad_perm:[1,0,3,2] row_mask:0xf bank_mask:0xf
    v_add_f32_dpp v121, v121, v121 quad_perm:[1,0,3,2] row_mask:0xf bank_mask:0xf
    v_add_f32_dpp v122, v122, v122 quad_perm:[1,0,3,2] row_mask:0xf bank_mask:0xf
    v_add_f32_dpp v123, v123, v123 quad_perm:[1,0,3,2] row_mask:0xf bank_mask:0xf
    v_add_f32_dpp v124, v124, v124 quad_perm:[1,0,3,2] row_mask:0xf bank_mask:0xf
    v_add_f32_dpp v125, v125, v125 quad_perm:[1,0,3,2] row_mask:0xf bank_mask:0xf
    v_add_f32_dpp v126, v126, v126 quad_perm:[1,0,3,2] row_mask:0xf bank_mask:0xf
    v_add_f32_dpp v127, v127, v127 quad_perm:[1,0,3,2] row_mask:0xf bank_mask:0xf
    v_add_f32_dpp v112, v112, v112 quad_perm:[2,3,0,1] row_mask:0xf bank_mask:0xf
    v_add_f32_dpp v113, v113, v113 quad_perm:[2,3,0,1] row_mask:0xf bank_mask:0xf
    v_add_f32_dpp v114, v114, v114 quad_perm:[2,3,0,1] row_mask:0xf bank_mask:0xf
    v_add_f32_dpp v115, v115, v115 quad_perm:[2,3,0,1] row_mask:0xf bank_mask:0xf
    v_add_f32_dpp v116, v116, v116 quad_perm:[2,3,0,1] row_mask:0xf bank_mask:0xf
    v_add_f32_dpp v117, v117, v117 quad_perm:[2,3,0,1] row_mask:0xf bank_mask:0xf
    v_add_f32_dpp v118, v118, v118 quad_perm:[2,3,0,1] row_mask:0xf bank_mask:0xf
    v_add_f32_dpp v119, v119, v119 quad_perm:[2,3,0,1] row_mask:0xf bank_mask:0xf
    v_add_f32_dpp v120, v120, v120 quad_perm:[2,3,0,1] row_mask:0xf bank_mask:0xf
    v_add_f32_dpp v121, v121, v121 quad_perm:[2,3,0,1] row_mask:0xf bank_mask:0xf
    v_add_f32_dpp v122, v122, v122 quad_perm:[2,3,0,1] row_mask:0xf bank_mask:0xf
    v_add_f32_dpp v123, v123, v123 quad_perm:[2,3,0,1] row_mask:0xf bank_mask:0xf
    v_add_f32_dpp v124, v124, v124 quad_perm:[2,3,0,1] row_mask:0xf bank_mask:0xf
    v_add_f32_dpp v125, v125, v125 quad_perm:[2,3,0,1] row_mask:0xf bank_mask:0xf
    v_add_f32_dpp v126, v126, v126 quad_perm:[2,3,0,1] row_mask:0xf bank_mask:0xf
    v_add_f32_dpp v127, v127, v127 quad_perm:[2,3,0,1] row_mask:0xf bank_mask:0xf
    v_add_f32_dpp v112, v112, v112 row_half_mirror row_mask:0xf bank_mask:0xf
    v_add_f32_dpp v113, v113, v113 row_half_mirror row_mask:0xf bank_mask:0xf
    v_add_f32_dpp v114, v114, v114 row_half_mirror row_mask:0xf bank_mask:0xf
    v_add_f32_dpp v115, v115, v115 row_half_mirror row_mask:0xf bank_mask:0xf
    v_add_f32_dpp v116, v116, v116 row_half_mirror row_mask:0xf bank_mask:0xf
    v_add_f32_dpp v117, v117, v117 row_half_mirror row_mask:0xf bank_mask:0xf
    v_add_f32_dpp v118, v118, v118 row_half_mirror row_mask:0xf bank_mask:0xf
    v_add_f32_dpp v119, v119, v119 row_half_mirror row_mask:0xf bank_mask:0xf
    v_add_f32_dpp v120, v120, v120 row_half_mirror row_mask:0xf bank_mask:0xf
    v_add_f32_dpp v121, v121, v121 row_half_mirror row_mask:0xf bank_mask:0xf
    v_add_f32_dpp v122, v122, v122 row_half_mirror row_mask:0xf bank_mask:0xf
    v_add_f32_dpp v123, v123, v123 row_half_mirror row_mask:0xf bank_mask:0xf
    v_add_f32_dpp v124, v124, v124 row_half_mirror row_mask:0xf bank_mask:0xf
    v_add_f32_dpp v125, v125, v125 row_half_mirror row_mask:0xf bank_mask:0xf
    v_add_f32_dpp v126, v126, v126 row_half_mirror row_mask:0xf bank_mask:0xf
    v_add_f32_dpp v127, v127, v127 row_half_mirror row_mask:0xf bank_mask:0xf
    v_add_f32_dpp v112, v112, v112 row_mirror row_mask:0xf bank_mask:0xf
    v_add_f32_dpp v113, v113, v113 row_mirror row_mask:0xf bank_mask:0xf
    v_add_f32_dpp v114, v114, v114 row_mirror row_mask:0xf bank_mask:0xf
    v_add_f32_dpp v115, v115, v115 row_mirror row_mask:0xf bank_mask:0xf
    v_add_f32_dpp v116, v116, v116 row_mirror row_mask:0xf bank_mask:0xf
    v_add_f32_dpp v117, v117, v117 row_mirror row_mask:0xf bank_mask:0xf
    v_add_f32_dpp v118, v118, v118 row_mirror row_mask:0xf bank_mask:0xf
    v_add_f32_dpp v119, v119, v119 row_mirror row_mask:0xf bank_mask:0xf
    v_add_f32_dpp v120, v120, v120 row_mirror row_mask:0xf bank_mask:0xf
    v_add_f32_dpp v121, v121, v121 row_mirror row_mask:0xf bank_mask:0xf
    v_add_f32_dpp v122, v122, v122 row_mirror row_mask:0xf bank_mask:0xf
    v_add_f32_dpp v123, v123, v123 row_mirror row_mask:0xf bank_mask:0xf
    v_add_f32_dpp v124, v124, v124 row_mirror row_mask:0xf bank_mask:0xf
    v_add_f32_dpp v125, v125, v125 row_mirror row_mask:0xf bank_mask:0xf
    v_add_f32_dpp v126, v126, v126 row_mirror row_mask:0xf bank_mask:0xf
    v_add_f32_dpp v127, v127, v127 row_mirror row_mask:0xf bank_mask:0xf
    v_cmp_eq_u32 vcc, s57, v14
    v_cvt_pk_bf16_f32 v63, v112, v113
    v_lshlrev_b32 v112, 16, v63
    v_and_b32 v113, 0xffff0000, v63
    v_mul_f32 v112, v62, v112
    v_mul_f32 v113, v62, v113
    v_cvt_pk_bf16_f32 v63, v112, v113
    v_lshlrev_b32 v112, 16, v63
    v_and_b32 v113, 0xffff0000, v63
    v_cndmask_b32 v24, v24, v112, vcc
    v_cndmask_b32 v25, v25, v113, vcc
    v_cvt_pk_bf16_f32 v63, v114, v115
    v_lshlrev_b32 v114, 16, v63
    v_and_b32 v115, 0xffff0000, v63
    v_mul_f32 v114, v62, v114
    v_mul_f32 v115, v62, v115
    v_cvt_pk_bf16_f32 v63, v114, v115
    v_lshlrev_b32 v114, 16, v63
    v_and_b32 v115, 0xffff0000, v63
    v_cndmask_b32 v26, v26, v114, vcc
    v_cndmask_b32 v27, v27, v115, vcc
    v_cvt_pk_bf16_f32 v63, v116, v117
    v_lshlrev_b32 v116, 16, v63
    v_and_b32 v117, 0xffff0000, v63
    v_mul_f32 v116, v62, v116
    v_mul_f32 v117, v62, v117
    v_cvt_pk_bf16_f32 v63, v116, v117
    v_lshlrev_b32 v116, 16, v63
    v_and_b32 v117, 0xffff0000, v63
    v_cndmask_b32 v28, v28, v116, vcc
    v_cndmask_b32 v29, v29, v117, vcc
    v_cvt_pk_bf16_f32 v63, v118, v119
    v_lshlrev_b32 v118, 16, v63
    v_and_b32 v119, 0xffff0000, v63
    v_mul_f32 v118, v62, v118
    v_mul_f32 v119, v62, v119
    v_cvt_pk_bf16_f32 v63, v118, v119
    v_lshlrev_b32 v118, 16, v63
    v_and_b32 v119, 0xffff0000, v63
    v_cndmask_b32 v30, v30, v118, vcc
    v_cndmask_b32 v31, v31, v119, vcc
    v_cvt_pk_bf16_f32 v63, v120, v121
    v_lshlrev_b32 v120, 16, v63
    v_and_b32 v121, 0xffff0000, v63
    v_mul_f32 v120, v62, v120
    v_mul_f32 v121, v62, v121
    v_cvt_pk_bf16_f32 v63, v120, v121
    v_lshlrev_b32 v120, 16, v63
    v_and_b32 v121, 0xffff0000, v63
    v_cndmask_b32 v32, v32, v120, vcc
    v_cndmask_b32 v33, v33, v121, vcc
    v_cvt_pk_bf16_f32 v63, v122, v123
    v_lshlrev_b32 v122, 16, v63
    v_and_b32 v123, 0xffff0000, v63
    v_mul_f32 v122, v62, v122
    v_mul_f32 v123, v62, v123
    v_cvt_pk_bf16_f32 v63, v122, v123
    v_lshlrev_b32 v122, 16, v63
    v_and_b32 v123, 0xffff0000, v63
    v_cndmask_b32 v34, v34, v122, vcc
    v_cndmask_b32 v35, v35, v123, vcc
    v_cvt_pk_bf16_f32 v63, v124, v125
    v_lshlrev_b32 v124, 16, v63
    v_and_b32 v125, 0xffff0000, v63
    v_mul_f32 v124, v62, v124
    v_mul_f32 v125, v62, v125
    v_cvt_pk_bf16_f32 v63, v124, v125
    v_lshlrev_b32 v124, 16, v63
    v_and_b32 v125, 0xffff0000, v63
    v_cndmask_b32 v36, v36, v124, vcc
    v_cndmask_b32 v37, v37, v125, vcc
    v_cvt_pk_bf16_f32 v63, v126, v127
    v_lshlrev_b32 v126, 16, v63
    v_and_b32 v127, 0xffff0000, v63
    v_mul_f32 v126, v62, v126
    v_mul_f32 v127, v62, v127
    v_cvt_pk_bf16_f32 v63, v126, v127
    v_lshlrev_b32 v126, 16, v63
    v_and_b32 v127, 0xffff0000, v63
    v_cndmask_b32 v38, v38, v126, vcc
    v_cndmask_b32 v39, v39, v127, vcc
L_recurrent_scan__compressed_kv_cla__moe_arch_mod__prompt_kernel_rt2_noy_2:
L_recurrent_scan__compressed_kv_cla__moe_arch_mod__prompt_kernel_nrt_144:
    s_mov_b32 m0, s42
    s_mov_b32 s36, 15360
    buffer_load_dwordx4 v15, s[16:19], 0 offen lds
    buffer_load_dwordx4 v15, s[16:19], s36 offen offset:1024 lds
    s_mov_b32 s36, 4194304
    buffer_load_dwordx2 v[48:49], v16, s[24:27], s36 offen sc1
L_recurrent_scan__compressed_kv_cla__moe_arch_mod__prompt_kernel_swend_148:
    s_branch L_recurrent_scan__compressed_kv_cla__moe_arch_mod__prompt_kernel_back_152
L_recurrent_scan__compressed_kv_cla__moe_arch_mod__prompt_kernel_rare_154:
    s_cmp_eq_u32 s28, 0
    s_cbranch_scc0 L_recurrent_scan__compressed_kv_cla__moe_arch_mod__prompt_kernel_g_147
    s_mov_b32 s43, s38
    s_getpc_b64 s[36:37]
L_recurrent_scan__compressed_kv_cla__moe_arch_mod__prompt_kernel_pc_146:
    s_sub_u32 s36, s36, L_recurrent_scan__compressed_kv_cla__moe_arch_mod__prompt_kernel_pc_146-L_pc
    s_subb_u32 s37, s37, 0
    s_lshr_b32 s38, s2, 3
    s_lshl_b32 s38, s38, 7
    v_lshl_add_u32 v4, v1, 12, s38
    v_min_u32 v4, L_end-L_pc-4, v4
    v_mov_b32 v5, s37
    v_add_co_u32 v4, vcc, s36, v4
    s_mov_b64 exec, 0xffff
    s_nop 0
    v_addc_co_u32 v5, vcc, 0, v5, vcc
    global_load_dword v63, v[4:5], off
    s_mov_b64 exec, -1
    s_nop 1
    s_mov_b32 s38, s43
L_recurrent_scan__compressed_kv_cla__moe_arch_mod__prompt_kernel_g_147:
    s_sub_u32 s36, s56, s38
    s_sub_u32 s37, s57, s38
    s_min_u32 s36, s36, s37
    s_cmp_lt_u32 s36, 16
    s_cbranch_scc0 L_recurrent_scan__compressed_kv_cla__moe_arch_mod__prompt_kernel_nrt_145
    s_waitcnt vmcnt(16)
    v_readfirstlane_b32 s36, v61
    s_nop 0
    s_cmp_lt_u32 s36, 16
    s_cbranch_scc1 L_recurrent_scan__compressed_kv_cla__moe_arch_mod__prompt_kernel_rt1_rare_3
L_recurrent_scan__compressed_kv_cla__moe_arch_mod__prompt_kernel_rt1_back_4:
    s_lshl_b32 s37, s30, 8
    s_add_u32 s36, s37, 59768832
    s_add_u32 s37, s36, 4096
    v_and_b32 v60, 15, v1
    v_lshlrev_b32 v60, 13, v60
    v_lshl_add_u32 v60, v19, 4, v60
    buffer_load_dwordx4 v[96:99], v60, s[24:27], s36 offen offset:0 sc1
    buffer_load_dwordx4 v[100:103], v60, s[24:27], s36 offen offset:64 sc1
    buffer_load_dwordx4 v[104:107], v60, s[24:27], s36 offen offset:128 sc1
    buffer_load_dwordx4 v[108:111], v60, s[24:27], s36 offen offset:192 sc1
    buffer_load_dwordx4 v[112:115], v60, s[24:27], s37 offen offset:0 sc1
    buffer_load_dwordx4 v[116:119], v60, s[24:27], s37 offen offset:64 sc1
    buffer_load_dwordx4 v[120:123], v60, s[24:27], s37 offen offset:128 sc1
    buffer_load_dwordx4 v[124:127], v60, s[24:27], s37 offen offset:192 sc1
L_recurrent_scan__compressed_kv_cla__moe_arch_mod__prompt_kernel_nrt_145:
L_recurrent_scan__compressed_kv_cla__moe_arch_mod__prompt_kernel_swend_153:
    s_branch L_recurrent_scan__compressed_kv_cla__moe_arch_mod__prompt_kernel_back_155
L_recurrent_scan__compressed_kv_cla__moe_arch_mod__prompt_kernel_rare_156:
    global_load_dword v59, v58, s[90:91] sc1
    s_branch L_recurrent_scan__compressed_kv_cla__moe_arch_mod__prompt_kernel_back_157
L_recurrent_scan__compressed_kv_cla__moe_arch_mod__prompt_kernel_rare_166:
    s_cmp_eq_u32 s35, 0
    s_cbranch_scc0 L_recurrent_scan__compressed_kv_cla__moe_arch_mod__prompt_kernel_swn_165
    s_mov_b32 s61, 0x40000
    s_waitcnt vmcnt(8)
    s_branch L_recurrent_scan__compressed_kv_cla__moe_arch_mod__prompt_kernel_cchk_160
L_recurrent_scan__compressed_kv_cla__moe_arch_mod__prompt_kernel_cspin_158:
    s_sub_u32 s61, s61, 1
    s_cbranch_scc1 L_recurrent_scan__compressed_kv_cla__moe_arch_mod__prompt_kernel_cspinx_159
    global_load_dword v59, v58, s[90:91] sc1
    s_waitcnt vmcnt(0)
L_recurrent_scan__compressed_kv_cla__moe_arch_mod__prompt_kernel_cchk_160:
    v_cmp_le_u32 vcc, 4, v59
    s_nop 0
    s_and_b32 s60, vcc_lo, 15
    s_and_b32 s36, s60, 7
    s_cmp_eq_u32 s36, 7
    s_cbranch_scc1 L_recurrent_scan__compressed_kv_cla__moe_arch_mod__prompt_kernel_cspinx_159
    s_sleep 6
    s_branch L_recurrent_scan__compressed_kv_cla__moe_arch_mod__prompt_kernel_cspin_158
L_recurrent_scan__compressed_kv_cla__moe_arch_mod__prompt_kernel_cspinx_159:
    s_branch L_recurrent_scan__compressed_kv_cla__moe_arch_mod__prompt_kernel_swend_164
L_recurrent_scan__compressed_kv_cla__moe_arch_mod__prompt_kernel_swn_165:
    s_mov_b32 s61, 0x40000
    s_waitcnt vmcnt(8)
    s_branch L_recurrent_scan__compressed_kv_cla__moe_arch_mod__prompt_kernel_cchk_163
L_recurrent_scan__compressed_kv_cla__moe_arch_mod__prompt_kernel_cspin_161:
    s_sub_u32 s61, s61, 1
    s_cbranch_scc1 L_recurrent_scan__compressed_kv_cla__moe_arch_mod__prompt_kernel_cspinx_162
    global_load_dword v59, v58, s[90:91] sc1
    s_waitcnt vmcnt(0)
L_recurrent_scan__compressed_kv_cla__moe_arch_mod__prompt_kernel_cchk_163:
    v_cmp_le_u32 vcc, 4, v59
    s_nop 0
    s_and_b32 s60, vcc_lo, 15
    s_and_b32 s36, s60, 15
    s_cmp_eq_u32 s36, 15
    s_cbranch_scc1 L_recurrent_scan__compressed_kv_cla__moe_arch_mod__prompt_kernel_cspinx_162
    s_sleep 6
    s_branch L_recurrent_scan__compressed_kv_cla__moe_arch_mod__prompt_kernel_cspin_161
L_recurrent_scan__compressed_kv_cla__moe_arch_mod__prompt_kernel_cspinx_162:
L_recurrent_scan__compressed_kv_cla__moe_arch_mod__prompt_kernel_swend_164:
    s_branch L_recurrent_scan__compressed_kv_cla__moe_arch_mod__prompt_kernel_back_167
L_recurrent_scan__compressed_kv_cla__moe_arch_mod__prompt_kernel_f2m_168:
    v_lshrrev_b32 v28, 4, v1
    v_bfe_u32 v26, v1, 2, 2
    v_lshl_add_u32 v26, v28, 3, v26
    v_lshlrev_b32 v26, 7, v26
    v_and_b32 v27, 3, v1
    v_lshl_add_u32 v26, v27, 3, v26
    v_bfe_u32 v27, v1, 3, 2
    s_lshl_b32 s36, s28, 12
    s_add_u32 s36, s36, 131072
    v_add_u32 v26, s36, v26
    v_xor_b32 v28, 0, v27
    v_lshl_add_u32 v28, v28, 5, v26
    ds_read_b64_tr_b16 v[112:113], v28 offset:0
    ds_read_b64_tr_b16 v[114:115], v28 offset:512
    v_xor_b32 v28, 1, v27
    v_lshl_add_u32 v28, v28, 5, v26
    ds_read_b64_tr_b16 v[116:117], v28 offset:0
    ds_read_b64_tr_b16 v[118:119], v28 offset:512
    v_xor_b32 v28, 2, v27
    v_lshl_add_u32 v28, v28, 5, v26
    ds_read_b64_tr_b16 v[120:121], v28 offset:0
    ds_read_b64_tr_b16 v[122:123], v28 offset:512
    v_xor_b32 v28, 3, v27
    v_lshl_add_u32 v28, v28, 5, v26
    ds_read_b64_tr_b16 v[124:125], v28 offset:0
    ds_read_b64_tr_b16 v[126:127], v28 offset:512
    v_add_f32_dpp v96, v96, v96 row_ror:4 row_mask:0xf bank_mask:0xf
    v_add_f32_dpp v97, v97, v97 row_ror:4 row_mask:0xf bank_mask:0xf
    v_add_f32_dpp v98, v98, v98 row_ror:4 row_mask:0xf bank_mask:0xf
    v_add_f32_dpp v99, v99, v99 row_ror:4 row_mask:0xf bank_mask:0xf
    v_add_f32_dpp v100, v100, v100 row_ror:4 row_mask:0xf bank_mask:0xf
    v_add_f32_dpp v101, v101, v101 row_ror:4 row_mask:0xf bank_mask:0xf
    v_add_f32_dpp v102, v102, v102 row_ror:4 row_mask:0xf bank_mask:0xf
    v_add_f32_dpp v103, v103, v103 row_ror:4 row_mask:0xf bank_mask:0xf
    v_add_f32_dpp v96, v96, v96 row_ror:8 row_mask:0xf bank_mask:0xf
    v_add_f32_dpp v97, v97, v97 row_ror:8 row_mask:0xf bank_mask:0xf
    v_add_f32_dpp v98, v98, v98 row_ror:8 row_mask:0xf bank_mask:0xf
    v_add_f32_dpp v99, v99, v99 row_ror:8 row_mask:0xf bank_mask:0xf
    v_add_f32_dpp v100, v100, v100 row_ror:8 row_mask:0xf bank_mask:0xf
    v_add_f32_dpp v101, v101, v101 row_ror:8 row_mask:0xf bank_mask:0xf
    v_add_f32_dpp v102, v102, v102 row_ror:8 row_mask:0xf bank_mask:0xf
    v_add_f32_dpp v103, v103, v103 row_ror:8 row_mask:0xf bank_mask:0xf
    v_cvt_pk_bf16_f32 v29, v96, v97
    v_lshlrev_b32 v96, 16, v29
    v_and_b32 v97, 0xffff0000, v29
    v_cvt_pk_bf16_f32 v29, v98, v99
    v_lshlrev_b32 v98, 16, v29
    v_and_b32 v99, 0xffff0000, v29
    v_cvt_pk_bf16_f32 v29, v100, v101
    v_lshlrev_b32 v100, 16, v29
    v_and_b32 v101, 0xffff0000, v29
    v_cvt_pk_bf16_f32 v29, v102, v103
    v_lshlrev_b32 v102, 16, v29
    v_and_b32 v103, 0xffff0000, v29
    v_mul_f32 v104, 0xbfb8aa3b, v96
    v_mul_f32 v105, 0xbfb8aa3b, v97
    v_mul_f32 v106, 0xbfb8aa3b, v98
    v_mul_f32 v107, 0xbfb8aa3b, v99
    v_mul_f32 v108, 0xbfb8aa3b, v100
    v_mul_f32 v109, 0xbfb8aa3b, v101
    v_mul_f32 v110, 0xbfb8aa3b, v102
    v_mul_f32 v111, 0xbfb8aa3b, v103
    v_exp_f32 v104, v104
    v_exp_f32 v105, v105
    v_exp_f32 v106, v106
    v_exp_f32 v107, v107
    v_exp_f32 v108, v108
    v_exp_f32 v109, v109
    v_exp_f32 v110, v110
    v_exp_f32 v111, v111
    v_add_f32 v104, 1.0, v104
    v_add_f32 v105, 1.0, v105
    v_add_f32 v106, 1.0, v106
    v_add_f32 v107, 1.0, v107
    v_add_f32 v108, 1.0, v108
    v_add_f32 v109, 1.0, v109
    v_add_f32 v110, 1.0, v110
    v_add_f32 v111, 1.0, v111
    v_rcp_f32 v104, v104
    v_rcp_f32 v105, v105
    v_rcp_f32 v106, v106
    v_rcp_f32 v107, v107
    v_rcp_f32 v108, v108
    v_rcp_f32 v109, v109
    v_rcp_f32 v110, v110
    v_rcp_f32 v111, v111
    v_mul_f32 v104, v96, v104
    v_mul_f32 v105, v97, v105
    v_mul_f32 v106, v98, v106
    v_mul_f32 v107, v99, v107
    v_mul_f32 v108, v100, v108
    v_mul_f32 v109, v101, v109
    v_mul_f32 v110, v102, v110
    v_mul_f32 v111, v103, v111
    v_cvt_pk_bf16_f32 v29, v104, v105
    v_lshlrev_b32 v104, 16, v29
    v_and_b32 v105, 0xffff0000, v29
    v_cvt_pk_bf16_f32 v29, v106, v107
    v_lshlrev_b32 v106, 16, v29
    v_and_b32 v107, 0xffff0000, v29
    v_cvt_pk_bf16_f32 v29, v108, v109
    v_lshlrev_b32 v108, 16, v29
    v_and_b32 v109, 0xffff0000, v29
    v_cvt_pk_bf16_f32 v29, v110, v111
    v_lshlrev_b32 v110, 16, v29
    v_and_b32 v111, 0xffff0000, v29
    v_mul_f32_dpp v96, v96, v104 quad_perm:[2,3,0,1] row_mask:0xf bank_mask:0xf
    v_mul_f32_dpp v97, v97, v105 quad_perm:[2,3,0,1] row_mask:0xf bank_mask:0xf
    v_mul_f32_dpp v98, v98, v106 quad_perm:[2,3,0,1] row_mask:0xf bank_mask:0xf
    v_mul_f32_dpp v99, v99, v107 quad_perm:[2,3,0,1] row_mask:0xf bank_mask:0xf
    v_mul_f32_dpp v100, v100, v108 quad_perm:[2,3,0,1] row_mask:0xf bank_mask:0xf
    v_mul_f32_dpp v101, v101, v109 quad_perm:[2,3,0,1] row_mask:0xf bank_mask:0xf
    v_mul_f32_dpp v102, v102, v110 quad_perm:[2,3,0,1] row_mask:0xf bank_mask:0xf
    v_mul_f32_dpp v103, v103, v111 quad_perm:[2,3,0,1] row_mask:0xf bank_mask:0xf
    v_cvt_pk_bf16_f32 v36, v96, v97
    v_cvt_pk_bf16_f32 v37, v98, v99
    v_cvt_pk_bf16_f32 v38, v100, v101
    v_cvt_pk_bf16_f32 v39, v102, v103
    s_waitcnt lgkmcnt(0)
    v_lshl_add_u32 v28, v1, 4, s36
    v_mfma_f32_16x16x32_bf16 v[96:99], v[112:115], v[36:39], 0
    v_mfma_f32_16x16x32_bf16 v[100:103], v[116:119], v[36:39], 0
    v_mfma_f32_16x16x32_bf16 v[104:107], v[120:123], v[36:39], 0
    v_mfma_f32_16x16x32_bf16 v[108:111], v[124:127], v[36:39], 0
    s_nop 7
    ds_write_b128 v28, v[96:99] offset:0
    ds_write_b128 v28, v[100:103] offset:1024
    ds_write_b128 v28, v[104:107] offset:2048
    ds_write_b128 v28, v[108:111] offset:3072
    s_cmp_lt_u32 s28, 4
    s_cbranch_scc1 L_recurrent_scan__compressed_kv_cla__moe_arch_mod__prompt_kernel_f2b_170
    s_branch L_recurrent_scan__compressed_kv_cla__moe_arch_mod__prompt_kernel_f2a_169
L_recurrent_scan__compressed_kv_cla__moe_arch_mod__prompt_kernel_gy_176:
    v_lshlrev_b32 v96, 16, v40
    v_and_b32 v97, 0xffff0000, v40
    v_sub_f32 v112, v96, v48
    v_sub_f32 v113, v97, v48
    v_cvt_pk_bf16_f32 v10, v112, v113
    v_lshlrev_b32 v112, 16, v10
    v_and_b32 v113, 0xffff0000, v10
    v_mul_f32 v112, v112, v49
    v_mul_f32 v113, v113, v49
    v_cvt_pk_bf16_f32 v10, v112, v113
    v_lshlrev_b32 v112, 16, v10
    v_and_b32 v113, 0xffff0000, v10
    v_add_f32 v112, v112, v24
    v_add_f32 v113, v113, v25
    v_cvt_pk_bf16_f32 v10, v112, v113
    v_lshlrev_b32 v112, 16, v10
    v_and_b32 v113, 0xffff0000, v10
    v_mul_f32 v11, 0xbfb8aa3b, v112
    v_mul_f32 v12, 0xbfb8aa3b, v113
    v_exp_f32 v11, v11
    v_exp_f32 v12, v12
    s_nop 0
    v_add_f32 v11, 1.0, v11
    v_add_f32 v12, 1.0, v12
    v_rcp_f32 v11, v11
    v_rcp_f32 v12, v12
    s_nop 0
    v_mul_f32 v112, v112, v11
    v_mul_f32 v113, v113, v12
    v_cvt_pk_bf16_f32 v10, v112, v113
    v_lshlrev_b32 v112, 16, v10
    v_and_b32 v113, 0xffff0000, v10
    v_lshlrev_b32 v98, 16, v41
    v_and_b32 v99, 0xffff0000, v41
    v_sub_f32 v114, v98, v48
    v_sub_f32 v115, v99, v48
    v_cvt_pk_bf16_f32 v10, v114, v115
    v_lshlrev_b32 v114, 16, v10
    v_and_b32 v115, 0xffff0000, v10
    v_mul_f32 v114, v114, v49
    v_mul_f32 v115, v115, v49
    v_cvt_pk_bf16_f32 v10, v114, v115
    v_lshlrev_b32 v114, 16, v10
    v_and_b32 v115, 0xffff0000, v10
    v_add_f32 v114, v114, v26
    v_add_f32 v115, v115, v27
    v_cvt_pk_bf16_f32 v10, v114, v115
    v_lshlrev_b32 v114, 16, v10
    v_and_b32 v115, 0xffff0000, v10
    v_mul_f32 v11, 0xbfb8aa3b, v114
    v_mul_f32 v12, 0xbfb8aa3b, v115
    v_exp_f32 v11, v11
    v_exp_f32 v12, v12
    s_nop 0
    v_add_f32 v11, 1.0, v11
    v_add_f32 v12, 1.0, v12
    v_rcp_f32 v11, v11
    v_rcp_f32 v12, v12
    s_nop 0
    v_mul_f32 v114, v114, v11
    v_mul_f32 v115, v115, v12
    v_cvt_pk_bf16_f32 v10, v114, v115
    v_lshlrev_b32 v114, 16, v10
    v_and_b32 v115, 0xffff0000, v10
    v_lshlrev_b32 v100, 16, v42
    v_and_b32 v101, 0xffff0000, v42
    v_sub_f32 v116, v100, v48
    v_sub_f32 v117, v101, v48
    v_cvt_pk_bf16_f32 v10, v116, v117
    v_lshlrev_b32 v116, 16, v10
    v_and_b32 v117, 0xffff0000, v10
    v_mul_f32 v116, v116, v49
    v_mul_f32 v117, v117, v49
    v_cvt_pk_bf16_f32 v10, v116, v117
    v_lshlrev_b32 v116, 16, v10
    v_and_b32 v117, 0xffff0000, v10
    v_add_f32 v116, v116, v28
    v_add_f32 v117, v117, v29
    v_cvt_pk_bf16_f32 v10, v116, v117
    v_lshlrev_b32 v116, 16, v10
    v_and_b32 v117, 0xffff0000, v10
    v_mul_f32 v11, 0xbfb8aa3b, v116
    v_mul_f32 v12, 0xbfb8aa3b, v117
    v_exp_f32 v11, v11
    v_exp_f32 v12, v12
    s_nop 0
    v_add_f32 v11, 1.0, v11
    v_add_f32 v12, 1.0, v12
    v_rcp_f32 v11, v11
    v_rcp_f32 v12, v12
    s_nop 0
    v_mul_f32 v116, v116, v11
    v_mul_f32 v117, v117, v12
    v_cvt_pk_bf16_f32 v10, v116, v117
    v_lshlrev_b32 v116, 16, v10
    v_and_b32 v117, 0xffff0000, v10
    v_lshlrev_b32 v102, 16, v43
    v_and_b32 v103, 0xffff0000, v43
    v_sub_f32 v118, v102, v48
    v_sub_f32 v119, v103, v48
    v_cvt_pk_bf16_f32 v10, v118, v119
    v_lshlrev_b32 v118, 16, v10
    v_and_b32 v119, 0xffff0000, v10
    v_mul_f32 v118, v118, v49
    v_mul_f32 v119, v119, v49
    v_cvt_pk_bf16_f32 v10, v118, v119
    v_lshlrev_b32 v118, 16, v10
    v_and_b32 v119, 0xffff0000, v10
    v_add_f32 v118, v118, v30
    v_add_f32 v119, v119, v31
    v_cvt_pk_bf16_f32 v10, v118, v119
    v_lshlrev_b32 v118, 16, v10
    v_and_b32 v119, 0xffff0000, v10
    v_mul_f32 v11, 0xbfb8aa3b, v118
    v_mul_f32 v12, 0xbfb8aa3b, v119
    v_exp_f32 v11, v11
    v_exp_f32 v12, v12
    s_nop 0
    v_add_f32 v11, 1.0, v11
    v_add_f32 v12, 1.0, v12
    v_rcp_f32 v11, v11
    v_rcp_f32 v12, v12
    s_nop 0
    v_mul_f32 v118, v118, v11
    v_mul_f32 v119, v119, v12
    v_cvt_pk_bf16_f32 v10, v118, v119
    v_lshlrev_b32 v118, 16, v10
    v_and_b32 v119, 0xffff0000, v10
    s_waitcnt vmcnt(0)
    v_mov_b32 v4, s40
    v_mov_b32 v13, 1
    s_mov_b64 exec, 1
    global_atomic_add v4, v13, s[90:91]
    s_mov_b64 exec, -1
    v_lshlrev_b32 v104, 16, v44
    v_and_b32 v105, 0xffff0000, v44
    v_sub_f32 v120, v104, v48
    v_sub_f32 v121, v105, v48
    v_cvt_pk_bf16_f32 v10, v120, v121
    v_lshlrev_b32 v120, 16, v10
    v_and_b32 v121, 0xffff0000, v10
    v_mul_f32 v120, v120, v49
    v_mul_f32 v121, v121, v49
    v_cvt_pk_bf16_f32 v10, v120, v121
    v_lshlrev_b32 v120, 16, v10
    v_and_b32 v121, 0xffff0000, v10
    v_add_f32 v120, v120, v32
    v_add_f32 v121, v121, v33
    v_cvt_pk_bf16_f32 v10, v120, v121
    v_lshlrev_b32 v120, 16, v10
    v_and_b32 v121, 0xffff0000, v10
    v_mul_f32 v11, 0xbfb8aa3b, v120
    v_mul_f32 v12, 0xbfb8aa3b, v121
    v_exp_f32 v11, v11
    v_exp_f32 v12, v12
    s_nop 0
    v_add_f32 v11, 1.0, v11
    v_add_f32 v12, 1.0, v12
    v_rcp_f32 v11, v11
    v_rcp_f32 v12, v12
    s_nop 0
    v_mul_f32 v120, v120, v11
    v_mul_f32 v121, v121, v12
    v_cvt_pk_bf16_f32 v10, v120, v121
    v_lshlrev_b32 v120, 16, v10
    v_and_b32 v121, 0xffff0000, v10
    v_lshlrev_b32 v106, 16, v45
    v_and_b32 v107, 0xffff0000, v45
    v_sub_f32 v122, v106, v48
    v_sub_f32 v123, v107, v48
    v_cvt_pk_bf16_f32 v10, v122, v123
    v_lshlrev_b32 v122, 16, v10
    v_and_b32 v123, 0xffff0000, v10
    v_mul_f32 v122, v122, v49
    v_mul_f32 v123, v123, v49
    v_cvt_pk_bf16_f32 v10, v122, v123
    v_lshlrev_b32 v122, 16, v10
    v_and_b32 v123, 0xffff0000, v10
    v_add_f32 v122, v122, v34
    v_add_f32 v123, v123, v35
    v_cvt_pk_bf16_f32 v10, v122, v123
    v_lshlrev_b32 v122, 16, v10
    v_and_b32 v123, 0xffff0000, v10
    v_mul_f32 v11, 0xbfb8aa3b, v122
    v_mul_f32 v12, 0xbfb8aa3b, v123
    v_exp_f32 v11, v11
    v_exp_f32 v12, v12
    s_nop 0
    v_add_f32 v11, 1.0, v11
    v_add_f32 v12, 1.0, v12
    v_rcp_f32 v11, v11
    v_rcp_f32 v12, v12
    s_nop 0
    v_mul_f32 v122, v122, v11
    v_mul_f32 v123, v123, v12
    v_cvt_pk_bf16_f32 v10, v122, v123
    v_lshlrev_b32 v122, 16, v10
    v_and_b32 v123, 0xffff0000, v10
    v_lshlrev_b32 v108, 16, v46
    v_and_b32 v109, 0xffff0000, v46
    v_sub_f32 v124, v108, v48
    v_sub_f32 v125, v109, v48
    v_cvt_pk_bf16_f32 v10, v124, v125
    v_lshlrev_b32 v124, 16, v10
    v_and_b32 v125, 0xffff0000, v10
    v_mul_f32 v124, v124, v49
    v_mul_f32 v125, v125, v49
    v_cvt_pk_bf16_f32 v10, v124, v125
    v_lshlrev_b32 v124, 16, v10
    v_and_b32 v125, 0xffff0000, v10
    v_add_f32 v124, v124, v36
    v_add_f32 v125, v125, v37
    v_cvt_pk_bf16_f32 v10, v124, v125
    v_lshlrev_b32 v124, 16, v10
    v_and_b32 v125, 0xffff0000, v10
    v_mul_f32 v11, 0xbfb8aa3b, v124
    v_mul_f32 v12, 0xbfb8aa3b, v125
    v_exp_f32 v11, v11
    v_exp_f32 v12, v12
    s_nop 0
    v_add_f32 v11, 1.0, v11
    v_add_f32 v12, 1.0, v12
    v_rcp_f32 v11, v11
    v_rcp_f32 v12, v12
    s_nop 0
    v_mul_f32 v124, v124, v11
    v_mul_f32 v125, v125, v12
    v_cvt_pk_bf16_f32 v10, v124, v125
    v_lshlrev_b32 v124, 16, v10
    v_and_b32 v125, 0xffff0000, v10
    v_lshlrev_b32 v110, 16, v47
    v_and_b32 v111, 0xffff0000, v47
    v_sub_f32 v126, v110, v48
    v_sub_f32 v127, v111, v48
    v_cvt_pk_bf16_f32 v10, v126, v127
    v_lshlrev_b32 v126, 16, v10
    v_and_b32 v127, 0xffff0000, v10
    v_mul_f32 v126, v126, v49
    v_mul_f32 v127, v127, v49
    v_cvt_pk_bf16_f32 v10, v126, v127
    v_lshlrev_b32 v126, 16, v10
    v_and_b32 v127, 0xffff0000, v10
    v_add_f32 v126, v126, v38
    v_add_f32 v127, v127, v39
    v_cvt_pk_bf16_f32 v10, v126, v127
    v_lshlrev_b32 v126, 16, v10
    v_and_b32 v127, 0xffff0000, v10
    v_mul_f32 v11, 0xbfb8aa3b, v126
    v_mul_f32 v12, 0xbfb8aa3b, v127
    v_exp_f32 v11, v11
    v_exp_f32 v12, v12
    s_nop 0
    v_add_f32 v11, 1.0, v11
    v_add_f32 v12, 1.0, v12
    v_rcp_f32 v11, v11
    v_rcp_f32 v12, v12
    s_nop 0
    v_mul_f32 v126, v126, v11
    v_mul_f32 v127, v127, v12
    v_cvt_pk_bf16_f32 v10, v126, v127
    v_lshlrev_b32 v126, 16, v10
    v_and_b32 v127, 0xffff0000, v10
    s_branch L_recurrent_scan__compressed_kv_cla__moe_arch_mod__prompt_kernel_gyb_177
L_recurrent_scan__compressed_kv_cla__moe_arch_mod__prompt_kernel_rare_180:
    s_mov_b32 s61, 0x40000
L_recurrent_scan__compressed_kv_cla__moe_arch_mod__prompt_kernel_spin_178:
    s_sub_u32 s61, s61, 1
    s_cbranch_scc1 L_recurrent_scan__compressed_kv_cla__moe_arch_mod__prompt_kernel_spinx_179
    s_sleep 1
    global_load_dword v23, v5, s[90:91] sc1
    s_waitcnt vmcnt(0)
    v_readfirstlane_b32 s36, v23
    s_nop 0
    s_cmp_lt_u32 s36, 8
    s_cbranch_scc1 L_recurrent_scan__compressed_kv_cla__moe_arch_mod__prompt_kernel_spin_178
L_recurrent_scan__compressed_kv_cla__moe_arch_mod__prompt_kernel_spinx_179:
    s_branch L_recurrent_scan__compressed_kv_cla__moe_arch_mod__prompt_kernel_back_181
L_end:
    s_endpgm
.section .rodata,"a"
.p2align 6
.amdhsa_kernel recurrent_scan__compressed_kv_cla__moe_arch_mod__prompt_kernel
  .amdhsa_next_free_vgpr 256
  .amdhsa_next_free_sgpr 102
  .amdhsa_accum_offset 256
  .amdhsa_group_segment_fixed_size 0
  .amdhsa_kernarg_size 112
  .amdhsa_user_sgpr_count 2
  .amdhsa_user_sgpr_kernarg_segment_ptr 1
  .amdhsa_system_sgpr_workgroup_id_x 1
.end_amdhsa_kernel
```

```asm
; @launch kernel=recurrent_scan__compressed_kv_cla__moe_arch_mod__prompt_kernel grid=(256,1,1) block=(512,1,1) lds=163840
.amdgcn_target "amdgcn-amd-amdhsa--gfx950"
.text
.globl recurrent_scan__compressed_kv_cla__moe_arch_mod__prompt_kernel
.p2align 8
.type recurrent_scan__compressed_kv_cla__moe_arch_mod__prompt_kernel,@function
recurrent_scan__compressed_kv_cla__moe_arch_mod__prompt_kernel:
    s_cmp_ge_u32 s2, 256
    s_cbranch_scc1 L_end
    s_load_dwordx4 s[44:47], s[0:1], 0
    s_load_dwordx2 s[52:53], s[0:1], 56
    s_load_dwordx4 s[48:51], s[0:1], 24
    s_getpc_b64 s[36:37]
L_pc:
    s_lshr_b32 s38, s2, 3
    s_lshl_b32 s38, s38, 7
    v_lshl_add_u32 v16, v0, 12, s38
    v_cmp_gt_u32 vcc, L_end-L_pc-4, v16
    v_mov_b32 v17, s37
    s_and_b64 exec, exec, vcc
    s_cbranch_execz L_nocpf
    v_add_co_u32 v16, vcc, s36, v16
    s_nop 1
    v_addc_co_u32 v17, vcc, 0, v17, vcc
    global_load_dword v119, v[16:17], off
L_nocpf:
    s_mov_b64 exec, -1
    v_lshrrev_b32 v16, 6, v0
    v_and_b32 v1, 63, v0
    v_readfirstlane_b32 s28, v16
    v_lshlrev_b32 v116, 4, v1
    s_lshl_b32 s42, s2, 3
    s_cmp_lt_u32 s28, 4
    s_cbranch_scc1 L_nox
    s_add_u32 s43, s42, s28
    s_sub_u32 s42, s43, 4
    v_lshl_add_u32 v18, s42, 11, v116
    v_add_u32 v19, 8192, v18
    s_waitcnt lgkmcnt(0)
    global_load_dwordx4 v[20:23], v18, s[44:45]
    global_load_dwordx4 v[24:27], v18, s[44:45] offset:1024
    global_load_dwordx4 v[28:31], v19, s[44:45]
    global_load_dwordx4 v[32:35], v19, s[44:45] offset:1024
    global_load_dwordx4 v[36:39], v116, s[52:53]
    global_load_dwordx4 v[40:43], v116, s[52:53] offset:1024
    s_barrier
L_nox:
    s_load_dwordx4 s[88:91], s[0:1], 96
    s_load_dwordx4 s[92:95], s[0:1], 64
    s_load_dwordx2 s[96:97], s[0:1], 16
    s_and_b32 s29, s2, 7
    s_lshl_b32 s29, s29, 2
    s_bfe_u32 s36, s2, 0x20003
    s_add_u32 s29, s29, s36
    s_lshr_b32 s30, s2, 5
    v_lshrrev_b32 v16, 3, v1
    s_lshl_b32 s36, s30, 8
    s_lshl_b32 s37, s28, 5
    s_add_u32 s36, s36, s37
    v_add_u32 v16, s36, v16
    v_lshlrev_b32 v16, 10, v16
    v_lshrrev_b32 v18, 4, v1
    v_and_b32 v19, 7, v1
    v_xor_b32 v19, v19, v18
    v_lshl_add_u32 v2, v19, 4, v16
    v_xor_b32 v19, 4, v19
    v_lshl_add_u32 v3, v19, 4, v16
    v_add_u32 v3, 7168, v3
    v_add_u32 v4, 14336, v2
    v_add_u32 v5, 14336, v3
    s_and_b32 s36, s28, 3
    s_lshl_b32 s37, s36, 4
    v_add_u32 v16, s37, v18
    v_lshlrev_b32 v16, 13, v16
    s_lshl_b32 s37, s29, 8
    v_add_u32 v16, s37, v16
    v_and_b32 v19, 15, v1
    v_lshlrev_b32 v18, 1, v18
    v_xor_b32 v19, v19, v18
    v_lshl_add_u32 v6, v19, 4, v16
    v_add_u32 v7, 31744, v6
    v_xor_b32 v19, 8, v19
    v_lshl_add_u32 v8, v19, 4, v16
    v_add_u32 v8, 63488, v8
    v_add_u32 v9, 31744, v8
    s_lshl_b32 s33, s28, 12
    s_add_u32 s34, s33, 65536
    s_mov_b32 s31, 0
    s_mov_b32 s32, 0
    s_mov_b32 s40, 128
    s_mov_b32 s41, 524288
    s_waitcnt lgkmcnt(0)
    s_mov_b32 s4, s46
    s_and_b32 s5, s47, 0xffff
    s_mov_b32 s6, 2097152
    s_mov_b32 s7, 0x20000
    s_mov_b32 s8, s48
    s_and_b32 s9, s49, 0xffff
    s_mov_b32 s10, 4194304
    s_mov_b32 s11, 0x20000
    s_mov_b32 s20, s50
    s_and_b32 s21, s51, 0xffff
    s_mov_b32 s22, 4194304
    s_mov_b32 s23, 0x20000
    s_cmp_lt_u32 s28, 4
    s_cbranch_scc0 L_pro_s
    s_barrier
    s_cmp_eq_u32 s2, 0
    s_cbranch_scc1 L_recurrent_scan__compressed_kv_cla__moe_arch_mod__prompt_kernel_rare_1
L_recurrent_scan__compressed_kv_cla__moe_arch_mod__prompt_kernel_back_2:
    s_add_u32 m0, s33, 0
    s_add_u32 s36, s31, 131072
    buffer_load_dwordx4 v2, s[4:7], s31 offen offset:0 lds
    buffer_load_dwordx4 v3, s[4:7], s31 offen offset:1024 lds
    buffer_load_dwordx4 v4, s[4:7], s31 offen offset:2048 lds
    buffer_load_dwordx4 v5, s[4:7], s31 offen offset:3072 lds
    s_add_u32 m0, s34, 0
    s_nop 0
    buffer_load_dwordx4 v6, s[8:11], s32 offen offset:0 nt lds
    buffer_load_dwordx4 v7, s[8:11], s32 offen offset:1024 nt lds
    buffer_load_dwordx4 v8, s[8:11], s32 offen offset:2048 nt lds
    buffer_load_dwordx4 v9, s[8:11], s32 offen offset:3072 nt lds
    s_add_u32 m0, s33, 16384
    s_nop 0
    buffer_load_dwordx4 v2, s[4:7], s36 offen offset:0 lds
    buffer_load_dwordx4 v3, s[4:7], s36 offen offset:1024 lds
    buffer_load_dwordx4 v4, s[4:7], s36 offen offset:2048 lds
    buffer_load_dwordx4 v5, s[4:7], s36 offen offset:3072 lds
    s_add_u32 m0, s34, 16384
    s_nop 0
    buffer_load_dwordx4 v6, s[20:23], s32 offen offset:0 nt lds
    buffer_load_dwordx4 v7, s[20:23], s32 offen offset:1024 nt lds
    buffer_load_dwordx4 v8, s[20:23], s32 offen offset:2048 nt lds
    buffer_load_dwordx4 v9, s[20:23], s32 offen offset:3072 nt lds
    s_add_u32 s31, s31, s40
    s_add_u32 s32, s32, s41
L_pro_s:
    s_add_u32 s54, s90, 0
    s_addc_u32 s55, s91, 0
    s_add_u32 s12, s54, 8388608
    s_addc_u32 s13, s55, 0
    s_and_b32 s13, s13, 0xffff
    s_mov_b32 s14, 33554432
    s_mov_b32 s15, 0x20000
    s_mov_b32 s24, s54
    s_and_b32 s25, s55, 0xffff
    s_mov_b32 s26, 83886080
    s_mov_b32 s27, 0x20000
    s_add_u32 s90, s54, 61865984
    s_addc_u32 s91, s55, 0
    v_and_b32 v16, 15, v1
    v_lshrrev_b32 v17, 4, v1
    s_bfe_u32 s36, s28, 0x10001
    s_lshl_b32 s36, s36, 14
    v_lshl_add_u32 v18, v16, 7, s36
    v_lshrrev_b32 v19, 1, v16
    v_xor_b32 v19, v19, v17
    v_lshl_add_u32 v10, v19, 4, v18
    v_xor_b32 v19, 4, v19
    v_lshl_add_u32 v11, v19, 4, v18
    v_lshrrev_b32 v16, 2, v16
    v_lshl_add_u32 v18, v17, 3, v16
    v_lshlrev_b32 v18, 8, v18
    s_lshr_b32 s36, s28, 2
    s_lshl_b32 s36, s36, 14
    s_add_u32 s36, s36, 65536
    v_add_u32 v18, s36, v18
    v_and_b32 v19, 3, v1
    v_lshl_add_u32 v18, v19, 3, v18
    v_and_b32 v17, 1, v17
    v_lshl_add_u32 v16, v17, 2, v16
    s_and_b32 s36, s28, 1
    s_lshl_b32 s36, s36, 2
    s_add_u32 s37, s36, 0
    v_xor_b32 v19, s37, v16
    v_lshl_add_u32 v12, v19, 5, v18
    s_add_u32 s37, s36, 1
    v_xor_b32 v19, s37, v16
    v_lshl_add_u32 v13, v19, 5, v18
    s_add_u32 s37, s36, 2
    v_xor_b32 v19, s37, v16
    v_lshl_add_u32 v14, v19, 5, v18
    s_add_u32 s37, s36, 3
    v_xor_b32 v19, s37, v16
    v_lshl_add_u32 v15, v19, 5, v18
    v_mov_b64 v[128:129], 0
    v_mov_b64 v[130:131], 0
    v_mov_b64 v[132:133], 0
    v_mov_b64 v[134:135], 0
    v_mov_b64 v[136:137], 0
    v_mov_b64 v[138:139], 0
    v_mov_b64 v[140:141], 0
    v_mov_b64 v[142:143], 0
    v_mov_b64 v[144:145], 0
    v_mov_b64 v[146:147], 0
    v_mov_b64 v[148:149], 0
    v_mov_b64 v[150:151], 0
    v_mov_b64 v[152:153], 0
    v_mov_b64 v[154:155], 0
    v_mov_b64 v[156:157], 0
    v_mov_b64 v[158:159], 0
    v_mov_b64 v[160:161], 0
    v_mov_b64 v[162:163], 0
    v_mov_b64 v[164:165], 0
    v_mov_b64 v[166:167], 0
    v_mov_b64 v[168:169], 0
    v_mov_b64 v[170:171], 0
    v_mov_b64 v[172:173], 0
    v_mov_b64 v[174:175], 0
    v_mov_b64 v[176:177], 0
    v_mov_b64 v[178:179], 0
    v_mov_b64 v[180:181], 0
    v_mov_b64 v[182:183], 0
    v_mov_b64 v[184:185], 0
    v_mov_b64 v[186:187], 0
    v_mov_b64 v[188:189], 0
    v_mov_b64 v[190:191], 0
    v_mov_b64 v[192:193], 0
    v_mov_b64 v[194:195], 0
    v_mov_b64 v[196:197], 0
    v_mov_b64 v[198:199], 0
    v_mov_b64 v[200:201], 0
    v_mov_b64 v[202:203], 0
    v_mov_b64 v[204:205], 0
    v_mov_b64 v[206:207], 0
    v_mov_b64 v[208:209], 0
    v_mov_b64 v[210:211], 0
    v_mov_b64 v[212:213], 0
    v_mov_b64 v[214:215], 0
    v_mov_b64 v[216:217], 0
    v_mov_b64 v[218:219], 0
    v_mov_b64 v[220:221], 0
    v_mov_b64 v[222:223], 0
    v_mov_b64 v[224:225], 0
    v_mov_b64 v[226:227], 0
    v_mov_b64 v[228:229], 0
    v_mov_b64 v[230:231], 0
    v_mov_b64 v[232:233], 0
    v_mov_b64 v[234:235], 0
    v_mov_b64 v[236:237], 0
    v_mov_b64 v[238:239], 0
    v_mov_b64 v[240:241], 0
    v_mov_b64 v[242:243], 0
    v_mov_b64 v[244:245], 0
    v_mov_b64 v[246:247], 0
    v_mov_b64 v[248:249], 0
    v_mov_b64 v[250:251], 0
    v_mov_b64 v[252:253], 0
    v_mov_b64 v[254:255], 0
    v_mov_b32 v118, 0
    v_mov_b32 v117, 0
    s_lshl_b32 s36, s30, 7
    s_lshl_b32 s37, s28, 4
    s_add_u32 s36, s36, s37
    v_bfe_u32 v17, v1, 1, 4
    v_add_u32 v17, s36, v17
    v_lshlrev_b32 v17, 13, v17
    v_and_b32 v19, 1, v1
    v_lshl_add_u32 v17, v19, 7, v17
    s_lshl_b32 s36, s29, 8
    v_add_u32 v17, s36, v17
    s_mov_b32 s45, 32768
    s_cmp_lt_u32 s28, 4
    s_cbranch_scc0 L_pro_b
    s_add_u32 m0, s33, 32768
    s_add_u32 s36, s31, 131072
    buffer_load_dwordx4 v2, s[4:7], s31 offen offset:0 lds
    buffer_load_dwordx4 v3, s[4:7], s31 offen offset:1024 lds
    buffer_load_dwordx4 v4, s[4:7], s31 offen offset:2048 lds
    buffer_load_dwordx4 v5, s[4:7], s31 offen offset:3072 lds
    s_add_u32 m0, s34, 32768
    s_nop 0
    buffer_load_dwordx4 v6, s[8:11], s32 offen offset:0 nt lds
    buffer_load_dwordx4 v7, s[8:11], s32 offen offset:1024 nt lds
    buffer_load_dwordx4 v8, s[8:11], s32 offen offset:2048 nt lds
    buffer_load_dwordx4 v9, s[8:11], s32 offen offset:3072 nt lds
    s_add_u32 m0, s33, 49152
    s_nop 0
    buffer_load_dwordx4 v2, s[4:7], s36 offen offset:0 lds
    buffer_load_dwordx4 v3, s[4:7], s36 offen offset:1024 lds
    buffer_load_dwordx4 v4, s[4:7], s36 offen offset:2048 lds
    buffer_load_dwordx4 v5, s[4:7], s36 offen offset:3072 lds
    s_add_u32 m0, s34, 49152
    s_nop 0
    buffer_load_dwordx4 v6, s[20:23], s32 offen offset:0 nt lds
    buffer_load_dwordx4 v7, s[20:23], s32 offen offset:1024 nt lds
    buffer_load_dwordx4 v8, s[20:23], s32 offen offset:2048 nt lds
    buffer_load_dwordx4 v9, s[20:23], s32 offen offset:3072 nt lds
    s_add_u32 s31, s31, s40
    s_add_u32 s32, s32, s41
    s_waitcnt vmcnt(16)
    s_branch L_pro_j
L_pro_b:
    s_mov_b64 s[8:9], s[20:21]
    s_mov_b32 s31, 256
    s_mov_b32 s32, 1048576
    s_and_b32 s60, s28, 3
    s_waitcnt vmcnt(0)
    s_mov_b32 s3, 0
L_ln:
    v_lshlrev_b32 v44, 16, v36
    v_and_b32 v45, 0xffff0000, v36
    v_lshlrev_b32 v46, 16, v37
    v_and_b32 v47, 0xffff0000, v37
    v_lshlrev_b32 v48, 16, v38
    v_and_b32 v49, 0xffff0000, v38
    v_lshlrev_b32 v50, 16, v39
    v_and_b32 v51, 0xffff0000, v39
    v_lshlrev_b32 v52, 16, v40
    v_and_b32 v53, 0xffff0000, v40
    v_lshlrev_b32 v54, 16, v41
    v_and_b32 v55, 0xffff0000, v41
    v_lshlrev_b32 v56, 16, v42
    v_and_b32 v57, 0xffff0000, v42
    v_lshlrev_b32 v58, 16, v43
    v_and_b32 v59, 0xffff0000, v43
    v_lshlrev_b32 v60, 16, v20
    v_lshlrev_b32 v76, 16, v28
    v_and_b32 v61, 0xffff0000, v20
    v_and_b32 v77, 0xffff0000, v28
    v_lshlrev_b32 v62, 16, v21
    v_lshlrev_b32 v78, 16, v29
    v_and_b32 v63, 0xffff0000, v21
    v_and_b32 v79, 0xffff0000, v29
    v_lshlrev_b32 v64, 16, v22
    v_lshlrev_b32 v80, 16, v30
    v_and_b32 v65, 0xffff0000, v22
    v_and_b32 v81, 0xffff0000, v30
    v_lshlrev_b32 v66, 16, v23
    v_lshlrev_b32 v82, 16, v31
    v_and_b32 v67, 0xffff0000, v23
    v_and_b32 v83, 0xffff0000, v31
    v_lshlrev_b32 v68, 16, v24
    v_lshlrev_b32 v84, 16, v32
    v_and_b32 v69, 0xffff0000, v24
    v_and_b32 v85, 0xffff0000, v32
    v_lshlrev_b32 v70, 16, v25
    v_lshlrev_b32 v86, 16, v33
    v_and_b32 v71, 0xffff0000, v25
    v_and_b32 v87, 0xffff0000, v33
    v_lshlrev_b32 v72, 16, v26
    v_lshlrev_b32 v88, 16, v34
    v_and_b32 v73, 0xffff0000, v26
    v_and_b32 v89, 0xffff0000, v34
    v_lshlrev_b32 v74, 16, v27
    v_lshlrev_b32 v90, 16, v35
    v_and_b32 v75, 0xffff0000, v27
    v_and_b32 v91, 0xffff0000, v35
    v_pk_add_f32 v[92:93], v[60:61], v[62:63]
    v_pk_add_f32 v[100:101], v[76:77], v[78:79]
    v_pk_add_f32 v[92:93], v[92:93], v[64:65]
    v_pk_add_f32 v[100:101], v[100:101], v[80:81]
    v_pk_add_f32 v[92:93], v[92:93], v[66:67]
    v_pk_add_f32 v[100:101], v[100:101], v[82:83]
    v_pk_add_f32 v[92:93], v[92:93], v[68:69]
    v_pk_add_f32 v[100:101], v[100:101], v[84:85]
    v_pk_add_f32 v[92:93], v[92:93], v[70:71]
    v_pk_add_f32 v[100:101], v[100:101], v[86:87]
    v_pk_add_f32 v[92:93], v[92:93], v[72:73]
    v_pk_add_f32 v[100:101], v[100:101], v[88:89]
    v_pk_add_f32 v[92:93], v[92:93], v[74:75]
    v_pk_add_f32 v[100:101], v[100:101], v[90:91]
    v_add_f32 v92, v92, v93
    v_add_f32 v100, v100, v101
    s_nop 0
    v_add_f32_dpp v92, v92, v92 quad_perm:[1,0,3,2] row_mask:0xf bank_mask:0xf
    v_add_f32_dpp v100, v100, v100 quad_perm:[1,0,3,2] row_mask:0xf bank_mask:0xf
    s_nop 0
    v_add_f32_dpp v92, v92, v92 quad_perm:[2,3,0,1] row_mask:0xf bank_mask:0xf
    v_add_f32_dpp v100, v100, v100 quad_perm:[2,3,0,1] row_mask:0xf bank_mask:0xf
    s_nop 0
    v_add_f32_dpp v92, v92, v92 row_half_mirror row_mask:0xf bank_mask:0xf
    v_add_f32_dpp v100, v100, v100 row_half_mirror row_mask:0xf bank_mask:0xf
    s_nop 0
    v_add_f32_dpp v92, v92, v92 row_mirror row_mask:0xf bank_mask:0xf
    v_add_f32_dpp v100, v100, v100 row_mirror row_mask:0xf bank_mask:0xf
    v_readlane_b32 s36, v92, 0
    v_readlane_b32 s56, v100, 0
    v_readlane_b32 s37, v92, 16
    v_readlane_b32 s57, v100, 16
    v_readlane_b32 s38, v92, 32
    v_readlane_b32 s58, v100, 32
    v_readlane_b32 s39, v92, 48
    v_readlane_b32 s59, v100, 48
    v_mov_b32 v96, s36
    v_mov_b32 v104, s56
    v_add_f32 v96, s37, v96
    v_add_f32 v104, s57, v104
    v_add_f32 v96, s38, v96
    v_add_f32 v104, s58, v104
    v_add_f32 v96, s39, v96
    v_add_f32 v104, s59, v104
    v_mul_f32 v96, 0xba800000, v96
    v_mul_f32 v104, 0xba800000, v104
    v_mov_b32 v97, v96
    v_mov_b32 v105, v104
    v_pk_add_f32 v[94:95], v[60:61], v[96:97]
    v_pk_add_f32 v[102:103], v[76:77], v[104:105]
    v_pk_mul_f32 v[92:93], v[94:95], v[94:95]
    v_pk_mul_f32 v[100:101], v[102:103], v[102:103]
    v_pk_add_f32 v[94:95], v[62:63], v[96:97]
    v_pk_add_f32 v[102:103], v[78:79], v[104:105]
    v_pk_fma_f32 v[92:93], v[94:95], v[94:95], v[92:93]
    v_pk_fma_f32 v[100:101], v[102:103], v[102:103], v[100:101]
    v_pk_add_f32 v[94:95], v[64:65], v[96:97]
    v_pk_add_f32 v[102:103], v[80:81], v[104:105]
    v_pk_fma_f32 v[92:93], v[94:95], v[94:95], v[92:93]
    v_pk_fma_f32 v[100:101], v[102:103], v[102:103], v[100:101]
    v_pk_add_f32 v[94:95], v[66:67], v[96:97]
    v_pk_add_f32 v[102:103], v[82:83], v[104:105]
    v_pk_fma_f32 v[92:93], v[94:95], v[94:95], v[92:93]
    v_pk_fma_f32 v[100:101], v[102:103], v[102:103], v[100:101]
    v_pk_add_f32 v[94:95], v[68:69], v[96:97]
    v_pk_add_f32 v[102:103], v[84:85], v[104:105]
    v_pk_fma_f32 v[92:93], v[94:95], v[94:95], v[92:93]
    v_pk_fma_f32 v[100:101], v[102:103], v[102:103], v[100:101]
    v_pk_add_f32 v[94:95], v[70:71], v[96:97]
    v_pk_add_f32 v[102:103], v[86:87], v[104:105]
    v_pk_fma_f32 v[92:93], v[94:95], v[94:95], v[92:93]
    v_pk_fma_f32 v[100:101], v[102:103], v[102:103], v[100:101]
    v_pk_add_f32 v[94:95], v[72:73], v[96:97]
    v_pk_add_f32 v[102:103], v[88:89], v[104:105]
    v_pk_fma_f32 v[92:93], v[94:95], v[94:95], v[92:93]
    v_pk_fma_f32 v[100:101], v[102:103], v[102:103], v[100:101]
    v_pk_add_f32 v[94:95], v[74:75], v[96:97]
    v_pk_add_f32 v[102:103], v[90:91], v[104:105]
    v_pk_fma_f32 v[92:93], v[94:95], v[94:95], v[92:93]
    v_pk_fma_f32 v[100:101], v[102:103], v[102:103], v[100:101]
    v_add_f32 v92, v92, v93
    v_add_f32 v100, v100, v101
    s_nop 0
    v_add_f32_dpp v92, v92, v92 quad_perm:[1,0,3,2] row_mask:0xf bank_mask:0xf
    v_add_f32_dpp v100, v100, v100 quad_perm:[1,0,3,2] row_mask:0xf bank_mask:0xf
    s_nop 0
    v_add_f32_dpp v92, v92, v92 quad_perm:[2,3,0,1] row_mask:0xf bank_mask:0xf
    v_add_f32_dpp v100, v100, v100 quad_perm:[2,3,0,1] row_mask:0xf bank_mask:0xf
    s_nop 0
    v_add_f32_dpp v92, v92, v92 row_half_mirror row_mask:0xf bank_mask:0xf
    v_add_f32_dpp v100, v100, v100 row_half_mirror row_mask:0xf bank_mask:0xf
    s_nop 0
    v_add_f32_dpp v92, v92, v92 row_mirror row_mask:0xf bank_mask:0xf
    v_add_f32_dpp v100, v100, v100 row_mirror row_mask:0xf bank_mask:0xf
    v_readlane_b32 s36, v92, 0
    v_readlane_b32 s56, v100, 0
    v_readlane_b32 s37, v92, 16
    v_readlane_b32 s57, v100, 16
    v_readlane_b32 s38, v92, 32
    v_readlane_b32 s58, v100, 32
    v_readlane_b32 s39, v92, 48
    v_readlane_b32 s59, v100, 48
    v_mov_b32 v94, s36
    v_mov_b32 v102, s56
    v_add_f32 v94, s37, v94
    v_add_f32 v102, s57, v102
    v_add_f32 v94, s38, v94
    v_add_f32 v102, s58, v102
    v_add_f32 v94, s39, v94
    v_add_f32 v102, s59, v102
    v_mul_f32 v94, 0x3a800000, v94
    v_mul_f32 v102, 0x3a800000, v102
    v_cvt_pk_bf16_f32 v95, v96, v94
    v_cvt_pk_bf16_f32 v103, v104, v102
    v_lshlrev_b32 v96, 16, v95
    v_lshlrev_b32 v104, 16, v103
    v_and_b32 v94, 0xffff0000, v95
    v_and_b32 v102, 0xffff0000, v103
    v_add_f32 v94, 0x3727c5ac, v94
    v_add_f32 v102, 0x3727c5ac, v102
    v_cvt_pk_bf16_f32 v94, v94, v94
    v_cvt_pk_bf16_f32 v102, v102, v102
    v_lshlrev_b32 v94, 16, v94
    v_lshlrev_b32 v102, 16, v102
    v_sqrt_f32 v94, v94
    v_sqrt_f32 v102, v102
    v_mov_b32 v97, v96
    v_mov_b32 v105, v104
    v_cvt_pk_bf16_f32 v94, v94, v94
    v_cvt_pk_bf16_f32 v102, v102, v102
    v_lshlrev_b32 v94, 16, v94
    v_lshlrev_b32 v102, 16, v102
    v_rcp_f32 v99, v94
    v_rcp_f32 v107, v102
    v_fma_f32 v95, -v94, v99, 1.0
    v_fma_f32 v103, -v102, v107, 1.0
    v_fma_f32 v99, v95, v99, v99
    v_fma_f32 v107, v103, v107, v107
    v_mov_b32 v98, v99
    v_mov_b32 v106, v107
    v_pk_add_f32 v[60:61], v[60:61], v[96:97]
    v_pk_add_f32 v[76:77], v[76:77], v[104:105]
    v_cvt_pk_bf16_f32 v94, v60, v61
    v_cvt_pk_bf16_f32 v102, v76, v77
    v_lshlrev_b32 v60, 16, v94
    v_lshlrev_b32 v76, 16, v102
    v_and_b32 v61, 0xffff0000, v94
    v_and_b32 v77, 0xffff0000, v102
    v_pk_mul_f32 v[60:61], v[60:61], v[98:99]
    v_pk_mul_f32 v[76:77], v[76:77], v[106:107]
    v_cvt_pk_bf16_f32 v108, v60, v61
    v_cvt_pk_bf16_f32 v120, v76, v77
    v_lshlrev_b32 v60, 16, v108
    v_lshlrev_b32 v76, 16, v120
    v_and_b32 v61, 0xffff0000, v108
    v_and_b32 v77, 0xffff0000, v120
    v_pk_mul_f32 v[92:93], v[60:61], v[44:45]
    v_pk_mul_f32 v[100:101], v[76:77], v[44:45]
    v_pk_add_f32 v[62:63], v[62:63], v[96:97]
    v_pk_add_f32 v[78:79], v[78:79], v[104:105]
    v_cvt_pk_bf16_f32 v94, v62, v63
    v_cvt_pk_bf16_f32 v102, v78, v79
    v_lshlrev_b32 v62, 16, v94
    v_lshlrev_b32 v78, 16, v102
    v_and_b32 v63, 0xffff0000, v94
    v_and_b32 v79, 0xffff0000, v102
    v_pk_mul_f32 v[62:63], v[62:63], v[98:99]
    v_pk_mul_f32 v[78:79], v[78:79], v[106:107]
    v_cvt_pk_bf16_f32 v109, v62, v63
    v_cvt_pk_bf16_f32 v121, v78, v79
    v_lshlrev_b32 v62, 16, v109
    v_lshlrev_b32 v78, 16, v121
    v_and_b32 v63, 0xffff0000, v109
    v_and_b32 v79, 0xffff0000, v121
    v_pk_fma_f32 v[92:93], v[62:63], v[46:47], v[92:93]
    v_pk_fma_f32 v[100:101], v[78:79], v[46:47], v[100:101]
    v_pk_add_f32 v[64:65], v[64:65], v[96:97]
    v_pk_add_f32 v[80:81], v[80:81], v[104:105]
    v_cvt_pk_bf16_f32 v94, v64, v65
    v_cvt_pk_bf16_f32 v102, v80, v81
    v_lshlrev_b32 v64, 16, v94
    v_lshlrev_b32 v80, 16, v102
    v_and_b32 v65, 0xffff0000, v94
    v_and_b32 v81, 0xffff0000, v102
    v_pk_mul_f32 v[64:65], v[64:65], v[98:99]
    v_pk_mul_f32 v[80:81], v[80:81], v[106:107]
    v_cvt_pk_bf16_f32 v110, v64, v65
    v_cvt_pk_bf16_f32 v122, v80, v81
    v_lshlrev_b32 v64, 16, v110
    v_lshlrev_b32 v80, 16, v122
    v_and_b32 v65, 0xffff0000, v110
    v_and_b32 v81, 0xffff0000, v122
    v_pk_fma_f32 v[92:93], v[64:65], v[48:49], v[92:93]
    v_pk_fma_f32 v[100:101], v[80:81], v[48:49], v[100:101]
    v_pk_add_f32 v[66:67], v[66:67], v[96:97]
    v_pk_add_f32 v[82:83], v[82:83], v[104:105]
    v_cvt_pk_bf16_f32 v94, v66, v67
    v_cvt_pk_bf16_f32 v102, v82, v83
    v_lshlrev_b32 v66, 16, v94
    v_lshlrev_b32 v82, 16, v102
    v_and_b32 v67, 0xffff0000, v94
    v_and_b32 v83, 0xffff0000, v102
    v_pk_mul_f32 v[66:67], v[66:67], v[98:99]
    v_pk_mul_f32 v[82:83], v[82:83], v[106:107]
    v_cvt_pk_bf16_f32 v111, v66, v67
    v_cvt_pk_bf16_f32 v123, v82, v83
    v_lshlrev_b32 v66, 16, v111
    v_lshlrev_b32 v82, 16, v123
    v_and_b32 v67, 0xffff0000, v111
    v_and_b32 v83, 0xffff0000, v123
    v_pk_fma_f32 v[92:93], v[66:67], v[50:51], v[92:93]
    v_pk_fma_f32 v[100:101], v[82:83], v[50:51], v[100:101]
    v_pk_add_f32 v[68:69], v[68:69], v[96:97]
    v_pk_add_f32 v[84:85], v[84:85], v[104:105]
    v_cvt_pk_bf16_f32 v94, v68, v69
    v_cvt_pk_bf16_f32 v102, v84, v85
    v_lshlrev_b32 v68, 16, v94
    v_lshlrev_b32 v84, 16, v102
    v_and_b32 v69, 0xffff0000, v94
    v_and_b32 v85, 0xffff0000, v102
    v_pk_mul_f32 v[68:69], v[68:69], v[98:99]
    v_pk_mul_f32 v[84:85], v[84:85], v[106:107]
    v_cvt_pk_bf16_f32 v112, v68, v69
    v_cvt_pk_bf16_f32 v124, v84, v85
    v_lshlrev_b32 v68, 16, v112
    v_lshlrev_b32 v84, 16, v124
    v_and_b32 v69, 0xffff0000, v112
    v_and_b32 v85, 0xffff0000, v124
    v_pk_fma_f32 v[92:93], v[68:69], v[52:53], v[92:93]
    v_pk_fma_f32 v[100:101], v[84:85], v[52:53], v[100:101]
    v_pk_add_f32 v[70:71], v[70:71], v[96:97]
    v_pk_add_f32 v[86:87], v[86:87], v[104:105]
    v_cvt_pk_bf16_f32 v94, v70, v71
    v_cvt_pk_bf16_f32 v102, v86, v87
    v_lshlrev_b32 v70, 16, v94
    v_lshlrev_b32 v86, 16, v102
    v_and_b32 v71, 0xffff0000, v94
    v_and_b32 v87, 0xffff0000, v102
    v_pk_mul_f32 v[70:71], v[70:71], v[98:99]
    v_pk_mul_f32 v[86:87], v[86:87], v[106:107]
    v_cvt_pk_bf16_f32 v113, v70, v71
    v_cvt_pk_bf16_f32 v125, v86, v87
    v_lshlrev_b32 v70, 16, v113
    v_lshlrev_b32 v86, 16, v125
    v_and_b32 v71, 0xffff0000, v113
    v_and_b32 v87, 0xffff0000, v125
    v_pk_fma_f32 v[92:93], v[70:71], v[54:55], v[92:93]
    v_pk_fma_f32 v[100:101], v[86:87], v[54:55], v[100:101]
    v_pk_add_f32 v[72:73], v[72:73], v[96:97]
    v_pk_add_f32 v[88:89], v[88:89], v[104:105]
    v_cvt_pk_bf16_f32 v94, v72, v73
    v_cvt_pk_bf16_f32 v102, v88, v89
    v_lshlrev_b32 v72, 16, v94
    v_lshlrev_b32 v88, 16, v102
    v_and_b32 v73, 0xffff0000, v94
    v_and_b32 v89, 0xffff0000, v102
    v_pk_mul_f32 v[72:73], v[72:73], v[98:99]
    v_pk_mul_f32 v[88:89], v[88:89], v[106:107]
    v_cvt_pk_bf16_f32 v114, v72, v73
    v_cvt_pk_bf16_f32 v126, v88, v89
    v_lshlrev_b32 v72, 16, v114
    v_lshlrev_b32 v88, 16, v126
    v_and_b32 v73, 0xffff0000, v114
    v_and_b32 v89, 0xffff0000, v126
    v_pk_fma_f32 v[92:93], v[72:73], v[56:57], v[92:93]
    v_pk_fma_f32 v[100:101], v[88:89], v[56:57], v[100:101]
    v_pk_add_f32 v[74:75], v[74:75], v[96:97]
    v_pk_add_f32 v[90:91], v[90:91], v[104:105]
    v_cvt_pk_bf16_f32 v94, v74, v75
    v_cvt_pk_bf16_f32 v102, v90, v91
    v_lshlrev_b32 v74, 16, v94
    v_lshlrev_b32 v90, 16, v102
    v_and_b32 v75, 0xffff0000, v94
    v_and_b32 v91, 0xffff0000, v102
    v_pk_mul_f32 v[74:75], v[74:75], v[98:99]
    v_pk_mul_f32 v[90:91], v[90:91], v[106:107]
    v_cvt_pk_bf16_f32 v115, v74, v75
    v_cvt_pk_bf16_f32 v127, v90, v91
    v_lshlrev_b32 v74, 16, v115
    v_lshlrev_b32 v90, 16, v127
    v_and_b32 v75, 0xffff0000, v115
    v_and_b32 v91, 0xffff0000, v127
    v_pk_fma_f32 v[92:93], v[74:75], v[58:59], v[92:93]
    v_pk_fma_f32 v[100:101], v[90:91], v[58:59], v[100:101]
    v_add_f32 v92, v92, v93
    v_add_f32 v100, v100, v101
    v_xor_b32 v98, 0x80000000, v96
    v_xor_b32 v106, 0x80000000, v104
    s_mul_i32 s36, s60, 2064
    s_mul_i32 s56, s28, 2064
    s_add_u32 s36, s36, 131072
    s_add_u32 s56, s56, 131072
    v_lshl_add_u32 v95, v1, 4, s36
    v_lshl_add_u32 v103, v1, 4, s56
    ds_write_b128 v95, v[108:111]
    ds_write_b128 v103, v[120:123]
    ds_write_b128 v95, v[112:115] offset:1024
    ds_write_b128 v103, v[124:127] offset:1024
    s_nop 0
    v_add_f32_dpp v92, v92, v92 quad_perm:[1,0,3,2] row_mask:0xf bank_mask:0xf
    v_add_f32_dpp v100, v100, v100 quad_perm:[1,0,3,2] row_mask:0xf bank_mask:0xf
    s_nop 0
    v_add_f32_dpp v92, v92, v92 quad_perm:[2,3,0,1] row_mask:0xf bank_mask:0xf
    v_add_f32_dpp v100, v100, v100 quad_perm:[2,3,0,1] row_mask:0xf bank_mask:0xf
    s_nop 0
    v_add_f32_dpp v92, v92, v92 row_half_mirror row_mask:0xf bank_mask:0xf
    v_add_f32_dpp v100, v100, v100 row_half_mirror row_mask:0xf bank_mask:0xf
    s_nop 0
    v_add_f32_dpp v92, v92, v92 row_mirror row_mask:0xf bank_mask:0xf
    v_add_f32_dpp v100, v100, v100 row_mirror row_mask:0xf bank_mask:0xf
    v_readlane_b32 s36, v92, 0
    v_readlane_b32 s56, v100, 0
    v_readlane_b32 s37, v92, 16
    v_readlane_b32 s57, v100, 16
    v_readlane_b32 s38, v92, 32
    v_readlane_b32 s58, v100, 32
    v_readlane_b32 s39, v92, 48
    v_readlane_b32 s59, v100, 48
    v_mov_b32 v93, s36
    v_mov_b32 v101, s56
    v_add_f32 v93, s37, v93
    v_add_f32 v101, s57, v101
    v_add_f32 v93, s38, v93
    v_add_f32 v101, s58, v101
    v_add_f32 v93, s39, v93
    v_add_f32 v101, s59, v101
    v_cvt_pk_bf16_f32 v93, v93, v93
    v_cvt_pk_bf16_f32 v101, v101, v101
    v_lshlrev_b32 v93, 16, v93
    v_lshlrev_b32 v101, 16, v101
    v_ashrrev_i32 v95, 31, v93
    v_ashrrev_i32 v103, 31, v101
    v_or_b32 v95, 0x80000000, v95
    v_or_b32 v103, 0x80000000, v103
    v_xor_b32 v95, v93, v95
    v_xor_b32 v103, v101, v103
    v_and_b32 v95, 0xffff0000, v95
    v_and_b32 v103, 0xffff0000, v103
    s_sub_u32 s36, 0xffff, s42
    s_sub_u32 s56, 0xffff, s43
    v_or_b32 v95, s36, v95
    v_or_b32 v103, s56, v103
    s_lshl_b32 s37, s60, 3
    s_lshl_b32 s57, s28, 3
    s_add_u32 s37, s37, 147712
    s_add_u32 s57, s57, 147712
    v_mov_b32 v94, s37
    v_mov_b32 v102, s57
    ds_write_b64 v94, v[98:99]
    ds_write_b64 v102, v[106:107]
    ds_write_b32 v94, v95 offset:64
    ds_write_b32 v102, v103 offset:64
    s_waitcnt vmcnt(0) lgkmcnt(0)
    s_cmp_eq_u32 s3, 0
    s_mov_b32 s3, 0
    s_cbranch_scc0 L_ln
L_pro_j:
    s_barrier
    ds_read_b128 v[20:23], v10 offset:0
    ds_read_b64_tr_b16 v[52:53], v12 offset:0
    ds_read_b64_tr_b16 v[54:55], v12 offset:1024
    ds_read_b64_tr_b16 v[56:57], v13 offset:0
    ds_read_b64_tr_b16 v[58:59], v13 offset:1024
    ds_read_b64_tr_b16 v[60:61], v14 offset:0
    ds_read_b64_tr_b16 v[62:63], v14 offset:1024
    ds_read_b64_tr_b16 v[64:65], v15 offset:0
    ds_read_b64_tr_b16 v[66:67], v15 offset:1024
    ds_read_b128 v[24:27], v10 offset:2048
    ds_read_b128 v[28:31], v10 offset:4096
    ds_read_b128 v[32:35], v10 offset:6144
    ds_read_b128 v[36:39], v10 offset:8192
    ds_read_b128 v[40:43], v10 offset:10240
    ds_read_b128 v[44:47], v10 offset:12288
    ds_read_b128 v[48:51], v10 offset:14336
    s_add_u32 s36, s2, s28
    s_cmp_eq_u32 s36, 0
    s_cbranch_scc1 L_recurrent_scan__compressed_kv_cla__moe_arch_mod__prompt_kernel_rare_3
L_recurrent_scan__compressed_kv_cla__moe_arch_mod__prompt_kernel_back_4:
    s_mov_b32 s35, 0
    s_cmp_eq_u32 s28, 0
    s_cselect_b32 s43, 9, 0
    s_cselect_b32 s44, 2, 1
    s_cmp_lt_u32 s28, 4
    s_cbranch_scc0 L_kv_vloop
    .p2align 6
L_kv_kloop:
    s_waitcnt lgkmcnt(0)
    v_mfma_f32_16x16x32_bf16 v[128:131], v[52:55], v[20:23], v[128:131]
    ds_read_b128 v[68:71], v11 offset:0
    v_mfma_f32_16x16x32_bf16 v[132:135], v[56:59], v[20:23], v[132:135]
    ds_read_b64_tr_b16 v[100:101], v12 offset:8192
    v_mfma_f32_16x16x32_bf16 v[136:139], v[60:63], v[20:23], v[136:139]
    ds_read_b64_tr_b16 v[102:103], v12 offset:9216
    v_mfma_f32_16x16x32_bf16 v[140:143], v[64:67], v[20:23], v[140:143]
    ds_read_b64_tr_b16 v[104:105], v13 offset:8192
    v_mfma_f32_16x16x32_bf16 v[144:147], v[52:55], v[24:27], v[144:147]
    ds_read_b64_tr_b16 v[106:107], v13 offset:9216
    v_mfma_f32_16x16x32_bf16 v[148:151], v[56:59], v[24:27], v[148:151]
    ds_read_b64_tr_b16 v[108:109], v14 offset:8192
    v_mfma_f32_16x16x32_bf16 v[152:155], v[60:63], v[24:27], v[152:155]
    ds_read_b64_tr_b16 v[110:111], v14 offset:9216
    v_mfma_f32_16x16x32_bf16 v[156:159], v[64:67], v[24:27], v[156:159]
    ds_read_b64_tr_b16 v[112:113], v15 offset:8192
    v_mfma_f32_16x16x32_bf16 v[160:163], v[52:55], v[28:31], v[160:163]
    ds_read_b64_tr_b16 v[114:115], v15 offset:9216
    v_mfma_f32_16x16x32_bf16 v[164:167], v[56:59], v[28:31], v[164:167]
    ds_read_b128 v[72:75], v11 offset:2048
    v_mfma_f32_16x16x32_bf16 v[168:171], v[60:63], v[28:31], v[168:171]
    ds_read_b128 v[76:79], v11 offset:4096
    v_mfma_f32_16x16x32_bf16 v[172:175], v[64:67], v[28:31], v[172:175]
    ds_read_b128 v[80:83], v11 offset:6144
    v_mfma_f32_16x16x32_bf16 v[176:179], v[52:55], v[32:35], v[176:179]
    ds_read_b128 v[84:87], v11 offset:8192
    v_mfma_f32_16x16x32_bf16 v[180:183], v[56:59], v[32:35], v[180:183]
    ds_read_b128 v[88:91], v11 offset:10240
    v_mfma_f32_16x16x32_bf16 v[184:187], v[60:63], v[32:35], v[184:187]
    ds_read_b128 v[92:95], v11 offset:12288
    v_mfma_f32_16x16x32_bf16 v[188:191], v[64:67], v[32:35], v[188:191]
    ds_read_b128 v[96:99], v11 offset:14336
    v_mfma_f32_16x16x32_bf16 v[192:195], v[52:55], v[36:39], v[192:195]
    v_mfma_f32_16x16x32_bf16 v[196:199], v[56:59], v[36:39], v[196:199]
    v_mfma_f32_16x16x32_bf16 v[200:203], v[60:63], v[36:39], v[200:203]
    v_mfma_f32_16x16x32_bf16 v[204:207], v[64:67], v[36:39], v[204:207]
    v_mfma_f32_16x16x32_bf16 v[208:211], v[52:55], v[40:43], v[208:211]
    v_mfma_f32_16x16x32_bf16 v[212:215], v[56:59], v[40:43], v[212:215]
    v_mfma_f32_16x16x32_bf16 v[216:219], v[60:63], v[40:43], v[216:219]
    v_mfma_f32_16x16x32_bf16 v[220:223], v[64:67], v[40:43], v[220:223]
    v_mfma_f32_16x16x32_bf16 v[224:227], v[52:55], v[44:47], v[224:227]
    v_mfma_f32_16x16x32_bf16 v[228:231], v[56:59], v[44:47], v[228:231]
    v_mfma_f32_16x16x32_bf16 v[232:235], v[60:63], v[44:47], v[232:235]
    v_mfma_f32_16x16x32_bf16 v[236:239], v[64:67], v[44:47], v[236:239]
    v_mfma_f32_16x16x32_bf16 v[240:243], v[52:55], v[48:51], v[240:243]
    v_mfma_f32_16x16x32_bf16 v[244:247], v[56:59], v[48:51], v[244:247]
    v_mfma_f32_16x16x32_bf16 v[248:251], v[60:63], v[48:51], v[248:251]
    v_mfma_f32_16x16x32_bf16 v[252:255], v[64:67], v[48:51], v[252:255]
    s_cmp_eq_u32 s35, 3
    s_cbranch_scc1 L_recurrent_scan__compressed_kv_cla__moe_arch_mod__prompt_kernel_rare_5
L_recurrent_scan__compressed_kv_cla__moe_arch_mod__prompt_kernel_back_6:
    s_cmp_lt_u32 s35, s44
    s_cbranch_scc1 L_recurrent_scan__compressed_kv_cla__moe_arch_mod__prompt_kernel_w0_7
    s_waitcnt vmcnt(1)
L_recurrent_scan__compressed_kv_cla__moe_arch_mod__prompt_kernel_w0b_8:
    s_waitcnt lgkmcnt(0)
    s_barrier
    v_mfma_f32_16x16x32_bf16 v[128:131], v[100:103], v[68:71], v[128:131]
    ds_read_b128 v[20:23], v10 offset:32768
    s_add_u32 m0, s33, 0
    v_mfma_f32_16x16x32_bf16 v[132:135], v[104:107], v[68:71], v[132:135]
    ds_read_b64_tr_b16 v[52:53], v12 offset:32768
    buffer_load_dwordx4 v2, s[4:7], s31 offen offset:0 lds
    v_mfma_f32_16x16x32_bf16 v[136:139], v[108:111], v[68:71], v[136:139]
    ds_read_b64_tr_b16 v[54:55], v12 offset:33792
    v_mfma_f32_16x16x32_bf16 v[140:143], v[112:115], v[68:71], v[140:143]
    ds_read_b64_tr_b16 v[56:57], v13 offset:32768
    v_mfma_f32_16x16x32_bf16 v[144:147], v[100:103], v[72:75], v[144:147]
    ds_read_b64_tr_b16 v[58:59], v13 offset:33792
    buffer_load_dwordx4 v3, s[4:7], s31 offen offset:1024 lds
    v_mfma_f32_16x16x32_bf16 v[148:151], v[104:107], v[72:75], v[148:151]
    ds_read_b64_tr_b16 v[60:61], v14 offset:32768
    v_mfma_f32_16x16x32_bf16 v[152:155], v[108:111], v[72:75], v[152:155]
    ds_read_b64_tr_b16 v[62:63], v14 offset:33792
    v_mfma_f32_16x16x32_bf16 v[156:159], v[112:115], v[72:75], v[156:159]
    ds_read_b64_tr_b16 v[64:65], v15 offset:32768
    buffer_load_dwordx4 v4, s[4:7], s31 offen offset:2048 lds
    v_mfma_f32_16x16x32_bf16 v[160:163], v[100:103], v[76:79], v[160:163]
    ds_read_b64_tr_b16 v[66:67], v15 offset:33792
    v_mfma_f32_16x16x32_bf16 v[164:167], v[104:107], v[76:79], v[164:167]
    ds_read_b128 v[24:27], v10 offset:34816
    v_mfma_f32_16x16x32_bf16 v[168:171], v[108:111], v[76:79], v[168:171]
    ds_read_b128 v[28:31], v10 offset:36864
    buffer_load_dwordx4 v5, s[4:7], s31 offen offset:3072 lds
    v_mfma_f32_16x16x32_bf16 v[172:175], v[112:115], v[76:79], v[172:175]
    ds_read_b128 v[32:35], v10 offset:38912
    v_mfma_f32_16x16x32_bf16 v[176:179], v[100:103], v[80:83], v[176:179]
    ds_read_b128 v[36:39], v10 offset:40960
    s_add_u32 m0, s34, 0
    v_mfma_f32_16x16x32_bf16 v[180:183], v[104:107], v[80:83], v[180:183]
    ds_read_b128 v[40:43], v10 offset:43008
    buffer_load_dwordx4 v6, s[8:11], s32 offen offset:0 nt lds
    v_mfma_f32_16x16x32_bf16 v[184:187], v[108:111], v[80:83], v[184:187]
    ds_read_b128 v[44:47], v10 offset:45056
    v_mfma_f32_16x16x32_bf16 v[188:191], v[112:115], v[80:83], v[188:191]
    ds_read_b128 v[48:51], v10 offset:47104
    v_mfma_f32_16x16x32_bf16 v[192:195], v[100:103], v[84:87], v[192:195]
    buffer_load_dwordx4 v7, s[8:11], s32 offen offset:1024 nt lds
    v_mfma_f32_16x16x32_bf16 v[196:199], v[104:107], v[84:87], v[196:199]
    v_mfma_f32_16x16x32_bf16 v[200:203], v[108:111], v[84:87], v[200:203]
    v_mfma_f32_16x16x32_bf16 v[204:207], v[112:115], v[84:87], v[204:207]
    buffer_load_dwordx4 v8, s[8:11], s32 offen offset:2048 nt lds
    v_mfma_f32_16x16x32_bf16 v[208:211], v[100:103], v[88:91], v[208:211]
    v_mfma_f32_16x16x32_bf16 v[212:215], v[104:107], v[88:91], v[212:215]
    v_mfma_f32_16x16x32_bf16 v[216:219], v[108:111], v[88:91], v[216:219]
    buffer_load_dwordx4 v9, s[8:11], s32 offen offset:3072 nt lds
    v_mfma_f32_16x16x32_bf16 v[220:223], v[112:115], v[88:91], v[220:223]
    v_mfma_f32_16x16x32_bf16 v[224:227], v[100:103], v[92:95], v[224:227]
    v_mfma_f32_16x16x32_bf16 v[228:231], v[104:107], v[92:95], v[228:231]
    v_mfma_f32_16x16x32_bf16 v[232:235], v[108:111], v[92:95], v[232:235]
    v_mfma_f32_16x16x32_bf16 v[236:239], v[112:115], v[92:95], v[236:239]
    v_mfma_f32_16x16x32_bf16 v[240:243], v[100:103], v[96:99], v[240:243]
    v_mfma_f32_16x16x32_bf16 v[244:247], v[104:107], v[96:99], v[244:247]
    v_mfma_f32_16x16x32_bf16 v[248:251], v[108:111], v[96:99], v[248:251]
    v_mfma_f32_16x16x32_bf16 v[252:255], v[112:115], v[96:99], v[252:255]
    s_bitcmp1_b32 3, s35
    s_cselect_b32 exec_lo, 255, 1
    s_mov_b32 exec_hi, 0
    global_load_dword v0, v17, s[96:97]
    s_mov_b64 exec, -1
    s_cselect_b32 s36, s45, 0
    v_add_u32 v17, s36, v17
    v_min_u32 v17, 8388480, v17
    s_nop 1
    s_add_u32 s31, s31, s40
    s_add_u32 s32, s32, s41
    s_waitcnt lgkmcnt(0)
    v_mfma_f32_16x16x32_bf16 v[128:131], v[52:55], v[20:23], v[128:131]
    ds_read_b128 v[68:71], v11 offset:32768
    v_mfma_f32_16x16x32_bf16 v[132:135], v[56:59], v[20:23], v[132:135]
    ds_read_b64_tr_b16 v[100:101], v12 offset:40960
    v_mfma_f32_16x16x32_bf16 v[136:139], v[60:63], v[20:23], v[136:139]
    ds_read_b64_tr_b16 v[102:103], v12 offset:41984
    v_mfma_f32_16x16x32_bf16 v[140:143], v[64:67], v[20:23], v[140:143]
    ds_read_b64_tr_b16 v[104:105], v13 offset:40960
    v_mfma_f32_16x16x32_bf16 v[144:147], v[52:55], v[24:27], v[144:147]
    ds_read_b64_tr_b16 v[106:107], v13 offset:41984
    v_mfma_f32_16x16x32_bf16 v[148:151], v[56:59], v[24:27], v[148:151]
    ds_read_b64_tr_b16 v[108:109], v14 offset:40960
    v_mfma_f32_16x16x32_bf16 v[152:155], v[60:63], v[24:27], v[152:155]
    ds_read_b64_tr_b16 v[110:111], v14 offset:41984
    v_mfma_f32_16x16x32_bf16 v[156:159], v[64:67], v[24:27], v[156:159]
    ds_read_b64_tr_b16 v[112:113], v15 offset:40960
    v_mfma_f32_16x16x32_bf16 v[160:163], v[52:55], v[28:31], v[160:163]
    ds_read_b64_tr_b16 v[114:115], v15 offset:41984
    v_mfma_f32_16x16x32_bf16 v[164:167], v[56:59], v[28:31], v[164:167]
    ds_read_b128 v[72:75], v11 offset:34816
    v_mfma_f32_16x16x32_bf16 v[168:171], v[60:63], v[28:31], v[168:171]
    ds_read_b128 v[76:79], v11 offset:36864
    v_mfma_f32_16x16x32_bf16 v[172:175], v[64:67], v[28:31], v[172:175]
    ds_read_b128 v[80:83], v11 offset:38912
    v_mfma_f32_16x16x32_bf16 v[176:179], v[52:55], v[32:35], v[176:179]
    ds_read_b128 v[84:87], v11 offset:40960
    v_mfma_f32_16x16x32_bf16 v[180:183], v[56:59], v[32:35], v[180:183]
    ds_read_b128 v[88:91], v11 offset:43008
    v_mfma_f32_16x16x32_bf16 v[184:187], v[60:63], v[32:35], v[184:187]
    ds_read_b128 v[92:95], v11 offset:45056
    v_mfma_f32_16x16x32_bf16 v[188:191], v[64:67], v[32:35], v[188:191]
    ds_read_b128 v[96:99], v11 offset:47104
    v_mfma_f32_16x16x32_bf16 v[192:195], v[52:55], v[36:39], v[192:195]
    v_mfma_f32_16x16x32_bf16 v[196:199], v[56:59], v[36:39], v[196:199]
    v_mfma_f32_16x16x32_bf16 v[200:203], v[60:63], v[36:39], v[200:203]
    v_mfma_f32_16x16x32_bf16 v[204:207], v[64:67], v[36:39], v[204:207]
    v_mfma_f32_16x16x32_bf16 v[208:211], v[52:55], v[40:43], v[208:211]
    s_bitcmp1_b32 s43, s35
    s_cbranch_scc1 L_recurrent_scan__compressed_kv_cla__moe_arch_mod__prompt_kernel_rare_13
L_recurrent_scan__compressed_kv_cla__moe_arch_mod__prompt_kernel_back_14:
    v_mfma_f32_16x16x32_bf16 v[212:215], v[56:59], v[40:43], v[212:215]
    v_mfma_f32_16x16x32_bf16 v[216:219], v[60:63], v[40:43], v[216:219]
    v_mfma_f32_16x16x32_bf16 v[220:223], v[64:67], v[40:43], v[220:223]
    v_mfma_f32_16x16x32_bf16 v[224:227], v[52:55], v[44:47], v[224:227]
    v_mfma_f32_16x16x32_bf16 v[228:231], v[56:59], v[44:47], v[228:231]
    v_mfma_f32_16x16x32_bf16 v[232:235], v[60:63], v[44:47], v[232:235]
    v_mfma_f32_16x16x32_bf16 v[236:239], v[64:67], v[44:47], v[236:239]
    v_mfma_f32_16x16x32_bf16 v[240:243], v[52:55], v[48:51], v[240:243]
    v_mfma_f32_16x16x32_bf16 v[244:247], v[56:59], v[48:51], v[244:247]
    v_mfma_f32_16x16x32_bf16 v[248:251], v[60:63], v[48:51], v[248:251]
    v_mfma_f32_16x16x32_bf16 v[252:255], v[64:67], v[48:51], v[252:255]
    s_bitcmp1_b32 s43, s35
    s_cbranch_scc1 L_recurrent_scan__compressed_kv_cla__moe_arch_mod__prompt_kernel_w0_15
    s_waitcnt vmcnt(1)
L_recurrent_scan__compressed_kv_cla__moe_arch_mod__prompt_kernel_w0b_16:
    s_waitcnt lgkmcnt(0)
    s_cmp_eq_u32 s35, 3
    s_barrier
    s_cbranch_scc1 L_p1_fin0
    v_mfma_f32_16x16x32_bf16 v[128:131], v[100:103], v[68:71], v[128:131]
    ds_read_b128 v[20:23], v10 offset:0
    s_add_u32 m0, s33, 32768
    v_mfma_f32_16x16x32_bf16 v[132:135], v[104:107], v[68:71], v[132:135]
    ds_read_b64_tr_b16 v[52:53], v12 offset:0
    buffer_load_dwordx4 v2, s[4:7], s31 offen offset:0 lds
    v_mfma_f32_16x16x32_bf16 v[136:139], v[108:111], v[68:71], v[136:139]
    ds_read_b64_tr_b16 v[54:55], v12 offset:1024
    v_mfma_f32_16x16x32_bf16 v[140:143], v[112:115], v[68:71], v[140:143]
    ds_read_b64_tr_b16 v[56:57], v13 offset:0
    v_mfma_f32_16x16x32_bf16 v[144:147], v[100:103], v[72:75], v[144:147]
    ds_read_b64_tr_b16 v[58:59], v13 offset:1024
    buffer_load_dwordx4 v3, s[4:7], s31 offen offset:1024 lds
    v_mfma_f32_16x16x32_bf16 v[148:151], v[104:107], v[72:75], v[148:151]
    ds_read_b64_tr_b16 v[60:61], v14 offset:0
    v_mfma_f32_16x16x32_bf16 v[152:155], v[108:111], v[72:75], v[152:155]
    ds_read_b64_tr_b16 v[62:63], v14 offset:1024
    v_mfma_f32_16x16x32_bf16 v[156:159], v[112:115], v[72:75], v[156:159]
    ds_read_b64_tr_b16 v[64:65], v15 offset:0
    buffer_load_dwordx4 v4, s[4:7], s31 offen offset:2048 lds
    v_mfma_f32_16x16x32_bf16 v[160:163], v[100:103], v[76:79], v[160:163]
    ds_read_b64_tr_b16 v[66:67], v15 offset:1024
    v_mfma_f32_16x16x32_bf16 v[164:167], v[104:107], v[76:79], v[164:167]
    ds_read_b128 v[24:27], v10 offset:2048
    v_mfma_f32_16x16x32_bf16 v[168:171], v[108:111], v[76:79], v[168:171]
    ds_read_b128 v[28:31], v10 offset:4096
    buffer_load_dwordx4 v5, s[4:7], s31 offen offset:3072 lds
    v_mfma_f32_16x16x32_bf16 v[172:175], v[112:115], v[76:79], v[172:175]
    ds_read_b128 v[32:35], v10 offset:6144
    v_mfma_f32_16x16x32_bf16 v[176:179], v[100:103], v[80:83], v[176:179]
    ds_read_b128 v[36:39], v10 offset:8192
    s_add_u32 m0, s34, 32768
    v_mfma_f32_16x16x32_bf16 v[180:183], v[104:107], v[80:83], v[180:183]
    ds_read_b128 v[40:43], v10 offset:10240
    buffer_load_dwordx4 v6, s[8:11], s32 offen offset:0 nt lds
    v_mfma_f32_16x16x32_bf16 v[184:187], v[108:111], v[80:83], v[184:187]
    ds_read_b128 v[44:47], v10 offset:12288
    v_mfma_f32_16x16x32_bf16 v[188:191], v[112:115], v[80:83], v[188:191]
    ds_read_b128 v[48:51], v10 offset:14336
    v_mfma_f32_16x16x32_bf16 v[192:195], v[100:103], v[84:87], v[192:195]
    buffer_load_dwordx4 v7, s[8:11], s32 offen offset:1024 nt lds
    v_mfma_f32_16x16x32_bf16 v[196:199], v[104:107], v[84:87], v[196:199]
    v_mfma_f32_16x16x32_bf16 v[200:203], v[108:111], v[84:87], v[200:203]
    v_mfma_f32_16x16x32_bf16 v[204:207], v[112:115], v[84:87], v[204:207]
    buffer_load_dwordx4 v8, s[8:11], s32 offen offset:2048 nt lds
    v_mfma_f32_16x16x32_bf16 v[208:211], v[100:103], v[88:91], v[208:211]
    v_mfma_f32_16x16x32_bf16 v[212:215], v[104:107], v[88:91], v[212:215]
    v_mfma_f32_16x16x32_bf16 v[216:219], v[108:111], v[88:91], v[216:219]
    buffer_load_dwordx4 v9, s[8:11], s32 offen offset:3072 nt lds
    v_mfma_f32_16x16x32_bf16 v[220:223], v[112:115], v[88:91], v[220:223]
    v_mfma_f32_16x16x32_bf16 v[224:227], v[100:103], v[92:95], v[224:227]
    v_mfma_f32_16x16x32_bf16 v[228:231], v[104:107], v[92:95], v[228:231]
    v_mfma_f32_16x16x32_bf16 v[232:235], v[108:111], v[92:95], v[232:235]
    v_mfma_f32_16x16x32_bf16 v[236:239], v[112:115], v[92:95], v[236:239]
    v_mfma_f32_16x16x32_bf16 v[240:243], v[100:103], v[96:99], v[240:243]
    v_mfma_f32_16x16x32_bf16 v[244:247], v[104:107], v[96:99], v[244:247]
    v_mfma_f32_16x16x32_bf16 v[248:251], v[108:111], v[96:99], v[248:251]
    s_add_u32 s36, s35, s28
    s_cmp_eq_u32 s36, 0
    s_cbranch_scc1 L_recurrent_scan__compressed_kv_cla__moe_arch_mod__prompt_kernel_rare_25
L_recurrent_scan__compressed_kv_cla__moe_arch_mod__prompt_kernel_back_26:
    v_mfma_f32_16x16x32_bf16 v[252:255], v[112:115], v[96:99], v[252:255]
    s_bitcmp1_b32 3, s35
    s_cselect_b32 exec_lo, 255, 1
    s_mov_b32 exec_hi, 0
    global_load_dword v0, v17, s[96:97]
    s_mov_b64 exec, -1
    s_cselect_b32 s36, s45, 0
    v_add_u32 v17, s36, v17
    v_min_u32 v17, 8388480, v17
    s_nop 1
    s_add_u32 s31, s31, s40
    s_add_u32 s32, s32, s41
    s_add_u32 s35, s35, 1
    s_branch L_kv_kloop
L_p1_fin0:
    v_mfma_f32_16x16x32_bf16 v[128:131], v[100:103], v[68:71], v[128:131]
    s_and_b32 s36, s28, 3
    s_sub_u32 s37, 15, s30
    s_cmp_lt_u32 s28, 4
    s_cselect_b32 s37, s37, s30
    s_lshl_b32 s37, s37, 2
    s_add_u32 s37, s37, s36
    s_lshl_b32 s37, s37, 16
    v_lshl_add_u32 v6, v1, 4, s37
    v_add_u32 v7, 32768, v6
    s_mov_b32 s32, 0
    s_mov_b32 s8, s54
    s_and_b32 s9, s55, 0xffff
    s_mov_b32 s10, 4194304
    s_mov_b32 s11, 0x20000
    v_mfma_f32_16x16x32_bf16 v[132:135], v[104:107], v[68:71], v[132:135]
    buffer_load_dwordx4 v[24:27], v6, s[8:11], s32 offen offset:0 sc1
    v_mfma_f32_16x16x32_bf16 v[136:139], v[108:111], v[68:71], v[136:139]
    v_lshrrev_b32 v18, 4, v1
    v_mfma_f32_16x16x32_bf16 v[140:143], v[112:115], v[68:71], v[140:143]
    v_bfe_u32 v20, v1, 2, 2
    v_mfma_f32_16x16x32_bf16 v[144:147], v[100:103], v[72:75], v[144:147]
    v_lshl_add_u32 v19, v18, 3, v20
    v_mfma_f32_16x16x32_bf16 v[148:151], v[104:107], v[72:75], v[148:151]
    buffer_load_dwordx4 v[28:31], v7, s[8:11], s32 offen offset:0 sc1
    v_lshlrev_b32 v19, 8, v19
    v_mfma_f32_16x16x32_bf16 v[152:155], v[108:111], v[72:75], v[152:155]
    v_and_b32 v21, 3, v1
    v_mfma_f32_16x16x32_bf16 v[156:159], v[112:115], v[72:75], v[156:159]
    v_lshl_add_u32 v19, v21, 3, v19
    v_mfma_f32_16x16x32_bf16 v[160:163], v[100:103], v[76:79], v[160:163]
    v_and_b32 v21, 1, v18
    v_mfma_f32_16x16x32_bf16 v[164:167], v[104:107], v[76:79], v[164:167]
    buffer_load_dwordx4 v[32:35], v6, s[8:11], s32 offen offset:1024 sc1
    v_lshl_add_u32 v20, v21, 2, v20
    v_mfma_f32_16x16x32_bf16 v[168:171], v[108:111], v[76:79], v[168:171]
    v_xor_b32 v21, 0, v20
    v_mfma_f32_16x16x32_bf16 v[172:175], v[112:115], v[76:79], v[172:175]
    v_lshl_add_u32 v10, v21, 5, v19
    v_mfma_f32_16x16x32_bf16 v[176:179], v[100:103], v[80:83], v[176:179]
    v_xor_b32 v21, 1, v20
    v_mfma_f32_16x16x32_bf16 v[180:183], v[104:107], v[80:83], v[180:183]
    buffer_load_dwordx4 v[36:39], v7, s[8:11], s32 offen offset:1024 sc1
    v_lshl_add_u32 v11, v21, 5, v19
    v_mfma_f32_16x16x32_bf16 v[184:187], v[108:111], v[80:83], v[184:187]
    v_xor_b32 v21, 2, v20
    v_mfma_f32_16x16x32_bf16 v[188:191], v[112:115], v[80:83], v[188:191]
    v_lshl_add_u32 v12, v21, 5, v19
    v_mfma_f32_16x16x32_bf16 v[192:195], v[100:103], v[84:87], v[192:195]
    v_xor_b32 v21, 3, v20
    v_mfma_f32_16x16x32_bf16 v[196:199], v[104:107], v[84:87], v[196:199]
    buffer_load_dwordx4 v[40:43], v6, s[8:11], s32 offen offset:2048 sc1
    v_lshl_add_u32 v13, v21, 5, v19
    v_mfma_f32_16x16x32_bf16 v[200:203], v[108:111], v[84:87], v[200:203]
    v_xor_b32 v21, 4, v20
    v_mfma_f32_16x16x32_bf16 v[204:207], v[112:115], v[84:87], v[204:207]
    v_lshl_add_u32 v14, v21, 5, v19
    v_mfma_f32_16x16x32_bf16 v[208:211], v[100:103], v[88:91], v[208:211]
    v_xor_b32 v21, 5, v20
    v_mfma_f32_16x16x32_bf16 v[212:215], v[104:107], v[88:91], v[212:215]
    buffer_load_dwordx4 v[44:47], v7, s[8:11], s32 offen offset:2048 sc1
    v_lshl_add_u32 v15, v21, 5, v19
    v_mfma_f32_16x16x32_bf16 v[216:219], v[108:111], v[88:91], v[216:219]
    v_xor_b32 v21, 6, v20
    v_mfma_f32_16x16x32_bf16 v[220:223], v[112:115], v[88:91], v[220:223]
    v_lshl_add_u32 v16, v21, 5, v19
    v_mfma_f32_16x16x32_bf16 v[224:227], v[100:103], v[92:95], v[224:227]
    v_xor_b32 v21, 7, v20
    v_mfma_f32_16x16x32_bf16 v[228:231], v[104:107], v[92:95], v[228:231]
    buffer_load_dwordx4 v[48:51], v6, s[8:11], s32 offen offset:3072 sc1
    v_lshl_add_u32 v17, v21, 5, v19
    v_mfma_f32_16x16x32_bf16 v[232:235], v[108:111], v[92:95], v[232:235]
    s_lshl_b32 s45, s29, 20
    v_mfma_f32_16x16x32_bf16 v[236:239], v[112:115], v[92:95], v[236:239]
    v_mfma_f32_16x16x32_bf16 v[240:243], v[100:103], v[96:99], v[240:243]
    v_mfma_f32_16x16x32_bf16 v[244:247], v[104:107], v[96:99], v[244:247]
    buffer_load_dwordx4 v[52:55], v7, s[8:11], s32 offen offset:3072 sc1
    v_mfma_f32_16x16x32_bf16 v[248:251], v[108:111], v[96:99], v[248:251]
    v_mfma_f32_16x16x32_bf16 v[252:255], v[112:115], v[96:99], v[252:255]
    s_branch L_p1_done
    .p2align 6
L_kv_vloop:
    s_waitcnt lgkmcnt(0)
    v_mfma_f32_16x16x32_bf16 v[128:131], v[20:23], v[52:55], v[128:131]
    ds_read_b128 v[68:71], v11 offset:0
    v_mfma_f32_16x16x32_bf16 v[160:163], v[20:23], v[56:59], v[160:163]
    ds_read_b64_tr_b16 v[100:101], v12 offset:8192
    v_mfma_f32_16x16x32_bf16 v[192:195], v[20:23], v[60:63], v[192:195]
    ds_read_b64_tr_b16 v[102:103], v12 offset:9216
    v_mfma_f32_16x16x32_bf16 v[224:227], v[20:23], v[64:67], v[224:227]
    ds_read_b64_tr_b16 v[104:105], v13 offset:8192
    v_mfma_f32_16x16x32_bf16 v[132:135], v[24:27], v[52:55], v[132:135]
    ds_read_b64_tr_b16 v[106:107], v13 offset:9216
    v_mfma_f32_16x16x32_bf16 v[164:167], v[24:27], v[56:59], v[164:167]
    ds_read_b64_tr_b16 v[108:109], v14 offset:8192
    v_mfma_f32_16x16x32_bf16 v[196:199], v[24:27], v[60:63], v[196:199]
    ds_read_b64_tr_b16 v[110:111], v14 offset:9216
    v_mfma_f32_16x16x32_bf16 v[228:231], v[24:27], v[64:67], v[228:231]
    ds_read_b64_tr_b16 v[112:113], v15 offset:8192
    v_mfma_f32_16x16x32_bf16 v[136:139], v[28:31], v[52:55], v[136:139]
    ds_read_b64_tr_b16 v[114:115], v15 offset:9216
    v_mfma_f32_16x16x32_bf16 v[168:171], v[28:31], v[56:59], v[168:171]
    ds_read_b128 v[72:75], v11 offset:2048
    v_mfma_f32_16x16x32_bf16 v[200:203], v[28:31], v[60:63], v[200:203]
    ds_read_b128 v[76:79], v11 offset:4096
    v_mfma_f32_16x16x32_bf16 v[232:235], v[28:31], v[64:67], v[232:235]
    ds_read_b128 v[80:83], v11 offset:6144
    v_mfma_f32_16x16x32_bf16 v[140:143], v[32:35], v[52:55], v[140:143]
    ds_read_b128 v[84:87], v11 offset:8192
    v_mfma_f32_16x16x32_bf16 v[172:175], v[32:35], v[56:59], v[172:175]
    ds_read_b128 v[88:91], v11 offset:10240
    v_mfma_f32_16x16x32_bf16 v[204:207], v[32:35], v[60:63], v[204:207]
    ds_read_b128 v[92:95], v11 offset:12288
    v_mfma_f32_16x16x32_bf16 v[236:239], v[32:35], v[64:67], v[236:239]
    ds_read_b128 v[96:99], v11 offset:14336
    v_mfma_f32_16x16x32_bf16 v[144:147], v[36:39], v[52:55], v[144:147]
    v_mfma_f32_16x16x32_bf16 v[176:179], v[36:39], v[56:59], v[176:179]
    v_mfma_f32_16x16x32_bf16 v[208:211], v[36:39], v[60:63], v[208:211]
    v_mfma_f32_16x16x32_bf16 v[240:243], v[36:39], v[64:67], v[240:243]
    v_mfma_f32_16x16x32_bf16 v[148:151], v[40:43], v[52:55], v[148:151]
    v_mfma_f32_16x16x32_bf16 v[180:183], v[40:43], v[56:59], v[180:183]
    v_mfma_f32_16x16x32_bf16 v[212:215], v[40:43], v[60:63], v[212:215]
    v_mfma_f32_16x16x32_bf16 v[244:247], v[40:43], v[64:67], v[244:247]
    v_mfma_f32_16x16x32_bf16 v[152:155], v[44:47], v[52:55], v[152:155]
    v_mfma_f32_16x16x32_bf16 v[184:187], v[44:47], v[56:59], v[184:187]
    v_mfma_f32_16x16x32_bf16 v[216:219], v[44:47], v[60:63], v[216:219]
    v_mfma_f32_16x16x32_bf16 v[248:251], v[44:47], v[64:67], v[248:251]
    v_mfma_f32_16x16x32_bf16 v[156:159], v[48:51], v[52:55], v[156:159]
    v_mfma_f32_16x16x32_bf16 v[188:191], v[48:51], v[56:59], v[188:191]
    v_mfma_f32_16x16x32_bf16 v[220:223], v[48:51], v[60:63], v[220:223]
    v_mfma_f32_16x16x32_bf16 v[252:255], v[48:51], v[64:67], v[252:255]
    s_cmp_lt_u32 s35, s44
    s_cbranch_scc1 L_recurrent_scan__compressed_kv_cla__moe_arch_mod__prompt_kernel_w0_27
    s_waitcnt vmcnt(1)
L_recurrent_scan__compressed_kv_cla__moe_arch_mod__prompt_kernel_w0b_28:
    s_waitcnt lgkmcnt(0)
    s_barrier
    s_add_u32 m0, s33, 0
    s_nop 0
    buffer_load_dwordx4 v2, s[4:7], s31 offen offset:0 lds
    buffer_load_dwordx4 v3, s[4:7], s31 offen offset:1024 lds
    buffer_load_dwordx4 v4, s[4:7], s31 offen offset:2048 lds
    buffer_load_dwordx4 v5, s[4:7], s31 offen offset:3072 lds
    s_add_u32 m0, s34, 0
    s_nop 0
    buffer_load_dwordx4 v6, s[8:11], s32 offen offset:0 nt lds
    buffer_load_dwordx4 v7, s[8:11], s32 offen offset:1024 nt lds
    buffer_load_dwordx4 v8, s[8:11], s32 offen offset:2048 nt lds
    buffer_load_dwordx4 v9, s[8:11], s32 offen offset:3072 nt lds
    s_add_u32 s31, s31, s40
    s_add_u32 s32, s32, s41
    s_cmp_eq_u32 s35, 0
    s_cbranch_scc1 L_recurrent_scan__compressed_kv_cla__moe_arch_mod__prompt_kernel_rare_32
L_recurrent_scan__compressed_kv_cla__moe_arch_mod__prompt_kernel_back_33:
    v_mfma_f32_16x16x32_bf16 v[128:131], v[68:71], v[100:103], v[128:131]
    ds_read_b128 v[20:23], v10 offset:32768
    v_mfma_f32_16x16x32_bf16 v[160:163], v[68:71], v[104:107], v[160:163]
    ds_read_b64_tr_b16 v[52:53], v12 offset:32768
    v_mfma_f32_16x16x32_bf16 v[192:195], v[68:71], v[108:111], v[192:195]
    ds_read_b64_tr_b16 v[54:55], v12 offset:33792
    v_mfma_f32_16x16x32_bf16 v[224:227], v[68:71], v[112:115], v[224:227]
    ds_read_b64_tr_b16 v[56:57], v13 offset:32768
    v_mfma_f32_16x16x32_bf16 v[132:135], v[72:75], v[100:103], v[132:135]
    ds_read_b64_tr_b16 v[58:59], v13 offset:33792
    v_mfma_f32_16x16x32_bf16 v[164:167], v[72:75], v[104:107], v[164:167]
    ds_read_b64_tr_b16 v[60:61], v14 offset:32768
    v_mfma_f32_16x16x32_bf16 v[196:199], v[72:75], v[108:111], v[196:199]
    ds_read_b64_tr_b16 v[62:63], v14 offset:33792
    v_mfma_f32_16x16x32_bf16 v[228:231], v[72:75], v[112:115], v[228:231]
    ds_read_b64_tr_b16 v[64:65], v15 offset:32768
    v_mfma_f32_16x16x32_bf16 v[136:139], v[76:79], v[100:103], v[136:139]
    ds_read_b64_tr_b16 v[66:67], v15 offset:33792
    v_mfma_f32_16x16x32_bf16 v[168:171], v[76:79], v[104:107], v[168:171]
    ds_read_b128 v[24:27], v10 offset:34816
    v_mfma_f32_16x16x32_bf16 v[200:203], v[76:79], v[108:111], v[200:203]
    ds_read_b128 v[28:31], v10 offset:36864
    v_mfma_f32_16x16x32_bf16 v[232:235], v[76:79], v[112:115], v[232:235]
    ds_read_b128 v[32:35], v10 offset:38912
    v_mfma_f32_16x16x32_bf16 v[140:143], v[80:83], v[100:103], v[140:143]
    ds_read_b128 v[36:39], v10 offset:40960
    v_mfma_f32_16x16x32_bf16 v[172:175], v[80:83], v[104:107], v[172:175]
    ds_read_b128 v[40:43], v10 offset:43008
    v_mfma_f32_16x16x32_bf16 v[204:207], v[80:83], v[108:111], v[204:207]
    ds_read_b128 v[44:47], v10 offset:45056
    v_mfma_f32_16x16x32_bf16 v[236:239], v[80:83], v[112:115], v[236:239]
    ds_read_b128 v[48:51], v10 offset:47104
    v_mfma_f32_16x16x32_bf16 v[144:147], v[84:87], v[100:103], v[144:147]
    v_mfma_f32_16x16x32_bf16 v[176:179], v[84:87], v[104:107], v[176:179]
    v_mfma_f32_16x16x32_bf16 v[208:211], v[84:87], v[108:111], v[208:211]
    v_mfma_f32_16x16x32_bf16 v[240:243], v[84:87], v[112:115], v[240:243]
    v_mfma_f32_16x16x32_bf16 v[148:151], v[88:91], v[100:103], v[148:151]
    v_mfma_f32_16x16x32_bf16 v[180:183], v[88:91], v[104:107], v[180:183]
    v_mfma_f32_16x16x32_bf16 v[212:215], v[88:91], v[108:111], v[212:215]
    v_mfma_f32_16x16x32_bf16 v[244:247], v[88:91], v[112:115], v[244:247]
    v_mfma_f32_16x16x32_bf16 v[152:155], v[92:95], v[100:103], v[152:155]
    v_mfma_f32_16x16x32_bf16 v[184:187], v[92:95], v[104:107], v[184:187]
    v_mfma_f32_16x16x32_bf16 v[216:219], v[92:95], v[108:111], v[216:219]
    v_mfma_f32_16x16x32_bf16 v[248:251], v[92:95], v[112:115], v[248:251]
    v_mfma_f32_16x16x32_bf16 v[156:159], v[96:99], v[100:103], v[156:159]
    v_mfma_f32_16x16x32_bf16 v[188:191], v[96:99], v[104:107], v[188:191]
    v_mfma_f32_16x16x32_bf16 v[220:223], v[96:99], v[108:111], v[220:223]
    v_mfma_f32_16x16x32_bf16 v[252:255], v[96:99], v[112:115], v[252:255]
    s_bitcmp1_b32 3, s35
    s_cselect_b32 exec_lo, 255, 1
    s_mov_b32 exec_hi, 0
    global_load_dword v0, v17, s[96:97]
    s_mov_b64 exec, -1
    s_cselect_b32 s36, s45, 0
    v_add_u32 v17, s36, v17
    v_min_u32 v17, 8388480, v17
    s_nop 1
    s_waitcnt lgkmcnt(0)
    v_mfma_f32_16x16x32_bf16 v[128:131], v[20:23], v[52:55], v[128:131]
    ds_read_b128 v[68:71], v11 offset:32768
    v_mfma_f32_16x16x32_bf16 v[160:163], v[20:23], v[56:59], v[160:163]
    ds_read_b64_tr_b16 v[100:101], v12 offset:40960
    v_mfma_f32_16x16x32_bf16 v[192:195], v[20:23], v[60:63], v[192:195]
    ds_read_b64_tr_b16 v[102:103], v12 offset:41984
    v_mfma_f32_16x16x32_bf16 v[224:227], v[20:23], v[64:67], v[224:227]
    ds_read_b64_tr_b16 v[104:105], v13 offset:40960
    v_mfma_f32_16x16x32_bf16 v[132:135], v[24:27], v[52:55], v[132:135]
    ds_read_b64_tr_b16 v[106:107], v13 offset:41984
    v_mfma_f32_16x16x32_bf16 v[164:167], v[24:27], v[56:59], v[164:167]
    ds_read_b64_tr_b16 v[108:109], v14 offset:40960
    v_mfma_f32_16x16x32_bf16 v[196:199], v[24:27], v[60:63], v[196:199]
    ds_read_b64_tr_b16 v[110:111], v14 offset:41984
    v_mfma_f32_16x16x32_bf16 v[228:231], v[24:27], v[64:67], v[228:231]
    ds_read_b64_tr_b16 v[112:113], v15 offset:40960
    v_mfma_f32_16x16x32_bf16 v[136:139], v[28:31], v[52:55], v[136:139]
    ds_read_b64_tr_b16 v[114:115], v15 offset:41984
    v_mfma_f32_16x16x32_bf16 v[168:171], v[28:31], v[56:59], v[168:171]
    ds_read_b128 v[72:75], v11 offset:34816
    v_mfma_f32_16x16x32_bf16 v[200:203], v[28:31], v[60:63], v[200:203]
    ds_read_b128 v[76:79], v11 offset:36864
    v_mfma_f32_16x16x32_bf16 v[232:235], v[28:31], v[64:67], v[232:235]
    ds_read_b128 v[80:83], v11 offset:38912
    v_mfma_f32_16x16x32_bf16 v[140:143], v[32:35], v[52:55], v[140:143]
    ds_read_b128 v[84:87], v11 offset:40960
    v_mfma_f32_16x16x32_bf16 v[172:175], v[32:35], v[56:59], v[172:175]
    ds_read_b128 v[88:91], v11 offset:43008
    v_mfma_f32_16x16x32_bf16 v[204:207], v[32:35], v[60:63], v[204:207]
    ds_read_b128 v[92:95], v11 offset:45056
    v_mfma_f32_16x16x32_bf16 v[236:239], v[32:35], v[64:67], v[236:239]
    ds_read_b128 v[96:99], v11 offset:47104
    v_mfma_f32_16x16x32_bf16 v[144:147], v[36:39], v[52:55], v[144:147]
    v_mfma_f32_16x16x32_bf16 v[176:179], v[36:39], v[56:59], v[176:179]
    v_mfma_f32_16x16x32_bf16 v[208:211], v[36:39], v[60:63], v[208:211]
    v_mfma_f32_16x16x32_bf16 v[240:243], v[36:39], v[64:67], v[240:243]
    v_mfma_f32_16x16x32_bf16 v[148:151], v[40:43], v[52:55], v[148:151]
    v_mfma_f32_16x16x32_bf16 v[180:183], v[40:43], v[56:59], v[180:183]
    v_mfma_f32_16x16x32_bf16 v[212:215], v[40:43], v[60:63], v[212:215]
    v_mfma_f32_16x16x32_bf16 v[244:247], v[40:43], v[64:67], v[244:247]
    v_mfma_f32_16x16x32_bf16 v[152:155], v[44:47], v[52:55], v[152:155]
    v_mfma_f32_16x16x32_bf16 v[184:187], v[44:47], v[56:59], v[184:187]
    v_mfma_f32_16x16x32_bf16 v[216:219], v[44:47], v[60:63], v[216:219]
    v_mfma_f32_16x16x32_bf16 v[248:251], v[44:47], v[64:67], v[248:251]
    v_mfma_f32_16x16x32_bf16 v[156:159], v[48:51], v[52:55], v[156:159]
    v_mfma_f32_16x16x32_bf16 v[188:191], v[48:51], v[56:59], v[188:191]
    v_mfma_f32_16x16x32_bf16 v[220:223], v[48:51], v[60:63], v[220:223]
    v_mfma_f32_16x16x32_bf16 v[252:255], v[48:51], v[64:67], v[252:255]
    s_waitcnt vmcnt(1) lgkmcnt(0)
    s_cmp_eq_u32 s35, 3
    s_barrier
    s_cbranch_scc1 L_p1_fin1
    s_add_u32 m0, s33, 32768
    s_nop 0
    buffer_load_dwordx4 v2, s[4:7], s31 offen offset:0 lds
    buffer_load_dwordx4 v3, s[4:7], s31 offen offset:1024 lds
    buffer_load_dwordx4 v4, s[4:7], s31 offen offset:2048 lds
    buffer_load_dwordx4 v5, s[4:7], s31 offen offset:3072 lds
    s_add_u32 m0, s34, 32768
    s_nop 0
    buffer_load_dwordx4 v6, s[8:11], s32 offen offset:0 nt lds
    buffer_load_dwordx4 v7, s[8:11], s32 offen offset:1024 nt lds
    buffer_load_dwordx4 v8, s[8:11], s32 offen offset:2048 nt lds
    buffer_load_dwordx4 v9, s[8:11], s32 offen offset:3072 nt lds
    s_add_u32 s31, s31, s40
    s_add_u32 s32, s32, s41
    s_cmp_eq_u32 s35, 2
    s_cbranch_scc1 L_recurrent_scan__compressed_kv_cla__moe_arch_mod__prompt_kernel_rare_36
L_recurrent_scan__compressed_kv_cla__moe_arch_mod__prompt_kernel_back_37:
    v_mfma_f32_16x16x32_bf16 v[128:131], v[68:71], v[100:103], v[128:131]
    ds_read_b128 v[20:23], v10 offset:0
    v_mfma_f32_16x16x32_bf16 v[160:163], v[68:71], v[104:107], v[160:163]
    ds_read_b64_tr_b16 v[52:53], v12 offset:0
    v_mfma_f32_16x16x32_bf16 v[192:195], v[68:71], v[108:111], v[192:195]
    ds_read_b64_tr_b16 v[54:55], v12 offset:1024
    v_mfma_f32_16x16x32_bf16 v[224:227], v[68:71], v[112:115], v[224:227]
    ds_read_b64_tr_b16 v[56:57], v13 offset:0
    v_mfma_f32_16x16x32_bf16 v[132:135], v[72:75], v[100:103], v[132:135]
    ds_read_b64_tr_b16 v[58:59], v13 offset:1024
    v_mfma_f32_16x16x32_bf16 v[164:167], v[72:75], v[104:107], v[164:167]
    ds_read_b64_tr_b16 v[60:61], v14 offset:0
    v_mfma_f32_16x16x32_bf16 v[196:199], v[72:75], v[108:111], v[196:199]
    ds_read_b64_tr_b16 v[62:63], v14 offset:1024
    v_mfma_f32_16x16x32_bf16 v[228:231], v[72:75], v[112:115], v[228:231]
    ds_read_b64_tr_b16 v[64:65], v15 offset:0
    v_mfma_f32_16x16x32_bf16 v[136:139], v[76:79], v[100:103], v[136:139]
    ds_read_b64_tr_b16 v[66:67], v15 offset:1024
    v_mfma_f32_16x16x32_bf16 v[168:171], v[76:79], v[104:107], v[168:171]
    ds_read_b128 v[24:27], v10 offset:2048
    v_mfma_f32_16x16x32_bf16 v[200:203], v[76:79], v[108:111], v[200:203]
    ds_read_b128 v[28:31], v10 offset:4096
    v_mfma_f32_16x16x32_bf16 v[232:235], v[76:79], v[112:115], v[232:235]
    ds_read_b128 v[32:35], v10 offset:6144
    v_mfma_f32_16x16x32_bf16 v[140:143], v[80:83], v[100:103], v[140:143]
    ds_read_b128 v[36:39], v10 offset:8192
    v_mfma_f32_16x16x32_bf16 v[172:175], v[80:83], v[104:107], v[172:175]
    ds_read_b128 v[40:43], v10 offset:10240
    v_mfma_f32_16x16x32_bf16 v[204:207], v[80:83], v[108:111], v[204:207]
    ds_read_b128 v[44:47], v10 offset:12288
    v_mfma_f32_16x16x32_bf16 v[236:239], v[80:83], v[112:115], v[236:239]
    ds_read_b128 v[48:51], v10 offset:14336
    v_mfma_f32_16x16x32_bf16 v[144:147], v[84:87], v[100:103], v[144:147]
    v_mfma_f32_16x16x32_bf16 v[176:179], v[84:87], v[104:107], v[176:179]
    v_mfma_f32_16x16x32_bf16 v[208:211], v[84:87], v[108:111], v[208:211]
    v_mfma_f32_16x16x32_bf16 v[240:243], v[84:87], v[112:115], v[240:243]
    v_mfma_f32_16x16x32_bf16 v[148:151], v[88:91], v[100:103], v[148:151]
    v_mfma_f32_16x16x32_bf16 v[180:183], v[88:91], v[104:107], v[180:183]
    v_mfma_f32_16x16x32_bf16 v[212:215], v[88:91], v[108:111], v[212:215]
    v_mfma_f32_16x16x32_bf16 v[244:247], v[88:91], v[112:115], v[244:247]
    v_mfma_f32_16x16x32_bf16 v[152:155], v[92:95], v[100:103], v[152:155]
    v_mfma_f32_16x16x32_bf16 v[184:187], v[92:95], v[104:107], v[184:187]
    v_mfma_f32_16x16x32_bf16 v[216:219], v[92:95], v[108:111], v[216:219]
    v_mfma_f32_16x16x32_bf16 v[248:251], v[92:95], v[112:115], v[248:251]
    v_mfma_f32_16x16x32_bf16 v[156:159], v[96:99], v[100:103], v[156:159]
    v_mfma_f32_16x16x32_bf16 v[188:191], v[96:99], v[104:107], v[188:191]
    v_mfma_f32_16x16x32_bf16 v[220:223], v[96:99], v[108:111], v[220:223]
    v_mfma_f32_16x16x32_bf16 v[252:255], v[96:99], v[112:115], v[252:255]
    s_bitcmp1_b32 3, s35
    s_cselect_b32 exec_lo, 255, 1
    s_mov_b32 exec_hi, 0
    global_load_dword v0, v17, s[96:97]
    s_mov_b64 exec, -1
    s_cselect_b32 s36, s45, 0
    v_add_u32 v17, s36, v17
    v_min_u32 v17, 8388480, v17
    s_nop 1
    s_add_u32 s35, s35, 1
    s_branch L_kv_vloop
L_p1_fin1:
    s_and_b32 s36, s28, 3
    s_sub_u32 s37, 15, s30
    s_cmp_lt_u32 s28, 4
    s_cselect_b32 s37, s37, s30
    s_lshl_b32 s37, s37, 2
    s_add_u32 s37, s37, s36
    s_lshl_b32 s37, s37, 16
    v_lshl_add_u32 v6, v1, 4, s37
    v_add_u32 v7, 32768, v6
    s_mov_b32 s32, 0
    s_mov_b32 s8, s54
    s_and_b32 s9, s55, 0xffff
    s_mov_b32 s10, 4194304
    s_mov_b32 s11, 0x20000
    v_mfma_f32_16x16x32_bf16 v[128:131], v[68:71], v[100:103], v[128:131]
    v_mfma_f32_16x16x32_bf16 v[160:163], v[68:71], v[104:107], v[160:163]
    buffer_load_dwordx4 v[24:27], v6, s[8:11], s32 offen offset:0 sc1
    v_mfma_f32_16x16x32_bf16 v[192:195], v[68:71], v[108:111], v[192:195]
    v_lshrrev_b32 v18, 4, v1
    v_mfma_f32_16x16x32_bf16 v[224:227], v[68:71], v[112:115], v[224:227]
    v_bfe_u32 v20, v1, 2, 2
    v_mfma_f32_16x16x32_bf16 v[132:135], v[72:75], v[100:103], v[132:135]
    v_lshl_add_u32 v19, v18, 3, v20
    v_mfma_f32_16x16x32_bf16 v[164:167], v[72:75], v[104:107], v[164:167]
    buffer_load_dwordx4 v[28:31], v7, s[8:11], s32 offen offset:0 sc1
    v_lshlrev_b32 v19, 8, v19
    v_mfma_f32_16x16x32_bf16 v[196:199], v[72:75], v[108:111], v[196:199]
    v_and_b32 v21, 3, v1
    v_mfma_f32_16x16x32_bf16 v[228:231], v[72:75], v[112:115], v[228:231]
    v_lshl_add_u32 v19, v21, 3, v19
    v_mfma_f32_16x16x32_bf16 v[136:139], v[76:79], v[100:103], v[136:139]
    v_and_b32 v21, 1, v18
    v_mfma_f32_16x16x32_bf16 v[168:171], v[76:79], v[104:107], v[168:171]
    buffer_load_dwordx4 v[32:35], v6, s[8:11], s32 offen offset:1024 sc1
    v_lshl_add_u32 v20, v21, 2, v20
    v_mfma_f32_16x16x32_bf16 v[200:203], v[76:79], v[108:111], v[200:203]
    v_xor_b32 v21, 0, v20
    v_mfma_f32_16x16x32_bf16 v[232:235], v[76:79], v[112:115], v[232:235]
    v_lshl_add_u32 v10, v21, 5, v19
    v_mfma_f32_16x16x32_bf16 v[140:143], v[80:83], v[100:103], v[140:143]
    v_xor_b32 v21, 1, v20
    v_mfma_f32_16x16x32_bf16 v[172:175], v[80:83], v[104:107], v[172:175]
    buffer_load_dwordx4 v[36:39], v7, s[8:11], s32 offen offset:1024 sc1
    v_lshl_add_u32 v11, v21, 5, v19
    v_mfma_f32_16x16x32_bf16 v[204:207], v[80:83], v[108:111], v[204:207]
    v_xor_b32 v21, 2, v20
    v_mfma_f32_16x16x32_bf16 v[236:239], v[80:83], v[112:115], v[236:239]
    v_lshl_add_u32 v12, v21, 5, v19
    v_mfma_f32_16x16x32_bf16 v[144:147], v[84:87], v[100:103], v[144:147]
    v_xor_b32 v21, 3, v20
    v_mfma_f32_16x16x32_bf16 v[176:179], v[84:87], v[104:107], v[176:179]
    buffer_load_dwordx4 v[40:43], v6, s[8:11], s32 offen offset:2048 sc1
    v_lshl_add_u32 v13, v21, 5, v19
    v_mfma_f32_16x16x32_bf16 v[208:211], v[84:87], v[108:111], v[208:211]
    v_xor_b32 v21, 4, v20
    v_mfma_f32_16x16x32_bf16 v[240:243], v[84:87], v[112:115], v[240:243]
    v_lshl_add_u32 v14, v21, 5, v19
    v_mfma_f32_16x16x32_bf16 v[148:151], v[88:91], v[100:103], v[148:151]
    v_xor_b32 v21, 5, v20
    v_mfma_f32_16x16x32_bf16 v[180:183], v[88:91], v[104:107], v[180:183]
    buffer_load_dwordx4 v[44:47], v7, s[8:11], s32 offen offset:2048 sc1
    v_lshl_add_u32 v15, v21, 5, v19
    v_mfma_f32_16x16x32_bf16 v[212:215], v[88:91], v[108:111], v[212:215]
    v_xor_b32 v21, 6, v20
    v_mfma_f32_16x16x32_bf16 v[244:247], v[88:91], v[112:115], v[244:247]
    v_lshl_add_u32 v16, v21, 5, v19
    v_mfma_f32_16x16x32_bf16 v[152:155], v[92:95], v[100:103], v[152:155]
    v_xor_b32 v21, 7, v20
    v_mfma_f32_16x16x32_bf16 v[184:187], v[92:95], v[104:107], v[184:187]
    buffer_load_dwordx4 v[48:51], v6, s[8:11], s32 offen offset:3072 sc1
    v_lshl_add_u32 v17, v21, 5, v19
    v_mfma_f32_16x16x32_bf16 v[216:219], v[92:95], v[108:111], v[216:219]
    s_lshl_b32 s45, s29, 20
    v_mfma_f32_16x16x32_bf16 v[248:251], v[92:95], v[112:115], v[248:251]
    v_mfma_f32_16x16x32_bf16 v[156:159], v[96:99], v[100:103], v[156:159]
    v_mfma_f32_16x16x32_bf16 v[188:191], v[96:99], v[104:107], v[188:191]
    buffer_load_dwordx4 v[52:55], v7, s[8:11], s32 offen offset:3072 sc1
    v_mfma_f32_16x16x32_bf16 v[220:223], v[96:99], v[108:111], v[220:223]
    v_mfma_f32_16x16x32_bf16 v[252:255], v[96:99], v[112:115], v[252:255]
L_p1_done:
    s_waitcnt vmcnt(8)
    ds_read_b64_tr_b16 v[64:65], v10 offset:0
    ds_read_b64_tr_b16 v[66:67], v10 offset:1024
    ds_read_b64_tr_b16 v[68:69], v11 offset:0
    ds_read_b64_tr_b16 v[70:71], v11 offset:1024
    ds_read_b64_tr_b16 v[72:73], v12 offset:0
    ds_read_b64_tr_b16 v[74:75], v12 offset:1024
    ds_read_b64_tr_b16 v[76:77], v13 offset:0
    ds_read_b64_tr_b16 v[78:79], v13 offset:1024
    ds_read_b64_tr_b16 v[80:81], v14 offset:0
    ds_read_b64_tr_b16 v[82:83], v14 offset:1024
    ds_read_b64_tr_b16 v[84:85], v15 offset:0
    ds_read_b64_tr_b16 v[86:87], v15 offset:1024
    s_add_u32 m0, s33, 32768
    s_add_u32 s32, s32, 4096
    v_cvt_pk_bf16_f32 v128, v128, v129
    v_cvt_pk_bf16_f32 v129, v130, v131
    v_cvt_pk_bf16_f32 v130, v132, v133
    v_cvt_pk_bf16_f32 v131, v134, v135
    buffer_load_dwordx4 v2, s[4:7], s31 offen offset:0 lds
    v_cvt_pk_bf16_f32 v132, v136, v137
    v_cvt_pk_bf16_f32 v133, v138, v139
    v_cvt_pk_bf16_f32 v134, v140, v141
    v_cvt_pk_bf16_f32 v135, v142, v143
    buffer_load_dwordx4 v3, s[4:7], s31 offen offset:1024 lds
    v_cvt_pk_bf16_f32 v136, v144, v145
    v_cvt_pk_bf16_f32 v137, v146, v147
    v_cvt_pk_bf16_f32 v138, v148, v149
    v_cvt_pk_bf16_f32 v139, v150, v151
    buffer_load_dwordx4 v4, s[4:7], s31 offen offset:2048 lds
    v_cvt_pk_bf16_f32 v140, v152, v153
    v_cvt_pk_bf16_f32 v141, v154, v155
    v_cvt_pk_bf16_f32 v142, v156, v157
    v_cvt_pk_bf16_f32 v143, v158, v159
    buffer_load_dwordx4 v5, s[4:7], s31 offen offset:3072 lds
    v_cvt_pk_bf16_f32 v144, v160, v161
    v_cvt_pk_bf16_f32 v145, v162, v163
    v_cvt_pk_bf16_f32 v146, v164, v165
    v_cvt_pk_bf16_f32 v147, v166, v167
    s_add_u32 m0, s34, 32768
    s_mov_b32 s31, 3145728
    v_cvt_pk_bf16_f32 v148, v168, v169
    v_cvt_pk_bf16_f32 v149, v170, v171
    v_cvt_pk_bf16_f32 v150, v172, v173
    v_cvt_pk_bf16_f32 v151, v174, v175
    buffer_load_dwordx4 v2, s[4:7], s31 offen offset:0 lds
    v_cvt_pk_bf16_f32 v152, v176, v177
    v_cvt_pk_bf16_f32 v153, v178, v179
    v_cvt_pk_bf16_f32 v154, v180, v181
    v_cvt_pk_bf16_f32 v155, v182, v183
    buffer_load_dwordx4 v3, s[4:7], s31 offen offset:1024 lds
    v_cvt_pk_bf16_f32 v156, v184, v185
    v_cvt_pk_bf16_f32 v157, v186, v187
    v_cvt_pk_bf16_f32 v158, v188, v189
    v_cvt_pk_bf16_f32 v159, v190, v191
    buffer_load_dwordx4 v4, s[4:7], s31 offen offset:2048 lds
    v_cvt_pk_bf16_f32 v160, v192, v193
    v_cvt_pk_bf16_f32 v161, v194, v195
    v_cvt_pk_bf16_f32 v162, v196, v197
    v_cvt_pk_bf16_f32 v163, v198, v199
    buffer_load_dwordx4 v5, s[4:7], s31 offen offset:3072 lds
    v_cvt_pk_bf16_f32 v164, v200, v201
    v_cvt_pk_bf16_f32 v165, v202, v203
    v_cvt_pk_bf16_f32 v166, v204, v205
    v_cvt_pk_bf16_f32 v167, v206, v207
    s_add_u32 s31, s31, s40
    s_mov_b32 s34, s33
    v_cvt_pk_bf16_f32 v168, v208, v209
    v_cvt_pk_bf16_f32 v169, v210, v211
    v_cvt_pk_bf16_f32 v170, v212, v213
    v_cvt_pk_bf16_f32 v171, v214, v215
    buffer_load_dwordx4 v[96:99], v6, s[8:11], s32 offen offset:0 sc1
    v_cvt_pk_bf16_f32 v172, v216, v217
    v_cvt_pk_bf16_f32 v173, v218, v219
    v_cvt_pk_bf16_f32 v174, v220, v221
    v_cvt_pk_bf16_f32 v175, v222, v223
    buffer_load_dwordx4 v[100:103], v7, s[8:11], s32 offen offset:0 sc1
    v_cvt_pk_bf16_f32 v176, v224, v225
    v_cvt_pk_bf16_f32 v177, v226, v227
    v_cvt_pk_bf16_f32 v178, v228, v229
    v_cvt_pk_bf16_f32 v179, v230, v231
    buffer_load_dwordx4 v[104:107], v6, s[8:11], s32 offen offset:1024 sc1
    v_cvt_pk_bf16_f32 v180, v232, v233
    v_cvt_pk_bf16_f32 v181, v234, v235
    v_cvt_pk_bf16_f32 v182, v236, v237
    v_cvt_pk_bf16_f32 v183, v238, v239
    buffer_load_dwordx4 v[108:111], v7, s[8:11], s32 offen offset:1024 sc1
    v_cvt_pk_bf16_f32 v184, v240, v241
    v_cvt_pk_bf16_f32 v185, v242, v243
    v_cvt_pk_bf16_f32 v186, v244, v245
    v_cvt_pk_bf16_f32 v187, v246, v247
    buffer_load_dwordx4 v[112:115], v6, s[8:11], s32 offen offset:2048 sc1
    v_cvt_pk_bf16_f32 v188, v248, v249
    v_cvt_pk_bf16_f32 v189, v250, v251
    v_cvt_pk_bf16_f32 v190, v252, v253
    v_cvt_pk_bf16_f32 v191, v254, v255
    s_lshl_b32 s38, s29, 20
    s_lshl_b32 s37, s30, 17
    s_add_u32 s38, s38, s37
    s_bfe_u32 s37, s28, 0x10001
    s_lshl_b32 s37, s37, 16
    s_add_u32 s38, s38, s37
    s_lshr_b32 s36, s28, 2
    s_lshl_b32 s37, s36, 15
    s_add_u32 s38, s38, s37
    s_and_b32 s37, s28, 1
    s_add_u32 s36, s36, 11
    s_lshl_b32 s37, s37, s36
    s_add_u32 s38, s38, s37
    s_cmp_lt_u32 s28, 4
    s_cselect_b32 s36, 4, 32
    s_cselect_b32 s37, 16, 64
    s_cselect_b32 s39, 32, 4
    s_lshl_b32 s36, s36, 8
    s_lshl_b32 s37, s37, 8
    s_lshl_b32 s39, s39, 8
    s_mov_b64 s[16:17], s[12:13]
    s_mov_b64 s[18:19], s[14:15]
    s_cmp_eq_u32 s30, 0
    s_cselect_b32 s52, 2, 4
    v_lshlrev_b32 v58, 4, v1
    v_add_u32 v59, s36, v58
    v_add_u32 v60, s37, v58
    v_add_u32 v61, s36, v60
    v_mov_b64 v[192:193], 0
    v_mov_b64 v[194:195], 0
    v_mov_b64 v[196:197], 0
    v_mov_b64 v[198:199], 0
    v_mov_b64 v[200:201], 0
    v_mov_b64 v[202:203], 0
    v_mov_b64 v[204:205], 0
    v_mov_b64 v[206:207], 0
    v_mov_b64 v[208:209], 0
    v_mov_b64 v[210:211], 0
    v_mov_b64 v[212:213], 0
    v_mov_b64 v[214:215], 0
    v_mov_b64 v[216:217], 0
    v_mov_b64 v[218:219], 0
    v_mov_b64 v[220:221], 0
    v_mov_b64 v[222:223], 0
    v_mov_b64 v[224:225], 0
    v_mov_b64 v[226:227], 0
    v_mov_b64 v[228:229], 0
    v_mov_b64 v[230:231], 0
    v_mov_b64 v[232:233], 0
    v_mov_b64 v[234:235], 0
    v_mov_b64 v[236:237], 0
    v_mov_b64 v[238:239], 0
    v_mov_b64 v[240:241], 0
    v_mov_b64 v[242:243], 0
    v_mov_b64 v[244:245], 0
    v_mov_b64 v[246:247], 0
    v_mov_b64 v[248:249], 0
    v_mov_b64 v[250:251], 0
    v_mov_b64 v[252:253], 0
    v_mov_b64 v[254:255], 0
    buffer_load_dwordx4 v[116:119], v7, s[8:11], s32 offen offset:2048 sc1
    s_mov_b32 s35, 0
    s_waitcnt vmcnt(14)
    s_cmp_eq_u32 s30, 0
    s_cbranch_scc1 L_recurrent_scan__compressed_kv_cla__moe_arch_mod__prompt_kernel_rare_64
L_recurrent_scan__compressed_kv_cla__moe_arch_mod__prompt_kernel_back_65:
    .p2align 6
L_p2_loop:
    s_cmp_ge_u32 s35, 2
    s_cbranch_scc1 L_recurrent_scan__compressed_kv_cla__moe_arch_mod__prompt_kernel_rare_54
L_recurrent_scan__compressed_kv_cla__moe_arch_mod__prompt_kernel_back_55:
    s_waitcnt lgkmcnt(8)
    s_waitcnt vmcnt(23)
    v_mfma_f32_16x16x32_bf16 v[192:195], v[64:67], v[24:27], v[192:195]
    ds_read_b64_tr_b16 v[88:89], v16 offset:0
    v_mfma_f32_16x16x32_bf16 v[224:227], v[64:67], v[28:31], v[224:227]
    ds_read_b64_tr_b16 v[90:91], v16 offset:1024
    v_mfma_f32_16x16x32_bf16 v[196:199], v[68:71], v[24:27], v[196:199]
    ds_read_b64_tr_b16 v[92:93], v17 offset:0
    buffer_load_dwordx4 v[120:123], v6, s[8:11], s32 offen offset:3072 sc1
    v_mfma_f32_16x16x32_bf16 v[228:231], v[68:71], v[28:31], v[228:231]
    ds_read_b64_tr_b16 v[94:95], v17 offset:1024
    s_waitcnt lgkmcnt(8)
    v_mfma_f32_16x16x32_bf16 v[200:203], v[72:75], v[24:27], v[200:203]
    ds_read_b64_tr_b16 v[64:65], v10 offset:8192
    v_mfma_f32_16x16x32_bf16 v[232:235], v[72:75], v[28:31], v[232:235]
    ds_read_b64_tr_b16 v[66:67], v10 offset:9216
    v_mfma_f32_16x16x32_bf16 v[204:207], v[76:79], v[24:27], v[204:207]
    ds_read_b64_tr_b16 v[68:69], v11 offset:8192
    buffer_load_dwordx4 v[124:127], v7, s[8:11], s32 offen offset:3072 sc1
    v_mfma_f32_16x16x32_bf16 v[236:239], v[76:79], v[28:31], v[236:239]
    ds_read_b64_tr_b16 v[70:71], v11 offset:9216
    s_add_u32 s32, s32, 4096
    s_waitcnt lgkmcnt(8)
    v_mfma_f32_16x16x32_bf16 v[208:211], v[80:83], v[24:27], v[208:211]
    ds_read_b64_tr_b16 v[72:73], v12 offset:8192
    s_cmp_lt_u32 s35, 3
    s_cselect_b32 s10, 4194304, 0
    v_mfma_f32_16x16x32_bf16 v[240:243], v[80:83], v[28:31], v[240:243]
    ds_read_b64_tr_b16 v[74:75], v12 offset:9216
    s_cmp_lt_u32 s35, s52
    s_cselect_b32 s18, s18, 0
    v_mfma_f32_16x16x32_bf16 v[212:215], v[84:87], v[24:27], v[212:215]
    ds_read_b64_tr_b16 v[76:77], v13 offset:8192
    buffer_store_dwordx4 v[128:131], v58, s[16:19], s38 offen sc1
    v_mfma_f32_16x16x32_bf16 v[244:247], v[84:87], v[28:31], v[244:247]
    ds_read_b64_tr_b16 v[78:79], v13 offset:9216
    s_waitcnt lgkmcnt(8)
    v_mfma_f32_16x16x32_bf16 v[216:219], v[88:91], v[24:27], v[216:219]
    ds_read_b64_tr_b16 v[80:81], v14 offset:8192
    v_mov_b64 v[128:129], v[144:145]
    v_mfma_f32_16x16x32_bf16 v[248:251], v[88:91], v[28:31], v[248:251]
    ds_read_b64_tr_b16 v[82:83], v14 offset:9216
    v_mfma_f32_16x16x32_bf16 v[220:223], v[92:95], v[24:27], v[220:223]
    ds_read_b64_tr_b16 v[84:85], v15 offset:8192
    v_mov_b64 v[130:131], v[146:147]
    v_mfma_f32_16x16x32_bf16 v[252:255], v[92:95], v[28:31], v[252:255]
    ds_read_b64_tr_b16 v[86:87], v15 offset:9216
    s_waitcnt lgkmcnt(8)
    s_waitcnt vmcnt(23)
    v_mfma_f32_16x16x32_bf16 v[192:195], v[64:67], v[32:35], v[192:195]
    ds_read_b64_tr_b16 v[88:89], v16 offset:8192
    v_mov_b64 v[144:145], v[160:161]
    v_mfma_f32_16x16x32_bf16 v[224:227], v[64:67], v[36:39], v[224:227]
    ds_read_b64_tr_b16 v[90:91], v16 offset:9216
    v_mfma_f32_16x16x32_bf16 v[196:199], v[68:71], v[32:35], v[196:199]
    ds_read_b64_tr_b16 v[92:93], v17 offset:8192
    buffer_load_dwordx4 v[24:27], v6, s[8:11], s32 offen offset:0 sc1
    v_mov_b64 v[146:147], v[162:163]
    v_mfma_f32_16x16x32_bf16 v[228:231], v[68:71], v[36:39], v[228:231]
    ds_read_b64_tr_b16 v[94:95], v17 offset:9216
    s_waitcnt lgkmcnt(8)
    v_mfma_f32_16x16x32_bf16 v[200:203], v[72:75], v[32:35], v[200:203]
    ds_read_b64_tr_b16 v[64:65], v10 offset:16384
    v_mov_b64 v[160:161], v[176:177]
    v_mfma_f32_16x16x32_bf16 v[232:235], v[72:75], v[36:39], v[232:235]
    ds_read_b64_tr_b16 v[66:67], v10 offset:17408
    v_mfma_f32_16x16x32_bf16 v[204:207], v[76:79], v[32:35], v[204:207]
    ds_read_b64_tr_b16 v[68:69], v11 offset:16384
    buffer_load_dwordx4 v[28:31], v7, s[8:11], s32 offen offset:0 sc1
    v_mov_b64 v[162:163], v[178:179]
    v_mfma_f32_16x16x32_bf16 v[236:239], v[76:79], v[36:39], v[236:239]
    ds_read_b64_tr_b16 v[70:71], v11 offset:17408
    s_waitcnt lgkmcnt(8)
    v_mfma_f32_16x16x32_bf16 v[208:211], v[80:83], v[32:35], v[208:211]
    ds_read_b64_tr_b16 v[72:73], v12 offset:16384
    v_mfma_f32_16x16x32_bf16 v[240:243], v[80:83], v[36:39], v[240:243]
    ds_read_b64_tr_b16 v[74:75], v12 offset:17408
    v_mfma_f32_16x16x32_bf16 v[212:215], v[84:87], v[32:35], v[212:215]
    ds_read_b64_tr_b16 v[76:77], v13 offset:16384
    v_mfma_f32_16x16x32_bf16 v[244:247], v[84:87], v[36:39], v[244:247]
    ds_read_b64_tr_b16 v[78:79], v13 offset:17408
    s_waitcnt lgkmcnt(8)
    v_mfma_f32_16x16x32_bf16 v[216:219], v[88:91], v[32:35], v[216:219]
    ds_read_b64_tr_b16 v[80:81], v14 offset:16384
    v_mfma_f32_16x16x32_bf16 v[248:251], v[88:91], v[36:39], v[248:251]
    ds_read_b64_tr_b16 v[82:83], v14 offset:17408
    v_mfma_f32_16x16x32_bf16 v[220:223], v[92:95], v[32:35], v[220:223]
    ds_read_b64_tr_b16 v[84:85], v15 offset:16384
    buffer_store_dwordx4 v[132:135], v59, s[16:19], s38 offen sc1
    v_mfma_f32_16x16x32_bf16 v[252:255], v[92:95], v[36:39], v[252:255]
    ds_read_b64_tr_b16 v[86:87], v15 offset:17408
    s_waitcnt lgkmcnt(8)
    s_waitcnt vmcnt(24)
    v_mfma_f32_16x16x32_bf16 v[192:195], v[64:67], v[40:43], v[192:195]
    ds_read_b64_tr_b16 v[88:89], v16 offset:16384
    v_mov_b64 v[132:133], v[148:149]
    v_mfma_f32_16x16x32_bf16 v[224:227], v[64:67], v[44:47], v[224:227]
    ds_read_b64_tr_b16 v[90:91], v16 offset:17408
    v_mfma_f32_16x16x32_bf16 v[196:199], v[68:71], v[40:43], v[196:199]
    ds_read_b64_tr_b16 v[92:93], v17 offset:16384
    buffer_load_dwordx4 v[32:35], v6, s[8:11], s32 offen offset:1024 sc1
    v_mov_b64 v[134:135], v[150:151]
    v_mfma_f32_16x16x32_bf16 v[228:231], v[68:71], v[44:47], v[228:231]
    ds_read_b64_tr_b16 v[94:95], v17 offset:17408
    s_waitcnt lgkmcnt(8)
    v_mfma_f32_16x16x32_bf16 v[200:203], v[72:75], v[40:43], v[200:203]
    ds_read_b64_tr_b16 v[64:65], v10 offset:24576
    v_mov_b64 v[148:149], v[164:165]
    v_mfma_f32_16x16x32_bf16 v[232:235], v[72:75], v[44:47], v[232:235]
    ds_read_b64_tr_b16 v[66:67], v10 offset:25600
    v_mfma_f32_16x16x32_bf16 v[204:207], v[76:79], v[40:43], v[204:207]
    ds_read_b64_tr_b16 v[68:69], v11 offset:24576
    buffer_load_dwordx4 v[36:39], v7, s[8:11], s32 offen offset:1024 sc1
    v_mov_b64 v[150:151], v[166:167]
    v_mfma_f32_16x16x32_bf16 v[236:239], v[76:79], v[44:47], v[236:239]
    ds_read_b64_tr_b16 v[70:71], v11 offset:25600
    s_waitcnt lgkmcnt(8)
    v_mfma_f32_16x16x32_bf16 v[208:211], v[80:83], v[40:43], v[208:211]
    ds_read_b64_tr_b16 v[72:73], v12 offset:24576
    v_mov_b64 v[164:165], v[180:181]
    v_mfma_f32_16x16x32_bf16 v[240:243], v[80:83], v[44:47], v[240:243]
    ds_read_b64_tr_b16 v[74:75], v12 offset:25600
    v_mfma_f32_16x16x32_bf16 v[212:215], v[84:87], v[40:43], v[212:215]
    ds_read_b64_tr_b16 v[76:77], v13 offset:24576
    v_mov_b64 v[166:167], v[182:183]
    v_mfma_f32_16x16x32_bf16 v[244:247], v[84:87], v[44:47], v[244:247]
    ds_read_b64_tr_b16 v[78:79], v13 offset:25600
    s_waitcnt lgkmcnt(8)
    v_mfma_f32_16x16x32_bf16 v[216:219], v[88:91], v[40:43], v[216:219]
    ds_read_b64_tr_b16 v[80:81], v14 offset:24576
    v_mfma_f32_16x16x32_bf16 v[248:251], v[88:91], v[44:47], v[248:251]
    ds_read_b64_tr_b16 v[82:83], v14 offset:25600
    v_mfma_f32_16x16x32_bf16 v[220:223], v[92:95], v[40:43], v[220:223]
    ds_read_b64_tr_b16 v[84:85], v15 offset:24576
    v_mfma_f32_16x16x32_bf16 v[252:255], v[92:95], v[44:47], v[252:255]
    ds_read_b64_tr_b16 v[86:87], v15 offset:25600
    s_waitcnt lgkmcnt(8)
    s_waitcnt vmcnt(20)
    v_mfma_f32_16x16x32_bf16 v[192:195], v[64:67], v[48:51], v[192:195]
    ds_read_b64_tr_b16 v[88:89], v16 offset:24576
    v_mfma_f32_16x16x32_bf16 v[224:227], v[64:67], v[52:55], v[224:227]
    ds_read_b64_tr_b16 v[90:91], v16 offset:25600
    v_mfma_f32_16x16x32_bf16 v[196:199], v[68:71], v[48:51], v[196:199]
    ds_read_b64_tr_b16 v[92:93], v17 offset:24576
    buffer_load_dwordx4 v[40:43], v6, s[8:11], s32 offen offset:2048 sc1
    v_mfma_f32_16x16x32_bf16 v[228:231], v[68:71], v[52:55], v[228:231]
    ds_read_b64_tr_b16 v[94:95], v17 offset:25600
    s_waitcnt lgkmcnt(8)
    v_mfma_f32_16x16x32_bf16 v[200:203], v[72:75], v[48:51], v[200:203]
    v_mfma_f32_16x16x32_bf16 v[232:235], v[72:75], v[52:55], v[232:235]
    v_mfma_f32_16x16x32_bf16 v[204:207], v[76:79], v[48:51], v[204:207]
    buffer_load_dwordx4 v[44:47], v7, s[8:11], s32 offen offset:2048 sc1
    v_mfma_f32_16x16x32_bf16 v[236:239], v[76:79], v[52:55], v[236:239]
    s_cmp_ge_u32 s35, 2
    s_cbranch_scc1 L_recurrent_scan__compressed_kv_cla__moe_arch_mod__prompt_kernel_rare_48
L_recurrent_scan__compressed_kv_cla__moe_arch_mod__prompt_kernel_back_49:
    s_waitcnt lgkmcnt(0)
    s_waitcnt vmcnt(20)
    s_cmp_eq_u32 s35, s52
    s_cbranch_scc1 L_recurrent_scan__compressed_kv_cla__moe_arch_mod__prompt_kernel_rare_62
L_recurrent_scan__compressed_kv_cla__moe_arch_mod__prompt_kernel_back_63:
    s_barrier
    v_mfma_f32_16x16x32_bf16 v[208:211], v[80:83], v[48:51], v[208:211]
    ds_read_b64_tr_b16 v[64:65], v10 offset:32768
    ds_read_b64_tr_b16 v[66:67], v10 offset:33792
    v_mfma_f32_16x16x32_bf16 v[240:243], v[80:83], v[52:55], v[240:243]
    ds_read_b64_tr_b16 v[68:69], v11 offset:32768
    ds_read_b64_tr_b16 v[70:71], v11 offset:33792
    v_mfma_f32_16x16x32_bf16 v[212:215], v[84:87], v[48:51], v[212:215]
    ds_read_b64_tr_b16 v[72:73], v12 offset:32768
    ds_read_b64_tr_b16 v[74:75], v12 offset:33792
    v_mfma_f32_16x16x32_bf16 v[244:247], v[84:87], v[52:55], v[244:247]
    ds_read_b64_tr_b16 v[76:77], v13 offset:32768
    ds_read_b64_tr_b16 v[78:79], v13 offset:33792
    s_add_u32 m0, s34, 0
    v_mfma_f32_16x16x32_bf16 v[216:219], v[88:91], v[48:51], v[216:219]
    ds_read_b64_tr_b16 v[80:81], v14 offset:32768
    ds_read_b64_tr_b16 v[82:83], v14 offset:33792
    buffer_load_dwordx4 v2, s[4:7], s31 offen offset:0 sc1 lds
    v_mfma_f32_16x16x32_bf16 v[248:251], v[88:91], v[52:55], v[248:251]
    buffer_load_dwordx4 v3, s[4:7], s31 offen offset:1024 sc1 lds
    v_mfma_f32_16x16x32_bf16 v[220:223], v[92:95], v[48:51], v[220:223]
    ds_read_b64_tr_b16 v[84:85], v15 offset:32768
    ds_read_b64_tr_b16 v[86:87], v15 offset:33792
    buffer_load_dwordx4 v4, s[4:7], s31 offen offset:2048 sc1 lds
    v_mfma_f32_16x16x32_bf16 v[252:255], v[92:95], v[52:55], v[252:255]
    buffer_load_dwordx4 v5, s[4:7], s31 offen offset:3072 sc1 lds
    s_add_u32 s31, s31, s40
    s_cmp_ge_u32 s35, 2
    s_cbranch_scc1 L_recurrent_scan__compressed_kv_cla__moe_arch_mod__prompt_kernel_rare_60
L_recurrent_scan__compressed_kv_cla__moe_arch_mod__prompt_kernel_back_61:
    s_waitcnt lgkmcnt(8)
    s_waitcnt vmcnt(18)
    v_mfma_f32_16x16x32_bf16 v[192:195], v[64:67], v[96:99], v[192:195]
    ds_read_b64_tr_b16 v[88:89], v16 offset:32768
    v_mfma_f32_16x16x32_bf16 v[224:227], v[64:67], v[100:103], v[224:227]
    ds_read_b64_tr_b16 v[90:91], v16 offset:33792
    v_mfma_f32_16x16x32_bf16 v[196:199], v[68:71], v[96:99], v[196:199]
    ds_read_b64_tr_b16 v[92:93], v17 offset:32768
    buffer_load_dwordx4 v[48:51], v6, s[8:11], s32 offen offset:3072 sc1
    v_mfma_f32_16x16x32_bf16 v[228:231], v[68:71], v[100:103], v[228:231]
    ds_read_b64_tr_b16 v[94:95], v17 offset:33792
    s_waitcnt lgkmcnt(8)
    v_mfma_f32_16x16x32_bf16 v[200:203], v[72:75], v[96:99], v[200:203]
    ds_read_b64_tr_b16 v[64:65], v10 offset:40960
    v_mfma_f32_16x16x32_bf16 v[232:235], v[72:75], v[100:103], v[232:235]
    ds_read_b64_tr_b16 v[66:67], v10 offset:41984
    v_mfma_f32_16x16x32_bf16 v[204:207], v[76:79], v[96:99], v[204:207]
    ds_read_b64_tr_b16 v[68:69], v11 offset:40960
    buffer_load_dwordx4 v[52:55], v7, s[8:11], s32 offen offset:3072 sc1
    v_mfma_f32_16x16x32_bf16 v[236:239], v[76:79], v[100:103], v[236:239]
    ds_read_b64_tr_b16 v[70:71], v11 offset:41984
    s_add_u32 s32, s32, 4096
    s_waitcnt lgkmcnt(8)
    v_mfma_f32_16x16x32_bf16 v[208:211], v[80:83], v[96:99], v[208:211]
    ds_read_b64_tr_b16 v[72:73], v12 offset:40960
    v_mfma_f32_16x16x32_bf16 v[240:243], v[80:83], v[100:103], v[240:243]
    ds_read_b64_tr_b16 v[74:75], v12 offset:41984
    v_mfma_f32_16x16x32_bf16 v[212:215], v[84:87], v[96:99], v[212:215]
    ds_read_b64_tr_b16 v[76:77], v13 offset:40960
    buffer_store_dwordx4 v[136:139], v60, s[16:19], s38 offen sc1
    v_mfma_f32_16x16x32_bf16 v[244:247], v[84:87], v[100:103], v[244:247]
    ds_read_b64_tr_b16 v[78:79], v13 offset:41984
    s_waitcnt lgkmcnt(8)
    v_mfma_f32_16x16x32_bf16 v[216:219], v[88:91], v[96:99], v[216:219]
    ds_read_b64_tr_b16 v[80:81], v14 offset:40960
    v_mov_b64 v[136:137], v[152:153]
    v_mfma_f32_16x16x32_bf16 v[248:251], v[88:91], v[100:103], v[248:251]
    ds_read_b64_tr_b16 v[82:83], v14 offset:41984
    v_mfma_f32_16x16x32_bf16 v[220:223], v[92:95], v[96:99], v[220:223]
    ds_read_b64_tr_b16 v[84:85], v15 offset:40960
    v_mov_b64 v[138:139], v[154:155]
    v_mfma_f32_16x16x32_bf16 v[252:255], v[92:95], v[100:103], v[252:255]
    ds_read_b64_tr_b16 v[86:87], v15 offset:41984
    s_waitcnt lgkmcnt(8)
    s_waitcnt vmcnt(19)
    v_mfma_f32_16x16x32_bf16 v[192:195], v[64:67], v[104:107], v[192:195]
    ds_read_b64_tr_b16 v[88:89], v16 offset:40960
    v_mov_b64 v[152:153], v[168:169]
    v_mfma_f32_16x16x32_bf16 v[224:227], v[64:67], v[108:111], v[224:227]
    ds_read_b64_tr_b16 v[90:91], v16 offset:41984
    v_mfma_f32_16x16x32_bf16 v[196:199], v[68:71], v[104:107], v[196:199]
    ds_read_b64_tr_b16 v[92:93], v17 offset:40960
    buffer_load_dwordx4 v[96:99], v6, s[8:11], s32 offen offset:0 sc1
    v_mov_b64 v[154:155], v[170:171]
    v_mfma_f32_16x16x32_bf16 v[228:231], v[68:71], v[108:111], v[228:231]
    ds_read_b64_tr_b16 v[94:95], v17 offset:41984
    s_waitcnt lgkmcnt(8)
    v_mfma_f32_16x16x32_bf16 v[200:203], v[72:75], v[104:107], v[200:203]
    ds_read_b64_tr_b16 v[64:65], v10 offset:49152
    v_mov_b64 v[168:169], v[184:185]
    v_mfma_f32_16x16x32_bf16 v[232:235], v[72:75], v[108:111], v[232:235]
    ds_read_b64_tr_b16 v[66:67], v10 offset:50176
    v_mfma_f32_16x16x32_bf16 v[204:207], v[76:79], v[104:107], v[204:207]
    ds_read_b64_tr_b16 v[68:69], v11 offset:49152
    buffer_load_dwordx4 v[100:103], v7, s[8:11], s32 offen offset:0 sc1
    v_mov_b64 v[170:171], v[186:187]
    v_mfma_f32_16x16x32_bf16 v[236:239], v[76:79], v[108:111], v[236:239]
    ds_read_b64_tr_b16 v[70:71], v11 offset:50176
    s_waitcnt lgkmcnt(8)
    v_mfma_f32_16x16x32_bf16 v[208:211], v[80:83], v[104:107], v[208:211]
    ds_read_b64_tr_b16 v[72:73], v12 offset:49152
    v_mfma_f32_16x16x32_bf16 v[240:243], v[80:83], v[108:111], v[240:243]
    ds_read_b64_tr_b16 v[74:75], v12 offset:50176
    v_mfma_f32_16x16x32_bf16 v[212:215], v[84:87], v[104:107], v[212:215]
    ds_read_b64_tr_b16 v[76:77], v13 offset:49152
    v_mfma_f32_16x16x32_bf16 v[244:247], v[84:87], v[108:111], v[244:247]
    ds_read_b64_tr_b16 v[78:79], v13 offset:50176
    s_waitcnt lgkmcnt(8)
    v_mfma_f32_16x16x32_bf16 v[216:219], v[88:91], v[104:107], v[216:219]
    ds_read_b64_tr_b16 v[80:81], v14 offset:49152
    v_mfma_f32_16x16x32_bf16 v[248:251], v[88:91], v[108:111], v[248:251]
    ds_read_b64_tr_b16 v[82:83], v14 offset:50176
    v_mfma_f32_16x16x32_bf16 v[220:223], v[92:95], v[104:107], v[220:223]
    ds_read_b64_tr_b16 v[84:85], v15 offset:49152
    buffer_store_dwordx4 v[140:143], v61, s[16:19], s38 offen sc1
    v_mfma_f32_16x16x32_bf16 v[252:255], v[92:95], v[108:111], v[252:255]
    ds_read_b64_tr_b16 v[86:87], v15 offset:50176
    s_add_u32 s38, s38, s39
    s_waitcnt lgkmcnt(8)
    s_waitcnt vmcnt(20)
    v_mfma_f32_16x16x32_bf16 v[192:195], v[64:67], v[112:115], v[192:195]
    ds_read_b64_tr_b16 v[88:89], v16 offset:49152
    v_mov_b64 v[140:141], v[156:157]
    v_mfma_f32_16x16x32_bf16 v[224:227], v[64:67], v[116:119], v[224:227]
    ds_read_b64_tr_b16 v[90:91], v16 offset:50176
    v_mfma_f32_16x16x32_bf16 v[196:199], v[68:71], v[112:115], v[196:199]
    ds_read_b64_tr_b16 v[92:93], v17 offset:49152
    buffer_load_dwordx4 v[104:107], v6, s[8:11], s32 offen offset:1024 sc1
    v_mov_b64 v[142:143], v[158:159]
    v_mfma_f32_16x16x32_bf16 v[228:231], v[68:71], v[116:119], v[228:231]
    ds_read_b64_tr_b16 v[94:95], v17 offset:50176
    s_waitcnt lgkmcnt(8)
    v_mfma_f32_16x16x32_bf16 v[200:203], v[72:75], v[112:115], v[200:203]
    ds_read_b64_tr_b16 v[64:65], v10 offset:57344
    v_mov_b64 v[156:157], v[172:173]
    v_mfma_f32_16x16x32_bf16 v[232:235], v[72:75], v[116:119], v[232:235]
    ds_read_b64_tr_b16 v[66:67], v10 offset:58368
    v_xor_b32 v10, 65536, v10
    v_mfma_f32_16x16x32_bf16 v[204:207], v[76:79], v[112:115], v[204:207]
    ds_read_b64_tr_b16 v[68:69], v11 offset:57344
    buffer_load_dwordx4 v[108:111], v7, s[8:11], s32 offen offset:1024 sc1
    v_mov_b64 v[158:159], v[174:175]
    v_mfma_f32_16x16x32_bf16 v[236:239], v[76:79], v[116:119], v[236:239]
    ds_read_b64_tr_b16 v[70:71], v11 offset:58368
    v_xor_b32 v11, 65536, v11
    s_waitcnt lgkmcnt(8)
    v_mfma_f32_16x16x32_bf16 v[208:211], v[80:83], v[112:115], v[208:211]
    ds_read_b64_tr_b16 v[72:73], v12 offset:57344
    v_mov_b64 v[172:173], v[188:189]
    v_mfma_f32_16x16x32_bf16 v[240:243], v[80:83], v[116:119], v[240:243]
    ds_read_b64_tr_b16 v[74:75], v12 offset:58368
    v_xor_b32 v12, 65536, v12
    v_mfma_f32_16x16x32_bf16 v[212:215], v[84:87], v[112:115], v[212:215]
    ds_read_b64_tr_b16 v[76:77], v13 offset:57344
    v_mov_b64 v[174:175], v[190:191]
    v_mfma_f32_16x16x32_bf16 v[244:247], v[84:87], v[116:119], v[244:247]
    ds_read_b64_tr_b16 v[78:79], v13 offset:58368
    v_xor_b32 v13, 65536, v13
    s_waitcnt lgkmcnt(8)
    v_mfma_f32_16x16x32_bf16 v[216:219], v[88:91], v[112:115], v[216:219]
    ds_read_b64_tr_b16 v[80:81], v14 offset:57344
    v_mfma_f32_16x16x32_bf16 v[248:251], v[88:91], v[116:119], v[248:251]
    ds_read_b64_tr_b16 v[82:83], v14 offset:58368
    v_xor_b32 v14, 65536, v14
    v_mfma_f32_16x16x32_bf16 v[220:223], v[92:95], v[112:115], v[220:223]
    ds_read_b64_tr_b16 v[84:85], v15 offset:57344
    v_mfma_f32_16x16x32_bf16 v[252:255], v[92:95], v[116:119], v[252:255]
    ds_read_b64_tr_b16 v[86:87], v15 offset:58368
    v_xor_b32 v15, 65536, v15
    s_waitcnt lgkmcnt(8)
    s_waitcnt vmcnt(20)
    v_mfma_f32_16x16x32_bf16 v[192:195], v[64:67], v[120:123], v[192:195]
    ds_read_b64_tr_b16 v[88:89], v16 offset:57344
    v_mfma_f32_16x16x32_bf16 v[224:227], v[64:67], v[124:127], v[224:227]
    ds_read_b64_tr_b16 v[90:91], v16 offset:58368
    v_xor_b32 v16, 65536, v16
    v_mfma_f32_16x16x32_bf16 v[196:199], v[68:71], v[120:123], v[196:199]
    ds_read_b64_tr_b16 v[92:93], v17 offset:57344
    buffer_load_dwordx4 v[112:115], v6, s[8:11], s32 offen offset:2048 sc1
    v_mfma_f32_16x16x32_bf16 v[228:231], v[68:71], v[124:127], v[228:231]
    ds_read_b64_tr_b16 v[94:95], v17 offset:58368
    v_xor_b32 v17, 65536, v17
    s_waitcnt lgkmcnt(8)
    v_mfma_f32_16x16x32_bf16 v[200:203], v[72:75], v[120:123], v[200:203]
    v_mfma_f32_16x16x32_bf16 v[232:235], v[72:75], v[124:127], v[232:235]
    v_mfma_f32_16x16x32_bf16 v[204:207], v[76:79], v[120:123], v[204:207]
    buffer_load_dwordx4 v[116:119], v7, s[8:11], s32 offen offset:2048 sc1
    v_mfma_f32_16x16x32_bf16 v[236:239], v[76:79], v[124:127], v[236:239]
    s_waitcnt lgkmcnt(0)
    s_barrier
    v_mfma_f32_16x16x32_bf16 v[208:211], v[80:83], v[120:123], v[208:211]
    ds_read_b64_tr_b16 v[64:65], v10 offset:0
    ds_read_b64_tr_b16 v[66:67], v10 offset:1024
    v_mfma_f32_16x16x32_bf16 v[240:243], v[80:83], v[124:127], v[240:243]
    ds_read_b64_tr_b16 v[68:69], v11 offset:0
    ds_read_b64_tr_b16 v[70:71], v11 offset:1024
    v_mfma_f32_16x16x32_bf16 v[212:215], v[84:87], v[120:123], v[212:215]
    ds_read_b64_tr_b16 v[72:73], v12 offset:0
    ds_read_b64_tr_b16 v[74:75], v12 offset:1024
    v_mfma_f32_16x16x32_bf16 v[244:247], v[84:87], v[124:127], v[244:247]
    ds_read_b64_tr_b16 v[76:77], v13 offset:0
    ds_read_b64_tr_b16 v[78:79], v13 offset:1024
    s_add_u32 m0, s34, 32768
    v_mfma_f32_16x16x32_bf16 v[216:219], v[88:91], v[120:123], v[216:219]
    ds_read_b64_tr_b16 v[80:81], v14 offset:0
    ds_read_b64_tr_b16 v[82:83], v14 offset:1024
    buffer_load_dwordx4 v2, s[4:7], s31 offen offset:0 sc1 lds
    v_mfma_f32_16x16x32_bf16 v[248:251], v[88:91], v[124:127], v[248:251]
    buffer_load_dwordx4 v3, s[4:7], s31 offen offset:1024 sc1 lds
    v_mfma_f32_16x16x32_bf16 v[220:223], v[92:95], v[120:123], v[220:223]
    ds_read_b64_tr_b16 v[84:85], v15 offset:0
    ds_read_b64_tr_b16 v[86:87], v15 offset:1024
    buffer_load_dwordx4 v4, s[4:7], s31 offen offset:2048 sc1 lds
    v_mfma_f32_16x16x32_bf16 v[252:255], v[92:95], v[124:127], v[252:255]
    buffer_load_dwordx4 v5, s[4:7], s31 offen offset:3072 sc1 lds
    s_add_u32 s31, s31, s40
    s_xor_b32 s34, s34, 65536
    s_add_u32 s35, s35, 1
    s_cmp_lt_u32 s35, 4
    s_cbranch_scc1 L_p2_loop
    s_load_dwordx2 s[32:33], s[0:1], 40
    s_load_dwordx2 s[34:35], s[0:1], 80
    s_load_dwordx2 s[96:97], s[0:1], 0
    s_load_dwordx2 s[98:99], s[0:1], 88
    s_cmp_lt_u32 s28, 4
    s_cbranch_scc0 L_grp1
    v_mov_b32 v20, 1040356334
    v_mov_b32 v21, v20
    s_and_b32 s37, s28, 3
    s_lshl_b32 s37, s37, 13
    v_lshlrev_b32 v7, 4, v1
    v_add_u32 v4, s37, v7
    v_add_u32 v6, 4096, v4
    v_add_u32 v19, 131072, v4
    s_add_u32 s43, s37, 32768
    s_add_u32 s44, s37, 98304
    s_waitcnt vmcnt(4) lgkmcnt(0)
    v_pk_mul_f32 v[192:193], v[192:193], v[20:21]
    v_pk_mul_f32 v[194:195], v[194:195], v[20:21]
    v_pk_mul_f32 v[196:197], v[196:197], v[20:21]
    v_pk_mul_f32 v[198:199], v[198:199], v[20:21]
    v_cvt_pk_bf16_f32 v128, v192, v193
    v_cvt_pk_bf16_f32 v129, v194, v195
    v_cvt_pk_bf16_f32 v130, v196, v197
    v_cvt_pk_bf16_f32 v131, v198, v199
    ds_write_b128 v19, v[128:131] offset:0
    v_pk_mul_f32 v[200:201], v[200:201], v[20:21]
    v_pk_mul_f32 v[202:203], v[202:203], v[20:21]
    v_pk_mul_f32 v[204:205], v[204:205], v[20:21]
    v_pk_mul_f32 v[206:207], v[206:207], v[20:21]
    v_cvt_pk_bf16_f32 v132, v200, v201
    v_cvt_pk_bf16_f32 v133, v202, v203
    v_cvt_pk_bf16_f32 v134, v204, v205
    v_cvt_pk_bf16_f32 v135, v206, v207
    ds_write_b128 v19, v[132:135] offset:1024
    v_pk_mul_f32 v[208:209], v[208:209], v[20:21]
    v_pk_mul_f32 v[210:211], v[210:211], v[20:21]
    v_pk_mul_f32 v[212:213], v[212:213], v[20:21]
    v_pk_mul_f32 v[214:215], v[214:215], v[20:21]
    v_cvt_pk_bf16_f32 v136, v208, v209
    v_cvt_pk_bf16_f32 v137, v210, v211
    v_cvt_pk_bf16_f32 v138, v212, v213
    v_cvt_pk_bf16_f32 v139, v214, v215
    ds_write_b128 v19, v[136:139] offset:2048
    v_pk_mul_f32 v[216:217], v[216:217], v[20:21]
    v_pk_mul_f32 v[218:219], v[218:219], v[20:21]
    v_pk_mul_f32 v[220:221], v[220:221], v[20:21]
    v_pk_mul_f32 v[222:223], v[222:223], v[20:21]
    v_cvt_pk_bf16_f32 v140, v216, v217
    v_cvt_pk_bf16_f32 v141, v218, v219
    v_cvt_pk_bf16_f32 v142, v220, v221
    v_cvt_pk_bf16_f32 v143, v222, v223
    ds_write_b128 v19, v[140:143] offset:3072
    v_pk_mul_f32 v[224:225], v[224:225], v[20:21]
    v_pk_mul_f32 v[226:227], v[226:227], v[20:21]
    v_pk_mul_f32 v[228:229], v[228:229], v[20:21]
    v_pk_mul_f32 v[230:231], v[230:231], v[20:21]
    v_cvt_pk_bf16_f32 v144, v224, v225
    v_cvt_pk_bf16_f32 v145, v226, v227
    v_cvt_pk_bf16_f32 v146, v228, v229
    v_cvt_pk_bf16_f32 v147, v230, v231
    ds_write_b128 v19, v[144:147] offset:4096
    v_pk_mul_f32 v[232:233], v[232:233], v[20:21]
    v_pk_mul_f32 v[234:235], v[234:235], v[20:21]
    v_pk_mul_f32 v[236:237], v[236:237], v[20:21]
    v_pk_mul_f32 v[238:239], v[238:239], v[20:21]
    v_cvt_pk_bf16_f32 v148, v232, v233
    v_cvt_pk_bf16_f32 v149, v234, v235
    v_cvt_pk_bf16_f32 v150, v236, v237
    v_cvt_pk_bf16_f32 v151, v238, v239
    ds_write_b128 v19, v[148:151] offset:5120
    v_pk_mul_f32 v[240:241], v[240:241], v[20:21]
    v_pk_mul_f32 v[242:243], v[242:243], v[20:21]
    v_pk_mul_f32 v[244:245], v[244:245], v[20:21]
    v_pk_mul_f32 v[246:247], v[246:247], v[20:21]
    v_cvt_pk_bf16_f32 v152, v240, v241
    v_cvt_pk_bf16_f32 v153, v242, v243
    v_cvt_pk_bf16_f32 v154, v244, v245
    v_cvt_pk_bf16_f32 v155, v246, v247
    ds_write_b128 v19, v[152:155] offset:6144
    v_pk_mul_f32 v[248:249], v[248:249], v[20:21]
    v_pk_mul_f32 v[250:251], v[250:251], v[20:21]
    v_pk_mul_f32 v[252:253], v[252:253], v[20:21]
    v_pk_mul_f32 v[254:255], v[254:255], v[20:21]
    v_cvt_pk_bf16_f32 v156, v248, v249
    v_cvt_pk_bf16_f32 v157, v250, v251
    v_cvt_pk_bf16_f32 v158, v252, v253
    v_cvt_pk_bf16_f32 v159, v254, v255
    ds_write_b128 v19, v[156:159] offset:7168
    v_mov_b32 v2, v7
    v_and_b32 v21, 15, v1
    v_lshrrev_b32 v22, 4, v1
    v_lshlrev_b32 v22, 2, v22
    v_sub_u32 v18, v21, v22
    s_mov_b32 s40, 0
    s_mov_b32 s41, 16384
    s_mov_b32 s49, 0xffff
    s_lshl_b32 s51, s30, 1
    s_add_u32 s51, s51, 1
    s_and_b32 s50, s28, 3
    s_lshl_b32 s50, s50, 5
    v_mov_b32 v36, 0x3f803f80
    v_mov_b32 v37, 0x3f803f80
    v_mov_b32 v38, 0x3f803f80
    v_mov_b32 v39, 0x3f803f80
    s_lshl_b32 s31, 1, s51
    s_or_b32 s31, s31, 0x8000
    s_add_u32 s36, s51, 1
    s_lshl_b32 s36, -1, s36
    s_or_b32 s48, s36, 0xaaaaaaab
    s_and_b32 s48, s48, 0x7fff
    s_or_b32 s39, s36, 0x55555555
    s_and_b32 s39, s39, 0xffff
    s_add_u32 s46, s45, 65536
    s_add_u32 s47, s45, 98304
    s_mov_b64 s[52:53], 0
    s_waitcnt lgkmcnt(0)
    s_barrier
    s_add_u32 s16, s54, 41943040
    s_addc_u32 s17, s55, 0
    s_and_b32 s17, s17, 0xffff
    s_mov_b32 s18, 16777216
    s_mov_b32 s19, 0x20000
    s_mov_b32 s4, s92
    s_and_b32 s5, s93, 0xffff
    s_mov_b32 s6, 7340032
    s_mov_b32 s7, 0x20000
    s_mov_b32 s8, s94
    s_and_b32 s9, s95, 0xffff
    s_mov_b32 s10, 7340032
    s_mov_b32 s11, 0x20000
    s_and_b32 s60, s29, 3
    s_add_u32 s60, s60, 4
    s_sub_u32 s3, s2, 32
    s_cmp_eq_u32 s28, 0
    s_cselect_b32 s36, 0xad, 0x2d
    s_cselect_b32 s42, 14, 12
    s_cmp_lt_u32 s3, 224
    s_cselect_b32 s36, s36, 0
    s_lshl_b32 s36, s36, s60
    s_or_b32 s42, s42, s36
    ds_read_b128 v[64:67], v2 offset:0
    ds_read_b128 v[68:71], v2 offset:1024
    ds_read_b128 v[72:75], v2 offset:2048
    ds_read_b128 v[76:79], v2 offset:3072
    ds_read_b128 v[80:83], v2 offset:4096
    ds_read_b128 v[84:87], v2 offset:5120
    ds_read_b128 v[88:91], v2 offset:6144
    ds_read_b128 v[92:95], v2 offset:7168
    s_waitcnt lgkmcnt(7)
    v_mfma_f32_16x16x32_bf16 v[96:99], v[64:67], v[128:131], 0
    v_mov_b64 v[192:193], 0
    v_mov_b64 v[194:195], 0
    v_mfma_f32_16x16x32_bf16 v[104:107], v[64:67], v[144:147], 0
    ds_read_b128 v[64:67], v2 offset:8192
    v_mov_b64 v[196:197], 0
    v_mov_b64 v[198:199], 0
    s_waitcnt lgkmcnt(7)
    v_mfma_f32_16x16x32_bf16 v[96:99], v[68:71], v[132:135], v[96:99]
    v_mov_b64 v[200:201], 0
    v_mov_b64 v[202:203], 0
    v_mfma_f32_16x16x32_bf16 v[104:107], v[68:71], v[148:151], v[104:107]
    ds_read_b128 v[68:71], v2 offset:9216
    v_mov_b64 v[204:205], 0
    v_mov_b64 v[206:207], 0
    s_waitcnt lgkmcnt(7)
    v_mfma_f32_16x16x32_bf16 v[96:99], v[72:75], v[136:139], v[96:99]
    v_mov_b64 v[208:209], 0
    v_mfma_f32_16x16x32_bf16 v[104:107], v[72:75], v[152:155], v[104:107]
    ds_read_b128 v[72:75], v2 offset:10240
    v_mov_b64 v[210:211], 0
    v_mov_b64 v[212:213], 0
    s_waitcnt lgkmcnt(7)
    v_mfma_f32_16x16x32_bf16 v[96:99], v[76:79], v[140:143], v[96:99]
    v_mov_b64 v[214:215], 0
    v_mov_b64 v[216:217], 0
    v_mfma_f32_16x16x32_bf16 v[104:107], v[76:79], v[156:159], v[104:107]
    ds_read_b128 v[76:79], v2 offset:11264
    v_mov_b64 v[218:219], 0
    v_mov_b64 v[220:221], 0
    s_waitcnt lgkmcnt(7)
    v_mfma_f32_16x16x32_bf16 v[100:103], v[80:83], v[128:131], 0
    v_mov_b64 v[222:223], 0
    v_mov_b64 v[224:225], 0
    v_mfma_f32_16x16x32_bf16 v[108:111], v[80:83], v[144:147], 0
    ds_read_b128 v[80:83], v2 offset:12288
    v_mov_b64 v[226:227], 0
    s_waitcnt lgkmcnt(7)
    v_mfma_f32_16x16x32_bf16 v[100:103], v[84:87], v[132:135], v[100:103]
    v_mov_b64 v[228:229], 0
    v_mov_b64 v[230:231], 0
    v_mfma_f32_16x16x32_bf16 v[108:111], v[84:87], v[148:151], v[108:111]
    ds_read_b128 v[84:87], v2 offset:13312
    v_mov_b64 v[232:233], 0
    v_mov_b64 v[234:235], 0
    s_waitcnt lgkmcnt(7)
    v_mfma_f32_16x16x32_bf16 v[100:103], v[88:91], v[136:139], v[100:103]
    v_mov_b64 v[236:237], 0
    v_mov_b64 v[238:239], 0
    v_mfma_f32_16x16x32_bf16 v[108:111], v[88:91], v[152:155], v[108:111]
    ds_read_b128 v[88:91], v2 offset:14336
    v_mov_b64 v[240:241], 0
    v_mov_b64 v[242:243], 0
    s_waitcnt lgkmcnt(7)
    v_mfma_f32_16x16x32_bf16 v[100:103], v[92:95], v[140:143], v[100:103]
    v_mov_b64 v[244:245], 0
    v_mfma_f32_16x16x32_bf16 v[108:111], v[92:95], v[156:159], v[108:111]
    ds_read_b128 v[92:95], v2 offset:15360
    v_mov_b64 v[246:247], 0
    v_mov_b64 v[248:249], 0
    s_waitcnt lgkmcnt(7)
    v_mfma_f32_16x16x32_bf16 v[112:115], v[64:67], v[128:131], 0
    v_mov_b64 v[250:251], 0
    v_mov_b64 v[252:253], 0
    v_mfma_f32_16x16x32_bf16 v[120:123], v[64:67], v[144:147], 0
    v_mov_b64 v[254:255], 0
    v_mov_b64 v[28:29], 0
    s_waitcnt lgkmcnt(6)
    v_mfma_f32_16x16x32_bf16 v[112:115], v[68:71], v[132:135], v[112:115]
    v_mov_b64 v[30:31], 0
    v_mov_b64 v[32:33], 0
    v_mfma_f32_16x16x32_bf16 v[120:123], v[68:71], v[148:151], v[120:123]
    v_mov_b64 v[34:35], 0
    s_waitcnt lgkmcnt(5)
    v_mfma_f32_16x16x32_bf16 v[112:115], v[72:75], v[136:139], v[112:115]
    v_mfma_f32_16x16x32_bf16 v[120:123], v[72:75], v[152:155], v[120:123]
    v_max3_f32 v22, v96, v97, v98
    v_max3_f32 v23, v104, v105, v106
    s_waitcnt lgkmcnt(4)
    v_mfma_f32_16x16x32_bf16 v[112:115], v[76:79], v[140:143], v[112:115]
    v_max3_f32 v22, v22, v99, v100
    v_max3_f32 v23, v23, v107, v108
    v_mfma_f32_16x16x32_bf16 v[120:123], v[76:79], v[156:159], v[120:123]
    v_max3_f32 v22, v22, v101, v102
    v_max3_f32 v23, v23, v109, v110
    s_waitcnt lgkmcnt(3)
    v_mfma_f32_16x16x32_bf16 v[116:119], v[80:83], v[128:131], 0
    v_max_f32 v22, v22, v103
    v_max_f32 v23, v23, v111
    v_mfma_f32_16x16x32_bf16 v[124:127], v[80:83], v[144:147], 0
    v_mov_b32 v24, v22
    v_mov_b32 v25, v23
    s_waitcnt lgkmcnt(2)
    v_mfma_f32_16x16x32_bf16 v[116:119], v[84:87], v[132:135], v[116:119]
    v_permlane16_swap_b32 v22, v24
    v_permlane16_swap_b32 v23, v25
    v_mfma_f32_16x16x32_bf16 v[124:127], v[84:87], v[148:151], v[124:127]
    v_max_f32 v22, v22, v24
    v_max_f32 v23, v23, v25
    s_waitcnt lgkmcnt(1)
    v_mfma_f32_16x16x32_bf16 v[116:119], v[88:91], v[136:139], v[116:119]
    v_mov_b32 v24, v22
    v_mov_b32 v25, v23
    v_mfma_f32_16x16x32_bf16 v[124:127], v[88:91], v[152:155], v[124:127]
    v_permlane32_swap_b32 v22, v24
    v_permlane32_swap_b32 v23, v25
    s_waitcnt lgkmcnt(0)
    v_mfma_f32_16x16x32_bf16 v[116:119], v[92:95], v[140:143], v[116:119]
    v_max_f32 v22, v22, v24
    v_max_f32 v23, v23, v25
    v_mfma_f32_16x16x32_bf16 v[124:127], v[92:95], v[156:159], v[124:127]
    v_sub_f32 v40, 0, v22
    v_sub_f32 v41, 0, v22
    v_sub_f32 v42, 0, v22
    v_sub_f32 v43, 0, v22
    v_sub_f32 v44, 0, v23
    v_sub_f32 v45, 0, v23
    v_sub_f32 v46, 0, v23
    v_sub_f32 v47, 0, v23
    v_add_u32 v3, 65536, v2
    v_add_u32 v2, s41, v2
    v_and_b32 v2, s49, v2
    s_waitcnt vmcnt(0)
    s_barrier
    s_cmp_eq_u32 s28, 0
    s_cbranch_scc1 L_recurrent_scan__compressed_kv_cla__moe_arch_mod__prompt_kernel_rare_66
L_recurrent_scan__compressed_kv_cla__moe_arch_mod__prompt_kernel_back_67:
    ds_read_b128 v[64:67], v2 offset:0
    ds_read_b128 v[68:71], v2 offset:1024
    ds_read_b128 v[72:75], v2 offset:2048
    ds_read_b128 v[76:79], v2 offset:3072
    ds_read_b128 v[80:83], v2 offset:4096
    ds_read_b128 v[84:87], v2 offset:5120
    ds_read_b128 v[88:91], v2 offset:6144
    ds_write_b32 v19, v40
    ds_write_b32 v19, v44 offset:4
    v_pk_add_f32 v[96:97], v[96:97], v[40:41]
    v_pk_add_f32 v[98:99], v[98:99], v[40:41]
    v_pk_add_f32 v[100:101], v[100:101], v[40:41]
    v_pk_add_f32 v[102:103], v[102:103], v[40:41]
    v_pk_add_f32 v[104:105], v[104:105], v[44:45]
    v_pk_add_f32 v[106:107], v[106:107], v[44:45]
    v_pk_add_f32 v[108:109], v[108:109], v[44:45]
    v_pk_add_f32 v[110:111], v[110:111], v[44:45]
    v_pk_add_f32 v[112:113], v[112:113], v[40:41]
    v_pk_add_f32 v[114:115], v[114:115], v[40:41]
    v_pk_add_f32 v[116:117], v[116:117], v[40:41]
    v_pk_add_f32 v[118:119], v[118:119], v[40:41]
    v_pk_add_f32 v[120:121], v[120:121], v[44:45]
    v_pk_add_f32 v[122:123], v[122:123], v[44:45]
    v_pk_add_f32 v[124:125], v[124:125], v[44:45]
    v_pk_add_f32 v[126:127], v[126:127], v[44:45]
    v_exp_f32 v96, v96
    v_exp_f32 v97, v97
    v_exp_f32 v98, v98
    v_exp_f32 v99, v99
    v_exp_f32 v104, v104
    v_exp_f32 v105, v105
    v_exp_f32 v106, v106
    v_exp_f32 v107, v107
    v_exp_f32 v100, v100
    v_exp_f32 v101, v101
    v_exp_f32 v102, v102
    v_exp_f32 v103, v103
    v_exp_f32 v108, v108
    v_exp_f32 v109, v109
    v_exp_f32 v110, v110
    v_exp_f32 v111, v111
    v_cvt_pk_bf16_f32 v48, v96, v97
    v_cvt_pk_bf16_f32 v49, v98, v99
    v_cvt_pk_bf16_f32 v52, v104, v105
    v_cvt_pk_bf16_f32 v53, v106, v107
    v_cvt_pk_bf16_f32 v50, v100, v101
    v_cvt_pk_bf16_f32 v51, v102, v103
    v_cvt_pk_bf16_f32 v54, v108, v109
    v_cvt_pk_bf16_f32 v55, v110, v111
    .p2align 6
L_body0:
    s_waitcnt lgkmcnt(5)
    v_mfma_f32_16x16x32_bf16 v[96:99], v[64:67], v[128:131], v[40:43]
    v_exp_f32 v112, v112
    v_mfma_f32_16x16x32_bf16 v[104:107], v[64:67], v[144:147], v[44:47]
    ds_read_b128 v[92:95], v2 offset:7168
    s_bitcmp1_b32 s48, s40
    s_cbranch_scc0 L_recurrent_scan__compressed_kv_cla__moe_arch_mod__prompt_kernel_nodma_90
    s_add_u32 m0, s43, 0
    s_nop 0
    buffer_load_dwordx4 v4, s[12:15], s46 offen offset:0 sc1 lds
    buffer_load_dwordx4 v4, s[12:15], s46 offen offset:1024 sc1 lds
L_recurrent_scan__compressed_kv_cla__moe_arch_mod__prompt_kernel_nodma_90:
    v_mfma_f32_16x16x32_bf16 v[96:99], v[68:71], v[132:135], v[96:99]
    v_exp_f32 v113, v113
    v_mfma_f32_16x16x32_bf16 v[104:107], v[68:71], v[148:151], v[104:107]
    ds_read_b128 v[64:67], v3 offset:0
    s_waitcnt lgkmcnt(5)
    v_mfma_f32_16x16x32_bf16 v[96:99], v[72:75], v[136:139], v[96:99]
    v_exp_f32 v114, v114
    v_mfma_f32_16x16x32_bf16 v[104:107], v[72:75], v[152:155], v[104:107]
    ds_read_b128 v[68:71], v3 offset:1024
    v_cvt_pk_bf16_f32 v56, v112, v113
    s_bitcmp1_b32 s48, s40
    s_cbranch_scc0 L_recurrent_scan__compressed_kv_cla__moe_arch_mod__prompt_kernel_nodma_91
    s_add_u32 m0, s43, 0
    s_nop 0
    buffer_load_dwordx4 v4, s[12:15], s46 offen offset:2048 sc1 lds
    buffer_load_dwordx4 v4, s[12:15], s46 offen offset:3072 sc1 lds
L_recurrent_scan__compressed_kv_cla__moe_arch_mod__prompt_kernel_nodma_91:
    v_mfma_f32_16x16x32_bf16 v[96:99], v[76:79], v[140:143], v[96:99]
    v_exp_f32 v115, v115
    v_mfma_f32_16x16x32_bf16 v[104:107], v[76:79], v[156:159], v[104:107]
    ds_read_b128 v[72:75], v3 offset:2048
    s_waitcnt lgkmcnt(5)
    v_mfma_f32_16x16x32_bf16 v[100:103], v[80:83], v[128:131], v[40:43]
    v_exp_f32 v120, v120
    v_mfma_f32_16x16x32_bf16 v[108:111], v[80:83], v[144:147], v[44:47]
    ds_read_b128 v[76:79], v3 offset:3072
    v_cvt_pk_bf16_f32 v57, v114, v115
    v_mfma_f32_16x16x32_bf16 v[100:103], v[84:87], v[132:135], v[100:103]
    v_exp_f32 v121, v121
    v_mfma_f32_16x16x32_bf16 v[108:111], v[84:87], v[148:151], v[108:111]
    ds_read_b128 v[80:83], v3 offset:4096
    s_bitcmp1_b32 s48, s40
    s_cbranch_scc0 L_recurrent_scan__compressed_kv_cla__moe_arch_mod__prompt_kernel_nodma_92
    s_add_u32 m0, s43, 4096
    s_nop 0
    buffer_load_dwordx4 v6, s[12:15], s46 offen offset:0 sc1 lds
    buffer_load_dwordx4 v6, s[12:15], s46 offen offset:1024 sc1 lds
L_recurrent_scan__compressed_kv_cla__moe_arch_mod__prompt_kernel_nodma_92:
    s_waitcnt lgkmcnt(5)
    v_mfma_f32_16x16x32_bf16 v[100:103], v[88:91], v[136:139], v[100:103]
    v_exp_f32 v122, v122
    v_mfma_f32_16x16x32_bf16 v[108:111], v[88:91], v[152:155], v[108:111]
    ds_read_b128 v[84:87], v3 offset:5120
    v_cvt_pk_bf16_f32 v60, v120, v121
    v_mfma_f32_16x16x32_bf16 v[100:103], v[92:95], v[140:143], v[100:103]
    v_exp_f32 v123, v123
    v_mfma_f32_16x16x32_bf16 v[108:111], v[92:95], v[156:159], v[108:111]
    ds_read_b128 v[88:91], v3 offset:6144
    s_bitcmp1_b32 s48, s40
    s_cbranch_scc0 L_recurrent_scan__compressed_kv_cla__moe_arch_mod__prompt_kernel_nodma_93
    s_add_u32 m0, s43, 4096
    s_nop 0
    buffer_load_dwordx4 v6, s[12:15], s46 offen offset:2048 sc1 lds
    buffer_load_dwordx4 v6, s[12:15], s46 offen offset:3072 sc1 lds
    s_add_u32 s46, s46, 65536
    s_xor_b32 s43, s43, 32768
L_recurrent_scan__compressed_kv_cla__moe_arch_mod__prompt_kernel_nodma_93:
    s_waitcnt lgkmcnt(5)
    v_mfma_f32_16x16x32_bf16 v[192:195], v[64:67], v[48:51], v[192:195]
    v_exp_f32 v116, v116
    v_mfma_f32_16x16x32_bf16 v[224:227], v[64:67], v[52:55], v[224:227]
    ds_read_b128 v[92:95], v3 offset:7168
    v_cvt_pk_bf16_f32 v61, v122, v123
    v_mfma_f32_16x16x32_bf16 v[196:199], v[68:71], v[48:51], v[196:199]
    v_exp_f32 v117, v117
    v_mfma_f32_16x16x32_bf16 v[228:231], v[68:71], v[52:55], v[228:231]
    ds_read_b128 v[64:67], v2 offset:8192
    s_waitcnt lgkmcnt(5)
    v_mfma_f32_16x16x32_bf16 v[200:203], v[72:75], v[48:51], v[200:203]
    v_exp_f32 v118, v118
    v_mfma_f32_16x16x32_bf16 v[232:235], v[72:75], v[52:55], v[232:235]
    v_mfma_f32_16x16x32_bf16 v[28:31], v[36:39], v[48:51], v[28:31]
    ds_read_b128 v[68:71], v2 offset:9216
    v_cvt_pk_bf16_f32 v58, v116, v117
    s_bitcmp1_b32 s39, s40
    s_cbranch_scc0 L_recurrent_scan__compressed_kv_cla__moe_arch_mod__prompt_kernel_nodma_94
    s_add_u32 m0, s44, 0
    s_nop 0
    buffer_load_dwordx4 v4, s[12:15], s47 offen offset:0 sc1 lds
    buffer_load_dwordx4 v4, s[12:15], s47 offen offset:1024 sc1 lds
L_recurrent_scan__compressed_kv_cla__moe_arch_mod__prompt_kernel_nodma_94:
    v_mfma_f32_16x16x32_bf16 v[204:207], v[76:79], v[48:51], v[204:207]
    v_exp_f32 v119, v119
    v_mfma_f32_16x16x32_bf16 v[236:239], v[76:79], v[52:55], v[236:239]
    ds_read_b128 v[72:75], v2 offset:10240
    s_waitcnt lgkmcnt(5)
    v_mfma_f32_16x16x32_bf16 v[208:211], v[80:83], v[48:51], v[208:211]
    v_exp_f32 v124, v124
    v_mfma_f32_16x16x32_bf16 v[240:243], v[80:83], v[52:55], v[240:243]
    ds_read_b128 v[76:79], v2 offset:11264
    v_cvt_pk_bf16_f32 v59, v118, v119
    s_bitcmp1_b32 s39, s40
    s_cbranch_scc0 L_recurrent_scan__compressed_kv_cla__moe_arch_mod__prompt_kernel_nodma_95
    s_add_u32 m0, s44, 0
    s_nop 0
    buffer_load_dwordx4 v4, s[12:15], s47 offen offset:2048 sc1 lds
    buffer_load_dwordx4 v4, s[12:15], s47 offen offset:3072 sc1 lds
L_recurrent_scan__compressed_kv_cla__moe_arch_mod__prompt_kernel_nodma_95:
    v_mfma_f32_16x16x32_bf16 v[212:215], v[84:87], v[48:51], v[212:215]
    v_exp_f32 v125, v125
    v_mfma_f32_16x16x32_bf16 v[244:247], v[84:87], v[52:55], v[244:247]
    ds_read_b128 v[80:83], v2 offset:12288
    s_waitcnt lgkmcnt(5)
    v_mfma_f32_16x16x32_bf16 v[216:219], v[88:91], v[48:51], v[216:219]
    v_exp_f32 v126, v126
    v_mfma_f32_16x16x32_bf16 v[248:251], v[88:91], v[52:55], v[248:251]
    v_mfma_f32_16x16x32_bf16 v[32:35], v[36:39], v[52:55], v[32:35]
    ds_read_b128 v[84:87], v2 offset:13312
    v_cvt_pk_bf16_f32 v62, v124, v125
    v_mfma_f32_16x16x32_bf16 v[220:223], v[92:95], v[48:51], v[220:223]
    v_exp_f32 v127, v127
    v_mfma_f32_16x16x32_bf16 v[252:255], v[92:95], v[52:55], v[252:255]
    ds_read_b128 v[88:91], v2 offset:14336
    v_cvt_pk_bf16_f32 v63, v126, v127
    s_bitcmp1_b32 s39, s40
    s_cbranch_scc0 L_recurrent_scan__compressed_kv_cla__moe_arch_mod__prompt_kernel_nodma_96
    s_add_u32 m0, s44, 4096
    s_nop 0
    buffer_load_dwordx4 v6, s[12:15], s47 offen offset:0 sc1 lds
    buffer_load_dwordx4 v6, s[12:15], s47 offen offset:1024 sc1 lds
L_recurrent_scan__compressed_kv_cla__moe_arch_mod__prompt_kernel_nodma_96:
    s_bitcmp1_b32 s31, s40
    s_cbranch_scc1 L_recurrent_scan__compressed_kv_cla__moe_arch_mod__prompt_kernel_rare_72
L_recurrent_scan__compressed_kv_cla__moe_arch_mod__prompt_kernel_back_73:
    s_waitcnt lgkmcnt(5)
    v_mfma_f32_16x16x32_bf16 v[112:115], v[64:67], v[128:131], v[40:43]
    v_exp_f32 v96, v96
    v_mfma_f32_16x16x32_bf16 v[120:123], v[64:67], v[144:147], v[44:47]
    ds_read_b128 v[92:95], v2 offset:15360
    v_mfma_f32_16x16x32_bf16 v[112:115], v[68:71], v[132:135], v[112:115]
    v_exp_f32 v97, v97
    v_mfma_f32_16x16x32_bf16 v[120:123], v[68:71], v[148:151], v[120:123]
    ds_read_b128 v[64:67], v3 offset:8192
    s_bitcmp1_b32 s39, s40
    s_cbranch_scc0 L_recurrent_scan__compressed_kv_cla__moe_arch_mod__prompt_kernel_nodma_97
    s_add_u32 m0, s44, 4096
    s_nop 0
    buffer_load_dwordx4 v6, s[12:15], s47 offen offset:2048 sc1 lds
    buffer_load_dwordx4 v6, s[12:15], s47 offen offset:3072 sc1 lds
    s_add_u32 s47, s47, 65536
    s_xor_b32 s44, s44, 32768
L_recurrent_scan__compressed_kv_cla__moe_arch_mod__prompt_kernel_nodma_97:
    s_waitcnt lgkmcnt(5)
    v_mfma_f32_16x16x32_bf16 v[112:115], v[72:75], v[136:139], v[112:115]
    v_exp_f32 v98, v98
    v_mfma_f32_16x16x32_bf16 v[120:123], v[72:75], v[152:155], v[120:123]
    ds_read_b128 v[68:71], v3 offset:9216
    v_cvt_pk_bf16_f32 v48, v96, v97
    v_mfma_f32_16x16x32_bf16 v[112:115], v[76:79], v[140:143], v[112:115]
    v_exp_f32 v99, v99
    v_mfma_f32_16x16x32_bf16 v[120:123], v[76:79], v[156:159], v[120:123]
    ds_read_b128 v[72:75], v3 offset:10240
    s_waitcnt lgkmcnt(5)
    v_mfma_f32_16x16x32_bf16 v[116:119], v[80:83], v[128:131], v[40:43]
    v_exp_f32 v104, v104
    v_mfma_f32_16x16x32_bf16 v[124:127], v[80:83], v[144:147], v[44:47]
    ds_read_b128 v[76:79], v3 offset:11264
    v_cvt_pk_bf16_f32 v49, v98, v99
    v_mfma_f32_16x16x32_bf16 v[116:119], v[84:87], v[132:135], v[116:119]
    v_exp_f32 v105, v105
    v_mfma_f32_16x16x32_bf16 v[124:127], v[84:87], v[148:151], v[124:127]
    ds_read_b128 v[80:83], v3 offset:12288
    s_waitcnt lgkmcnt(5)
    v_mfma_f32_16x16x32_bf16 v[116:119], v[88:91], v[136:139], v[116:119]
    v_exp_f32 v106, v106
    v_mfma_f32_16x16x32_bf16 v[124:127], v[88:91], v[152:155], v[124:127]
    ds_read_b128 v[84:87], v3 offset:13312
    v_cvt_pk_bf16_f32 v52, v104, v105
    v_mfma_f32_16x16x32_bf16 v[116:119], v[92:95], v[140:143], v[116:119]
    v_exp_f32 v107, v107
    v_mfma_f32_16x16x32_bf16 v[124:127], v[92:95], v[156:159], v[124:127]
    ds_read_b128 v[88:91], v3 offset:14336
    s_waitcnt lgkmcnt(5)
    v_mfma_f32_16x16x32_bf16 v[192:195], v[64:67], v[56:59], v[192:195]
    v_exp_f32 v100, v100
    v_mfma_f32_16x16x32_bf16 v[224:227], v[64:67], v[60:63], v[224:227]
    ds_read_b128 v[92:95], v3 offset:15360
    v_cvt_pk_bf16_f32 v53, v106, v107
    v_mfma_f32_16x16x32_bf16 v[196:199], v[68:71], v[56:59], v[196:199]
    v_exp_f32 v101, v101
    v_mfma_f32_16x16x32_bf16 v[228:231], v[68:71], v[60:63], v[228:231]
    v_add_u32 v3, 65536, v2
    v_add_u32 v2, s41, v2
    s_waitcnt lgkmcnt(4)
    v_mfma_f32_16x16x32_bf16 v[200:203], v[72:75], v[56:59], v[200:203]
    v_exp_f32 v102, v102
    s_add_u32 s40, s40, 1
    v_and_b32 v2, s49, v2
    v_mfma_f32_16x16x32_bf16 v[232:235], v[72:75], v[60:63], v[232:235]
    v_mfma_f32_16x16x32_bf16 v[28:31], v[36:39], v[56:59], v[28:31]
    v_cvt_pk_bf16_f32 v50, v100, v101
    s_waitcnt vmcnt(8) lgkmcnt(0)
    s_cmp_le_u32 s40, s51
    s_cbranch_scc1 L_recurrent_scan__compressed_kv_cla__moe_arch_mod__prompt_kernel_rlx_74
    s_waitcnt vmcnt(0)
L_recurrent_scan__compressed_kv_cla__moe_arch_mod__prompt_kernel_rlx_74:
    s_bitcmp1_b32 s42, s40
    s_cbranch_scc1 L_recurrent_scan__compressed_kv_cla__moe_arch_mod__prompt_kernel_rare_88
L_recurrent_scan__compressed_kv_cla__moe_arch_mod__prompt_kernel_back_89:
    s_barrier
    v_mfma_f32_16x16x32_bf16 v[204:207], v[76:79], v[56:59], v[204:207]
    v_exp_f32 v103, v103
    v_mfma_f32_16x16x32_bf16 v[236:239], v[76:79], v[60:63], v[236:239]
    ds_read_b128 v[68:71], v2 offset:1024
    ds_read_b128 v[64:67], v2 offset:0
    v_mfma_f32_16x16x32_bf16 v[208:211], v[80:83], v[56:59], v[208:211]
    v_exp_f32 v108, v108
    v_mfma_f32_16x16x32_bf16 v[240:243], v[80:83], v[60:63], v[240:243]
    ds_read_b128 v[76:79], v2 offset:3072
    ds_read_b128 v[72:75], v2 offset:2048
    v_cvt_pk_bf16_f32 v51, v102, v103
    v_mfma_f32_16x16x32_bf16 v[212:215], v[84:87], v[56:59], v[212:215]
    v_exp_f32 v109, v109
    v_mfma_f32_16x16x32_bf16 v[244:247], v[84:87], v[60:63], v[244:247]
    ds_read_b128 v[80:83], v2 offset:4096
    v_mfma_f32_16x16x32_bf16 v[216:219], v[88:91], v[56:59], v[216:219]
    v_exp_f32 v110, v110
    v_mfma_f32_16x16x32_bf16 v[248:251], v[88:91], v[60:63], v[248:251]
    v_mfma_f32_16x16x32_bf16 v[32:35], v[36:39], v[60:63], v[32:35]
    ds_read_b128 v[84:87], v2 offset:5120
    v_cvt_pk_bf16_f32 v54, v108, v109
    v_mfma_f32_16x16x32_bf16 v[220:223], v[92:95], v[56:59], v[220:223]
    v_exp_f32 v111, v111
    v_mfma_f32_16x16x32_bf16 v[252:255], v[92:95], v[60:63], v[252:255]
    ds_read_b128 v[88:91], v2 offset:6144
    v_cvt_pk_bf16_f32 v55, v110, v111
    s_cmp_lg_u32 s40, 16
    s_cbranch_scc1 L_body0
    s_mov_b32 s4, s34
    s_and_b32 s5, s35, 0xffff
    s_mov_b32 s6, 7340032
    s_mov_b32 s7, 0x20000
    s_mov_b32 s8, s32
    s_and_b32 s9, s33, 0xffff
    s_mov_b32 s10, 8388608
    s_mov_b32 s11, 0x20000
    s_lshr_b32 s38, s2, 4
    s_mul_i32 s38, s38, 224
    s_and_b32 s39, s2, 15
    s_lshl_b32 s39, s39, 7
    v_lshrrev_b32 v25, 3, v1
    s_lshl_b32 s36, s28, 5
    s_add_u32 s36, s36, s38
    v_add_u32 v25, s36, v25
    v_mul_u32_u24 v25, 2048, v25
    v_add_u32 v25, s39, v25
    v_bfe_u32 v26, v1, 4, 1
    v_lshlrev_b32 v26, 1, v26
    v_and_b32 v27, 7, v1
    v_xor_b32 v26, v26, v27
    v_lshl_add_u32 v24, v26, 4, v25
    v_xor_b32 v26, 4, v26
    v_lshl_add_u32 v25, v26, 4, v25
    v_add_u32 v25, 15360, v25
    v_add_u32 v26, 30720, v24
    v_add_u32 v27, 30720, v25
    s_lshl_b32 s36, s28, 12
    s_add_u32 s36, s36, 131072
    s_cmp_lt_u32 s28, 7
    s_cselect_b32 m0, s36, 0x30000
    s_cselect_b32 s6, 7340032, 0
    buffer_load_dwordx4 v24, s[4:7], 0 offen offset:0 lds
    buffer_load_dwordx4 v25, s[4:7], 0 offen offset:1024 lds
    buffer_load_dwordx4 v26, s[4:7], 0 offen offset:2048 lds
    buffer_load_dwordx4 v27, s[4:7], 0 offen offset:3072 lds
    s_lshr_b32 s36, s2, 5
    s_add_u32 s36, s36, 48
    s_lshl_b32 s36, s36, 7
    v_mov_b32 v12, s36
    global_load_dword v11, v12, s[90:91] sc1
    s_sub_u32 s36, 32, s50
    s_cmp_lt_i32 s36, 0
    s_cbranch_scc0 L_recurrent_scan__compressed_kv_cla__moe_arch_mod__prompt_kernel_rare_98
L_recurrent_scan__compressed_kv_cla__moe_arch_mod__prompt_kernel_back_99:
    s_waitcnt lgkmcnt(5)
    v_mfma_f32_16x16x32_bf16 v[192:195], v[64:67], v[48:51], v[192:195]
    v_exp_f32 v112, v112
    v_mfma_f32_16x16x32_bf16 v[224:227], v[64:67], v[52:55], v[224:227]
    ds_read_b128 v[92:95], v3 offset:7168
    v_exp_f32 v113, v113
    v_mfma_f32_16x16x32_bf16 v[196:199], v[68:71], v[48:51], v[196:199]
    v_cvt_pk_bf16_f32 v56, v112, v113
    v_exp_f32 v114, v114
    v_mfma_f32_16x16x32_bf16 v[228:231], v[68:71], v[52:55], v[228:231]
    ds_read_b128 v[64:67], v3 offset:8192
    v_exp_f32 v115, v115
    s_waitcnt lgkmcnt(5)
    v_mfma_f32_16x16x32_bf16 v[200:203], v[72:75], v[48:51], v[200:203]
    v_cvt_pk_bf16_f32 v57, v114, v115
    v_exp_f32 v120, v120
    v_mfma_f32_16x16x32_bf16 v[232:235], v[72:75], v[52:55], v[232:235]
    v_mfma_f32_16x16x32_bf16 v[28:31], v[36:39], v[48:51], v[28:31]
    ds_read_b128 v[68:71], v3 offset:9216
    v_exp_f32 v121, v121
    v_mfma_f32_16x16x32_bf16 v[204:207], v[76:79], v[48:51], v[204:207]
    v_cvt_pk_bf16_f32 v60, v120, v121
    v_exp_f32 v122, v122
    v_mfma_f32_16x16x32_bf16 v[236:239], v[76:79], v[52:55], v[236:239]
    ds_read_b128 v[72:75], v3 offset:10240
    v_exp_f32 v123, v123
    s_waitcnt lgkmcnt(6)
    v_mfma_f32_16x16x32_bf16 v[208:211], v[80:83], v[48:51], v[208:211]
    v_cvt_pk_bf16_f32 v61, v122, v123
    v_exp_f32 v116, v116
    v_mfma_f32_16x16x32_bf16 v[240:243], v[80:83], v[52:55], v[240:243]
    ds_read_b128 v[76:79], v3 offset:11264
    v_exp_f32 v117, v117
    s_waitcnt lgkmcnt(6)
    v_mfma_f32_16x16x32_bf16 v[212:215], v[84:87], v[48:51], v[212:215]
    v_cvt_pk_bf16_f32 v58, v116, v117
    v_exp_f32 v118, v118
    v_mfma_f32_16x16x32_bf16 v[244:247], v[84:87], v[52:55], v[244:247]
    ds_read_b128 v[80:83], v3 offset:12288
    v_exp_f32 v119, v119
    s_waitcnt lgkmcnt(6)
    v_mfma_f32_16x16x32_bf16 v[216:219], v[88:91], v[48:51], v[216:219]
    v_cvt_pk_bf16_f32 v59, v118, v119
    v_exp_f32 v124, v124
    v_mfma_f32_16x16x32_bf16 v[248:251], v[88:91], v[52:55], v[248:251]
    v_mfma_f32_16x16x32_bf16 v[32:35], v[36:39], v[52:55], v[32:35]
    ds_read_b128 v[84:87], v3 offset:13312
    v_exp_f32 v125, v125
    s_waitcnt lgkmcnt(6)
    v_mfma_f32_16x16x32_bf16 v[220:223], v[92:95], v[48:51], v[220:223]
    v_cvt_pk_bf16_f32 v62, v124, v125
    v_exp_f32 v126, v126
    v_mfma_f32_16x16x32_bf16 v[252:255], v[92:95], v[52:55], v[252:255]
    ds_read_b128 v[88:91], v3 offset:14336
    v_exp_f32 v127, v127
    s_nop 0
    v_cvt_pk_bf16_f32 v63, v126, v127
    s_nop 1
    s_waitcnt lgkmcnt(6)
    v_mfma_f32_16x16x32_bf16 v[192:195], v[64:67], v[56:59], v[192:195]
    v_mfma_f32_16x16x32_bf16 v[224:227], v[64:67], v[60:63], v[224:227]
    ds_read_b128 v[92:95], v3 offset:15360
    s_waitcnt lgkmcnt(6)
    v_mfma_f32_16x16x32_bf16 v[196:199], v[68:71], v[56:59], v[196:199]
    v_mfma_f32_16x16x32_bf16 v[228:231], v[68:71], v[60:63], v[228:231]
    s_waitcnt lgkmcnt(5)
    v_mfma_f32_16x16x32_bf16 v[200:203], v[72:75], v[56:59], v[200:203]
    v_mfma_f32_16x16x32_bf16 v[232:235], v[72:75], v[60:63], v[232:235]
    v_mfma_f32_16x16x32_bf16 v[28:31], v[36:39], v[56:59], v[28:31]
    s_waitcnt lgkmcnt(4)
    v_mfma_f32_16x16x32_bf16 v[204:207], v[76:79], v[56:59], v[204:207]
    v_mfma_f32_16x16x32_bf16 v[236:239], v[76:79], v[60:63], v[236:239]
    s_waitcnt lgkmcnt(3)
    v_mfma_f32_16x16x32_bf16 v[208:211], v[80:83], v[56:59], v[208:211]
    v_mfma_f32_16x16x32_bf16 v[240:243], v[80:83], v[60:63], v[240:243]
    s_waitcnt lgkmcnt(2)
    v_mfma_f32_16x16x32_bf16 v[212:215], v[84:87], v[56:59], v[212:215]
    v_mfma_f32_16x16x32_bf16 v[244:247], v[84:87], v[60:63], v[244:247]
    s_waitcnt lgkmcnt(1)
    v_mfma_f32_16x16x32_bf16 v[216:219], v[88:91], v[56:59], v[216:219]
    v_mfma_f32_16x16x32_bf16 v[248:251], v[88:91], v[60:63], v[248:251]
    v_mfma_f32_16x16x32_bf16 v[32:35], v[36:39], v[60:63], v[32:35]
    s_waitcnt lgkmcnt(0)
    v_mfma_f32_16x16x32_bf16 v[220:223], v[92:95], v[56:59], v[220:223]
    v_mfma_f32_16x16x32_bf16 v[252:255], v[92:95], v[60:63], v[252:255]
    s_waitcnt vmcnt(0)
    v_readfirstlane_b32 s36, v11
    s_nop 0
    s_cmp_lt_u32 s36, 28
    s_cbranch_scc1 L_recurrent_scan__compressed_kv_cla__moe_arch_mod__prompt_kernel_rare_102
L_recurrent_scan__compressed_kv_cla__moe_arch_mod__prompt_kernel_back_103:
    s_lshr_b32 s36, s2, 4
    s_mul_i32 s36, s36, 7
    s_min_u32 s37, s28, 6
    s_add_u32 s36, s36, s37
    s_lshl_b32 s36, s36, 11
    s_add_u32 s36, s36, 58720256
    v_and_b32 v11, 15, v1
    v_lshlrev_b32 v11, 4, v11
    v_lshrrev_b32 v12, 4, v1
    v_lshl_add_u32 v11, v12, 9, v11
    buffer_load_dwordx4 v[96:99], v11, s[24:27], s36 offen offset:0 sc1
    buffer_load_dwordx4 v[100:103], v11, s[24:27], s36 offen offset:256 sc1
    s_lshl_b32 s37, s28, 13
    v_add_u32 v105, s37, v7
    v_xor_b32 v106, 32768, v105
    s_lshl_b32 s37, s28, 8
    s_add_u32 s37, s37, 159744
    v_lshl_add_u32 v107, v1, 2, s37
    v_xor_b32 v108, 1024, v107
    ds_write_b32 v107, v32
    s_mov_b32 s36, 0x5d800000
    v_cmp_nge_f32 vcc, s36, v28
    s_nop 0
    s_or_b64 s[52:53], s[52:53], vcc
    v_cmp_nge_f32 vcc, s36, v32
    s_nop 0
    s_or_b64 s[52:53], s[52:53], vcc
    s_or_b32 s36, s52, s53
    v_mov_b32 v110, s36
    s_lshl_b32 s37, s28, 2
    s_add_u32 s37, s37, 161792
    v_mov_b32 v111, s37
    ds_write_b32 v111, v110
    ds_write_b128 v105, v[224:227] offset:0
    ds_write_b128 v105, v[228:231] offset:1024
    ds_write_b128 v105, v[232:235] offset:2048
    ds_write_b128 v105, v[236:239] offset:3072
    ds_write_b128 v105, v[240:243] offset:4096
    ds_write_b128 v105, v[244:247] offset:5120
    ds_write_b128 v105, v[248:251] offset:6144
    ds_write_b128 v105, v[252:255] offset:7168
    v_mov_b32 v112, 161856
    v_mov_b32 v114, s56
    v_mov_b32 v115, s57
    v_mov_b32 v116, s58
    v_mov_b32 v117, s59
    ds_write_b128 v112, v[114:117]
    v_and_b32 v111, 7, v1
    v_lshlrev_b32 v111, 2, v111
    v_add_u32 v111, 161792, v111
    s_sub_u32 s36, 15, s30
    s_lshl_b32 s38, s36, 3
    s_and_b32 s37, s28, 3
    s_lshl_b32 s37, s37, 1
    s_add_u32 s38, s38, s37
    s_lshl_b32 s38, s38, 17
    s_lshl_b32 s37, s29, 12
    s_add_u32 s38, s38, s37
    s_waitcnt lgkmcnt(0)
    s_barrier
    ds_read_b32 v110, v111
    ds_read_b32 v109, v108
    ds_read_b128 v[64:67], v106 offset:0
    ds_read_b128 v[68:71], v106 offset:1024
    ds_read_b128 v[72:75], v106 offset:2048
    ds_read_b128 v[76:79], v106 offset:3072
    ds_read_b128 v[80:83], v106 offset:4096
    ds_read_b128 v[84:87], v106 offset:5120
    ds_read_b128 v[88:91], v106 offset:6144
    ds_read_b128 v[92:95], v106 offset:7168
    s_waitcnt lgkmcnt(8)
    v_add_f32 v109, v109, v28
    v_cmp_ne_u32 s[52:53], 0, v110
    v_rcp_f32 v109, v109
    s_nop 0
    v_mov_b32 v108, v109
    s_waitcnt lgkmcnt(6)
    v_pk_add_f32 v[192:193], v[192:193], v[64:65]
    v_pk_add_f32 v[194:195], v[194:195], v[66:67]
    v_pk_add_f32 v[196:197], v[196:197], v[68:69]
    v_pk_add_f32 v[198:199], v[198:199], v[70:71]
    v_pk_mul_f32 v[192:193], v[192:193], v[108:109]
    v_pk_mul_f32 v[194:195], v[194:195], v[108:109]
    v_pk_mul_f32 v[196:197], v[196:197], v[108:109]
    v_pk_mul_f32 v[198:199], v[198:199], v[108:109]
    v_cvt_pk_bf16_f32 v48, v192, v193
    v_cvt_pk_bf16_f32 v49, v194, v195
    v_cvt_pk_bf16_f32 v50, v196, v197
    v_cvt_pk_bf16_f32 v51, v198, v199
    buffer_store_dwordx4 v[48:51], v7, s[16:19], s38 offen offset:0 sc1
    s_waitcnt lgkmcnt(4)
    v_pk_add_f32 v[200:201], v[200:201], v[72:73]
    v_pk_add_f32 v[202:203], v[202:203], v[74:75]
    v_pk_add_f32 v[204:205], v[204:205], v[76:77]
    v_pk_add_f32 v[206:207], v[206:207], v[78:79]
    v_pk_mul_f32 v[200:201], v[200:201], v[108:109]
    v_pk_mul_f32 v[202:203], v[202:203], v[108:109]
    v_pk_mul_f32 v[204:205], v[204:205], v[108:109]
    v_pk_mul_f32 v[206:207], v[206:207], v[108:109]
    v_cvt_pk_bf16_f32 v52, v200, v201
    v_cvt_pk_bf16_f32 v53, v202, v203
    v_cvt_pk_bf16_f32 v54, v204, v205
    v_cvt_pk_bf16_f32 v55, v206, v207
    buffer_store_dwordx4 v[52:55], v7, s[16:19], s38 offen offset:1024 sc1
    s_waitcnt lgkmcnt(2)
    v_pk_add_f32 v[208:209], v[208:209], v[80:81]
    v_pk_add_f32 v[210:211], v[210:211], v[82:83]
    v_pk_add_f32 v[212:213], v[212:213], v[84:85]
    v_pk_add_f32 v[214:215], v[214:215], v[86:87]
    v_pk_mul_f32 v[208:209], v[208:209], v[108:109]
    v_pk_mul_f32 v[210:211], v[210:211], v[108:109]
    v_pk_mul_f32 v[212:213], v[212:213], v[108:109]
    v_pk_mul_f32 v[214:215], v[214:215], v[108:109]
    v_cvt_pk_bf16_f32 v56, v208, v209
    v_cvt_pk_bf16_f32 v57, v210, v211
    v_cvt_pk_bf16_f32 v58, v212, v213
    v_cvt_pk_bf16_f32 v59, v214, v215
    buffer_store_dwordx4 v[56:59], v7, s[16:19], s38 offen offset:2048 sc1
    s_waitcnt lgkmcnt(0)
    v_pk_add_f32 v[216:217], v[216:217], v[88:89]
    v_pk_add_f32 v[218:219], v[218:219], v[90:91]
    v_pk_add_f32 v[220:221], v[220:221], v[92:93]
    v_pk_add_f32 v[222:223], v[222:223], v[94:95]
    v_pk_mul_f32 v[216:217], v[216:217], v[108:109]
    v_pk_mul_f32 v[218:219], v[218:219], v[108:109]
    v_pk_mul_f32 v[220:221], v[220:221], v[108:109]
    v_pk_mul_f32 v[222:223], v[222:223], v[108:109]
    v_cvt_pk_bf16_f32 v60, v216, v217
    v_cvt_pk_bf16_f32 v61, v218, v219
    v_cvt_pk_bf16_f32 v62, v220, v221
    v_cvt_pk_bf16_f32 v63, v222, v223
    buffer_store_dwordx4 v[60:63], v7, s[16:19], s38 offen offset:3072 sc1
    s_cmp_eq_u64 s[52:53], 0
    s_cbranch_scc1 L_p3_done
    s_waitcnt vmcnt(0)
    v_mov_b32 v112, v96
    v_mov_b32 v113, v97
    v_mov_b32 v114, v98
    v_mov_b32 v115, v99
    v_mov_b32 v116, v100
    v_mov_b32 v117, v101
    v_mov_b32 v118, v102
    v_mov_b32 v119, v103
    v_mov_b32 v192, 0
    v_mov_b32 v193, 0
    v_mov_b32 v194, 0
    v_mov_b32 v195, 0
    v_mov_b32 v196, 0
    v_mov_b32 v197, 0
    v_mov_b32 v198, 0
    v_mov_b32 v199, 0
    v_mov_b32 v200, 0
    v_mov_b32 v201, 0
    v_mov_b32 v202, 0
    v_mov_b32 v203, 0
    v_mov_b32 v204, 0
    v_mov_b32 v205, 0
    v_mov_b32 v206, 0
    v_mov_b32 v207, 0
    v_mov_b32 v208, 0
    v_mov_b32 v209, 0
    v_mov_b32 v210, 0
    v_mov_b32 v211, 0
    v_mov_b32 v212, 0
    v_mov_b32 v213, 0
    v_mov_b32 v214, 0
    v_mov_b32 v215, 0
    v_mov_b32 v216, 0
    v_mov_b32 v217, 0
    v_mov_b32 v218, 0
    v_mov_b32 v219, 0
    v_mov_b32 v220, 0
    v_mov_b32 v221, 0
    v_mov_b32 v222, 0
    v_mov_b32 v223, 0
    v_mov_b32 v224, 0
    v_mov_b32 v225, 0
    v_mov_b32 v226, 0
    v_mov_b32 v227, 0
    v_mov_b32 v228, 0
    v_mov_b32 v229, 0
    v_mov_b32 v230, 0
    v_mov_b32 v231, 0
    v_mov_b32 v232, 0
    v_mov_b32 v233, 0
    v_mov_b32 v234, 0
    v_mov_b32 v235, 0
    v_mov_b32 v236, 0
    v_mov_b32 v237, 0
    v_mov_b32 v238, 0
    v_mov_b32 v239, 0
    v_mov_b32 v240, 0
    v_mov_b32 v241, 0
    v_mov_b32 v242, 0
    v_mov_b32 v243, 0
    v_mov_b32 v244, 0
    v_mov_b32 v245, 0
    v_mov_b32 v246, 0
    v_mov_b32 v247, 0
    v_mov_b32 v248, 0
    v_mov_b32 v249, 0
    v_mov_b32 v250, 0
    v_mov_b32 v251, 0
    v_mov_b32 v252, 0
    v_mov_b32 v253, 0
    v_mov_b32 v254, 0
    v_mov_b32 v255, 0
    v_mov_b32 v28, 0
    v_mov_b32 v40, 4048155338
    v_mov_b32 v32, 0
    v_mov_b32 v41, 4048155338
    s_lshl_b32 s43, s28, 12
    v_add_u32 v4, s43, v7
    s_mov_b32 s46, s45
    s_sub_u32 s40, 16, s30
    s_sub_u32 s39, 15, s30
    s_lshl_b32 s37, s39, 7
    s_and_b32 s36, s28, 3
    s_lshl_b32 s36, s36, 5
    s_add_u32 s36, s36, s37
    s_sub_u32 s50, 0, s36
L_recurrent_scan__compressed_kv_cla__moe_arch_mod__prompt_kernel_stile_104:
    s_waitcnt vmcnt(0) lgkmcnt(0)
    s_barrier
    s_mov_b32 m0, s43
    s_add_u32 s47, s46, 32768
    buffer_load_dwordx4 v4, s[12:15], s46 offen offset:0 sc1 lds
    buffer_load_dwordx4 v4, s[12:15], s46 offen offset:1024 sc1 lds
    buffer_load_dwordx4 v4, s[12:15], s46 offen offset:2048 sc1 lds
    buffer_load_dwordx4 v4, s[12:15], s46 offen offset:3072 sc1 lds
    s_add_u32 m0, s43, 32768
    s_add_u32 s46, s46, 65536
    buffer_load_dwordx4 v4, s[12:15], s47 offen offset:0 sc1 lds
    buffer_load_dwordx4 v4, s[12:15], s47 offen offset:1024 sc1 lds
    buffer_load_dwordx4 v4, s[12:15], s47 offen offset:2048 sc1 lds
    buffer_load_dwordx4 v4, s[12:15], s47 offen offset:3072 sc1 lds
    v_mov_b32 v2, v7
    s_mov_b32 s41, 4
    s_waitcnt vmcnt(0)
    s_barrier
L_recurrent_scan__compressed_kv_cla__moe_arch_mod__prompt_kernel_sunit_105:
    s_cmp_gt_i32 s50, 0
    s_cbranch_scc1 L_recurrent_scan__compressed_kv_cla__moe_arch_mod__prompt_kernel_snext_106
    ds_read_b128 v[64:67], v2 offset:0
    ds_read_b128 v[68:71], v2 offset:1024
    ds_read_b128 v[72:75], v2 offset:2048
    ds_read_b128 v[76:79], v2 offset:3072
    ds_read_b128 v[80:83], v2 offset:4096
    ds_read_b128 v[84:87], v2 offset:5120
    ds_read_b128 v[88:91], v2 offset:6144
    ds_read_b128 v[92:95], v2 offset:7168
    s_waitcnt lgkmcnt(0)
    v_mfma_f32_16x16x32_bf16 v[96:99], v[64:67], v[128:131], 0
    v_mfma_f32_16x16x32_bf16 v[104:107], v[64:67], v[144:147], 0
    v_mfma_f32_16x16x32_bf16 v[96:99], v[68:71], v[132:135], v[96:99]
    v_mfma_f32_16x16x32_bf16 v[104:107], v[68:71], v[148:151], v[104:107]
    v_mfma_f32_16x16x32_bf16 v[96:99], v[72:75], v[136:139], v[96:99]
    v_mfma_f32_16x16x32_bf16 v[104:107], v[72:75], v[152:155], v[104:107]
    v_mfma_f32_16x16x32_bf16 v[96:99], v[76:79], v[140:143], v[96:99]
    v_mfma_f32_16x16x32_bf16 v[104:107], v[76:79], v[156:159], v[104:107]
    v_mfma_f32_16x16x32_bf16 v[100:103], v[80:83], v[128:131], 0
    v_mfma_f32_16x16x32_bf16 v[108:111], v[80:83], v[144:147], 0
    v_mfma_f32_16x16x32_bf16 v[100:103], v[84:87], v[132:135], v[100:103]
    v_mfma_f32_16x16x32_bf16 v[108:111], v[84:87], v[148:151], v[108:111]
    v_mfma_f32_16x16x32_bf16 v[100:103], v[88:91], v[136:139], v[100:103]
    v_mfma_f32_16x16x32_bf16 v[108:111], v[88:91], v[152:155], v[108:111]
    v_mfma_f32_16x16x32_bf16 v[100:103], v[92:95], v[140:143], v[100:103]
    v_mfma_f32_16x16x32_bf16 v[108:111], v[92:95], v[156:159], v[108:111]
    ds_read_b128 v[64:67], v2 offset:32768
    ds_read_b128 v[68:71], v2 offset:33792
    ds_read_b128 v[72:75], v2 offset:34816
    ds_read_b128 v[76:79], v2 offset:35840
    ds_read_b128 v[80:83], v2 offset:36864
    ds_read_b128 v[84:87], v2 offset:37888
    ds_read_b128 v[88:91], v2 offset:38912
    ds_read_b128 v[92:95], v2 offset:39936
    s_nop 1
    s_cmp_lt_i32 s50, 0
    s_cbranch_scc0 L_recurrent_scan__compressed_kv_cla__moe_arch_mod__prompt_kernel_rare_107
L_recurrent_scan__compressed_kv_cla__moe_arch_mod__prompt_kernel_back_108:
    v_max3_f32 v22, v96, v97, v98
    v_max3_f32 v22, v22, v99, v100
    v_max3_f32 v22, v22, v101, v102
    v_max3_f32 v22, v22, v103, v40
    v_mov_b32 v24, v22
    s_nop 1
    v_permlane16_swap_b32 v22, v24
    s_nop 1
    v_max_f32 v22, v22, v24
    v_mov_b32 v24, v22
    s_nop 1
    v_permlane32_swap_b32 v22, v24
    s_nop 1
    v_max_f32 v22, v22, v24
    v_sub_f32 v25, v40, v22
    v_exp_f32 v25, v25
    v_mov_b32 v40, v22
    v_mul_f32 v28, v28, v25
    v_mul_f32 v192, v192, v25
    v_mul_f32 v193, v193, v25
    v_mul_f32 v194, v194, v25
    v_mul_f32 v195, v195, v25
    v_mul_f32 v196, v196, v25
    v_mul_f32 v197, v197, v25
    v_mul_f32 v198, v198, v25
    v_mul_f32 v199, v199, v25
    v_mul_f32 v200, v200, v25
    v_mul_f32 v201, v201, v25
    v_mul_f32 v202, v202, v25
    v_mul_f32 v203, v203, v25
    v_mul_f32 v204, v204, v25
    v_mul_f32 v205, v205, v25
    v_mul_f32 v206, v206, v25
    v_mul_f32 v207, v207, v25
    v_mul_f32 v208, v208, v25
    v_mul_f32 v209, v209, v25
    v_mul_f32 v210, v210, v25
    v_mul_f32 v211, v211, v25
    v_mul_f32 v212, v212, v25
    v_mul_f32 v213, v213, v25
    v_mul_f32 v214, v214, v25
    v_mul_f32 v215, v215, v25
    v_mul_f32 v216, v216, v25
    v_mul_f32 v217, v217, v25
    v_mul_f32 v218, v218, v25
    v_mul_f32 v219, v219, v25
    v_mul_f32 v220, v220, v25
    v_mul_f32 v221, v221, v25
    v_mul_f32 v222, v222, v25
    v_mul_f32 v223, v223, v25
    v_sub_f32 v96, v96, v22
    v_sub_f32 v97, v97, v22
    v_sub_f32 v98, v98, v22
    v_sub_f32 v99, v99, v22
    v_sub_f32 v100, v100, v22
    v_sub_f32 v101, v101, v22
    v_sub_f32 v102, v102, v22
    v_sub_f32 v103, v103, v22
    v_max3_f32 v23, v104, v105, v106
    v_max3_f32 v23, v23, v107, v108
    v_max3_f32 v23, v23, v109, v110
    v_max3_f32 v23, v23, v111, v41
    v_mov_b32 v24, v23
    s_nop 1
    v_permlane16_swap_b32 v23, v24
    s_nop 1
    v_max_f32 v23, v23, v24
    v_mov_b32 v24, v23
    s_nop 1
    v_permlane32_swap_b32 v23, v24
    s_nop 1
    v_max_f32 v23, v23, v24
    v_sub_f32 v25, v41, v23
    v_exp_f32 v25, v25
    v_mov_b32 v41, v23
    v_mul_f32 v32, v32, v25
    v_mul_f32 v224, v224, v25
    v_mul_f32 v225, v225, v25
    v_mul_f32 v226, v226, v25
    v_mul_f32 v227, v227, v25
    v_mul_f32 v228, v228, v25
    v_mul_f32 v229, v229, v25
    v_mul_f32 v230, v230, v25
    v_mul_f32 v231, v231, v25
    v_mul_f32 v232, v232, v25
    v_mul_f32 v233, v233, v25
    v_mul_f32 v234, v234, v25
    v_mul_f32 v235, v235, v25
    v_mul_f32 v236, v236, v25
    v_mul_f32 v237, v237, v25
    v_mul_f32 v238, v238, v25
    v_mul_f32 v239, v239, v25
    v_mul_f32 v240, v240, v25
    v_mul_f32 v241, v241, v25
    v_mul_f32 v242, v242, v25
    v_mul_f32 v243, v243, v25
    v_mul_f32 v244, v244, v25
    v_mul_f32 v245, v245, v25
    v_mul_f32 v246, v246, v25
    v_mul_f32 v247, v247, v25
    v_mul_f32 v248, v248, v25
    v_mul_f32 v249, v249, v25
    v_mul_f32 v250, v250, v25
    v_mul_f32 v251, v251, v25
    v_mul_f32 v252, v252, v25
    v_mul_f32 v253, v253, v25
    v_mul_f32 v254, v254, v25
    v_mul_f32 v255, v255, v25
    v_sub_f32 v104, v104, v23
    v_sub_f32 v105, v105, v23
    v_sub_f32 v106, v106, v23
    v_sub_f32 v107, v107, v23
    v_sub_f32 v108, v108, v23
    v_sub_f32 v109, v109, v23
    v_sub_f32 v110, v110, v23
    v_sub_f32 v111, v111, v23
    v_exp_f32 v96, v96
    v_exp_f32 v97, v97
    v_exp_f32 v98, v98
    v_exp_f32 v99, v99
    v_exp_f32 v104, v104
    v_exp_f32 v105, v105
    v_exp_f32 v106, v106
    v_exp_f32 v107, v107
    v_exp_f32 v100, v100
    v_exp_f32 v101, v101
    v_exp_f32 v102, v102
    v_exp_f32 v103, v103
    v_exp_f32 v108, v108
    v_exp_f32 v109, v109
    v_exp_f32 v110, v110
    v_exp_f32 v111, v111
    v_add_f32 v28, v28, v96
    v_add_f32 v28, v28, v97
    v_cvt_pk_bf16_f32 v48, v96, v97
    v_add_f32 v28, v28, v98
    v_add_f32 v28, v28, v99
    v_cvt_pk_bf16_f32 v49, v98, v99
    v_add_f32 v32, v32, v104
    v_add_f32 v32, v32, v105
    v_cvt_pk_bf16_f32 v52, v104, v105
    v_add_f32 v32, v32, v106
    v_add_f32 v32, v32, v107
    v_cvt_pk_bf16_f32 v53, v106, v107
    v_add_f32 v28, v28, v100
    v_add_f32 v28, v28, v101
    v_cvt_pk_bf16_f32 v50, v100, v101
    v_add_f32 v28, v28, v102
    v_add_f32 v28, v28, v103
    v_cvt_pk_bf16_f32 v51, v102, v103
    v_add_f32 v32, v32, v108
    v_add_f32 v32, v32, v109
    v_cvt_pk_bf16_f32 v54, v108, v109
    v_add_f32 v32, v32, v110
    v_add_f32 v32, v32, v111
    v_cvt_pk_bf16_f32 v55, v110, v111
    s_waitcnt lgkmcnt(0)
    s_nop 0
    v_mfma_f32_16x16x32_bf16 v[192:195], v[64:67], v[48:51], v[192:195]
    v_mfma_f32_16x16x32_bf16 v[224:227], v[64:67], v[52:55], v[224:227]
    v_mfma_f32_16x16x32_bf16 v[196:199], v[68:71], v[48:51], v[196:199]
    v_mfma_f32_16x16x32_bf16 v[228:231], v[68:71], v[52:55], v[228:231]
    v_mfma_f32_16x16x32_bf16 v[200:203], v[72:75], v[48:51], v[200:203]
    v_mfma_f32_16x16x32_bf16 v[232:235], v[72:75], v[52:55], v[232:235]
    v_mfma_f32_16x16x32_bf16 v[204:207], v[76:79], v[48:51], v[204:207]
    v_mfma_f32_16x16x32_bf16 v[236:239], v[76:79], v[52:55], v[236:239]
    v_mfma_f32_16x16x32_bf16 v[208:211], v[80:83], v[48:51], v[208:211]
    v_mfma_f32_16x16x32_bf16 v[240:243], v[80:83], v[52:55], v[240:243]
    v_mfma_f32_16x16x32_bf16 v[212:215], v[84:87], v[48:51], v[212:215]
    v_mfma_f32_16x16x32_bf16 v[244:247], v[84:87], v[52:55], v[244:247]
    v_mfma_f32_16x16x32_bf16 v[216:219], v[88:91], v[48:51], v[216:219]
    v_mfma_f32_16x16x32_bf16 v[248:251], v[88:91], v[52:55], v[248:251]
    v_mfma_f32_16x16x32_bf16 v[220:223], v[92:95], v[48:51], v[220:223]
    v_mfma_f32_16x16x32_bf16 v[252:255], v[92:95], v[52:55], v[252:255]
L_recurrent_scan__compressed_kv_cla__moe_arch_mod__prompt_kernel_snext_106:
    v_add_u32 v2, 8192, v2
    s_add_u32 s50, s50, 32
    s_sub_u32 s41, s41, 1
    s_cmp_lg_u32 s41, 0
    s_cbranch_scc1 L_recurrent_scan__compressed_kv_cla__moe_arch_mod__prompt_kernel_sunit_105
    s_sub_u32 s40, s40, 1
    s_cmp_lg_u32 s40, 0
    s_cbranch_scc1 L_recurrent_scan__compressed_kv_cla__moe_arch_mod__prompt_kernel_stile_104
    v_mov_b32 v20, v28
    s_nop 1
    v_permlane16_swap_b32 v28, v20
    s_nop 1
    v_add_f32 v28, v28, v20
    v_mov_b32 v20, v28
    s_nop 1
    v_permlane32_swap_b32 v28, v20
    s_nop 1
    v_add_f32 v28, v28, v20
    v_mov_b32 v20, v32
    s_nop 1
    v_permlane16_swap_b32 v32, v20
    s_nop 1
    v_add_f32 v32, v32, v20
    v_mov_b32 v20, v32
    s_nop 1
    v_permlane32_swap_b32 v32, v20
    s_nop 1
    v_add_f32 v32, v32, v20
    s_mov_b32 s36, 0x5d800000
    v_cmp_nge_f32 vcc, s36, v28
    s_nop 0
    s_or_b64 s[52:53], s[52:53], vcc
    v_cmp_nge_f32 vcc, s36, v32
    s_nop 0
    s_or_b64 s[52:53], s[52:53], vcc
    v_rcp_f32 v20, v28
    v_rcp_f32 v22, v32
    s_lshl_b32 s38, s39, 3
    s_and_b32 s37, s28, 3
    s_lshl_b32 s37, s37, 1
    s_add_u32 s38, s38, s37
    s_lshl_b32 s38, s38, 17
    s_lshl_b32 s37, s29, 12
    s_add_u32 s38, s38, s37
    v_mov_b32 v21, v20
    v_mov_b32 v23, v22
    v_pk_mul_f32 v[192:193], v[192:193], v[20:21]
    v_pk_mul_f32 v[194:195], v[194:195], v[20:21]
    v_pk_mul_f32 v[196:197], v[196:197], v[20:21]
    v_pk_mul_f32 v[198:199], v[198:199], v[20:21]
    v_cvt_pk_bf16_f32 v192, v192, v193
    v_cvt_pk_bf16_f32 v193, v194, v195
    v_cvt_pk_bf16_f32 v194, v196, v197
    v_cvt_pk_bf16_f32 v195, v198, v199
    buffer_store_dwordx4 v[192:195], v7, s[16:19], s38 offen offset:0 sc1
    v_pk_mul_f32 v[200:201], v[200:201], v[20:21]
    v_pk_mul_f32 v[202:203], v[202:203], v[20:21]
    v_pk_mul_f32 v[204:205], v[204:205], v[20:21]
    v_pk_mul_f32 v[206:207], v[206:207], v[20:21]
    v_cvt_pk_bf16_f32 v200, v200, v201
    v_cvt_pk_bf16_f32 v201, v202, v203
    v_cvt_pk_bf16_f32 v202, v204, v205
    v_cvt_pk_bf16_f32 v203, v206, v207
    buffer_store_dwordx4 v[200:203], v7, s[16:19], s38 offen offset:1024 sc1
    v_pk_mul_f32 v[208:209], v[208:209], v[20:21]
    v_pk_mul_f32 v[210:211], v[210:211], v[20:21]
    v_pk_mul_f32 v[212:213], v[212:213], v[20:21]
    v_pk_mul_f32 v[214:215], v[214:215], v[20:21]
    v_cvt_pk_bf16_f32 v208, v208, v209
    v_cvt_pk_bf16_f32 v209, v210, v211
    v_cvt_pk_bf16_f32 v210, v212, v213
    v_cvt_pk_bf16_f32 v211, v214, v215
    buffer_store_dwordx4 v[208:211], v7, s[16:19], s38 offen offset:2048 sc1
    v_pk_mul_f32 v[216:217], v[216:217], v[20:21]
    v_pk_mul_f32 v[218:219], v[218:219], v[20:21]
    v_pk_mul_f32 v[220:221], v[220:221], v[20:21]
    v_pk_mul_f32 v[222:223], v[222:223], v[20:21]
    v_cvt_pk_bf16_f32 v216, v216, v217
    v_cvt_pk_bf16_f32 v217, v218, v219
    v_cvt_pk_bf16_f32 v218, v220, v221
    v_cvt_pk_bf16_f32 v219, v222, v223
    buffer_store_dwordx4 v[216:219], v7, s[16:19], s38 offen offset:3072 sc1
    s_add_u32 s38, s38, 131072
    v_pk_mul_f32 v[224:225], v[224:225], v[22:23]
    v_pk_mul_f32 v[226:227], v[226:227], v[22:23]
    v_pk_mul_f32 v[228:229], v[228:229], v[22:23]
    v_pk_mul_f32 v[230:231], v[230:231], v[22:23]
    v_cvt_pk_bf16_f32 v224, v224, v225
    v_cvt_pk_bf16_f32 v225, v226, v227
    v_cvt_pk_bf16_f32 v226, v228, v229
    v_cvt_pk_bf16_f32 v227, v230, v231
    buffer_store_dwordx4 v[224:227], v7, s[16:19], s38 offen offset:0 sc1
    v_pk_mul_f32 v[232:233], v[232:233], v[22:23]
    v_pk_mul_f32 v[234:235], v[234:235], v[22:23]
    v_pk_mul_f32 v[236:237], v[236:237], v[22:23]
    v_pk_mul_f32 v[238:239], v[238:239], v[22:23]
    v_cvt_pk_bf16_f32 v232, v232, v233
    v_cvt_pk_bf16_f32 v233, v234, v235
    v_cvt_pk_bf16_f32 v234, v236, v237
    v_cvt_pk_bf16_f32 v235, v238, v239
    buffer_store_dwordx4 v[232:235], v7, s[16:19], s38 offen offset:1024 sc1
    v_pk_mul_f32 v[240:241], v[240:241], v[22:23]
    v_pk_mul_f32 v[242:243], v[242:243], v[22:23]
    v_pk_mul_f32 v[244:245], v[244:245], v[22:23]
    v_pk_mul_f32 v[246:247], v[246:247], v[22:23]
    v_cvt_pk_bf16_f32 v240, v240, v241
    v_cvt_pk_bf16_f32 v241, v242, v243
    v_cvt_pk_bf16_f32 v242, v244, v245
    v_cvt_pk_bf16_f32 v243, v246, v247
    buffer_store_dwordx4 v[240:243], v7, s[16:19], s38 offen offset:2048 sc1
    v_pk_mul_f32 v[248:249], v[248:249], v[22:23]
    v_pk_mul_f32 v[250:251], v[250:251], v[22:23]
    v_pk_mul_f32 v[252:253], v[252:253], v[22:23]
    v_pk_mul_f32 v[254:255], v[254:255], v[22:23]
    v_cvt_pk_bf16_f32 v248, v248, v249
    v_cvt_pk_bf16_f32 v249, v250, v251
    v_cvt_pk_bf16_f32 v250, v252, v253
    v_cvt_pk_bf16_f32 v251, v254, v255
    buffer_store_dwordx4 v[248:251], v7, s[16:19], s38 offen offset:3072 sc1
    v_mov_b32 v96, v112
    v_mov_b32 v97, v113
    v_mov_b32 v98, v114
    v_mov_b32 v99, v115
    v_mov_b32 v100, v116
    v_mov_b32 v101, v117
    v_mov_b32 v102, v118
    v_mov_b32 v103, v119
    s_branch L_p3_done
L_recurrent_scan__compressed_kv_cla__moe_arch_mod__prompt_kernel_rare_1:
    s_mul_i32 s36, s28, 12288
    s_add_u32 s36, s36, 61865984
    v_lshl_add_u32 v16, v1, 4, s36
    v_mov_b32 v108, 0
    v_mov_b32 v109, 0
    v_mov_b32 v110, 0
    v_mov_b32 v111, 0
    global_store_dwordx4 v16, v[108:111], s[90:91] sc1
    v_add_u32 v16, 1024, v16
    global_store_dwordx4 v16, v[108:111], s[90:91] sc1
    v_add_u32 v16, 1024, v16
    global_store_dwordx4 v16, v[108:111], s[90:91] sc1
    v_add_u32 v16, 1024, v16
    global_store_dwordx4 v16, v[108:111], s[90:91] sc1
    v_add_u32 v16, 1024, v16
    global_store_dwordx4 v16, v[108:111], s[90:91] sc1
    v_add_u32 v16, 1024, v16
    global_store_dwordx4 v16, v[108:111], s[90:91] sc1
    v_add_u32 v16, 1024, v16
    global_store_dwordx4 v16, v[108:111], s[90:91] sc1
    v_add_u32 v16, 1024, v16
    global_store_dwordx4 v16, v[108:111], s[90:91] sc1
    v_add_u32 v16, 1024, v16
    global_store_dwordx4 v16, v[108:111], s[90:91] sc1
    v_add_u32 v16, 1024, v16
    global_store_dwordx4 v16, v[108:111], s[90:91] sc1
    v_add_u32 v16, 1024, v16
    global_store_dwordx4 v16, v[108:111], s[90:91] sc1
    v_add_u32 v16, 1024, v16
    global_store_dwordx4 v16, v[108:111], s[90:91] sc1
    v_add_u32 v16, 1024, v16
    s_branch L_recurrent_scan__compressed_kv_cla__moe_arch_mod__prompt_kernel_back_2
L_recurrent_scan__compressed_kv_cla__moe_arch_mod__prompt_kernel_rare_3:
    v_mov_b32 v19, 1
    s_mov_b64 exec, 1
    global_store_dword v118, v19, s[88:89] sc1
    s_mov_b64 exec, -1
    s_branch L_recurrent_scan__compressed_kv_cla__moe_arch_mod__prompt_kernel_back_4
L_recurrent_scan__compressed_kv_cla__moe_arch_mod__prompt_kernel_rare_5:
    v_lshrrev_b32 v3, 4, v1
    s_lshl_b32 s37, s28, 4
    v_add_u32 v19, s37, v3
    v_lshlrev_b32 v19, 13, v19
    s_lshl_b32 s37, s29, 8
    v_add_u32 v19, s37, v19
    v_and_b32 v16, 15, v1
    v_lshlrev_b32 v3, 1, v3
    v_xor_b32 v16, v16, v3
    v_lshl_add_u32 v2, v16, 4, v19
    v_add_u32 v3, 31744, v2
    v_xor_b32 v16, 8, v16
    v_lshl_add_u32 v4, v16, 4, v19
    v_add_u32 v4, 63488, v4
    v_add_u32 v5, 31744, v4
    s_mov_b32 s4, s96
    s_and_b32 s5, s97, 0xffff
    s_mov_b32 s6, 8388608
    s_mov_b32 s7, 0x20000
    s_mov_b32 s31, 0
    s_mov_b32 s40, 1048576
    s_mov_b64 s[8:9], s[4:5]
    s_mov_b32 s10, s6
    s_mov_b32 s32, 2097152
    v_mov_b32 v6, v2
    v_mov_b32 v7, v3
    v_mov_b32 v8, v4
    v_mov_b32 v9, v5
    s_branch L_recurrent_scan__compressed_kv_cla__moe_arch_mod__prompt_kernel_back_6
L_recurrent_scan__compressed_kv_cla__moe_arch_mod__prompt_kernel_w0_7:
    s_cmp_eq_u32 s35, 0
    s_cbranch_scc0 L_recurrent_scan__compressed_kv_cla__moe_arch_mod__prompt_kernel_swn_10
    v_and_b32 v16, 7, v1
    v_lshrrev_b32 v18, 3, v1
    v_mul_u32_u24 v19, 2064, v16
    v_lshl_add_u32 v19, v18, 4, v19
    s_lshl_b32 s36, s28, 8
    s_add_u32 s36, s36, 131072
    v_add_u32 v19, s36, v19
    ds_read_b128 v[120:123], v19
    ds_read_b128 v[124:127], v19 offset:128
    v_lshlrev_b32 v16, 4, v16
    v_lshl_add_u32 v16, v18, 8, v16
    s_lshr_b32 s36, s2, 1
    s_lshl_b32 s36, s36, 15
    s_and_b32 s37, s2, 1
    s_lshl_b32 s37, s37, 7
    s_add_u32 s36, s36, s37
    s_lshl_b32 s37, s28, 12
    s_add_u32 s36, s36, s37
    s_waitcnt lgkmcnt(0)
    buffer_store_dwordx4 v[120:123], v16, s[24:27], s36 offen sc1
    buffer_store_dwordx4 v[124:127], v16, s[24:27], s36 offen offset:2048 sc1
    s_waitcnt vmcnt(2)
    s_branch L_recurrent_scan__compressed_kv_cla__moe_arch_mod__prompt_kernel_swend_9
L_recurrent_scan__compressed_kv_cla__moe_arch_mod__prompt_kernel_swn_10:
    s_waitcnt vmcnt(2)
L_recurrent_scan__compressed_kv_cla__moe_arch_mod__prompt_kernel_swend_9:
    s_branch L_recurrent_scan__compressed_kv_cla__moe_arch_mod__prompt_kernel_w0b_8
L_recurrent_scan__compressed_kv_cla__moe_arch_mod__prompt_kernel_rare_13:
    s_cmp_eq_u32 s35, 0
    s_cbranch_scc0 L_recurrent_scan__compressed_kv_cla__moe_arch_mod__prompt_kernel_swn_12
    global_load_dword v116, v118, s[88:89] sc1
    s_branch L_recurrent_scan__compressed_kv_cla__moe_arch_mod__prompt_kernel_swend_11
L_recurrent_scan__compressed_kv_cla__moe_arch_mod__prompt_kernel_swn_12:
    v_and_b32 v117, 15, v1
    v_add_u32 v117, 112, v117
    v_lshlrev_b32 v117, 7, v117
    global_load_dword v116, v117, s[90:91] sc1
L_recurrent_scan__compressed_kv_cla__moe_arch_mod__prompt_kernel_swend_11:
    s_branch L_recurrent_scan__compressed_kv_cla__moe_arch_mod__prompt_kernel_back_14
L_recurrent_scan__compressed_kv_cla__moe_arch_mod__prompt_kernel_rare_19:
    s_mov_b32 s61, 0x40000
L_recurrent_scan__compressed_kv_cla__moe_arch_mod__prompt_kernel_spin_17:
    s_sub_u32 s61, s61, 1
    s_cbranch_scc1 L_recurrent_scan__compressed_kv_cla__moe_arch_mod__prompt_kernel_spinx_18
    s_sleep 8
    global_load_dword v116, v118, s[88:89] sc1
    s_waitcnt vmcnt(0)
    v_readfirstlane_b32 s36, v116
    s_nop 0
    s_cmp_lt_u32 s36, 1
    s_cbranch_scc1 L_recurrent_scan__compressed_kv_cla__moe_arch_mod__prompt_kernel_spin_17
L_recurrent_scan__compressed_kv_cla__moe_arch_mod__prompt_kernel_spinx_18:
    s_branch L_recurrent_scan__compressed_kv_cla__moe_arch_mod__prompt_kernel_back_20
L_recurrent_scan__compressed_kv_cla__moe_arch_mod__prompt_kernel_w0_15:
    s_waitcnt vmcnt(0)
    s_cmp_eq_u32 s35, 0
    s_cbranch_scc0 L_recurrent_scan__compressed_kv_cla__moe_arch_mod__prompt_kernel_swn_24
    v_readfirstlane_b32 s36, v116
    s_nop 0
    s_cmp_lt_u32 s36, 1
    s_cbranch_scc1 L_recurrent_scan__compressed_kv_cla__moe_arch_mod__prompt_kernel_rare_19
L_recurrent_scan__compressed_kv_cla__moe_arch_mod__prompt_kernel_back_20:
    s_branch L_recurrent_scan__compressed_kv_cla__moe_arch_mod__prompt_kernel_swend_23
L_recurrent_scan__compressed_kv_cla__moe_arch_mod__prompt_kernel_swn_24:
    s_mov_b32 s61, 0x40000
L_recurrent_scan__compressed_kv_cla__moe_arch_mod__prompt_kernel_lspin_21:
    v_cmp_gt_u32 vcc, 16, v116
    s_nop 0
    s_cmp_eq_u64 vcc, 0
    s_cbranch_scc1 L_recurrent_scan__compressed_kv_cla__moe_arch_mod__prompt_kernel_lspinx_22
    s_sub_u32 s61, s61, 1
    s_cbranch_scc1 L_recurrent_scan__compressed_kv_cla__moe_arch_mod__prompt_kernel_lspinx_22
    s_sleep 8
    global_load_dword v116, v117, s[90:91] sc1
    s_waitcnt vmcnt(0)
    s_branch L_recurrent_scan__compressed_kv_cla__moe_arch_mod__prompt_kernel_lspin_21
L_recurrent_scan__compressed_kv_cla__moe_arch_mod__prompt_kernel_lspinx_22:
L_recurrent_scan__compressed_kv_cla__moe_arch_mod__prompt_kernel_swend_23:
    s_branch L_recurrent_scan__compressed_kv_cla__moe_arch_mod__prompt_kernel_w0b_16
L_recurrent_scan__compressed_kv_cla__moe_arch_mod__prompt_kernel_rare_25:
    s_lshr_b32 s36, s2, 4
    s_add_u32 s36, s36, 112
    s_lshl_b32 s36, s36, 7
    v_mov_b32 v16, s36
    v_mov_b32 v19, 1
    s_mov_b64 exec, 1
    global_atomic_add v16, v19, s[90:91]
    s_mov_b64 exec, -1
    s_nop 3
    s_branch L_recurrent_scan__compressed_kv_cla__moe_arch_mod__prompt_kernel_back_26
L_recurrent_scan__compressed_kv_cla__moe_arch_mod__prompt_kernel_w0_27:
    s_cmp_eq_u32 s35, 0
    s_cbranch_scc0 L_recurrent_scan__compressed_kv_cla__moe_arch_mod__prompt_kernel_swn_30
    s_waitcnt vmcnt(2)
    s_branch L_recurrent_scan__compressed_kv_cla__moe_arch_mod__prompt_kernel_swend_29
L_recurrent_scan__compressed_kv_cla__moe_arch_mod__prompt_kernel_swn_30:
    s_waitcnt vmcnt(2)
L_recurrent_scan__compressed_kv_cla__moe_arch_mod__prompt_kernel_swend_29:
    s_branch L_recurrent_scan__compressed_kv_cla__moe_arch_mod__prompt_kernel_w0b_28
L_recurrent_scan__compressed_kv_cla__moe_arch_mod__prompt_kernel_rare_32:
    v_and_b32 v16, 7, v1
    v_lshrrev_b32 v18, 3, v1
    v_mul_u32_u24 v19, 2064, v16
    v_lshl_add_u32 v19, v18, 4, v19
    s_lshl_b32 s36, s28, 8
    s_add_u32 s36, s36, 131072
    v_add_u32 v19, s36, v19
    ds_read_b128 v[120:123], v19
    ds_read_b128 v[124:127], v19 offset:128
    v_lshlrev_b32 v16, 4, v16
    v_lshl_add_u32 v16, v18, 8, v16
    s_lshr_b32 s36, s2, 1
    s_lshl_b32 s36, s36, 15
    s_and_b32 s37, s2, 1
    s_lshl_b32 s37, s37, 7
    s_add_u32 s36, s36, s37
    s_lshl_b32 s37, s28, 12
    s_add_u32 s36, s36, s37
    s_waitcnt lgkmcnt(0)
    buffer_store_dwordx4 v[120:123], v16, s[24:27], s36 offen sc1
    buffer_store_dwordx4 v[124:127], v16, s[24:27], s36 offen offset:2048 sc1
    s_cmp_eq_u32 s28, 7
    s_cbranch_scc0 L_recurrent_scan__compressed_kv_cla__moe_arch_mod__prompt_kernel_l7_31
    v_and_b32 v120, 7, v1
    v_lshlrev_b32 v120, 3, v120
    v_add_u32 v121, 147712, v120
    ds_read_b64 v[122:123], v121
    ds_read_b32 v124, v121 offset:64
    s_lshl_b32 s36, s2, 6
    s_add_u32 s36, s36, 4194304
    s_lshl_b32 s37, s2, 3
    s_add_u32 s37, s37, 4276224
    s_waitcnt lgkmcnt(0)
    v_mov_b32 v126, v124
    s_nop 1
    v_max_u32_dpp v126, v126, v126 quad_perm:[1,0,3,2] row_mask:0xf bank_mask:0xf
    s_nop 1
    v_max_u32_dpp v126, v126, v126 quad_perm:[2,3,0,1] row_mask:0xf bank_mask:0xf
    s_nop 1
    v_max_u32_dpp v126, v126, v126 row_half_mirror row_mask:0xf bank_mask:0xf
    v_cmp_eq_u32 vcc, v126, v124
    s_nop 1
    v_cndmask_b32 v127, v124, v118, vcc
    s_nop 1
    v_max_u32_dpp v127, v127, v127 quad_perm:[1,0,3,2] row_mask:0xf bank_mask:0xf
    s_nop 1
    v_max_u32_dpp v127, v127, v127 quad_perm:[2,3,0,1] row_mask:0xf bank_mask:0xf
    s_nop 1
    v_max_u32_dpp v127, v127, v127 row_half_mirror row_mask:0xf bank_mask:0xf
    s_mov_b64 exec, 0xff
    buffer_store_dwordx2 v[122:123], v120, s[24:27], s36 offen sc1
    s_mov_b64 exec, 1
    buffer_store_dwordx2 v[126:127], v120, s[24:27], s37 offen sc1
    s_mov_b64 exec, -1
    s_nop 3
L_recurrent_scan__compressed_kv_cla__moe_arch_mod__prompt_kernel_l7_31:
    s_branch L_recurrent_scan__compressed_kv_cla__moe_arch_mod__prompt_kernel_back_33
L_recurrent_scan__compressed_kv_cla__moe_arch_mod__prompt_kernel_rare_36:
    v_lshrrev_b32 v3, 4, v1
    s_lshl_b32 s37, s28, 4
    v_add_u32 v19, s37, v3
    v_lshlrev_b32 v19, 13, v19
    s_lshl_b32 s37, s29, 8
    v_add_u32 v19, s37, v19
    v_and_b32 v16, 15, v1
    v_lshlrev_b32 v3, 1, v3
    v_xor_b32 v16, v16, v3
    v_lshl_add_u32 v2, v16, 4, v19
    v_add_u32 v3, 31744, v2
    v_xor_b32 v16, 8, v16
    v_lshl_add_u32 v4, v16, 4, v19
    v_add_u32 v4, 63488, v4
    v_add_u32 v5, 31744, v4
    s_mov_b32 s4, s96
    s_and_b32 s5, s97, 0xffff
    s_mov_b32 s6, 8388608
    s_mov_b32 s7, 0x20000
    s_mov_b32 s31, 0
    s_mov_b32 s40, 1048576
    s_mov_b64 s[8:9], s[4:5]
    s_mov_b32 s10, s6
    s_mov_b32 s32, 2097152
    v_mov_b32 v6, v2
    v_mov_b32 v7, v3
    v_mov_b32 v8, v4
    v_mov_b32 v9, v5
    s_branch L_recurrent_scan__compressed_kv_cla__moe_arch_mod__prompt_kernel_back_37
L_recurrent_scan__compressed_kv_cla__moe_arch_mod__prompt_kernel_rare_42:
    s_mov_b32 s61, 0x40000
L_recurrent_scan__compressed_kv_cla__moe_arch_mod__prompt_kernel_spin_40:
    s_sub_u32 s61, s61, 1
    s_cbranch_scc1 L_recurrent_scan__compressed_kv_cla__moe_arch_mod__prompt_kernel_spinx_41
    s_sleep 8
    global_load_dword v56, v57, s[90:91] sc1
    s_waitcnt vmcnt(0)
    v_readfirstlane_b32 s36, v56
    s_nop 0
    s_cmp_lt_u32 s36, 1
    s_cbranch_scc1 L_recurrent_scan__compressed_kv_cla__moe_arch_mod__prompt_kernel_spin_40
L_recurrent_scan__compressed_kv_cla__moe_arch_mod__prompt_kernel_spinx_41:
    s_branch L_recurrent_scan__compressed_kv_cla__moe_arch_mod__prompt_kernel_back_43
L_recurrent_scan__compressed_kv_cla__moe_arch_mod__prompt_kernel_rare_48:
    s_cmp_lt_u32 s28, 4
    s_cbranch_scc0 L_recurrent_scan__compressed_kv_cla__moe_arch_mod__prompt_kernel_ng_45
    s_cmp_eq_u32 s35, 2
    s_cbranch_scc0 L_recurrent_scan__compressed_kv_cla__moe_arch_mod__prompt_kernel_swn_47
    s_mov_b32 s6, 0
    s_mov_b32 s34, 0x30000
    s_branch L_recurrent_scan__compressed_kv_cla__moe_arch_mod__prompt_kernel_swend_46
L_recurrent_scan__compressed_kv_cla__moe_arch_mod__prompt_kernel_swn_47:
    s_mov_b64 s[4:5], s[12:13]
    s_mov_b32 s6, s14
    s_mov_b32 s31, s45
    s_mov_b32 s40, 32768
    s_mov_b32 s34, s33
    v_add_u32 v2, s33, v58
    v_mov_b32 v3, v2
    v_mov_b32 v4, v2
    v_mov_b32 v5, v2
    s_cmp_eq_u32 s28, 0
    s_cbranch_scc0 L_recurrent_scan__compressed_kv_cla__moe_arch_mod__prompt_kernel_g_44
    s_waitcnt vmcnt(10)
    v_readfirstlane_b32 s36, v56
    s_nop 0
    s_cmp_lt_u32 s36, 1
    s_cbranch_scc1 L_recurrent_scan__compressed_kv_cla__moe_arch_mod__prompt_kernel_rare_42
L_recurrent_scan__compressed_kv_cla__moe_arch_mod__prompt_kernel_back_43:
L_recurrent_scan__compressed_kv_cla__moe_arch_mod__prompt_kernel_g_44:
L_recurrent_scan__compressed_kv_cla__moe_arch_mod__prompt_kernel_swend_46:
L_recurrent_scan__compressed_kv_cla__moe_arch_mod__prompt_kernel_ng_45:
    s_branch L_recurrent_scan__compressed_kv_cla__moe_arch_mod__prompt_kernel_back_49
L_recurrent_scan__compressed_kv_cla__moe_arch_mod__prompt_kernel_rare_54:
    s_cmp_eq_u32 s35, 3
    s_cbranch_scc0 L_recurrent_scan__compressed_kv_cla__moe_arch_mod__prompt_kernel_nv0_50
    s_cmp_eq_u32 s28, 0
    s_cbranch_scc0 L_recurrent_scan__compressed_kv_cla__moe_arch_mod__prompt_kernel_g_39
    s_add_u32 s36, s29, 64
    s_lshl_b32 s36, s36, 7
    v_mov_b32 v57, s36
    global_load_dword v56, v57, s[90:91] sc1
L_recurrent_scan__compressed_kv_cla__moe_arch_mod__prompt_kernel_g_39:
L_recurrent_scan__compressed_kv_cla__moe_arch_mod__prompt_kernel_nv0_50:
    s_cmp_ge_u32 s28, 4
    s_cbranch_scc0 L_recurrent_scan__compressed_kv_cla__moe_arch_mod__prompt_kernel_ng_51
    s_cmp_eq_u32 s35, 2
    s_cbranch_scc0 L_recurrent_scan__compressed_kv_cla__moe_arch_mod__prompt_kernel_swn_53
    s_mov_b32 s6, 0
    s_mov_b32 s34, 0x30000
    s_branch L_recurrent_scan__compressed_kv_cla__moe_arch_mod__prompt_kernel_swend_52
L_recurrent_scan__compressed_kv_cla__moe_arch_mod__prompt_kernel_swn_53:
    s_mov_b64 s[4:5], s[12:13]
    s_mov_b32 s6, s14
    s_mov_b32 s31, s45
    s_mov_b32 s40, 32768
    s_mov_b32 s34, s33
    v_add_u32 v2, s33, v58
    v_mov_b32 v3, v2
    v_mov_b32 v4, v2
    v_mov_b32 v5, v2
L_recurrent_scan__compressed_kv_cla__moe_arch_mod__prompt_kernel_swend_52:
L_recurrent_scan__compressed_kv_cla__moe_arch_mod__prompt_kernel_ng_51:
    s_branch L_recurrent_scan__compressed_kv_cla__moe_arch_mod__prompt_kernel_back_55
L_recurrent_scan__compressed_kv_cla__moe_arch_mod__prompt_kernel_rare_60:
    s_cmp_eq_u32 s35, 3
    s_cbranch_scc0 L_recurrent_scan__compressed_kv_cla__moe_arch_mod__prompt_kernel_nv0_56
    s_add_u32 s34, s33, 32768
L_recurrent_scan__compressed_kv_cla__moe_arch_mod__prompt_kernel_nv0_56:
    s_cmp_ge_u32 s28, 4
    s_cbranch_scc0 L_recurrent_scan__compressed_kv_cla__moe_arch_mod__prompt_kernel_ng_57
    s_cmp_eq_u32 s35, 2
    s_cbranch_scc0 L_recurrent_scan__compressed_kv_cla__moe_arch_mod__prompt_kernel_swn_59
    s_add_u32 s36, s28, s30
    s_cmp_eq_u32 s36, 4
    s_cbranch_scc0 L_recurrent_scan__compressed_kv_cla__moe_arch_mod__prompt_kernel_g_38
    s_add_u32 s36, s29, 64
    s_lshl_b32 s36, s36, 7
    v_mov_b32 v62, s36
    v_mov_b32 v63, 1
    s_mov_b64 exec, 1
    global_atomic_add v62, v63, s[90:91]
    s_mov_b64 exec, -1
    s_nop 3
L_recurrent_scan__compressed_kv_cla__moe_arch_mod__prompt_kernel_g_38:
    s_branch L_recurrent_scan__compressed_kv_cla__moe_arch_mod__prompt_kernel_swend_58
L_recurrent_scan__compressed_kv_cla__moe_arch_mod__prompt_kernel_swn_59:
L_recurrent_scan__compressed_kv_cla__moe_arch_mod__prompt_kernel_swend_58:
L_recurrent_scan__compressed_kv_cla__moe_arch_mod__prompt_kernel_ng_57:
    s_branch L_recurrent_scan__compressed_kv_cla__moe_arch_mod__prompt_kernel_back_61
L_recurrent_scan__compressed_kv_cla__moe_arch_mod__prompt_kernel_rare_62:
    s_waitcnt vmcnt(18)
    s_branch L_recurrent_scan__compressed_kv_cla__moe_arch_mod__prompt_kernel_back_63
L_recurrent_scan__compressed_kv_cla__moe_arch_mod__prompt_kernel_rare_64:
    s_lshl_b32 s36, s39, 1
    s_add_u32 s36, s36, s38
    s_add_u32 s37, s36, s39
    buffer_store_dwordx4 v[160:163], v58, s[16:19], s36 offen sc1
    buffer_store_dwordx4 v[164:167], v59, s[16:19], s36 offen sc1
    buffer_store_dwordx4 v[168:171], v60, s[16:19], s36 offen sc1
    buffer_store_dwordx4 v[172:175], v61, s[16:19], s36 offen sc1
    buffer_store_dwordx4 v[176:179], v58, s[16:19], s37 offen sc1
    buffer_store_dwordx4 v[180:183], v59, s[16:19], s37 offen sc1
    buffer_store_dwordx4 v[184:187], v60, s[16:19], s37 offen sc1
    buffer_store_dwordx4 v[188:191], v61, s[16:19], s37 offen sc1
    s_branch L_recurrent_scan__compressed_kv_cla__moe_arch_mod__prompt_kernel_back_65
L_recurrent_scan__compressed_kv_cla__moe_arch_mod__prompt_kernel_rare_66:
    s_lshl_b32 s36, s29, 7
    v_mov_b32 v13, s36
    global_load_dword v14, v13, s[90:91] sc1
    s_branch L_recurrent_scan__compressed_kv_cla__moe_arch_mod__prompt_kernel_back_67
L_recurrent_scan__compressed_kv_cla__moe_arch_mod__prompt_kernel_rare_72:
    s_mov_b32 s41, 32768
    s_cmp_eq_u32 s40, 15
    s_cbranch_scc0 L_recurrent_scan__compressed_kv_cla__moe_arch_mod__prompt_kernel_r_68
    s_mov_b32 s41, 65536
    s_mov_b32 s49, 0x1ffff
    s_sub_u32 s36, 0, s50
    s_cmp_lt_i32 s36, 0
    s_cbranch_scc1 L_recurrent_scan__compressed_kv_cla__moe_arch_mod__prompt_kernel_nm_71
    v_mov_b32 v20, 4048155338
    v_subrev_u32 v21, s36, v18
    v_cmp_gt_i32 s[20:21], 0, v21
    v_cmp_gt_i32 s[22:23], 1, v21
    v_cmp_gt_i32 s[62:63], 2, v21
    v_cmp_gt_i32 vcc, 3, v21
    v_cndmask_b32 v96, v96, v20, s[20:21]
    v_cndmask_b32 v97, v97, v20, s[22:23]
    v_cndmask_b32 v98, v98, v20, s[62:63]
    v_cndmask_b32 v99, v99, v20, vcc
    v_cmp_gt_i32 s[20:21], 16, v21
    v_cmp_gt_i32 s[22:23], 17, v21
    v_cmp_gt_i32 s[62:63], 18, v21
    v_cmp_gt_i32 vcc, 19, v21
    v_cndmask_b32 v100, v100, v20, s[20:21]
    v_cndmask_b32 v101, v101, v20, s[22:23]
    v_cndmask_b32 v102, v102, v20, s[62:63]
    v_cndmask_b32 v103, v103, v20, vcc
    v_cmp_gt_i32 s[20:21], -16, v21
    v_cmp_gt_i32 s[22:23], -15, v21
    v_cmp_gt_i32 s[62:63], -14, v21
    v_cmp_gt_i32 vcc, -13, v21
    v_cndmask_b32 v104, v104, v20, s[20:21]
    v_cndmask_b32 v105, v105, v20, s[22:23]
    v_cndmask_b32 v106, v106, v20, s[62:63]
    v_cndmask_b32 v107, v107, v20, vcc
    v_cmp_gt_i32 s[20:21], 0, v21
    v_cmp_gt_i32 s[22:23], 1, v21
    v_cmp_gt_i32 s[62:63], 2, v21
    v_cmp_gt_i32 vcc, 3, v21
    v_cndmask_b32 v108, v108, v20, s[20:21]
    v_cndmask_b32 v109, v109, v20, s[22:23]
    v_cndmask_b32 v110, v110, v20, s[62:63]
    v_cndmask_b32 v111, v111, v20, vcc
L_recurrent_scan__compressed_kv_cla__moe_arch_mod__prompt_kernel_nm_71:
L_recurrent_scan__compressed_kv_cla__moe_arch_mod__prompt_kernel_r_68:
    s_branch L_recurrent_scan__compressed_kv_cla__moe_arch_mod__prompt_kernel_back_73
L_recurrent_scan__compressed_kv_cla__moe_arch_mod__prompt_kernel_rare_82:
    s_mov_b32 s61, 0x40000
L_recurrent_scan__compressed_kv_cla__moe_arch_mod__prompt_kernel_spin_80:
    s_sub_u32 s61, s61, 1
    s_cbranch_scc1 L_recurrent_scan__compressed_kv_cla__moe_arch_mod__prompt_kernel_spinx_81
    s_sleep 8
    global_load_dword v14, v13, s[90:91] sc1
    s_waitcnt vmcnt(0)
    v_readfirstlane_b32 s36, v14
    s_nop 0
    s_cmp_lt_u32 s36, 7
    s_cbranch_scc1 L_recurrent_scan__compressed_kv_cla__moe_arch_mod__prompt_kernel_spin_80
L_recurrent_scan__compressed_kv_cla__moe_arch_mod__prompt_kernel_spinx_81:
    s_branch L_recurrent_scan__compressed_kv_cla__moe_arch_mod__prompt_kernel_back_83
L_recurrent_scan__compressed_kv_cla__moe_arch_mod__prompt_kernel_rare_88:
    s_cmp_eq_u32 s40, 1
    s_cbranch_scc0 L_recurrent_scan__compressed_kv_cla__moe_arch_mod__prompt_kernel_swn_85
    v_readfirstlane_b32 s36, v14
    s_nop 0
    s_cmp_lt_u32 s36, 7
    s_cbranch_scc1 L_recurrent_scan__compressed_kv_cla__moe_arch_mod__prompt_kernel_rare_82
L_recurrent_scan__compressed_kv_cla__moe_arch_mod__prompt_kernel_back_83:
    s_branch L_recurrent_scan__compressed_kv_cla__moe_arch_mod__prompt_kernel_swend_84
L_recurrent_scan__compressed_kv_cla__moe_arch_mod__prompt_kernel_swn_85:
    s_cmp_eq_u32 s40, 2
    s_cbranch_scc0 L_recurrent_scan__compressed_kv_cla__moe_arch_mod__prompt_kernel_swn_86
    s_mov_b32 s36, 4276224
    buffer_load_dwordx4 v[160:163], v7, s[24:27], s36 offen offset:0 sc1
    buffer_load_dwordx4 v[164:167], v7, s[24:27], s36 offen offset:1024 sc1
    s_branch L_recurrent_scan__compressed_kv_cla__moe_arch_mod__prompt_kernel_swend_84
L_recurrent_scan__compressed_kv_cla__moe_arch_mod__prompt_kernel_swn_86:
    s_cmp_eq_u32 s40, 3
    s_cbranch_scc0 L_recurrent_scan__compressed_kv_cla__moe_arch_mod__prompt_kernel_swn_87
    v_max_u32 v24, v160, v161
    v_min_u32 v25, v160, v161
    v_med3_u32 v25, v24, v25, v162
    v_max_u32 v24, v24, v162
    v_med3_u32 v25, v24, v25, v163
    v_max_u32 v24, v24, v163
    v_med3_u32 v25, v24, v25, v164
    v_max_u32 v24, v24, v164
    v_med3_u32 v25, v24, v25, v165
    v_max_u32 v24, v24, v165
    v_med3_u32 v25, v24, v25, v166
    v_max_u32 v24, v24, v166
    v_med3_u32 v25, v24, v25, v167
    v_max_u32 v24, v24, v167
    v_mov_b32 v26, v24
    s_nop 1
    v_max_u32_dpp v26, v26, v26 quad_perm:[1,0,3,2] row_mask:0xf bank_mask:0xf
    s_nop 1
    v_max_u32_dpp v26, v26, v26 quad_perm:[2,3,0,1] row_mask:0xf bank_mask:0xf
    s_nop 1
    v_max_u32_dpp v26, v26, v26 row_half_mirror row_mask:0xf bank_mask:0xf
    s_nop 1
    v_max_u32_dpp v26, v26, v26 row_mirror row_mask:0xf bank_mask:0xf
    s_nop 0
    v_readlane_b32 s20, v26, 0
    v_readlane_b32 s21, v26, 16
    v_readlane_b32 s22, v26, 32
    v_readlane_b32 s23, v26, 48
    s_max_u32 s20, s20, s21
    s_max_u32 s22, s22, s23
    s_max_u32 s20, s20, s22
    s_mov_b32 s58, s20
    v_cmp_eq_u32 vcc, s58, v24
    s_nop 1
    v_cndmask_b32 v26, v24, v25, vcc
    s_nop 1
    v_max_u32_dpp v26, v26, v26 quad_perm:[1,0,3,2] row_mask:0xf bank_mask:0xf
    s_nop 1
    v_max_u32_dpp v26, v26, v26 quad_perm:[2,3,0,1] row_mask:0xf bank_mask:0xf
    s_nop 1
    v_max_u32_dpp v26, v26, v26 row_half_mirror row_mask:0xf bank_mask:0xf
    s_nop 1
    v_max_u32_dpp v26, v26, v26 row_mirror row_mask:0xf bank_mask:0xf
    s_nop 0
    v_readlane_b32 s20, v26, 0
    v_readlane_b32 s21, v26, 16
    v_readlane_b32 s22, v26, 32
    v_readlane_b32 s23, v26, 48
    s_max_u32 s20, s20, s21
    s_max_u32 s22, s22, s23
    s_max_u32 s20, s20, s22
    s_mov_b32 s59, s20
    s_and_b32 s36, s58, 0xffff
    s_sub_u32 s56, 0xffff, s36
    s_and_b32 s36, s59, 0xffff
    s_sub_u32 s57, 0xffff, s36
    v_and_b32 v24, 1, v1
    v_mov_b32 v25, s56
    v_mov_b32 v26, s57
    v_cmp_eq_u32 vcc, 1, v24
    s_nop 1
    v_cndmask_b32 v25, v25, v26, vcc
    v_lshrrev_b32 v26, 4, v25
    v_lshlrev_b32 v26, 15, v26
    v_and_b32 v25, 15, v25
    v_lshl_add_u32 v26, v25, 4, v26
    v_lshrrev_b32 v27, 4, v1
    v_lshl_add_u32 v26, v27, 8, v26
    s_and_b32 s36, s3, 3
    s_lshl_b32 s36, s36, 13
    s_add_u32 s37, s36, 4096
    s_mov_b32 exec_lo, 0x00030003
    s_mov_b32 exec_hi, 0x00030003
    buffer_load_dwordx4 v[160:163], v26, s[24:27], s36 offen offset:0 sc1
    buffer_load_dwordx4 v[164:167], v26, s[24:27], s36 offen offset:1024 sc1
    buffer_load_dwordx4 v[168:171], v26, s[24:27], s36 offen offset:2048 sc1
    buffer_load_dwordx4 v[172:175], v26, s[24:27], s36 offen offset:3072 sc1
    buffer_load_dwordx4 v[176:179], v26, s[24:27], s37 offen offset:0 sc1
    buffer_load_dwordx4 v[180:183], v26, s[24:27], s37 offen offset:1024 sc1
    buffer_load_dwordx4 v[184:187], v26, s[24:27], s37 offen offset:2048 sc1
    buffer_load_dwordx4 v[188:191], v26, s[24:27], s37 offen offset:3072 sc1
    s_mov_b64 exec, -1
    s_branch L_recurrent_scan__compressed_kv_cla__moe_arch_mod__prompt_kernel_swend_84
L_recurrent_scan__compressed_kv_cla__moe_arch_mod__prompt_kernel_swn_87:
    s_sub_u32 s38, s40, s60
    s_cmp_eq_u32 s38, 0
    s_cbranch_scc0 L_recurrent_scan__compressed_kv_cla__moe_arch_mod__prompt_kernel_swn_76
    s_and_b32 s20, s3, 3
    s_lshl_b32 s20, s20, 8
    s_lshl_b32 s21, s28, 5
    s_add_u32 s20, s20, s21
    s_lshr_b32 s21, s3, 2
    s_lshl_b32 s21, s21, 7
    v_lshrrev_b32 v25, 3, v1
    s_lshl_b32 s36, s28, 5
    s_add_u32 s36, s36, s20
    v_add_u32 v25, s36, v25
    v_mul_u32_u24 v25, 7168, v25
    v_add_u32 v25, s21, v25
    v_bfe_u32 v26, v1, 4, 1
    v_lshlrev_b32 v26, 1, v26
    v_and_b32 v27, 7, v1
    v_xor_b32 v26, v26, v27
    v_lshl_add_u32 v24, v26, 4, v25
    v_xor_b32 v26, 4, v26
    v_lshl_add_u32 v25, v26, 4, v25
    v_add_u32 v25, 56320, v25
    v_add_u32 v26, 112640, v24
    v_add_u32 v27, 112640, v25
    s_lshl_b32 s36, s28, 13
    s_add_u32 m0, s36, 131072
    s_mov_b32 s37, 229376
    buffer_load_dwordx4 v24, s[4:7], 0 offen offset:0 nt lds
    buffer_load_dwordx4 v25, s[4:7], 0 offen offset:1024 nt lds
    buffer_load_dwordx4 v26, s[4:7], 0 offen offset:2048 nt lds
    buffer_load_dwordx4 v27, s[4:7], 0 offen offset:3072 nt lds
    s_add_u32 m0, s36, 135168
    s_nop 0
    buffer_load_dwordx4 v24, s[4:7], s37 offen offset:0 nt lds
    buffer_load_dwordx4 v25, s[4:7], s37 offen offset:1024 nt lds
    buffer_load_dwordx4 v26, s[4:7], s37 offen offset:2048 nt lds
    buffer_load_dwordx4 v27, s[4:7], s37 offen offset:3072 nt lds
    s_branch L_recurrent_scan__compressed_kv_cla__moe_arch_mod__prompt_kernel_swend_75
L_recurrent_scan__compressed_kv_cla__moe_arch_mod__prompt_kernel_swn_76:
    s_cmp_eq_u32 s38, 2
    s_cbranch_scc0 L_recurrent_scan__compressed_kv_cla__moe_arch_mod__prompt_kernel_swn_77
    v_lshrrev_b32 v8, 4, v1
    v_bfe_u32 v5, v1, 2, 2
    v_lshl_add_u32 v5, v8, 3, v5
    v_lshlrev_b32 v5, 7, v5
    v_and_b32 v9, 3, v1
    v_lshl_add_u32 v5, v9, 3, v5
    v_bfe_u32 v9, v1, 3, 2
    v_xor_b32 v9, s28, v9
    v_lshl_add_u32 v5, v9, 5, v5
    v_add_u32 v5, 131072, v5
    ds_read_b64_tr_b16 v[14:15], v5 offset:0
    ds_read_b64_tr_b16 v[16:17], v5 offset:512
    ds_read_b64_tr_b16 v[20:21], v5 offset:4096
    ds_read_b64_tr_b16 v[22:23], v5 offset:4608
    ds_read_b64_tr_b16 v[24:25], v5 offset:8192
    ds_read_b64_tr_b16 v[26:27], v5 offset:8704
    s_and_b32 s36, s3, 3
    s_lshl_b32 s36, s36, 6
    s_lshr_b32 s37, s3, 2
    s_lshl_b32 s37, s37, 12
    s_add_u32 s36, s36, s37
    s_lshl_b32 s37, s28, 10
    s_add_u32 s36, s36, s37
    s_add_u32 s36, s36, 58720256
    v_and_b32 v9, 1, v1
    v_lshlrev_b32 v9, 4, v9
    v_lshl_add_u32 v9, v8, 8, v9
    s_waitcnt lgkmcnt(4)
    v_mfma_f32_16x16x32_bf16 v[10:13], v[14:17], v[160:163], 0
    ds_read_b64_tr_b16 v[14:15], v5 offset:12288
    ds_read_b64_tr_b16 v[16:17], v5 offset:12800
    s_waitcnt lgkmcnt(4)
    v_mfma_f32_16x16x32_bf16 v[10:13], v[20:23], v[164:167], v[10:13]
    ds_read_b64_tr_b16 v[20:21], v5 offset:16384
    ds_read_b64_tr_b16 v[22:23], v5 offset:16896
    s_waitcnt lgkmcnt(4)
    v_mfma_f32_16x16x32_bf16 v[10:13], v[24:27], v[168:171], v[10:13]
    ds_read_b64_tr_b16 v[24:25], v5 offset:20480
    ds_read_b64_tr_b16 v[26:27], v5 offset:20992
    s_waitcnt lgkmcnt(4)
    v_mfma_f32_16x16x32_bf16 v[10:13], v[14:17], v[172:175], v[10:13]
    ds_read_b64_tr_b16 v[14:15], v5 offset:24576
    ds_read_b64_tr_b16 v[16:17], v5 offset:25088
    s_waitcnt lgkmcnt(4)
    v_mfma_f32_16x16x32_bf16 v[10:13], v[20:23], v[176:179], v[10:13]
    ds_read_b64_tr_b16 v[20:21], v5 offset:28672
    ds_read_b64_tr_b16 v[22:23], v5 offset:29184
    s_waitcnt lgkmcnt(4)
    v_mfma_f32_16x16x32_bf16 v[10:13], v[24:27], v[180:183], v[10:13]
    s_waitcnt lgkmcnt(2)
    v_mfma_f32_16x16x32_bf16 v[10:13], v[14:17], v[184:187], v[10:13]
    s_waitcnt lgkmcnt(0)
    v_mfma_f32_16x16x32_bf16 v[10:13], v[20:23], v[188:191], v[10:13]
    s_nop 5
    s_mov_b32 exec_lo, 0x00030003
    s_mov_b32 exec_hi, 0x00030003
    buffer_store_dwordx4 v[10:13], v9, s[24:27], s36 offen sc1
    s_mov_b64 exec, -1
    s_nop 1
    s_branch L_recurrent_scan__compressed_kv_cla__moe_arch_mod__prompt_kernel_swend_75
L_recurrent_scan__compressed_kv_cla__moe_arch_mod__prompt_kernel_swn_77:
    s_cmp_eq_u32 s38, 3
    s_cbranch_scc0 L_recurrent_scan__compressed_kv_cla__moe_arch_mod__prompt_kernel_swn_78
    s_and_b32 s20, s3, 3
    s_lshl_b32 s20, s20, 8
    s_lshl_b32 s21, s28, 5
    s_add_u32 s20, s20, s21
    s_lshr_b32 s21, s3, 2
    s_lshl_b32 s21, s21, 7
    v_lshrrev_b32 v25, 3, v1
    s_lshl_b32 s36, s28, 5
    s_add_u32 s36, s36, s20
    v_add_u32 v25, s36, v25
    v_mul_u32_u24 v25, 7168, v25
    v_add_u32 v25, s21, v25
    v_bfe_u32 v26, v1, 4, 1
    v_lshlrev_b32 v26, 1, v26
    v_and_b32 v27, 7, v1
    v_xor_b32 v26, v26, v27
    v_lshl_add_u32 v24, v26, 4, v25
    v_xor_b32 v26, 4, v26
    v_lshl_add_u32 v25, v26, 4, v25
    v_add_u32 v25, 56320, v25
    v_add_u32 v26, 112640, v24
    v_add_u32 v27, 112640, v25
    s_lshl_b32 s36, s28, 13
    s_add_u32 m0, s36, 131072
    s_mov_b32 s37, 229376
    buffer_load_dwordx4 v24, s[8:11], 0 offen offset:0 nt lds
    buffer_load_dwordx4 v25, s[8:11], 0 offen offset:1024 nt lds
    buffer_load_dwordx4 v26, s[8:11], 0 offen offset:2048 nt lds
    buffer_load_dwordx4 v27, s[8:11], 0 offen offset:3072 nt lds
    s_add_u32 m0, s36, 135168
    s_nop 0
    buffer_load_dwordx4 v24, s[8:11], s37 offen offset:0 nt lds
    buffer_load_dwordx4 v25, s[8:11], s37 offen offset:1024 nt lds
    buffer_load_dwordx4 v26, s[8:11], s37 offen offset:2048 nt lds
    buffer_load_dwordx4 v27, s[8:11], s37 offen offset:3072 nt lds
    s_branch L_recurrent_scan__compressed_kv_cla__moe_arch_mod__prompt_kernel_swend_75
L_recurrent_scan__compressed_kv_cla__moe_arch_mod__prompt_kernel_swn_78:
    s_cmp_eq_u32 s38, 5
    s_cbranch_scc0 L_recurrent_scan__compressed_kv_cla__moe_arch_mod__prompt_kernel_swn_79
    v_lshrrev_b32 v8, 4, v1
    v_bfe_u32 v5, v1, 2, 2
    v_lshl_add_u32 v5, v8, 3, v5
    v_lshlrev_b32 v5, 7, v5
    v_and_b32 v9, 3, v1
    v_lshl_add_u32 v5, v9, 3, v5
    v_bfe_u32 v9, v1, 3, 2
    v_xor_b32 v9, s28, v9
    v_lshl_add_u32 v5, v9, 5, v5
    v_add_u32 v5, 131072, v5
    ds_read_b64_tr_b16 v[14:15], v5 offset:0
    ds_read_b64_tr_b16 v[16:17], v5 offset:512
    ds_read_b64_tr_b16 v[20:21], v5 offset:4096
    ds_read_b64_tr_b16 v[22:23], v5 offset:4608
    ds_read_b64_tr_b16 v[24:25], v5 offset:8192
    ds_read_b64_tr_b16 v[26:27], v5 offset:8704
    s_and_b32 s36, s3, 3
    s_lshl_b32 s36, s36, 6
    s_lshr_b32 s37, s3, 2
    s_lshl_b32 s37, s37, 12
    s_add_u32 s36, s36, s37
    s_lshl_b32 s37, s28, 10
    s_add_u32 s36, s36, s37
    s_add_u32 s36, s36, 58720288
    v_and_b32 v9, 1, v1
    v_lshlrev_b32 v9, 4, v9
    v_lshl_add_u32 v9, v8, 8, v9
    s_waitcnt lgkmcnt(4)
    v_mfma_f32_16x16x32_bf16 v[10:13], v[14:17], v[160:163], 0
    ds_read_b64_tr_b16 v[14:15], v5 offset:12288
    ds_read_b64_tr_b16 v[16:17], v5 offset:12800
    s_waitcnt lgkmcnt(4)
    v_mfma_f32_16x16x32_bf16 v[10:13], v[20:23], v[164:167], v[10:13]
    ds_read_b64_tr_b16 v[20:21], v5 offset:16384
    ds_read_b64_tr_b16 v[22:23], v5 offset:16896
    s_waitcnt lgkmcnt(4)
    v_mfma_f32_16x16x32_bf16 v[10:13], v[24:27], v[168:171], v[10:13]
    ds_read_b64_tr_b16 v[24:25], v5 offset:20480
    ds_read_b64_tr_b16 v[26:27], v5 offset:20992
    s_waitcnt lgkmcnt(4)
    v_mfma_f32_16x16x32_bf16 v[10:13], v[14:17], v[172:175], v[10:13]
    ds_read_b64_tr_b16 v[14:15], v5 offset:24576
    ds_read_b64_tr_b16 v[16:17], v5 offset:25088
    s_waitcnt lgkmcnt(4)
    v_mfma_f32_16x16x32_bf16 v[10:13], v[20:23], v[176:179], v[10:13]
    ds_read_b64_tr_b16 v[20:21], v5 offset:28672
    ds_read_b64_tr_b16 v[22:23], v5 offset:29184
    s_waitcnt lgkmcnt(4)
    v_mfma_f32_16x16x32_bf16 v[10:13], v[24:27], v[180:183], v[10:13]
    s_waitcnt lgkmcnt(2)
    v_mfma_f32_16x16x32_bf16 v[10:13], v[14:17], v[184:187], v[10:13]
    s_waitcnt lgkmcnt(0)
    v_mfma_f32_16x16x32_bf16 v[10:13], v[20:23], v[188:191], v[10:13]
    s_nop 5
    s_mov_b32 exec_lo, 0x00030003
    s_mov_b32 exec_hi, 0x00030003
    buffer_store_dwordx4 v[10:13], v9, s[24:27], s36 offen sc1
    s_mov_b64 exec, -1
    s_nop 1
    s_branch L_recurrent_scan__compressed_kv_cla__moe_arch_mod__prompt_kernel_swend_75
L_recurrent_scan__compressed_kv_cla__moe_arch_mod__prompt_kernel_swn_79:
    s_mul_i32 s36, s3, 2341
    s_lshr_b32 s36, s36, 16
    s_add_u32 s36, s36, 48
    s_lshl_b32 s36, s36, 7
    v_mov_b32 v20, s36
    v_mov_b32 v21, 1
    s_mov_b64 exec, 1
    global_atomic_add v20, v21, s[90:91]
    s_mov_b64 exec, -1
    s_nop 3
L_recurrent_scan__compressed_kv_cla__moe_arch_mod__prompt_kernel_swend_75:
L_recurrent_scan__compressed_kv_cla__moe_arch_mod__prompt_kernel_swend_84:
    s_branch L_recurrent_scan__compressed_kv_cla__moe_arch_mod__prompt_kernel_back_89
L_recurrent_scan__compressed_kv_cla__moe_arch_mod__prompt_kernel_rare_98:
    v_mov_b32 v20, 4048155338
    v_subrev_u32 v21, s36, v18
    v_cmp_gt_i32 s[20:21], 0, v21
    v_cmp_gt_i32 s[22:23], 1, v21
    v_cmp_gt_i32 s[62:63], 2, v21
    v_cmp_gt_i32 vcc, 3, v21
    v_cndmask_b32 v112, v112, v20, s[20:21]
    v_cndmask_b32 v113, v113, v20, s[22:23]
    v_cndmask_b32 v114, v114, v20, s[62:63]
    v_cndmask_b32 v115, v115, v20, vcc
    v_cmp_gt_i32 s[20:21], 16, v21
    v_cmp_gt_i32 s[22:23], 17, v21
    v_cmp_gt_i32 s[62:63], 18, v21
    v_cmp_gt_i32 vcc, 19, v21
    v_cndmask_b32 v116, v116, v20, s[20:21]
    v_cndmask_b32 v117, v117, v20, s[22:23]
    v_cndmask_b32 v118, v118, v20, s[62:63]
    v_cndmask_b32 v119, v119, v20, vcc
    v_cmp_gt_i32 s[20:21], -16, v21
    v_cmp_gt_i32 s[22:23], -15, v21
    v_cmp_gt_i32 s[62:63], -14, v21
    v_cmp_gt_i32 vcc, -13, v21
    v_cndmask_b32 v120, v120, v20, s[20:21]
    v_cndmask_b32 v121, v121, v20, s[22:23]
    v_cndmask_b32 v122, v122, v20, s[62:63]
    v_cndmask_b32 v123, v123, v20, vcc
    v_cmp_gt_i32 s[20:21], 0, v21
    v_cmp_gt_i32 s[22:23], 1, v21
    v_cmp_gt_i32 s[62:63], 2, v21
    v_cmp_gt_i32 vcc, 3, v21
    v_cndmask_b32 v124, v124, v20, s[20:21]
    v_cndmask_b32 v125, v125, v20, s[22:23]
    v_cndmask_b32 v126, v126, v20, s[62:63]
    v_cndmask_b32 v127, v127, v20, vcc
    s_branch L_recurrent_scan__compressed_kv_cla__moe_arch_mod__prompt_kernel_back_99
L_recurrent_scan__compressed_kv_cla__moe_arch_mod__prompt_kernel_rare_102:
    s_mov_b32 s61, 0x40000
L_recurrent_scan__compressed_kv_cla__moe_arch_mod__prompt_kernel_spin_100:
    s_sub_u32 s61, s61, 1
    s_cbranch_scc1 L_recurrent_scan__compressed_kv_cla__moe_arch_mod__prompt_kernel_spinx_101
    s_sleep 8
    global_load_dword v11, v12, s[90:91] sc1
    s_waitcnt vmcnt(0)
    v_readfirstlane_b32 s36, v11
    s_nop 0
    s_cmp_lt_u32 s36, 28
    s_cbranch_scc1 L_recurrent_scan__compressed_kv_cla__moe_arch_mod__prompt_kernel_spin_100
L_recurrent_scan__compressed_kv_cla__moe_arch_mod__prompt_kernel_spinx_101:
    s_branch L_recurrent_scan__compressed_kv_cla__moe_arch_mod__prompt_kernel_back_103
L_recurrent_scan__compressed_kv_cla__moe_arch_mod__prompt_kernel_rare_107:
    v_mov_b32 v20, 4048155338
    v_subrev_u32 v21, s50, v18
    v_cmp_gt_i32 s[20:21], 0, v21
    v_cmp_gt_i32 s[22:23], 1, v21
    v_cmp_gt_i32 s[62:63], 2, v21
    v_cmp_gt_i32 vcc, 3, v21
    v_cndmask_b32 v96, v96, v20, s[20:21]
    v_cndmask_b32 v97, v97, v20, s[22:23]
    v_cndmask_b32 v98, v98, v20, s[62:63]
    v_cndmask_b32 v99, v99, v20, vcc
    v_cmp_gt_i32 s[20:21], 16, v21
    v_cmp_gt_i32 s[22:23], 17, v21
    v_cmp_gt_i32 s[62:63], 18, v21
    v_cmp_gt_i32 vcc, 19, v21
    v_cndmask_b32 v100, v100, v20, s[20:21]
    v_cndmask_b32 v101, v101, v20, s[22:23]
    v_cndmask_b32 v102, v102, v20, s[62:63]
    v_cndmask_b32 v103, v103, v20, vcc
    v_cmp_gt_i32 s[20:21], -16, v21
    v_cmp_gt_i32 s[22:23], -15, v21
    v_cmp_gt_i32 s[62:63], -14, v21
    v_cmp_gt_i32 vcc, -13, v21
    v_cndmask_b32 v104, v104, v20, s[20:21]
    v_cndmask_b32 v105, v105, v20, s[22:23]
    v_cndmask_b32 v106, v106, v20, s[62:63]
    v_cndmask_b32 v107, v107, v20, vcc
    v_cmp_gt_i32 s[20:21], 0, v21
    v_cmp_gt_i32 s[22:23], 1, v21
    v_cmp_gt_i32 s[62:63], 2, v21
    v_cmp_gt_i32 vcc, 3, v21
    v_cndmask_b32 v108, v108, v20, s[20:21]
    v_cndmask_b32 v109, v109, v20, s[22:23]
    v_cndmask_b32 v110, v110, v20, s[62:63]
    v_cndmask_b32 v111, v111, v20, vcc
    s_branch L_recurrent_scan__compressed_kv_cla__moe_arch_mod__prompt_kernel_back_108
L_grp1:
    v_mov_b32 v20, 1040356334
    v_mov_b32 v21, v20
    s_and_b32 s37, s28, 3
    s_lshl_b32 s37, s37, 13
    v_lshlrev_b32 v7, 4, v1
    v_add_u32 v4, s37, v7
    v_add_u32 v6, 4096, v4
    v_add_u32 v19, 131072, v4
    s_add_u32 s43, s37, 32768
    s_add_u32 s44, s37, 98304
    s_waitcnt vmcnt(4) lgkmcnt(0)
    v_pk_mul_f32 v[192:193], v[192:193], v[20:21]
    v_pk_mul_f32 v[194:195], v[194:195], v[20:21]
    v_pk_mul_f32 v[196:197], v[196:197], v[20:21]
    v_pk_mul_f32 v[198:199], v[198:199], v[20:21]
    v_cvt_pk_bf16_f32 v128, v192, v193
    v_cvt_pk_bf16_f32 v129, v194, v195
    v_cvt_pk_bf16_f32 v130, v196, v197
    v_cvt_pk_bf16_f32 v131, v198, v199
    v_pk_mul_f32 v[200:201], v[200:201], v[20:21]
    v_pk_mul_f32 v[202:203], v[202:203], v[20:21]
    v_pk_mul_f32 v[204:205], v[204:205], v[20:21]
    v_pk_mul_f32 v[206:207], v[206:207], v[20:21]
    v_cvt_pk_bf16_f32 v132, v200, v201
    v_cvt_pk_bf16_f32 v133, v202, v203
    v_cvt_pk_bf16_f32 v134, v204, v205
    v_cvt_pk_bf16_f32 v135, v206, v207
    v_pk_mul_f32 v[208:209], v[208:209], v[20:21]
    v_pk_mul_f32 v[210:211], v[210:211], v[20:21]
    v_pk_mul_f32 v[212:213], v[212:213], v[20:21]
    v_pk_mul_f32 v[214:215], v[214:215], v[20:21]
    v_cvt_pk_bf16_f32 v136, v208, v209
    v_cvt_pk_bf16_f32 v137, v210, v211
    v_cvt_pk_bf16_f32 v138, v212, v213
    v_cvt_pk_bf16_f32 v139, v214, v215
    v_pk_mul_f32 v[216:217], v[216:217], v[20:21]
    v_pk_mul_f32 v[218:219], v[218:219], v[20:21]
    v_pk_mul_f32 v[220:221], v[220:221], v[20:21]
    v_pk_mul_f32 v[222:223], v[222:223], v[20:21]
    v_cvt_pk_bf16_f32 v140, v216, v217
    v_cvt_pk_bf16_f32 v141, v218, v219
    v_cvt_pk_bf16_f32 v142, v220, v221
    v_cvt_pk_bf16_f32 v143, v222, v223
    v_pk_mul_f32 v[224:225], v[224:225], v[20:21]
    v_pk_mul_f32 v[226:227], v[226:227], v[20:21]
    v_pk_mul_f32 v[228:229], v[228:229], v[20:21]
    v_pk_mul_f32 v[230:231], v[230:231], v[20:21]
    v_cvt_pk_bf16_f32 v144, v224, v225
    v_cvt_pk_bf16_f32 v145, v226, v227
    v_cvt_pk_bf16_f32 v146, v228, v229
    v_cvt_pk_bf16_f32 v147, v230, v231
    v_pk_mul_f32 v[232:233], v[232:233], v[20:21]
    v_pk_mul_f32 v[234:235], v[234:235], v[20:21]
    v_pk_mul_f32 v[236:237], v[236:237], v[20:21]
    v_pk_mul_f32 v[238:239], v[238:239], v[20:21]
    v_cvt_pk_bf16_f32 v148, v232, v233
    v_cvt_pk_bf16_f32 v149, v234, v235
    v_cvt_pk_bf16_f32 v150, v236, v237
    v_cvt_pk_bf16_f32 v151, v238, v239
    v_pk_mul_f32 v[240:241], v[240:241], v[20:21]
    v_pk_mul_f32 v[242:243], v[242:243], v[20:21]
    v_pk_mul_f32 v[244:245], v[244:245], v[20:21]
    v_pk_mul_f32 v[246:247], v[246:247], v[20:21]
    v_cvt_pk_bf16_f32 v152, v240, v241
    v_cvt_pk_bf16_f32 v153, v242, v243
    v_cvt_pk_bf16_f32 v154, v244, v245
    v_cvt_pk_bf16_f32 v155, v246, v247
    v_pk_mul_f32 v[248:249], v[248:249], v[20:21]
    v_pk_mul_f32 v[250:251], v[250:251], v[20:21]
    v_pk_mul_f32 v[252:253], v[252:253], v[20:21]
    v_pk_mul_f32 v[254:255], v[254:255], v[20:21]
    v_cvt_pk_bf16_f32 v156, v248, v249
    v_cvt_pk_bf16_f32 v157, v250, v251
    v_cvt_pk_bf16_f32 v158, v252, v253
    v_cvt_pk_bf16_f32 v159, v254, v255
    v_mov_b32 v2, v7
    v_and_b32 v21, 15, v1
    v_lshrrev_b32 v22, 4, v1
    v_lshlrev_b32 v22, 2, v22
    v_sub_u32 v18, v21, v22
    s_mov_b32 s40, 0
    s_mov_b32 s41, 16384
    s_mov_b32 s49, 0xffff
    s_lshl_b32 s51, s30, 1
    s_add_u32 s51, s51, 1
    s_and_b32 s50, s28, 3
    s_lshl_b32 s50, s50, 5
    v_mov_b32 v36, 0x3f803f80
    v_mov_b32 v37, 0x3f803f80
    v_mov_b32 v38, 0x3f803f80
    v_mov_b32 v39, 0x3f803f80
    s_lshl_b32 s42, 7, s51
    s_lshr_b32 s42, s42, 2
    s_or_b32 s42, s42, 0x8001
    s_mov_b64 s[52:53], 0
    s_waitcnt lgkmcnt(0)
    s_barrier
    ds_read_b128 v[160:163], v19 offset:0
    ds_read_b128 v[164:167], v19 offset:1024
    ds_read_b128 v[168:171], v19 offset:2048
    ds_read_b128 v[172:175], v19 offset:3072
    ds_read_b128 v[176:179], v19 offset:4096
    ds_read_b128 v[180:183], v19 offset:5120
    ds_read_b128 v[184:187], v19 offset:6144
    ds_read_b128 v[188:191], v19 offset:7168
    s_add_u32 s16, s54, 41943040
    s_addc_u32 s17, s55, 0
    s_and_b32 s17, s17, 0xffff
    s_mov_b32 s18, 16777216
    s_mov_b32 s19, 0x20000
    s_cmp_eq_u32 s28, 4
    s_cbranch_scc1 L_recurrent_scan__compressed_kv_cla__moe_arch_mod__prompt_kernel_rare_109
L_recurrent_scan__compressed_kv_cla__moe_arch_mod__prompt_kernel_back_110:
    s_sub_u32 s36, s2, 128
    s_lshl_b32 s36, s36, 1
    s_and_b32 s37, s28, 1
    s_add_u32 s36, s36, s37
    s_cmp_lt_u32 s28, 6
    s_cselect_b64 s[4:5], s[32:33], s[34:35]
    s_cselect_b32 s37, 32, 28
    s_lshl_b32 s37, s37, 3
    s_cmp_lt_u32 s36, s37
    s_cselect_b32 s6, 32768, 0
    s_cselect_b32 s36, s36, 0
    s_sub_u32 s37, s37, s36
    s_lshl_b32 s37, s37, 15
    s_min_u32 s6, s6, s37
    s_lshl_b32 s36, s36, 15
    s_add_u32 s4, s4, s36
    s_addc_u32 s5, s5, 0
    s_and_b32 s5, s5, 0xffff
    s_mov_b32 s7, 0x20000
    v_cmp_gt_u32 vcc, 32, v1
    v_lshlrev_b32 v13, 7, v1
    v_mov_b32 v12, 0x100000
    v_cndmask_b32 v13, v12, v13, vcc
    s_mov_b32 s48, 0
    s_cmp_eq_u32 s28, 5
    s_cselect_b32 s36, 0x1000, 0
    s_or_b32 s42, s42, s36
    ds_read_b128 v[64:67], v2 offset:0
    ds_read_b128 v[68:71], v2 offset:1024
    ds_read_b128 v[72:75], v2 offset:2048
    ds_read_b128 v[76:79], v2 offset:3072
    ds_read_b128 v[80:83], v2 offset:4096
    ds_read_b128 v[84:87], v2 offset:5120
    ds_read_b128 v[88:91], v2 offset:6144
    ds_read_b128 v[92:95], v2 offset:7168
    s_waitcnt lgkmcnt(7)
    v_mfma_f32_16x16x32_bf16 v[96:99], v[64:67], v[128:131], 0
    v_mov_b64 v[192:193], 0
    v_mov_b64 v[194:195], 0
    v_mfma_f32_16x16x32_bf16 v[104:107], v[64:67], v[144:147], 0
    ds_read_b128 v[64:67], v2 offset:8192
    v_mov_b64 v[196:197], 0
    v_mov_b64 v[198:199], 0
    s_waitcnt lgkmcnt(7)
    v_mfma_f32_16x16x32_bf16 v[96:99], v[68:71], v[132:135], v[96:99]
    v_mov_b64 v[200:201], 0
    v_mov_b64 v[202:203], 0
    v_mfma_f32_16x16x32_bf16 v[104:107], v[68:71], v[148:151], v[104:107]
    ds_read_b128 v[68:71], v2 offset:9216
    v_mov_b64 v[204:205], 0
    v_mov_b64 v[206:207], 0
    s_waitcnt lgkmcnt(7)
    v_mfma_f32_16x16x32_bf16 v[96:99], v[72:75], v[136:139], v[96:99]
    v_mov_b64 v[208:209], 0
    v_mfma_f32_16x16x32_bf16 v[104:107], v[72:75], v[152:155], v[104:107]
    ds_read_b128 v[72:75], v2 offset:10240
    v_mov_b64 v[210:211], 0
    v_mov_b64 v[212:213], 0
    s_waitcnt lgkmcnt(7)
    v_mfma_f32_16x16x32_bf16 v[96:99], v[76:79], v[140:143], v[96:99]
    v_mov_b64 v[214:215], 0
    v_mov_b64 v[216:217], 0
    v_mfma_f32_16x16x32_bf16 v[104:107], v[76:79], v[156:159], v[104:107]
    ds_read_b128 v[76:79], v2 offset:11264
    v_mov_b64 v[218:219], 0
    v_mov_b64 v[220:221], 0
    s_waitcnt lgkmcnt(7)
    v_mfma_f32_16x16x32_bf16 v[100:103], v[80:83], v[128:131], 0
    v_mov_b64 v[222:223], 0
    v_mov_b64 v[224:225], 0
    v_mfma_f32_16x16x32_bf16 v[108:111], v[80:83], v[144:147], 0
    ds_read_b128 v[80:83], v2 offset:12288
    v_mov_b64 v[226:227], 0
    s_waitcnt lgkmcnt(7)
    v_mfma_f32_16x16x32_bf16 v[100:103], v[84:87], v[132:135], v[100:103]
    v_mov_b64 v[228:229], 0
    v_mov_b64 v[230:231], 0
    v_mfma_f32_16x16x32_bf16 v[108:111], v[84:87], v[148:151], v[108:111]
    ds_read_b128 v[84:87], v2 offset:13312
    v_mov_b64 v[232:233], 0
    v_mov_b64 v[234:235], 0
    s_waitcnt lgkmcnt(7)
    v_mfma_f32_16x16x32_bf16 v[100:103], v[88:91], v[136:139], v[100:103]
    v_mov_b64 v[236:237], 0
    v_mov_b64 v[238:239], 0
    v_mfma_f32_16x16x32_bf16 v[108:111], v[88:91], v[152:155], v[108:111]
    ds_read_b128 v[88:91], v2 offset:14336
    v_mov_b64 v[240:241], 0
    v_mov_b64 v[242:243], 0
    s_waitcnt lgkmcnt(7)
    v_mfma_f32_16x16x32_bf16 v[100:103], v[92:95], v[140:143], v[100:103]
    v_mov_b64 v[244:245], 0
    v_mfma_f32_16x16x32_bf16 v[108:111], v[92:95], v[156:159], v[108:111]
    ds_read_b128 v[92:95], v2 offset:15360
    v_mov_b64 v[246:247], 0
    v_mov_b64 v[248:249], 0
    s_waitcnt lgkmcnt(7)
    v_mfma_f32_16x16x32_bf16 v[112:115], v[64:67], v[128:131], 0
    v_mov_b64 v[250:251], 0
    v_mov_b64 v[252:253], 0
    v_mfma_f32_16x16x32_bf16 v[120:123], v[64:67], v[144:147], 0
    v_mov_b64 v[254:255], 0
    v_mov_b64 v[28:29], 0
    s_waitcnt lgkmcnt(6)
    v_mfma_f32_16x16x32_bf16 v[112:115], v[68:71], v[132:135], v[112:115]
    v_mov_b64 v[30:31], 0
    v_mov_b64 v[32:33], 0
    v_mfma_f32_16x16x32_bf16 v[120:123], v[68:71], v[148:151], v[120:123]
    v_mov_b64 v[34:35], 0
    s_waitcnt lgkmcnt(5)
    v_mfma_f32_16x16x32_bf16 v[112:115], v[72:75], v[136:139], v[112:115]
    s_add_u32 s36, s30, s50
    s_cmp_eq_u32 s36, 0
    s_cbranch_scc1 L_recurrent_scan__compressed_kv_cla__moe_arch_mod__prompt_kernel_rare_112
L_recurrent_scan__compressed_kv_cla__moe_arch_mod__prompt_kernel_back_113:
    v_mfma_f32_16x16x32_bf16 v[120:123], v[72:75], v[152:155], v[120:123]
    v_max3_f32 v22, v96, v97, v98
    v_max3_f32 v23, v104, v105, v106
    s_waitcnt lgkmcnt(4)
    v_mfma_f32_16x16x32_bf16 v[112:115], v[76:79], v[140:143], v[112:115]
    v_max3_f32 v22, v22, v99, v100
    v_max3_f32 v23, v23, v107, v108
    v_mfma_f32_16x16x32_bf16 v[120:123], v[76:79], v[156:159], v[120:123]
    v_max3_f32 v22, v22, v101, v102
    v_max3_f32 v23, v23, v109, v110
    s_waitcnt lgkmcnt(3)
    v_mfma_f32_16x16x32_bf16 v[116:119], v[80:83], v[128:131], 0
    v_max_f32 v22, v22, v103
    v_max_f32 v23, v23, v111
    v_mfma_f32_16x16x32_bf16 v[124:127], v[80:83], v[144:147], 0
    v_mov_b32 v24, v22
    v_mov_b32 v25, v23
    s_waitcnt lgkmcnt(2)
    v_mfma_f32_16x16x32_bf16 v[116:119], v[84:87], v[132:135], v[116:119]
    v_permlane16_swap_b32 v22, v24
    v_permlane16_swap_b32 v23, v25
    v_mfma_f32_16x16x32_bf16 v[124:127], v[84:87], v[148:151], v[124:127]
    v_max_f32 v22, v22, v24
    v_max_f32 v23, v23, v25
    s_waitcnt lgkmcnt(1)
    v_mfma_f32_16x16x32_bf16 v[116:119], v[88:91], v[136:139], v[116:119]
    v_mov_b32 v24, v22
    v_mov_b32 v25, v23
    v_mfma_f32_16x16x32_bf16 v[124:127], v[88:91], v[152:155], v[124:127]
    v_permlane32_swap_b32 v22, v24
    v_permlane32_swap_b32 v23, v25
    s_waitcnt lgkmcnt(0)
    v_mfma_f32_16x16x32_bf16 v[116:119], v[92:95], v[140:143], v[116:119]
    v_max_f32 v22, v22, v24
    v_max_f32 v23, v23, v25
    v_mfma_f32_16x16x32_bf16 v[124:127], v[92:95], v[156:159], v[124:127]
    v_sub_f32 v40, 0, v22
    v_sub_f32 v41, 0, v22
    v_sub_f32 v42, 0, v22
    v_sub_f32 v43, 0, v22
    v_sub_f32 v44, 0, v23
    v_sub_f32 v45, 0, v23
    v_sub_f32 v46, 0, v23
    v_sub_f32 v47, 0, v23
    v_add_u32 v3, 65536, v2
    v_add_u32 v2, s41, v2
    v_and_b32 v2, s49, v2
    s_waitcnt vmcnt(1)
    s_cmp_eq_u32 s28, 4
    s_cbranch_scc1 L_recurrent_scan__compressed_kv_cla__moe_arch_mod__prompt_kernel_pw_114
    s_waitcnt vmcnt(0)
L_recurrent_scan__compressed_kv_cla__moe_arch_mod__prompt_kernel_pw_114:
    s_barrier
    ds_read_b128 v[64:67], v2 offset:0
    ds_read_b128 v[68:71], v2 offset:1024
    ds_read_b128 v[72:75], v2 offset:2048
    ds_read_b128 v[76:79], v2 offset:3072
    ds_read_b128 v[80:83], v2 offset:4096
    ds_read_b128 v[84:87], v2 offset:5120
    ds_read_b128 v[88:91], v2 offset:6144
    v_pk_add_f32 v[96:97], v[96:97], v[40:41]
    v_pk_add_f32 v[98:99], v[98:99], v[40:41]
    v_pk_add_f32 v[100:101], v[100:101], v[40:41]
    v_pk_add_f32 v[102:103], v[102:103], v[40:41]
    v_pk_add_f32 v[104:105], v[104:105], v[44:45]
    v_pk_add_f32 v[106:107], v[106:107], v[44:45]
    v_pk_add_f32 v[108:109], v[108:109], v[44:45]
    v_pk_add_f32 v[110:111], v[110:111], v[44:45]
    v_pk_add_f32 v[112:113], v[112:113], v[40:41]
    v_pk_add_f32 v[114:115], v[114:115], v[40:41]
    v_pk_add_f32 v[116:117], v[116:117], v[40:41]
    v_pk_add_f32 v[118:119], v[118:119], v[40:41]
    v_pk_add_f32 v[120:121], v[120:121], v[44:45]
    v_pk_add_f32 v[122:123], v[122:123], v[44:45]
    v_pk_add_f32 v[124:125], v[124:125], v[44:45]
    v_pk_add_f32 v[126:127], v[126:127], v[44:45]
    v_exp_f32 v96, v96
    v_exp_f32 v97, v97
    v_exp_f32 v98, v98
    v_exp_f32 v99, v99
    v_exp_f32 v104, v104
    v_exp_f32 v105, v105
    v_exp_f32 v106, v106
    v_exp_f32 v107, v107
    v_exp_f32 v100, v100
    v_exp_f32 v101, v101
    v_exp_f32 v102, v102
    v_exp_f32 v103, v103
    v_exp_f32 v108, v108
    v_exp_f32 v109, v109
    v_exp_f32 v110, v110
    v_exp_f32 v111, v111
    v_cvt_pk_bf16_f32 v48, v96, v97
    v_cvt_pk_bf16_f32 v49, v98, v99
    v_cvt_pk_bf16_f32 v52, v104, v105
    v_cvt_pk_bf16_f32 v53, v106, v107
    v_cvt_pk_bf16_f32 v50, v100, v101
    v_cvt_pk_bf16_f32 v51, v102, v103
    v_cvt_pk_bf16_f32 v54, v108, v109
    v_cvt_pk_bf16_f32 v55, v110, v111
    .p2align 6
L_body1:
    s_bitcmp1_b32 s42, s40
    s_cbranch_scc1 L_recurrent_scan__compressed_kv_cla__moe_arch_mod__prompt_kernel_rare_119
L_recurrent_scan__compressed_kv_cla__moe_arch_mod__prompt_kernel_back_120:
    s_waitcnt lgkmcnt(5)
    v_mfma_f32_16x16x32_bf16 v[96:99], v[64:67], v[128:131], v[40:43]
    v_exp_f32 v112, v112
    v_mfma_f32_16x16x32_bf16 v[104:107], v[64:67], v[144:147], v[44:47]
    ds_read_b128 v[92:95], v2 offset:7168
    v_mfma_f32_16x16x32_bf16 v[96:99], v[68:71], v[132:135], v[96:99]
    v_exp_f32 v113, v113
    v_mfma_f32_16x16x32_bf16 v[104:107], v[68:71], v[148:151], v[104:107]
    ds_read_b128 v[64:67], v3 offset:0
    s_waitcnt lgkmcnt(5)
    v_mfma_f32_16x16x32_bf16 v[96:99], v[72:75], v[136:139], v[96:99]
    v_exp_f32 v114, v114
    v_mfma_f32_16x16x32_bf16 v[104:107], v[72:75], v[152:155], v[104:107]
    ds_read_b128 v[68:71], v3 offset:1024
    v_cvt_pk_bf16_f32 v56, v112, v113
    v_mfma_f32_16x16x32_bf16 v[96:99], v[76:79], v[140:143], v[96:99]
    v_exp_f32 v115, v115
    v_mfma_f32_16x16x32_bf16 v[104:107], v[76:79], v[156:159], v[104:107]
    ds_read_b128 v[72:75], v3 offset:2048
    s_waitcnt lgkmcnt(5)
    v_mfma_f32_16x16x32_bf16 v[100:103], v[80:83], v[128:131], v[40:43]
    v_exp_f32 v120, v120
    v_mfma_f32_16x16x32_bf16 v[108:111], v[80:83], v[144:147], v[44:47]
    ds_read_b128 v[76:79], v3 offset:3072
    v_cvt_pk_bf16_f32 v57, v114, v115
    v_mfma_f32_16x16x32_bf16 v[100:103], v[84:87], v[132:135], v[100:103]
    v_exp_f32 v121, v121
    v_mfma_f32_16x16x32_bf16 v[108:111], v[84:87], v[148:151], v[108:111]
    ds_read_b128 v[80:83], v3 offset:4096
    s_waitcnt lgkmcnt(5)
    v_mfma_f32_16x16x32_bf16 v[100:103], v[88:91], v[136:139], v[100:103]
    v_exp_f32 v122, v122
    v_mfma_f32_16x16x32_bf16 v[108:111], v[88:91], v[152:155], v[108:111]
    ds_read_b128 v[84:87], v3 offset:5120
    v_cvt_pk_bf16_f32 v60, v120, v121
    v_mfma_f32_16x16x32_bf16 v[100:103], v[92:95], v[140:143], v[100:103]
    v_exp_f32 v123, v123
    v_mfma_f32_16x16x32_bf16 v[108:111], v[92:95], v[156:159], v[108:111]
    ds_read_b128 v[88:91], v3 offset:6144
    s_waitcnt lgkmcnt(5)
    v_mfma_f32_16x16x32_bf16 v[192:195], v[64:67], v[48:51], v[192:195]
    v_exp_f32 v116, v116
    v_mfma_f32_16x16x32_bf16 v[224:227], v[64:67], v[52:55], v[224:227]
    ds_read_b128 v[92:95], v3 offset:7168
    v_cvt_pk_bf16_f32 v61, v122, v123
    v_mfma_f32_16x16x32_bf16 v[196:199], v[68:71], v[48:51], v[196:199]
    v_exp_f32 v117, v117
    v_mfma_f32_16x16x32_bf16 v[228:231], v[68:71], v[52:55], v[228:231]
    ds_read_b128 v[64:67], v2 offset:8192
    s_waitcnt lgkmcnt(5)
    v_mfma_f32_16x16x32_bf16 v[200:203], v[72:75], v[48:51], v[200:203]
    v_exp_f32 v118, v118
    v_mfma_f32_16x16x32_bf16 v[232:235], v[72:75], v[52:55], v[232:235]
    v_mfma_f32_16x16x32_bf16 v[28:31], v[36:39], v[48:51], v[28:31]
    ds_read_b128 v[68:71], v2 offset:9216
    v_cvt_pk_bf16_f32 v58, v116, v117
    v_mfma_f32_16x16x32_bf16 v[204:207], v[76:79], v[48:51], v[204:207]
    v_exp_f32 v119, v119
    v_mfma_f32_16x16x32_bf16 v[236:239], v[76:79], v[52:55], v[236:239]
    ds_read_b128 v[72:75], v2 offset:10240
    s_waitcnt lgkmcnt(5)
    v_mfma_f32_16x16x32_bf16 v[208:211], v[80:83], v[48:51], v[208:211]
    v_exp_f32 v124, v124
    buffer_load_dword v0, v13, s[4:7], s48 offen
    s_add_u32 s48, s48, 4096
    v_mfma_f32_16x16x32_bf16 v[240:243], v[80:83], v[52:55], v[240:243]
    ds_read_b128 v[76:79], v2 offset:11264
    v_cvt_pk_bf16_f32 v59, v118, v119
    v_mfma_f32_16x16x32_bf16 v[212:215], v[84:87], v[48:51], v[212:215]
    v_exp_f32 v125, v125
    v_mfma_f32_16x16x32_bf16 v[244:247], v[84:87], v[52:55], v[244:247]
    ds_read_b128 v[80:83], v2 offset:12288
    s_waitcnt lgkmcnt(5)
    v_mfma_f32_16x16x32_bf16 v[216:219], v[88:91], v[48:51], v[216:219]
    v_exp_f32 v126, v126
    v_mfma_f32_16x16x32_bf16 v[248:251], v[88:91], v[52:55], v[248:251]
    v_mfma_f32_16x16x32_bf16 v[32:35], v[36:39], v[52:55], v[32:35]
    ds_read_b128 v[84:87], v2 offset:13312
    v_cvt_pk_bf16_f32 v62, v124, v125
    v_mfma_f32_16x16x32_bf16 v[220:223], v[92:95], v[48:51], v[220:223]
    v_exp_f32 v127, v127
    v_mfma_f32_16x16x32_bf16 v[252:255], v[92:95], v[52:55], v[252:255]
    ds_read_b128 v[88:91], v2 offset:14336
    v_cvt_pk_bf16_f32 v63, v126, v127
    s_bitcmp1_b32 s42, s40
    s_cbranch_scc1 L_recurrent_scan__compressed_kv_cla__moe_arch_mod__prompt_kernel_rare_122
L_recurrent_scan__compressed_kv_cla__moe_arch_mod__prompt_kernel_back_123:
    s_waitcnt lgkmcnt(5)
    v_mfma_f32_16x16x32_bf16 v[112:115], v[64:67], v[128:131], v[40:43]
    v_exp_f32 v96, v96
    v_mfma_f32_16x16x32_bf16 v[120:123], v[64:67], v[144:147], v[44:47]
    ds_read_b128 v[92:95], v2 offset:15360
    v_mfma_f32_16x16x32_bf16 v[112:115], v[68:71], v[132:135], v[112:115]
    v_exp_f32 v97, v97
    v_mfma_f32_16x16x32_bf16 v[120:123], v[68:71], v[148:151], v[120:123]
    ds_read_b128 v[64:67], v3 offset:8192
    s_waitcnt lgkmcnt(5)
    v_mfma_f32_16x16x32_bf16 v[112:115], v[72:75], v[136:139], v[112:115]
    v_exp_f32 v98, v98
    v_mfma_f32_16x16x32_bf16 v[120:123], v[72:75], v[152:155], v[120:123]
    ds_read_b128 v[68:71], v3 offset:9216
    v_cvt_pk_bf16_f32 v48, v96, v97
    v_mfma_f32_16x16x32_bf16 v[112:115], v[76:79], v[140:143], v[112:115]
    v_exp_f32 v99, v99
    v_mfma_f32_16x16x32_bf16 v[120:123], v[76:79], v[156:159], v[120:123]
    ds_read_b128 v[72:75], v3 offset:10240
    s_waitcnt lgkmcnt(5)
    v_mfma_f32_16x16x32_bf16 v[116:119], v[80:83], v[128:131], v[40:43]
    v_exp_f32 v104, v104
    v_mfma_f32_16x16x32_bf16 v[124:127], v[80:83], v[144:147], v[44:47]
    ds_read_b128 v[76:79], v3 offset:11264
    v_cvt_pk_bf16_f32 v49, v98, v99
    v_mfma_f32_16x16x32_bf16 v[116:119], v[84:87], v[132:135], v[116:119]
    v_exp_f32 v105, v105
    v_mfma_f32_16x16x32_bf16 v[124:127], v[84:87], v[148:151], v[124:127]
    ds_read_b128 v[80:83], v3 offset:12288
    s_waitcnt lgkmcnt(5)
    v_mfma_f32_16x16x32_bf16 v[116:119], v[88:91], v[136:139], v[116:119]
    v_exp_f32 v106, v106
    v_mfma_f32_16x16x32_bf16 v[124:127], v[88:91], v[152:155], v[124:127]
    ds_read_b128 v[84:87], v3 offset:13312
    v_cvt_pk_bf16_f32 v52, v104, v105
    v_mfma_f32_16x16x32_bf16 v[116:119], v[92:95], v[140:143], v[116:119]
    v_exp_f32 v107, v107
    v_mfma_f32_16x16x32_bf16 v[124:127], v[92:95], v[156:159], v[124:127]
    ds_read_b128 v[88:91], v3 offset:14336
    s_waitcnt lgkmcnt(5)
    v_mfma_f32_16x16x32_bf16 v[192:195], v[64:67], v[56:59], v[192:195]
    v_exp_f32 v100, v100
    v_mfma_f32_16x16x32_bf16 v[224:227], v[64:67], v[60:63], v[224:227]
    ds_read_b128 v[92:95], v3 offset:15360
    v_cvt_pk_bf16_f32 v53, v106, v107
    v_mfma_f32_16x16x32_bf16 v[196:199], v[68:71], v[56:59], v[196:199]
    v_exp_f32 v101, v101
    v_mfma_f32_16x16x32_bf16 v[228:231], v[68:71], v[60:63], v[228:231]
    v_add_u32 v3, 65536, v2
    v_add_u32 v2, s41, v2
    s_waitcnt lgkmcnt(4)
    v_mfma_f32_16x16x32_bf16 v[200:203], v[72:75], v[56:59], v[200:203]
    v_exp_f32 v102, v102
    v_and_b32 v2, s49, v2
    v_mfma_f32_16x16x32_bf16 v[232:235], v[72:75], v[60:63], v[232:235]
    v_mfma_f32_16x16x32_bf16 v[28:31], v[36:39], v[56:59], v[28:31]
    v_cvt_pk_bf16_f32 v50, v100, v101
    s_waitcnt lgkmcnt(0)
    s_barrier
    v_mfma_f32_16x16x32_bf16 v[204:207], v[76:79], v[56:59], v[204:207]
    v_exp_f32 v103, v103
    v_mfma_f32_16x16x32_bf16 v[236:239], v[76:79], v[60:63], v[236:239]
    ds_read_b128 v[68:71], v2 offset:1024
    ds_read_b128 v[64:67], v2 offset:0
    v_mfma_f32_16x16x32_bf16 v[208:211], v[80:83], v[56:59], v[208:211]
    v_exp_f32 v108, v108
    v_mfma_f32_16x16x32_bf16 v[240:243], v[80:83], v[60:63], v[240:243]
    ds_read_b128 v[76:79], v2 offset:3072
    ds_read_b128 v[72:75], v2 offset:2048
    v_cvt_pk_bf16_f32 v51, v102, v103
    v_mfma_f32_16x16x32_bf16 v[212:215], v[84:87], v[56:59], v[212:215]
    v_exp_f32 v109, v109
    v_mfma_f32_16x16x32_bf16 v[244:247], v[84:87], v[60:63], v[244:247]
    ds_read_b128 v[80:83], v2 offset:4096
    v_mfma_f32_16x16x32_bf16 v[216:219], v[88:91], v[56:59], v[216:219]
    v_exp_f32 v110, v110
    v_mfma_f32_16x16x32_bf16 v[248:251], v[88:91], v[60:63], v[248:251]
    v_mfma_f32_16x16x32_bf16 v[32:35], v[36:39], v[60:63], v[32:35]
    ds_read_b128 v[84:87], v2 offset:5120
    v_cvt_pk_bf16_f32 v54, v108, v109
    v_mfma_f32_16x16x32_bf16 v[220:223], v[92:95], v[56:59], v[220:223]
    v_exp_f32 v111, v111
    v_mfma_f32_16x16x32_bf16 v[252:255], v[92:95], v[60:63], v[252:255]
    ds_read_b128 v[88:91], v2 offset:6144
    v_cvt_pk_bf16_f32 v55, v110, v111
    s_bitcmp1_b32 s42, s40
    s_cbranch_scc1 L_recurrent_scan__compressed_kv_cla__moe_arch_mod__prompt_kernel_rare_132
L_recurrent_scan__compressed_kv_cla__moe_arch_mod__prompt_kernel_back_133:
    s_add_u32 s40, s40, 1
    s_cmp_lg_u32 s40, 16
    s_cbranch_scc1 L_body1
    s_mov_b32 s4, s34
    s_and_b32 s5, s35, 0xffff
    s_mov_b32 s6, 7340032
    s_mov_b32 s7, 0x20000
    s_mov_b32 s8, s32
    s_and_b32 s9, s33, 0xffff
    s_mov_b32 s10, 8388608
    s_mov_b32 s11, 0x20000
    s_lshr_b32 s38, s2, 4
    s_mul_i32 s38, s38, 224
    s_and_b32 s39, s2, 15
    s_lshl_b32 s39, s39, 7
    v_lshrrev_b32 v25, 3, v1
    s_lshl_b32 s36, s28, 5
    s_add_u32 s36, s36, s38
    v_add_u32 v25, s36, v25
    v_mul_u32_u24 v25, 2048, v25
    v_add_u32 v25, s39, v25
    v_bfe_u32 v26, v1, 4, 1
    v_lshlrev_b32 v26, 1, v26
    v_and_b32 v27, 7, v1
    v_xor_b32 v26, v26, v27
    v_lshl_add_u32 v24, v26, 4, v25
    v_xor_b32 v26, 4, v26
    v_lshl_add_u32 v25, v26, 4, v25
    v_add_u32 v25, 15360, v25
    v_add_u32 v26, 30720, v24
    v_add_u32 v27, 30720, v25
    s_lshl_b32 s36, s28, 12
    s_add_u32 s36, s36, 131072
    s_cmp_lt_u32 s28, 7
    s_cselect_b32 m0, s36, 0x30000
    s_cselect_b32 s6, 7340032, 0
    buffer_load_dwordx4 v24, s[4:7], 0 offen offset:0 lds
    buffer_load_dwordx4 v25, s[4:7], 0 offen offset:1024 lds
    buffer_load_dwordx4 v26, s[4:7], 0 offen offset:2048 lds
    buffer_load_dwordx4 v27, s[4:7], 0 offen offset:3072 lds
    s_lshr_b32 s36, s2, 5
    s_add_u32 s36, s36, 48
    s_lshl_b32 s36, s36, 7
    v_mov_b32 v12, s36
    global_load_dword v11, v12, s[90:91] sc1
    s_sub_u32 s36, 96, s50
    s_cmp_lt_i32 s36, 0
    s_cbranch_scc0 L_recurrent_scan__compressed_kv_cla__moe_arch_mod__prompt_kernel_rare_125
L_recurrent_scan__compressed_kv_cla__moe_arch_mod__prompt_kernel_back_126:
    s_waitcnt lgkmcnt(5)
    v_mfma_f32_16x16x32_bf16 v[192:195], v[64:67], v[48:51], v[192:195]
    v_exp_f32 v112, v112
    v_mfma_f32_16x16x32_bf16 v[224:227], v[64:67], v[52:55], v[224:227]
    ds_read_b128 v[92:95], v3 offset:7168
    v_exp_f32 v113, v113
    v_mfma_f32_16x16x32_bf16 v[196:199], v[68:71], v[48:51], v[196:199]
    v_cvt_pk_bf16_f32 v56, v112, v113
    v_exp_f32 v114, v114
    v_mfma_f32_16x16x32_bf16 v[228:231], v[68:71], v[52:55], v[228:231]
    ds_read_b128 v[64:67], v3 offset:8192
    v_exp_f32 v115, v115
    s_waitcnt lgkmcnt(5)
    v_mfma_f32_16x16x32_bf16 v[200:203], v[72:75], v[48:51], v[200:203]
    v_cvt_pk_bf16_f32 v57, v114, v115
    v_exp_f32 v120, v120
    v_mfma_f32_16x16x32_bf16 v[232:235], v[72:75], v[52:55], v[232:235]
    v_mfma_f32_16x16x32_bf16 v[28:31], v[36:39], v[48:51], v[28:31]
    ds_read_b128 v[68:71], v3 offset:9216
    v_exp_f32 v121, v121
    v_mfma_f32_16x16x32_bf16 v[204:207], v[76:79], v[48:51], v[204:207]
    v_cvt_pk_bf16_f32 v60, v120, v121
    v_exp_f32 v122, v122
    v_mfma_f32_16x16x32_bf16 v[236:239], v[76:79], v[52:55], v[236:239]
    ds_read_b128 v[72:75], v3 offset:10240
    v_exp_f32 v123, v123
    s_waitcnt lgkmcnt(6)
    v_mfma_f32_16x16x32_bf16 v[208:211], v[80:83], v[48:51], v[208:211]
    v_cvt_pk_bf16_f32 v61, v122, v123
    v_exp_f32 v116, v116
    v_mfma_f32_16x16x32_bf16 v[240:243], v[80:83], v[52:55], v[240:243]
    ds_read_b128 v[76:79], v3 offset:11264
    v_exp_f32 v117, v117
    s_waitcnt lgkmcnt(6)
    v_mfma_f32_16x16x32_bf16 v[212:215], v[84:87], v[48:51], v[212:215]
    v_cvt_pk_bf16_f32 v58, v116, v117
    v_exp_f32 v118, v118
    v_mfma_f32_16x16x32_bf16 v[244:247], v[84:87], v[52:55], v[244:247]
    ds_read_b128 v[80:83], v3 offset:12288
    v_exp_f32 v119, v119
    s_waitcnt lgkmcnt(6)
    v_mfma_f32_16x16x32_bf16 v[216:219], v[88:91], v[48:51], v[216:219]
    v_cvt_pk_bf16_f32 v59, v118, v119
    v_exp_f32 v124, v124
    v_mfma_f32_16x16x32_bf16 v[248:251], v[88:91], v[52:55], v[248:251]
    v_mfma_f32_16x16x32_bf16 v[32:35], v[36:39], v[52:55], v[32:35]
    ds_read_b128 v[84:87], v3 offset:13312
    v_exp_f32 v125, v125
    s_waitcnt lgkmcnt(6)
    v_mfma_f32_16x16x32_bf16 v[220:223], v[92:95], v[48:51], v[220:223]
    v_cvt_pk_bf16_f32 v62, v124, v125
    v_exp_f32 v126, v126
    v_mfma_f32_16x16x32_bf16 v[252:255], v[92:95], v[52:55], v[252:255]
    ds_read_b128 v[88:91], v3 offset:14336
    v_exp_f32 v127, v127
    s_nop 0
    v_cvt_pk_bf16_f32 v63, v126, v127
    s_nop 1
    s_waitcnt lgkmcnt(6)
    v_mfma_f32_16x16x32_bf16 v[192:195], v[64:67], v[56:59], v[192:195]
    v_mfma_f32_16x16x32_bf16 v[224:227], v[64:67], v[60:63], v[224:227]
    ds_read_b128 v[92:95], v3 offset:15360
    s_waitcnt lgkmcnt(6)
    v_mfma_f32_16x16x32_bf16 v[196:199], v[68:71], v[56:59], v[196:199]
    v_mfma_f32_16x16x32_bf16 v[228:231], v[68:71], v[60:63], v[228:231]
    s_waitcnt lgkmcnt(5)
    v_mfma_f32_16x16x32_bf16 v[200:203], v[72:75], v[56:59], v[200:203]
    v_mfma_f32_16x16x32_bf16 v[232:235], v[72:75], v[60:63], v[232:235]
    v_mfma_f32_16x16x32_bf16 v[28:31], v[36:39], v[56:59], v[28:31]
    s_waitcnt lgkmcnt(4)
    v_mfma_f32_16x16x32_bf16 v[204:207], v[76:79], v[56:59], v[204:207]
    v_mfma_f32_16x16x32_bf16 v[236:239], v[76:79], v[60:63], v[236:239]
    s_waitcnt lgkmcnt(3)
    v_mfma_f32_16x16x32_bf16 v[208:211], v[80:83], v[56:59], v[208:211]
    v_mfma_f32_16x16x32_bf16 v[240:243], v[80:83], v[60:63], v[240:243]
    s_waitcnt lgkmcnt(2)
    v_mfma_f32_16x16x32_bf16 v[212:215], v[84:87], v[56:59], v[212:215]
    v_mfma_f32_16x16x32_bf16 v[244:247], v[84:87], v[60:63], v[244:247]
    s_waitcnt lgkmcnt(1)
    v_mfma_f32_16x16x32_bf16 v[216:219], v[88:91], v[56:59], v[216:219]
    v_mfma_f32_16x16x32_bf16 v[248:251], v[88:91], v[60:63], v[248:251]
    v_mfma_f32_16x16x32_bf16 v[32:35], v[36:39], v[60:63], v[32:35]
    s_waitcnt lgkmcnt(0)
    v_mfma_f32_16x16x32_bf16 v[220:223], v[92:95], v[56:59], v[220:223]
    v_mfma_f32_16x16x32_bf16 v[252:255], v[92:95], v[60:63], v[252:255]
    s_waitcnt vmcnt(0)
    v_readfirstlane_b32 s36, v11
    s_nop 0
    s_cmp_lt_u32 s36, 28
    s_cbranch_scc1 L_recurrent_scan__compressed_kv_cla__moe_arch_mod__prompt_kernel_rare_136
L_recurrent_scan__compressed_kv_cla__moe_arch_mod__prompt_kernel_back_137:
    s_lshr_b32 s36, s2, 4
    s_mul_i32 s36, s36, 7
    s_min_u32 s37, s28, 6
    s_add_u32 s36, s36, s37
    s_lshl_b32 s36, s36, 11
    s_add_u32 s36, s36, 58720256
    v_and_b32 v11, 15, v1
    v_lshlrev_b32 v11, 4, v11
    v_lshrrev_b32 v12, 4, v1
    v_lshl_add_u32 v11, v12, 9, v11
    buffer_load_dwordx4 v[96:99], v11, s[24:27], s36 offen offset:0 sc1
    buffer_load_dwordx4 v[100:103], v11, s[24:27], s36 offen offset:256 sc1
    s_lshl_b32 s37, s28, 13
    v_add_u32 v105, s37, v7
    v_xor_b32 v106, 32768, v105
    s_lshl_b32 s37, s28, 8
    s_add_u32 s37, s37, 159744
    v_lshl_add_u32 v107, v1, 2, s37
    v_xor_b32 v108, 1024, v107
    ds_write_b32 v107, v28
    s_mov_b32 s36, 0x5d800000
    v_cmp_nge_f32 vcc, s36, v28
    s_nop 0
    s_or_b64 s[52:53], s[52:53], vcc
    v_cmp_nge_f32 vcc, s36, v32
    s_nop 0
    s_or_b64 s[52:53], s[52:53], vcc
    s_or_b32 s36, s52, s53
    v_mov_b32 v110, s36
    s_lshl_b32 s37, s28, 2
    s_add_u32 s37, s37, 161792
    v_mov_b32 v111, s37
    ds_write_b32 v111, v110
    ds_write_b128 v105, v[192:195] offset:0
    ds_write_b128 v105, v[196:199] offset:1024
    ds_write_b128 v105, v[200:203] offset:2048
    ds_write_b128 v105, v[204:207] offset:3072
    ds_write_b128 v105, v[208:211] offset:4096
    ds_write_b128 v105, v[212:215] offset:5120
    ds_write_b128 v105, v[216:219] offset:6144
    ds_write_b128 v105, v[220:223] offset:7168
    v_mov_b32 v112, 161856
    v_and_b32 v111, 7, v1
    v_lshlrev_b32 v111, 2, v111
    v_add_u32 v111, 161792, v111
    s_sub_u32 s36, 15, s30
    s_lshl_b32 s38, s36, 3
    s_and_b32 s37, s28, 3
    s_lshl_b32 s37, s37, 1
    s_add_u32 s38, s38, s37
    s_add_u32 s38, s38, 1
    s_lshl_b32 s38, s38, 17
    s_lshl_b32 s37, s29, 12
    s_add_u32 s38, s38, s37
    s_waitcnt lgkmcnt(0)
    s_barrier
    ds_read_b128 v[114:117], v112
    ds_read_b32 v110, v111
    ds_read_b32 v109, v108
    ds_read_b128 v[64:67], v106 offset:0
    ds_read_b128 v[68:71], v106 offset:1024
    ds_read_b128 v[72:75], v106 offset:2048
    ds_read_b128 v[76:79], v106 offset:3072
    ds_read_b128 v[80:83], v106 offset:4096
    ds_read_b128 v[84:87], v106 offset:5120
    ds_read_b128 v[88:91], v106 offset:6144
    ds_read_b128 v[92:95], v106 offset:7168
    s_waitcnt lgkmcnt(8)
    v_add_f32 v109, v109, v32
    v_cmp_ne_u32 s[52:53], 0, v110
    v_readfirstlane_b32 s56, v114
    v_readfirstlane_b32 s57, v115
    v_readfirstlane_b32 s58, v116
    v_readfirstlane_b32 s59, v117
    v_rcp_f32 v109, v109
    s_nop 0
    v_mov_b32 v108, v109
    s_waitcnt lgkmcnt(6)
    v_pk_add_f32 v[224:225], v[224:225], v[64:65]
    v_pk_add_f32 v[226:227], v[226:227], v[66:67]
    v_pk_add_f32 v[228:229], v[228:229], v[68:69]
    v_pk_add_f32 v[230:231], v[230:231], v[70:71]
    v_pk_mul_f32 v[224:225], v[224:225], v[108:109]
    v_pk_mul_f32 v[226:227], v[226:227], v[108:109]
    v_pk_mul_f32 v[228:229], v[228:229], v[108:109]
    v_pk_mul_f32 v[230:231], v[230:231], v[108:109]
    v_cvt_pk_bf16_f32 v48, v224, v225
    v_cvt_pk_bf16_f32 v49, v226, v227
    v_cvt_pk_bf16_f32 v50, v228, v229
    v_cvt_pk_bf16_f32 v51, v230, v231
    buffer_store_dwordx4 v[48:51], v7, s[16:19], s38 offen offset:0 sc1
    s_waitcnt lgkmcnt(4)
    v_pk_add_f32 v[232:233], v[232:233], v[72:73]
    v_pk_add_f32 v[234:235], v[234:235], v[74:75]
    v_pk_add_f32 v[236:237], v[236:237], v[76:77]
    v_pk_add_f32 v[238:239], v[238:239], v[78:79]
    v_pk_mul_f32 v[232:233], v[232:233], v[108:109]
    v_pk_mul_f32 v[234:235], v[234:235], v[108:109]
    v_pk_mul_f32 v[236:237], v[236:237], v[108:109]
    v_pk_mul_f32 v[238:239], v[238:239], v[108:109]
    v_cvt_pk_bf16_f32 v52, v232, v233
    v_cvt_pk_bf16_f32 v53, v234, v235
    v_cvt_pk_bf16_f32 v54, v236, v237
    v_cvt_pk_bf16_f32 v55, v238, v239
    buffer_store_dwordx4 v[52:55], v7, s[16:19], s38 offen offset:1024 sc1
    s_waitcnt lgkmcnt(2)
    v_pk_add_f32 v[240:241], v[240:241], v[80:81]
    v_pk_add_f32 v[242:243], v[242:243], v[82:83]
    v_pk_add_f32 v[244:245], v[244:245], v[84:85]
    v_pk_add_f32 v[246:247], v[246:247], v[86:87]
    v_pk_mul_f32 v[240:241], v[240:241], v[108:109]
    v_pk_mul_f32 v[242:243], v[242:243], v[108:109]
    v_pk_mul_f32 v[244:245], v[244:245], v[108:109]
    v_pk_mul_f32 v[246:247], v[246:247], v[108:109]
    v_cvt_pk_bf16_f32 v56, v240, v241
    v_cvt_pk_bf16_f32 v57, v242, v243
    v_cvt_pk_bf16_f32 v58, v244, v245
    v_cvt_pk_bf16_f32 v59, v246, v247
    buffer_store_dwordx4 v[56:59], v7, s[16:19], s38 offen offset:2048 sc1
    s_waitcnt lgkmcnt(0)
    v_pk_add_f32 v[248:249], v[248:249], v[88:89]
    v_pk_add_f32 v[250:251], v[250:251], v[90:91]
    v_pk_add_f32 v[252:253], v[252:253], v[92:93]
    v_pk_add_f32 v[254:255], v[254:255], v[94:95]
    v_pk_mul_f32 v[248:249], v[248:249], v[108:109]
    v_pk_mul_f32 v[250:251], v[250:251], v[108:109]
    v_pk_mul_f32 v[252:253], v[252:253], v[108:109]
    v_pk_mul_f32 v[254:255], v[254:255], v[108:109]
    v_cvt_pk_bf16_f32 v60, v248, v249
    v_cvt_pk_bf16_f32 v61, v250, v251
    v_cvt_pk_bf16_f32 v62, v252, v253
    v_cvt_pk_bf16_f32 v63, v254, v255
    buffer_store_dwordx4 v[60:63], v7, s[16:19], s38 offen offset:3072 sc1
    s_cmp_eq_u64 s[52:53], 0
    s_cbranch_scc1 L_p3_done
    s_waitcnt vmcnt(0)
    v_mov_b32 v112, v96
    v_mov_b32 v113, v97
    v_mov_b32 v114, v98
    v_mov_b32 v115, v99
    v_mov_b32 v116, v100
    v_mov_b32 v117, v101
    v_mov_b32 v118, v102
    v_mov_b32 v119, v103
    v_swap_b32 v128, v160
    v_swap_b32 v129, v161
    v_swap_b32 v130, v162
    v_swap_b32 v131, v163
    v_swap_b32 v132, v164
    v_swap_b32 v133, v165
    v_swap_b32 v134, v166
    v_swap_b32 v135, v167
    v_swap_b32 v136, v168
    v_swap_b32 v137, v169
    v_swap_b32 v138, v170
    v_swap_b32 v139, v171
    v_swap_b32 v140, v172
    v_swap_b32 v141, v173
    v_swap_b32 v142, v174
    v_swap_b32 v143, v175
    v_swap_b32 v144, v176
    v_swap_b32 v145, v177
    v_swap_b32 v146, v178
    v_swap_b32 v147, v179
    v_swap_b32 v148, v180
    v_swap_b32 v149, v181
    v_swap_b32 v150, v182
    v_swap_b32 v151, v183
    v_swap_b32 v152, v184
    v_swap_b32 v153, v185
    v_swap_b32 v154, v186
    v_swap_b32 v155, v187
    v_swap_b32 v156, v188
    v_swap_b32 v157, v189
    v_swap_b32 v158, v190
    v_swap_b32 v159, v191
    v_mov_b32 v192, 0
    v_mov_b32 v193, 0
    v_mov_b32 v194, 0
    v_mov_b32 v195, 0
    v_mov_b32 v196, 0
    v_mov_b32 v197, 0
    v_mov_b32 v198, 0
    v_mov_b32 v199, 0
    v_mov_b32 v200, 0
    v_mov_b32 v201, 0
    v_mov_b32 v202, 0
    v_mov_b32 v203, 0
    v_mov_b32 v204, 0
    v_mov_b32 v205, 0
    v_mov_b32 v206, 0
    v_mov_b32 v207, 0
    v_mov_b32 v208, 0
    v_mov_b32 v209, 0
    v_mov_b32 v210, 0
    v_mov_b32 v211, 0
    v_mov_b32 v212, 0
    v_mov_b32 v213, 0
    v_mov_b32 v214, 0
    v_mov_b32 v215, 0
    v_mov_b32 v216, 0
    v_mov_b32 v217, 0
    v_mov_b32 v218, 0
    v_mov_b32 v219, 0
    v_mov_b32 v220, 0
    v_mov_b32 v221, 0
    v_mov_b32 v222, 0
    v_mov_b32 v223, 0
    v_mov_b32 v224, 0
    v_mov_b32 v225, 0
    v_mov_b32 v226, 0
    v_mov_b32 v227, 0
    v_mov_b32 v228, 0
    v_mov_b32 v229, 0
    v_mov_b32 v230, 0
    v_mov_b32 v231, 0
    v_mov_b32 v232, 0
    v_mov_b32 v233, 0
    v_mov_b32 v234, 0
    v_mov_b32 v235, 0
    v_mov_b32 v236, 0
    v_mov_b32 v237, 0
    v_mov_b32 v238, 0
    v_mov_b32 v239, 0
    v_mov_b32 v240, 0
    v_mov_b32 v241, 0
    v_mov_b32 v242, 0
    v_mov_b32 v243, 0
    v_mov_b32 v244, 0
    v_mov_b32 v245, 0
    v_mov_b32 v246, 0
    v_mov_b32 v247, 0
    v_mov_b32 v248, 0
    v_mov_b32 v249, 0
    v_mov_b32 v250, 0
    v_mov_b32 v251, 0
    v_mov_b32 v252, 0
    v_mov_b32 v253, 0
    v_mov_b32 v254, 0
    v_mov_b32 v255, 0
    v_mov_b32 v28, 0
    v_mov_b32 v40, 4048155338
    v_mov_b32 v32, 0
    v_mov_b32 v41, 4048155338
    s_lshl_b32 s43, s28, 12
    v_add_u32 v4, s43, v7
    s_mov_b32 s46, s45
    s_sub_u32 s40, 16, s30
    s_mov_b32 s39, s30
    s_lshl_b32 s37, s39, 7
    s_and_b32 s36, s28, 3
    s_lshl_b32 s36, s36, 5
    s_add_u32 s36, s36, s37
    s_sub_u32 s50, 0, s36
L_recurrent_scan__compressed_kv_cla__moe_arch_mod__prompt_kernel_stile_138:
    s_waitcnt vmcnt(0) lgkmcnt(0)
    s_barrier
    s_mov_b32 m0, s43
    s_add_u32 s47, s46, 32768
    buffer_load_dwordx4 v4, s[12:15], s46 offen offset:0 sc1 lds
    buffer_load_dwordx4 v4, s[12:15], s46 offen offset:1024 sc1 lds
    buffer_load_dwordx4 v4, s[12:15], s46 offen offset:2048 sc1 lds
    buffer_load_dwordx4 v4, s[12:15], s46 offen offset:3072 sc1 lds
    s_add_u32 m0, s43, 32768
    s_add_u32 s46, s46, 65536
    buffer_load_dwordx4 v4, s[12:15], s47 offen offset:0 sc1 lds
    buffer_load_dwordx4 v4, s[12:15], s47 offen offset:1024 sc1 lds
    buffer_load_dwordx4 v4, s[12:15], s47 offen offset:2048 sc1 lds
    buffer_load_dwordx4 v4, s[12:15], s47 offen offset:3072 sc1 lds
    v_mov_b32 v2, v7
    s_mov_b32 s41, 4
    s_waitcnt vmcnt(0)
    s_barrier
L_recurrent_scan__compressed_kv_cla__moe_arch_mod__prompt_kernel_sunit_139:
    s_cmp_gt_i32 s50, 0
    s_cbranch_scc1 L_recurrent_scan__compressed_kv_cla__moe_arch_mod__prompt_kernel_snext_140
    ds_read_b128 v[64:67], v2 offset:0
    ds_read_b128 v[68:71], v2 offset:1024
    ds_read_b128 v[72:75], v2 offset:2048
    ds_read_b128 v[76:79], v2 offset:3072
    ds_read_b128 v[80:83], v2 offset:4096
    ds_read_b128 v[84:87], v2 offset:5120
    ds_read_b128 v[88:91], v2 offset:6144
    ds_read_b128 v[92:95], v2 offset:7168
    s_waitcnt lgkmcnt(0)
    v_mfma_f32_16x16x32_bf16 v[96:99], v[64:67], v[128:131], 0
    v_mfma_f32_16x16x32_bf16 v[104:107], v[64:67], v[144:147], 0
    v_mfma_f32_16x16x32_bf16 v[96:99], v[68:71], v[132:135], v[96:99]
    v_mfma_f32_16x16x32_bf16 v[104:107], v[68:71], v[148:151], v[104:107]
    v_mfma_f32_16x16x32_bf16 v[96:99], v[72:75], v[136:139], v[96:99]
    v_mfma_f32_16x16x32_bf16 v[104:107], v[72:75], v[152:155], v[104:107]
    v_mfma_f32_16x16x32_bf16 v[96:99], v[76:79], v[140:143], v[96:99]
    v_mfma_f32_16x16x32_bf16 v[104:107], v[76:79], v[156:159], v[104:107]
    v_mfma_f32_16x16x32_bf16 v[100:103], v[80:83], v[128:131], 0
    v_mfma_f32_16x16x32_bf16 v[108:111], v[80:83], v[144:147], 0
    v_mfma_f32_16x16x32_bf16 v[100:103], v[84:87], v[132:135], v[100:103]
    v_mfma_f32_16x16x32_bf16 v[108:111], v[84:87], v[148:151], v[108:111]
    v_mfma_f32_16x16x32_bf16 v[100:103], v[88:91], v[136:139], v[100:103]
    v_mfma_f32_16x16x32_bf16 v[108:111], v[88:91], v[152:155], v[108:111]
    v_mfma_f32_16x16x32_bf16 v[100:103], v[92:95], v[140:143], v[100:103]
    v_mfma_f32_16x16x32_bf16 v[108:111], v[92:95], v[156:159], v[108:111]
    ds_read_b128 v[64:67], v2 offset:32768
    ds_read_b128 v[68:71], v2 offset:33792
    ds_read_b128 v[72:75], v2 offset:34816
    ds_read_b128 v[76:79], v2 offset:35840
    ds_read_b128 v[80:83], v2 offset:36864
    ds_read_b128 v[84:87], v2 offset:37888
    ds_read_b128 v[88:91], v2 offset:38912
    ds_read_b128 v[92:95], v2 offset:39936
    s_nop 1
    s_cmp_lt_i32 s50, 0
    s_cbranch_scc0 L_recurrent_scan__compressed_kv_cla__moe_arch_mod__prompt_kernel_rare_141
L_recurrent_scan__compressed_kv_cla__moe_arch_mod__prompt_kernel_back_142:
    v_max3_f32 v22, v96, v97, v98
    v_max3_f32 v22, v22, v99, v100
    v_max3_f32 v22, v22, v101, v102
    v_max3_f32 v22, v22, v103, v40
    v_mov_b32 v24, v22
    s_nop 1
    v_permlane16_swap_b32 v22, v24
    s_nop 1
    v_max_f32 v22, v22, v24
    v_mov_b32 v24, v22
    s_nop 1
    v_permlane32_swap_b32 v22, v24
    s_nop 1
    v_max_f32 v22, v22, v24
    v_sub_f32 v25, v40, v22
    v_exp_f32 v25, v25
    v_mov_b32 v40, v22
    v_mul_f32 v28, v28, v25
    v_mul_f32 v192, v192, v25
    v_mul_f32 v193, v193, v25
    v_mul_f32 v194, v194, v25
    v_mul_f32 v195, v195, v25
    v_mul_f32 v196, v196, v25
    v_mul_f32 v197, v197, v25
    v_mul_f32 v198, v198, v25
    v_mul_f32 v199, v199, v25
    v_mul_f32 v200, v200, v25
    v_mul_f32 v201, v201, v25
    v_mul_f32 v202, v202, v25
    v_mul_f32 v203, v203, v25
    v_mul_f32 v204, v204, v25
    v_mul_f32 v205, v205, v25
    v_mul_f32 v206, v206, v25
    v_mul_f32 v207, v207, v25
    v_mul_f32 v208, v208, v25
    v_mul_f32 v209, v209, v25
    v_mul_f32 v210, v210, v25
    v_mul_f32 v211, v211, v25
    v_mul_f32 v212, v212, v25
    v_mul_f32 v213, v213, v25
    v_mul_f32 v214, v214, v25
    v_mul_f32 v215, v215, v25
    v_mul_f32 v216, v216, v25
    v_mul_f32 v217, v217, v25
    v_mul_f32 v218, v218, v25
    v_mul_f32 v219, v219, v25
    v_mul_f32 v220, v220, v25
    v_mul_f32 v221, v221, v25
    v_mul_f32 v222, v222, v25
    v_mul_f32 v223, v223, v25
    v_sub_f32 v96, v96, v22
    v_sub_f32 v97, v97, v22
    v_sub_f32 v98, v98, v22
    v_sub_f32 v99, v99, v22
    v_sub_f32 v100, v100, v22
    v_sub_f32 v101, v101, v22
    v_sub_f32 v102, v102, v22
    v_sub_f32 v103, v103, v22
    v_max3_f32 v23, v104, v105, v106
    v_max3_f32 v23, v23, v107, v108
    v_max3_f32 v23, v23, v109, v110
    v_max3_f32 v23, v23, v111, v41
    v_mov_b32 v24, v23
    s_nop 1
    v_permlane16_swap_b32 v23, v24
    s_nop 1
    v_max_f32 v23, v23, v24
    v_mov_b32 v24, v23
    s_nop 1
    v_permlane32_swap_b32 v23, v24
    s_nop 1
    v_max_f32 v23, v23, v24
    v_sub_f32 v25, v41, v23
    v_exp_f32 v25, v25
    v_mov_b32 v41, v23
    v_mul_f32 v32, v32, v25
    v_mul_f32 v224, v224, v25
    v_mul_f32 v225, v225, v25
    v_mul_f32 v226, v226, v25
    v_mul_f32 v227, v227, v25
    v_mul_f32 v228, v228, v25
    v_mul_f32 v229, v229, v25
    v_mul_f32 v230, v230, v25
    v_mul_f32 v231, v231, v25
    v_mul_f32 v232, v232, v25
    v_mul_f32 v233, v233, v25
    v_mul_f32 v234, v234, v25
    v_mul_f32 v235, v235, v25
    v_mul_f32 v236, v236, v25
    v_mul_f32 v237, v237, v25
    v_mul_f32 v238, v238, v25
    v_mul_f32 v239, v239, v25
    v_mul_f32 v240, v240, v25
    v_mul_f32 v241, v241, v25
    v_mul_f32 v242, v242, v25
    v_mul_f32 v243, v243, v25
    v_mul_f32 v244, v244, v25
    v_mul_f32 v245, v245, v25
    v_mul_f32 v246, v246, v25
    v_mul_f32 v247, v247, v25
    v_mul_f32 v248, v248, v25
    v_mul_f32 v249, v249, v25
    v_mul_f32 v250, v250, v25
    v_mul_f32 v251, v251, v25
    v_mul_f32 v252, v252, v25
    v_mul_f32 v253, v253, v25
    v_mul_f32 v254, v254, v25
    v_mul_f32 v255, v255, v25
    v_sub_f32 v104, v104, v23
    v_sub_f32 v105, v105, v23
    v_sub_f32 v106, v106, v23
    v_sub_f32 v107, v107, v23
    v_sub_f32 v108, v108, v23
    v_sub_f32 v109, v109, v23
    v_sub_f32 v110, v110, v23
    v_sub_f32 v111, v111, v23
    v_exp_f32 v96, v96
    v_exp_f32 v97, v97
    v_exp_f32 v98, v98
    v_exp_f32 v99, v99
    v_exp_f32 v104, v104
    v_exp_f32 v105, v105
    v_exp_f32 v106, v106
    v_exp_f32 v107, v107
    v_exp_f32 v100, v100
    v_exp_f32 v101, v101
    v_exp_f32 v102, v102
    v_exp_f32 v103, v103
    v_exp_f32 v108, v108
    v_exp_f32 v109, v109
    v_exp_f32 v110, v110
    v_exp_f32 v111, v111
    v_add_f32 v28, v28, v96
    v_add_f32 v28, v28, v97
    v_cvt_pk_bf16_f32 v48, v96, v97
    v_add_f32 v28, v28, v98
    v_add_f32 v28, v28, v99
    v_cvt_pk_bf16_f32 v49, v98, v99
    v_add_f32 v32, v32, v104
    v_add_f32 v32, v32, v105
    v_cvt_pk_bf16_f32 v52, v104, v105
    v_add_f32 v32, v32, v106
    v_add_f32 v32, v32, v107
    v_cvt_pk_bf16_f32 v53, v106, v107
    v_add_f32 v28, v28, v100
    v_add_f32 v28, v28, v101
    v_cvt_pk_bf16_f32 v50, v100, v101
    v_add_f32 v28, v28, v102
    v_add_f32 v28, v28, v103
    v_cvt_pk_bf16_f32 v51, v102, v103
    v_add_f32 v32, v32, v108
    v_add_f32 v32, v32, v109
    v_cvt_pk_bf16_f32 v54, v108, v109
    v_add_f32 v32, v32, v110
    v_add_f32 v32, v32, v111
    v_cvt_pk_bf16_f32 v55, v110, v111
    s_waitcnt lgkmcnt(0)
    s_nop 0
    v_mfma_f32_16x16x32_bf16 v[192:195], v[64:67], v[48:51], v[192:195]
    v_mfma_f32_16x16x32_bf16 v[224:227], v[64:67], v[52:55], v[224:227]
    v_mfma_f32_16x16x32_bf16 v[196:199], v[68:71], v[48:51], v[196:199]
    v_mfma_f32_16x16x32_bf16 v[228:231], v[68:71], v[52:55], v[228:231]
    v_mfma_f32_16x16x32_bf16 v[200:203], v[72:75], v[48:51], v[200:203]
    v_mfma_f32_16x16x32_bf16 v[232:235], v[72:75], v[52:55], v[232:235]
    v_mfma_f32_16x16x32_bf16 v[204:207], v[76:79], v[48:51], v[204:207]
    v_mfma_f32_16x16x32_bf16 v[236:239], v[76:79], v[52:55], v[236:239]
    v_mfma_f32_16x16x32_bf16 v[208:211], v[80:83], v[48:51], v[208:211]
    v_mfma_f32_16x16x32_bf16 v[240:243], v[80:83], v[52:55], v[240:243]
    v_mfma_f32_16x16x32_bf16 v[212:215], v[84:87], v[48:51], v[212:215]
    v_mfma_f32_16x16x32_bf16 v[244:247], v[84:87], v[52:55], v[244:247]
    v_mfma_f32_16x16x32_bf16 v[216:219], v[88:91], v[48:51], v[216:219]
    v_mfma_f32_16x16x32_bf16 v[248:251], v[88:91], v[52:55], v[248:251]
    v_mfma_f32_16x16x32_bf16 v[220:223], v[92:95], v[48:51], v[220:223]
    v_mfma_f32_16x16x32_bf16 v[252:255], v[92:95], v[52:55], v[252:255]
L_recurrent_scan__compressed_kv_cla__moe_arch_mod__prompt_kernel_snext_140:
    v_add_u32 v2, 8192, v2
    s_add_u32 s50, s50, 32
    s_sub_u32 s41, s41, 1
    s_cmp_lg_u32 s41, 0
    s_cbranch_scc1 L_recurrent_scan__compressed_kv_cla__moe_arch_mod__prompt_kernel_sunit_139
    s_sub_u32 s40, s40, 1
    s_cmp_lg_u32 s40, 0
    s_cbranch_scc1 L_recurrent_scan__compressed_kv_cla__moe_arch_mod__prompt_kernel_stile_138
    v_mov_b32 v20, v28
    s_nop 1
    v_permlane16_swap_b32 v28, v20
    s_nop 1
    v_add_f32 v28, v28, v20
    v_mov_b32 v20, v28
    s_nop 1
    v_permlane32_swap_b32 v28, v20
    s_nop 1
    v_add_f32 v28, v28, v20
    v_mov_b32 v20, v32
    s_nop 1
    v_permlane16_swap_b32 v32, v20
    s_nop 1
    v_add_f32 v32, v32, v20
    v_mov_b32 v20, v32
    s_nop 1
    v_permlane32_swap_b32 v32, v20
    s_nop 1
    v_add_f32 v32, v32, v20
    s_mov_b32 s36, 0x5d800000
    v_cmp_nge_f32 vcc, s36, v28
    s_nop 0
    s_or_b64 s[52:53], s[52:53], vcc
    v_cmp_nge_f32 vcc, s36, v32
    s_nop 0
    s_or_b64 s[52:53], s[52:53], vcc
    v_rcp_f32 v20, v28
    v_rcp_f32 v22, v32
    s_lshl_b32 s38, s39, 3
    s_and_b32 s37, s28, 3
    s_lshl_b32 s37, s37, 1
    s_add_u32 s38, s38, s37
    s_lshl_b32 s38, s38, 17
    s_lshl_b32 s37, s29, 12
    s_add_u32 s38, s38, s37
    v_mov_b32 v21, v20
    v_mov_b32 v23, v22
    v_pk_mul_f32 v[192:193], v[192:193], v[20:21]
    v_pk_mul_f32 v[194:195], v[194:195], v[20:21]
    v_pk_mul_f32 v[196:197], v[196:197], v[20:21]
    v_pk_mul_f32 v[198:199], v[198:199], v[20:21]
    v_cvt_pk_bf16_f32 v192, v192, v193
    v_cvt_pk_bf16_f32 v193, v194, v195
    v_cvt_pk_bf16_f32 v194, v196, v197
    v_cvt_pk_bf16_f32 v195, v198, v199
    buffer_store_dwordx4 v[192:195], v7, s[16:19], s38 offen offset:0 sc1
    v_pk_mul_f32 v[200:201], v[200:201], v[20:21]
    v_pk_mul_f32 v[202:203], v[202:203], v[20:21]
    v_pk_mul_f32 v[204:205], v[204:205], v[20:21]
    v_pk_mul_f32 v[206:207], v[206:207], v[20:21]
    v_cvt_pk_bf16_f32 v200, v200, v201
    v_cvt_pk_bf16_f32 v201, v202, v203
    v_cvt_pk_bf16_f32 v202, v204, v205
    v_cvt_pk_bf16_f32 v203, v206, v207
    buffer_store_dwordx4 v[200:203], v7, s[16:19], s38 offen offset:1024 sc1
    v_pk_mul_f32 v[208:209], v[208:209], v[20:21]
    v_pk_mul_f32 v[210:211], v[210:211], v[20:21]
    v_pk_mul_f32 v[212:213], v[212:213], v[20:21]
    v_pk_mul_f32 v[214:215], v[214:215], v[20:21]
    v_cvt_pk_bf16_f32 v208, v208, v209
    v_cvt_pk_bf16_f32 v209, v210, v211
    v_cvt_pk_bf16_f32 v210, v212, v213
    v_cvt_pk_bf16_f32 v211, v214, v215
    buffer_store_dwordx4 v[208:211], v7, s[16:19], s38 offen offset:2048 sc1
    v_pk_mul_f32 v[216:217], v[216:217], v[20:21]
    v_pk_mul_f32 v[218:219], v[218:219], v[20:21]
    v_pk_mul_f32 v[220:221], v[220:221], v[20:21]
    v_pk_mul_f32 v[222:223], v[222:223], v[20:21]
    v_cvt_pk_bf16_f32 v216, v216, v217
    v_cvt_pk_bf16_f32 v217, v218, v219
    v_cvt_pk_bf16_f32 v218, v220, v221
    v_cvt_pk_bf16_f32 v219, v222, v223
    buffer_store_dwordx4 v[216:219], v7, s[16:19], s38 offen offset:3072 sc1
    s_add_u32 s38, s38, 131072
    v_pk_mul_f32 v[224:225], v[224:225], v[22:23]
    v_pk_mul_f32 v[226:227], v[226:227], v[22:23]
    v_pk_mul_f32 v[228:229], v[228:229], v[22:23]
    v_pk_mul_f32 v[230:231], v[230:231], v[22:23]
    v_cvt_pk_bf16_f32 v224, v224, v225
    v_cvt_pk_bf16_f32 v225, v226, v227
    v_cvt_pk_bf16_f32 v226, v228, v229
    v_cvt_pk_bf16_f32 v227, v230, v231
    buffer_store_dwordx4 v[224:227], v7, s[16:19], s38 offen offset:0 sc1
    v_pk_mul_f32 v[232:233], v[232:233], v[22:23]
    v_pk_mul_f32 v[234:235], v[234:235], v[22:23]
    v_pk_mul_f32 v[236:237], v[236:237], v[22:23]
    v_pk_mul_f32 v[238:239], v[238:239], v[22:23]
    v_cvt_pk_bf16_f32 v232, v232, v233
    v_cvt_pk_bf16_f32 v233, v234, v235
    v_cvt_pk_bf16_f32 v234, v236, v237
    v_cvt_pk_bf16_f32 v235, v238, v239
    buffer_store_dwordx4 v[232:235], v7, s[16:19], s38 offen offset:1024 sc1
    v_pk_mul_f32 v[240:241], v[240:241], v[22:23]
    v_pk_mul_f32 v[242:243], v[242:243], v[22:23]
    v_pk_mul_f32 v[244:245], v[244:245], v[22:23]
    v_pk_mul_f32 v[246:247], v[246:247], v[22:23]
    v_cvt_pk_bf16_f32 v240, v240, v241
    v_cvt_pk_bf16_f32 v241, v242, v243
    v_cvt_pk_bf16_f32 v242, v244, v245
    v_cvt_pk_bf16_f32 v243, v246, v247
    buffer_store_dwordx4 v[240:243], v7, s[16:19], s38 offen offset:2048 sc1
    v_pk_mul_f32 v[248:249], v[248:249], v[22:23]
    v_pk_mul_f32 v[250:251], v[250:251], v[22:23]
    v_pk_mul_f32 v[252:253], v[252:253], v[22:23]
    v_pk_mul_f32 v[254:255], v[254:255], v[22:23]
    v_cvt_pk_bf16_f32 v248, v248, v249
    v_cvt_pk_bf16_f32 v249, v250, v251
    v_cvt_pk_bf16_f32 v250, v252, v253
    v_cvt_pk_bf16_f32 v251, v254, v255
    buffer_store_dwordx4 v[248:251], v7, s[16:19], s38 offen offset:3072 sc1
    v_mov_b32 v96, v112
    v_mov_b32 v97, v113
    v_mov_b32 v98, v114
    v_mov_b32 v99, v115
    v_mov_b32 v100, v116
    v_mov_b32 v101, v117
    v_mov_b32 v102, v118
    v_mov_b32 v103, v119
    s_branch L_p3_done
L_recurrent_scan__compressed_kv_cla__moe_arch_mod__prompt_kernel_rare_109:
    s_lshl_b32 s36, s29, 7
    s_cmp_eq_u32 s30, 0
    s_cselect_b32 s37, 4, 0
    s_add_u32 s36, s36, s37
    v_mov_b32 v20, s36
    v_mov_b32 v21, 1
    s_mov_b64 exec, 1
    global_atomic_add v20, v21, s[90:91]
    s_mov_b64 exec, -1
    s_nop 3
    s_branch L_recurrent_scan__compressed_kv_cla__moe_arch_mod__prompt_kernel_back_110
L_recurrent_scan__compressed_kv_cla__moe_arch_mod__prompt_kernel_rare_112:
    s_cmp_lt_i32 s36, 0
    s_cbranch_scc1 L_recurrent_scan__compressed_kv_cla__moe_arch_mod__prompt_kernel_nm_111
    v_mov_b32 v20, 4048155338
    v_subrev_u32 v21, s36, v18
    v_cmp_gt_i32 s[20:21], 0, v21
    v_cmp_gt_i32 s[22:23], 1, v21
    v_cmp_gt_i32 s[62:63], 2, v21
    v_cmp_gt_i32 vcc, 3, v21
    v_cndmask_b32 v96, v96, v20, s[20:21]
    v_cndmask_b32 v97, v97, v20, s[22:23]
    v_cndmask_b32 v98, v98, v20, s[62:63]
    v_cndmask_b32 v99, v99, v20, vcc
    v_cmp_gt_i32 s[20:21], 16, v21
    v_cmp_gt_i32 s[22:23], 17, v21
    v_cmp_gt_i32 s[62:63], 18, v21
    v_cmp_gt_i32 vcc, 19, v21
    v_cndmask_b32 v100, v100, v20, s[20:21]
    v_cndmask_b32 v101, v101, v20, s[22:23]
    v_cndmask_b32 v102, v102, v20, s[62:63]
    v_cndmask_b32 v103, v103, v20, vcc
    v_cmp_gt_i32 s[20:21], -16, v21
    v_cmp_gt_i32 s[22:23], -15, v21
    v_cmp_gt_i32 s[62:63], -14, v21
    v_cmp_gt_i32 vcc, -13, v21
    v_cndmask_b32 v104, v104, v20, s[20:21]
    v_cndmask_b32 v105, v105, v20, s[22:23]
    v_cndmask_b32 v106, v106, v20, s[62:63]
    v_cndmask_b32 v107, v107, v20, vcc
    v_cmp_gt_i32 s[20:21], 0, v21
    v_cmp_gt_i32 s[22:23], 1, v21
    v_cmp_gt_i32 s[62:63], 2, v21
    v_cmp_gt_i32 vcc, 3, v21
    v_cndmask_b32 v108, v108, v20, s[20:21]
    v_cndmask_b32 v109, v109, v20, s[22:23]
    v_cndmask_b32 v110, v110, v20, s[62:63]
    v_cndmask_b32 v111, v111, v20, vcc
L_recurrent_scan__compressed_kv_cla__moe_arch_mod__prompt_kernel_nm_111:
    s_branch L_recurrent_scan__compressed_kv_cla__moe_arch_mod__prompt_kernel_back_113
L_recurrent_scan__compressed_kv_cla__moe_arch_mod__prompt_kernel_rare_119:
    s_add_u32 s36, s40, 1
    s_sub_u32 s36, s36, s51
    s_cmp_lt_u32 s36, 2
    s_cbranch_scc0 L_recurrent_scan__compressed_kv_cla__moe_arch_mod__prompt_kernel_r_115
    s_lshl_b32 s36, s36, 6
    s_add_u32 s36, s36, 32
    s_sub_u32 s36, s36, s50
    s_cmp_lt_i32 s36, 0
    s_cbranch_scc1 L_recurrent_scan__compressed_kv_cla__moe_arch_mod__prompt_kernel_nm_118
    v_mov_b32 v20, 4048155338
    v_subrev_u32 v21, s36, v18
    v_cmp_gt_i32 s[20:21], 0, v21
    v_cmp_gt_i32 s[22:23], 1, v21
    v_cmp_gt_i32 s[62:63], 2, v21
    v_cmp_gt_i32 vcc, 3, v21
    v_cndmask_b32 v112, v112, v20, s[20:21]
    v_cndmask_b32 v113, v113, v20, s[22:23]
    v_cndmask_b32 v114, v114, v20, s[62:63]
    v_cndmask_b32 v115, v115, v20, vcc
    v_cmp_gt_i32 s[20:21], 16, v21
    v_cmp_gt_i32 s[22:23], 17, v21
    v_cmp_gt_i32 s[62:63], 18, v21
    v_cmp_gt_i32 vcc, 19, v21
    v_cndmask_b32 v116, v116, v20, s[20:21]
    v_cndmask_b32 v117, v117, v20, s[22:23]
    v_cndmask_b32 v118, v118, v20, s[62:63]
    v_cndmask_b32 v119, v119, v20, vcc
    v_cmp_gt_i32 s[20:21], -16, v21
    v_cmp_gt_i32 s[22:23], -15, v21
    v_cmp_gt_i32 s[62:63], -14, v21
    v_cmp_gt_i32 vcc, -13, v21
    v_cndmask_b32 v120, v120, v20, s[20:21]
    v_cndmask_b32 v121, v121, v20, s[22:23]
    v_cndmask_b32 v122, v122, v20, s[62:63]
    v_cndmask_b32 v123, v123, v20, vcc
    v_cmp_gt_i32 s[20:21], 0, v21
    v_cmp_gt_i32 s[22:23], 1, v21
    v_cmp_gt_i32 s[62:63], 2, v21
    v_cmp_gt_i32 vcc, 3, v21
    v_cndmask_b32 v124, v124, v20, s[20:21]
    v_cndmask_b32 v125, v125, v20, s[22:23]
    v_cndmask_b32 v126, v126, v20, s[62:63]
    v_cndmask_b32 v127, v127, v20, vcc
L_recurrent_scan__compressed_kv_cla__moe_arch_mod__prompt_kernel_nm_118:
L_recurrent_scan__compressed_kv_cla__moe_arch_mod__prompt_kernel_r_115:
    s_branch L_recurrent_scan__compressed_kv_cla__moe_arch_mod__prompt_kernel_back_120
L_recurrent_scan__compressed_kv_cla__moe_arch_mod__prompt_kernel_rare_122:
    s_add_u32 s36, s40, 2
    s_sub_u32 s36, s36, s51
    s_cmp_eq_u32 s36, 1
    s_cselect_b32 s41, 0x8000, s41
    s_cmp_eq_u32 s40, 15
    s_cbranch_scc0 L_recurrent_scan__compressed_kv_cla__moe_arch_mod__prompt_kernel_r_116
    s_mov_b32 s41, 65536
    s_mov_b32 s49, 0x1ffff
    s_mov_b32 s36, 1
L_recurrent_scan__compressed_kv_cla__moe_arch_mod__prompt_kernel_r_116:
    s_cmp_lt_u32 s36, 2
    s_cbranch_scc0 L_recurrent_scan__compressed_kv_cla__moe_arch_mod__prompt_kernel_r_117
    s_lshl_b32 s36, s36, 6
    s_sub_u32 s36, s36, s50
    s_cmp_lt_i32 s36, 0
    s_cbranch_scc1 L_recurrent_scan__compressed_kv_cla__moe_arch_mod__prompt_kernel_nm_121
    v_mov_b32 v20, 4048155338
    v_subrev_u32 v21, s36, v18
    v_cmp_gt_i32 s[20:21], 0, v21
    v_cmp_gt_i32 s[22:23], 1, v21
    v_cmp_gt_i32 s[62:63], 2, v21
    v_cmp_gt_i32 vcc, 3, v21
    v_cndmask_b32 v96, v96, v20, s[20:21]
    v_cndmask_b32 v97, v97, v20, s[22:23]
    v_cndmask_b32 v98, v98, v20, s[62:63]
    v_cndmask_b32 v99, v99, v20, vcc
    v_cmp_gt_i32 s[20:21], 16, v21
    v_cmp_gt_i32 s[22:23], 17, v21
    v_cmp_gt_i32 s[62:63], 18, v21
    v_cmp_gt_i32 vcc, 19, v21
    v_cndmask_b32 v100, v100, v20, s[20:21]
    v_cndmask_b32 v101, v101, v20, s[22:23]
    v_cndmask_b32 v102, v102, v20, s[62:63]
    v_cndmask_b32 v103, v103, v20, vcc
    v_cmp_gt_i32 s[20:21], -16, v21
    v_cmp_gt_i32 s[22:23], -15, v21
    v_cmp_gt_i32 s[62:63], -14, v21
    v_cmp_gt_i32 vcc, -13, v21
    v_cndmask_b32 v104, v104, v20, s[20:21]
    v_cndmask_b32 v105, v105, v20, s[22:23]
    v_cndmask_b32 v106, v106, v20, s[62:63]
    v_cndmask_b32 v107, v107, v20, vcc
    v_cmp_gt_i32 s[20:21], 0, v21
    v_cmp_gt_i32 s[22:23], 1, v21
    v_cmp_gt_i32 s[62:63], 2, v21
    v_cmp_gt_i32 vcc, 3, v21
    v_cndmask_b32 v108, v108, v20, s[20:21]
    v_cndmask_b32 v109, v109, v20, s[22:23]
    v_cndmask_b32 v110, v110, v20, s[62:63]
    v_cndmask_b32 v111, v111, v20, vcc
L_recurrent_scan__compressed_kv_cla__moe_arch_mod__prompt_kernel_nm_121:
L_recurrent_scan__compressed_kv_cla__moe_arch_mod__prompt_kernel_r_117:
    s_branch L_recurrent_scan__compressed_kv_cla__moe_arch_mod__prompt_kernel_back_123
L_recurrent_scan__compressed_kv_cla__moe_arch_mod__prompt_kernel_rare_125:
    v_mov_b32 v20, 4048155338
    v_subrev_u32 v21, s36, v18
    v_cmp_gt_i32 s[20:21], 0, v21
    v_cmp_gt_i32 s[22:23], 1, v21
    v_cmp_gt_i32 s[62:63], 2, v21
    v_cmp_gt_i32 vcc, 3, v21
    v_cndmask_b32 v112, v112, v20, s[20:21]
    v_cndmask_b32 v113, v113, v20, s[22:23]
    v_cndmask_b32 v114, v114, v20, s[62:63]
    v_cndmask_b32 v115, v115, v20, vcc
    v_cmp_gt_i32 s[20:21], 16, v21
    v_cmp_gt_i32 s[22:23], 17, v21
    v_cmp_gt_i32 s[62:63], 18, v21
    v_cmp_gt_i32 vcc, 19, v21
    v_cndmask_b32 v116, v116, v20, s[20:21]
    v_cndmask_b32 v117, v117, v20, s[22:23]
    v_cndmask_b32 v118, v118, v20, s[62:63]
    v_cndmask_b32 v119, v119, v20, vcc
    v_cmp_gt_i32 s[20:21], -16, v21
    v_cmp_gt_i32 s[22:23], -15, v21
    v_cmp_gt_i32 s[62:63], -14, v21
    v_cmp_gt_i32 vcc, -13, v21
    v_cndmask_b32 v120, v120, v20, s[20:21]
    v_cndmask_b32 v121, v121, v20, s[22:23]
    v_cndmask_b32 v122, v122, v20, s[62:63]
    v_cndmask_b32 v123, v123, v20, vcc
    v_cmp_gt_i32 s[20:21], 0, v21
    v_cmp_gt_i32 s[22:23], 1, v21
    v_cmp_gt_i32 s[62:63], 2, v21
    v_cmp_gt_i32 vcc, 3, v21
    v_cndmask_b32 v124, v124, v20, s[20:21]
    v_cndmask_b32 v125, v125, v20, s[22:23]
    v_cndmask_b32 v126, v126, v20, s[62:63]
    v_cndmask_b32 v127, v127, v20, vcc
    s_branch L_recurrent_scan__compressed_kv_cla__moe_arch_mod__prompt_kernel_back_126
L_recurrent_scan__compressed_kv_cla__moe_arch_mod__prompt_kernel_rare_132:
    s_cmp_eq_u32 s40, 0
    s_cbranch_scc0 L_recurrent_scan__compressed_kv_cla__moe_arch_mod__prompt_kernel_nm_127
    ds_read_b64 v[14:15], v19
    s_waitcnt lgkmcnt(0)
L_recurrent_scan__compressed_kv_cla__moe_arch_mod__prompt_kernel_nm_127:
    s_cmp_eq_u32 s40, 12
    s_cbranch_scc0 L_recurrent_scan__compressed_kv_cla__moe_arch_mod__prompt_kernel_bh_130
    s_getpc_b64 s[36:37]
L_recurrent_scan__compressed_kv_cla__moe_arch_mod__prompt_kernel_pc_131:
    s_sub_u32 s36, s36, L_recurrent_scan__compressed_kv_cla__moe_arch_mod__prompt_kernel_pc_131-L_pc
    s_subb_u32 s37, s37, 0
    s_lshr_b32 s38, s2, 3
    s_lshl_b32 s38, s38, 7
    v_lshl_add_u32 v26, v1, 12, s38
    v_min_u32 v26, L_end-L_pc-4, v26
    v_mov_b32 v27, s37
    v_add_co_u32 v26, vcc, s36, v26
    s_mov_b64 exec, 0xffff
    s_nop 0
    v_addc_co_u32 v27, vcc, 0, v27, vcc
    global_load_dword v0, v[26:27], off
    s_mov_b64 exec, -1
    s_nop 1
L_recurrent_scan__compressed_kv_cla__moe_arch_mod__prompt_kernel_bh_130:
    s_add_u32 s36, s40, 1
    s_cmp_eq_u32 s36, s51
    s_cbranch_scc0 L_recurrent_scan__compressed_kv_cla__moe_arch_mod__prompt_kernel_ns_128
    v_swap_b32 v128, v160
    v_swap_b32 v129, v161
    v_swap_b32 v130, v162
    v_swap_b32 v131, v163
    v_swap_b32 v132, v164
    v_swap_b32 v133, v165
    v_swap_b32 v134, v166
    v_swap_b32 v135, v167
    v_swap_b32 v136, v168
    v_swap_b32 v137, v169
    v_swap_b32 v138, v170
    v_swap_b32 v139, v171
    v_swap_b32 v140, v172
    v_swap_b32 v141, v173
    v_swap_b32 v142, v174
    v_swap_b32 v143, v175
    v_swap_b32 v144, v176
    v_swap_b32 v145, v177
    v_swap_b32 v146, v178
    v_swap_b32 v147, v179
    v_swap_b32 v148, v180
    v_swap_b32 v149, v181
    v_swap_b32 v150, v182
    v_swap_b32 v151, v183
    v_swap_b32 v152, v184
    v_swap_b32 v153, v185
    v_swap_b32 v154, v186
    v_swap_b32 v155, v187
    v_swap_b32 v156, v188
    v_swap_b32 v157, v189
    v_swap_b32 v158, v190
    v_swap_b32 v159, v191
    v_mov_b32 v40, v14
    v_mov_b32 v41, v14
    v_mov_b32 v42, v14
    v_mov_b32 v43, v14
    v_mov_b32 v44, v15
    v_mov_b32 v45, v15
    v_mov_b32 v46, v15
    v_mov_b32 v47, v15
    s_nop 1
L_recurrent_scan__compressed_kv_cla__moe_arch_mod__prompt_kernel_ns_128:
    s_cmp_eq_u32 s40, s51
    s_cbranch_scc0 L_recurrent_scan__compressed_kv_cla__moe_arch_mod__prompt_kernel_ne_129
    s_nop 4
    s_mov_b32 s36, 0x5d800000
    v_cmp_nge_f32 vcc, s36, v28
    s_nop 0
    s_or_b64 s[52:53], s[52:53], vcc
    v_cmp_nge_f32 vcc, s36, v32
    s_nop 0
    s_or_b64 s[52:53], s[52:53], vcc
    v_rcp_f32 v20, v28
    v_rcp_f32 v22, v32
    s_lshl_b32 s38, s30, 3
    s_and_b32 s37, s28, 3
    s_lshl_b32 s37, s37, 1
    s_add_u32 s38, s38, s37
    s_lshl_b32 s38, s38, 17
    s_lshl_b32 s37, s29, 12
    s_add_u32 s38, s38, s37
    v_mov_b32 v21, v20
    v_mov_b32 v23, v22
    v_pk_mul_f32 v[192:193], v[192:193], v[20:21]
    v_pk_mul_f32 v[194:195], v[194:195], v[20:21]
    v_pk_mul_f32 v[196:197], v[196:197], v[20:21]
    v_pk_mul_f32 v[198:199], v[198:199], v[20:21]
    v_cvt_pk_bf16_f32 v192, v192, v193
    v_cvt_pk_bf16_f32 v193, v194, v195
    v_cvt_pk_bf16_f32 v194, v196, v197
    v_cvt_pk_bf16_f32 v195, v198, v199
    buffer_store_dwordx4 v[192:195], v7, s[16:19], s38 offen offset:0 sc1
    v_pk_mul_f32 v[200:201], v[200:201], v[20:21]
    v_pk_mul_f32 v[202:203], v[202:203], v[20:21]
    v_pk_mul_f32 v[204:205], v[204:205], v[20:21]
    v_pk_mul_f32 v[206:207], v[206:207], v[20:21]
    v_cvt_pk_bf16_f32 v200, v200, v201
    v_cvt_pk_bf16_f32 v201, v202, v203
    v_cvt_pk_bf16_f32 v202, v204, v205
    v_cvt_pk_bf16_f32 v203, v206, v207
    buffer_store_dwordx4 v[200:203], v7, s[16:19], s38 offen offset:1024 sc1
    v_pk_mul_f32 v[208:209], v[208:209], v[20:21]
    v_pk_mul_f32 v[210:211], v[210:211], v[20:21]
    v_pk_mul_f32 v[212:213], v[212:213], v[20:21]
    v_pk_mul_f32 v[214:215], v[214:215], v[20:21]
    v_cvt_pk_bf16_f32 v208, v208, v209
    v_cvt_pk_bf16_f32 v209, v210, v211
    v_cvt_pk_bf16_f32 v210, v212, v213
    v_cvt_pk_bf16_f32 v211, v214, v215
    buffer_store_dwordx4 v[208:211], v7, s[16:19], s38 offen offset:2048 sc1
    v_pk_mul_f32 v[216:217], v[216:217], v[20:21]
    v_pk_mul_f32 v[218:219], v[218:219], v[20:21]
    v_pk_mul_f32 v[220:221], v[220:221], v[20:21]
    v_pk_mul_f32 v[222:223], v[222:223], v[20:21]
    v_cvt_pk_bf16_f32 v216, v216, v217
    v_cvt_pk_bf16_f32 v217, v218, v219
    v_cvt_pk_bf16_f32 v218, v220, v221
    v_cvt_pk_bf16_f32 v219, v222, v223
    buffer_store_dwordx4 v[216:219], v7, s[16:19], s38 offen offset:3072 sc1
    s_add_u32 s38, s38, 131072
    v_pk_mul_f32 v[224:225], v[224:225], v[22:23]
    v_pk_mul_f32 v[226:227], v[226:227], v[22:23]
    v_pk_mul_f32 v[228:229], v[228:229], v[22:23]
    v_pk_mul_f32 v[230:231], v[230:231], v[22:23]
    v_cvt_pk_bf16_f32 v224, v224, v225
    v_cvt_pk_bf16_f32 v225, v226, v227
    v_cvt_pk_bf16_f32 v226, v228, v229
    v_cvt_pk_bf16_f32 v227, v230, v231
    buffer_store_dwordx4 v[224:227], v7, s[16:19], s38 offen offset:0 sc1
    v_pk_mul_f32 v[232:233], v[232:233], v[22:23]
    v_pk_mul_f32 v[234:235], v[234:235], v[22:23]
    v_pk_mul_f32 v[236:237], v[236:237], v[22:23]
    v_pk_mul_f32 v[238:239], v[238:239], v[22:23]
    v_cvt_pk_bf16_f32 v232, v232, v233
    v_cvt_pk_bf16_f32 v233, v234, v235
    v_cvt_pk_bf16_f32 v234, v236, v237
    v_cvt_pk_bf16_f32 v235, v238, v239
    buffer_store_dwordx4 v[232:235], v7, s[16:19], s38 offen offset:1024 sc1
    v_pk_mul_f32 v[240:241], v[240:241], v[22:23]
    v_pk_mul_f32 v[242:243], v[242:243], v[22:23]
    v_pk_mul_f32 v[244:245], v[244:245], v[22:23]
    v_pk_mul_f32 v[246:247], v[246:247], v[22:23]
    v_cvt_pk_bf16_f32 v240, v240, v241
    v_cvt_pk_bf16_f32 v241, v242, v243
    v_cvt_pk_bf16_f32 v242, v244, v245
    v_cvt_pk_bf16_f32 v243, v246, v247
    buffer_store_dwordx4 v[240:243], v7, s[16:19], s38 offen offset:2048 sc1
    v_pk_mul_f32 v[248:249], v[248:249], v[22:23]
    v_pk_mul_f32 v[250:251], v[250:251], v[22:23]
    v_pk_mul_f32 v[252:253], v[252:253], v[22:23]
    v_pk_mul_f32 v[254:255], v[254:255], v[22:23]
    v_cvt_pk_bf16_f32 v248, v248, v249
    v_cvt_pk_bf16_f32 v249, v250, v251
    v_cvt_pk_bf16_f32 v250, v252, v253
    v_cvt_pk_bf16_f32 v251, v254, v255
    buffer_store_dwordx4 v[248:251], v7, s[16:19], s38 offen offset:3072 sc1
    v_mov_b64 v[28:29], 0
    v_mov_b64 v[30:31], 0
    v_mov_b64 v[32:33], 0
    v_mov_b64 v[34:35], 0
    v_mov_b64 v[192:193], 0
    v_mov_b64 v[194:195], 0
    v_mov_b64 v[196:197], 0
    v_mov_b64 v[198:199], 0
    v_mov_b64 v[200:201], 0
    v_mov_b64 v[202:203], 0
    v_mov_b64 v[204:205], 0
    v_mov_b64 v[206:207], 0
    v_mov_b64 v[208:209], 0
    v_mov_b64 v[210:211], 0
    v_mov_b64 v[212:213], 0
    v_mov_b64 v[214:215], 0
    v_mov_b64 v[216:217], 0
    v_mov_b64 v[218:219], 0
    v_mov_b64 v[220:221], 0
    v_mov_b64 v[222:223], 0
    v_mov_b64 v[224:225], 0
    v_mov_b64 v[226:227], 0
    v_mov_b64 v[228:229], 0
    v_mov_b64 v[230:231], 0
    v_mov_b64 v[232:233], 0
    v_mov_b64 v[234:235], 0
    v_mov_b64 v[236:237], 0
    v_mov_b64 v[238:239], 0
    v_mov_b64 v[240:241], 0
    v_mov_b64 v[242:243], 0
    v_mov_b64 v[244:245], 0
    v_mov_b64 v[246:247], 0
    v_mov_b64 v[248:249], 0
    v_mov_b64 v[250:251], 0
    v_mov_b64 v[252:253], 0
    v_mov_b64 v[254:255], 0
L_recurrent_scan__compressed_kv_cla__moe_arch_mod__prompt_kernel_ne_129:
    s_branch L_recurrent_scan__compressed_kv_cla__moe_arch_mod__prompt_kernel_back_133
L_recurrent_scan__compressed_kv_cla__moe_arch_mod__prompt_kernel_rare_136:
    s_mov_b32 s61, 0x40000
L_recurrent_scan__compressed_kv_cla__moe_arch_mod__prompt_kernel_spin_134:
    s_sub_u32 s61, s61, 1
    s_cbranch_scc1 L_recurrent_scan__compressed_kv_cla__moe_arch_mod__prompt_kernel_spinx_135
    s_sleep 8
    global_load_dword v11, v12, s[90:91] sc1
    s_waitcnt vmcnt(0)
    v_readfirstlane_b32 s36, v11
    s_nop 0
    s_cmp_lt_u32 s36, 28
    s_cbranch_scc1 L_recurrent_scan__compressed_kv_cla__moe_arch_mod__prompt_kernel_spin_134
L_recurrent_scan__compressed_kv_cla__moe_arch_mod__prompt_kernel_spinx_135:
    s_branch L_recurrent_scan__compressed_kv_cla__moe_arch_mod__prompt_kernel_back_137
L_recurrent_scan__compressed_kv_cla__moe_arch_mod__prompt_kernel_rare_141:
    v_mov_b32 v20, 4048155338
    v_subrev_u32 v21, s50, v18
    v_cmp_gt_i32 s[20:21], 0, v21
    v_cmp_gt_i32 s[22:23], 1, v21
    v_cmp_gt_i32 s[62:63], 2, v21
    v_cmp_gt_i32 vcc, 3, v21
    v_cndmask_b32 v96, v96, v20, s[20:21]
    v_cndmask_b32 v97, v97, v20, s[22:23]
    v_cndmask_b32 v98, v98, v20, s[62:63]
    v_cndmask_b32 v99, v99, v20, vcc
    v_cmp_gt_i32 s[20:21], 16, v21
    v_cmp_gt_i32 s[22:23], 17, v21
    v_cmp_gt_i32 s[62:63], 18, v21
    v_cmp_gt_i32 vcc, 19, v21
    v_cndmask_b32 v100, v100, v20, s[20:21]
    v_cndmask_b32 v101, v101, v20, s[22:23]
    v_cndmask_b32 v102, v102, v20, s[62:63]
    v_cndmask_b32 v103, v103, v20, vcc
    v_cmp_gt_i32 s[20:21], -16, v21
    v_cmp_gt_i32 s[22:23], -15, v21
    v_cmp_gt_i32 s[62:63], -14, v21
    v_cmp_gt_i32 vcc, -13, v21
    v_cndmask_b32 v104, v104, v20, s[20:21]
    v_cndmask_b32 v105, v105, v20, s[22:23]
    v_cndmask_b32 v106, v106, v20, s[62:63]
    v_cndmask_b32 v107, v107, v20, vcc
    v_cmp_gt_i32 s[20:21], 0, v21
    v_cmp_gt_i32 s[22:23], 1, v21
    v_cmp_gt_i32 s[62:63], 2, v21
    v_cmp_gt_i32 vcc, 3, v21
    v_cndmask_b32 v108, v108, v20, s[20:21]
    v_cndmask_b32 v109, v109, v20, s[22:23]
    v_cndmask_b32 v110, v110, v20, s[62:63]
    v_cndmask_b32 v111, v111, v20, vcc
    s_branch L_recurrent_scan__compressed_kv_cla__moe_arch_mod__prompt_kernel_back_142
L_p3_done:
    s_waitcnt vmcnt(4)
    s_and_b32 s36, s2, 7
    s_lshl_b32 s36, s36, 2
    s_sub_u32 s40, 47, s30
    s_lshl_b32 s40, s40, 7
    s_add_u32 s40, s40, s36
    s_add_u32 s41, s30, 32
    s_lshl_b32 s41, s41, 7
    s_add_u32 s41, s41, s36
    s_and_b32 s63, s30, 1
    s_bfe_u32 s36, s2, 0x10002
    s_lshl_b32 s36, s36, 3
    s_add_u32 s30, s30, s36
    s_and_b32 s29, s29, 15
    s_and_b32 s36, s28, 3
    s_lshl_b32 s37, s29, 2
    s_add_u32 s36, s36, s37
    s_lshl_b32 s36, s36, 18
    s_lshr_b32 s37, s28, 2
    s_lshl_b32 s37, s37, 12
    s_add_u32 s36, s36, s37
    s_lshl_b32 s37, s63, 16
    s_add_u32 s36, s36, s37
    s_lshr_b32 s37, s28, 2
    s_lshl_b32 s37, s37, 17
    s_add_u32 s36, s36, s37
    v_lshl_add_u32 v2, v1, 4, s36
    v_xor_b32 v3, 131072, v2
    v_lshrrev_b32 v19, 4, v1
    s_lshr_b32 s36, s28, 2
    s_lshl_b32 s36, s36, 7
    s_and_b32 s37, s28, 3
    s_lshl_b32 s37, s37, 4
    s_add_u32 s36, s36, s37
    s_lshl_b32 s33, s36, 8
    s_lshl_b32 s37, s63, 11
    s_add_u32 s36, s36, s37
    v_add_u32 v18, s36, v19
    v_lshlrev_b32 v18, 11, v18
    s_lshr_b32 s36, s30, 1
    s_lshl_b32 s36, s36, 8
    v_add_u32 v18, s36, v18
    v_lshlrev_b32 v20, 1, v19
    v_and_b32 v21, 15, v1
    v_xor_b32 v20, v20, v21
    v_lshl_add_u32 v6, v20, 4, v18
    v_xor_b32 v20, 8, v20
    v_lshl_add_u32 v7, v20, 4, v18
    v_add_u32 v7, 7168, v7
    v_add_u32 v8, 14336, v6
    v_add_u32 v9, 14336, v7
    s_add_u32 s36, s2, 1
    s_and_b32 s62, s36, 3
    s_lshl_b32 s31, s62, 14
    s_lshl_b32 s32, s62, 20
    s_waitcnt vmcnt(0)
    s_barrier
    s_cmp_eq_u32 s28, 0
    s_cbranch_scc1 L_recurrent_scan__compressed_kv_cla__moe_arch_mod__prompt_kernel_rare_143
L_recurrent_scan__compressed_kv_cla__moe_arch_mod__prompt_kernel_back_144:
    s_bitcmp1_b32 0x70, s28
    s_cbranch_scc1 L_recurrent_scan__compressed_kv_cla__moe_arch_mod__prompt_kernel_f2m_170
L_recurrent_scan__compressed_kv_cla__moe_arch_mod__prompt_kernel_f2a_171:
    s_mov_b32 s34, s33
    s_add_u32 m0, s34, 65536
    s_nop 0
    buffer_load_dwordx4 v6, s[8:11], s32 offen offset:0 lds
    buffer_load_dwordx4 v7, s[8:11], s32 offen offset:1024 lds
    buffer_load_dwordx4 v8, s[8:11], s32 offen offset:2048 lds
    buffer_load_dwordx4 v9, s[8:11], s32 offen offset:3072 lds
    s_add_u32 s32, s32, 131072
    s_add_u32 m0, s34, 81920
    s_nop 0
    buffer_load_dwordx4 v6, s[8:11], s32 offen offset:0 lds
    buffer_load_dwordx4 v7, s[8:11], s32 offen offset:1024 lds
    buffer_load_dwordx4 v8, s[8:11], s32 offen offset:2048 lds
    buffer_load_dwordx4 v9, s[8:11], s32 offen offset:3072 lds
    s_add_u32 s32, s32, 393216
    s_and_b32 s32, s32, 0x3fffff
    s_add_u32 m0, s34, 0
    s_nop 0
    buffer_load_dwordx4 v6, s[8:11], s32 offen offset:0 lds
    buffer_load_dwordx4 v7, s[8:11], s32 offen offset:1024 lds
    buffer_load_dwordx4 v8, s[8:11], s32 offen offset:2048 lds
    buffer_load_dwordx4 v9, s[8:11], s32 offen offset:3072 lds
    s_add_u32 s32, s32, 131072
    s_add_u32 m0, s34, 16384
    s_nop 0
    buffer_load_dwordx4 v6, s[8:11], s32 offen offset:0 lds
    buffer_load_dwordx4 v7, s[8:11], s32 offen offset:1024 lds
    buffer_load_dwordx4 v8, s[8:11], s32 offen offset:2048 lds
    buffer_load_dwordx4 v9, s[8:11], s32 offen offset:3072 lds
    s_add_u32 s32, s32, 393216
    s_and_b32 s32, s32, 0x3fffff
    s_cmp_lt_u32 s28, 4
    s_cbranch_scc1 L_recurrent_scan__compressed_kv_cla__moe_arch_mod__prompt_kernel_f2m_170
L_recurrent_scan__compressed_kv_cla__moe_arch_mod__prompt_kernel_f2b_172:
    s_add_u32 s4, s54, 41943040
    s_addc_u32 s5, s55, 0
    s_and_b32 s5, s5, 0xffff
    s_mov_b32 s6, 16777216
    s_mov_b32 s7, 0x20000
    s_mov_b32 s16, s96
    s_and_b32 s17, s97, 0xffff
    s_mov_b32 s18, 4194304
    s_mov_b32 s19, 0x20000
    s_mov_b32 s20, s98
    s_and_b32 s21, s99, 0xffff
    s_mov_b32 s22, 4194304
    s_mov_b32 s23, 0x20000
    s_lshl_b32 s36, s29, 7
    s_and_b32 s37, s28, 3
    s_lshl_b32 s37, s37, 5
    s_add_u32 s36, s36, s37
    s_lshr_b32 s37, s28, 2
    s_lshl_b32 s37, s37, 4
    s_add_u32 s38, s36, s37
    v_and_b32 v17, 15, v1
    v_add_u32 v14, s38, v17
    v_lshlrev_b32 v16, 3, v14
    v_lshrrev_b32 v15, 3, v1
    v_add_u32 v15, s38, v15
    v_lshlrev_b32 v15, 11, v15
    v_and_b32 v4, 7, v1
    v_lshl_add_u32 v15, v4, 4, v15
    s_lshl_b32 s36, s30, 7
    v_add_u32 v15, s36, v15
    s_lshl_b32 s36, s28, 12
    s_add_u32 s42, s36, 131072
    v_lshl_add_u32 v17, v17, 7, s42
    v_lshl_add_u32 v17, v19, 3, v17
    v_bfe_u32 v20, v1, 2, 2
    v_lshl_add_u32 v18, v19, 2, v20
    v_and_b32 v20, 7, v18
    s_lshl_b32 s36, s63, 2
    s_xor_b32 s36, s36, 4
    v_xor_b32 v20, s36, v20
    v_lshlrev_b32 v18, 8, v18
    s_lshr_b32 s36, s28, 2
    s_lshl_b32 s36, s36, 15
    s_add_u32 s36, s36, 65536
    v_add_u32 v18, s36, v18
    v_and_b32 v21, 3, v1
    v_lshl_add_u32 v18, v21, 3, v18
    v_xor_b32 v21, 0, v20
    v_lshl_add_u32 v50, v21, 5, v18
    v_xor_b32 v21, 1, v20
    v_lshl_add_u32 v51, v21, 5, v18
    v_xor_b32 v21, 2, v20
    v_lshl_add_u32 v52, v21, 5, v18
    v_xor_b32 v21, 3, v20
    v_lshl_add_u32 v53, v21, 5, v18
    v_xor_b32 v21, 4, v20
    v_lshl_add_u32 v54, v21, 5, v18
    v_xor_b32 v21, 5, v20
    v_lshl_add_u32 v55, v21, 5, v18
    v_xor_b32 v21, 6, v20
    v_lshl_add_u32 v56, v21, 5, v18
    v_xor_b32 v21, 7, v20
    v_lshl_add_u32 v57, v21, 5, v18
    v_mov_b64 v[192:193], 0
    v_mov_b64 v[194:195], 0
    v_mov_b64 v[196:197], 0
    v_mov_b64 v[198:199], 0
    v_mov_b64 v[200:201], 0
    v_mov_b64 v[202:203], 0
    v_mov_b64 v[204:205], 0
    v_mov_b64 v[206:207], 0
    v_mov_b64 v[208:209], 0
    v_mov_b64 v[210:211], 0
    v_mov_b64 v[212:213], 0
    v_mov_b64 v[214:215], 0
    v_mov_b64 v[216:217], 0
    v_mov_b64 v[218:219], 0
    v_mov_b64 v[220:221], 0
    v_mov_b64 v[222:223], 0
    v_mov_b64 v[224:225], 0
    v_mov_b64 v[226:227], 0
    v_mov_b64 v[228:229], 0
    v_mov_b64 v[230:231], 0
    v_mov_b64 v[232:233], 0
    v_mov_b64 v[234:235], 0
    v_mov_b64 v[236:237], 0
    v_mov_b64 v[238:239], 0
    v_mov_b64 v[240:241], 0
    v_mov_b64 v[242:243], 0
    v_mov_b64 v[244:245], 0
    v_mov_b64 v[246:247], 0
    v_mov_b64 v[248:249], 0
    v_mov_b64 v[250:251], 0
    v_mov_b64 v[252:253], 0
    v_mov_b64 v[254:255], 0
    s_mov_b32 s60, 15
    s_cmp_eq_u32 s28, 3
    s_cbranch_scc0 L_recurrent_scan__compressed_kv_cla__moe_arch_mod__prompt_kernel_w7j_173
    v_add_u32 v58, s62, v1
    v_and_b32 v58, 3, v58
    s_add_u32 s36, s29, 32
    s_lshl_b32 s36, s36, 7
    s_lshl_b32 s37, s63, 4
    s_add_u32 s36, s36, s37
    v_lshl_add_u32 v58, v58, 2, s36
    s_mov_b32 s61, 0x40000
L_recurrent_scan__compressed_kv_cla__moe_arch_mod__prompt_kernel_cspin_174:
    s_sub_u32 s61, s61, 1
    s_cbranch_scc1 L_recurrent_scan__compressed_kv_cla__moe_arch_mod__prompt_kernel_cspinx_175
    global_load_dword v59, v58, s[90:91] sc1
    s_waitcnt vmcnt(0)
L_recurrent_scan__compressed_kv_cla__moe_arch_mod__prompt_kernel_cchk_176:
    v_cmp_le_u32 vcc, 4, v59
    s_nop 0
    s_and_b32 s60, vcc_lo, 15
    s_and_b32 s36, s60, 3
    s_cmp_eq_u32 s36, 3
    s_cbranch_scc1 L_recurrent_scan__compressed_kv_cla__moe_arch_mod__prompt_kernel_cspinx_175
    s_sleep 6
    s_branch L_recurrent_scan__compressed_kv_cla__moe_arch_mod__prompt_kernel_cspin_174
L_recurrent_scan__compressed_kv_cla__moe_arch_mod__prompt_kernel_cspinx_175:
L_recurrent_scan__compressed_kv_cla__moe_arch_mod__prompt_kernel_w7j_173:
    s_waitcnt vmcnt(12)
    s_waitcnt lgkmcnt(0)
    s_barrier
    buffer_load_dwordx4 v[128:131], v2, s[4:7], s31 offen offset:0 sc1
    buffer_load_dwordx4 v[132:135], v3, s[4:7], s31 offen offset:0 sc1
    buffer_load_dwordx4 v[136:139], v2, s[4:7], s31 offen offset:1024 sc1
    buffer_load_dwordx4 v[140:143], v3, s[4:7], s31 offen offset:1024 sc1
    buffer_load_dwordx4 v[144:147], v2, s[4:7], s31 offen offset:2048 sc1
    buffer_load_dwordx4 v[148:151], v3, s[4:7], s31 offen offset:2048 sc1
    buffer_load_dwordx4 v[152:155], v2, s[4:7], s31 offen offset:3072 sc1
    buffer_load_dwordx4 v[156:159], v3, s[4:7], s31 offen offset:3072 sc1
    s_add_u32 s31, s31, 8192
    s_and_b32 s31, s31, 0xffff
    s_cmp_lt_u32 s28, 4
    s_cbranch_scc0 L_recurrent_scan__compressed_kv_cla__moe_arch_mod__prompt_kernel_g_145
    s_lshl_b32 s36, s28, 10
    s_add_u32 s36, s36, 131072
    v_lshl_add_u32 v28, v1, 4, s36
    ds_read_b128 v[96:99], v28 offset:0
    ds_read_b128 v[100:103], v28 offset:4096
    ds_read_b128 v[104:107], v28 offset:8192
    ds_read_b128 v[108:111], v28 offset:12288
    ds_read_b128 v[112:115], v28 offset:16384
    ds_read_b128 v[116:119], v28 offset:20480
    ds_read_b128 v[120:123], v28 offset:24576
    s_lshr_b32 s36, s2, 4
    s_lshl_b32 s36, s36, 13
    s_and_b32 s37, s2, 15
    s_lshl_b32 s37, s37, 8
    s_add_u32 s36, s36, s37
    s_lshl_b32 s37, s28, 6
    s_add_u32 s36, s36, s37
    s_add_u32 s36, s36, 59768832
    v_and_b32 v28, 1, v1
    v_lshlrev_b32 v28, 12, v28
    v_lshl_add_u32 v28, v19, 4, v28
    s_waitcnt lgkmcnt(0)
    v_add_f32 v96, v96, v100
    v_add_f32 v97, v97, v101
    v_add_f32 v98, v98, v102
    v_add_f32 v99, v99, v103
    v_add_f32 v96, v96, v104
    v_add_f32 v97, v97, v105
    v_add_f32 v98, v98, v106
    v_add_f32 v99, v99, v107
    v_add_f32 v96, v96, v108
    v_add_f32 v97, v97, v109
    v_add_f32 v98, v98, v110
    v_add_f32 v99, v99, v111
    v_add_f32 v96, v96, v112
    v_add_f32 v97, v97, v113
    v_add_f32 v98, v98, v114
    v_add_f32 v99, v99, v115
    v_add_f32 v96, v96, v116
    v_add_f32 v97, v97, v117
    v_add_f32 v98, v98, v118
    v_add_f32 v99, v99, v119
    v_add_f32 v96, v96, v120
    v_add_f32 v97, v97, v121
    v_add_f32 v98, v98, v122
    v_add_f32 v99, v99, v123
    s_mov_b32 exec_lo, 0x00030003
    s_mov_b32 exec_hi, 0x00030003
    buffer_store_dwordx4 v[96:99], v28, s[24:27], s36 offen sc1
    s_mov_b64 exec, -1
    s_nop 3
L_recurrent_scan__compressed_kv_cla__moe_arch_mod__prompt_kernel_g_145:
    v_lshlrev_b32 v22, 4, v1
    v_add_u32 v20, s42, v22
    v_xor_b32 v21, 16384, v20
    s_lshl_b32 s36, s2, 15
    s_lshl_b32 s37, s28, 12
    s_add_u32 s36, s36, s37
    s_add_u32 s36, s36, 67108864
    s_mov_b32 s41, s36
    s_xor_b32 s39, s36, 1048576
    s_add_u32 s40, s2, 128
    s_lshl_b32 s40, s40, 7
    ds_read_b64_tr_b16 v[64:65], v50 offset:0
    ds_read_b64_tr_b16 v[66:67], v50 offset:4096
    ds_read_b64_tr_b16 v[68:69], v51 offset:0
    ds_read_b64_tr_b16 v[70:71], v51 offset:4096
    ds_read_b64_tr_b16 v[72:73], v52 offset:0
    ds_read_b64_tr_b16 v[74:75], v52 offset:4096
    ds_read_b64_tr_b16 v[76:77], v53 offset:0
    ds_read_b64_tr_b16 v[78:79], v53 offset:4096
    ds_read_b64_tr_b16 v[80:81], v54 offset:0
    ds_read_b64_tr_b16 v[82:83], v54 offset:4096
    ds_read_b64_tr_b16 v[84:85], v55 offset:0
    ds_read_b64_tr_b16 v[86:87], v55 offset:4096
    s_mov_b32 s35, 0
    s_waitcnt vmcnt(0)
    buffer_load_dwordx4 v[160:163], v2, s[4:7], s31 offen offset:0 sc1
    buffer_load_dwordx4 v[164:167], v3, s[4:7], s31 offen offset:0 sc1
    buffer_load_dwordx4 v[168:171], v2, s[4:7], s31 offen offset:1024 sc1
    buffer_load_dwordx4 v[172:175], v3, s[4:7], s31 offen offset:1024 sc1
    buffer_load_dwordx4 v[176:179], v2, s[4:7], s31 offen offset:2048 sc1
    buffer_load_dwordx4 v[180:183], v3, s[4:7], s31 offen offset:2048 sc1
    .p2align 6
L_p4_loop:
    s_cmp_lg_u32 s35, 0
    s_cbranch_scc1 L_recurrent_scan__compressed_kv_cla__moe_arch_mod__prompt_kernel_rare_153
L_recurrent_scan__compressed_kv_cla__moe_arch_mod__prompt_kernel_back_154:
    s_waitcnt lgkmcnt(8)
    v_mfma_f32_16x16x32_bf16 v[192:195], v[64:67], v[128:131], v[192:195]
    ds_read_b64_tr_b16 v[88:89], v56 offset:0
    v_mfma_f32_16x16x32_bf16 v[224:227], v[64:67], v[132:135], v[224:227]
    ds_read_b64_tr_b16 v[90:91], v56 offset:4096
    v_mfma_f32_16x16x32_bf16 v[196:199], v[68:71], v[128:131], v[196:199]
    ds_read_b64_tr_b16 v[92:93], v57 offset:0
    v_mfma_f32_16x16x32_bf16 v[228:231], v[68:71], v[132:135], v[228:231]
    ds_read_b64_tr_b16 v[94:95], v57 offset:4096
    buffer_load_dwordx4 v[184:187], v2, s[4:7], s31 offen offset:3072 sc1
    s_waitcnt lgkmcnt(8)
    v_mfma_f32_16x16x32_bf16 v[200:203], v[72:75], v[128:131], v[200:203]
    ds_read_b64_tr_b16 v[64:65], v50 offset:8192
    v_mfma_f32_16x16x32_bf16 v[232:235], v[72:75], v[132:135], v[232:235]
    ds_read_b64_tr_b16 v[66:67], v50 offset:12288
    v_mfma_f32_16x16x32_bf16 v[204:207], v[76:79], v[128:131], v[204:207]
    ds_read_b64_tr_b16 v[68:69], v51 offset:8192
    v_mfma_f32_16x16x32_bf16 v[236:239], v[76:79], v[132:135], v[236:239]
    ds_read_b64_tr_b16 v[70:71], v51 offset:12288
    s_waitcnt lgkmcnt(8)
    v_mfma_f32_16x16x32_bf16 v[208:211], v[80:83], v[128:131], v[208:211]
    ds_read_b64_tr_b16 v[72:73], v52 offset:8192
    v_mfma_f32_16x16x32_bf16 v[240:243], v[80:83], v[132:135], v[240:243]
    ds_read_b64_tr_b16 v[74:75], v52 offset:12288
    buffer_load_dwordx4 v[188:191], v3, s[4:7], s31 offen offset:3072 sc1
    s_add_u32 s31, s31, 8192
    s_and_b32 s31, s31, 0xffff
    v_mfma_f32_16x16x32_bf16 v[212:215], v[84:87], v[128:131], v[212:215]
    ds_read_b64_tr_b16 v[76:77], v53 offset:8192
    v_mfma_f32_16x16x32_bf16 v[244:247], v[84:87], v[132:135], v[244:247]
    ds_read_b64_tr_b16 v[78:79], v53 offset:12288
    s_waitcnt lgkmcnt(8)
    v_mfma_f32_16x16x32_bf16 v[216:219], v[88:91], v[128:131], v[216:219]
    ds_read_b64_tr_b16 v[80:81], v54 offset:8192
    v_mfma_f32_16x16x32_bf16 v[248:251], v[88:91], v[132:135], v[248:251]
    ds_read_b64_tr_b16 v[82:83], v54 offset:12288
    v_mfma_f32_16x16x32_bf16 v[220:223], v[92:95], v[128:131], v[220:223]
    ds_read_b64_tr_b16 v[84:85], v55 offset:8192
    v_mfma_f32_16x16x32_bf16 v[252:255], v[92:95], v[132:135], v[252:255]
    ds_read_b64_tr_b16 v[86:87], v55 offset:12288
    s_waitcnt lgkmcnt(8)
    s_waitcnt vmcnt(24)
    v_mfma_f32_16x16x32_bf16 v[192:195], v[64:67], v[136:139], v[192:195]
    ds_read_b64_tr_b16 v[88:89], v56 offset:8192
    v_mfma_f32_16x16x32_bf16 v[224:227], v[64:67], v[140:143], v[224:227]
    ds_read_b64_tr_b16 v[90:91], v56 offset:12288
    buffer_load_dwordx4 v[128:131], v2, s[4:7], s31 offen offset:0 sc1
    v_mfma_f32_16x16x32_bf16 v[196:199], v[68:71], v[136:139], v[196:199]
    ds_read_b64_tr_b16 v[92:93], v57 offset:8192
    v_mfma_f32_16x16x32_bf16 v[228:231], v[68:71], v[140:143], v[228:231]
    ds_read_b64_tr_b16 v[94:95], v57 offset:12288
    s_waitcnt lgkmcnt(8)
    v_mfma_f32_16x16x32_bf16 v[200:203], v[72:75], v[136:139], v[200:203]
    v_mfma_f32_16x16x32_bf16 v[232:235], v[72:75], v[140:143], v[232:235]
    buffer_load_dwordx4 v[132:135], v3, s[4:7], s31 offen offset:0 sc1
    v_mfma_f32_16x16x32_bf16 v[204:207], v[76:79], v[136:139], v[204:207]
    v_mfma_f32_16x16x32_bf16 v[236:239], v[76:79], v[140:143], v[236:239]
    s_waitcnt lgkmcnt(0)
    s_waitcnt vmcnt(20)
    s_barrier
    v_mfma_f32_16x16x32_bf16 v[208:211], v[80:83], v[136:139], v[208:211]
    ds_read_b64_tr_b16 v[64:65], v50 offset:16384
    ds_read_b64_tr_b16 v[66:67], v50 offset:20480
    v_mfma_f32_16x16x32_bf16 v[240:243], v[80:83], v[140:143], v[240:243]
    ds_read_b64_tr_b16 v[68:69], v51 offset:16384
    ds_read_b64_tr_b16 v[70:71], v51 offset:20480
    s_add_u32 m0, s34, 65536
    v_mfma_f32_16x16x32_bf16 v[212:215], v[84:87], v[136:139], v[212:215]
    ds_read_b64_tr_b16 v[72:73], v52 offset:16384
    ds_read_b64_tr_b16 v[74:75], v52 offset:20480
    buffer_load_dwordx4 v6, s[8:11], s32 offen offset:0 lds
    v_mfma_f32_16x16x32_bf16 v[244:247], v[84:87], v[140:143], v[244:247]
    ds_read_b64_tr_b16 v[76:77], v53 offset:16384
    ds_read_b64_tr_b16 v[78:79], v53 offset:20480
    v_mfma_f32_16x16x32_bf16 v[216:219], v[88:91], v[136:139], v[216:219]
    ds_read_b64_tr_b16 v[80:81], v54 offset:16384
    ds_read_b64_tr_b16 v[82:83], v54 offset:20480
    buffer_load_dwordx4 v7, s[8:11], s32 offen offset:1024 lds
    v_mfma_f32_16x16x32_bf16 v[248:251], v[88:91], v[140:143], v[248:251]
    v_mfma_f32_16x16x32_bf16 v[220:223], v[92:95], v[136:139], v[220:223]
    ds_read_b64_tr_b16 v[84:85], v55 offset:16384
    ds_read_b64_tr_b16 v[86:87], v55 offset:20480
    buffer_load_dwordx4 v8, s[8:11], s32 offen offset:2048 lds
    v_mfma_f32_16x16x32_bf16 v[252:255], v[92:95], v[140:143], v[252:255]
    buffer_load_dwordx4 v9, s[8:11], s32 offen offset:3072 lds
    s_add_u32 s32, s32, 131072
    s_waitcnt lgkmcnt(8)
    v_mfma_f32_16x16x32_bf16 v[192:195], v[64:67], v[144:147], v[192:195]
    ds_read_b64_tr_b16 v[88:89], v56 offset:16384
    v_mfma_f32_16x16x32_bf16 v[224:227], v[64:67], v[148:151], v[224:227]
    ds_read_b64_tr_b16 v[90:91], v56 offset:20480
    v_mfma_f32_16x16x32_bf16 v[196:199], v[68:71], v[144:147], v[196:199]
    ds_read_b64_tr_b16 v[92:93], v57 offset:16384
    v_mfma_f32_16x16x32_bf16 v[228:231], v[68:71], v[148:151], v[228:231]
    ds_read_b64_tr_b16 v[94:95], v57 offset:20480
    buffer_load_dwordx4 v[136:139], v2, s[4:7], s31 offen offset:1024 sc1
    s_waitcnt lgkmcnt(8)
    v_mfma_f32_16x16x32_bf16 v[200:203], v[72:75], v[144:147], v[200:203]
    ds_read_b64_tr_b16 v[64:65], v50 offset:24576
    v_mfma_f32_16x16x32_bf16 v[232:235], v[72:75], v[148:151], v[232:235]
    ds_read_b64_tr_b16 v[66:67], v50 offset:28672
    v_xor_b32 v50, 65536, v50
    v_mfma_f32_16x16x32_bf16 v[204:207], v[76:79], v[144:147], v[204:207]
    ds_read_b64_tr_b16 v[68:69], v51 offset:24576
    v_mfma_f32_16x16x32_bf16 v[236:239], v[76:79], v[148:151], v[236:239]
    ds_read_b64_tr_b16 v[70:71], v51 offset:28672
    v_xor_b32 v51, 65536, v51
    s_waitcnt lgkmcnt(8)
    v_mfma_f32_16x16x32_bf16 v[208:211], v[80:83], v[144:147], v[208:211]
    ds_read_b64_tr_b16 v[72:73], v52 offset:24576
    v_mfma_f32_16x16x32_bf16 v[240:243], v[80:83], v[148:151], v[240:243]
    ds_read_b64_tr_b16 v[74:75], v52 offset:28672
    v_xor_b32 v52, 65536, v52
    buffer_load_dwordx4 v[140:143], v3, s[4:7], s31 offen offset:1024 sc1
    v_mfma_f32_16x16x32_bf16 v[212:215], v[84:87], v[144:147], v[212:215]
    ds_read_b64_tr_b16 v[76:77], v53 offset:24576
    v_mfma_f32_16x16x32_bf16 v[244:247], v[84:87], v[148:151], v[244:247]
    ds_read_b64_tr_b16 v[78:79], v53 offset:28672
    v_xor_b32 v53, 65536, v53
    s_waitcnt lgkmcnt(8)
    v_mfma_f32_16x16x32_bf16 v[216:219], v[88:91], v[144:147], v[216:219]
    ds_read_b64_tr_b16 v[80:81], v54 offset:24576
    v_mfma_f32_16x16x32_bf16 v[248:251], v[88:91], v[148:151], v[248:251]
    ds_read_b64_tr_b16 v[82:83], v54 offset:28672
    v_xor_b32 v54, 65536, v54
    v_mfma_f32_16x16x32_bf16 v[220:223], v[92:95], v[144:147], v[220:223]
    ds_read_b64_tr_b16 v[84:85], v55 offset:24576
    v_mfma_f32_16x16x32_bf16 v[252:255], v[92:95], v[148:151], v[252:255]
    ds_read_b64_tr_b16 v[86:87], v55 offset:28672
    v_xor_b32 v55, 65536, v55
    s_waitcnt lgkmcnt(8)
    s_waitcnt vmcnt(24)
    v_mfma_f32_16x16x32_bf16 v[192:195], v[64:67], v[152:155], v[192:195]
    ds_read_b64_tr_b16 v[88:89], v56 offset:24576
    v_mfma_f32_16x16x32_bf16 v[224:227], v[64:67], v[156:159], v[224:227]
    ds_read_b64_tr_b16 v[90:91], v56 offset:28672
    v_xor_b32 v56, 65536, v56
    buffer_load_dwordx4 v[144:147], v2, s[4:7], s31 offen offset:2048 sc1
    v_mfma_f32_16x16x32_bf16 v[196:199], v[68:71], v[152:155], v[196:199]
    ds_read_b64_tr_b16 v[92:93], v57 offset:24576
    v_mfma_f32_16x16x32_bf16 v[228:231], v[68:71], v[156:159], v[228:231]
    ds_read_b64_tr_b16 v[94:95], v57 offset:28672
    v_xor_b32 v57, 65536, v57
    s_waitcnt lgkmcnt(8)
    v_mfma_f32_16x16x32_bf16 v[200:203], v[72:75], v[152:155], v[200:203]
    v_mfma_f32_16x16x32_bf16 v[232:235], v[72:75], v[156:159], v[232:235]
    buffer_load_dwordx4 v[148:151], v3, s[4:7], s31 offen offset:2048 sc1
    v_mfma_f32_16x16x32_bf16 v[204:207], v[76:79], v[152:155], v[204:207]
    v_mfma_f32_16x16x32_bf16 v[236:239], v[76:79], v[156:159], v[236:239]
    s_waitcnt lgkmcnt(0)
    s_waitcnt vmcnt(20)
    s_barrier
    v_mfma_f32_16x16x32_bf16 v[208:211], v[80:83], v[152:155], v[208:211]
    ds_read_b64_tr_b16 v[64:65], v50 offset:0
    ds_read_b64_tr_b16 v[66:67], v50 offset:4096
    v_mfma_f32_16x16x32_bf16 v[240:243], v[80:83], v[156:159], v[240:243]
    ds_read_b64_tr_b16 v[68:69], v51 offset:0
    ds_read_b64_tr_b16 v[70:71], v51 offset:4096
    s_add_u32 m0, s34, 81920
    v_mfma_f32_16x16x32_bf16 v[212:215], v[84:87], v[152:155], v[212:215]
    ds_read_b64_tr_b16 v[72:73], v52 offset:0
    ds_read_b64_tr_b16 v[74:75], v52 offset:4096
    buffer_load_dwordx4 v6, s[8:11], s32 offen offset:0 lds
    v_mfma_f32_16x16x32_bf16 v[244:247], v[84:87], v[156:159], v[244:247]
    ds_read_b64_tr_b16 v[76:77], v53 offset:0
    ds_read_b64_tr_b16 v[78:79], v53 offset:4096
    v_mfma_f32_16x16x32_bf16 v[216:219], v[88:91], v[152:155], v[216:219]
    ds_read_b64_tr_b16 v[80:81], v54 offset:0
    ds_read_b64_tr_b16 v[82:83], v54 offset:4096
    buffer_load_dwordx4 v7, s[8:11], s32 offen offset:1024 lds
    v_mfma_f32_16x16x32_bf16 v[248:251], v[88:91], v[156:159], v[248:251]
    v_mfma_f32_16x16x32_bf16 v[220:223], v[92:95], v[152:155], v[220:223]
    ds_read_b64_tr_b16 v[84:85], v55 offset:0
    ds_read_b64_tr_b16 v[86:87], v55 offset:4096
    buffer_load_dwordx4 v8, s[8:11], s32 offen offset:2048 lds
    v_mfma_f32_16x16x32_bf16 v[252:255], v[92:95], v[156:159], v[252:255]
    buffer_load_dwordx4 v9, s[8:11], s32 offen offset:3072 lds
    s_add_u32 s32, s32, 393216
    s_and_b32 s32, s32, 0x3fffff
    s_cmp_eq_u32 s35, 2
    s_cbranch_scc1 L_recurrent_scan__compressed_kv_cla__moe_arch_mod__prompt_kernel_rare_156
L_recurrent_scan__compressed_kv_cla__moe_arch_mod__prompt_kernel_back_157:
    s_waitcnt lgkmcnt(8)
    s_waitcnt vmcnt(20)
    v_mfma_f32_16x16x32_bf16 v[192:195], v[64:67], v[160:163], v[192:195]
    ds_read_b64_tr_b16 v[88:89], v56 offset:0
    v_mfma_f32_16x16x32_bf16 v[224:227], v[64:67], v[164:167], v[224:227]
    ds_read_b64_tr_b16 v[90:91], v56 offset:4096
    v_mfma_f32_16x16x32_bf16 v[196:199], v[68:71], v[160:163], v[196:199]
    ds_read_b64_tr_b16 v[92:93], v57 offset:0
    v_mfma_f32_16x16x32_bf16 v[228:231], v[68:71], v[164:167], v[228:231]
    ds_read_b64_tr_b16 v[94:95], v57 offset:4096
    buffer_load_dwordx4 v[152:155], v2, s[4:7], s31 offen offset:3072 sc1
    s_waitcnt lgkmcnt(8)
    v_mfma_f32_16x16x32_bf16 v[200:203], v[72:75], v[160:163], v[200:203]
    ds_read_b64_tr_b16 v[64:65], v50 offset:8192
    v_mfma_f32_16x16x32_bf16 v[232:235], v[72:75], v[164:167], v[232:235]
    ds_read_b64_tr_b16 v[66:67], v50 offset:12288
    v_mfma_f32_16x16x32_bf16 v[204:207], v[76:79], v[160:163], v[204:207]
    ds_read_b64_tr_b16 v[68:69], v51 offset:8192
    v_mfma_f32_16x16x32_bf16 v[236:239], v[76:79], v[164:167], v[236:239]
    ds_read_b64_tr_b16 v[70:71], v51 offset:12288
    s_waitcnt lgkmcnt(8)
    v_mfma_f32_16x16x32_bf16 v[208:211], v[80:83], v[160:163], v[208:211]
    ds_read_b64_tr_b16 v[72:73], v52 offset:8192
    v_mfma_f32_16x16x32_bf16 v[240:243], v[80:83], v[164:167], v[240:243]
    ds_read_b64_tr_b16 v[74:75], v52 offset:12288
    buffer_load_dwordx4 v[156:159], v3, s[4:7], s31 offen offset:3072 sc1
    s_add_u32 s31, s31, 8192
    s_and_b32 s31, s31, 0xffff
    v_mfma_f32_16x16x32_bf16 v[212:215], v[84:87], v[160:163], v[212:215]
    ds_read_b64_tr_b16 v[76:77], v53 offset:8192
    v_mfma_f32_16x16x32_bf16 v[244:247], v[84:87], v[164:167], v[244:247]
    ds_read_b64_tr_b16 v[78:79], v53 offset:12288
    s_waitcnt lgkmcnt(8)
    v_mfma_f32_16x16x32_bf16 v[216:219], v[88:91], v[160:163], v[216:219]
    ds_read_b64_tr_b16 v[80:81], v54 offset:8192
    v_mfma_f32_16x16x32_bf16 v[248:251], v[88:91], v[164:167], v[248:251]
    ds_read_b64_tr_b16 v[82:83], v54 offset:12288
    v_mfma_f32_16x16x32_bf16 v[220:223], v[92:95], v[160:163], v[220:223]
    ds_read_b64_tr_b16 v[84:85], v55 offset:8192
    v_mfma_f32_16x16x32_bf16 v[252:255], v[92:95], v[164:167], v[252:255]
    ds_read_b64_tr_b16 v[86:87], v55 offset:12288
    s_waitcnt lgkmcnt(8)
    s_waitcnt vmcnt(20)
    v_mfma_f32_16x16x32_bf16 v[192:195], v[64:67], v[168:171], v[192:195]
    ds_read_b64_tr_b16 v[88:89], v56 offset:8192
    v_mfma_f32_16x16x32_bf16 v[224:227], v[64:67], v[172:175], v[224:227]
    ds_read_b64_tr_b16 v[90:91], v56 offset:12288
    buffer_load_dwordx4 v[160:163], v2, s[4:7], s31 offen offset:0 sc1
    v_mfma_f32_16x16x32_bf16 v[196:199], v[68:71], v[168:171], v[196:199]
    ds_read_b64_tr_b16 v[92:93], v57 offset:8192
    v_mfma_f32_16x16x32_bf16 v[228:231], v[68:71], v[172:175], v[228:231]
    ds_read_b64_tr_b16 v[94:95], v57 offset:12288
    s_waitcnt lgkmcnt(8)
    v_mfma_f32_16x16x32_bf16 v[200:203], v[72:75], v[168:171], v[200:203]
    v_mfma_f32_16x16x32_bf16 v[232:235], v[72:75], v[172:175], v[232:235]
    buffer_load_dwordx4 v[164:167], v3, s[4:7], s31 offen offset:0 sc1
    v_mfma_f32_16x16x32_bf16 v[204:207], v[76:79], v[168:171], v[204:207]
    v_mfma_f32_16x16x32_bf16 v[236:239], v[76:79], v[172:175], v[236:239]
    s_cmp_lt_u32 s60, 15
    s_cbranch_scc1 L_recurrent_scan__compressed_kv_cla__moe_arch_mod__prompt_kernel_rare_158
L_recurrent_scan__compressed_kv_cla__moe_arch_mod__prompt_kernel_back_159:
    s_waitcnt lgkmcnt(0)
    s_waitcnt vmcnt(20)
    s_barrier
    v_mfma_f32_16x16x32_bf16 v[208:211], v[80:83], v[168:171], v[208:211]
    ds_read_b64_tr_b16 v[64:65], v50 offset:16384
    ds_read_b64_tr_b16 v[66:67], v50 offset:20480
    v_mfma_f32_16x16x32_bf16 v[240:243], v[80:83], v[172:175], v[240:243]
    ds_read_b64_tr_b16 v[68:69], v51 offset:16384
    ds_read_b64_tr_b16 v[70:71], v51 offset:20480
    s_add_u32 m0, s34, 0
    v_mfma_f32_16x16x32_bf16 v[212:215], v[84:87], v[168:171], v[212:215]
    ds_read_b64_tr_b16 v[72:73], v52 offset:16384
    ds_read_b64_tr_b16 v[74:75], v52 offset:20480
    buffer_load_dwordx4 v6, s[8:11], s32 offen offset:0 lds
    v_mfma_f32_16x16x32_bf16 v[244:247], v[84:87], v[172:175], v[244:247]
    ds_read_b64_tr_b16 v[76:77], v53 offset:16384
    ds_read_b64_tr_b16 v[78:79], v53 offset:20480
    v_mfma_f32_16x16x32_bf16 v[216:219], v[88:91], v[168:171], v[216:219]
    ds_read_b64_tr_b16 v[80:81], v54 offset:16384
    ds_read_b64_tr_b16 v[82:83], v54 offset:20480
    buffer_load_dwordx4 v7, s[8:11], s32 offen offset:1024 lds
    v_mfma_f32_16x16x32_bf16 v[248:251], v[88:91], v[172:175], v[248:251]
    v_mfma_f32_16x16x32_bf16 v[220:223], v[92:95], v[168:171], v[220:223]
    ds_read_b64_tr_b16 v[84:85], v55 offset:16384
    ds_read_b64_tr_b16 v[86:87], v55 offset:20480
    buffer_load_dwordx4 v8, s[8:11], s32 offen offset:2048 lds
    v_mfma_f32_16x16x32_bf16 v[252:255], v[92:95], v[172:175], v[252:255]
    buffer_load_dwordx4 v9, s[8:11], s32 offen offset:3072 lds
    s_add_u32 s32, s32, 131072
    s_waitcnt lgkmcnt(8)
    s_waitcnt vmcnt(24)
    v_mfma_f32_16x16x32_bf16 v[192:195], v[64:67], v[176:179], v[192:195]
    ds_read_b64_tr_b16 v[88:89], v56 offset:16384
    v_mfma_f32_16x16x32_bf16 v[224:227], v[64:67], v[180:183], v[224:227]
    ds_read_b64_tr_b16 v[90:91], v56 offset:20480
    v_mfma_f32_16x16x32_bf16 v[196:199], v[68:71], v[176:179], v[196:199]
    ds_read_b64_tr_b16 v[92:93], v57 offset:16384
    v_mfma_f32_16x16x32_bf16 v[228:231], v[68:71], v[180:183], v[228:231]
    ds_read_b64_tr_b16 v[94:95], v57 offset:20480
    buffer_load_dwordx4 v[168:171], v2, s[4:7], s31 offen offset:1024 sc1
    s_waitcnt lgkmcnt(8)
    v_mfma_f32_16x16x32_bf16 v[200:203], v[72:75], v[176:179], v[200:203]
    ds_read_b64_tr_b16 v[64:65], v50 offset:24576
    v_mfma_f32_16x16x32_bf16 v[232:235], v[72:75], v[180:183], v[232:235]
    ds_read_b64_tr_b16 v[66:67], v50 offset:28672
    v_xor_b32 v50, 65536, v50
    v_mfma_f32_16x16x32_bf16 v[204:207], v[76:79], v[176:179], v[204:207]
    ds_read_b64_tr_b16 v[68:69], v51 offset:24576
    v_mfma_f32_16x16x32_bf16 v[236:239], v[76:79], v[180:183], v[236:239]
    ds_read_b64_tr_b16 v[70:71], v51 offset:28672
    v_xor_b32 v51, 65536, v51
    s_waitcnt lgkmcnt(8)
    v_mfma_f32_16x16x32_bf16 v[208:211], v[80:83], v[176:179], v[208:211]
    ds_read_b64_tr_b16 v[72:73], v52 offset:24576
    v_mfma_f32_16x16x32_bf16 v[240:243], v[80:83], v[180:183], v[240:243]
    ds_read_b64_tr_b16 v[74:75], v52 offset:28672
    v_xor_b32 v52, 65536, v52
    buffer_load_dwordx4 v[172:175], v3, s[4:7], s31 offen offset:1024 sc1
    v_mfma_f32_16x16x32_bf16 v[212:215], v[84:87], v[176:179], v[212:215]
    ds_read_b64_tr_b16 v[76:77], v53 offset:24576
    v_mfma_f32_16x16x32_bf16 v[244:247], v[84:87], v[180:183], v[244:247]
    ds_read_b64_tr_b16 v[78:79], v53 offset:28672
    v_xor_b32 v53, 65536, v53
    s_waitcnt lgkmcnt(8)
    v_mfma_f32_16x16x32_bf16 v[216:219], v[88:91], v[176:179], v[216:219]
    ds_read_b64_tr_b16 v[80:81], v54 offset:24576
    v_mfma_f32_16x16x32_bf16 v[248:251], v[88:91], v[180:183], v[248:251]
    ds_read_b64_tr_b16 v[82:83], v54 offset:28672
    v_xor_b32 v54, 65536, v54
    v_mfma_f32_16x16x32_bf16 v[220:223], v[92:95], v[176:179], v[220:223]
    ds_read_b64_tr_b16 v[84:85], v55 offset:24576
    v_mfma_f32_16x16x32_bf16 v[252:255], v[92:95], v[180:183], v[252:255]
    ds_read_b64_tr_b16 v[86:87], v55 offset:28672
    v_xor_b32 v55, 65536, v55
    s_waitcnt lgkmcnt(8)
    s_waitcnt vmcnt(24)
    v_mfma_f32_16x16x32_bf16 v[192:195], v[64:67], v[184:187], v[192:195]
    ds_read_b64_tr_b16 v[88:89], v56 offset:24576
    v_mfma_f32_16x16x32_bf16 v[224:227], v[64:67], v[188:191], v[224:227]
    ds_read_b64_tr_b16 v[90:91], v56 offset:28672
    v_xor_b32 v56, 65536, v56
    buffer_load_dwordx4 v[176:179], v2, s[4:7], s31 offen offset:2048 sc1
    v_mfma_f32_16x16x32_bf16 v[196:199], v[68:71], v[184:187], v[196:199]
    ds_read_b64_tr_b16 v[92:93], v57 offset:24576
    v_mfma_f32_16x16x32_bf16 v[228:231], v[68:71], v[188:191], v[228:231]
    ds_read_b64_tr_b16 v[94:95], v57 offset:28672
    v_xor_b32 v57, 65536, v57
    s_waitcnt lgkmcnt(8)
    v_mfma_f32_16x16x32_bf16 v[200:203], v[72:75], v[184:187], v[200:203]
    v_mfma_f32_16x16x32_bf16 v[232:235], v[72:75], v[188:191], v[232:235]
    buffer_load_dwordx4 v[180:183], v3, s[4:7], s31 offen offset:2048 sc1
    v_mfma_f32_16x16x32_bf16 v[204:207], v[76:79], v[184:187], v[204:207]
    v_mfma_f32_16x16x32_bf16 v[236:239], v[76:79], v[188:191], v[236:239]
    s_cmp_lt_u32 s60, 15
    s_cbranch_scc1 L_recurrent_scan__compressed_kv_cla__moe_arch_mod__prompt_kernel_rare_168
L_recurrent_scan__compressed_kv_cla__moe_arch_mod__prompt_kernel_back_169:
    s_waitcnt lgkmcnt(0)
    s_waitcnt vmcnt(20)
    s_barrier
    v_mfma_f32_16x16x32_bf16 v[208:211], v[80:83], v[184:187], v[208:211]
    ds_read_b64_tr_b16 v[64:65], v50 offset:0
    ds_read_b64_tr_b16 v[66:67], v50 offset:4096
    v_mfma_f32_16x16x32_bf16 v[240:243], v[80:83], v[188:191], v[240:243]
    ds_read_b64_tr_b16 v[68:69], v51 offset:0
    ds_read_b64_tr_b16 v[70:71], v51 offset:4096
    s_add_u32 m0, s34, 16384
    v_mfma_f32_16x16x32_bf16 v[212:215], v[84:87], v[184:187], v[212:215]
    ds_read_b64_tr_b16 v[72:73], v52 offset:0
    ds_read_b64_tr_b16 v[74:75], v52 offset:4096
    buffer_load_dwordx4 v6, s[8:11], s32 offen offset:0 lds
    v_mfma_f32_16x16x32_bf16 v[244:247], v[84:87], v[188:191], v[244:247]
    ds_read_b64_tr_b16 v[76:77], v53 offset:0
    ds_read_b64_tr_b16 v[78:79], v53 offset:4096
    v_mfma_f32_16x16x32_bf16 v[216:219], v[88:91], v[184:187], v[216:219]
    ds_read_b64_tr_b16 v[80:81], v54 offset:0
    ds_read_b64_tr_b16 v[82:83], v54 offset:4096
    buffer_load_dwordx4 v7, s[8:11], s32 offen offset:1024 lds
    v_mfma_f32_16x16x32_bf16 v[248:251], v[88:91], v[188:191], v[248:251]
    v_mfma_f32_16x16x32_bf16 v[220:223], v[92:95], v[184:187], v[220:223]
    ds_read_b64_tr_b16 v[84:85], v55 offset:0
    ds_read_b64_tr_b16 v[86:87], v55 offset:4096
    buffer_load_dwordx4 v8, s[8:11], s32 offen offset:2048 lds
    v_mfma_f32_16x16x32_bf16 v[252:255], v[92:95], v[188:191], v[252:255]
    buffer_load_dwordx4 v9, s[8:11], s32 offen offset:3072 lds
    s_add_u32 s32, s32, 393216
    s_and_b32 s32, s32, 0x3fffff
    s_add_u32 s35, s35, 1
    s_cmp_lt_u32 s35, 3
    s_cbranch_scc1 L_p4_loop
    s_sub_u32 s36, s56, s38
    s_sub_u32 s37, s57, s38
    s_min_u32 s36, s36, s37
    s_cmp_lt_u32 s36, 16
    s_cbranch_scc1 L_recurrent_scan__compressed_kv_cla__moe_arch_mod__prompt_kernel_rare_177
L_recurrent_scan__compressed_kv_cla__moe_arch_mod__prompt_kernel_back_178:
    s_xor_b32 s37, s40, 4096
    v_mov_b32 v5, s37
    s_waitcnt vmcnt(16)
    ds_read_b64 v[40:41], v17 offset:0
    ds_read_b64 v[42:43], v17 offset:32
    ds_read_b64 v[44:45], v17 offset:64
    ds_read_b64 v[46:47], v17 offset:96
    s_waitcnt lgkmcnt(12)
    v_mfma_f32_16x16x32_bf16 v[192:195], v[64:67], v[128:131], v[192:195]
    ds_read_b64_tr_b16 v[88:89], v56 offset:0
    v_mfma_f32_16x16x32_bf16 v[224:227], v[64:67], v[132:135], v[224:227]
    ds_read_b64_tr_b16 v[90:91], v56 offset:4096
    buffer_load_dwordx4 v[184:187], v2, s[4:7], s31 offen offset:3072 sc1
    v_mfma_f32_16x16x32_bf16 v[196:199], v[68:71], v[128:131], v[196:199]
    ds_read_b64_tr_b16 v[92:93], v57 offset:0
    v_mfma_f32_16x16x32_bf16 v[228:231], v[68:71], v[132:135], v[228:231]
    ds_read_b64_tr_b16 v[94:95], v57 offset:4096
    s_waitcnt lgkmcnt(12)
    v_mfma_f32_16x16x32_bf16 v[200:203], v[72:75], v[128:131], v[200:203]
    ds_read_b64_tr_b16 v[64:65], v50 offset:8192
    v_mfma_f32_16x16x32_bf16 v[232:235], v[72:75], v[132:135], v[232:235]
    ds_read_b64_tr_b16 v[66:67], v50 offset:12288
    buffer_load_dwordx4 v[188:191], v3, s[4:7], s31 offen offset:3072 sc1
    v_mfma_f32_16x16x32_bf16 v[204:207], v[76:79], v[128:131], v[204:207]
    ds_read_b64_tr_b16 v[68:69], v51 offset:8192
    v_mfma_f32_16x16x32_bf16 v[236:239], v[76:79], v[132:135], v[236:239]
    ds_read_b64_tr_b16 v[70:71], v51 offset:12288
    s_waitcnt lgkmcnt(12)
    s_waitcnt lgkmcnt(8)
    v_mfma_f32_16x16x32_bf16 v[208:211], v[80:83], v[128:131], v[208:211]
    ds_read_b64_tr_b16 v[72:73], v52 offset:8192
    v_lshlrev_b32 v96, 16, v40
    v_and_b32 v97, 0xffff0000, v40
    v_sub_f32 v112, v96, v48
    v_sub_f32 v113, v97, v48
    v_mfma_f32_16x16x32_bf16 v[240:243], v[80:83], v[132:135], v[240:243]
    ds_read_b64_tr_b16 v[74:75], v52 offset:12288
    v_cvt_pk_bf16_f32 v10, v112, v113
    v_lshlrev_b32 v112, 16, v10
    v_and_b32 v113, 0xffff0000, v10
    v_mul_f32 v112, v112, v49
    v_mfma_f32_16x16x32_bf16 v[212:215], v[84:87], v[128:131], v[212:215]
    ds_read_b64_tr_b16 v[76:77], v53 offset:8192
    v_mul_f32 v113, v113, v49
    v_cvt_pk_bf16_f32 v10, v112, v113
    v_mfma_f32_16x16x32_bf16 v[244:247], v[84:87], v[132:135], v[244:247]
    ds_read_b64_tr_b16 v[78:79], v53 offset:12288
    v_lshlrev_b32 v112, 16, v10
    v_and_b32 v113, 0xffff0000, v10
    v_mul_f32 v11, 0xbfb8aa3b, v112
    v_mul_f32 v12, 0xbfb8aa3b, v113
    s_waitcnt vmcnt(10)
    s_barrier
    s_waitcnt lgkmcnt(8)
    v_mfma_f32_16x16x32_bf16 v[216:219], v[88:91], v[128:131], v[216:219]
    ds_read_b64_tr_b16 v[80:81], v50 offset:16384
    v_exp_f32 v11, v11
    v_exp_f32 v12, v12
    v_mfma_f32_16x16x32_bf16 v[248:251], v[88:91], v[132:135], v[248:251]
    ds_read_b64_tr_b16 v[82:83], v50 offset:20480
    v_add_f32 v11, 1.0, v11
    v_add_f32 v12, 1.0, v12
    v_rcp_f32 v11, v11
    v_rcp_f32 v12, v12
    v_mfma_f32_16x16x32_bf16 v[220:223], v[92:95], v[128:131], v[220:223]
    ds_read_b64_tr_b16 v[84:85], v51 offset:16384
    v_mul_f32 v112, v112, v11
    v_mul_f32 v113, v113, v12
    v_mfma_f32_16x16x32_bf16 v[252:255], v[92:95], v[132:135], v[252:255]
    ds_read_b64_tr_b16 v[86:87], v51 offset:20480
    v_cvt_pk_bf16_f32 v10, v112, v113
    v_lshlrev_b32 v112, 16, v10
    v_and_b32 v113, 0xffff0000, v10
    v_lshlrev_b32 v98, 16, v41
    s_waitcnt lgkmcnt(8)
    v_mfma_f32_16x16x32_bf16 v[192:195], v[64:67], v[136:139], v[192:195]
    ds_read_b64_tr_b16 v[88:89], v52 offset:16384
    v_and_b32 v99, 0xffff0000, v41
    v_sub_f32 v114, v98, v48
    v_sub_f32 v115, v99, v48
    v_cvt_pk_bf16_f32 v10, v114, v115
    v_mfma_f32_16x16x32_bf16 v[224:227], v[64:67], v[140:143], v[224:227]
    ds_read_b64_tr_b16 v[90:91], v52 offset:20480
    v_lshlrev_b32 v114, 16, v10
    v_and_b32 v115, 0xffff0000, v10
    v_mfma_f32_16x16x32_bf16 v[196:199], v[68:71], v[136:139], v[196:199]
    ds_read_b64_tr_b16 v[92:93], v53 offset:16384
    v_mul_f32 v114, v114, v49
    v_mul_f32 v115, v115, v49
    v_cvt_pk_bf16_f32 v10, v114, v115
    v_lshlrev_b32 v114, 16, v10
    v_mfma_f32_16x16x32_bf16 v[228:231], v[68:71], v[140:143], v[228:231]
    ds_read_b64_tr_b16 v[94:95], v53 offset:20480
    v_and_b32 v115, 0xffff0000, v10
    v_mul_f32 v11, 0xbfb8aa3b, v114
    s_waitcnt lgkmcnt(8)
    v_mfma_f32_16x16x32_bf16 v[200:203], v[72:75], v[136:139], v[200:203]
    ds_read_b64_tr_b16 v[64:65], v50 offset:24576
    v_mul_f32 v12, 0xbfb8aa3b, v115
    v_exp_f32 v11, v11
    v_exp_f32 v12, v12
    v_add_f32 v11, 1.0, v11
    v_mfma_f32_16x16x32_bf16 v[232:235], v[72:75], v[140:143], v[232:235]
    ds_read_b64_tr_b16 v[66:67], v50 offset:28672
    v_xor_b32 v50, 65536, v50
    v_add_f32 v12, 1.0, v12
    v_rcp_f32 v11, v11
    v_mfma_f32_16x16x32_bf16 v[204:207], v[76:79], v[136:139], v[204:207]
    ds_read_b64_tr_b16 v[68:69], v51 offset:24576
    v_rcp_f32 v12, v12
    v_mul_f32 v114, v114, v11
    v_mul_f32 v115, v115, v12
    v_cvt_pk_bf16_f32 v10, v114, v115
    v_mfma_f32_16x16x32_bf16 v[236:239], v[76:79], v[140:143], v[236:239]
    ds_read_b64_tr_b16 v[70:71], v51 offset:28672
    v_xor_b32 v51, 65536, v51
    v_lshlrev_b32 v114, 16, v10
    v_and_b32 v115, 0xffff0000, v10
    s_waitcnt lgkmcnt(8)
    v_mfma_f32_16x16x32_bf16 v[192:195], v[80:83], v[144:147], v[192:195]
    ds_read_b64_tr_b16 v[72:73], v52 offset:24576
    v_lshlrev_b32 v100, 16, v42
    v_and_b32 v101, 0xffff0000, v42
    v_sub_f32 v116, v100, v48
    v_sub_f32 v117, v101, v48
    v_mfma_f32_16x16x32_bf16 v[224:227], v[80:83], v[148:151], v[224:227]
    ds_read_b64_tr_b16 v[74:75], v52 offset:28672
    v_xor_b32 v52, 65536, v52
    v_cvt_pk_bf16_f32 v10, v116, v117
    v_lshlrev_b32 v116, 16, v10
    v_and_b32 v117, 0xffff0000, v10
    v_mul_f32 v116, v116, v49
    v_mfma_f32_16x16x32_bf16 v[196:199], v[84:87], v[144:147], v[196:199]
    ds_read_b64_tr_b16 v[76:77], v53 offset:24576
    v_mul_f32 v117, v117, v49
    v_cvt_pk_bf16_f32 v10, v116, v117
    v_mfma_f32_16x16x32_bf16 v[228:231], v[84:87], v[148:151], v[228:231]
    ds_read_b64_tr_b16 v[78:79], v53 offset:28672
    v_xor_b32 v53, 65536, v53
    v_lshlrev_b32 v116, 16, v10
    v_and_b32 v117, 0xffff0000, v10
    v_mul_f32 v11, 0xbfb8aa3b, v116
    v_mul_f32 v12, 0xbfb8aa3b, v117
    s_waitcnt lgkmcnt(8)
    v_mfma_f32_16x16x32_bf16 v[200:203], v[88:91], v[144:147], v[200:203]
    ds_read_b64_tr_b16 v[80:81], v50 offset:0
    v_exp_f32 v11, v11
    v_exp_f32 v12, v12
    v_mfma_f32_16x16x32_bf16 v[232:235], v[88:91], v[148:151], v[232:235]
    ds_read_b64_tr_b16 v[82:83], v50 offset:4096
    v_add_f32 v11, 1.0, v11
    v_add_f32 v12, 1.0, v12
    v_rcp_f32 v11, v11
    v_rcp_f32 v12, v12
    v_mfma_f32_16x16x32_bf16 v[204:207], v[92:95], v[144:147], v[204:207]
    ds_read_b64_tr_b16 v[84:85], v51 offset:0
    v_mul_f32 v116, v116, v11
    v_mul_f32 v117, v117, v12
    v_mfma_f32_16x16x32_bf16 v[236:239], v[92:95], v[148:151], v[236:239]
    ds_read_b64_tr_b16 v[86:87], v51 offset:4096
    v_cvt_pk_bf16_f32 v10, v116, v117
    v_lshlrev_b32 v116, 16, v10
    v_and_b32 v117, 0xffff0000, v10
    v_lshlrev_b32 v102, 16, v43
    s_waitcnt lgkmcnt(8)
    v_mfma_f32_16x16x32_bf16 v[192:195], v[64:67], v[152:155], v[192:195]
    ds_read_b64_tr_b16 v[88:89], v52 offset:0
    v_and_b32 v103, 0xffff0000, v43
    v_sub_f32 v118, v102, v48
    v_sub_f32 v119, v103, v48
    v_cvt_pk_bf16_f32 v10, v118, v119
    v_mfma_f32_16x16x32_bf16 v[224:227], v[64:67], v[156:159], v[224:227]
    ds_read_b64_tr_b16 v[90:91], v52 offset:4096
    v_lshlrev_b32 v118, 16, v10
    v_and_b32 v119, 0xffff0000, v10
    v_mfma_f32_16x16x32_bf16 v[196:199], v[68:71], v[152:155], v[196:199]
    ds_read_b64_tr_b16 v[92:93], v53 offset:0
    v_mul_f32 v118, v118, v49
    v_mul_f32 v119, v119, v49
    v_cvt_pk_bf16_f32 v10, v118, v119
    v_lshlrev_b32 v118, 16, v10
    v_mfma_f32_16x16x32_bf16 v[228:231], v[68:71], v[156:159], v[228:231]
    ds_read_b64_tr_b16 v[94:95], v53 offset:4096
    v_and_b32 v119, 0xffff0000, v10
    v_mul_f32 v11, 0xbfb8aa3b, v118
    s_waitcnt lgkmcnt(8)
    v_mfma_f32_16x16x32_bf16 v[200:203], v[72:75], v[152:155], v[200:203]
    ds_read_b64_tr_b16 v[64:65], v50 offset:8192
    v_mul_f32 v12, 0xbfb8aa3b, v119
    v_exp_f32 v11, v11
    v_exp_f32 v12, v12
    v_add_f32 v11, 1.0, v11
    v_mfma_f32_16x16x32_bf16 v[232:235], v[72:75], v[156:159], v[232:235]
    ds_read_b64_tr_b16 v[66:67], v50 offset:12288
    v_add_f32 v12, 1.0, v12
    v_rcp_f32 v11, v11
    v_mfma_f32_16x16x32_bf16 v[204:207], v[76:79], v[152:155], v[204:207]
    ds_read_b64_tr_b16 v[68:69], v51 offset:8192
    v_rcp_f32 v12, v12
    v_mul_f32 v118, v118, v11
    v_mul_f32 v119, v119, v12
    v_cvt_pk_bf16_f32 v10, v118, v119
    v_mfma_f32_16x16x32_bf16 v[236:239], v[76:79], v[156:159], v[236:239]
    ds_read_b64_tr_b16 v[70:71], v51 offset:12288
    v_lshlrev_b32 v118, 16, v10
    v_and_b32 v119, 0xffff0000, v10
    s_waitcnt lgkmcnt(8)
    v_mfma_f32_16x16x32_bf16 v[192:195], v[80:83], v[160:163], v[192:195]
    ds_read_b64_tr_b16 v[72:73], v52 offset:8192
    v_lshlrev_b32 v104, 16, v44
    v_and_b32 v105, 0xffff0000, v44
    v_sub_f32 v120, v104, v48
    v_sub_f32 v121, v105, v48
    v_mfma_f32_16x16x32_bf16 v[224:227], v[80:83], v[164:167], v[224:227]
    ds_read_b64_tr_b16 v[74:75], v52 offset:12288
    v_cvt_pk_bf16_f32 v10, v120, v121
    v_lshlrev_b32 v120, 16, v10
    v_and_b32 v121, 0xffff0000, v10
    v_mul_f32 v120, v120, v49
    v_mfma_f32_16x16x32_bf16 v[196:199], v[84:87], v[160:163], v[196:199]
    ds_read_b64_tr_b16 v[76:77], v53 offset:8192
    v_mul_f32 v121, v121, v49
    v_cvt_pk_bf16_f32 v10, v120, v121
    v_mfma_f32_16x16x32_bf16 v[228:231], v[84:87], v[164:167], v[228:231]
    ds_read_b64_tr_b16 v[78:79], v53 offset:12288
    v_lshlrev_b32 v120, 16, v10
    v_and_b32 v121, 0xffff0000, v10
    v_mul_f32 v11, 0xbfb8aa3b, v120
    v_mul_f32 v12, 0xbfb8aa3b, v121
    s_waitcnt vmcnt(2)
    s_barrier
    s_waitcnt lgkmcnt(8)
    v_mfma_f32_16x16x32_bf16 v[200:203], v[88:91], v[160:163], v[200:203]
    ds_read_b64_tr_b16 v[80:81], v50 offset:16384
    v_exp_f32 v11, v11
    v_exp_f32 v12, v12
    v_mfma_f32_16x16x32_bf16 v[232:235], v[88:91], v[164:167], v[232:235]
    ds_read_b64_tr_b16 v[82:83], v50 offset:20480
    v_add_f32 v11, 1.0, v11
    v_add_f32 v12, 1.0, v12
    v_rcp_f32 v11, v11
    v_rcp_f32 v12, v12
    v_mfma_f32_16x16x32_bf16 v[204:207], v[92:95], v[160:163], v[204:207]
    ds_read_b64_tr_b16 v[84:85], v51 offset:16384
    v_mul_f32 v120, v120, v11
    v_mul_f32 v121, v121, v12
    v_mfma_f32_16x16x32_bf16 v[236:239], v[92:95], v[164:167], v[236:239]
    ds_read_b64_tr_b16 v[86:87], v51 offset:20480
    v_cvt_pk_bf16_f32 v10, v120, v121
    v_lshlrev_b32 v120, 16, v10
    v_and_b32 v121, 0xffff0000, v10
    v_lshlrev_b32 v106, 16, v45
    s_waitcnt lgkmcnt(8)
    v_mfma_f32_16x16x32_bf16 v[192:195], v[64:67], v[168:171], v[192:195]
    ds_read_b64_tr_b16 v[88:89], v52 offset:16384
    v_and_b32 v107, 0xffff0000, v45
    v_sub_f32 v122, v106, v48
    v_sub_f32 v123, v107, v48
    v_cvt_pk_bf16_f32 v10, v122, v123
    v_mfma_f32_16x16x32_bf16 v[224:227], v[64:67], v[172:175], v[224:227]
    ds_read_b64_tr_b16 v[90:91], v52 offset:20480
    v_lshlrev_b32 v122, 16, v10
    v_and_b32 v123, 0xffff0000, v10
    v_mfma_f32_16x16x32_bf16 v[196:199], v[68:71], v[168:171], v[196:199]
    ds_read_b64_tr_b16 v[92:93], v53 offset:16384
    v_mul_f32 v122, v122, v49
    v_mul_f32 v123, v123, v49
    v_cvt_pk_bf16_f32 v10, v122, v123
    v_lshlrev_b32 v122, 16, v10
    v_mfma_f32_16x16x32_bf16 v[228:231], v[68:71], v[172:175], v[228:231]
    ds_read_b64_tr_b16 v[94:95], v53 offset:20480
    v_and_b32 v123, 0xffff0000, v10
    v_mul_f32 v11, 0xbfb8aa3b, v122
    s_waitcnt lgkmcnt(8)
    v_mfma_f32_16x16x32_bf16 v[200:203], v[72:75], v[168:171], v[200:203]
    ds_read_b64_tr_b16 v[64:65], v50 offset:24576
    v_mul_f32 v12, 0xbfb8aa3b, v123
    v_exp_f32 v11, v11
    v_exp_f32 v12, v12
    v_add_f32 v11, 1.0, v11
    v_mfma_f32_16x16x32_bf16 v[232:235], v[72:75], v[172:175], v[232:235]
    ds_read_b64_tr_b16 v[66:67], v50 offset:28672
    v_add_f32 v12, 1.0, v12
    v_rcp_f32 v11, v11
    v_mfma_f32_16x16x32_bf16 v[204:207], v[76:79], v[168:171], v[204:207]
    ds_read_b64_tr_b16 v[68:69], v51 offset:24576
    v_rcp_f32 v12, v12
    v_mul_f32 v122, v122, v11
    v_mul_f32 v123, v123, v12
    v_cvt_pk_bf16_f32 v10, v122, v123
    v_mfma_f32_16x16x32_bf16 v[236:239], v[76:79], v[172:175], v[236:239]
    ds_read_b64_tr_b16 v[70:71], v51 offset:28672
    v_lshlrev_b32 v122, 16, v10
    v_and_b32 v123, 0xffff0000, v10
    s_waitcnt lgkmcnt(8)
    v_mfma_f32_16x16x32_bf16 v[192:195], v[80:83], v[176:179], v[192:195]
    ds_read_b64_tr_b16 v[72:73], v52 offset:24576
    v_lshlrev_b32 v108, 16, v46
    v_and_b32 v109, 0xffff0000, v46
    v_sub_f32 v124, v108, v48
    v_sub_f32 v125, v109, v48
    v_mfma_f32_16x16x32_bf16 v[224:227], v[80:83], v[180:183], v[224:227]
    ds_read_b64_tr_b16 v[74:75], v52 offset:28672
    v_cvt_pk_bf16_f32 v10, v124, v125
    v_lshlrev_b32 v124, 16, v10
    v_and_b32 v125, 0xffff0000, v10
    v_mul_f32 v124, v124, v49
    v_mfma_f32_16x16x32_bf16 v[196:199], v[84:87], v[176:179], v[196:199]
    ds_read_b64_tr_b16 v[76:77], v53 offset:24576
    v_mul_f32 v125, v125, v49
    v_cvt_pk_bf16_f32 v10, v124, v125
    v_mfma_f32_16x16x32_bf16 v[228:231], v[84:87], v[180:183], v[228:231]
    ds_read_b64_tr_b16 v[78:79], v53 offset:28672
    v_lshlrev_b32 v124, 16, v10
    v_and_b32 v125, 0xffff0000, v10
    v_mul_f32 v11, 0xbfb8aa3b, v124
    v_mul_f32 v12, 0xbfb8aa3b, v125
    s_waitcnt lgkmcnt(8)
    v_mfma_f32_16x16x32_bf16 v[200:203], v[88:91], v[176:179], v[200:203]
    ds_read_b64_tr_b16 v[80:81], v54 offset:8192
    v_exp_f32 v11, v11
    v_exp_f32 v12, v12
    v_mfma_f32_16x16x32_bf16 v[232:235], v[88:91], v[180:183], v[232:235]
    ds_read_b64_tr_b16 v[82:83], v54 offset:12288
    v_add_f32 v11, 1.0, v11
    v_add_f32 v12, 1.0, v12
    v_rcp_f32 v11, v11
    v_rcp_f32 v12, v12
    v_mfma_f32_16x16x32_bf16 v[204:207], v[92:95], v[176:179], v[204:207]
    ds_read_b64_tr_b16 v[84:85], v55 offset:8192
    v_mul_f32 v124, v124, v11
    v_mul_f32 v125, v125, v12
    v_mfma_f32_16x16x32_bf16 v[236:239], v[92:95], v[180:183], v[236:239]
    ds_read_b64_tr_b16 v[86:87], v55 offset:12288
    v_cvt_pk_bf16_f32 v10, v124, v125
    v_lshlrev_b32 v124, 16, v10
    v_and_b32 v125, 0xffff0000, v10
    v_lshlrev_b32 v110, 16, v47
    s_waitcnt lgkmcnt(8)
    s_waitcnt vmcnt(0)
    v_mfma_f32_16x16x32_bf16 v[192:195], v[64:67], v[184:187], v[192:195]
    ds_read_b64_tr_b16 v[88:89], v56 offset:8192
    v_and_b32 v111, 0xffff0000, v47
    v_sub_f32 v126, v110, v48
    v_sub_f32 v127, v111, v48
    v_cvt_pk_bf16_f32 v10, v126, v127
    v_mfma_f32_16x16x32_bf16 v[224:227], v[64:67], v[188:191], v[224:227]
    ds_read_b64_tr_b16 v[90:91], v56 offset:12288
    v_lshlrev_b32 v126, 16, v10
    v_and_b32 v127, 0xffff0000, v10
    v_mfma_f32_16x16x32_bf16 v[196:199], v[68:71], v[184:187], v[196:199]
    ds_read_b64_tr_b16 v[92:93], v57 offset:8192
    v_mul_f32 v126, v126, v49
    v_mul_f32 v127, v127, v49
    v_cvt_pk_bf16_f32 v10, v126, v127
    v_lshlrev_b32 v126, 16, v10
    v_mfma_f32_16x16x32_bf16 v[228:231], v[68:71], v[188:191], v[228:231]
    ds_read_b64_tr_b16 v[94:95], v57 offset:12288
    v_and_b32 v127, 0xffff0000, v10
    v_mul_f32 v11, 0xbfb8aa3b, v126
    s_waitcnt lgkmcnt(8)
    v_mfma_f32_16x16x32_bf16 v[200:203], v[72:75], v[184:187], v[200:203]
    ds_read_b64_tr_b16 v[64:65], v54 offset:16384
    v_mul_f32 v12, 0xbfb8aa3b, v127
    v_exp_f32 v11, v11
    v_exp_f32 v12, v12
    v_add_f32 v11, 1.0, v11
    v_mfma_f32_16x16x32_bf16 v[232:235], v[72:75], v[188:191], v[232:235]
    ds_read_b64_tr_b16 v[66:67], v54 offset:20480
    v_add_f32 v12, 1.0, v12
    v_rcp_f32 v11, v11
    v_mfma_f32_16x16x32_bf16 v[204:207], v[76:79], v[184:187], v[204:207]
    ds_read_b64_tr_b16 v[68:69], v55 offset:16384
    v_rcp_f32 v12, v12
    v_mul_f32 v126, v126, v11
    v_mul_f32 v127, v127, v12
    v_cvt_pk_bf16_f32 v10, v126, v127
    v_mfma_f32_16x16x32_bf16 v[236:239], v[76:79], v[188:191], v[236:239]
    ds_read_b64_tr_b16 v[70:71], v55 offset:20480
    v_lshlrev_b32 v126, 16, v10
    v_and_b32 v127, 0xffff0000, v10
    s_waitcnt lgkmcnt(8)
    v_mfma_f32_16x16x32_bf16 v[208:211], v[80:83], v[136:139], v[208:211]
    ds_read_b64_tr_b16 v[72:73], v56 offset:16384
    v_mfma_f32_16x16x32_bf16 v[240:243], v[80:83], v[140:143], v[240:243]
    ds_read_b64_tr_b16 v[74:75], v56 offset:20480
    v_mfma_f32_16x16x32_bf16 v[212:215], v[84:87], v[136:139], v[212:215]
    ds_read_b64_tr_b16 v[76:77], v57 offset:16384
    ds_write_b128 v20, v[224:227] offset:0
    v_mfma_f32_16x16x32_bf16 v[244:247], v[84:87], v[140:143], v[244:247]
    ds_read_b64_tr_b16 v[78:79], v57 offset:20480
    ds_write_b128 v20, v[228:231] offset:1024
    s_waitcnt lgkmcnt(10)
    v_mfma_f32_16x16x32_bf16 v[216:219], v[88:91], v[136:139], v[216:219]
    ds_read_b64_tr_b16 v[80:81], v54 offset:24576
    ds_write_b128 v20, v[232:235] offset:2048
    v_mfma_f32_16x16x32_bf16 v[248:251], v[88:91], v[140:143], v[248:251]
    ds_read_b64_tr_b16 v[82:83], v54 offset:28672
    v_xor_b32 v54, 65536, v54
    ds_write_b128 v20, v[236:239] offset:3072
    v_mfma_f32_16x16x32_bf16 v[220:223], v[92:95], v[136:139], v[220:223]
    ds_read_b64_tr_b16 v[84:85], v55 offset:24576
    v_mfma_f32_16x16x32_bf16 v[252:255], v[92:95], v[140:143], v[252:255]
    ds_read_b64_tr_b16 v[86:87], v55 offset:28672
    v_xor_b32 v55, 65536, v55
    s_waitcnt lgkmcnt(12)
    v_mfma_f32_16x16x32_bf16 v[208:211], v[64:67], v[144:147], v[208:211]
    ds_read_b64_tr_b16 v[88:89], v56 offset:24576
    v_mfma_f32_16x16x32_bf16 v[240:243], v[64:67], v[148:151], v[240:243]
    ds_read_b64_tr_b16 v[90:91], v56 offset:28672
    v_xor_b32 v56, 65536, v56
    v_mfma_f32_16x16x32_bf16 v[212:215], v[68:71], v[144:147], v[212:215]
    ds_read_b64_tr_b16 v[92:93], v57 offset:24576
    s_waitcnt lgkmcnt(5)
    s_barrier
    v_mfma_f32_16x16x32_bf16 v[244:247], v[68:71], v[148:151], v[244:247]
    ds_read_b64_tr_b16 v[94:95], v57 offset:28672
    v_xor_b32 v57, 65536, v57
    ds_read_b128 v[224:227], v21 offset:0
    ds_read_b128 v[228:231], v21 offset:1024
    v_mfma_f32_16x16x32_bf16 v[216:219], v[72:75], v[144:147], v[216:219]
    ds_read_b64_tr_b16 v[64:65], v54 offset:0
    ds_read_b128 v[232:235], v21 offset:2048
    ds_read_b128 v[236:239], v21 offset:3072
    v_mfma_f32_16x16x32_bf16 v[248:251], v[72:75], v[148:151], v[248:251]
    ds_read_b64_tr_b16 v[66:67], v54 offset:4096
    v_mfma_f32_16x16x32_bf16 v[220:223], v[76:79], v[144:147], v[220:223]
    ds_read_b64_tr_b16 v[68:69], v55 offset:0
    v_mfma_f32_16x16x32_bf16 v[252:255], v[76:79], v[148:151], v[252:255]
    ds_read_b64_tr_b16 v[70:71], v55 offset:4096
    s_waitcnt lgkmcnt(12)
    v_mfma_f32_16x16x32_bf16 v[208:211], v[80:83], v[152:155], v[208:211]
    ds_read_b64_tr_b16 v[72:73], v56 offset:0
    s_waitcnt lgkmcnt(8)
    v_add_f32 v192, v192, v224
    v_add_f32 v193, v193, v225
    v_mfma_f32_16x16x32_bf16 v[240:243], v[80:83], v[156:159], v[240:243]
    ds_read_b64_tr_b16 v[74:75], v56 offset:4096
    v_add_f32 v194, v194, v226
    v_add_f32 v195, v195, v227
    buffer_store_dwordx4 v[192:195], v22, s[24:27], s41 offen offset:0 sc1
    v_mfma_f32_16x16x32_bf16 v[212:215], v[84:87], v[152:155], v[212:215]
    ds_read_b64_tr_b16 v[76:77], v57 offset:0
    s_waitcnt lgkmcnt(9)
    v_add_f32 v196, v196, v228
    v_add_f32 v197, v197, v229
    v_mfma_f32_16x16x32_bf16 v[244:247], v[84:87], v[156:159], v[244:247]
    ds_read_b64_tr_b16 v[78:79], v57 offset:4096
    v_add_f32 v198, v198, v230
    v_add_f32 v199, v199, v231
    buffer_store_dwordx4 v[196:199], v22, s[24:27], s41 offen offset:1024 sc1
    v_mfma_f32_16x16x32_bf16 v[216:219], v[88:91], v[152:155], v[216:219]
    ds_read_b64_tr_b16 v[80:81], v54 offset:8192
    s_waitcnt lgkmcnt(9)
    v_add_f32 v200, v200, v232
    v_add_f32 v201, v201, v233
    v_mfma_f32_16x16x32_bf16 v[248:251], v[88:91], v[156:159], v[248:251]
    ds_read_b64_tr_b16 v[82:83], v54 offset:12288
    v_add_f32 v202, v202, v234
    v_add_f32 v203, v203, v235
    buffer_store_dwordx4 v[200:203], v22, s[24:27], s41 offen offset:2048 sc1
    v_mfma_f32_16x16x32_bf16 v[220:223], v[92:95], v[152:155], v[220:223]
    ds_read_b64_tr_b16 v[84:85], v55 offset:8192
    s_waitcnt lgkmcnt(10)
    v_add_f32 v204, v204, v236
    v_add_f32 v205, v205, v237
    v_mfma_f32_16x16x32_bf16 v[252:255], v[92:95], v[156:159], v[252:255]
    ds_read_b64_tr_b16 v[86:87], v55 offset:12288
    v_add_f32 v206, v206, v238
    v_add_f32 v207, v207, v239
    buffer_store_dwordx4 v[204:207], v22, s[24:27], s41 offen offset:3072 sc1
    s_waitcnt lgkmcnt(8)
    v_mfma_f32_16x16x32_bf16 v[208:211], v[64:67], v[160:163], v[208:211]
    ds_read_b64_tr_b16 v[88:89], v56 offset:8192
    v_mfma_f32_16x16x32_bf16 v[240:243], v[64:67], v[164:167], v[240:243]
    ds_read_b64_tr_b16 v[90:91], v56 offset:12288
    v_mfma_f32_16x16x32_bf16 v[212:215], v[68:71], v[160:163], v[212:215]
    ds_read_b64_tr_b16 v[92:93], v57 offset:8192
    v_mfma_f32_16x16x32_bf16 v[244:247], v[68:71], v[164:167], v[244:247]
    ds_read_b64_tr_b16 v[94:95], v57 offset:12288
    s_waitcnt lgkmcnt(8)
    v_mfma_f32_16x16x32_bf16 v[216:219], v[72:75], v[160:163], v[216:219]
    ds_read_b64_tr_b16 v[64:65], v54 offset:16384
    v_mfma_f32_16x16x32_bf16 v[248:251], v[72:75], v[164:167], v[248:251]
    ds_read_b64_tr_b16 v[66:67], v54 offset:20480
    v_mfma_f32_16x16x32_bf16 v[220:223], v[76:79], v[160:163], v[220:223]
    ds_read_b64_tr_b16 v[68:69], v55 offset:16384
    v_mfma_f32_16x16x32_bf16 v[252:255], v[76:79], v[164:167], v[252:255]
    ds_read_b64_tr_b16 v[70:71], v55 offset:20480
    s_waitcnt lgkmcnt(8)
    v_mfma_f32_16x16x32_bf16 v[208:211], v[80:83], v[168:171], v[208:211]
    ds_read_b64_tr_b16 v[72:73], v56 offset:16384
    v_mfma_f32_16x16x32_bf16 v[240:243], v[80:83], v[172:175], v[240:243]
    ds_read_b64_tr_b16 v[74:75], v56 offset:20480
    v_mfma_f32_16x16x32_bf16 v[212:215], v[84:87], v[168:171], v[212:215]
    ds_read_b64_tr_b16 v[76:77], v57 offset:16384
    v_mfma_f32_16x16x32_bf16 v[244:247], v[84:87], v[172:175], v[244:247]
    ds_read_b64_tr_b16 v[78:79], v57 offset:20480
    s_waitcnt lgkmcnt(8)
    v_mfma_f32_16x16x32_bf16 v[216:219], v[88:91], v[168:171], v[216:219]
    ds_read_b64_tr_b16 v[80:81], v54 offset:24576
    v_mfma_f32_16x16x32_bf16 v[248:251], v[88:91], v[172:175], v[248:251]
    ds_read_b64_tr_b16 v[82:83], v54 offset:28672
    v_mfma_f32_16x16x32_bf16 v[220:223], v[92:95], v[168:171], v[220:223]
    ds_read_b64_tr_b16 v[84:85], v55 offset:24576
    s_lshr_b32 s36, s28, 2
    s_lshl_b32 s36, s36, 15
    s_and_b32 s37, s28, 3
    v_mfma_f32_16x16x32_bf16 v[252:255], v[92:95], v[172:175], v[252:255]
    ds_read_b64_tr_b16 v[86:87], v55 offset:28672
    s_lshl_b32 s37, s37, 12
    s_add_u32 s36, s36, s37
    s_add_u32 s36, s36, 65536
    s_waitcnt lgkmcnt(8)
    v_mfma_f32_16x16x32_bf16 v[208:211], v[64:67], v[176:179], v[208:211]
    ds_read_b64_tr_b16 v[88:89], v56 offset:24576
    v_add_u32 v20, s36, v22
    v_xor_b32 v21, 32768, v20
    v_mfma_f32_16x16x32_bf16 v[240:243], v[64:67], v[180:183], v[240:243]
    ds_read_b64_tr_b16 v[90:91], v56 offset:28672
    v_mfma_f32_16x16x32_bf16 v[212:215], v[68:71], v[176:179], v[212:215]
    ds_read_b64_tr_b16 v[92:93], v57 offset:24576
    v_mfma_f32_16x16x32_bf16 v[244:247], v[68:71], v[180:183], v[244:247]
    ds_read_b64_tr_b16 v[94:95], v57 offset:28672
    s_waitcnt lgkmcnt(8)
    v_mfma_f32_16x16x32_bf16 v[216:219], v[72:75], v[176:179], v[216:219]
    v_mfma_f32_16x16x32_bf16 v[248:251], v[72:75], v[180:183], v[248:251]
    v_mfma_f32_16x16x32_bf16 v[220:223], v[76:79], v[176:179], v[220:223]
    v_mfma_f32_16x16x32_bf16 v[252:255], v[76:79], v[180:183], v[252:255]
    s_waitcnt lgkmcnt(4)
    v_mfma_f32_16x16x32_bf16 v[208:211], v[80:83], v[184:187], v[208:211]
    v_mfma_f32_16x16x32_bf16 v[240:243], v[80:83], v[188:191], v[240:243]
    v_mfma_f32_16x16x32_bf16 v[212:215], v[84:87], v[184:187], v[212:215]
    v_mfma_f32_16x16x32_bf16 v[244:247], v[84:87], v[188:191], v[244:247]
    s_waitcnt lgkmcnt(0)
    v_mfma_f32_16x16x32_bf16 v[216:219], v[88:91], v[184:187], v[216:219]
    v_mfma_f32_16x16x32_bf16 v[248:251], v[88:91], v[188:191], v[248:251]
    v_mfma_f32_16x16x32_bf16 v[220:223], v[92:95], v[184:187], v[220:223]
    v_mfma_f32_16x16x32_bf16 v[252:255], v[92:95], v[188:191], v[252:255]
    s_waitcnt vmcnt(0)
    v_mov_b32 v4, s40
    v_mov_b32 v13, 1
    s_mov_b64 exec, 1
    global_atomic_add v4, v13, s[90:91]
    s_mov_b64 exec, -1
    s_nop 3
    s_nop 4
    ds_write_b128 v20, v[240:243] offset:0
    ds_write_b128 v20, v[244:247] offset:1024
    ds_write_b128 v20, v[248:251] offset:2048
    ds_write_b128 v20, v[252:255] offset:3072
    s_sub_u32 s36, s56, s38
    s_sub_u32 s37, s57, s38
    s_min_u32 s36, s36, s37
    s_cmp_lt_u32 s36, 16
    s_cbranch_scc1 L_recurrent_scan__compressed_kv_cla__moe_arch_mod__prompt_kernel_rare_179
L_recurrent_scan__compressed_kv_cla__moe_arch_mod__prompt_kernel_back_180:
    s_cmp_eq_u32 s28, 3
    s_cbranch_scc1 L_recurrent_scan__compressed_kv_cla__moe_arch_mod__prompt_kernel_rare_183
L_recurrent_scan__compressed_kv_cla__moe_arch_mod__prompt_kernel_back_184:
    s_waitcnt lgkmcnt(0)
    s_barrier
    buffer_load_dwordx4 v[64:67], v22, s[24:27], s39 offen offset:0 sc1
    buffer_load_dwordx4 v[68:71], v22, s[24:27], s39 offen offset:1024 sc1
    buffer_load_dwordx4 v[72:75], v22, s[24:27], s39 offen offset:2048 sc1
    buffer_load_dwordx4 v[76:79], v22, s[24:27], s39 offen offset:3072 sc1
    ds_read_b128 v[128:131], v21 offset:0
    ds_read_b128 v[132:135], v21 offset:1024
    ds_read_b128 v[136:139], v21 offset:2048
    ds_read_b128 v[140:143], v21 offset:3072
    s_waitcnt lgkmcnt(3)
    v_pk_add_f32 v[128:129], v[128:129], v[208:209]
    v_pk_add_f32 v[130:131], v[130:131], v[210:211]
    s_waitcnt lgkmcnt(2)
    v_pk_add_f32 v[132:133], v[132:133], v[212:213]
    v_pk_add_f32 v[134:135], v[134:135], v[214:215]
    s_waitcnt lgkmcnt(1)
    v_pk_add_f32 v[136:137], v[136:137], v[216:217]
    v_pk_add_f32 v[138:139], v[138:139], v[218:219]
    s_waitcnt lgkmcnt(0)
    v_pk_add_f32 v[140:141], v[140:141], v[220:221]
    v_pk_add_f32 v[142:143], v[142:143], v[222:223]
    s_waitcnt vmcnt(3)
    v_pk_add_f32 v[128:129], v[128:129], v[64:65]
    v_cvt_pk_bf16_f32 v23, v128, v129
    v_lshlrev_b32 v128, 16, v23
    v_and_b32 v129, 0xffff0000, v23
    v_pk_mul_f32 v[128:129], v[128:129], v[112:113]
    v_cvt_pk_bf16_f32 v23, v128, v129
    v_lshlrev_b32 v128, 16, v23
    v_and_b32 v129, 0xffff0000, v23
    v_pk_add_f32 v[128:129], v[128:129], v[96:97]
    v_cvt_pk_bf16_f32 v80, v128, v129
    v_pk_add_f32 v[130:131], v[130:131], v[66:67]
    v_cvt_pk_bf16_f32 v23, v130, v131
    v_lshlrev_b32 v130, 16, v23
    v_and_b32 v131, 0xffff0000, v23
    v_pk_mul_f32 v[130:131], v[130:131], v[114:115]
    v_cvt_pk_bf16_f32 v23, v130, v131
    v_lshlrev_b32 v130, 16, v23
    v_and_b32 v131, 0xffff0000, v23
    v_pk_add_f32 v[130:131], v[130:131], v[98:99]
    v_cvt_pk_bf16_f32 v81, v130, v131
    ds_write_b64 v17, v[80:81] offset:0
    s_waitcnt vmcnt(2)
    v_pk_add_f32 v[132:133], v[132:133], v[68:69]
    v_cvt_pk_bf16_f32 v23, v132, v133
    v_lshlrev_b32 v132, 16, v23
    v_and_b32 v133, 0xffff0000, v23
    v_pk_mul_f32 v[132:133], v[132:133], v[116:117]
    v_cvt_pk_bf16_f32 v23, v132, v133
    v_lshlrev_b32 v132, 16, v23
    v_and_b32 v133, 0xffff0000, v23
    v_pk_add_f32 v[132:133], v[132:133], v[100:101]
    v_cvt_pk_bf16_f32 v82, v132, v133
    v_pk_add_f32 v[134:135], v[134:135], v[70:71]
    v_cvt_pk_bf16_f32 v23, v134, v135
    v_lshlrev_b32 v134, 16, v23
    v_and_b32 v135, 0xffff0000, v23
    v_pk_mul_f32 v[134:135], v[134:135], v[118:119]
    v_cvt_pk_bf16_f32 v23, v134, v135
    v_lshlrev_b32 v134, 16, v23
    v_and_b32 v135, 0xffff0000, v23
    v_pk_add_f32 v[134:135], v[134:135], v[102:103]
    v_cvt_pk_bf16_f32 v83, v134, v135
    ds_write_b64 v17, v[82:83] offset:32
    s_waitcnt vmcnt(1)
    v_pk_add_f32 v[136:137], v[136:137], v[72:73]
    v_cvt_pk_bf16_f32 v23, v136, v137
    v_lshlrev_b32 v136, 16, v23
    v_and_b32 v137, 0xffff0000, v23
    v_pk_mul_f32 v[136:137], v[136:137], v[120:121]
    v_cvt_pk_bf16_f32 v23, v136, v137
    v_lshlrev_b32 v136, 16, v23
    v_and_b32 v137, 0xffff0000, v23
    v_pk_add_f32 v[136:137], v[136:137], v[104:105]
    v_cvt_pk_bf16_f32 v84, v136, v137
    v_pk_add_f32 v[138:139], v[138:139], v[74:75]
    v_cvt_pk_bf16_f32 v23, v138, v139
    v_lshlrev_b32 v138, 16, v23
    v_and_b32 v139, 0xffff0000, v23
    v_pk_mul_f32 v[138:139], v[138:139], v[122:123]
    v_cvt_pk_bf16_f32 v23, v138, v139
    v_lshlrev_b32 v138, 16, v23
    v_and_b32 v139, 0xffff0000, v23
    v_pk_add_f32 v[138:139], v[138:139], v[106:107]
    v_cvt_pk_bf16_f32 v85, v138, v139
    ds_write_b64 v17, v[84:85] offset:64
    s_waitcnt vmcnt(0)
    v_pk_add_f32 v[140:141], v[140:141], v[76:77]
    v_cvt_pk_bf16_f32 v23, v140, v141
    v_lshlrev_b32 v140, 16, v23
    v_and_b32 v141, 0xffff0000, v23
    v_pk_mul_f32 v[140:141], v[140:141], v[124:125]
    v_cvt_pk_bf16_f32 v23, v140, v141
    v_lshlrev_b32 v140, 16, v23
    v_and_b32 v141, 0xffff0000, v23
    v_pk_add_f32 v[140:141], v[140:141], v[108:109]
    v_cvt_pk_bf16_f32 v86, v140, v141
    v_pk_add_f32 v[142:143], v[142:143], v[78:79]
    v_cvt_pk_bf16_f32 v23, v142, v143
    v_lshlrev_b32 v142, 16, v23
    v_and_b32 v143, 0xffff0000, v23
    v_pk_mul_f32 v[142:143], v[142:143], v[126:127]
    v_cvt_pk_bf16_f32 v23, v142, v143
    v_lshlrev_b32 v142, 16, v23
    v_and_b32 v143, 0xffff0000, v23
    v_pk_add_f32 v[142:143], v[142:143], v[110:111]
    v_cvt_pk_bf16_f32 v87, v142, v143
    ds_write_b64 v17, v[86:87] offset:96
    v_add_u32 v22, s42, v22
    s_mov_b32 s36, 16384
    s_waitcnt lgkmcnt(0)
    ds_read_b128 v[64:67], v22
    ds_read_b128 v[68:71], v22 offset:1024
    s_waitcnt lgkmcnt(1)
    buffer_store_dwordx4 v[64:67], v15, s[20:23], 0 offen sc1
    s_waitcnt lgkmcnt(0)
    buffer_store_dwordx4 v[68:71], v15, s[20:23], s36 offen sc1
    s_endpgm
L_recurrent_scan__compressed_kv_cla__moe_arch_mod__prompt_kernel_rare_143:
    v_mov_b32 v26, s40
    v_mov_b32 v28, 1
    v_writelane_b32 v26, s41, 1
    s_mov_b64 exec, 3
    global_atomic_add v26, v28, s[90:91]
    s_mov_b64 exec, -1
    s_branch L_recurrent_scan__compressed_kv_cla__moe_arch_mod__prompt_kernel_back_144
L_recurrent_scan__compressed_kv_cla__moe_arch_mod__prompt_kernel_rt1_rare_3:
    s_mov_b32 s61, 0x40000
L_recurrent_scan__compressed_kv_cla__moe_arch_mod__prompt_kernel_rt1_spin_1:
    s_sub_u32 s61, s61, 1
    s_cbranch_scc1 L_recurrent_scan__compressed_kv_cla__moe_arch_mod__prompt_kernel_rt1_spinx_2
    s_sleep 1
    global_load_dword v61, v60, s[90:91] sc1
    s_waitcnt vmcnt(0)
    v_readfirstlane_b32 s36, v61
    s_nop 0
    s_cmp_lt_u32 s36, 16
    s_cbranch_scc1 L_recurrent_scan__compressed_kv_cla__moe_arch_mod__prompt_kernel_rt1_spin_1
L_recurrent_scan__compressed_kv_cla__moe_arch_mod__prompt_kernel_rt1_spinx_2:
    s_branch L_recurrent_scan__compressed_kv_cla__moe_arch_mod__prompt_kernel_rt1_back_4
L_recurrent_scan__compressed_kv_cla__moe_arch_mod__prompt_kernel_rare_153:
    s_cmp_eq_u32 s35, 1
    s_cbranch_scc0 L_recurrent_scan__compressed_kv_cla__moe_arch_mod__prompt_kernel_swn_152
    s_cmp_eq_u32 s28, 0
    s_cbranch_scc0 L_recurrent_scan__compressed_kv_cla__moe_arch_mod__prompt_kernel_g_146
    s_and_b32 s36, s2, 15
    s_add_u32 s36, s36, 96
    s_lshl_b32 s36, s36, 7
    v_mov_b32 v26, s36
    v_mov_b32 v27, 1
    s_mov_b64 exec, 1
    global_atomic_add v26, v27, s[90:91]
    s_mov_b64 exec, -1
    s_nop 3
L_recurrent_scan__compressed_kv_cla__moe_arch_mod__prompt_kernel_g_146:
    s_branch L_recurrent_scan__compressed_kv_cla__moe_arch_mod__prompt_kernel_swend_151
L_recurrent_scan__compressed_kv_cla__moe_arch_mod__prompt_kernel_swn_152:
    s_sub_u32 s36, s56, s38
    s_sub_u32 s37, s57, s38
    s_min_u32 s36, s36, s37
    s_cmp_lt_u32 s36, 16
    s_cbranch_scc0 L_recurrent_scan__compressed_kv_cla__moe_arch_mod__prompt_kernel_nrt_147
    s_add_u32 s36, s30, 96
    s_lshl_b32 s36, s36, 7
    v_mov_b32 v60, s36
    global_load_dword v61, v60, s[90:91] sc1
L_recurrent_scan__compressed_kv_cla__moe_arch_mod__prompt_kernel_nrt_147:
    s_mov_b32 m0, s42
    s_mov_b32 s36, 15360
    buffer_load_dwordx4 v15, s[16:19], 0 offen lds
    buffer_load_dwordx4 v15, s[16:19], s36 offen offset:1024 lds
    s_mov_b32 s36, 4194304
    buffer_load_dwordx2 v[48:49], v16, s[24:27], s36 offen sc1
L_recurrent_scan__compressed_kv_cla__moe_arch_mod__prompt_kernel_swend_151:
    s_branch L_recurrent_scan__compressed_kv_cla__moe_arch_mod__prompt_kernel_back_154
L_recurrent_scan__compressed_kv_cla__moe_arch_mod__prompt_kernel_rare_156:
    s_cmp_eq_u32 s28, 0
    s_cbranch_scc0 L_recurrent_scan__compressed_kv_cla__moe_arch_mod__prompt_kernel_g_150
    s_mov_b32 s43, s38
    s_getpc_b64 s[36:37]
L_recurrent_scan__compressed_kv_cla__moe_arch_mod__prompt_kernel_pc_149:
    s_sub_u32 s36, s36, L_recurrent_scan__compressed_kv_cla__moe_arch_mod__prompt_kernel_pc_149-L_pc
    s_subb_u32 s37, s37, 0
    s_lshr_b32 s38, s2, 3
    s_lshl_b32 s38, s38, 7
    v_lshl_add_u32 v4, v1, 12, s38
    v_min_u32 v4, L_end-L_pc-4, v4
    v_mov_b32 v5, s37
    v_add_co_u32 v4, vcc, s36, v4
    s_mov_b64 exec, 0xffff
    s_nop 0
    v_addc_co_u32 v5, vcc, 0, v5, vcc
    global_load_dword v63, v[4:5], off
    s_mov_b64 exec, -1
    s_nop 1
    s_mov_b32 s38, s43
L_recurrent_scan__compressed_kv_cla__moe_arch_mod__prompt_kernel_g_150:
    s_sub_u32 s36, s56, s38
    s_sub_u32 s37, s57, s38
    s_min_u32 s36, s36, s37
    s_cmp_lt_u32 s36, 16
    s_cbranch_scc0 L_recurrent_scan__compressed_kv_cla__moe_arch_mod__prompt_kernel_nrt_148
    s_waitcnt vmcnt(16)
    v_readfirstlane_b32 s36, v61
    s_nop 0
    s_cmp_lt_u32 s36, 16
    s_cbranch_scc1 L_recurrent_scan__compressed_kv_cla__moe_arch_mod__prompt_kernel_rt1_rare_3
L_recurrent_scan__compressed_kv_cla__moe_arch_mod__prompt_kernel_rt1_back_4:
    s_lshl_b32 s37, s30, 8
    s_add_u32 s36, s37, 59768832
    s_add_u32 s37, s36, 4096
    v_and_b32 v60, 15, v1
    v_lshlrev_b32 v60, 13, v60
    v_lshl_add_u32 v60, v19, 4, v60
    buffer_load_dwordx4 v[96:99], v60, s[24:27], s36 offen offset:0 sc1
    buffer_load_dwordx4 v[100:103], v60, s[24:27], s36 offen offset:64 sc1
    buffer_load_dwordx4 v[104:107], v60, s[24:27], s36 offen offset:128 sc1
    buffer_load_dwordx4 v[108:111], v60, s[24:27], s36 offen offset:192 sc1
    buffer_load_dwordx4 v[112:115], v60, s[24:27], s37 offen offset:0 sc1
    buffer_load_dwordx4 v[116:119], v60, s[24:27], s37 offen offset:64 sc1
    buffer_load_dwordx4 v[120:123], v60, s[24:27], s37 offen offset:128 sc1
    buffer_load_dwordx4 v[124:127], v60, s[24:27], s37 offen offset:192 sc1
L_recurrent_scan__compressed_kv_cla__moe_arch_mod__prompt_kernel_nrt_148:
L_recurrent_scan__compressed_kv_cla__moe_arch_mod__prompt_kernel_swend_155:
    s_branch L_recurrent_scan__compressed_kv_cla__moe_arch_mod__prompt_kernel_back_157
L_recurrent_scan__compressed_kv_cla__moe_arch_mod__prompt_kernel_rare_158:
    global_load_dword v59, v58, s[90:91] sc1
    s_branch L_recurrent_scan__compressed_kv_cla__moe_arch_mod__prompt_kernel_back_159
L_recurrent_scan__compressed_kv_cla__moe_arch_mod__prompt_kernel_rare_168:
    s_cmp_eq_u32 s35, 0
    s_cbranch_scc0 L_recurrent_scan__compressed_kv_cla__moe_arch_mod__prompt_kernel_swn_167
    s_mov_b32 s61, 0x40000
    s_waitcnt vmcnt(8)
    s_branch L_recurrent_scan__compressed_kv_cla__moe_arch_mod__prompt_kernel_cchk_162
L_recurrent_scan__compressed_kv_cla__moe_arch_mod__prompt_kernel_cspin_160:
    s_sub_u32 s61, s61, 1
    s_cbranch_scc1 L_recurrent_scan__compressed_kv_cla__moe_arch_mod__prompt_kernel_cspinx_161
    global_load_dword v59, v58, s[90:91] sc1
    s_waitcnt vmcnt(0)
L_recurrent_scan__compressed_kv_cla__moe_arch_mod__prompt_kernel_cchk_162:
    v_cmp_le_u32 vcc, 4, v59
    s_nop 0
    s_and_b32 s60, vcc_lo, 15
    s_and_b32 s36, s60, 7
    s_cmp_eq_u32 s36, 7
    s_cbranch_scc1 L_recurrent_scan__compressed_kv_cla__moe_arch_mod__prompt_kernel_cspinx_161
    s_sleep 6
    s_branch L_recurrent_scan__compressed_kv_cla__moe_arch_mod__prompt_kernel_cspin_160
L_recurrent_scan__compressed_kv_cla__moe_arch_mod__prompt_kernel_cspinx_161:
    s_branch L_recurrent_scan__compressed_kv_cla__moe_arch_mod__prompt_kernel_swend_166
L_recurrent_scan__compressed_kv_cla__moe_arch_mod__prompt_kernel_swn_167:
    s_mov_b32 s61, 0x40000
    s_waitcnt vmcnt(8)
    s_branch L_recurrent_scan__compressed_kv_cla__moe_arch_mod__prompt_kernel_cchk_165
L_recurrent_scan__compressed_kv_cla__moe_arch_mod__prompt_kernel_cspin_163:
    s_sub_u32 s61, s61, 1
    s_cbranch_scc1 L_recurrent_scan__compressed_kv_cla__moe_arch_mod__prompt_kernel_cspinx_164
    global_load_dword v59, v58, s[90:91] sc1
    s_waitcnt vmcnt(0)
L_recurrent_scan__compressed_kv_cla__moe_arch_mod__prompt_kernel_cchk_165:
    v_cmp_le_u32 vcc, 4, v59
    s_nop 0
    s_and_b32 s60, vcc_lo, 15
    s_and_b32 s36, s60, 15
    s_cmp_eq_u32 s36, 15
    s_cbranch_scc1 L_recurrent_scan__compressed_kv_cla__moe_arch_mod__prompt_kernel_cspinx_164
    s_sleep 6
    s_branch L_recurrent_scan__compressed_kv_cla__moe_arch_mod__prompt_kernel_cspin_163
L_recurrent_scan__compressed_kv_cla__moe_arch_mod__prompt_kernel_cspinx_164:
L_recurrent_scan__compressed_kv_cla__moe_arch_mod__prompt_kernel_swend_166:
    s_branch L_recurrent_scan__compressed_kv_cla__moe_arch_mod__prompt_kernel_back_169
L_recurrent_scan__compressed_kv_cla__moe_arch_mod__prompt_kernel_f2m_170:
    v_lshrrev_b32 v28, 4, v1
    v_bfe_u32 v26, v1, 2, 2
    v_lshl_add_u32 v26, v28, 3, v26
    v_lshlrev_b32 v26, 7, v26
    v_and_b32 v27, 3, v1
    v_lshl_add_u32 v26, v27, 3, v26
    v_bfe_u32 v27, v1, 3, 2
    s_lshl_b32 s36, s28, 12
    s_add_u32 s36, s36, 131072
    v_add_u32 v26, s36, v26
    v_xor_b32 v28, 0, v27
    v_lshl_add_u32 v28, v28, 5, v26
    ds_read_b64_tr_b16 v[112:113], v28 offset:0
    ds_read_b64_tr_b16 v[114:115], v28 offset:512
    v_xor_b32 v28, 1, v27
    v_lshl_add_u32 v28, v28, 5, v26
    ds_read_b64_tr_b16 v[116:117], v28 offset:0
    ds_read_b64_tr_b16 v[118:119], v28 offset:512
    v_xor_b32 v28, 2, v27
    v_lshl_add_u32 v28, v28, 5, v26
    ds_read_b64_tr_b16 v[120:121], v28 offset:0
    ds_read_b64_tr_b16 v[122:123], v28 offset:512
    v_xor_b32 v28, 3, v27
    v_lshl_add_u32 v28, v28, 5, v26
    ds_read_b64_tr_b16 v[124:125], v28 offset:0
    ds_read_b64_tr_b16 v[126:127], v28 offset:512
    v_add_f32_dpp v96, v96, v96 row_ror:4 row_mask:0xf bank_mask:0xf
    v_add_f32_dpp v97, v97, v97 row_ror:4 row_mask:0xf bank_mask:0xf
    v_add_f32_dpp v98, v98, v98 row_ror:4 row_mask:0xf bank_mask:0xf
    v_add_f32_dpp v99, v99, v99 row_ror:4 row_mask:0xf bank_mask:0xf
    v_add_f32_dpp v100, v100, v100 row_ror:4 row_mask:0xf bank_mask:0xf
    v_add_f32_dpp v101, v101, v101 row_ror:4 row_mask:0xf bank_mask:0xf
    v_add_f32_dpp v102, v102, v102 row_ror:4 row_mask:0xf bank_mask:0xf
    v_add_f32_dpp v103, v103, v103 row_ror:4 row_mask:0xf bank_mask:0xf
    v_add_f32_dpp v96, v96, v96 row_ror:8 row_mask:0xf bank_mask:0xf
    v_add_f32_dpp v97, v97, v97 row_ror:8 row_mask:0xf bank_mask:0xf
    v_add_f32_dpp v98, v98, v98 row_ror:8 row_mask:0xf bank_mask:0xf
    v_add_f32_dpp v99, v99, v99 row_ror:8 row_mask:0xf bank_mask:0xf
    v_add_f32_dpp v100, v100, v100 row_ror:8 row_mask:0xf bank_mask:0xf
    v_add_f32_dpp v101, v101, v101 row_ror:8 row_mask:0xf bank_mask:0xf
    v_add_f32_dpp v102, v102, v102 row_ror:8 row_mask:0xf bank_mask:0xf
    v_add_f32_dpp v103, v103, v103 row_ror:8 row_mask:0xf bank_mask:0xf
    v_cvt_pk_bf16_f32 v29, v96, v97
    v_lshlrev_b32 v96, 16, v29
    v_and_b32 v97, 0xffff0000, v29
    v_cvt_pk_bf16_f32 v29, v98, v99
    v_lshlrev_b32 v98, 16, v29
    v_and_b32 v99, 0xffff0000, v29
    v_cvt_pk_bf16_f32 v29, v100, v101
    v_lshlrev_b32 v100, 16, v29
    v_and_b32 v101, 0xffff0000, v29
    v_cvt_pk_bf16_f32 v29, v102, v103
    v_lshlrev_b32 v102, 16, v29
    v_and_b32 v103, 0xffff0000, v29
    v_mul_f32 v104, 0xbfb8aa3b, v96
    v_mul_f32 v105, 0xbfb8aa3b, v97
    v_mul_f32 v106, 0xbfb8aa3b, v98
    v_mul_f32 v107, 0xbfb8aa3b, v99
    v_mul_f32 v108, 0xbfb8aa3b, v100
    v_mul_f32 v109, 0xbfb8aa3b, v101
    v_mul_f32 v110, 0xbfb8aa3b, v102
    v_mul_f32 v111, 0xbfb8aa3b, v103
    v_exp_f32 v104, v104
    v_exp_f32 v105, v105
    v_exp_f32 v106, v106
    v_exp_f32 v107, v107
    v_exp_f32 v108, v108
    v_exp_f32 v109, v109
    v_exp_f32 v110, v110
    v_exp_f32 v111, v111
    v_add_f32 v104, 1.0, v104
    v_add_f32 v105, 1.0, v105
    v_add_f32 v106, 1.0, v106
    v_add_f32 v107, 1.0, v107
    v_add_f32 v108, 1.0, v108
    v_add_f32 v109, 1.0, v109
    v_add_f32 v110, 1.0, v110
    v_add_f32 v111, 1.0, v111
    v_rcp_f32 v104, v104
    v_rcp_f32 v105, v105
    v_rcp_f32 v106, v106
    v_rcp_f32 v107, v107
    v_rcp_f32 v108, v108
    v_rcp_f32 v109, v109
    v_rcp_f32 v110, v110
    v_rcp_f32 v111, v111
    v_mul_f32 v104, v96, v104
    v_mul_f32 v105, v97, v105
    v_mul_f32 v106, v98, v106
    v_mul_f32 v107, v99, v107
    v_mul_f32 v108, v100, v108
    v_mul_f32 v109, v101, v109
    v_mul_f32 v110, v102, v110
    v_mul_f32 v111, v103, v111
    v_cvt_pk_bf16_f32 v29, v104, v105
    v_lshlrev_b32 v104, 16, v29
    v_and_b32 v105, 0xffff0000, v29
    v_cvt_pk_bf16_f32 v29, v106, v107
    v_lshlrev_b32 v106, 16, v29
    v_and_b32 v107, 0xffff0000, v29
    v_cvt_pk_bf16_f32 v29, v108, v109
    v_lshlrev_b32 v108, 16, v29
    v_and_b32 v109, 0xffff0000, v29
    v_cvt_pk_bf16_f32 v29, v110, v111
    v_lshlrev_b32 v110, 16, v29
    v_and_b32 v111, 0xffff0000, v29
    v_mul_f32_dpp v96, v96, v104 quad_perm:[2,3,0,1] row_mask:0xf bank_mask:0xf
    v_mul_f32_dpp v97, v97, v105 quad_perm:[2,3,0,1] row_mask:0xf bank_mask:0xf
    v_mul_f32_dpp v98, v98, v106 quad_perm:[2,3,0,1] row_mask:0xf bank_mask:0xf
    v_mul_f32_dpp v99, v99, v107 quad_perm:[2,3,0,1] row_mask:0xf bank_mask:0xf
    v_mul_f32_dpp v100, v100, v108 quad_perm:[2,3,0,1] row_mask:0xf bank_mask:0xf
    v_mul_f32_dpp v101, v101, v109 quad_perm:[2,3,0,1] row_mask:0xf bank_mask:0xf
    v_mul_f32_dpp v102, v102, v110 quad_perm:[2,3,0,1] row_mask:0xf bank_mask:0xf
    v_mul_f32_dpp v103, v103, v111 quad_perm:[2,3,0,1] row_mask:0xf bank_mask:0xf
    v_cvt_pk_bf16_f32 v36, v96, v97
    v_cvt_pk_bf16_f32 v37, v98, v99
    v_cvt_pk_bf16_f32 v38, v100, v101
    v_cvt_pk_bf16_f32 v39, v102, v103
    s_waitcnt lgkmcnt(0)
    v_lshl_add_u32 v28, v1, 4, s36
    v_mfma_f32_16x16x32_bf16 v[96:99], v[112:115], v[36:39], 0
    v_mfma_f32_16x16x32_bf16 v[100:103], v[116:119], v[36:39], 0
    v_mfma_f32_16x16x32_bf16 v[104:107], v[120:123], v[36:39], 0
    v_mfma_f32_16x16x32_bf16 v[108:111], v[124:127], v[36:39], 0
    s_nop 7
    ds_write_b128 v28, v[96:99] offset:0
    ds_write_b128 v28, v[100:103] offset:1024
    ds_write_b128 v28, v[104:107] offset:2048
    ds_write_b128 v28, v[108:111] offset:3072
    s_cmp_lt_u32 s28, 4
    s_cbranch_scc1 L_recurrent_scan__compressed_kv_cla__moe_arch_mod__prompt_kernel_f2b_172
    s_branch L_recurrent_scan__compressed_kv_cla__moe_arch_mod__prompt_kernel_f2a_171
L_recurrent_scan__compressed_kv_cla__moe_arch_mod__prompt_kernel_rare_177:
    v_mov_b64 v[24:25], 0
    v_mov_b64 v[26:27], 0
    v_mov_b64 v[28:29], 0
    v_mov_b64 v[30:31], 0
    v_mov_b64 v[32:33], 0
    v_mov_b64 v[34:35], 0
    v_mov_b64 v[36:37], 0
    v_mov_b64 v[38:39], 0
    s_waitcnt vmcnt(16)
    s_sub_u32 s36, s56, s38
    s_cmp_lt_u32 s36, 16
    s_cbranch_scc0 L_recurrent_scan__compressed_kv_cla__moe_arch_mod__prompt_kernel_rt2_noy_1
    s_and_b32 s36, s58, 0xffff0000
    s_cmp_lt_i32 s36, 0
    s_cselect_b32 s37, 0x80000000, -1
    s_xor_b32 s36, s36, s37
    s_and_b32 s36, s36, 0xffff0000
    v_mov_b32 v62, s36
    v_mul_f32 v62, 0xbfb8aa3b, v62
    v_exp_f32 v62, v62
    s_nop 0
    v_add_f32 v62, 1.0, v62
    v_rcp_f32 v62, v62
    s_nop 0
    v_cvt_pk_bf16_f32 v62, v62, v62
    v_lshlrev_b32 v62, 16, v62
    v_add_f32_dpp v96, v96, v96 quad_perm:[1,0,3,2] row_mask:0xf bank_mask:0xf
    v_add_f32_dpp v97, v97, v97 quad_perm:[1,0,3,2] row_mask:0xf bank_mask:0xf
    v_add_f32_dpp v98, v98, v98 quad_perm:[1,0,3,2] row_mask:0xf bank_mask:0xf
    v_add_f32_dpp v99, v99, v99 quad_perm:[1,0,3,2] row_mask:0xf bank_mask:0xf
    v_add_f32_dpp v100, v100, v100 quad_perm:[1,0,3,2] row_mask:0xf bank_mask:0xf
    v_add_f32_dpp v101, v101, v101 quad_perm:[1,0,3,2] row_mask:0xf bank_mask:0xf
    v_add_f32_dpp v102, v102, v102 quad_perm:[1,0,3,2] row_mask:0xf bank_mask:0xf
    v_add_f32_dpp v103, v103, v103 quad_perm:[1,0,3,2] row_mask:0xf bank_mask:0xf
    v_add_f32_dpp v104, v104, v104 quad_perm:[1,0,3,2] row_mask:0xf bank_mask:0xf
    v_add_f32_dpp v105, v105, v105 quad_perm:[1,0,3,2] row_mask:0xf bank_mask:0xf
    v_add_f32_dpp v106, v106, v106 quad_perm:[1,0,3,2] row_mask:0xf bank_mask:0xf
    v_add_f32_dpp v107, v107, v107 quad_perm:[1,0,3,2] row_mask:0xf bank_mask:0xf
    v_add_f32_dpp v108, v108, v108 quad_perm:[1,0,3,2] row_mask:0xf bank_mask:0xf
    v_add_f32_dpp v109, v109, v109 quad_perm:[1,0,3,2] row_mask:0xf bank_mask:0xf
    v_add_f32_dpp v110, v110, v110 quad_perm:[1,0,3,2] row_mask:0xf bank_mask:0xf
    v_add_f32_dpp v111, v111, v111 quad_perm:[1,0,3,2] row_mask:0xf bank_mask:0xf
    v_add_f32_dpp v96, v96, v96 quad_perm:[2,3,0,1] row_mask:0xf bank_mask:0xf
    v_add_f32_dpp v97, v97, v97 quad_perm:[2,3,0,1] row_mask:0xf bank_mask:0xf
    v_add_f32_dpp v98, v98, v98 quad_perm:[2,3,0,1] row_mask:0xf bank_mask:0xf
    v_add_f32_dpp v99, v99, v99 quad_perm:[2,3,0,1] row_mask:0xf bank_mask:0xf
    v_add_f32_dpp v100, v100, v100 quad_perm:[2,3,0,1] row_mask:0xf bank_mask:0xf
    v_add_f32_dpp v101, v101, v101 quad_perm:[2,3,0,1] row_mask:0xf bank_mask:0xf
    v_add_f32_dpp v102, v102, v102 quad_perm:[2,3,0,1] row_mask:0xf bank_mask:0xf
    v_add_f32_dpp v103, v103, v103 quad_perm:[2,3,0,1] row_mask:0xf bank_mask:0xf
    v_add_f32_dpp v104, v104, v104 quad_perm:[2,3,0,1] row_mask:0xf bank_mask:0xf
    v_add_f32_dpp v105, v105, v105 quad_perm:[2,3,0,1] row_mask:0xf bank_mask:0xf
    v_add_f32_dpp v106, v106, v106 quad_perm:[2,3,0,1] row_mask:0xf bank_mask:0xf
    v_add_f32_dpp v107, v107, v107 quad_perm:[2,3,0,1] row_mask:0xf bank_mask:0xf
    v_add_f32_dpp v108, v108, v108 quad_perm:[2,3,0,1] row_mask:0xf bank_mask:0xf
    v_add_f32_dpp v109, v109, v109 quad_perm:[2,3,0,1] row_mask:0xf bank_mask:0xf
    v_add_f32_dpp v110, v110, v110 quad_perm:[2,3,0,1] row_mask:0xf bank_mask:0xf
    v_add_f32_dpp v111, v111, v111 quad_perm:[2,3,0,1] row_mask:0xf bank_mask:0xf
    v_add_f32_dpp v96, v96, v96 row_half_mirror row_mask:0xf bank_mask:0xf
    v_add_f32_dpp v97, v97, v97 row_half_mirror row_mask:0xf bank_mask:0xf
    v_add_f32_dpp v98, v98, v98 row_half_mirror row_mask:0xf bank_mask:0xf
    v_add_f32_dpp v99, v99, v99 row_half_mirror row_mask:0xf bank_mask:0xf
    v_add_f32_dpp v100, v100, v100 row_half_mirror row_mask:0xf bank_mask:0xf
    v_add_f32_dpp v101, v101, v101 row_half_mirror row_mask:0xf bank_mask:0xf
    v_add_f32_dpp v102, v102, v102 row_half_mirror row_mask:0xf bank_mask:0xf
    v_add_f32_dpp v103, v103, v103 row_half_mirror row_mask:0xf bank_mask:0xf
    v_add_f32_dpp v104, v104, v104 row_half_mirror row_mask:0xf bank_mask:0xf
    v_add_f32_dpp v105, v105, v105 row_half_mirror row_mask:0xf bank_mask:0xf
    v_add_f32_dpp v106, v106, v106 row_half_mirror row_mask:0xf bank_mask:0xf
    v_add_f32_dpp v107, v107, v107 row_half_mirror row_mask:0xf bank_mask:0xf
    v_add_f32_dpp v108, v108, v108 row_half_mirror row_mask:0xf bank_mask:0xf
    v_add_f32_dpp v109, v109, v109 row_half_mirror row_mask:0xf bank_mask:0xf
    v_add_f32_dpp v110, v110, v110 row_half_mirror row_mask:0xf bank_mask:0xf
    v_add_f32_dpp v111, v111, v111 row_half_mirror row_mask:0xf bank_mask:0xf
    v_add_f32_dpp v96, v96, v96 row_mirror row_mask:0xf bank_mask:0xf
    v_add_f32_dpp v97, v97, v97 row_mirror row_mask:0xf bank_mask:0xf
    v_add_f32_dpp v98, v98, v98 row_mirror row_mask:0xf bank_mask:0xf
    v_add_f32_dpp v99, v99, v99 row_mirror row_mask:0xf bank_mask:0xf
    v_add_f32_dpp v100, v100, v100 row_mirror row_mask:0xf bank_mask:0xf
    v_add_f32_dpp v101, v101, v101 row_mirror row_mask:0xf bank_mask:0xf
    v_add_f32_dpp v102, v102, v102 row_mirror row_mask:0xf bank_mask:0xf
    v_add_f32_dpp v103, v103, v103 row_mirror row_mask:0xf bank_mask:0xf
    v_add_f32_dpp v104, v104, v104 row_mirror row_mask:0xf bank_mask:0xf
    v_add_f32_dpp v105, v105, v105 row_mirror row_mask:0xf bank_mask:0xf
    v_add_f32_dpp v106, v106, v106 row_mirror row_mask:0xf bank_mask:0xf
    v_add_f32_dpp v107, v107, v107 row_mirror row_mask:0xf bank_mask:0xf
    v_add_f32_dpp v108, v108, v108 row_mirror row_mask:0xf bank_mask:0xf
    v_add_f32_dpp v109, v109, v109 row_mirror row_mask:0xf bank_mask:0xf
    v_add_f32_dpp v110, v110, v110 row_mirror row_mask:0xf bank_mask:0xf
    v_add_f32_dpp v111, v111, v111 row_mirror row_mask:0xf bank_mask:0xf
    v_cmp_eq_u32 vcc, s56, v14
    v_cvt_pk_bf16_f32 v63, v96, v97
    v_lshlrev_b32 v96, 16, v63
    v_and_b32 v97, 0xffff0000, v63
    v_mul_f32 v96, v62, v96
    v_mul_f32 v97, v62, v97
    v_cvt_pk_bf16_f32 v63, v96, v97
    v_lshlrev_b32 v96, 16, v63
    v_and_b32 v97, 0xffff0000, v63
    v_cndmask_b32 v24, v24, v96, vcc
    v_cndmask_b32 v25, v25, v97, vcc
    v_cvt_pk_bf16_f32 v63, v98, v99
    v_lshlrev_b32 v98, 16, v63
    v_and_b32 v99, 0xffff0000, v63
    v_mul_f32 v98, v62, v98
    v_mul_f32 v99, v62, v99
    v_cvt_pk_bf16_f32 v63, v98, v99
    v_lshlrev_b32 v98, 16, v63
    v_and_b32 v99, 0xffff0000, v63
    v_cndmask_b32 v26, v26, v98, vcc
    v_cndmask_b32 v27, v27, v99, vcc
    v_cvt_pk_bf16_f32 v63, v100, v101
    v_lshlrev_b32 v100, 16, v63
    v_and_b32 v101, 0xffff0000, v63
    v_mul_f32 v100, v62, v100
    v_mul_f32 v101, v62, v101
    v_cvt_pk_bf16_f32 v63, v100, v101
    v_lshlrev_b32 v100, 16, v63
    v_and_b32 v101, 0xffff0000, v63
    v_cndmask_b32 v28, v28, v100, vcc
    v_cndmask_b32 v29, v29, v101, vcc
    v_cvt_pk_bf16_f32 v63, v102, v103
    v_lshlrev_b32 v102, 16, v63
    v_and_b32 v103, 0xffff0000, v63
    v_mul_f32 v102, v62, v102
    v_mul_f32 v103, v62, v103
    v_cvt_pk_bf16_f32 v63, v102, v103
    v_lshlrev_b32 v102, 16, v63
    v_and_b32 v103, 0xffff0000, v63
    v_cndmask_b32 v30, v30, v102, vcc
    v_cndmask_b32 v31, v31, v103, vcc
    v_cvt_pk_bf16_f32 v63, v104, v105
    v_lshlrev_b32 v104, 16, v63
    v_and_b32 v105, 0xffff0000, v63
    v_mul_f32 v104, v62, v104
    v_mul_f32 v105, v62, v105
    v_cvt_pk_bf16_f32 v63, v104, v105
    v_lshlrev_b32 v104, 16, v63
    v_and_b32 v105, 0xffff0000, v63
    v_cndmask_b32 v32, v32, v104, vcc
    v_cndmask_b32 v33, v33, v105, vcc
    v_cvt_pk_bf16_f32 v63, v106, v107
    v_lshlrev_b32 v106, 16, v63
    v_and_b32 v107, 0xffff0000, v63
    v_mul_f32 v106, v62, v106
    v_mul_f32 v107, v62, v107
    v_cvt_pk_bf16_f32 v63, v106, v107
    v_lshlrev_b32 v106, 16, v63
    v_and_b32 v107, 0xffff0000, v63
    v_cndmask_b32 v34, v34, v106, vcc
    v_cndmask_b32 v35, v35, v107, vcc
    v_cvt_pk_bf16_f32 v63, v108, v109
    v_lshlrev_b32 v108, 16, v63
    v_and_b32 v109, 0xffff0000, v63
    v_mul_f32 v108, v62, v108
    v_mul_f32 v109, v62, v109
    v_cvt_pk_bf16_f32 v63, v108, v109
    v_lshlrev_b32 v108, 16, v63
    v_and_b32 v109, 0xffff0000, v63
    v_cndmask_b32 v36, v36, v108, vcc
    v_cndmask_b32 v37, v37, v109, vcc
    v_cvt_pk_bf16_f32 v63, v110, v111
    v_lshlrev_b32 v110, 16, v63
    v_and_b32 v111, 0xffff0000, v63
    v_mul_f32 v110, v62, v110
    v_mul_f32 v111, v62, v111
    v_cvt_pk_bf16_f32 v63, v110, v111
    v_lshlrev_b32 v110, 16, v63
    v_and_b32 v111, 0xffff0000, v63
    v_cndmask_b32 v38, v38, v110, vcc
    v_cndmask_b32 v39, v39, v111, vcc
L_recurrent_scan__compressed_kv_cla__moe_arch_mod__prompt_kernel_rt2_noy_1:
    s_sub_u32 s36, s57, s38
    s_cmp_lt_u32 s36, 16
    s_cbranch_scc0 L_recurrent_scan__compressed_kv_cla__moe_arch_mod__prompt_kernel_rt2_noy_2
    s_and_b32 s36, s59, 0xffff0000
    s_cmp_lt_i32 s36, 0
    s_cselect_b32 s37, 0x80000000, -1
    s_xor_b32 s36, s36, s37
    s_and_b32 s36, s36, 0xffff0000
    v_mov_b32 v62, s36
    v_mul_f32 v62, 0xbfb8aa3b, v62
    v_exp_f32 v62, v62
    s_nop 0
    v_add_f32 v62, 1.0, v62
    v_rcp_f32 v62, v62
    s_nop 0
    v_cvt_pk_bf16_f32 v62, v62, v62
    v_lshlrev_b32 v62, 16, v62
    v_add_f32_dpp v112, v112, v112 quad_perm:[1,0,3,2] row_mask:0xf bank_mask:0xf
    v_add_f32_dpp v113, v113, v113 quad_perm:[1,0,3,2] row_mask:0xf bank_mask:0xf
    v_add_f32_dpp v114, v114, v114 quad_perm:[1,0,3,2] row_mask:0xf bank_mask:0xf
    v_add_f32_dpp v115, v115, v115 quad_perm:[1,0,3,2] row_mask:0xf bank_mask:0xf
    v_add_f32_dpp v116, v116, v116 quad_perm:[1,0,3,2] row_mask:0xf bank_mask:0xf
    v_add_f32_dpp v117, v117, v117 quad_perm:[1,0,3,2] row_mask:0xf bank_mask:0xf
    v_add_f32_dpp v118, v118, v118 quad_perm:[1,0,3,2] row_mask:0xf bank_mask:0xf
    v_add_f32_dpp v119, v119, v119 quad_perm:[1,0,3,2] row_mask:0xf bank_mask:0xf
    v_add_f32_dpp v120, v120, v120 quad_perm:[1,0,3,2] row_mask:0xf bank_mask:0xf
    v_add_f32_dpp v121, v121, v121 quad_perm:[1,0,3,2] row_mask:0xf bank_mask:0xf
    v_add_f32_dpp v122, v122, v122 quad_perm:[1,0,3,2] row_mask:0xf bank_mask:0xf
    v_add_f32_dpp v123, v123, v123 quad_perm:[1,0,3,2] row_mask:0xf bank_mask:0xf
    v_add_f32_dpp v124, v124, v124 quad_perm:[1,0,3,2] row_mask:0xf bank_mask:0xf
    v_add_f32_dpp v125, v125, v125 quad_perm:[1,0,3,2] row_mask:0xf bank_mask:0xf
    v_add_f32_dpp v126, v126, v126 quad_perm:[1,0,3,2] row_mask:0xf bank_mask:0xf
    v_add_f32_dpp v127, v127, v127 quad_perm:[1,0,3,2] row_mask:0xf bank_mask:0xf
    v_add_f32_dpp v112, v112, v112 quad_perm:[2,3,0,1] row_mask:0xf bank_mask:0xf
    v_add_f32_dpp v113, v113, v113 quad_perm:[2,3,0,1] row_mask:0xf bank_mask:0xf
    v_add_f32_dpp v114, v114, v114 quad_perm:[2,3,0,1] row_mask:0xf bank_mask:0xf
    v_add_f32_dpp v115, v115, v115 quad_perm:[2,3,0,1] row_mask:0xf bank_mask:0xf
    v_add_f32_dpp v116, v116, v116 quad_perm:[2,3,0,1] row_mask:0xf bank_mask:0xf
    v_add_f32_dpp v117, v117, v117 quad_perm:[2,3,0,1] row_mask:0xf bank_mask:0xf
    v_add_f32_dpp v118, v118, v118 quad_perm:[2,3,0,1] row_mask:0xf bank_mask:0xf
    v_add_f32_dpp v119, v119, v119 quad_perm:[2,3,0,1] row_mask:0xf bank_mask:0xf
    v_add_f32_dpp v120, v120, v120 quad_perm:[2,3,0,1] row_mask:0xf bank_mask:0xf
    v_add_f32_dpp v121, v121, v121 quad_perm:[2,3,0,1] row_mask:0xf bank_mask:0xf
    v_add_f32_dpp v122, v122, v122 quad_perm:[2,3,0,1] row_mask:0xf bank_mask:0xf
    v_add_f32_dpp v123, v123, v123 quad_perm:[2,3,0,1] row_mask:0xf bank_mask:0xf
    v_add_f32_dpp v124, v124, v124 quad_perm:[2,3,0,1] row_mask:0xf bank_mask:0xf
    v_add_f32_dpp v125, v125, v125 quad_perm:[2,3,0,1] row_mask:0xf bank_mask:0xf
    v_add_f32_dpp v126, v126, v126 quad_perm:[2,3,0,1] row_mask:0xf bank_mask:0xf
    v_add_f32_dpp v127, v127, v127 quad_perm:[2,3,0,1] row_mask:0xf bank_mask:0xf
    v_add_f32_dpp v112, v112, v112 row_half_mirror row_mask:0xf bank_mask:0xf
    v_add_f32_dpp v113, v113, v113 row_half_mirror row_mask:0xf bank_mask:0xf
    v_add_f32_dpp v114, v114, v114 row_half_mirror row_mask:0xf bank_mask:0xf
    v_add_f32_dpp v115, v115, v115 row_half_mirror row_mask:0xf bank_mask:0xf
    v_add_f32_dpp v116, v116, v116 row_half_mirror row_mask:0xf bank_mask:0xf
    v_add_f32_dpp v117, v117, v117 row_half_mirror row_mask:0xf bank_mask:0xf
    v_add_f32_dpp v118, v118, v118 row_half_mirror row_mask:0xf bank_mask:0xf
    v_add_f32_dpp v119, v119, v119 row_half_mirror row_mask:0xf bank_mask:0xf
    v_add_f32_dpp v120, v120, v120 row_half_mirror row_mask:0xf bank_mask:0xf
    v_add_f32_dpp v121, v121, v121 row_half_mirror row_mask:0xf bank_mask:0xf
    v_add_f32_dpp v122, v122, v122 row_half_mirror row_mask:0xf bank_mask:0xf
    v_add_f32_dpp v123, v123, v123 row_half_mirror row_mask:0xf bank_mask:0xf
    v_add_f32_dpp v124, v124, v124 row_half_mirror row_mask:0xf bank_mask:0xf
    v_add_f32_dpp v125, v125, v125 row_half_mirror row_mask:0xf bank_mask:0xf
    v_add_f32_dpp v126, v126, v126 row_half_mirror row_mask:0xf bank_mask:0xf
    v_add_f32_dpp v127, v127, v127 row_half_mirror row_mask:0xf bank_mask:0xf
    v_add_f32_dpp v112, v112, v112 row_mirror row_mask:0xf bank_mask:0xf
    v_add_f32_dpp v113, v113, v113 row_mirror row_mask:0xf bank_mask:0xf
    v_add_f32_dpp v114, v114, v114 row_mirror row_mask:0xf bank_mask:0xf
    v_add_f32_dpp v115, v115, v115 row_mirror row_mask:0xf bank_mask:0xf
    v_add_f32_dpp v116, v116, v116 row_mirror row_mask:0xf bank_mask:0xf
    v_add_f32_dpp v117, v117, v117 row_mirror row_mask:0xf bank_mask:0xf
    v_add_f32_dpp v118, v118, v118 row_mirror row_mask:0xf bank_mask:0xf
    v_add_f32_dpp v119, v119, v119 row_mirror row_mask:0xf bank_mask:0xf
    v_add_f32_dpp v120, v120, v120 row_mirror row_mask:0xf bank_mask:0xf
    v_add_f32_dpp v121, v121, v121 row_mirror row_mask:0xf bank_mask:0xf
    v_add_f32_dpp v122, v122, v122 row_mirror row_mask:0xf bank_mask:0xf
    v_add_f32_dpp v123, v123, v123 row_mirror row_mask:0xf bank_mask:0xf
    v_add_f32_dpp v124, v124, v124 row_mirror row_mask:0xf bank_mask:0xf
    v_add_f32_dpp v125, v125, v125 row_mirror row_mask:0xf bank_mask:0xf
    v_add_f32_dpp v126, v126, v126 row_mirror row_mask:0xf bank_mask:0xf
    v_add_f32_dpp v127, v127, v127 row_mirror row_mask:0xf bank_mask:0xf
    v_cmp_eq_u32 vcc, s57, v14
    v_cvt_pk_bf16_f32 v63, v112, v113
    v_lshlrev_b32 v112, 16, v63
    v_and_b32 v113, 0xffff0000, v63
    v_mul_f32 v112, v62, v112
    v_mul_f32 v113, v62, v113
    v_cvt_pk_bf16_f32 v63, v112, v113
    v_lshlrev_b32 v112, 16, v63
    v_and_b32 v113, 0xffff0000, v63
    v_cndmask_b32 v24, v24, v112, vcc
    v_cndmask_b32 v25, v25, v113, vcc
    v_cvt_pk_bf16_f32 v63, v114, v115
    v_lshlrev_b32 v114, 16, v63
    v_and_b32 v115, 0xffff0000, v63
    v_mul_f32 v114, v62, v114
    v_mul_f32 v115, v62, v115
    v_cvt_pk_bf16_f32 v63, v114, v115
    v_lshlrev_b32 v114, 16, v63
    v_and_b32 v115, 0xffff0000, v63
    v_cndmask_b32 v26, v26, v114, vcc
    v_cndmask_b32 v27, v27, v115, vcc
    v_cvt_pk_bf16_f32 v63, v116, v117
    v_lshlrev_b32 v116, 16, v63
    v_and_b32 v117, 0xffff0000, v63
    v_mul_f32 v116, v62, v116
    v_mul_f32 v117, v62, v117
    v_cvt_pk_bf16_f32 v63, v116, v117
    v_lshlrev_b32 v116, 16, v63
    v_and_b32 v117, 0xffff0000, v63
    v_cndmask_b32 v28, v28, v116, vcc
    v_cndmask_b32 v29, v29, v117, vcc
    v_cvt_pk_bf16_f32 v63, v118, v119
    v_lshlrev_b32 v118, 16, v63
    v_and_b32 v119, 0xffff0000, v63
    v_mul_f32 v118, v62, v118
    v_mul_f32 v119, v62, v119
    v_cvt_pk_bf16_f32 v63, v118, v119
    v_lshlrev_b32 v118, 16, v63
    v_and_b32 v119, 0xffff0000, v63
    v_cndmask_b32 v30, v30, v118, vcc
    v_cndmask_b32 v31, v31, v119, vcc
    v_cvt_pk_bf16_f32 v63, v120, v121
    v_lshlrev_b32 v120, 16, v63
    v_and_b32 v121, 0xffff0000, v63
    v_mul_f32 v120, v62, v120
    v_mul_f32 v121, v62, v121
    v_cvt_pk_bf16_f32 v63, v120, v121
    v_lshlrev_b32 v120, 16, v63
    v_and_b32 v121, 0xffff0000, v63
    v_cndmask_b32 v32, v32, v120, vcc
    v_cndmask_b32 v33, v33, v121, vcc
    v_cvt_pk_bf16_f32 v63, v122, v123
    v_lshlrev_b32 v122, 16, v63
    v_and_b32 v123, 0xffff0000, v63
    v_mul_f32 v122, v62, v122
    v_mul_f32 v123, v62, v123
    v_cvt_pk_bf16_f32 v63, v122, v123
    v_lshlrev_b32 v122, 16, v63
    v_and_b32 v123, 0xffff0000, v63
    v_cndmask_b32 v34, v34, v122, vcc
    v_cndmask_b32 v35, v35, v123, vcc
    v_cvt_pk_bf16_f32 v63, v124, v125
    v_lshlrev_b32 v124, 16, v63
    v_and_b32 v125, 0xffff0000, v63
    v_mul_f32 v124, v62, v124
    v_mul_f32 v125, v62, v125
    v_cvt_pk_bf16_f32 v63, v124, v125
    v_lshlrev_b32 v124, 16, v63
    v_and_b32 v125, 0xffff0000, v63
    v_cndmask_b32 v36, v36, v124, vcc
    v_cndmask_b32 v37, v37, v125, vcc
    v_cvt_pk_bf16_f32 v63, v126, v127
    v_lshlrev_b32 v126, 16, v63
    v_and_b32 v127, 0xffff0000, v63
    v_mul_f32 v126, v62, v126
    v_mul_f32 v127, v62, v127
    v_cvt_pk_bf16_f32 v63, v126, v127
    v_lshlrev_b32 v126, 16, v63
    v_and_b32 v127, 0xffff0000, v63
    v_cndmask_b32 v38, v38, v126, vcc
    v_cndmask_b32 v39, v39, v127, vcc
L_recurrent_scan__compressed_kv_cla__moe_arch_mod__prompt_kernel_rt2_noy_2:
    s_branch L_recurrent_scan__compressed_kv_cla__moe_arch_mod__prompt_kernel_back_178
L_recurrent_scan__compressed_kv_cla__moe_arch_mod__prompt_kernel_rare_179:
    v_lshlrev_b32 v96, 16, v40
    v_and_b32 v97, 0xffff0000, v40
    v_sub_f32 v112, v96, v48
    v_sub_f32 v113, v97, v48
    v_cvt_pk_bf16_f32 v10, v112, v113
    v_lshlrev_b32 v112, 16, v10
    v_and_b32 v113, 0xffff0000, v10
    v_mul_f32 v112, v112, v49
    v_mul_f32 v113, v113, v49
    v_cvt_pk_bf16_f32 v10, v112, v113
    v_lshlrev_b32 v112, 16, v10
    v_and_b32 v113, 0xffff0000, v10
    v_add_f32 v112, v112, v24
    v_add_f32 v113, v113, v25
    v_cvt_pk_bf16_f32 v10, v112, v113
    v_lshlrev_b32 v112, 16, v10
    v_and_b32 v113, 0xffff0000, v10
    v_mul_f32 v11, 0xbfb8aa3b, v112
    v_mul_f32 v12, 0xbfb8aa3b, v113
    v_exp_f32 v11, v11
    v_exp_f32 v12, v12
    s_nop 0
    v_add_f32 v11, 1.0, v11
    v_add_f32 v12, 1.0, v12
    v_rcp_f32 v11, v11
    v_rcp_f32 v12, v12
    s_nop 0
    v_mul_f32 v112, v112, v11
    v_mul_f32 v113, v113, v12
    v_cvt_pk_bf16_f32 v10, v112, v113
    v_lshlrev_b32 v112, 16, v10
    v_and_b32 v113, 0xffff0000, v10
    v_lshlrev_b32 v98, 16, v41
    v_and_b32 v99, 0xffff0000, v41
    v_sub_f32 v114, v98, v48
    v_sub_f32 v115, v99, v48
    v_cvt_pk_bf16_f32 v10, v114, v115
    v_lshlrev_b32 v114, 16, v10
    v_and_b32 v115, 0xffff0000, v10
    v_mul_f32 v114, v114, v49
    v_mul_f32 v115, v115, v49
    v_cvt_pk_bf16_f32 v10, v114, v115
    v_lshlrev_b32 v114, 16, v10
    v_and_b32 v115, 0xffff0000, v10
    v_add_f32 v114, v114, v26
    v_add_f32 v115, v115, v27
    v_cvt_pk_bf16_f32 v10, v114, v115
    v_lshlrev_b32 v114, 16, v10
    v_and_b32 v115, 0xffff0000, v10
    v_mul_f32 v11, 0xbfb8aa3b, v114
    v_mul_f32 v12, 0xbfb8aa3b, v115
    v_exp_f32 v11, v11
    v_exp_f32 v12, v12
    s_nop 0
    v_add_f32 v11, 1.0, v11
    v_add_f32 v12, 1.0, v12
    v_rcp_f32 v11, v11
    v_rcp_f32 v12, v12
    s_nop 0
    v_mul_f32 v114, v114, v11
    v_mul_f32 v115, v115, v12
    v_cvt_pk_bf16_f32 v10, v114, v115
    v_lshlrev_b32 v114, 16, v10
    v_and_b32 v115, 0xffff0000, v10
    v_lshlrev_b32 v100, 16, v42
    v_and_b32 v101, 0xffff0000, v42
    v_sub_f32 v116, v100, v48
    v_sub_f32 v117, v101, v48
    v_cvt_pk_bf16_f32 v10, v116, v117
    v_lshlrev_b32 v116, 16, v10
    v_and_b32 v117, 0xffff0000, v10
    v_mul_f32 v116, v116, v49
    v_mul_f32 v117, v117, v49
    v_cvt_pk_bf16_f32 v10, v116, v117
    v_lshlrev_b32 v116, 16, v10
    v_and_b32 v117, 0xffff0000, v10
    v_add_f32 v116, v116, v28
    v_add_f32 v117, v117, v29
    v_cvt_pk_bf16_f32 v10, v116, v117
    v_lshlrev_b32 v116, 16, v10
    v_and_b32 v117, 0xffff0000, v10
    v_mul_f32 v11, 0xbfb8aa3b, v116
    v_mul_f32 v12, 0xbfb8aa3b, v117
    v_exp_f32 v11, v11
    v_exp_f32 v12, v12
    s_nop 0
    v_add_f32 v11, 1.0, v11
    v_add_f32 v12, 1.0, v12
    v_rcp_f32 v11, v11
    v_rcp_f32 v12, v12
    s_nop 0
    v_mul_f32 v116, v116, v11
    v_mul_f32 v117, v117, v12
    v_cvt_pk_bf16_f32 v10, v116, v117
    v_lshlrev_b32 v116, 16, v10
    v_and_b32 v117, 0xffff0000, v10
    v_lshlrev_b32 v102, 16, v43
    v_and_b32 v103, 0xffff0000, v43
    v_sub_f32 v118, v102, v48
    v_sub_f32 v119, v103, v48
    v_cvt_pk_bf16_f32 v10, v118, v119
    v_lshlrev_b32 v118, 16, v10
    v_and_b32 v119, 0xffff0000, v10
    v_mul_f32 v118, v118, v49
    v_mul_f32 v119, v119, v49
    v_cvt_pk_bf16_f32 v10, v118, v119
    v_lshlrev_b32 v118, 16, v10
    v_and_b32 v119, 0xffff0000, v10
    v_add_f32 v118, v118, v30
    v_add_f32 v119, v119, v31
    v_cvt_pk_bf16_f32 v10, v118, v119
    v_lshlrev_b32 v118, 16, v10
    v_and_b32 v119, 0xffff0000, v10
    v_mul_f32 v11, 0xbfb8aa3b, v118
    v_mul_f32 v12, 0xbfb8aa3b, v119
    v_exp_f32 v11, v11
    v_exp_f32 v12, v12
    s_nop 0
    v_add_f32 v11, 1.0, v11
    v_add_f32 v12, 1.0, v12
    v_rcp_f32 v11, v11
    v_rcp_f32 v12, v12
    s_nop 0
    v_mul_f32 v118, v118, v11
    v_mul_f32 v119, v119, v12
    v_cvt_pk_bf16_f32 v10, v118, v119
    v_lshlrev_b32 v118, 16, v10
    v_and_b32 v119, 0xffff0000, v10
    v_lshlrev_b32 v104, 16, v44
    v_and_b32 v105, 0xffff0000, v44
    v_sub_f32 v120, v104, v48
    v_sub_f32 v121, v105, v48
    v_cvt_pk_bf16_f32 v10, v120, v121
    v_lshlrev_b32 v120, 16, v10
    v_and_b32 v121, 0xffff0000, v10
    v_mul_f32 v120, v120, v49
    v_mul_f32 v121, v121, v49
    v_cvt_pk_bf16_f32 v10, v120, v121
    v_lshlrev_b32 v120, 16, v10
    v_and_b32 v121, 0xffff0000, v10
    v_add_f32 v120, v120, v32
    v_add_f32 v121, v121, v33
    v_cvt_pk_bf16_f32 v10, v120, v121
    v_lshlrev_b32 v120, 16, v10
    v_and_b32 v121, 0xffff0000, v10
    v_mul_f32 v11, 0xbfb8aa3b, v120
    v_mul_f32 v12, 0xbfb8aa3b, v121
    v_exp_f32 v11, v11
    v_exp_f32 v12, v12
    s_nop 0
    v_add_f32 v11, 1.0, v11
    v_add_f32 v12, 1.0, v12
    v_rcp_f32 v11, v11
    v_rcp_f32 v12, v12
    s_nop 0
    v_mul_f32 v120, v120, v11
    v_mul_f32 v121, v121, v12
    v_cvt_pk_bf16_f32 v10, v120, v121
    v_lshlrev_b32 v120, 16, v10
    v_and_b32 v121, 0xffff0000, v10
    v_lshlrev_b32 v106, 16, v45
    v_and_b32 v107, 0xffff0000, v45
    v_sub_f32 v122, v106, v48
    v_sub_f32 v123, v107, v48
    v_cvt_pk_bf16_f32 v10, v122, v123
    v_lshlrev_b32 v122, 16, v10
    v_and_b32 v123, 0xffff0000, v10
    v_mul_f32 v122, v122, v49
    v_mul_f32 v123, v123, v49
    v_cvt_pk_bf16_f32 v10, v122, v123
    v_lshlrev_b32 v122, 16, v10
    v_and_b32 v123, 0xffff0000, v10
    v_add_f32 v122, v122, v34
    v_add_f32 v123, v123, v35
    v_cvt_pk_bf16_f32 v10, v122, v123
    v_lshlrev_b32 v122, 16, v10
    v_and_b32 v123, 0xffff0000, v10
    v_mul_f32 v11, 0xbfb8aa3b, v122
    v_mul_f32 v12, 0xbfb8aa3b, v123
    v_exp_f32 v11, v11
    v_exp_f32 v12, v12
    s_nop 0
    v_add_f32 v11, 1.0, v11
    v_add_f32 v12, 1.0, v12
    v_rcp_f32 v11, v11
    v_rcp_f32 v12, v12
    s_nop 0
    v_mul_f32 v122, v122, v11
    v_mul_f32 v123, v123, v12
    v_cvt_pk_bf16_f32 v10, v122, v123
    v_lshlrev_b32 v122, 16, v10
    v_and_b32 v123, 0xffff0000, v10
    v_lshlrev_b32 v108, 16, v46
    v_and_b32 v109, 0xffff0000, v46
    v_sub_f32 v124, v108, v48
    v_sub_f32 v125, v109, v48
    v_cvt_pk_bf16_f32 v10, v124, v125
    v_lshlrev_b32 v124, 16, v10
    v_and_b32 v125, 0xffff0000, v10
    v_mul_f32 v124, v124, v49
    v_mul_f32 v125, v125, v49
    v_cvt_pk_bf16_f32 v10, v124, v125
    v_lshlrev_b32 v124, 16, v10
    v_and_b32 v125, 0xffff0000, v10
    v_add_f32 v124, v124, v36
    v_add_f32 v125, v125, v37
    v_cvt_pk_bf16_f32 v10, v124, v125
    v_lshlrev_b32 v124, 16, v10
    v_and_b32 v125, 0xffff0000, v10
    v_mul_f32 v11, 0xbfb8aa3b, v124
    v_mul_f32 v12, 0xbfb8aa3b, v125
    v_exp_f32 v11, v11
    v_exp_f32 v12, v12
    s_nop 0
    v_add_f32 v11, 1.0, v11
    v_add_f32 v12, 1.0, v12
    v_rcp_f32 v11, v11
    v_rcp_f32 v12, v12
    s_nop 0
    v_mul_f32 v124, v124, v11
    v_mul_f32 v125, v125, v12
    v_cvt_pk_bf16_f32 v10, v124, v125
    v_lshlrev_b32 v124, 16, v10
    v_and_b32 v125, 0xffff0000, v10
    v_lshlrev_b32 v110, 16, v47
    v_and_b32 v111, 0xffff0000, v47
    v_sub_f32 v126, v110, v48
    v_sub_f32 v127, v111, v48
    v_cvt_pk_bf16_f32 v10, v126, v127
    v_lshlrev_b32 v126, 16, v10
    v_and_b32 v127, 0xffff0000, v10
    v_mul_f32 v126, v126, v49
    v_mul_f32 v127, v127, v49
    v_cvt_pk_bf16_f32 v10, v126, v127
    v_lshlrev_b32 v126, 16, v10
    v_and_b32 v127, 0xffff0000, v10
    v_add_f32 v126, v126, v38
    v_add_f32 v127, v127, v39
    v_cvt_pk_bf16_f32 v10, v126, v127
    v_lshlrev_b32 v126, 16, v10
    v_and_b32 v127, 0xffff0000, v10
    v_mul_f32 v11, 0xbfb8aa3b, v126
    v_mul_f32 v12, 0xbfb8aa3b, v127
    v_exp_f32 v11, v11
    v_exp_f32 v12, v12
    s_nop 0
    v_add_f32 v11, 1.0, v11
    v_add_f32 v12, 1.0, v12
    v_rcp_f32 v11, v11
    v_rcp_f32 v12, v12
    s_nop 0
    v_mul_f32 v126, v126, v11
    v_mul_f32 v127, v127, v12
    v_cvt_pk_bf16_f32 v10, v126, v127
    v_lshlrev_b32 v126, 16, v10
    v_and_b32 v127, 0xffff0000, v10
    s_branch L_recurrent_scan__compressed_kv_cla__moe_arch_mod__prompt_kernel_back_180
L_recurrent_scan__compressed_kv_cla__moe_arch_mod__prompt_kernel_rare_183:
    s_mov_b32 s61, 0x40000
L_recurrent_scan__compressed_kv_cla__moe_arch_mod__prompt_kernel_spin_181:
    s_sub_u32 s61, s61, 1
    s_cbranch_scc1 L_recurrent_scan__compressed_kv_cla__moe_arch_mod__prompt_kernel_spinx_182
    s_sleep 1
    global_load_dword v23, v5, s[90:91] sc1
    s_waitcnt vmcnt(0)
    v_readfirstlane_b32 s36, v23
    s_nop 0
    s_cmp_lt_u32 s36, 8
    s_cbranch_scc1 L_recurrent_scan__compressed_kv_cla__moe_arch_mod__prompt_kernel_spin_181
L_recurrent_scan__compressed_kv_cla__moe_arch_mod__prompt_kernel_spinx_182:
    s_branch L_recurrent_scan__compressed_kv_cla__moe_arch_mod__prompt_kernel_back_184
L_end:
    s_endpgm
.section .rodata,"a"
.p2align 6
.amdhsa_kernel recurrent_scan__compressed_kv_cla__moe_arch_mod__prompt_kernel
  .amdhsa_next_free_vgpr 256
  .amdhsa_next_free_sgpr 102
  .amdhsa_accum_offset 256
  .amdhsa_group_segment_fixed_size 0
  .amdhsa_kernarg_size 112
  .amdhsa_user_sgpr_count 2
  .amdhsa_user_sgpr_kernarg_segment_ptr 1
  .amdhsa_system_sgpr_workgroup_id_x 1
.end_amdhsa_kernel
```

```asm
; @launch kernel=recurrent_scan__compressed_kv_cla__moe_arch_mod__prompt_kernel grid=(256,1,1) block=(512,1,1) lds=163840
.amdgcn_target "amdgcn-amd-amdhsa--gfx950"
.text
.globl recurrent_scan__compressed_kv_cla__moe_arch_mod__prompt_kernel
.p2align 8
.type recurrent_scan__compressed_kv_cla__moe_arch_mod__prompt_kernel,@function
recurrent_scan__compressed_kv_cla__moe_arch_mod__prompt_kernel:
    s_cmp_ge_u32 s2, 256
    s_cbranch_scc1 L_end
    s_load_dwordx4 s[44:47], s[0:1], 0
    s_load_dwordx2 s[52:53], s[0:1], 56
    s_load_dwordx4 s[48:51], s[0:1], 24
    s_getpc_b64 s[36:37]
L_pc:
    s_lshr_b32 s38, s2, 3
    s_lshl_b32 s38, s38, 7
    v_lshl_add_u32 v16, v0, 12, s38
    v_cmp_gt_u32 vcc, L_end-L_pc-4, v16
    v_mov_b32 v17, s37
    s_and_b64 exec, exec, vcc
    s_cbranch_execz L_nocpf
    v_add_co_u32 v16, vcc, s36, v16
    s_nop 1
    v_addc_co_u32 v17, vcc, 0, v17, vcc
    global_load_dword v119, v[16:17], off
L_nocpf:
    s_mov_b64 exec, -1
    v_lshrrev_b32 v16, 6, v0
    v_and_b32 v1, 63, v0
    v_readfirstlane_b32 s28, v16
    v_lshlrev_b32 v116, 4, v1
    s_lshl_b32 s42, s2, 3
    s_cmp_lt_u32 s28, 4
    s_cbranch_scc1 L_nox
    s_add_u32 s43, s42, s28
    s_sub_u32 s42, s43, 4
    v_lshl_add_u32 v18, s42, 11, v116
    v_add_u32 v19, 8192, v18
    s_waitcnt lgkmcnt(0)
    global_load_dwordx4 v[20:23], v18, s[44:45]
    global_load_dwordx4 v[24:27], v18, s[44:45] offset:1024
    global_load_dwordx4 v[28:31], v19, s[44:45]
    global_load_dwordx4 v[32:35], v19, s[44:45] offset:1024
    global_load_dwordx4 v[36:39], v116, s[52:53]
    global_load_dwordx4 v[40:43], v116, s[52:53] offset:1024
    s_barrier
L_nox:
    s_load_dwordx4 s[88:91], s[0:1], 96
    s_load_dwordx4 s[92:95], s[0:1], 64
    s_load_dwordx2 s[96:97], s[0:1], 16
    s_and_b32 s29, s2, 7
    s_lshl_b32 s29, s29, 2
    s_bfe_u32 s36, s2, 0x20003
    s_add_u32 s29, s29, s36
    s_lshr_b32 s30, s2, 5
    v_lshrrev_b32 v16, 3, v1
    s_lshl_b32 s36, s30, 8
    s_lshl_b32 s37, s28, 5
    s_add_u32 s36, s36, s37
    v_add_u32 v16, s36, v16
    v_lshlrev_b32 v16, 10, v16
    v_lshrrev_b32 v18, 4, v1
    v_and_b32 v19, 7, v1
    v_xor_b32 v19, v19, v18
    v_lshl_add_u32 v2, v19, 4, v16
    v_xor_b32 v19, 4, v19
    v_lshl_add_u32 v3, v19, 4, v16
    v_add_u32 v3, 7168, v3
    v_add_u32 v4, 14336, v2
    v_add_u32 v5, 14336, v3
    s_and_b32 s36, s28, 3
    s_lshl_b32 s37, s36, 4
    v_add_u32 v16, s37, v18
    v_lshlrev_b32 v16, 13, v16
    s_lshl_b32 s37, s29, 8
    v_add_u32 v16, s37, v16
    v_and_b32 v19, 15, v1
    v_lshlrev_b32 v18, 1, v18
    v_xor_b32 v19, v19, v18
    v_lshl_add_u32 v6, v19, 4, v16
    v_add_u32 v7, 31744, v6
    v_xor_b32 v19, 8, v19
    v_lshl_add_u32 v8, v19, 4, v16
    v_add_u32 v8, 63488, v8
    v_add_u32 v9, 31744, v8
    s_lshl_b32 s33, s28, 12
    s_add_u32 s34, s33, 65536
    s_mov_b32 s31, 0
    s_mov_b32 s32, 0
    s_mov_b32 s40, 128
    s_mov_b32 s41, 524288
    s_waitcnt lgkmcnt(0)
    s_mov_b32 s4, s46
    s_and_b32 s5, s47, 0xffff
    s_mov_b32 s6, 2097152
    s_mov_b32 s7, 0x20000
    s_mov_b32 s8, s48
    s_and_b32 s9, s49, 0xffff
    s_mov_b32 s10, 4194304
    s_mov_b32 s11, 0x20000
    s_mov_b32 s20, s50
    s_and_b32 s21, s51, 0xffff
    s_mov_b32 s22, 4194304
    s_mov_b32 s23, 0x20000
    s_cmp_lt_u32 s28, 4
    s_cbranch_scc0 L_pro_s
    s_barrier
    s_cmp_eq_u32 s2, 0
    s_cbranch_scc1 L_recurrent_scan__compressed_kv_cla__moe_arch_mod__prompt_kernel_rare_1
L_recurrent_scan__compressed_kv_cla__moe_arch_mod__prompt_kernel_back_2:
    s_add_u32 m0, s33, 0
    s_add_u32 s36, s31, 131072
    buffer_load_dwordx4 v2, s[4:7], s31 offen offset:0 lds
    buffer_load_dwordx4 v3, s[4:7], s31 offen offset:1024 lds
    buffer_load_dwordx4 v4, s[4:7], s31 offen offset:2048 lds
    buffer_load_dwordx4 v5, s[4:7], s31 offen offset:3072 lds
    s_add_u32 m0, s34, 0
    s_nop 0
    buffer_load_dwordx4 v6, s[8:11], s32 offen offset:0 nt lds
    buffer_load_dwordx4 v7, s[8:11], s32 offen offset:1024 nt lds
    buffer_load_dwordx4 v8, s[8:11], s32 offen offset:2048 nt lds
    buffer_load_dwordx4 v9, s[8:11], s32 offen offset:3072 nt lds
    s_add_u32 m0, s33, 16384
    s_nop 0
    buffer_load_dwordx4 v2, s[4:7], s36 offen offset:0 lds
    buffer_load_dwordx4 v3, s[4:7], s36 offen offset:1024 lds
    buffer_load_dwordx4 v4, s[4:7], s36 offen offset:2048 lds
    buffer_load_dwordx4 v5, s[4:7], s36 offen offset:3072 lds
    s_add_u32 m0, s34, 16384
    s_nop 0
    buffer_load_dwordx4 v6, s[20:23], s32 offen offset:0 nt lds
    buffer_load_dwordx4 v7, s[20:23], s32 offen offset:1024 nt lds
    buffer_load_dwordx4 v8, s[20:23], s32 offen offset:2048 nt lds
    buffer_load_dwordx4 v9, s[20:23], s32 offen offset:3072 nt lds
    s_add_u32 s31, s31, s40
    s_add_u32 s32, s32, s41
L_pro_s:
    s_add_u32 s54, s90, 0
    s_addc_u32 s55, s91, 0
    s_add_u32 s12, s54, 8388608
    s_addc_u32 s13, s55, 0
    s_and_b32 s13, s13, 0xffff
    s_mov_b32 s14, 33554432
    s_mov_b32 s15, 0x20000
    s_mov_b32 s24, s54
    s_and_b32 s25, s55, 0xffff
    s_mov_b32 s26, 83886080
    s_mov_b32 s27, 0x20000
    s_add_u32 s90, s54, 61865984
    s_addc_u32 s91, s55, 0
    v_and_b32 v16, 15, v1
    v_lshrrev_b32 v17, 4, v1
    s_bfe_u32 s36, s28, 0x10001
    s_lshl_b32 s36, s36, 14
    v_lshl_add_u32 v18, v16, 7, s36
    v_lshrrev_b32 v19, 1, v16
    v_xor_b32 v19, v19, v17
    v_lshl_add_u32 v10, v19, 4, v18
    v_xor_b32 v19, 4, v19
    v_lshl_add_u32 v11, v19, 4, v18
    v_lshrrev_b32 v16, 2, v16
    v_lshl_add_u32 v18, v17, 3, v16
    v_lshlrev_b32 v18, 8, v18
    s_lshr_b32 s36, s28, 2
    s_lshl_b32 s36, s36, 14
    s_add_u32 s36, s36, 65536
    v_add_u32 v18, s36, v18
    v_and_b32 v19, 3, v1
    v_lshl_add_u32 v18, v19, 3, v18
    v_and_b32 v17, 1, v17
    v_lshl_add_u32 v16, v17, 2, v16
    s_and_b32 s36, s28, 1
    s_lshl_b32 s36, s36, 2
    s_add_u32 s37, s36, 0
    v_xor_b32 v19, s37, v16
    v_lshl_add_u32 v12, v19, 5, v18
    s_add_u32 s37, s36, 1
    v_xor_b32 v19, s37, v16
    v_lshl_add_u32 v13, v19, 5, v18
    s_add_u32 s37, s36, 2
    v_xor_b32 v19, s37, v16
    v_lshl_add_u32 v14, v19, 5, v18
    s_add_u32 s37, s36, 3
    v_xor_b32 v19, s37, v16
    v_lshl_add_u32 v15, v19, 5, v18
    v_mov_b64 v[128:129], 0
    v_mov_b64 v[130:131], 0
    v_mov_b64 v[132:133], 0
    v_mov_b64 v[134:135], 0
    v_mov_b64 v[136:137], 0
    v_mov_b64 v[138:139], 0
    v_mov_b64 v[140:141], 0
    v_mov_b64 v[142:143], 0
    v_mov_b64 v[144:145], 0
    v_mov_b64 v[146:147], 0
    v_mov_b64 v[148:149], 0
    v_mov_b64 v[150:151], 0
    v_mov_b64 v[152:153], 0
    v_mov_b64 v[154:155], 0
    v_mov_b64 v[156:157], 0
    v_mov_b64 v[158:159], 0
    v_mov_b64 v[160:161], 0
    v_mov_b64 v[162:163], 0
    v_mov_b64 v[164:165], 0
    v_mov_b64 v[166:167], 0
    v_mov_b64 v[168:169], 0
    v_mov_b64 v[170:171], 0
    v_mov_b64 v[172:173], 0
    v_mov_b64 v[174:175], 0
    v_mov_b64 v[176:177], 0
    v_mov_b64 v[178:179], 0
    v_mov_b64 v[180:181], 0
    v_mov_b64 v[182:183], 0
    v_mov_b64 v[184:185], 0
    v_mov_b64 v[186:187], 0
    v_mov_b64 v[188:189], 0
    v_mov_b64 v[190:191], 0
    v_mov_b64 v[192:193], 0
    v_mov_b64 v[194:195], 0
    v_mov_b64 v[196:197], 0
    v_mov_b64 v[198:199], 0
    v_mov_b64 v[200:201], 0
    v_mov_b64 v[202:203], 0
    v_mov_b64 v[204:205], 0
    v_mov_b64 v[206:207], 0
    v_mov_b64 v[208:209], 0
    v_mov_b64 v[210:211], 0
    v_mov_b64 v[212:213], 0
    v_mov_b64 v[214:215], 0
    v_mov_b64 v[216:217], 0
    v_mov_b64 v[218:219], 0
    v_mov_b64 v[220:221], 0
    v_mov_b64 v[222:223], 0
    v_mov_b64 v[224:225], 0
    v_mov_b64 v[226:227], 0
    v_mov_b64 v[228:229], 0
    v_mov_b64 v[230:231], 0
    v_mov_b64 v[232:233], 0
    v_mov_b64 v[234:235], 0
    v_mov_b64 v[236:237], 0
    v_mov_b64 v[238:239], 0
    v_mov_b64 v[240:241], 0
    v_mov_b64 v[242:243], 0
    v_mov_b64 v[244:245], 0
    v_mov_b64 v[246:247], 0
    v_mov_b64 v[248:249], 0
    v_mov_b64 v[250:251], 0
    v_mov_b64 v[252:253], 0
    v_mov_b64 v[254:255], 0
    v_mov_b32 v118, 0
    v_mov_b32 v117, 0
    s_lshl_b32 s36, s30, 7
    s_lshl_b32 s37, s28, 4
    s_add_u32 s36, s36, s37
    v_bfe_u32 v17, v1, 1, 4
    v_add_u32 v17, s36, v17
    v_lshlrev_b32 v17, 13, v17
    v_and_b32 v19, 1, v1
    v_lshl_add_u32 v17, v19, 7, v17
    s_lshl_b32 s36, s29, 8
    v_add_u32 v17, s36, v17
    s_mov_b32 s45, 32768
    s_cmp_lt_u32 s28, 4
    s_cbranch_scc0 L_pro_b
    s_add_u32 m0, s33, 32768
    s_add_u32 s36, s31, 131072
    buffer_load_dwordx4 v2, s[4:7], s31 offen offset:0 lds
    buffer_load_dwordx4 v3, s[4:7], s31 offen offset:1024 lds
    buffer_load_dwordx4 v4, s[4:7], s31 offen offset:2048 lds
    buffer_load_dwordx4 v5, s[4:7], s31 offen offset:3072 lds
    s_add_u32 m0, s34, 32768
    s_nop 0
    buffer_load_dwordx4 v6, s[8:11], s32 offen offset:0 nt lds
    buffer_load_dwordx4 v7, s[8:11], s32 offen offset:1024 nt lds
    buffer_load_dwordx4 v8, s[8:11], s32 offen offset:2048 nt lds
    buffer_load_dwordx4 v9, s[8:11], s32 offen offset:3072 nt lds
    s_add_u32 m0, s33, 49152
    s_nop 0
    buffer_load_dwordx4 v2, s[4:7], s36 offen offset:0 lds
    buffer_load_dwordx4 v3, s[4:7], s36 offen offset:1024 lds
    buffer_load_dwordx4 v4, s[4:7], s36 offen offset:2048 lds
    buffer_load_dwordx4 v5, s[4:7], s36 offen offset:3072 lds
    s_add_u32 m0, s34, 49152
    s_nop 0
    buffer_load_dwordx4 v6, s[20:23], s32 offen offset:0 nt lds
    buffer_load_dwordx4 v7, s[20:23], s32 offen offset:1024 nt lds
    buffer_load_dwordx4 v8, s[20:23], s32 offen offset:2048 nt lds
    buffer_load_dwordx4 v9, s[20:23], s32 offen offset:3072 nt lds
    s_add_u32 s31, s31, s40
    s_add_u32 s32, s32, s41
    s_waitcnt vmcnt(16)
    s_branch L_pro_j
L_pro_b:
    s_mov_b64 s[8:9], s[20:21]
    s_mov_b32 s31, 256
    s_mov_b32 s32, 1048576
    s_and_b32 s60, s28, 3
    s_waitcnt vmcnt(0)
    s_mov_b32 s3, 0
L_ln:
    v_lshlrev_b32 v44, 16, v36
    v_and_b32 v45, 0xffff0000, v36
    v_lshlrev_b32 v46, 16, v37
    v_and_b32 v47, 0xffff0000, v37
    v_lshlrev_b32 v48, 16, v38
    v_and_b32 v49, 0xffff0000, v38
    v_lshlrev_b32 v50, 16, v39
    v_and_b32 v51, 0xffff0000, v39
    v_lshlrev_b32 v52, 16, v40
    v_and_b32 v53, 0xffff0000, v40
    v_lshlrev_b32 v54, 16, v41
    v_and_b32 v55, 0xffff0000, v41
    v_lshlrev_b32 v56, 16, v42
    v_and_b32 v57, 0xffff0000, v42
    v_lshlrev_b32 v58, 16, v43
    v_and_b32 v59, 0xffff0000, v43
    v_lshlrev_b32 v60, 16, v20
    v_lshlrev_b32 v76, 16, v28
    v_and_b32 v61, 0xffff0000, v20
    v_and_b32 v77, 0xffff0000, v28
    v_lshlrev_b32 v62, 16, v21
    v_lshlrev_b32 v78, 16, v29
    v_and_b32 v63, 0xffff0000, v21
    v_and_b32 v79, 0xffff0000, v29
    v_lshlrev_b32 v64, 16, v22
    v_lshlrev_b32 v80, 16, v30
    v_and_b32 v65, 0xffff0000, v22
    v_and_b32 v81, 0xffff0000, v30
    v_lshlrev_b32 v66, 16, v23
    v_lshlrev_b32 v82, 16, v31
    v_and_b32 v67, 0xffff0000, v23
    v_and_b32 v83, 0xffff0000, v31
    v_lshlrev_b32 v68, 16, v24
    v_lshlrev_b32 v84, 16, v32
    v_and_b32 v69, 0xffff0000, v24
    v_and_b32 v85, 0xffff0000, v32
    v_lshlrev_b32 v70, 16, v25
    v_lshlrev_b32 v86, 16, v33
    v_and_b32 v71, 0xffff0000, v25
    v_and_b32 v87, 0xffff0000, v33
    v_lshlrev_b32 v72, 16, v26
    v_lshlrev_b32 v88, 16, v34
    v_and_b32 v73, 0xffff0000, v26
    v_and_b32 v89, 0xffff0000, v34
    v_lshlrev_b32 v74, 16, v27
    v_lshlrev_b32 v90, 16, v35
    v_and_b32 v75, 0xffff0000, v27
    v_and_b32 v91, 0xffff0000, v35
    v_pk_add_f32 v[92:93], v[60:61], v[62:63]
    v_pk_add_f32 v[100:101], v[76:77], v[78:79]
    v_pk_add_f32 v[92:93], v[92:93], v[64:65]
    v_pk_add_f32 v[100:101], v[100:101], v[80:81]
    v_pk_add_f32 v[92:93], v[92:93], v[66:67]
    v_pk_add_f32 v[100:101], v[100:101], v[82:83]
    v_pk_add_f32 v[92:93], v[92:93], v[68:69]
    v_pk_add_f32 v[100:101], v[100:101], v[84:85]
    v_pk_add_f32 v[92:93], v[92:93], v[70:71]
    v_pk_add_f32 v[100:101], v[100:101], v[86:87]
    v_pk_add_f32 v[92:93], v[92:93], v[72:73]
    v_pk_add_f32 v[100:101], v[100:101], v[88:89]
    v_pk_add_f32 v[92:93], v[92:93], v[74:75]
    v_pk_add_f32 v[100:101], v[100:101], v[90:91]
    v_add_f32 v92, v92, v93
    v_add_f32 v100, v100, v101
    s_nop 0
    v_add_f32_dpp v92, v92, v92 quad_perm:[1,0,3,2] row_mask:0xf bank_mask:0xf
    v_add_f32_dpp v100, v100, v100 quad_perm:[1,0,3,2] row_mask:0xf bank_mask:0xf
    s_nop 0
    v_add_f32_dpp v92, v92, v92 quad_perm:[2,3,0,1] row_mask:0xf bank_mask:0xf
    v_add_f32_dpp v100, v100, v100 quad_perm:[2,3,0,1] row_mask:0xf bank_mask:0xf
    s_nop 0
    v_add_f32_dpp v92, v92, v92 row_half_mirror row_mask:0xf bank_mask:0xf
    v_add_f32_dpp v100, v100, v100 row_half_mirror row_mask:0xf bank_mask:0xf
    s_nop 0
    v_add_f32_dpp v92, v92, v92 row_mirror row_mask:0xf bank_mask:0xf
    v_add_f32_dpp v100, v100, v100 row_mirror row_mask:0xf bank_mask:0xf
    v_readlane_b32 s36, v92, 0
    v_readlane_b32 s56, v100, 0
    v_readlane_b32 s37, v92, 16
    v_readlane_b32 s57, v100, 16
    v_readlane_b32 s38, v92, 32
    v_readlane_b32 s58, v100, 32
    v_readlane_b32 s39, v92, 48
    v_readlane_b32 s59, v100, 48
    v_mov_b32 v96, s36
    v_mov_b32 v104, s56
    v_add_f32 v96, s37, v96
    v_add_f32 v104, s57, v104
    v_add_f32 v96, s38, v96
    v_add_f32 v104, s58, v104
    v_add_f32 v96, s39, v96
    v_add_f32 v104, s59, v104
    v_mul_f32 v96, 0xba800000, v96
    v_mul_f32 v104, 0xba800000, v104
    v_mov_b32 v97, v96
    v_mov_b32 v105, v104
    v_pk_add_f32 v[94:95], v[60:61], v[96:97]
    v_pk_add_f32 v[102:103], v[76:77], v[104:105]
    v_pk_mul_f32 v[92:93], v[94:95], v[94:95]
    v_pk_mul_f32 v[100:101], v[102:103], v[102:103]
    v_pk_add_f32 v[94:95], v[62:63], v[96:97]
    v_pk_add_f32 v[102:103], v[78:79], v[104:105]
    v_pk_fma_f32 v[92:93], v[94:95], v[94:95], v[92:93]
    v_pk_fma_f32 v[100:101], v[102:103], v[102:103], v[100:101]
    v_pk_add_f32 v[94:95], v[64:65], v[96:97]
    v_pk_add_f32 v[102:103], v[80:81], v[104:105]
    v_pk_fma_f32 v[92:93], v[94:95], v[94:95], v[92:93]
    v_pk_fma_f32 v[100:101], v[102:103], v[102:103], v[100:101]
    v_pk_add_f32 v[94:95], v[66:67], v[96:97]
    v_pk_add_f32 v[102:103], v[82:83], v[104:105]
    v_pk_fma_f32 v[92:93], v[94:95], v[94:95], v[92:93]
    v_pk_fma_f32 v[100:101], v[102:103], v[102:103], v[100:101]
    v_pk_add_f32 v[94:95], v[68:69], v[96:97]
    v_pk_add_f32 v[102:103], v[84:85], v[104:105]
    v_pk_fma_f32 v[92:93], v[94:95], v[94:95], v[92:93]
    v_pk_fma_f32 v[100:101], v[102:103], v[102:103], v[100:101]
    v_pk_add_f32 v[94:95], v[70:71], v[96:97]
    v_pk_add_f32 v[102:103], v[86:87], v[104:105]
    v_pk_fma_f32 v[92:93], v[94:95], v[94:95], v[92:93]
    v_pk_fma_f32 v[100:101], v[102:103], v[102:103], v[100:101]
    v_pk_add_f32 v[94:95], v[72:73], v[96:97]
    v_pk_add_f32 v[102:103], v[88:89], v[104:105]
    v_pk_fma_f32 v[92:93], v[94:95], v[94:95], v[92:93]
    v_pk_fma_f32 v[100:101], v[102:103], v[102:103], v[100:101]
    v_pk_add_f32 v[94:95], v[74:75], v[96:97]
    v_pk_add_f32 v[102:103], v[90:91], v[104:105]
    v_pk_fma_f32 v[92:93], v[94:95], v[94:95], v[92:93]
    v_pk_fma_f32 v[100:101], v[102:103], v[102:103], v[100:101]
    v_add_f32 v92, v92, v93
    v_add_f32 v100, v100, v101
    s_nop 0
    v_add_f32_dpp v92, v92, v92 quad_perm:[1,0,3,2] row_mask:0xf bank_mask:0xf
    v_add_f32_dpp v100, v100, v100 quad_perm:[1,0,3,2] row_mask:0xf bank_mask:0xf
    s_nop 0
    v_add_f32_dpp v92, v92, v92 quad_perm:[2,3,0,1] row_mask:0xf bank_mask:0xf
    v_add_f32_dpp v100, v100, v100 quad_perm:[2,3,0,1] row_mask:0xf bank_mask:0xf
    s_nop 0
    v_add_f32_dpp v92, v92, v92 row_half_mirror row_mask:0xf bank_mask:0xf
    v_add_f32_dpp v100, v100, v100 row_half_mirror row_mask:0xf bank_mask:0xf
    s_nop 0
    v_add_f32_dpp v92, v92, v92 row_mirror row_mask:0xf bank_mask:0xf
    v_add_f32_dpp v100, v100, v100 row_mirror row_mask:0xf bank_mask:0xf
    v_readlane_b32 s36, v92, 0
    v_readlane_b32 s56, v100, 0
    v_readlane_b32 s37, v92, 16
    v_readlane_b32 s57, v100, 16
    v_readlane_b32 s38, v92, 32
    v_readlane_b32 s58, v100, 32
    v_readlane_b32 s39, v92, 48
    v_readlane_b32 s59, v100, 48
    v_mov_b32 v94, s36
    v_mov_b32 v102, s56
    v_add_f32 v94, s37, v94
    v_add_f32 v102, s57, v102
    v_add_f32 v94, s38, v94
    v_add_f32 v102, s58, v102
    v_add_f32 v94, s39, v94
    v_add_f32 v102, s59, v102
    v_mul_f32 v94, 0x3a800000, v94
    v_mul_f32 v102, 0x3a800000, v102
    v_cvt_pk_bf16_f32 v95, v96, v94
    v_cvt_pk_bf16_f32 v103, v104, v102
    v_lshlrev_b32 v96, 16, v95
    v_lshlrev_b32 v104, 16, v103
    v_and_b32 v94, 0xffff0000, v95
    v_and_b32 v102, 0xffff0000, v103
    v_add_f32 v94, 0x3727c5ac, v94
    v_add_f32 v102, 0x3727c5ac, v102
    v_cvt_pk_bf16_f32 v94, v94, v94
    v_cvt_pk_bf16_f32 v102, v102, v102
    v_lshlrev_b32 v94, 16, v94
    v_lshlrev_b32 v102, 16, v102
    v_sqrt_f32 v94, v94
    v_sqrt_f32 v102, v102
    v_mov_b32 v97, v96
    v_mov_b32 v105, v104
    v_cvt_pk_bf16_f32 v94, v94, v94
    v_cvt_pk_bf16_f32 v102, v102, v102
    v_lshlrev_b32 v94, 16, v94
    v_lshlrev_b32 v102, 16, v102
    v_rcp_f32 v99, v94
    v_rcp_f32 v107, v102
    v_fma_f32 v95, -v94, v99, 1.0
    v_fma_f32 v103, -v102, v107, 1.0
    v_fma_f32 v99, v95, v99, v99
    v_fma_f32 v107, v103, v107, v107
    v_mov_b32 v98, v99
    v_mov_b32 v106, v107
    v_pk_add_f32 v[60:61], v[60:61], v[96:97]
    v_pk_add_f32 v[76:77], v[76:77], v[104:105]
    v_cvt_pk_bf16_f32 v94, v60, v61
    v_cvt_pk_bf16_f32 v102, v76, v77
    v_lshlrev_b32 v60, 16, v94
    v_lshlrev_b32 v76, 16, v102
    v_and_b32 v61, 0xffff0000, v94
    v_and_b32 v77, 0xffff0000, v102
    v_pk_mul_f32 v[60:61], v[60:61], v[98:99]
    v_pk_mul_f32 v[76:77], v[76:77], v[106:107]
    v_cvt_pk_bf16_f32 v108, v60, v61
    v_cvt_pk_bf16_f32 v120, v76, v77
    v_lshlrev_b32 v60, 16, v108
    v_lshlrev_b32 v76, 16, v120
    v_and_b32 v61, 0xffff0000, v108
    v_and_b32 v77, 0xffff0000, v120
    v_pk_mul_f32 v[92:93], v[60:61], v[44:45]
    v_pk_mul_f32 v[100:101], v[76:77], v[44:45]
    v_pk_add_f32 v[62:63], v[62:63], v[96:97]
    v_pk_add_f32 v[78:79], v[78:79], v[104:105]
    v_cvt_pk_bf16_f32 v94, v62, v63
    v_cvt_pk_bf16_f32 v102, v78, v79
    v_lshlrev_b32 v62, 16, v94
    v_lshlrev_b32 v78, 16, v102
    v_and_b32 v63, 0xffff0000, v94
    v_and_b32 v79, 0xffff0000, v102
    v_pk_mul_f32 v[62:63], v[62:63], v[98:99]
    v_pk_mul_f32 v[78:79], v[78:79], v[106:107]
    v_cvt_pk_bf16_f32 v109, v62, v63
    v_cvt_pk_bf16_f32 v121, v78, v79
    v_lshlrev_b32 v62, 16, v109
    v_lshlrev_b32 v78, 16, v121
    v_and_b32 v63, 0xffff0000, v109
    v_and_b32 v79, 0xffff0000, v121
    v_pk_fma_f32 v[92:93], v[62:63], v[46:47], v[92:93]
    v_pk_fma_f32 v[100:101], v[78:79], v[46:47], v[100:101]
    v_pk_add_f32 v[64:65], v[64:65], v[96:97]
    v_pk_add_f32 v[80:81], v[80:81], v[104:105]
    v_cvt_pk_bf16_f32 v94, v64, v65
    v_cvt_pk_bf16_f32 v102, v80, v81
    v_lshlrev_b32 v64, 16, v94
    v_lshlrev_b32 v80, 16, v102
    v_and_b32 v65, 0xffff0000, v94
    v_and_b32 v81, 0xffff0000, v102
    v_pk_mul_f32 v[64:65], v[64:65], v[98:99]
    v_pk_mul_f32 v[80:81], v[80:81], v[106:107]
    v_cvt_pk_bf16_f32 v110, v64, v65
    v_cvt_pk_bf16_f32 v122, v80, v81
    v_lshlrev_b32 v64, 16, v110
    v_lshlrev_b32 v80, 16, v122
    v_and_b32 v65, 0xffff0000, v110
    v_and_b32 v81, 0xffff0000, v122
    v_pk_fma_f32 v[92:93], v[64:65], v[48:49], v[92:93]
    v_pk_fma_f32 v[100:101], v[80:81], v[48:49], v[100:101]
    v_pk_add_f32 v[66:67], v[66:67], v[96:97]
    v_pk_add_f32 v[82:83], v[82:83], v[104:105]
    v_cvt_pk_bf16_f32 v94, v66, v67
    v_cvt_pk_bf16_f32 v102, v82, v83
    v_lshlrev_b32 v66, 16, v94
    v_lshlrev_b32 v82, 16, v102
    v_and_b32 v67, 0xffff0000, v94
    v_and_b32 v83, 0xffff0000, v102
    v_pk_mul_f32 v[66:67], v[66:67], v[98:99]
    v_pk_mul_f32 v[82:83], v[82:83], v[106:107]
    v_cvt_pk_bf16_f32 v111, v66, v67
    v_cvt_pk_bf16_f32 v123, v82, v83
    v_lshlrev_b32 v66, 16, v111
    v_lshlrev_b32 v82, 16, v123
    v_and_b32 v67, 0xffff0000, v111
    v_and_b32 v83, 0xffff0000, v123
    v_pk_fma_f32 v[92:93], v[66:67], v[50:51], v[92:93]
    v_pk_fma_f32 v[100:101], v[82:83], v[50:51], v[100:101]
    v_pk_add_f32 v[68:69], v[68:69], v[96:97]
    v_pk_add_f32 v[84:85], v[84:85], v[104:105]
    v_cvt_pk_bf16_f32 v94, v68, v69
    v_cvt_pk_bf16_f32 v102, v84, v85
    v_lshlrev_b32 v68, 16, v94
    v_lshlrev_b32 v84, 16, v102
    v_and_b32 v69, 0xffff0000, v94
    v_and_b32 v85, 0xffff0000, v102
    v_pk_mul_f32 v[68:69], v[68:69], v[98:99]
    v_pk_mul_f32 v[84:85], v[84:85], v[106:107]
    v_cvt_pk_bf16_f32 v112, v68, v69
    v_cvt_pk_bf16_f32 v124, v84, v85
    v_lshlrev_b32 v68, 16, v112
    v_lshlrev_b32 v84, 16, v124
    v_and_b32 v69, 0xffff0000, v112
    v_and_b32 v85, 0xffff0000, v124
    v_pk_fma_f32 v[92:93], v[68:69], v[52:53], v[92:93]
    v_pk_fma_f32 v[100:101], v[84:85], v[52:53], v[100:101]
    v_pk_add_f32 v[70:71], v[70:71], v[96:97]
    v_pk_add_f32 v[86:87], v[86:87], v[104:105]
    v_cvt_pk_bf16_f32 v94, v70, v71
    v_cvt_pk_bf16_f32 v102, v86, v87
    v_lshlrev_b32 v70, 16, v94
    v_lshlrev_b32 v86, 16, v102
    v_and_b32 v71, 0xffff0000, v94
    v_and_b32 v87, 0xffff0000, v102
    v_pk_mul_f32 v[70:71], v[70:71], v[98:99]
    v_pk_mul_f32 v[86:87], v[86:87], v[106:107]
    v_cvt_pk_bf16_f32 v113, v70, v71
    v_cvt_pk_bf16_f32 v125, v86, v87
    v_lshlrev_b32 v70, 16, v113
    v_lshlrev_b32 v86, 16, v125
    v_and_b32 v71, 0xffff0000, v113
    v_and_b32 v87, 0xffff0000, v125
    v_pk_fma_f32 v[92:93], v[70:71], v[54:55], v[92:93]
    v_pk_fma_f32 v[100:101], v[86:87], v[54:55], v[100:101]
    v_pk_add_f32 v[72:73], v[72:73], v[96:97]
    v_pk_add_f32 v[88:89], v[88:89], v[104:105]
    v_cvt_pk_bf16_f32 v94, v72, v73
    v_cvt_pk_bf16_f32 v102, v88, v89
    v_lshlrev_b32 v72, 16, v94
    v_lshlrev_b32 v88, 16, v102
    v_and_b32 v73, 0xffff0000, v94
    v_and_b32 v89, 0xffff0000, v102
    v_pk_mul_f32 v[72:73], v[72:73], v[98:99]
    v_pk_mul_f32 v[88:89], v[88:89], v[106:107]
    v_cvt_pk_bf16_f32 v114, v72, v73
    v_cvt_pk_bf16_f32 v126, v88, v89
    v_lshlrev_b32 v72, 16, v114
    v_lshlrev_b32 v88, 16, v126
    v_and_b32 v73, 0xffff0000, v114
    v_and_b32 v89, 0xffff0000, v126
    v_pk_fma_f32 v[92:93], v[72:73], v[56:57], v[92:93]
    v_pk_fma_f32 v[100:101], v[88:89], v[56:57], v[100:101]
    v_pk_add_f32 v[74:75], v[74:75], v[96:97]
    v_pk_add_f32 v[90:91], v[90:91], v[104:105]
    v_cvt_pk_bf16_f32 v94, v74, v75
    v_cvt_pk_bf16_f32 v102, v90, v91
    v_lshlrev_b32 v74, 16, v94
    v_lshlrev_b32 v90, 16, v102
    v_and_b32 v75, 0xffff0000, v94
    v_and_b32 v91, 0xffff0000, v102
    v_pk_mul_f32 v[74:75], v[74:75], v[98:99]
    v_pk_mul_f32 v[90:91], v[90:91], v[106:107]
    v_cvt_pk_bf16_f32 v115, v74, v75
    v_cvt_pk_bf16_f32 v127, v90, v91
    v_lshlrev_b32 v74, 16, v115
    v_lshlrev_b32 v90, 16, v127
    v_and_b32 v75, 0xffff0000, v115
    v_and_b32 v91, 0xffff0000, v127
    v_pk_fma_f32 v[92:93], v[74:75], v[58:59], v[92:93]
    v_pk_fma_f32 v[100:101], v[90:91], v[58:59], v[100:101]
    v_add_f32 v92, v92, v93
    v_add_f32 v100, v100, v101
    v_xor_b32 v98, 0x80000000, v96
    v_xor_b32 v106, 0x80000000, v104
    s_mul_i32 s36, s60, 2064
    s_mul_i32 s56, s28, 2064
    s_add_u32 s36, s36, 131072
    s_add_u32 s56, s56, 131072
    v_lshl_add_u32 v95, v1, 4, s36
    v_lshl_add_u32 v103, v1, 4, s56
    ds_write_b128 v95, v[108:111]
    ds_write_b128 v103, v[120:123]
    ds_write_b128 v95, v[112:115] offset:1024
    ds_write_b128 v103, v[124:127] offset:1024
    s_nop 0
    v_add_f32_dpp v92, v92, v92 quad_perm:[1,0,3,2] row_mask:0xf bank_mask:0xf
    v_add_f32_dpp v100, v100, v100 quad_perm:[1,0,3,2] row_mask:0xf bank_mask:0xf
    s_nop 0
    v_add_f32_dpp v92, v92, v92 quad_perm:[2,3,0,1] row_mask:0xf bank_mask:0xf
    v_add_f32_dpp v100, v100, v100 quad_perm:[2,3,0,1] row_mask:0xf bank_mask:0xf
    s_nop 0
    v_add_f32_dpp v92, v92, v92 row_half_mirror row_mask:0xf bank_mask:0xf
    v_add_f32_dpp v100, v100, v100 row_half_mirror row_mask:0xf bank_mask:0xf
    s_nop 0
    v_add_f32_dpp v92, v92, v92 row_mirror row_mask:0xf bank_mask:0xf
    v_add_f32_dpp v100, v100, v100 row_mirror row_mask:0xf bank_mask:0xf
    v_readlane_b32 s36, v92, 0
    v_readlane_b32 s56, v100, 0
    v_readlane_b32 s37, v92, 16
    v_readlane_b32 s57, v100, 16
    v_readlane_b32 s38, v92, 32
    v_readlane_b32 s58, v100, 32
    v_readlane_b32 s39, v92, 48
    v_readlane_b32 s59, v100, 48
    v_mov_b32 v93, s36
    v_mov_b32 v101, s56
    v_add_f32 v93, s37, v93
    v_add_f32 v101, s57, v101
    v_add_f32 v93, s38, v93
    v_add_f32 v101, s58, v101
    v_add_f32 v93, s39, v93
    v_add_f32 v101, s59, v101
    v_cvt_pk_bf16_f32 v93, v93, v93
    v_cvt_pk_bf16_f32 v101, v101, v101
    v_lshlrev_b32 v93, 16, v93
    v_lshlrev_b32 v101, 16, v101
    v_ashrrev_i32 v95, 31, v93
    v_ashrrev_i32 v103, 31, v101
    v_or_b32 v95, 0x80000000, v95
    v_or_b32 v103, 0x80000000, v103
    v_xor_b32 v95, v93, v95
    v_xor_b32 v103, v101, v103
    v_and_b32 v95, 0xffff0000, v95
    v_and_b32 v103, 0xffff0000, v103
    s_sub_u32 s36, 0xffff, s42
    s_sub_u32 s56, 0xffff, s43
    v_or_b32 v95, s36, v95
    v_or_b32 v103, s56, v103
    s_lshl_b32 s37, s60, 3
    s_lshl_b32 s57, s28, 3
    s_add_u32 s37, s37, 147712
    s_add_u32 s57, s57, 147712
    v_mov_b32 v94, s37
    v_mov_b32 v102, s57
    ds_write_b64 v94, v[98:99]
    ds_write_b64 v102, v[106:107]
    ds_write_b32 v94, v95 offset:64
    ds_write_b32 v102, v103 offset:64
    s_waitcnt vmcnt(0) lgkmcnt(0)
    s_cmp_eq_u32 s3, 0
    s_mov_b32 s3, 0
    s_cbranch_scc0 L_ln
L_pro_j:
    s_barrier
    ds_read_b128 v[20:23], v10 offset:0
    ds_read_b64_tr_b16 v[52:53], v12 offset:0
    ds_read_b64_tr_b16 v[54:55], v12 offset:1024
    ds_read_b64_tr_b16 v[56:57], v13 offset:0
    ds_read_b64_tr_b16 v[58:59], v13 offset:1024
    ds_read_b64_tr_b16 v[60:61], v14 offset:0
    ds_read_b64_tr_b16 v[62:63], v14 offset:1024
    ds_read_b64_tr_b16 v[64:65], v15 offset:0
    ds_read_b64_tr_b16 v[66:67], v15 offset:1024
    ds_read_b128 v[24:27], v10 offset:2048
    ds_read_b128 v[28:31], v10 offset:4096
    ds_read_b128 v[32:35], v10 offset:6144
    ds_read_b128 v[36:39], v10 offset:8192
    ds_read_b128 v[40:43], v10 offset:10240
    ds_read_b128 v[44:47], v10 offset:12288
    ds_read_b128 v[48:51], v10 offset:14336
    s_add_u32 s36, s2, s28
    s_cmp_eq_u32 s36, 0
    s_cbranch_scc1 L_recurrent_scan__compressed_kv_cla__moe_arch_mod__prompt_kernel_rare_3
L_recurrent_scan__compressed_kv_cla__moe_arch_mod__prompt_kernel_back_4:
    s_mov_b32 s35, 0
    s_cmp_eq_u32 s28, 0
    s_cselect_b32 s43, 9, 0
    s_cselect_b32 s44, 2, 1
    s_cmp_lt_u32 s28, 4
    s_cbranch_scc0 L_kv_vloop
    .p2align 6
L_kv_kloop:
    s_waitcnt lgkmcnt(0)
    v_mfma_f32_16x16x32_bf16 v[128:131], v[52:55], v[20:23], v[128:131]
    ds_read_b128 v[68:71], v11 offset:0
    v_mfma_f32_16x16x32_bf16 v[132:135], v[56:59], v[20:23], v[132:135]
    ds_read_b64_tr_b16 v[100:101], v12 offset:8192
    v_mfma_f32_16x16x32_bf16 v[136:139], v[60:63], v[20:23], v[136:139]
    ds_read_b64_tr_b16 v[102:103], v12 offset:9216
    v_mfma_f32_16x16x32_bf16 v[140:143], v[64:67], v[20:23], v[140:143]
    ds_read_b64_tr_b16 v[104:105], v13 offset:8192
    v_mfma_f32_16x16x32_bf16 v[144:147], v[52:55], v[24:27], v[144:147]
    ds_read_b64_tr_b16 v[106:107], v13 offset:9216
    v_mfma_f32_16x16x32_bf16 v[148:151], v[56:59], v[24:27], v[148:151]
    ds_read_b64_tr_b16 v[108:109], v14 offset:8192
    v_mfma_f32_16x16x32_bf16 v[152:155], v[60:63], v[24:27], v[152:155]
    ds_read_b64_tr_b16 v[110:111], v14 offset:9216
    v_mfma_f32_16x16x32_bf16 v[156:159], v[64:67], v[24:27], v[156:159]
    ds_read_b64_tr_b16 v[112:113], v15 offset:8192
    v_mfma_f32_16x16x32_bf16 v[160:163], v[52:55], v[28:31], v[160:163]
    ds_read_b64_tr_b16 v[114:115], v15 offset:9216
    v_mfma_f32_16x16x32_bf16 v[164:167], v[56:59], v[28:31], v[164:167]
    ds_read_b128 v[72:75], v11 offset:2048
    v_mfma_f32_16x16x32_bf16 v[168:171], v[60:63], v[28:31], v[168:171]
    ds_read_b128 v[76:79], v11 offset:4096
    v_mfma_f32_16x16x32_bf16 v[172:175], v[64:67], v[28:31], v[172:175]
    ds_read_b128 v[80:83], v11 offset:6144
    v_mfma_f32_16x16x32_bf16 v[176:179], v[52:55], v[32:35], v[176:179]
    ds_read_b128 v[84:87], v11 offset:8192
    v_mfma_f32_16x16x32_bf16 v[180:183], v[56:59], v[32:35], v[180:183]
    ds_read_b128 v[88:91], v11 offset:10240
    v_mfma_f32_16x16x32_bf16 v[184:187], v[60:63], v[32:35], v[184:187]
    ds_read_b128 v[92:95], v11 offset:12288
    v_mfma_f32_16x16x32_bf16 v[188:191], v[64:67], v[32:35], v[188:191]
    ds_read_b128 v[96:99], v11 offset:14336
    v_mfma_f32_16x16x32_bf16 v[192:195], v[52:55], v[36:39], v[192:195]
    v_mfma_f32_16x16x32_bf16 v[196:199], v[56:59], v[36:39], v[196:199]
    v_mfma_f32_16x16x32_bf16 v[200:203], v[60:63], v[36:39], v[200:203]
    v_mfma_f32_16x16x32_bf16 v[204:207], v[64:67], v[36:39], v[204:207]
    v_mfma_f32_16x16x32_bf16 v[208:211], v[52:55], v[40:43], v[208:211]
    v_mfma_f32_16x16x32_bf16 v[212:215], v[56:59], v[40:43], v[212:215]
    v_mfma_f32_16x16x32_bf16 v[216:219], v[60:63], v[40:43], v[216:219]
    v_mfma_f32_16x16x32_bf16 v[220:223], v[64:67], v[40:43], v[220:223]
    v_mfma_f32_16x16x32_bf16 v[224:227], v[52:55], v[44:47], v[224:227]
    v_mfma_f32_16x16x32_bf16 v[228:231], v[56:59], v[44:47], v[228:231]
    v_mfma_f32_16x16x32_bf16 v[232:235], v[60:63], v[44:47], v[232:235]
    v_mfma_f32_16x16x32_bf16 v[236:239], v[64:67], v[44:47], v[236:239]
    v_mfma_f32_16x16x32_bf16 v[240:243], v[52:55], v[48:51], v[240:243]
    v_mfma_f32_16x16x32_bf16 v[244:247], v[56:59], v[48:51], v[244:247]
    v_mfma_f32_16x16x32_bf16 v[248:251], v[60:63], v[48:51], v[248:251]
    v_mfma_f32_16x16x32_bf16 v[252:255], v[64:67], v[48:51], v[252:255]
    s_cmp_eq_u32 s35, 3
    s_cbranch_scc1 L_recurrent_scan__compressed_kv_cla__moe_arch_mod__prompt_kernel_rare_5
L_recurrent_scan__compressed_kv_cla__moe_arch_mod__prompt_kernel_back_6:
    s_cmp_lt_u32 s35, s44
    s_cbranch_scc1 L_recurrent_scan__compressed_kv_cla__moe_arch_mod__prompt_kernel_w0_7
    s_waitcnt vmcnt(1)
L_recurrent_scan__compressed_kv_cla__moe_arch_mod__prompt_kernel_w0b_8:
    s_waitcnt lgkmcnt(0)
    s_barrier
    v_mfma_f32_16x16x32_bf16 v[128:131], v[100:103], v[68:71], v[128:131]
    ds_read_b128 v[20:23], v10 offset:32768
    s_add_u32 m0, s33, 0
    v_mfma_f32_16x16x32_bf16 v[132:135], v[104:107], v[68:71], v[132:135]
    ds_read_b64_tr_b16 v[52:53], v12 offset:32768
    buffer_load_dwordx4 v2, s[4:7], s31 offen offset:0 lds
    v_mfma_f32_16x16x32_bf16 v[136:139], v[108:111], v[68:71], v[136:139]
    ds_read_b64_tr_b16 v[54:55], v12 offset:33792
    v_mfma_f32_16x16x32_bf16 v[140:143], v[112:115], v[68:71], v[140:143]
    ds_read_b64_tr_b16 v[56:57], v13 offset:32768
    v_mfma_f32_16x16x32_bf16 v[144:147], v[100:103], v[72:75], v[144:147]
    ds_read_b64_tr_b16 v[58:59], v13 offset:33792
    buffer_load_dwordx4 v3, s[4:7], s31 offen offset:1024 lds
    v_mfma_f32_16x16x32_bf16 v[148:151], v[104:107], v[72:75], v[148:151]
    ds_read_b64_tr_b16 v[60:61], v14 offset:32768
    v_mfma_f32_16x16x32_bf16 v[152:155], v[108:111], v[72:75], v[152:155]
    ds_read_b64_tr_b16 v[62:63], v14 offset:33792
    v_mfma_f32_16x16x32_bf16 v[156:159], v[112:115], v[72:75], v[156:159]
    ds_read_b64_tr_b16 v[64:65], v15 offset:32768
    buffer_load_dwordx4 v4, s[4:7], s31 offen offset:2048 lds
    v_mfma_f32_16x16x32_bf16 v[160:163], v[100:103], v[76:79], v[160:163]
    ds_read_b64_tr_b16 v[66:67], v15 offset:33792
    v_mfma_f32_16x16x32_bf16 v[164:167], v[104:107], v[76:79], v[164:167]
    ds_read_b128 v[24:27], v10 offset:34816
    v_mfma_f32_16x16x32_bf16 v[168:171], v[108:111], v[76:79], v[168:171]
    ds_read_b128 v[28:31], v10 offset:36864
    buffer_load_dwordx4 v5, s[4:7], s31 offen offset:3072 lds
    v_mfma_f32_16x16x32_bf16 v[172:175], v[112:115], v[76:79], v[172:175]
    ds_read_b128 v[32:35], v10 offset:38912
    v_mfma_f32_16x16x32_bf16 v[176:179], v[100:103], v[80:83], v[176:179]
    ds_read_b128 v[36:39], v10 offset:40960
    s_add_u32 m0, s34, 0
    v_mfma_f32_16x16x32_bf16 v[180:183], v[104:107], v[80:83], v[180:183]
    ds_read_b128 v[40:43], v10 offset:43008
    buffer_load_dwordx4 v6, s[8:11], s32 offen offset:0 nt lds
    v_mfma_f32_16x16x32_bf16 v[184:187], v[108:111], v[80:83], v[184:187]
    ds_read_b128 v[44:47], v10 offset:45056
    v_mfma_f32_16x16x32_bf16 v[188:191], v[112:115], v[80:83], v[188:191]
    ds_read_b128 v[48:51], v10 offset:47104
    v_mfma_f32_16x16x32_bf16 v[192:195], v[100:103], v[84:87], v[192:195]
    buffer_load_dwordx4 v7, s[8:11], s32 offen offset:1024 nt lds
    v_mfma_f32_16x16x32_bf16 v[196:199], v[104:107], v[84:87], v[196:199]
    v_mfma_f32_16x16x32_bf16 v[200:203], v[108:111], v[84:87], v[200:203]
    v_mfma_f32_16x16x32_bf16 v[204:207], v[112:115], v[84:87], v[204:207]
    buffer_load_dwordx4 v8, s[8:11], s32 offen offset:2048 nt lds
    v_mfma_f32_16x16x32_bf16 v[208:211], v[100:103], v[88:91], v[208:211]
    v_mfma_f32_16x16x32_bf16 v[212:215], v[104:107], v[88:91], v[212:215]
    v_mfma_f32_16x16x32_bf16 v[216:219], v[108:111], v[88:91], v[216:219]
    buffer_load_dwordx4 v9, s[8:11], s32 offen offset:3072 nt lds
    v_mfma_f32_16x16x32_bf16 v[220:223], v[112:115], v[88:91], v[220:223]
    v_mfma_f32_16x16x32_bf16 v[224:227], v[100:103], v[92:95], v[224:227]
    v_mfma_f32_16x16x32_bf16 v[228:231], v[104:107], v[92:95], v[228:231]
    v_mfma_f32_16x16x32_bf16 v[232:235], v[108:111], v[92:95], v[232:235]
    v_mfma_f32_16x16x32_bf16 v[236:239], v[112:115], v[92:95], v[236:239]
    v_mfma_f32_16x16x32_bf16 v[240:243], v[100:103], v[96:99], v[240:243]
    v_mfma_f32_16x16x32_bf16 v[244:247], v[104:107], v[96:99], v[244:247]
    v_mfma_f32_16x16x32_bf16 v[248:251], v[108:111], v[96:99], v[248:251]
    v_mfma_f32_16x16x32_bf16 v[252:255], v[112:115], v[96:99], v[252:255]
    s_bitcmp1_b32 3, s35
    s_cselect_b32 exec_lo, 255, 1
    s_mov_b32 exec_hi, 0
    global_load_dword v0, v17, s[96:97]
    s_mov_b64 exec, -1
    s_cselect_b32 s36, s45, 0
    v_add_u32 v17, s36, v17
    v_min_u32 v17, 8388480, v17
    s_nop 1
    s_add_u32 s31, s31, s40
    s_add_u32 s32, s32, s41
    s_waitcnt lgkmcnt(0)
    v_mfma_f32_16x16x32_bf16 v[128:131], v[52:55], v[20:23], v[128:131]
    ds_read_b128 v[68:71], v11 offset:32768
    v_mfma_f32_16x16x32_bf16 v[132:135], v[56:59], v[20:23], v[132:135]
    ds_read_b64_tr_b16 v[100:101], v12 offset:40960
    v_mfma_f32_16x16x32_bf16 v[136:139], v[60:63], v[20:23], v[136:139]
    ds_read_b64_tr_b16 v[102:103], v12 offset:41984
    v_mfma_f32_16x16x32_bf16 v[140:143], v[64:67], v[20:23], v[140:143]
    ds_read_b64_tr_b16 v[104:105], v13 offset:40960
    v_mfma_f32_16x16x32_bf16 v[144:147], v[52:55], v[24:27], v[144:147]
    ds_read_b64_tr_b16 v[106:107], v13 offset:41984
    v_mfma_f32_16x16x32_bf16 v[148:151], v[56:59], v[24:27], v[148:151]
    ds_read_b64_tr_b16 v[108:109], v14 offset:40960
    v_mfma_f32_16x16x32_bf16 v[152:155], v[60:63], v[24:27], v[152:155]
    ds_read_b64_tr_b16 v[110:111], v14 offset:41984
    v_mfma_f32_16x16x32_bf16 v[156:159], v[64:67], v[24:27], v[156:159]
    ds_read_b64_tr_b16 v[112:113], v15 offset:40960
    v_mfma_f32_16x16x32_bf16 v[160:163], v[52:55], v[28:31], v[160:163]
    ds_read_b64_tr_b16 v[114:115], v15 offset:41984
    v_mfma_f32_16x16x32_bf16 v[164:167], v[56:59], v[28:31], v[164:167]
    ds_read_b128 v[72:75], v11 offset:34816
    v_mfma_f32_16x16x32_bf16 v[168:171], v[60:63], v[28:31], v[168:171]
    ds_read_b128 v[76:79], v11 offset:36864
    v_mfma_f32_16x16x32_bf16 v[172:175], v[64:67], v[28:31], v[172:175]
    ds_read_b128 v[80:83], v11 offset:38912
    v_mfma_f32_16x16x32_bf16 v[176:179], v[52:55], v[32:35], v[176:179]
    ds_read_b128 v[84:87], v11 offset:40960
    v_mfma_f32_16x16x32_bf16 v[180:183], v[56:59], v[32:35], v[180:183]
    ds_read_b128 v[88:91], v11 offset:43008
    v_mfma_f32_16x16x32_bf16 v[184:187], v[60:63], v[32:35], v[184:187]
    ds_read_b128 v[92:95], v11 offset:45056
    v_mfma_f32_16x16x32_bf16 v[188:191], v[64:67], v[32:35], v[188:191]
    ds_read_b128 v[96:99], v11 offset:47104
    v_mfma_f32_16x16x32_bf16 v[192:195], v[52:55], v[36:39], v[192:195]
    v_mfma_f32_16x16x32_bf16 v[196:199], v[56:59], v[36:39], v[196:199]
    v_mfma_f32_16x16x32_bf16 v[200:203], v[60:63], v[36:39], v[200:203]
    v_mfma_f32_16x16x32_bf16 v[204:207], v[64:67], v[36:39], v[204:207]
    v_mfma_f32_16x16x32_bf16 v[208:211], v[52:55], v[40:43], v[208:211]
    s_bitcmp1_b32 s43, s35
    s_cbranch_scc1 L_recurrent_scan__compressed_kv_cla__moe_arch_mod__prompt_kernel_rare_13
L_recurrent_scan__compressed_kv_cla__moe_arch_mod__prompt_kernel_back_14:
    v_mfma_f32_16x16x32_bf16 v[212:215], v[56:59], v[40:43], v[212:215]
    v_mfma_f32_16x16x32_bf16 v[216:219], v[60:63], v[40:43], v[216:219]
    v_mfma_f32_16x16x32_bf16 v[220:223], v[64:67], v[40:43], v[220:223]
    v_mfma_f32_16x16x32_bf16 v[224:227], v[52:55], v[44:47], v[224:227]
    v_mfma_f32_16x16x32_bf16 v[228:231], v[56:59], v[44:47], v[228:231]
    v_mfma_f32_16x16x32_bf16 v[232:235], v[60:63], v[44:47], v[232:235]
    v_mfma_f32_16x16x32_bf16 v[236:239], v[64:67], v[44:47], v[236:239]
    v_mfma_f32_16x16x32_bf16 v[240:243], v[52:55], v[48:51], v[240:243]
    v_mfma_f32_16x16x32_bf16 v[244:247], v[56:59], v[48:51], v[244:247]
    v_mfma_f32_16x16x32_bf16 v[248:251], v[60:63], v[48:51], v[248:251]
    v_mfma_f32_16x16x32_bf16 v[252:255], v[64:67], v[48:51], v[252:255]
    s_bitcmp1_b32 s43, s35
    s_cbranch_scc1 L_recurrent_scan__compressed_kv_cla__moe_arch_mod__prompt_kernel_w0_15
    s_waitcnt vmcnt(1)
L_recurrent_scan__compressed_kv_cla__moe_arch_mod__prompt_kernel_w0b_16:
    s_waitcnt lgkmcnt(0)
    s_cmp_eq_u32 s35, 3
    s_barrier
    s_cbranch_scc1 L_p1_fin0
    v_mfma_f32_16x16x32_bf16 v[128:131], v[100:103], v[68:71], v[128:131]
    ds_read_b128 v[20:23], v10 offset:0
    s_add_u32 m0, s33, 32768
    v_mfma_f32_16x16x32_bf16 v[132:135], v[104:107], v[68:71], v[132:135]
    ds_read_b64_tr_b16 v[52:53], v12 offset:0
    buffer_load_dwordx4 v2, s[4:7], s31 offen offset:0 lds
    v_mfma_f32_16x16x32_bf16 v[136:139], v[108:111], v[68:71], v[136:139]
    ds_read_b64_tr_b16 v[54:55], v12 offset:1024
    v_mfma_f32_16x16x32_bf16 v[140:143], v[112:115], v[68:71], v[140:143]
    ds_read_b64_tr_b16 v[56:57], v13 offset:0
    v_mfma_f32_16x16x32_bf16 v[144:147], v[100:103], v[72:75], v[144:147]
    ds_read_b64_tr_b16 v[58:59], v13 offset:1024
    buffer_load_dwordx4 v3, s[4:7], s31 offen offset:1024 lds
    v_mfma_f32_16x16x32_bf16 v[148:151], v[104:107], v[72:75], v[148:151]
    ds_read_b64_tr_b16 v[60:61], v14 offset:0
    v_mfma_f32_16x16x32_bf16 v[152:155], v[108:111], v[72:75], v[152:155]
    ds_read_b64_tr_b16 v[62:63], v14 offset:1024
    v_mfma_f32_16x16x32_bf16 v[156:159], v[112:115], v[72:75], v[156:159]
    ds_read_b64_tr_b16 v[64:65], v15 offset:0
    buffer_load_dwordx4 v4, s[4:7], s31 offen offset:2048 lds
    v_mfma_f32_16x16x32_bf16 v[160:163], v[100:103], v[76:79], v[160:163]
    ds_read_b64_tr_b16 v[66:67], v15 offset:1024
    v_mfma_f32_16x16x32_bf16 v[164:167], v[104:107], v[76:79], v[164:167]
    ds_read_b128 v[24:27], v10 offset:2048
    v_mfma_f32_16x16x32_bf16 v[168:171], v[108:111], v[76:79], v[168:171]
    ds_read_b128 v[28:31], v10 offset:4096
    buffer_load_dwordx4 v5, s[4:7], s31 offen offset:3072 lds
    v_mfma_f32_16x16x32_bf16 v[172:175], v[112:115], v[76:79], v[172:175]
    ds_read_b128 v[32:35], v10 offset:6144
    v_mfma_f32_16x16x32_bf16 v[176:179], v[100:103], v[80:83], v[176:179]
    ds_read_b128 v[36:39], v10 offset:8192
    s_add_u32 m0, s34, 32768
    v_mfma_f32_16x16x32_bf16 v[180:183], v[104:107], v[80:83], v[180:183]
    ds_read_b128 v[40:43], v10 offset:10240
    buffer_load_dwordx4 v6, s[8:11], s32 offen offset:0 nt lds
    v_mfma_f32_16x16x32_bf16 v[184:187], v[108:111], v[80:83], v[184:187]
    ds_read_b128 v[44:47], v10 offset:12288
    v_mfma_f32_16x16x32_bf16 v[188:191], v[112:115], v[80:83], v[188:191]
    ds_read_b128 v[48:51], v10 offset:14336
    v_mfma_f32_16x16x32_bf16 v[192:195], v[100:103], v[84:87], v[192:195]
    buffer_load_dwordx4 v7, s[8:11], s32 offen offset:1024 nt lds
    v_mfma_f32_16x16x32_bf16 v[196:199], v[104:107], v[84:87], v[196:199]
    v_mfma_f32_16x16x32_bf16 v[200:203], v[108:111], v[84:87], v[200:203]
    v_mfma_f32_16x16x32_bf16 v[204:207], v[112:115], v[84:87], v[204:207]
    buffer_load_dwordx4 v8, s[8:11], s32 offen offset:2048 nt lds
    v_mfma_f32_16x16x32_bf16 v[208:211], v[100:103], v[88:91], v[208:211]
    v_mfma_f32_16x16x32_bf16 v[212:215], v[104:107], v[88:91], v[212:215]
    v_mfma_f32_16x16x32_bf16 v[216:219], v[108:111], v[88:91], v[216:219]
    buffer_load_dwordx4 v9, s[8:11], s32 offen offset:3072 nt lds
    v_mfma_f32_16x16x32_bf16 v[220:223], v[112:115], v[88:91], v[220:223]
    v_mfma_f32_16x16x32_bf16 v[224:227], v[100:103], v[92:95], v[224:227]
    v_mfma_f32_16x16x32_bf16 v[228:231], v[104:107], v[92:95], v[228:231]
    v_mfma_f32_16x16x32_bf16 v[232:235], v[108:111], v[92:95], v[232:235]
    v_mfma_f32_16x16x32_bf16 v[236:239], v[112:115], v[92:95], v[236:239]
    v_mfma_f32_16x16x32_bf16 v[240:243], v[100:103], v[96:99], v[240:243]
    v_mfma_f32_16x16x32_bf16 v[244:247], v[104:107], v[96:99], v[244:247]
    v_mfma_f32_16x16x32_bf16 v[248:251], v[108:111], v[96:99], v[248:251]
    s_add_u32 s36, s35, s28
    s_cmp_eq_u32 s36, 0
    s_cbranch_scc1 L_recurrent_scan__compressed_kv_cla__moe_arch_mod__prompt_kernel_rare_25
L_recurrent_scan__compressed_kv_cla__moe_arch_mod__prompt_kernel_back_26:
    v_mfma_f32_16x16x32_bf16 v[252:255], v[112:115], v[96:99], v[252:255]
    s_bitcmp1_b32 3, s35
    s_cselect_b32 exec_lo, 255, 1
    s_mov_b32 exec_hi, 0
    global_load_dword v0, v17, s[96:97]
    s_mov_b64 exec, -1
    s_cselect_b32 s36, s45, 0
    v_add_u32 v17, s36, v17
    v_min_u32 v17, 8388480, v17
    s_nop 1
    s_add_u32 s31, s31, s40
    s_add_u32 s32, s32, s41
    s_add_u32 s35, s35, 1
    s_branch L_kv_kloop
L_p1_fin0:
    v_mfma_f32_16x16x32_bf16 v[128:131], v[100:103], v[68:71], v[128:131]
    s_and_b32 s36, s28, 3
    s_sub_u32 s37, 15, s30
    s_cmp_lt_u32 s28, 4
    s_cselect_b32 s37, s37, s30
    s_lshl_b32 s37, s37, 2
    s_add_u32 s37, s37, s36
    s_lshl_b32 s37, s37, 16
    v_lshl_add_u32 v6, v1, 4, s37
    v_add_u32 v7, 32768, v6
    s_mov_b32 s32, 0
    s_mov_b32 s8, s54
    s_and_b32 s9, s55, 0xffff
    s_mov_b32 s10, 4194304
    s_mov_b32 s11, 0x20000
    v_mfma_f32_16x16x32_bf16 v[132:135], v[104:107], v[68:71], v[132:135]
    buffer_load_dwordx4 v[24:27], v6, s[8:11], s32 offen offset:0 sc1
    v_mfma_f32_16x16x32_bf16 v[136:139], v[108:111], v[68:71], v[136:139]
    v_lshrrev_b32 v18, 4, v1
    v_mfma_f32_16x16x32_bf16 v[140:143], v[112:115], v[68:71], v[140:143]
    v_bfe_u32 v20, v1, 2, 2
    v_mfma_f32_16x16x32_bf16 v[144:147], v[100:103], v[72:75], v[144:147]
    v_lshl_add_u32 v19, v18, 3, v20
    v_mfma_f32_16x16x32_bf16 v[148:151], v[104:107], v[72:75], v[148:151]
    buffer_load_dwordx4 v[28:31], v7, s[8:11], s32 offen offset:0 sc1
    v_lshlrev_b32 v19, 8, v19
    v_mfma_f32_16x16x32_bf16 v[152:155], v[108:111], v[72:75], v[152:155]
    v_and_b32 v21, 3, v1
    v_mfma_f32_16x16x32_bf16 v[156:159], v[112:115], v[72:75], v[156:159]
    v_lshl_add_u32 v19, v21, 3, v19
    v_mfma_f32_16x16x32_bf16 v[160:163], v[100:103], v[76:79], v[160:163]
    v_and_b32 v21, 1, v18
    v_mfma_f32_16x16x32_bf16 v[164:167], v[104:107], v[76:79], v[164:167]
    buffer_load_dwordx4 v[32:35], v6, s[8:11], s32 offen offset:1024 sc1
    v_lshl_add_u32 v20, v21, 2, v20
    v_mfma_f32_16x16x32_bf16 v[168:171], v[108:111], v[76:79], v[168:171]
    v_xor_b32 v21, 0, v20
    v_mfma_f32_16x16x32_bf16 v[172:175], v[112:115], v[76:79], v[172:175]
    v_lshl_add_u32 v10, v21, 5, v19
    v_mfma_f32_16x16x32_bf16 v[176:179], v[100:103], v[80:83], v[176:179]
    v_xor_b32 v21, 1, v20
    v_mfma_f32_16x16x32_bf16 v[180:183], v[104:107], v[80:83], v[180:183]
    buffer_load_dwordx4 v[36:39], v7, s[8:11], s32 offen offset:1024 sc1
    v_lshl_add_u32 v11, v21, 5, v19
    v_mfma_f32_16x16x32_bf16 v[184:187], v[108:111], v[80:83], v[184:187]
    v_xor_b32 v21, 2, v20
    v_mfma_f32_16x16x32_bf16 v[188:191], v[112:115], v[80:83], v[188:191]
    v_lshl_add_u32 v12, v21, 5, v19
    v_mfma_f32_16x16x32_bf16 v[192:195], v[100:103], v[84:87], v[192:195]
    v_xor_b32 v21, 3, v20
    v_mfma_f32_16x16x32_bf16 v[196:199], v[104:107], v[84:87], v[196:199]
    buffer_load_dwordx4 v[40:43], v6, s[8:11], s32 offen offset:2048 sc1
    v_lshl_add_u32 v13, v21, 5, v19
    v_mfma_f32_16x16x32_bf16 v[200:203], v[108:111], v[84:87], v[200:203]
    v_xor_b32 v21, 4, v20
    v_mfma_f32_16x16x32_bf16 v[204:207], v[112:115], v[84:87], v[204:207]
    v_lshl_add_u32 v14, v21, 5, v19
    v_mfma_f32_16x16x32_bf16 v[208:211], v[100:103], v[88:91], v[208:211]
    v_xor_b32 v21, 5, v20
    v_mfma_f32_16x16x32_bf16 v[212:215], v[104:107], v[88:91], v[212:215]
    buffer_load_dwordx4 v[44:47], v7, s[8:11], s32 offen offset:2048 sc1
    v_lshl_add_u32 v15, v21, 5, v19
    v_mfma_f32_16x16x32_bf16 v[216:219], v[108:111], v[88:91], v[216:219]
    v_xor_b32 v21, 6, v20
    v_mfma_f32_16x16x32_bf16 v[220:223], v[112:115], v[88:91], v[220:223]
    v_lshl_add_u32 v16, v21, 5, v19
    v_mfma_f32_16x16x32_bf16 v[224:227], v[100:103], v[92:95], v[224:227]
    v_xor_b32 v21, 7, v20
    v_mfma_f32_16x16x32_bf16 v[228:231], v[104:107], v[92:95], v[228:231]
    buffer_load_dwordx4 v[48:51], v6, s[8:11], s32 offen offset:3072 sc1
    v_lshl_add_u32 v17, v21, 5, v19
    v_mfma_f32_16x16x32_bf16 v[232:235], v[108:111], v[92:95], v[232:235]
    s_lshl_b32 s45, s29, 20
    v_mfma_f32_16x16x32_bf16 v[236:239], v[112:115], v[92:95], v[236:239]
    v_mfma_f32_16x16x32_bf16 v[240:243], v[100:103], v[96:99], v[240:243]
    v_mfma_f32_16x16x32_bf16 v[244:247], v[104:107], v[96:99], v[244:247]
    buffer_load_dwordx4 v[52:55], v7, s[8:11], s32 offen offset:3072 sc1
    v_mfma_f32_16x16x32_bf16 v[248:251], v[108:111], v[96:99], v[248:251]
    v_mfma_f32_16x16x32_bf16 v[252:255], v[112:115], v[96:99], v[252:255]
    s_branch L_p1_done
    .p2align 6
L_kv_vloop:
    s_waitcnt lgkmcnt(0)
    v_mfma_f32_16x16x32_bf16 v[128:131], v[20:23], v[52:55], v[128:131]
    ds_read_b128 v[68:71], v11 offset:0
    v_mfma_f32_16x16x32_bf16 v[160:163], v[20:23], v[56:59], v[160:163]
    ds_read_b64_tr_b16 v[100:101], v12 offset:8192
    v_mfma_f32_16x16x32_bf16 v[192:195], v[20:23], v[60:63], v[192:195]
    ds_read_b64_tr_b16 v[102:103], v12 offset:9216
    v_mfma_f32_16x16x32_bf16 v[224:227], v[20:23], v[64:67], v[224:227]
    ds_read_b64_tr_b16 v[104:105], v13 offset:8192
    v_mfma_f32_16x16x32_bf16 v[132:135], v[24:27], v[52:55], v[132:135]
    ds_read_b64_tr_b16 v[106:107], v13 offset:9216
    v_mfma_f32_16x16x32_bf16 v[164:167], v[24:27], v[56:59], v[164:167]
    ds_read_b64_tr_b16 v[108:109], v14 offset:8192
    v_mfma_f32_16x16x32_bf16 v[196:199], v[24:27], v[60:63], v[196:199]
    ds_read_b64_tr_b16 v[110:111], v14 offset:9216
    v_mfma_f32_16x16x32_bf16 v[228:231], v[24:27], v[64:67], v[228:231]
    ds_read_b64_tr_b16 v[112:113], v15 offset:8192
    v_mfma_f32_16x16x32_bf16 v[136:139], v[28:31], v[52:55], v[136:139]
    ds_read_b64_tr_b16 v[114:115], v15 offset:9216
    v_mfma_f32_16x16x32_bf16 v[168:171], v[28:31], v[56:59], v[168:171]
    ds_read_b128 v[72:75], v11 offset:2048
    v_mfma_f32_16x16x32_bf16 v[200:203], v[28:31], v[60:63], v[200:203]
    ds_read_b128 v[76:79], v11 offset:4096
    v_mfma_f32_16x16x32_bf16 v[232:235], v[28:31], v[64:67], v[232:235]
    ds_read_b128 v[80:83], v11 offset:6144
    v_mfma_f32_16x16x32_bf16 v[140:143], v[32:35], v[52:55], v[140:143]
    ds_read_b128 v[84:87], v11 offset:8192
    v_mfma_f32_16x16x32_bf16 v[172:175], v[32:35], v[56:59], v[172:175]
    ds_read_b128 v[88:91], v11 offset:10240
    v_mfma_f32_16x16x32_bf16 v[204:207], v[32:35], v[60:63], v[204:207]
    ds_read_b128 v[92:95], v11 offset:12288
    v_mfma_f32_16x16x32_bf16 v[236:239], v[32:35], v[64:67], v[236:239]
    ds_read_b128 v[96:99], v11 offset:14336
    v_mfma_f32_16x16x32_bf16 v[144:147], v[36:39], v[52:55], v[144:147]
    v_mfma_f32_16x16x32_bf16 v[176:179], v[36:39], v[56:59], v[176:179]
    v_mfma_f32_16x16x32_bf16 v[208:211], v[36:39], v[60:63], v[208:211]
    v_mfma_f32_16x16x32_bf16 v[240:243], v[36:39], v[64:67], v[240:243]
    v_mfma_f32_16x16x32_bf16 v[148:151], v[40:43], v[52:55], v[148:151]
    v_mfma_f32_16x16x32_bf16 v[180:183], v[40:43], v[56:59], v[180:183]
    v_mfma_f32_16x16x32_bf16 v[212:215], v[40:43], v[60:63], v[212:215]
    v_mfma_f32_16x16x32_bf16 v[244:247], v[40:43], v[64:67], v[244:247]
    v_mfma_f32_16x16x32_bf16 v[152:155], v[44:47], v[52:55], v[152:155]
    v_mfma_f32_16x16x32_bf16 v[184:187], v[44:47], v[56:59], v[184:187]
    v_mfma_f32_16x16x32_bf16 v[216:219], v[44:47], v[60:63], v[216:219]
    v_mfma_f32_16x16x32_bf16 v[248:251], v[44:47], v[64:67], v[248:251]
    v_mfma_f32_16x16x32_bf16 v[156:159], v[48:51], v[52:55], v[156:159]
    v_mfma_f32_16x16x32_bf16 v[188:191], v[48:51], v[56:59], v[188:191]
    v_mfma_f32_16x16x32_bf16 v[220:223], v[48:51], v[60:63], v[220:223]
    v_mfma_f32_16x16x32_bf16 v[252:255], v[48:51], v[64:67], v[252:255]
    s_cmp_lt_u32 s35, s44
    s_cbranch_scc1 L_recurrent_scan__compressed_kv_cla__moe_arch_mod__prompt_kernel_w0_27
    s_waitcnt vmcnt(1)
L_recurrent_scan__compressed_kv_cla__moe_arch_mod__prompt_kernel_w0b_28:
    s_waitcnt lgkmcnt(0)
    s_barrier
    s_add_u32 m0, s33, 0
    s_nop 0
    buffer_load_dwordx4 v2, s[4:7], s31 offen offset:0 lds
    buffer_load_dwordx4 v3, s[4:7], s31 offen offset:1024 lds
    buffer_load_dwordx4 v4, s[4:7], s31 offen offset:2048 lds
    buffer_load_dwordx4 v5, s[4:7], s31 offen offset:3072 lds
    s_add_u32 m0, s34, 0
    s_nop 0
    buffer_load_dwordx4 v6, s[8:11], s32 offen offset:0 nt lds
    buffer_load_dwordx4 v7, s[8:11], s32 offen offset:1024 nt lds
    buffer_load_dwordx4 v8, s[8:11], s32 offen offset:2048 nt lds
    buffer_load_dwordx4 v9, s[8:11], s32 offen offset:3072 nt lds
    s_add_u32 s31, s31, s40
    s_add_u32 s32, s32, s41
    s_cmp_eq_u32 s35, 0
    s_cbranch_scc1 L_recurrent_scan__compressed_kv_cla__moe_arch_mod__prompt_kernel_rare_32
L_recurrent_scan__compressed_kv_cla__moe_arch_mod__prompt_kernel_back_33:
    v_mfma_f32_16x16x32_bf16 v[128:131], v[68:71], v[100:103], v[128:131]
    ds_read_b128 v[20:23], v10 offset:32768
    v_mfma_f32_16x16x32_bf16 v[160:163], v[68:71], v[104:107], v[160:163]
    ds_read_b64_tr_b16 v[52:53], v12 offset:32768
    v_mfma_f32_16x16x32_bf16 v[192:195], v[68:71], v[108:111], v[192:195]
    ds_read_b64_tr_b16 v[54:55], v12 offset:33792
    v_mfma_f32_16x16x32_bf16 v[224:227], v[68:71], v[112:115], v[224:227]
    ds_read_b64_tr_b16 v[56:57], v13 offset:32768
    v_mfma_f32_16x16x32_bf16 v[132:135], v[72:75], v[100:103], v[132:135]
    ds_read_b64_tr_b16 v[58:59], v13 offset:33792
    v_mfma_f32_16x16x32_bf16 v[164:167], v[72:75], v[104:107], v[164:167]
    ds_read_b64_tr_b16 v[60:61], v14 offset:32768
    v_mfma_f32_16x16x32_bf16 v[196:199], v[72:75], v[108:111], v[196:199]
    ds_read_b64_tr_b16 v[62:63], v14 offset:33792
    v_mfma_f32_16x16x32_bf16 v[228:231], v[72:75], v[112:115], v[228:231]
    ds_read_b64_tr_b16 v[64:65], v15 offset:32768
    v_mfma_f32_16x16x32_bf16 v[136:139], v[76:79], v[100:103], v[136:139]
    ds_read_b64_tr_b16 v[66:67], v15 offset:33792
    v_mfma_f32_16x16x32_bf16 v[168:171], v[76:79], v[104:107], v[168:171]
    ds_read_b128 v[24:27], v10 offset:34816
    v_mfma_f32_16x16x32_bf16 v[200:203], v[76:79], v[108:111], v[200:203]
    ds_read_b128 v[28:31], v10 offset:36864
    v_mfma_f32_16x16x32_bf16 v[232:235], v[76:79], v[112:115], v[232:235]
    ds_read_b128 v[32:35], v10 offset:38912
    v_mfma_f32_16x16x32_bf16 v[140:143], v[80:83], v[100:103], v[140:143]
    ds_read_b128 v[36:39], v10 offset:40960
    v_mfma_f32_16x16x32_bf16 v[172:175], v[80:83], v[104:107], v[172:175]
    ds_read_b128 v[40:43], v10 offset:43008
    v_mfma_f32_16x16x32_bf16 v[204:207], v[80:83], v[108:111], v[204:207]
    ds_read_b128 v[44:47], v10 offset:45056
    v_mfma_f32_16x16x32_bf16 v[236:239], v[80:83], v[112:115], v[236:239]
    ds_read_b128 v[48:51], v10 offset:47104
    v_mfma_f32_16x16x32_bf16 v[144:147], v[84:87], v[100:103], v[144:147]
    v_mfma_f32_16x16x32_bf16 v[176:179], v[84:87], v[104:107], v[176:179]
    v_mfma_f32_16x16x32_bf16 v[208:211], v[84:87], v[108:111], v[208:211]
    v_mfma_f32_16x16x32_bf16 v[240:243], v[84:87], v[112:115], v[240:243]
    v_mfma_f32_16x16x32_bf16 v[148:151], v[88:91], v[100:103], v[148:151]
    v_mfma_f32_16x16x32_bf16 v[180:183], v[88:91], v[104:107], v[180:183]
    v_mfma_f32_16x16x32_bf16 v[212:215], v[88:91], v[108:111], v[212:215]
    v_mfma_f32_16x16x32_bf16 v[244:247], v[88:91], v[112:115], v[244:247]
    v_mfma_f32_16x16x32_bf16 v[152:155], v[92:95], v[100:103], v[152:155]
    v_mfma_f32_16x16x32_bf16 v[184:187], v[92:95], v[104:107], v[184:187]
    v_mfma_f32_16x16x32_bf16 v[216:219], v[92:95], v[108:111], v[216:219]
    v_mfma_f32_16x16x32_bf16 v[248:251], v[92:95], v[112:115], v[248:251]
    v_mfma_f32_16x16x32_bf16 v[156:159], v[96:99], v[100:103], v[156:159]
    v_mfma_f32_16x16x32_bf16 v[188:191], v[96:99], v[104:107], v[188:191]
    v_mfma_f32_16x16x32_bf16 v[220:223], v[96:99], v[108:111], v[220:223]
    v_mfma_f32_16x16x32_bf16 v[252:255], v[96:99], v[112:115], v[252:255]
    s_bitcmp1_b32 3, s35
    s_cselect_b32 exec_lo, 255, 1
    s_mov_b32 exec_hi, 0
    global_load_dword v0, v17, s[96:97]
    s_mov_b64 exec, -1
    s_cselect_b32 s36, s45, 0
    v_add_u32 v17, s36, v17
    v_min_u32 v17, 8388480, v17
    s_nop 1
    s_waitcnt lgkmcnt(0)
    v_mfma_f32_16x16x32_bf16 v[128:131], v[20:23], v[52:55], v[128:131]
    ds_read_b128 v[68:71], v11 offset:32768
    v_mfma_f32_16x16x32_bf16 v[160:163], v[20:23], v[56:59], v[160:163]
    ds_read_b64_tr_b16 v[100:101], v12 offset:40960
    v_mfma_f32_16x16x32_bf16 v[192:195], v[20:23], v[60:63], v[192:195]
    ds_read_b64_tr_b16 v[102:103], v12 offset:41984
    v_mfma_f32_16x16x32_bf16 v[224:227], v[20:23], v[64:67], v[224:227]
    ds_read_b64_tr_b16 v[104:105], v13 offset:40960
    v_mfma_f32_16x16x32_bf16 v[132:135], v[24:27], v[52:55], v[132:135]
    ds_read_b64_tr_b16 v[106:107], v13 offset:41984
    v_mfma_f32_16x16x32_bf16 v[164:167], v[24:27], v[56:59], v[164:167]
    ds_read_b64_tr_b16 v[108:109], v14 offset:40960
    v_mfma_f32_16x16x32_bf16 v[196:199], v[24:27], v[60:63], v[196:199]
    ds_read_b64_tr_b16 v[110:111], v14 offset:41984
    v_mfma_f32_16x16x32_bf16 v[228:231], v[24:27], v[64:67], v[228:231]
    ds_read_b64_tr_b16 v[112:113], v15 offset:40960
    v_mfma_f32_16x16x32_bf16 v[136:139], v[28:31], v[52:55], v[136:139]
    ds_read_b64_tr_b16 v[114:115], v15 offset:41984
    v_mfma_f32_16x16x32_bf16 v[168:171], v[28:31], v[56:59], v[168:171]
    ds_read_b128 v[72:75], v11 offset:34816
    v_mfma_f32_16x16x32_bf16 v[200:203], v[28:31], v[60:63], v[200:203]
    ds_read_b128 v[76:79], v11 offset:36864
    v_mfma_f32_16x16x32_bf16 v[232:235], v[28:31], v[64:67], v[232:235]
    ds_read_b128 v[80:83], v11 offset:38912
    v_mfma_f32_16x16x32_bf16 v[140:143], v[32:35], v[52:55], v[140:143]
    ds_read_b128 v[84:87], v11 offset:40960
    v_mfma_f32_16x16x32_bf16 v[172:175], v[32:35], v[56:59], v[172:175]
    ds_read_b128 v[88:91], v11 offset:43008
    v_mfma_f32_16x16x32_bf16 v[204:207], v[32:35], v[60:63], v[204:207]
    ds_read_b128 v[92:95], v11 offset:45056
    v_mfma_f32_16x16x32_bf16 v[236:239], v[32:35], v[64:67], v[236:239]
    ds_read_b128 v[96:99], v11 offset:47104
    v_mfma_f32_16x16x32_bf16 v[144:147], v[36:39], v[52:55], v[144:147]
    v_mfma_f32_16x16x32_bf16 v[176:179], v[36:39], v[56:59], v[176:179]
    v_mfma_f32_16x16x32_bf16 v[208:211], v[36:39], v[60:63], v[208:211]
    v_mfma_f32_16x16x32_bf16 v[240:243], v[36:39], v[64:67], v[240:243]
    v_mfma_f32_16x16x32_bf16 v[148:151], v[40:43], v[52:55], v[148:151]
    v_mfma_f32_16x16x32_bf16 v[180:183], v[40:43], v[56:59], v[180:183]
    v_mfma_f32_16x16x32_bf16 v[212:215], v[40:43], v[60:63], v[212:215]
    v_mfma_f32_16x16x32_bf16 v[244:247], v[40:43], v[64:67], v[244:247]
    v_mfma_f32_16x16x32_bf16 v[152:155], v[44:47], v[52:55], v[152:155]
    v_mfma_f32_16x16x32_bf16 v[184:187], v[44:47], v[56:59], v[184:187]
    v_mfma_f32_16x16x32_bf16 v[216:219], v[44:47], v[60:63], v[216:219]
    v_mfma_f32_16x16x32_bf16 v[248:251], v[44:47], v[64:67], v[248:251]
    v_mfma_f32_16x16x32_bf16 v[156:159], v[48:51], v[52:55], v[156:159]
    v_mfma_f32_16x16x32_bf16 v[188:191], v[48:51], v[56:59], v[188:191]
    v_mfma_f32_16x16x32_bf16 v[220:223], v[48:51], v[60:63], v[220:223]
    v_mfma_f32_16x16x32_bf16 v[252:255], v[48:51], v[64:67], v[252:255]
    s_waitcnt vmcnt(1) lgkmcnt(0)
    s_cmp_eq_u32 s35, 3
    s_barrier
    s_cbranch_scc1 L_p1_fin1
    s_add_u32 m0, s33, 32768
    s_nop 0
    buffer_load_dwordx4 v2, s[4:7], s31 offen offset:0 lds
    buffer_load_dwordx4 v3, s[4:7], s31 offen offset:1024 lds
    buffer_load_dwordx4 v4, s[4:7], s31 offen offset:2048 lds
    buffer_load_dwordx4 v5, s[4:7], s31 offen offset:3072 lds
    s_add_u32 m0, s34, 32768
    s_nop 0
    buffer_load_dwordx4 v6, s[8:11], s32 offen offset:0 nt lds
    buffer_load_dwordx4 v7, s[8:11], s32 offen offset:1024 nt lds
    buffer_load_dwordx4 v8, s[8:11], s32 offen offset:2048 nt lds
    buffer_load_dwordx4 v9, s[8:11], s32 offen offset:3072 nt lds
    s_add_u32 s31, s31, s40
    s_add_u32 s32, s32, s41
    s_cmp_eq_u32 s35, 2
    s_cbranch_scc1 L_recurrent_scan__compressed_kv_cla__moe_arch_mod__prompt_kernel_rare_36
L_recurrent_scan__compressed_kv_cla__moe_arch_mod__prompt_kernel_back_37:
    v_mfma_f32_16x16x32_bf16 v[128:131], v[68:71], v[100:103], v[128:131]
    ds_read_b128 v[20:23], v10 offset:0
    v_mfma_f32_16x16x32_bf16 v[160:163], v[68:71], v[104:107], v[160:163]
    ds_read_b64_tr_b16 v[52:53], v12 offset:0
    v_mfma_f32_16x16x32_bf16 v[192:195], v[68:71], v[108:111], v[192:195]
    ds_read_b64_tr_b16 v[54:55], v12 offset:1024
    v_mfma_f32_16x16x32_bf16 v[224:227], v[68:71], v[112:115], v[224:227]
    ds_read_b64_tr_b16 v[56:57], v13 offset:0
    v_mfma_f32_16x16x32_bf16 v[132:135], v[72:75], v[100:103], v[132:135]
    ds_read_b64_tr_b16 v[58:59], v13 offset:1024
    v_mfma_f32_16x16x32_bf16 v[164:167], v[72:75], v[104:107], v[164:167]
    ds_read_b64_tr_b16 v[60:61], v14 offset:0
    v_mfma_f32_16x16x32_bf16 v[196:199], v[72:75], v[108:111], v[196:199]
    ds_read_b64_tr_b16 v[62:63], v14 offset:1024
    v_mfma_f32_16x16x32_bf16 v[228:231], v[72:75], v[112:115], v[228:231]
    ds_read_b64_tr_b16 v[64:65], v15 offset:0
    v_mfma_f32_16x16x32_bf16 v[136:139], v[76:79], v[100:103], v[136:139]
    ds_read_b64_tr_b16 v[66:67], v15 offset:1024
    v_mfma_f32_16x16x32_bf16 v[168:171], v[76:79], v[104:107], v[168:171]
    ds_read_b128 v[24:27], v10 offset:2048
    v_mfma_f32_16x16x32_bf16 v[200:203], v[76:79], v[108:111], v[200:203]
    ds_read_b128 v[28:31], v10 offset:4096
    v_mfma_f32_16x16x32_bf16 v[232:235], v[76:79], v[112:115], v[232:235]
    ds_read_b128 v[32:35], v10 offset:6144
    v_mfma_f32_16x16x32_bf16 v[140:143], v[80:83], v[100:103], v[140:143]
    ds_read_b128 v[36:39], v10 offset:8192
    v_mfma_f32_16x16x32_bf16 v[172:175], v[80:83], v[104:107], v[172:175]
    ds_read_b128 v[40:43], v10 offset:10240
    v_mfma_f32_16x16x32_bf16 v[204:207], v[80:83], v[108:111], v[204:207]
    ds_read_b128 v[44:47], v10 offset:12288
    v_mfma_f32_16x16x32_bf16 v[236:239], v[80:83], v[112:115], v[236:239]
    ds_read_b128 v[48:51], v10 offset:14336
    v_mfma_f32_16x16x32_bf16 v[144:147], v[84:87], v[100:103], v[144:147]
    v_mfma_f32_16x16x32_bf16 v[176:179], v[84:87], v[104:107], v[176:179]
    v_mfma_f32_16x16x32_bf16 v[208:211], v[84:87], v[108:111], v[208:211]
    v_mfma_f32_16x16x32_bf16 v[240:243], v[84:87], v[112:115], v[240:243]
    v_mfma_f32_16x16x32_bf16 v[148:151], v[88:91], v[100:103], v[148:151]
    v_mfma_f32_16x16x32_bf16 v[180:183], v[88:91], v[104:107], v[180:183]
    v_mfma_f32_16x16x32_bf16 v[212:215], v[88:91], v[108:111], v[212:215]
    v_mfma_f32_16x16x32_bf16 v[244:247], v[88:91], v[112:115], v[244:247]
    v_mfma_f32_16x16x32_bf16 v[152:155], v[92:95], v[100:103], v[152:155]
    v_mfma_f32_16x16x32_bf16 v[184:187], v[92:95], v[104:107], v[184:187]
    v_mfma_f32_16x16x32_bf16 v[216:219], v[92:95], v[108:111], v[216:219]
    v_mfma_f32_16x16x32_bf16 v[248:251], v[92:95], v[112:115], v[248:251]
    v_mfma_f32_16x16x32_bf16 v[156:159], v[96:99], v[100:103], v[156:159]
    v_mfma_f32_16x16x32_bf16 v[188:191], v[96:99], v[104:107], v[188:191]
    v_mfma_f32_16x16x32_bf16 v[220:223], v[96:99], v[108:111], v[220:223]
    v_mfma_f32_16x16x32_bf16 v[252:255], v[96:99], v[112:115], v[252:255]
    s_bitcmp1_b32 3, s35
    s_cselect_b32 exec_lo, 255, 1
    s_mov_b32 exec_hi, 0
    global_load_dword v0, v17, s[96:97]
    s_mov_b64 exec, -1
    s_cselect_b32 s36, s45, 0
    v_add_u32 v17, s36, v17
    v_min_u32 v17, 8388480, v17
    s_nop 1
    s_add_u32 s35, s35, 1
    s_branch L_kv_vloop
L_p1_fin1:
    s_and_b32 s36, s28, 3
    s_sub_u32 s37, 15, s30
    s_cmp_lt_u32 s28, 4
    s_cselect_b32 s37, s37, s30
    s_lshl_b32 s37, s37, 2
    s_add_u32 s37, s37, s36
    s_lshl_b32 s37, s37, 16
    v_lshl_add_u32 v6, v1, 4, s37
    v_add_u32 v7, 32768, v6
    s_mov_b32 s32, 0
    s_mov_b32 s8, s54
    s_and_b32 s9, s55, 0xffff
    s_mov_b32 s10, 4194304
    s_mov_b32 s11, 0x20000
    v_mfma_f32_16x16x32_bf16 v[128:131], v[68:71], v[100:103], v[128:131]
    v_mfma_f32_16x16x32_bf16 v[160:163], v[68:71], v[104:107], v[160:163]
    buffer_load_dwordx4 v[24:27], v6, s[8:11], s32 offen offset:0 sc1
    v_mfma_f32_16x16x32_bf16 v[192:195], v[68:71], v[108:111], v[192:195]
    v_lshrrev_b32 v18, 4, v1
    v_mfma_f32_16x16x32_bf16 v[224:227], v[68:71], v[112:115], v[224:227]
    v_bfe_u32 v20, v1, 2, 2
    v_mfma_f32_16x16x32_bf16 v[132:135], v[72:75], v[100:103], v[132:135]
    v_lshl_add_u32 v19, v18, 3, v20
    v_mfma_f32_16x16x32_bf16 v[164:167], v[72:75], v[104:107], v[164:167]
    buffer_load_dwordx4 v[28:31], v7, s[8:11], s32 offen offset:0 sc1
    v_lshlrev_b32 v19, 8, v19
    v_mfma_f32_16x16x32_bf16 v[196:199], v[72:75], v[108:111], v[196:199]
    v_and_b32 v21, 3, v1
    v_mfma_f32_16x16x32_bf16 v[228:231], v[72:75], v[112:115], v[228:231]
    v_lshl_add_u32 v19, v21, 3, v19
    v_mfma_f32_16x16x32_bf16 v[136:139], v[76:79], v[100:103], v[136:139]
    v_and_b32 v21, 1, v18
    v_mfma_f32_16x16x32_bf16 v[168:171], v[76:79], v[104:107], v[168:171]
    buffer_load_dwordx4 v[32:35], v6, s[8:11], s32 offen offset:1024 sc1
    v_lshl_add_u32 v20, v21, 2, v20
    v_mfma_f32_16x16x32_bf16 v[200:203], v[76:79], v[108:111], v[200:203]
    v_xor_b32 v21, 0, v20
    v_mfma_f32_16x16x32_bf16 v[232:235], v[76:79], v[112:115], v[232:235]
    v_lshl_add_u32 v10, v21, 5, v19
    v_mfma_f32_16x16x32_bf16 v[140:143], v[80:83], v[100:103], v[140:143]
    v_xor_b32 v21, 1, v20
    v_mfma_f32_16x16x32_bf16 v[172:175], v[80:83], v[104:107], v[172:175]
    buffer_load_dwordx4 v[36:39], v7, s[8:11], s32 offen offset:1024 sc1
    v_lshl_add_u32 v11, v21, 5, v19
    v_mfma_f32_16x16x32_bf16 v[204:207], v[80:83], v[108:111], v[204:207]
    v_xor_b32 v21, 2, v20
    v_mfma_f32_16x16x32_bf16 v[236:239], v[80:83], v[112:115], v[236:239]
    v_lshl_add_u32 v12, v21, 5, v19
    v_mfma_f32_16x16x32_bf16 v[144:147], v[84:87], v[100:103], v[144:147]
    v_xor_b32 v21, 3, v20
    v_mfma_f32_16x16x32_bf16 v[176:179], v[84:87], v[104:107], v[176:179]
    buffer_load_dwordx4 v[40:43], v6, s[8:11], s32 offen offset:2048 sc1
    v_lshl_add_u32 v13, v21, 5, v19
    v_mfma_f32_16x16x32_bf16 v[208:211], v[84:87], v[108:111], v[208:211]
    v_xor_b32 v21, 4, v20
    v_mfma_f32_16x16x32_bf16 v[240:243], v[84:87], v[112:115], v[240:243]
    v_lshl_add_u32 v14, v21, 5, v19
    v_mfma_f32_16x16x32_bf16 v[148:151], v[88:91], v[100:103], v[148:151]
    v_xor_b32 v21, 5, v20
    v_mfma_f32_16x16x32_bf16 v[180:183], v[88:91], v[104:107], v[180:183]
    buffer_load_dwordx4 v[44:47], v7, s[8:11], s32 offen offset:2048 sc1
    v_lshl_add_u32 v15, v21, 5, v19
    v_mfma_f32_16x16x32_bf16 v[212:215], v[88:91], v[108:111], v[212:215]
    v_xor_b32 v21, 6, v20
    v_mfma_f32_16x16x32_bf16 v[244:247], v[88:91], v[112:115], v[244:247]
    v_lshl_add_u32 v16, v21, 5, v19
    v_mfma_f32_16x16x32_bf16 v[152:155], v[92:95], v[100:103], v[152:155]
    v_xor_b32 v21, 7, v20
    v_mfma_f32_16x16x32_bf16 v[184:187], v[92:95], v[104:107], v[184:187]
    buffer_load_dwordx4 v[48:51], v6, s[8:11], s32 offen offset:3072 sc1
    v_lshl_add_u32 v17, v21, 5, v19
    v_mfma_f32_16x16x32_bf16 v[216:219], v[92:95], v[108:111], v[216:219]
    s_lshl_b32 s45, s29, 20
    v_mfma_f32_16x16x32_bf16 v[248:251], v[92:95], v[112:115], v[248:251]
    v_mfma_f32_16x16x32_bf16 v[156:159], v[96:99], v[100:103], v[156:159]
    v_mfma_f32_16x16x32_bf16 v[188:191], v[96:99], v[104:107], v[188:191]
    buffer_load_dwordx4 v[52:55], v7, s[8:11], s32 offen offset:3072 sc1
    v_mfma_f32_16x16x32_bf16 v[220:223], v[96:99], v[108:111], v[220:223]
    v_mfma_f32_16x16x32_bf16 v[252:255], v[96:99], v[112:115], v[252:255]
L_p1_done:
    s_waitcnt vmcnt(8)
    ds_read_b64_tr_b16 v[64:65], v10 offset:0
    ds_read_b64_tr_b16 v[66:67], v10 offset:1024
    ds_read_b64_tr_b16 v[68:69], v11 offset:0
    ds_read_b64_tr_b16 v[70:71], v11 offset:1024
    ds_read_b64_tr_b16 v[72:73], v12 offset:0
    ds_read_b64_tr_b16 v[74:75], v12 offset:1024
    ds_read_b64_tr_b16 v[76:77], v13 offset:0
    ds_read_b64_tr_b16 v[78:79], v13 offset:1024
    ds_read_b64_tr_b16 v[80:81], v14 offset:0
    ds_read_b64_tr_b16 v[82:83], v14 offset:1024
    ds_read_b64_tr_b16 v[84:85], v15 offset:0
    ds_read_b64_tr_b16 v[86:87], v15 offset:1024
    s_add_u32 m0, s33, 32768
    s_add_u32 s32, s32, 4096
    v_cvt_pk_bf16_f32 v128, v128, v129
    v_cvt_pk_bf16_f32 v129, v130, v131
    v_cvt_pk_bf16_f32 v130, v132, v133
    v_cvt_pk_bf16_f32 v131, v134, v135
    buffer_load_dwordx4 v2, s[4:7], s31 offen offset:0 lds
    v_cvt_pk_bf16_f32 v132, v136, v137
    v_cvt_pk_bf16_f32 v133, v138, v139
    v_cvt_pk_bf16_f32 v134, v140, v141
    v_cvt_pk_bf16_f32 v135, v142, v143
    buffer_load_dwordx4 v3, s[4:7], s31 offen offset:1024 lds
    v_cvt_pk_bf16_f32 v136, v144, v145
    v_cvt_pk_bf16_f32 v137, v146, v147
    v_cvt_pk_bf16_f32 v138, v148, v149
    v_cvt_pk_bf16_f32 v139, v150, v151
    buffer_load_dwordx4 v4, s[4:7], s31 offen offset:2048 lds
    v_cvt_pk_bf16_f32 v140, v152, v153
    v_cvt_pk_bf16_f32 v141, v154, v155
    v_cvt_pk_bf16_f32 v142, v156, v157
    v_cvt_pk_bf16_f32 v143, v158, v159
    buffer_load_dwordx4 v5, s[4:7], s31 offen offset:3072 lds
    v_cvt_pk_bf16_f32 v144, v160, v161
    v_cvt_pk_bf16_f32 v145, v162, v163
    v_cvt_pk_bf16_f32 v146, v164, v165
    v_cvt_pk_bf16_f32 v147, v166, v167
    s_add_u32 m0, s34, 32768
    s_mov_b32 s31, 3145728
    v_cvt_pk_bf16_f32 v148, v168, v169
    v_cvt_pk_bf16_f32 v149, v170, v171
    v_cvt_pk_bf16_f32 v150, v172, v173
    v_cvt_pk_bf16_f32 v151, v174, v175
    buffer_load_dwordx4 v2, s[4:7], s31 offen offset:0 lds
    v_cvt_pk_bf16_f32 v152, v176, v177
    v_cvt_pk_bf16_f32 v153, v178, v179
    v_cvt_pk_bf16_f32 v154, v180, v181
    v_cvt_pk_bf16_f32 v155, v182, v183
    buffer_load_dwordx4 v3, s[4:7], s31 offen offset:1024 lds
    v_cvt_pk_bf16_f32 v156, v184, v185
    v_cvt_pk_bf16_f32 v157, v186, v187
    v_cvt_pk_bf16_f32 v158, v188, v189
    v_cvt_pk_bf16_f32 v159, v190, v191
    buffer_load_dwordx4 v4, s[4:7], s31 offen offset:2048 lds
    v_cvt_pk_bf16_f32 v160, v192, v193
    v_cvt_pk_bf16_f32 v161, v194, v195
    v_cvt_pk_bf16_f32 v162, v196, v197
    v_cvt_pk_bf16_f32 v163, v198, v199
    buffer_load_dwordx4 v5, s[4:7], s31 offen offset:3072 lds
    v_cvt_pk_bf16_f32 v164, v200, v201
    v_cvt_pk_bf16_f32 v165, v202, v203
    v_cvt_pk_bf16_f32 v166, v204, v205
    v_cvt_pk_bf16_f32 v167, v206, v207
    s_add_u32 s31, s31, s40
    s_mov_b32 s34, s33
    v_cvt_pk_bf16_f32 v168, v208, v209
    v_cvt_pk_bf16_f32 v169, v210, v211
    v_cvt_pk_bf16_f32 v170, v212, v213
    v_cvt_pk_bf16_f32 v171, v214, v215
    buffer_load_dwordx4 v[96:99], v6, s[8:11], s32 offen offset:0 sc1
    v_cvt_pk_bf16_f32 v172, v216, v217
    v_cvt_pk_bf16_f32 v173, v218, v219
    v_cvt_pk_bf16_f32 v174, v220, v221
    v_cvt_pk_bf16_f32 v175, v222, v223
    buffer_load_dwordx4 v[100:103], v7, s[8:11], s32 offen offset:0 sc1
    v_cvt_pk_bf16_f32 v176, v224, v225
    v_cvt_pk_bf16_f32 v177, v226, v227
    v_cvt_pk_bf16_f32 v178, v228, v229
    v_cvt_pk_bf16_f32 v179, v230, v231
    buffer_load_dwordx4 v[104:107], v6, s[8:11], s32 offen offset:1024 sc1
    v_cvt_pk_bf16_f32 v180, v232, v233
    v_cvt_pk_bf16_f32 v181, v234, v235
    v_cvt_pk_bf16_f32 v182, v236, v237
    v_cvt_pk_bf16_f32 v183, v238, v239
    buffer_load_dwordx4 v[108:111], v7, s[8:11], s32 offen offset:1024 sc1
    v_cvt_pk_bf16_f32 v184, v240, v241
    v_cvt_pk_bf16_f32 v185, v242, v243
    v_cvt_pk_bf16_f32 v186, v244, v245
    v_cvt_pk_bf16_f32 v187, v246, v247
    buffer_load_dwordx4 v[112:115], v6, s[8:11], s32 offen offset:2048 sc1
    v_cvt_pk_bf16_f32 v188, v248, v249
    v_cvt_pk_bf16_f32 v189, v250, v251
    v_cvt_pk_bf16_f32 v190, v252, v253
    v_cvt_pk_bf16_f32 v191, v254, v255
    s_lshl_b32 s38, s29, 20
    s_lshl_b32 s37, s30, 17
    s_add_u32 s38, s38, s37
    s_bfe_u32 s37, s28, 0x10001
    s_lshl_b32 s37, s37, 16
    s_add_u32 s38, s38, s37
    s_lshr_b32 s36, s28, 2
    s_lshl_b32 s37, s36, 15
    s_add_u32 s38, s38, s37
    s_and_b32 s37, s28, 1
    s_add_u32 s36, s36, 11
    s_lshl_b32 s37, s37, s36
    s_add_u32 s38, s38, s37
    s_cmp_lt_u32 s28, 4
    s_cselect_b32 s36, 4, 32
    s_cselect_b32 s37, 16, 64
    s_cselect_b32 s39, 32, 4
    s_lshl_b32 s36, s36, 8
    s_lshl_b32 s37, s37, 8
    s_lshl_b32 s39, s39, 8
    s_mov_b64 s[16:17], s[12:13]
    s_mov_b64 s[18:19], s[14:15]
    s_cmp_eq_u32 s30, 0
    s_cselect_b32 s52, 2, 4
    v_lshlrev_b32 v58, 4, v1
    v_add_u32 v59, s36, v58
    v_add_u32 v60, s37, v58
    v_add_u32 v61, s36, v60
    v_mov_b64 v[192:193], 0
    v_mov_b64 v[194:195], 0
    v_mov_b64 v[196:197], 0
    v_mov_b64 v[198:199], 0
    v_mov_b64 v[200:201], 0
    v_mov_b64 v[202:203], 0
    v_mov_b64 v[204:205], 0
    v_mov_b64 v[206:207], 0
    v_mov_b64 v[208:209], 0
    v_mov_b64 v[210:211], 0
    v_mov_b64 v[212:213], 0
    v_mov_b64 v[214:215], 0
    v_mov_b64 v[216:217], 0
    v_mov_b64 v[218:219], 0
    v_mov_b64 v[220:221], 0
    v_mov_b64 v[222:223], 0
    v_mov_b64 v[224:225], 0
    v_mov_b64 v[226:227], 0
    v_mov_b64 v[228:229], 0
    v_mov_b64 v[230:231], 0
    v_mov_b64 v[232:233], 0
    v_mov_b64 v[234:235], 0
    v_mov_b64 v[236:237], 0
    v_mov_b64 v[238:239], 0
    v_mov_b64 v[240:241], 0
    v_mov_b64 v[242:243], 0
    v_mov_b64 v[244:245], 0
    v_mov_b64 v[246:247], 0
    v_mov_b64 v[248:249], 0
    v_mov_b64 v[250:251], 0
    v_mov_b64 v[252:253], 0
    v_mov_b64 v[254:255], 0
    buffer_load_dwordx4 v[116:119], v7, s[8:11], s32 offen offset:2048 sc1
    s_mov_b32 s35, 0
    s_waitcnt vmcnt(14)
    s_cmp_eq_u32 s30, 0
    s_cbranch_scc1 L_recurrent_scan__compressed_kv_cla__moe_arch_mod__prompt_kernel_rare_64
L_recurrent_scan__compressed_kv_cla__moe_arch_mod__prompt_kernel_back_65:
    .p2align 6
L_p2_loop:
    s_cmp_ge_u32 s35, 2
    s_cbranch_scc1 L_recurrent_scan__compressed_kv_cla__moe_arch_mod__prompt_kernel_rare_54
L_recurrent_scan__compressed_kv_cla__moe_arch_mod__prompt_kernel_back_55:
    s_waitcnt lgkmcnt(8)
    s_waitcnt vmcnt(23)
    v_mfma_f32_16x16x32_bf16 v[192:195], v[64:67], v[24:27], v[192:195]
    ds_read_b64_tr_b16 v[88:89], v16 offset:0
    v_mfma_f32_16x16x32_bf16 v[224:227], v[64:67], v[28:31], v[224:227]
    ds_read_b64_tr_b16 v[90:91], v16 offset:1024
    v_mfma_f32_16x16x32_bf16 v[196:199], v[68:71], v[24:27], v[196:199]
    ds_read_b64_tr_b16 v[92:93], v17 offset:0
    buffer_load_dwordx4 v[120:123], v6, s[8:11], s32 offen offset:3072 sc1
    v_mfma_f32_16x16x32_bf16 v[228:231], v[68:71], v[28:31], v[228:231]
    ds_read_b64_tr_b16 v[94:95], v17 offset:1024
    s_waitcnt lgkmcnt(8)
    v_mfma_f32_16x16x32_bf16 v[200:203], v[72:75], v[24:27], v[200:203]
    ds_read_b64_tr_b16 v[64:65], v10 offset:8192
    v_mfma_f32_16x16x32_bf16 v[232:235], v[72:75], v[28:31], v[232:235]
    ds_read_b64_tr_b16 v[66:67], v10 offset:9216
    v_mfma_f32_16x16x32_bf16 v[204:207], v[76:79], v[24:27], v[204:207]
    ds_read_b64_tr_b16 v[68:69], v11 offset:8192
    buffer_load_dwordx4 v[124:127], v7, s[8:11], s32 offen offset:3072 sc1
    v_mfma_f32_16x16x32_bf16 v[236:239], v[76:79], v[28:31], v[236:239]
    ds_read_b64_tr_b16 v[70:71], v11 offset:9216
    s_add_u32 s32, s32, 4096
    s_waitcnt lgkmcnt(8)
    v_mfma_f32_16x16x32_bf16 v[208:211], v[80:83], v[24:27], v[208:211]
    ds_read_b64_tr_b16 v[72:73], v12 offset:8192
    s_cmp_lt_u32 s35, 3
    s_cselect_b32 s10, 4194304, 0
    v_mfma_f32_16x16x32_bf16 v[240:243], v[80:83], v[28:31], v[240:243]
    ds_read_b64_tr_b16 v[74:75], v12 offset:9216
    s_cmp_lt_u32 s35, s52
    s_cselect_b32 s18, s18, 0
    v_mfma_f32_16x16x32_bf16 v[212:215], v[84:87], v[24:27], v[212:215]
    ds_read_b64_tr_b16 v[76:77], v13 offset:8192
    buffer_store_dwordx4 v[128:131], v58, s[16:19], s38 offen sc1
    v_mfma_f32_16x16x32_bf16 v[244:247], v[84:87], v[28:31], v[244:247]
    ds_read_b64_tr_b16 v[78:79], v13 offset:9216
    s_waitcnt lgkmcnt(8)
    v_mfma_f32_16x16x32_bf16 v[216:219], v[88:91], v[24:27], v[216:219]
    ds_read_b64_tr_b16 v[80:81], v14 offset:8192
    v_mov_b64 v[128:129], v[144:145]
    v_mfma_f32_16x16x32_bf16 v[248:251], v[88:91], v[28:31], v[248:251]
    ds_read_b64_tr_b16 v[82:83], v14 offset:9216
    v_mfma_f32_16x16x32_bf16 v[220:223], v[92:95], v[24:27], v[220:223]
    ds_read_b64_tr_b16 v[84:85], v15 offset:8192
    v_mov_b64 v[130:131], v[146:147]
    v_mfma_f32_16x16x32_bf16 v[252:255], v[92:95], v[28:31], v[252:255]
    ds_read_b64_tr_b16 v[86:87], v15 offset:9216
    s_waitcnt lgkmcnt(8)
    s_waitcnt vmcnt(23)
    v_mfma_f32_16x16x32_bf16 v[192:195], v[64:67], v[32:35], v[192:195]
    ds_read_b64_tr_b16 v[88:89], v16 offset:8192
    v_mov_b64 v[144:145], v[160:161]
    v_mfma_f32_16x16x32_bf16 v[224:227], v[64:67], v[36:39], v[224:227]
    ds_read_b64_tr_b16 v[90:91], v16 offset:9216
    v_mfma_f32_16x16x32_bf16 v[196:199], v[68:71], v[32:35], v[196:199]
    ds_read_b64_tr_b16 v[92:93], v17 offset:8192
    buffer_load_dwordx4 v[24:27], v6, s[8:11], s32 offen offset:0 sc1
    v_mov_b64 v[146:147], v[162:163]
    v_mfma_f32_16x16x32_bf16 v[228:231], v[68:71], v[36:39], v[228:231]
    ds_read_b64_tr_b16 v[94:95], v17 offset:9216
    s_waitcnt lgkmcnt(8)
    v_mfma_f32_16x16x32_bf16 v[200:203], v[72:75], v[32:35], v[200:203]
    ds_read_b64_tr_b16 v[64:65], v10 offset:16384
    v_mov_b64 v[160:161], v[176:177]
    v_mfma_f32_16x16x32_bf16 v[232:235], v[72:75], v[36:39], v[232:235]
    ds_read_b64_tr_b16 v[66:67], v10 offset:17408
    v_mfma_f32_16x16x32_bf16 v[204:207], v[76:79], v[32:35], v[204:207]
    ds_read_b64_tr_b16 v[68:69], v11 offset:16384
    buffer_load_dwordx4 v[28:31], v7, s[8:11], s32 offen offset:0 sc1
    v_mov_b64 v[162:163], v[178:179]
    v_mfma_f32_16x16x32_bf16 v[236:239], v[76:79], v[36:39], v[236:239]
    ds_read_b64_tr_b16 v[70:71], v11 offset:17408
    s_waitcnt lgkmcnt(8)
    v_mfma_f32_16x16x32_bf16 v[208:211], v[80:83], v[32:35], v[208:211]
    ds_read_b64_tr_b16 v[72:73], v12 offset:16384
    v_mfma_f32_16x16x32_bf16 v[240:243], v[80:83], v[36:39], v[240:243]
    ds_read_b64_tr_b16 v[74:75], v12 offset:17408
    v_mfma_f32_16x16x32_bf16 v[212:215], v[84:87], v[32:35], v[212:215]
    ds_read_b64_tr_b16 v[76:77], v13 offset:16384
    v_mfma_f32_16x16x32_bf16 v[244:247], v[84:87], v[36:39], v[244:247]
    ds_read_b64_tr_b16 v[78:79], v13 offset:17408
    s_waitcnt lgkmcnt(8)
    v_mfma_f32_16x16x32_bf16 v[216:219], v[88:91], v[32:35], v[216:219]
    ds_read_b64_tr_b16 v[80:81], v14 offset:16384
    v_mfma_f32_16x16x32_bf16 v[248:251], v[88:91], v[36:39], v[248:251]
    ds_read_b64_tr_b16 v[82:83], v14 offset:17408
    v_mfma_f32_16x16x32_bf16 v[220:223], v[92:95], v[32:35], v[220:223]
    ds_read_b64_tr_b16 v[84:85], v15 offset:16384
    buffer_store_dwordx4 v[132:135], v59, s[16:19], s38 offen sc1
    v_mfma_f32_16x16x32_bf16 v[252:255], v[92:95], v[36:39], v[252:255]
    ds_read_b64_tr_b16 v[86:87], v15 offset:17408
    s_waitcnt lgkmcnt(8)
    s_waitcnt vmcnt(24)
    v_mfma_f32_16x16x32_bf16 v[192:195], v[64:67], v[40:43], v[192:195]
    ds_read_b64_tr_b16 v[88:89], v16 offset:16384
    v_mov_b64 v[132:133], v[148:149]
    v_mfma_f32_16x16x32_bf16 v[224:227], v[64:67], v[44:47], v[224:227]
    ds_read_b64_tr_b16 v[90:91], v16 offset:17408
    v_mfma_f32_16x16x32_bf16 v[196:199], v[68:71], v[40:43], v[196:199]
    ds_read_b64_tr_b16 v[92:93], v17 offset:16384
    buffer_load_dwordx4 v[32:35], v6, s[8:11], s32 offen offset:1024 sc1
    v_mov_b64 v[134:135], v[150:151]
    v_mfma_f32_16x16x32_bf16 v[228:231], v[68:71], v[44:47], v[228:231]
    ds_read_b64_tr_b16 v[94:95], v17 offset:17408
    s_waitcnt lgkmcnt(8)
    v_mfma_f32_16x16x32_bf16 v[200:203], v[72:75], v[40:43], v[200:203]
    ds_read_b64_tr_b16 v[64:65], v10 offset:24576
    v_mov_b64 v[148:149], v[164:165]
    v_mfma_f32_16x16x32_bf16 v[232:235], v[72:75], v[44:47], v[232:235]
    ds_read_b64_tr_b16 v[66:67], v10 offset:25600
    v_mfma_f32_16x16x32_bf16 v[204:207], v[76:79], v[40:43], v[204:207]
    ds_read_b64_tr_b16 v[68:69], v11 offset:24576
    buffer_load_dwordx4 v[36:39], v7, s[8:11], s32 offen offset:1024 sc1
    v_mov_b64 v[150:151], v[166:167]
    v_mfma_f32_16x16x32_bf16 v[236:239], v[76:79], v[44:47], v[236:239]
    ds_read_b64_tr_b16 v[70:71], v11 offset:25600
    s_waitcnt lgkmcnt(8)
    v_mfma_f32_16x16x32_bf16 v[208:211], v[80:83], v[40:43], v[208:211]
    ds_read_b64_tr_b16 v[72:73], v12 offset:24576
    v_mov_b64 v[164:165], v[180:181]
    v_mfma_f32_16x16x32_bf16 v[240:243], v[80:83], v[44:47], v[240:243]
    ds_read_b64_tr_b16 v[74:75], v12 offset:25600
    v_mfma_f32_16x16x32_bf16 v[212:215], v[84:87], v[40:43], v[212:215]
    ds_read_b64_tr_b16 v[76:77], v13 offset:24576
    v_mov_b64 v[166:167], v[182:183]
    v_mfma_f32_16x16x32_bf16 v[244:247], v[84:87], v[44:47], v[244:247]
    ds_read_b64_tr_b16 v[78:79], v13 offset:25600
    s_waitcnt lgkmcnt(8)
    v_mfma_f32_16x16x32_bf16 v[216:219], v[88:91], v[40:43], v[216:219]
    ds_read_b64_tr_b16 v[80:81], v14 offset:24576
    v_mfma_f32_16x16x32_bf16 v[248:251], v[88:91], v[44:47], v[248:251]
    ds_read_b64_tr_b16 v[82:83], v14 offset:25600
    v_mfma_f32_16x16x32_bf16 v[220:223], v[92:95], v[40:43], v[220:223]
    ds_read_b64_tr_b16 v[84:85], v15 offset:24576
    v_mfma_f32_16x16x32_bf16 v[252:255], v[92:95], v[44:47], v[252:255]
    ds_read_b64_tr_b16 v[86:87], v15 offset:25600
    s_waitcnt lgkmcnt(8)
    s_waitcnt vmcnt(20)
    v_mfma_f32_16x16x32_bf16 v[192:195], v[64:67], v[48:51], v[192:195]
    ds_read_b64_tr_b16 v[88:89], v16 offset:24576
    v_mfma_f32_16x16x32_bf16 v[224:227], v[64:67], v[52:55], v[224:227]
    ds_read_b64_tr_b16 v[90:91], v16 offset:25600
    v_mfma_f32_16x16x32_bf16 v[196:199], v[68:71], v[48:51], v[196:199]
    ds_read_b64_tr_b16 v[92:93], v17 offset:24576
    buffer_load_dwordx4 v[40:43], v6, s[8:11], s32 offen offset:2048 sc1
    v_mfma_f32_16x16x32_bf16 v[228:231], v[68:71], v[52:55], v[228:231]
    ds_read_b64_tr_b16 v[94:95], v17 offset:25600
    s_waitcnt lgkmcnt(8)
    v_mfma_f32_16x16x32_bf16 v[200:203], v[72:75], v[48:51], v[200:203]
    v_mfma_f32_16x16x32_bf16 v[232:235], v[72:75], v[52:55], v[232:235]
    v_mfma_f32_16x16x32_bf16 v[204:207], v[76:79], v[48:51], v[204:207]
    buffer_load_dwordx4 v[44:47], v7, s[8:11], s32 offen offset:2048 sc1
    v_mfma_f32_16x16x32_bf16 v[236:239], v[76:79], v[52:55], v[236:239]
    s_cmp_ge_u32 s35, 2
    s_cbranch_scc1 L_recurrent_scan__compressed_kv_cla__moe_arch_mod__prompt_kernel_rare_48
L_recurrent_scan__compressed_kv_cla__moe_arch_mod__prompt_kernel_back_49:
    s_waitcnt lgkmcnt(0)
    s_waitcnt vmcnt(20)
    s_cmp_eq_u32 s35, s52
    s_cbranch_scc1 L_recurrent_scan__compressed_kv_cla__moe_arch_mod__prompt_kernel_rare_62
L_recurrent_scan__compressed_kv_cla__moe_arch_mod__prompt_kernel_back_63:
    s_barrier
    v_mfma_f32_16x16x32_bf16 v[208:211], v[80:83], v[48:51], v[208:211]
    ds_read_b64_tr_b16 v[64:65], v10 offset:32768
    ds_read_b64_tr_b16 v[66:67], v10 offset:33792
    v_mfma_f32_16x16x32_bf16 v[240:243], v[80:83], v[52:55], v[240:243]
    ds_read_b64_tr_b16 v[68:69], v11 offset:32768
    ds_read_b64_tr_b16 v[70:71], v11 offset:33792
    v_mfma_f32_16x16x32_bf16 v[212:215], v[84:87], v[48:51], v[212:215]
    ds_read_b64_tr_b16 v[72:73], v12 offset:32768
    ds_read_b64_tr_b16 v[74:75], v12 offset:33792
    v_mfma_f32_16x16x32_bf16 v[244:247], v[84:87], v[52:55], v[244:247]
    ds_read_b64_tr_b16 v[76:77], v13 offset:32768
    ds_read_b64_tr_b16 v[78:79], v13 offset:33792
    s_add_u32 m0, s34, 0
    v_mfma_f32_16x16x32_bf16 v[216:219], v[88:91], v[48:51], v[216:219]
    ds_read_b64_tr_b16 v[80:81], v14 offset:32768
    ds_read_b64_tr_b16 v[82:83], v14 offset:33792
    buffer_load_dwordx4 v2, s[4:7], s31 offen offset:0 sc1 lds
    v_mfma_f32_16x16x32_bf16 v[248:251], v[88:91], v[52:55], v[248:251]
    buffer_load_dwordx4 v3, s[4:7], s31 offen offset:1024 sc1 lds
    v_mfma_f32_16x16x32_bf16 v[220:223], v[92:95], v[48:51], v[220:223]
    ds_read_b64_tr_b16 v[84:85], v15 offset:32768
    ds_read_b64_tr_b16 v[86:87], v15 offset:33792
    buffer_load_dwordx4 v4, s[4:7], s31 offen offset:2048 sc1 lds
    v_mfma_f32_16x16x32_bf16 v[252:255], v[92:95], v[52:55], v[252:255]
    buffer_load_dwordx4 v5, s[4:7], s31 offen offset:3072 sc1 lds
    s_add_u32 s31, s31, s40
    s_cmp_ge_u32 s35, 2
    s_cbranch_scc1 L_recurrent_scan__compressed_kv_cla__moe_arch_mod__prompt_kernel_rare_60
L_recurrent_scan__compressed_kv_cla__moe_arch_mod__prompt_kernel_back_61:
    s_waitcnt lgkmcnt(8)
    s_waitcnt vmcnt(18)
    v_mfma_f32_16x16x32_bf16 v[192:195], v[64:67], v[96:99], v[192:195]
    ds_read_b64_tr_b16 v[88:89], v16 offset:32768
    v_mfma_f32_16x16x32_bf16 v[224:227], v[64:67], v[100:103], v[224:227]
    ds_read_b64_tr_b16 v[90:91], v16 offset:33792
    v_mfma_f32_16x16x32_bf16 v[196:199], v[68:71], v[96:99], v[196:199]
    ds_read_b64_tr_b16 v[92:93], v17 offset:32768
    buffer_load_dwordx4 v[48:51], v6, s[8:11], s32 offen offset:3072 sc1
    v_mfma_f32_16x16x32_bf16 v[228:231], v[68:71], v[100:103], v[228:231]
    ds_read_b64_tr_b16 v[94:95], v17 offset:33792
    s_waitcnt lgkmcnt(8)
    v_mfma_f32_16x16x32_bf16 v[200:203], v[72:75], v[96:99], v[200:203]
    ds_read_b64_tr_b16 v[64:65], v10 offset:40960
    v_mfma_f32_16x16x32_bf16 v[232:235], v[72:75], v[100:103], v[232:235]
    ds_read_b64_tr_b16 v[66:67], v10 offset:41984
    v_mfma_f32_16x16x32_bf16 v[204:207], v[76:79], v[96:99], v[204:207]
    ds_read_b64_tr_b16 v[68:69], v11 offset:40960
    buffer_load_dwordx4 v[52:55], v7, s[8:11], s32 offen offset:3072 sc1
    v_mfma_f32_16x16x32_bf16 v[236:239], v[76:79], v[100:103], v[236:239]
    ds_read_b64_tr_b16 v[70:71], v11 offset:41984
    s_add_u32 s32, s32, 4096
    s_waitcnt lgkmcnt(8)
    v_mfma_f32_16x16x32_bf16 v[208:211], v[80:83], v[96:99], v[208:211]
    ds_read_b64_tr_b16 v[72:73], v12 offset:40960
    v_mfma_f32_16x16x32_bf16 v[240:243], v[80:83], v[100:103], v[240:243]
    ds_read_b64_tr_b16 v[74:75], v12 offset:41984
    v_mfma_f32_16x16x32_bf16 v[212:215], v[84:87], v[96:99], v[212:215]
    ds_read_b64_tr_b16 v[76:77], v13 offset:40960
    buffer_store_dwordx4 v[136:139], v60, s[16:19], s38 offen sc1
    v_mfma_f32_16x16x32_bf16 v[244:247], v[84:87], v[100:103], v[244:247]
    ds_read_b64_tr_b16 v[78:79], v13 offset:41984
    s_waitcnt lgkmcnt(8)
    v_mfma_f32_16x16x32_bf16 v[216:219], v[88:91], v[96:99], v[216:219]
    ds_read_b64_tr_b16 v[80:81], v14 offset:40960
    v_mov_b64 v[136:137], v[152:153]
    v_mfma_f32_16x16x32_bf16 v[248:251], v[88:91], v[100:103], v[248:251]
    ds_read_b64_tr_b16 v[82:83], v14 offset:41984
    v_mfma_f32_16x16x32_bf16 v[220:223], v[92:95], v[96:99], v[220:223]
    ds_read_b64_tr_b16 v[84:85], v15 offset:40960
    v_mov_b64 v[138:139], v[154:155]
    v_mfma_f32_16x16x32_bf16 v[252:255], v[92:95], v[100:103], v[252:255]
    ds_read_b64_tr_b16 v[86:87], v15 offset:41984
    s_waitcnt lgkmcnt(8)
    s_waitcnt vmcnt(19)
    v_mfma_f32_16x16x32_bf16 v[192:195], v[64:67], v[104:107], v[192:195]
    ds_read_b64_tr_b16 v[88:89], v16 offset:40960
    v_mov_b64 v[152:153], v[168:169]
    v_mfma_f32_16x16x32_bf16 v[224:227], v[64:67], v[108:111], v[224:227]
    ds_read_b64_tr_b16 v[90:91], v16 offset:41984
    v_mfma_f32_16x16x32_bf16 v[196:199], v[68:71], v[104:107], v[196:199]
    ds_read_b64_tr_b16 v[92:93], v17 offset:40960
    buffer_load_dwordx4 v[96:99], v6, s[8:11], s32 offen offset:0 sc1
    v_mov_b64 v[154:155], v[170:171]
    v_mfma_f32_16x16x32_bf16 v[228:231], v[68:71], v[108:111], v[228:231]
    ds_read_b64_tr_b16 v[94:95], v17 offset:41984
    s_waitcnt lgkmcnt(8)
    v_mfma_f32_16x16x32_bf16 v[200:203], v[72:75], v[104:107], v[200:203]
    ds_read_b64_tr_b16 v[64:65], v10 offset:49152
    v_mov_b64 v[168:169], v[184:185]
    v_mfma_f32_16x16x32_bf16 v[232:235], v[72:75], v[108:111], v[232:235]
    ds_read_b64_tr_b16 v[66:67], v10 offset:50176
    v_mfma_f32_16x16x32_bf16 v[204:207], v[76:79], v[104:107], v[204:207]
    ds_read_b64_tr_b16 v[68:69], v11 offset:49152
    buffer_load_dwordx4 v[100:103], v7, s[8:11], s32 offen offset:0 sc1
    v_mov_b64 v[170:171], v[186:187]
    v_mfma_f32_16x16x32_bf16 v[236:239], v[76:79], v[108:111], v[236:239]
    ds_read_b64_tr_b16 v[70:71], v11 offset:50176
    s_waitcnt lgkmcnt(8)
    v_mfma_f32_16x16x32_bf16 v[208:211], v[80:83], v[104:107], v[208:211]
    ds_read_b64_tr_b16 v[72:73], v12 offset:49152
    v_mfma_f32_16x16x32_bf16 v[240:243], v[80:83], v[108:111], v[240:243]
    ds_read_b64_tr_b16 v[74:75], v12 offset:50176
    v_mfma_f32_16x16x32_bf16 v[212:215], v[84:87], v[104:107], v[212:215]
    ds_read_b64_tr_b16 v[76:77], v13 offset:49152
    v_mfma_f32_16x16x32_bf16 v[244:247], v[84:87], v[108:111], v[244:247]
    ds_read_b64_tr_b16 v[78:79], v13 offset:50176
    s_waitcnt lgkmcnt(8)
    v_mfma_f32_16x16x32_bf16 v[216:219], v[88:91], v[104:107], v[216:219]
    ds_read_b64_tr_b16 v[80:81], v14 offset:49152
    v_mfma_f32_16x16x32_bf16 v[248:251], v[88:91], v[108:111], v[248:251]
    ds_read_b64_tr_b16 v[82:83], v14 offset:50176
    v_mfma_f32_16x16x32_bf16 v[220:223], v[92:95], v[104:107], v[220:223]
    ds_read_b64_tr_b16 v[84:85], v15 offset:49152
    buffer_store_dwordx4 v[140:143], v61, s[16:19], s38 offen sc1
    v_mfma_f32_16x16x32_bf16 v[252:255], v[92:95], v[108:111], v[252:255]
    ds_read_b64_tr_b16 v[86:87], v15 offset:50176
    s_add_u32 s38, s38, s39
    s_waitcnt lgkmcnt(8)
    s_waitcnt vmcnt(20)
    v_mfma_f32_16x16x32_bf16 v[192:195], v[64:67], v[112:115], v[192:195]
    ds_read_b64_tr_b16 v[88:89], v16 offset:49152
    v_mov_b64 v[140:141], v[156:157]
    v_mfma_f32_16x16x32_bf16 v[224:227], v[64:67], v[116:119], v[224:227]
    ds_read_b64_tr_b16 v[90:91], v16 offset:50176
    v_mfma_f32_16x16x32_bf16 v[196:199], v[68:71], v[112:115], v[196:199]
    ds_read_b64_tr_b16 v[92:93], v17 offset:49152
    buffer_load_dwordx4 v[104:107], v6, s[8:11], s32 offen offset:1024 sc1
    v_mov_b64 v[142:143], v[158:159]
    v_mfma_f32_16x16x32_bf16 v[228:231], v[68:71], v[116:119], v[228:231]
    ds_read_b64_tr_b16 v[94:95], v17 offset:50176
    s_waitcnt lgkmcnt(8)
    v_mfma_f32_16x16x32_bf16 v[200:203], v[72:75], v[112:115], v[200:203]
    ds_read_b64_tr_b16 v[64:65], v10 offset:57344
    v_mov_b64 v[156:157], v[172:173]
    v_mfma_f32_16x16x32_bf16 v[232:235], v[72:75], v[116:119], v[232:235]
    ds_read_b64_tr_b16 v[66:67], v10 offset:58368
    v_xor_b32 v10, 65536, v10
    v_mfma_f32_16x16x32_bf16 v[204:207], v[76:79], v[112:115], v[204:207]
    ds_read_b64_tr_b16 v[68:69], v11 offset:57344
    buffer_load_dwordx4 v[108:111], v7, s[8:11], s32 offen offset:1024 sc1
    v_mov_b64 v[158:159], v[174:175]
    v_mfma_f32_16x16x32_bf16 v[236:239], v[76:79], v[116:119], v[236:239]
    ds_read_b64_tr_b16 v[70:71], v11 offset:58368
    v_xor_b32 v11, 65536, v11
    s_waitcnt lgkmcnt(8)
    v_mfma_f32_16x16x32_bf16 v[208:211], v[80:83], v[112:115], v[208:211]
    ds_read_b64_tr_b16 v[72:73], v12 offset:57344
    v_mov_b64 v[172:173], v[188:189]
    v_mfma_f32_16x16x32_bf16 v[240:243], v[80:83], v[116:119], v[240:243]
    ds_read_b64_tr_b16 v[74:75], v12 offset:58368
    v_xor_b32 v12, 65536, v12
    v_mfma_f32_16x16x32_bf16 v[212:215], v[84:87], v[112:115], v[212:215]
    ds_read_b64_tr_b16 v[76:77], v13 offset:57344
    v_mov_b64 v[174:175], v[190:191]
    v_mfma_f32_16x16x32_bf16 v[244:247], v[84:87], v[116:119], v[244:247]
    ds_read_b64_tr_b16 v[78:79], v13 offset:58368
    v_xor_b32 v13, 65536, v13
    s_waitcnt lgkmcnt(8)
    v_mfma_f32_16x16x32_bf16 v[216:219], v[88:91], v[112:115], v[216:219]
    ds_read_b64_tr_b16 v[80:81], v14 offset:57344
    v_mfma_f32_16x16x32_bf16 v[248:251], v[88:91], v[116:119], v[248:251]
    ds_read_b64_tr_b16 v[82:83], v14 offset:58368
    v_xor_b32 v14, 65536, v14
    v_mfma_f32_16x16x32_bf16 v[220:223], v[92:95], v[112:115], v[220:223]
    ds_read_b64_tr_b16 v[84:85], v15 offset:57344
    v_mfma_f32_16x16x32_bf16 v[252:255], v[92:95], v[116:119], v[252:255]
    ds_read_b64_tr_b16 v[86:87], v15 offset:58368
    v_xor_b32 v15, 65536, v15
    s_waitcnt lgkmcnt(8)
    s_waitcnt vmcnt(20)
    v_mfma_f32_16x16x32_bf16 v[192:195], v[64:67], v[120:123], v[192:195]
    ds_read_b64_tr_b16 v[88:89], v16 offset:57344
    v_mfma_f32_16x16x32_bf16 v[224:227], v[64:67], v[124:127], v[224:227]
    ds_read_b64_tr_b16 v[90:91], v16 offset:58368
    v_xor_b32 v16, 65536, v16
    v_mfma_f32_16x16x32_bf16 v[196:199], v[68:71], v[120:123], v[196:199]
    ds_read_b64_tr_b16 v[92:93], v17 offset:57344
    buffer_load_dwordx4 v[112:115], v6, s[8:11], s32 offen offset:2048 sc1
    v_mfma_f32_16x16x32_bf16 v[228:231], v[68:71], v[124:127], v[228:231]
    ds_read_b64_tr_b16 v[94:95], v17 offset:58368
    v_xor_b32 v17, 65536, v17
    s_waitcnt lgkmcnt(8)
    v_mfma_f32_16x16x32_bf16 v[200:203], v[72:75], v[120:123], v[200:203]
    v_mfma_f32_16x16x32_bf16 v[232:235], v[72:75], v[124:127], v[232:235]
    v_mfma_f32_16x16x32_bf16 v[204:207], v[76:79], v[120:123], v[204:207]
    buffer_load_dwordx4 v[116:119], v7, s[8:11], s32 offen offset:2048 sc1
    v_mfma_f32_16x16x32_bf16 v[236:239], v[76:79], v[124:127], v[236:239]
    s_waitcnt lgkmcnt(0)
    s_barrier
    v_mfma_f32_16x16x32_bf16 v[208:211], v[80:83], v[120:123], v[208:211]
    ds_read_b64_tr_b16 v[64:65], v10 offset:0
    ds_read_b64_tr_b16 v[66:67], v10 offset:1024
    v_mfma_f32_16x16x32_bf16 v[240:243], v[80:83], v[124:127], v[240:243]
    ds_read_b64_tr_b16 v[68:69], v11 offset:0
    ds_read_b64_tr_b16 v[70:71], v11 offset:1024
    v_mfma_f32_16x16x32_bf16 v[212:215], v[84:87], v[120:123], v[212:215]
    ds_read_b64_tr_b16 v[72:73], v12 offset:0
    ds_read_b64_tr_b16 v[74:75], v12 offset:1024
    v_mfma_f32_16x16x32_bf16 v[244:247], v[84:87], v[124:127], v[244:247]
    ds_read_b64_tr_b16 v[76:77], v13 offset:0
    ds_read_b64_tr_b16 v[78:79], v13 offset:1024
    s_add_u32 m0, s34, 32768
    v_mfma_f32_16x16x32_bf16 v[216:219], v[88:91], v[120:123], v[216:219]
    ds_read_b64_tr_b16 v[80:81], v14 offset:0
    ds_read_b64_tr_b16 v[82:83], v14 offset:1024
    buffer_load_dwordx4 v2, s[4:7], s31 offen offset:0 sc1 lds
    v_mfma_f32_16x16x32_bf16 v[248:251], v[88:91], v[124:127], v[248:251]
    buffer_load_dwordx4 v3, s[4:7], s31 offen offset:1024 sc1 lds
    v_mfma_f32_16x16x32_bf16 v[220:223], v[92:95], v[120:123], v[220:223]
    ds_read_b64_tr_b16 v[84:85], v15 offset:0
    ds_read_b64_tr_b16 v[86:87], v15 offset:1024
    buffer_load_dwordx4 v4, s[4:7], s31 offen offset:2048 sc1 lds
    v_mfma_f32_16x16x32_bf16 v[252:255], v[92:95], v[124:127], v[252:255]
    buffer_load_dwordx4 v5, s[4:7], s31 offen offset:3072 sc1 lds
    s_add_u32 s31, s31, s40
    s_xor_b32 s34, s34, 65536
    s_add_u32 s35, s35, 1
    s_cmp_lt_u32 s35, 4
    s_cbranch_scc1 L_p2_loop
    s_load_dwordx2 s[32:33], s[0:1], 40
    s_load_dwordx2 s[34:35], s[0:1], 80
    s_load_dwordx2 s[96:97], s[0:1], 0
    s_load_dwordx2 s[98:99], s[0:1], 88
    s_cmp_lt_u32 s28, 4
    s_cbranch_scc0 L_grp1
    v_mov_b32 v20, 1040356334
    v_mov_b32 v21, v20
    s_and_b32 s37, s28, 3
    s_lshl_b32 s37, s37, 13
    v_lshlrev_b32 v7, 4, v1
    v_add_u32 v4, s37, v7
    v_add_u32 v6, 4096, v4
    v_add_u32 v19, 131072, v4
    s_add_u32 s43, s37, 32768
    s_add_u32 s44, s37, 98304
    s_waitcnt vmcnt(4) lgkmcnt(0)
    v_pk_mul_f32 v[192:193], v[192:193], v[20:21]
    v_pk_mul_f32 v[194:195], v[194:195], v[20:21]
    v_pk_mul_f32 v[196:197], v[196:197], v[20:21]
    v_pk_mul_f32 v[198:199], v[198:199], v[20:21]
    v_cvt_pk_bf16_f32 v128, v192, v193
    v_cvt_pk_bf16_f32 v129, v194, v195
    v_cvt_pk_bf16_f32 v130, v196, v197
    v_cvt_pk_bf16_f32 v131, v198, v199
    ds_write_b128 v19, v[128:131] offset:0
    v_pk_mul_f32 v[200:201], v[200:201], v[20:21]
    v_pk_mul_f32 v[202:203], v[202:203], v[20:21]
    v_pk_mul_f32 v[204:205], v[204:205], v[20:21]
    v_pk_mul_f32 v[206:207], v[206:207], v[20:21]
    v_cvt_pk_bf16_f32 v132, v200, v201
    v_cvt_pk_bf16_f32 v133, v202, v203
    v_cvt_pk_bf16_f32 v134, v204, v205
    v_cvt_pk_bf16_f32 v135, v206, v207
    ds_write_b128 v19, v[132:135] offset:1024
    v_pk_mul_f32 v[208:209], v[208:209], v[20:21]
    v_pk_mul_f32 v[210:211], v[210:211], v[20:21]
    v_pk_mul_f32 v[212:213], v[212:213], v[20:21]
    v_pk_mul_f32 v[214:215], v[214:215], v[20:21]
    v_cvt_pk_bf16_f32 v136, v208, v209
    v_cvt_pk_bf16_f32 v137, v210, v211
    v_cvt_pk_bf16_f32 v138, v212, v213
    v_cvt_pk_bf16_f32 v139, v214, v215
    ds_write_b128 v19, v[136:139] offset:2048
    v_pk_mul_f32 v[216:217], v[216:217], v[20:21]
    v_pk_mul_f32 v[218:219], v[218:219], v[20:21]
    v_pk_mul_f32 v[220:221], v[220:221], v[20:21]
    v_pk_mul_f32 v[222:223], v[222:223], v[20:21]
    v_cvt_pk_bf16_f32 v140, v216, v217
    v_cvt_pk_bf16_f32 v141, v218, v219
    v_cvt_pk_bf16_f32 v142, v220, v221
    v_cvt_pk_bf16_f32 v143, v222, v223
    ds_write_b128 v19, v[140:143] offset:3072
    v_pk_mul_f32 v[224:225], v[224:225], v[20:21]
    v_pk_mul_f32 v[226:227], v[226:227], v[20:21]
    v_pk_mul_f32 v[228:229], v[228:229], v[20:21]
    v_pk_mul_f32 v[230:231], v[230:231], v[20:21]
    v_cvt_pk_bf16_f32 v144, v224, v225
    v_cvt_pk_bf16_f32 v145, v226, v227
    v_cvt_pk_bf16_f32 v146, v228, v229
    v_cvt_pk_bf16_f32 v147, v230, v231
    ds_write_b128 v19, v[144:147] offset:4096
    v_pk_mul_f32 v[232:233], v[232:233], v[20:21]
    v_pk_mul_f32 v[234:235], v[234:235], v[20:21]
    v_pk_mul_f32 v[236:237], v[236:237], v[20:21]
    v_pk_mul_f32 v[238:239], v[238:239], v[20:21]
    v_cvt_pk_bf16_f32 v148, v232, v233
    v_cvt_pk_bf16_f32 v149, v234, v235
    v_cvt_pk_bf16_f32 v150, v236, v237
    v_cvt_pk_bf16_f32 v151, v238, v239
    ds_write_b128 v19, v[148:151] offset:5120
    v_pk_mul_f32 v[240:241], v[240:241], v[20:21]
    v_pk_mul_f32 v[242:243], v[242:243], v[20:21]
    v_pk_mul_f32 v[244:245], v[244:245], v[20:21]
    v_pk_mul_f32 v[246:247], v[246:247], v[20:21]
    v_cvt_pk_bf16_f32 v152, v240, v241
    v_cvt_pk_bf16_f32 v153, v242, v243
    v_cvt_pk_bf16_f32 v154, v244, v245
    v_cvt_pk_bf16_f32 v155, v246, v247
    ds_write_b128 v19, v[152:155] offset:6144
    v_pk_mul_f32 v[248:249], v[248:249], v[20:21]
    v_pk_mul_f32 v[250:251], v[250:251], v[20:21]
    v_pk_mul_f32 v[252:253], v[252:253], v[20:21]
    v_pk_mul_f32 v[254:255], v[254:255], v[20:21]
    v_cvt_pk_bf16_f32 v156, v248, v249
    v_cvt_pk_bf16_f32 v157, v250, v251
    v_cvt_pk_bf16_f32 v158, v252, v253
    v_cvt_pk_bf16_f32 v159, v254, v255
    ds_write_b128 v19, v[156:159] offset:7168
    v_mov_b32 v2, v7
    v_and_b32 v21, 15, v1
    v_lshrrev_b32 v22, 4, v1
    v_lshlrev_b32 v22, 2, v22
    v_sub_u32 v18, v21, v22
    s_mov_b32 s40, 0
    s_mov_b32 s41, 16384
    s_mov_b32 s49, 0xffff
    s_lshl_b32 s51, s30, 1
    s_add_u32 s51, s51, 1
    s_and_b32 s50, s28, 3
    s_lshl_b32 s50, s50, 5
    v_mov_b32 v36, 0x3f803f80
    v_mov_b32 v37, 0x3f803f80
    v_mov_b32 v38, 0x3f803f80
    v_mov_b32 v39, 0x3f803f80
    s_lshl_b32 s31, 1, s51
    s_or_b32 s31, s31, 0x8000
    s_add_u32 s36, s51, 1
    s_lshl_b32 s36, -1, s36
    s_or_b32 s48, s36, 0xaaaaaaab
    s_and_b32 s48, s48, 0x7fff
    s_or_b32 s39, s36, 0x55555555
    s_and_b32 s39, s39, 0xffff
    s_add_u32 s46, s45, 65536
    s_add_u32 s47, s45, 98304
    s_mov_b64 s[52:53], 0
    s_waitcnt lgkmcnt(0)
    s_barrier
    s_add_u32 s16, s54, 41943040
    s_addc_u32 s17, s55, 0
    s_and_b32 s17, s17, 0xffff
    s_mov_b32 s18, 16777216
    s_mov_b32 s19, 0x20000
    s_mov_b32 s4, s92
    s_and_b32 s5, s93, 0xffff
    s_mov_b32 s6, 7340032
    s_mov_b32 s7, 0x20000
    s_mov_b32 s8, s94
    s_and_b32 s9, s95, 0xffff
    s_mov_b32 s10, 7340032
    s_mov_b32 s11, 0x20000
    s_and_b32 s60, s29, 3
    s_add_u32 s60, s60, 4
    s_sub_u32 s3, s2, 32
    s_cmp_eq_u32 s28, 0
    s_cselect_b32 s36, 0xad, 0x2d
    s_cselect_b32 s42, 14, 12
    s_cmp_lt_u32 s3, 224
    s_cselect_b32 s36, s36, 0
    s_lshl_b32 s36, s36, s60
    s_or_b32 s42, s42, s36
    ds_read_b128 v[64:67], v2 offset:0
    ds_read_b128 v[68:71], v2 offset:1024
    ds_read_b128 v[72:75], v2 offset:2048
    ds_read_b128 v[76:79], v2 offset:3072
    ds_read_b128 v[80:83], v2 offset:4096
    ds_read_b128 v[84:87], v2 offset:5120
    ds_read_b128 v[88:91], v2 offset:6144
    ds_read_b128 v[92:95], v2 offset:7168
    s_waitcnt lgkmcnt(7)
    v_mfma_f32_16x16x32_bf16 v[96:99], v[64:67], v[128:131], 0
    v_mov_b64 v[192:193], 0
    v_mov_b64 v[194:195], 0
    v_mfma_f32_16x16x32_bf16 v[104:107], v[64:67], v[144:147], 0
    ds_read_b128 v[64:67], v2 offset:8192
    v_mov_b64 v[196:197], 0
    v_mov_b64 v[198:199], 0
    s_waitcnt lgkmcnt(7)
    v_mfma_f32_16x16x32_bf16 v[96:99], v[68:71], v[132:135], v[96:99]
    v_mov_b64 v[200:201], 0
    v_mov_b64 v[202:203], 0
    v_mfma_f32_16x16x32_bf16 v[104:107], v[68:71], v[148:151], v[104:107]
    ds_read_b128 v[68:71], v2 offset:9216
    v_mov_b64 v[204:205], 0
    v_mov_b64 v[206:207], 0
    s_waitcnt lgkmcnt(7)
    v_mfma_f32_16x16x32_bf16 v[96:99], v[72:75], v[136:139], v[96:99]
    v_mov_b64 v[208:209], 0
    v_mfma_f32_16x16x32_bf16 v[104:107], v[72:75], v[152:155], v[104:107]
    ds_read_b128 v[72:75], v2 offset:10240
    v_mov_b64 v[210:211], 0
    v_mov_b64 v[212:213], 0
    s_waitcnt lgkmcnt(7)
    v_mfma_f32_16x16x32_bf16 v[96:99], v[76:79], v[140:143], v[96:99]
    v_mov_b64 v[214:215], 0
    v_mov_b64 v[216:217], 0
    v_mfma_f32_16x16x32_bf16 v[104:107], v[76:79], v[156:159], v[104:107]
    ds_read_b128 v[76:79], v2 offset:11264
    v_mov_b64 v[218:219], 0
    v_mov_b64 v[220:221], 0
    s_waitcnt lgkmcnt(7)
    v_mfma_f32_16x16x32_bf16 v[100:103], v[80:83], v[128:131], 0
    v_mov_b64 v[222:223], 0
    v_mov_b64 v[224:225], 0
    v_mfma_f32_16x16x32_bf16 v[108:111], v[80:83], v[144:147], 0
    ds_read_b128 v[80:83], v2 offset:12288
    v_mov_b64 v[226:227], 0
    s_waitcnt lgkmcnt(7)
    v_mfma_f32_16x16x32_bf16 v[100:103], v[84:87], v[132:135], v[100:103]
    v_mov_b64 v[228:229], 0
    v_mov_b64 v[230:231], 0
    v_mfma_f32_16x16x32_bf16 v[108:111], v[84:87], v[148:151], v[108:111]
    ds_read_b128 v[84:87], v2 offset:13312
    v_mov_b64 v[232:233], 0
    v_mov_b64 v[234:235], 0
    s_waitcnt lgkmcnt(7)
    v_mfma_f32_16x16x32_bf16 v[100:103], v[88:91], v[136:139], v[100:103]
    v_mov_b64 v[236:237], 0
    v_mov_b64 v[238:239], 0
    v_mfma_f32_16x16x32_bf16 v[108:111], v[88:91], v[152:155], v[108:111]
    ds_read_b128 v[88:91], v2 offset:14336
    v_mov_b64 v[240:241], 0
    v_mov_b64 v[242:243], 0
    s_waitcnt lgkmcnt(7)
    v_mfma_f32_16x16x32_bf16 v[100:103], v[92:95], v[140:143], v[100:103]
    v_mov_b64 v[244:245], 0
    v_mfma_f32_16x16x32_bf16 v[108:111], v[92:95], v[156:159], v[108:111]
    ds_read_b128 v[92:95], v2 offset:15360
    v_mov_b64 v[246:247], 0
    v_mov_b64 v[248:249], 0
    s_waitcnt lgkmcnt(7)
    v_mfma_f32_16x16x32_bf16 v[112:115], v[64:67], v[128:131], 0
    v_mov_b64 v[250:251], 0
    v_mov_b64 v[252:253], 0
    v_mfma_f32_16x16x32_bf16 v[120:123], v[64:67], v[144:147], 0
    v_mov_b64 v[254:255], 0
    v_mov_b64 v[28:29], 0
    s_waitcnt lgkmcnt(6)
    v_mfma_f32_16x16x32_bf16 v[112:115], v[68:71], v[132:135], v[112:115]
    v_mov_b64 v[30:31], 0
    v_mov_b64 v[32:33], 0
    v_mfma_f32_16x16x32_bf16 v[120:123], v[68:71], v[148:151], v[120:123]
    v_mov_b64 v[34:35], 0
    s_waitcnt lgkmcnt(5)
    v_mfma_f32_16x16x32_bf16 v[112:115], v[72:75], v[136:139], v[112:115]
    v_mfma_f32_16x16x32_bf16 v[120:123], v[72:75], v[152:155], v[120:123]
    v_max3_f32 v22, v96, v97, v98
    v_max3_f32 v23, v104, v105, v106
    s_waitcnt lgkmcnt(4)
    v_mfma_f32_16x16x32_bf16 v[112:115], v[76:79], v[140:143], v[112:115]
    v_max3_f32 v22, v22, v99, v100
    v_max3_f32 v23, v23, v107, v108
    v_mfma_f32_16x16x32_bf16 v[120:123], v[76:79], v[156:159], v[120:123]
    v_max3_f32 v22, v22, v101, v102
    v_max3_f32 v23, v23, v109, v110
    s_waitcnt lgkmcnt(3)
    v_mfma_f32_16x16x32_bf16 v[116:119], v[80:83], v[128:131], 0
    v_max_f32 v22, v22, v103
    v_max_f32 v23, v23, v111
    v_mfma_f32_16x16x32_bf16 v[124:127], v[80:83], v[144:147], 0
    v_mov_b32 v24, v22
    v_mov_b32 v25, v23
    s_waitcnt lgkmcnt(2)
    v_mfma_f32_16x16x32_bf16 v[116:119], v[84:87], v[132:135], v[116:119]
    v_permlane16_swap_b32 v22, v24
    v_permlane16_swap_b32 v23, v25
    v_mfma_f32_16x16x32_bf16 v[124:127], v[84:87], v[148:151], v[124:127]
    v_max_f32 v22, v22, v24
    v_max_f32 v23, v23, v25
    s_waitcnt lgkmcnt(1)
    v_mfma_f32_16x16x32_bf16 v[116:119], v[88:91], v[136:139], v[116:119]
    v_mov_b32 v24, v22
    v_mov_b32 v25, v23
    v_mfma_f32_16x16x32_bf16 v[124:127], v[88:91], v[152:155], v[124:127]
    v_permlane32_swap_b32 v22, v24
    v_permlane32_swap_b32 v23, v25
    s_waitcnt lgkmcnt(0)
    v_mfma_f32_16x16x32_bf16 v[116:119], v[92:95], v[140:143], v[116:119]
    v_max_f32 v22, v22, v24
    v_max_f32 v23, v23, v25
    v_mfma_f32_16x16x32_bf16 v[124:127], v[92:95], v[156:159], v[124:127]
    v_sub_f32 v40, 0, v22
    v_sub_f32 v41, 0, v22
    v_sub_f32 v42, 0, v22
    v_sub_f32 v43, 0, v22
    v_sub_f32 v44, 0, v23
    v_sub_f32 v45, 0, v23
    v_sub_f32 v46, 0, v23
    v_sub_f32 v47, 0, v23
    v_add_u32 v3, 65536, v2
    v_add_u32 v2, s41, v2
    v_and_b32 v2, s49, v2
    s_waitcnt vmcnt(0)
    s_barrier
    s_cmp_eq_u32 s28, 0
    s_cbranch_scc1 L_recurrent_scan__compressed_kv_cla__moe_arch_mod__prompt_kernel_rare_66
L_recurrent_scan__compressed_kv_cla__moe_arch_mod__prompt_kernel_back_67:
    ds_read_b128 v[64:67], v2 offset:0
    ds_read_b128 v[68:71], v2 offset:1024
    ds_read_b128 v[72:75], v2 offset:2048
    ds_read_b128 v[76:79], v2 offset:3072
    ds_read_b128 v[80:83], v2 offset:4096
    ds_read_b128 v[84:87], v2 offset:5120
    ds_read_b128 v[88:91], v2 offset:6144
    ds_write_b32 v19, v40
    ds_write_b32 v19, v44 offset:4
    v_pk_add_f32 v[96:97], v[96:97], v[40:41]
    v_pk_add_f32 v[98:99], v[98:99], v[40:41]
    v_pk_add_f32 v[100:101], v[100:101], v[40:41]
    v_pk_add_f32 v[102:103], v[102:103], v[40:41]
    v_pk_add_f32 v[104:105], v[104:105], v[44:45]
    v_pk_add_f32 v[106:107], v[106:107], v[44:45]
    v_pk_add_f32 v[108:109], v[108:109], v[44:45]
    v_pk_add_f32 v[110:111], v[110:111], v[44:45]
    v_pk_add_f32 v[112:113], v[112:113], v[40:41]
    v_pk_add_f32 v[114:115], v[114:115], v[40:41]
    v_pk_add_f32 v[116:117], v[116:117], v[40:41]
    v_pk_add_f32 v[118:119], v[118:119], v[40:41]
    v_pk_add_f32 v[120:121], v[120:121], v[44:45]
    v_pk_add_f32 v[122:123], v[122:123], v[44:45]
    v_pk_add_f32 v[124:125], v[124:125], v[44:45]
    v_pk_add_f32 v[126:127], v[126:127], v[44:45]
    v_exp_f32 v96, v96
    v_exp_f32 v97, v97
    v_exp_f32 v98, v98
    v_exp_f32 v99, v99
    v_exp_f32 v104, v104
    v_exp_f32 v105, v105
    v_exp_f32 v106, v106
    v_exp_f32 v107, v107
    v_exp_f32 v100, v100
    v_exp_f32 v101, v101
    v_exp_f32 v102, v102
    v_exp_f32 v103, v103
    v_exp_f32 v108, v108
    v_exp_f32 v109, v109
    v_exp_f32 v110, v110
    v_exp_f32 v111, v111
    v_cvt_pk_bf16_f32 v48, v96, v97
    v_cvt_pk_bf16_f32 v49, v98, v99
    v_cvt_pk_bf16_f32 v52, v104, v105
    v_cvt_pk_bf16_f32 v53, v106, v107
    v_cvt_pk_bf16_f32 v50, v100, v101
    v_cvt_pk_bf16_f32 v51, v102, v103
    v_cvt_pk_bf16_f32 v54, v108, v109
    v_cvt_pk_bf16_f32 v55, v110, v111
    .p2align 6
L_body0:
    s_waitcnt lgkmcnt(5)
    v_mfma_f32_16x16x32_bf16 v[96:99], v[64:67], v[128:131], v[40:43]
    v_exp_f32 v112, v112
    v_mfma_f32_16x16x32_bf16 v[104:107], v[64:67], v[144:147], v[44:47]
    ds_read_b128 v[92:95], v2 offset:7168
    s_bitcmp1_b32 s48, s40
    s_cbranch_scc0 L_recurrent_scan__compressed_kv_cla__moe_arch_mod__prompt_kernel_nodma_90
    s_add_u32 m0, s43, 0
    s_nop 0
    buffer_load_dwordx4 v4, s[12:15], s46 offen offset:0 sc1 lds
    buffer_load_dwordx4 v4, s[12:15], s46 offen offset:1024 sc1 lds
L_recurrent_scan__compressed_kv_cla__moe_arch_mod__prompt_kernel_nodma_90:
    v_mfma_f32_16x16x32_bf16 v[96:99], v[68:71], v[132:135], v[96:99]
    v_exp_f32 v113, v113
    v_mfma_f32_16x16x32_bf16 v[104:107], v[68:71], v[148:151], v[104:107]
    ds_read_b128 v[64:67], v3 offset:0
    s_waitcnt lgkmcnt(5)
    v_mfma_f32_16x16x32_bf16 v[96:99], v[72:75], v[136:139], v[96:99]
    v_exp_f32 v114, v114
    v_mfma_f32_16x16x32_bf16 v[104:107], v[72:75], v[152:155], v[104:107]
    ds_read_b128 v[68:71], v3 offset:1024
    v_cvt_pk_bf16_f32 v56, v112, v113
    s_bitcmp1_b32 s48, s40
    s_cbranch_scc0 L_recurrent_scan__compressed_kv_cla__moe_arch_mod__prompt_kernel_nodma_91
    s_add_u32 m0, s43, 0
    s_nop 0
    buffer_load_dwordx4 v4, s[12:15], s46 offen offset:2048 sc1 lds
    buffer_load_dwordx4 v4, s[12:15], s46 offen offset:3072 sc1 lds
L_recurrent_scan__compressed_kv_cla__moe_arch_mod__prompt_kernel_nodma_91:
    v_mfma_f32_16x16x32_bf16 v[96:99], v[76:79], v[140:143], v[96:99]
    v_exp_f32 v115, v115
    v_mfma_f32_16x16x32_bf16 v[104:107], v[76:79], v[156:159], v[104:107]
    ds_read_b128 v[72:75], v3 offset:2048
    s_waitcnt lgkmcnt(5)
    v_mfma_f32_16x16x32_bf16 v[100:103], v[80:83], v[128:131], v[40:43]
    v_exp_f32 v120, v120
    v_mfma_f32_16x16x32_bf16 v[108:111], v[80:83], v[144:147], v[44:47]
    ds_read_b128 v[76:79], v3 offset:3072
    v_cvt_pk_bf16_f32 v57, v114, v115
    v_mfma_f32_16x16x32_bf16 v[100:103], v[84:87], v[132:135], v[100:103]
    v_exp_f32 v121, v121
    v_mfma_f32_16x16x32_bf16 v[108:111], v[84:87], v[148:151], v[108:111]
    ds_read_b128 v[80:83], v3 offset:4096
    s_bitcmp1_b32 s48, s40
    s_cbranch_scc0 L_recurrent_scan__compressed_kv_cla__moe_arch_mod__prompt_kernel_nodma_92
    s_add_u32 m0, s43, 4096
    s_nop 0
    buffer_load_dwordx4 v6, s[12:15], s46 offen offset:0 sc1 lds
    buffer_load_dwordx4 v6, s[12:15], s46 offen offset:1024 sc1 lds
L_recurrent_scan__compressed_kv_cla__moe_arch_mod__prompt_kernel_nodma_92:
    s_waitcnt lgkmcnt(5)
    v_mfma_f32_16x16x32_bf16 v[100:103], v[88:91], v[136:139], v[100:103]
    v_exp_f32 v122, v122
    v_mfma_f32_16x16x32_bf16 v[108:111], v[88:91], v[152:155], v[108:111]
    ds_read_b128 v[84:87], v3 offset:5120
    v_cvt_pk_bf16_f32 v60, v120, v121
    v_mfma_f32_16x16x32_bf16 v[100:103], v[92:95], v[140:143], v[100:103]
    v_exp_f32 v123, v123
    v_mfma_f32_16x16x32_bf16 v[108:111], v[92:95], v[156:159], v[108:111]
    ds_read_b128 v[88:91], v3 offset:6144
    s_bitcmp1_b32 s48, s40
    s_cbranch_scc0 L_recurrent_scan__compressed_kv_cla__moe_arch_mod__prompt_kernel_nodma_93
    s_add_u32 m0, s43, 4096
    s_nop 0
    buffer_load_dwordx4 v6, s[12:15], s46 offen offset:2048 sc1 lds
    buffer_load_dwordx4 v6, s[12:15], s46 offen offset:3072 sc1 lds
    s_add_u32 s46, s46, 65536
    s_xor_b32 s43, s43, 32768
L_recurrent_scan__compressed_kv_cla__moe_arch_mod__prompt_kernel_nodma_93:
    s_waitcnt lgkmcnt(5)
    v_mfma_f32_16x16x32_bf16 v[192:195], v[64:67], v[48:51], v[192:195]
    v_exp_f32 v116, v116
    v_mfma_f32_16x16x32_bf16 v[224:227], v[64:67], v[52:55], v[224:227]
    ds_read_b128 v[92:95], v3 offset:7168
    v_cvt_pk_bf16_f32 v61, v122, v123
    v_mfma_f32_16x16x32_bf16 v[196:199], v[68:71], v[48:51], v[196:199]
    v_exp_f32 v117, v117
    v_mfma_f32_16x16x32_bf16 v[228:231], v[68:71], v[52:55], v[228:231]
    ds_read_b128 v[64:67], v2 offset:8192
    s_waitcnt lgkmcnt(5)
    v_mfma_f32_16x16x32_bf16 v[200:203], v[72:75], v[48:51], v[200:203]
    v_exp_f32 v118, v118
    v_mfma_f32_16x16x32_bf16 v[232:235], v[72:75], v[52:55], v[232:235]
    v_mfma_f32_16x16x32_bf16 v[28:31], v[36:39], v[48:51], v[28:31]
    ds_read_b128 v[68:71], v2 offset:9216
    v_cvt_pk_bf16_f32 v58, v116, v117
    s_bitcmp1_b32 s39, s40
    s_cbranch_scc0 L_recurrent_scan__compressed_kv_cla__moe_arch_mod__prompt_kernel_nodma_94
    s_add_u32 m0, s44, 0
    s_nop 0
    buffer_load_dwordx4 v4, s[12:15], s47 offen offset:0 sc1 lds
    buffer_load_dwordx4 v4, s[12:15], s47 offen offset:1024 sc1 lds
L_recurrent_scan__compressed_kv_cla__moe_arch_mod__prompt_kernel_nodma_94:
    v_mfma_f32_16x16x32_bf16 v[204:207], v[76:79], v[48:51], v[204:207]
    v_exp_f32 v119, v119
    v_mfma_f32_16x16x32_bf16 v[236:239], v[76:79], v[52:55], v[236:239]
    ds_read_b128 v[72:75], v2 offset:10240
    s_waitcnt lgkmcnt(5)
    v_mfma_f32_16x16x32_bf16 v[208:211], v[80:83], v[48:51], v[208:211]
    v_exp_f32 v124, v124
    v_mfma_f32_16x16x32_bf16 v[240:243], v[80:83], v[52:55], v[240:243]
    ds_read_b128 v[76:79], v2 offset:11264
    v_cvt_pk_bf16_f32 v59, v118, v119
    s_bitcmp1_b32 s39, s40
    s_cbranch_scc0 L_recurrent_scan__compressed_kv_cla__moe_arch_mod__prompt_kernel_nodma_95
    s_add_u32 m0, s44, 0
    s_nop 0
    buffer_load_dwordx4 v4, s[12:15], s47 offen offset:2048 sc1 lds
    buffer_load_dwordx4 v4, s[12:15], s47 offen offset:3072 sc1 lds
L_recurrent_scan__compressed_kv_cla__moe_arch_mod__prompt_kernel_nodma_95:
    v_mfma_f32_16x16x32_bf16 v[212:215], v[84:87], v[48:51], v[212:215]
    v_exp_f32 v125, v125
    v_mfma_f32_16x16x32_bf16 v[244:247], v[84:87], v[52:55], v[244:247]
    ds_read_b128 v[80:83], v2 offset:12288
    s_waitcnt lgkmcnt(5)
    v_mfma_f32_16x16x32_bf16 v[216:219], v[88:91], v[48:51], v[216:219]
    v_exp_f32 v126, v126
    v_mfma_f32_16x16x32_bf16 v[248:251], v[88:91], v[52:55], v[248:251]
    v_mfma_f32_16x16x32_bf16 v[32:35], v[36:39], v[52:55], v[32:35]
    ds_read_b128 v[84:87], v2 offset:13312
    v_cvt_pk_bf16_f32 v62, v124, v125
    v_mfma_f32_16x16x32_bf16 v[220:223], v[92:95], v[48:51], v[220:223]
    v_exp_f32 v127, v127
    v_mfma_f32_16x16x32_bf16 v[252:255], v[92:95], v[52:55], v[252:255]
    ds_read_b128 v[88:91], v2 offset:14336
    v_cvt_pk_bf16_f32 v63, v126, v127
    s_bitcmp1_b32 s39, s40
    s_cbranch_scc0 L_recurrent_scan__compressed_kv_cla__moe_arch_mod__prompt_kernel_nodma_96
    s_add_u32 m0, s44, 4096
    s_nop 0
    buffer_load_dwordx4 v6, s[12:15], s47 offen offset:0 sc1 lds
    buffer_load_dwordx4 v6, s[12:15], s47 offen offset:1024 sc1 lds
L_recurrent_scan__compressed_kv_cla__moe_arch_mod__prompt_kernel_nodma_96:
    s_bitcmp1_b32 s31, s40
    s_cbranch_scc1 L_recurrent_scan__compressed_kv_cla__moe_arch_mod__prompt_kernel_rare_72
L_recurrent_scan__compressed_kv_cla__moe_arch_mod__prompt_kernel_back_73:
    s_waitcnt lgkmcnt(5)
    v_mfma_f32_16x16x32_bf16 v[112:115], v[64:67], v[128:131], v[40:43]
    v_exp_f32 v96, v96
    v_mfma_f32_16x16x32_bf16 v[120:123], v[64:67], v[144:147], v[44:47]
    ds_read_b128 v[92:95], v2 offset:15360
    v_mfma_f32_16x16x32_bf16 v[112:115], v[68:71], v[132:135], v[112:115]
    v_exp_f32 v97, v97
    v_mfma_f32_16x16x32_bf16 v[120:123], v[68:71], v[148:151], v[120:123]
    ds_read_b128 v[64:67], v3 offset:8192
    s_bitcmp1_b32 s39, s40
    s_cbranch_scc0 L_recurrent_scan__compressed_kv_cla__moe_arch_mod__prompt_kernel_nodma_97
    s_add_u32 m0, s44, 4096
    s_nop 0
    buffer_load_dwordx4 v6, s[12:15], s47 offen offset:2048 sc1 lds
    buffer_load_dwordx4 v6, s[12:15], s47 offen offset:3072 sc1 lds
    s_add_u32 s47, s47, 65536
    s_xor_b32 s44, s44, 32768
L_recurrent_scan__compressed_kv_cla__moe_arch_mod__prompt_kernel_nodma_97:
    s_waitcnt lgkmcnt(5)
    v_mfma_f32_16x16x32_bf16 v[112:115], v[72:75], v[136:139], v[112:115]
    v_exp_f32 v98, v98
    v_mfma_f32_16x16x32_bf16 v[120:123], v[72:75], v[152:155], v[120:123]
    ds_read_b128 v[68:71], v3 offset:9216
    v_cvt_pk_bf16_f32 v48, v96, v97
    v_mfma_f32_16x16x32_bf16 v[112:115], v[76:79], v[140:143], v[112:115]
    v_exp_f32 v99, v99
    v_mfma_f32_16x16x32_bf16 v[120:123], v[76:79], v[156:159], v[120:123]
    ds_read_b128 v[72:75], v3 offset:10240
    s_waitcnt lgkmcnt(5)
    v_mfma_f32_16x16x32_bf16 v[116:119], v[80:83], v[128:131], v[40:43]
    v_exp_f32 v104, v104
    v_mfma_f32_16x16x32_bf16 v[124:127], v[80:83], v[144:147], v[44:47]
    ds_read_b128 v[76:79], v3 offset:11264
    v_cvt_pk_bf16_f32 v49, v98, v99
    v_mfma_f32_16x16x32_bf16 v[116:119], v[84:87], v[132:135], v[116:119]
    v_exp_f32 v105, v105
    v_mfma_f32_16x16x32_bf16 v[124:127], v[84:87], v[148:151], v[124:127]
    ds_read_b128 v[80:83], v3 offset:12288
    s_waitcnt lgkmcnt(5)
    v_mfma_f32_16x16x32_bf16 v[116:119], v[88:91], v[136:139], v[116:119]
    v_exp_f32 v106, v106
    v_mfma_f32_16x16x32_bf16 v[124:127], v[88:91], v[152:155], v[124:127]
    ds_read_b128 v[84:87], v3 offset:13312
    v_cvt_pk_bf16_f32 v52, v104, v105
    v_mfma_f32_16x16x32_bf16 v[116:119], v[92:95], v[140:143], v[116:119]
    v_exp_f32 v107, v107
    v_mfma_f32_16x16x32_bf16 v[124:127], v[92:95], v[156:159], v[124:127]
    ds_read_b128 v[88:91], v3 offset:14336
    s_waitcnt lgkmcnt(5)
    v_mfma_f32_16x16x32_bf16 v[192:195], v[64:67], v[56:59], v[192:195]
    v_exp_f32 v100, v100
    v_mfma_f32_16x16x32_bf16 v[224:227], v[64:67], v[60:63], v[224:227]
    ds_read_b128 v[92:95], v3 offset:15360
    v_cvt_pk_bf16_f32 v53, v106, v107
    v_mfma_f32_16x16x32_bf16 v[196:199], v[68:71], v[56:59], v[196:199]
    v_exp_f32 v101, v101
    v_mfma_f32_16x16x32_bf16 v[228:231], v[68:71], v[60:63], v[228:231]
    v_add_u32 v3, 65536, v2
    v_add_u32 v2, s41, v2
    s_waitcnt lgkmcnt(4)
    v_mfma_f32_16x16x32_bf16 v[200:203], v[72:75], v[56:59], v[200:203]
    v_exp_f32 v102, v102
    s_add_u32 s40, s40, 1
    v_and_b32 v2, s49, v2
    v_mfma_f32_16x16x32_bf16 v[232:235], v[72:75], v[60:63], v[232:235]
    v_mfma_f32_16x16x32_bf16 v[28:31], v[36:39], v[56:59], v[28:31]
    v_cvt_pk_bf16_f32 v50, v100, v101
    s_waitcnt vmcnt(8) lgkmcnt(0)
    s_cmp_le_u32 s40, s51
    s_cbranch_scc1 L_recurrent_scan__compressed_kv_cla__moe_arch_mod__prompt_kernel_rlx_74
    s_waitcnt vmcnt(0)
L_recurrent_scan__compressed_kv_cla__moe_arch_mod__prompt_kernel_rlx_74:
    s_bitcmp1_b32 s42, s40
    s_cbranch_scc1 L_recurrent_scan__compressed_kv_cla__moe_arch_mod__prompt_kernel_rare_88
L_recurrent_scan__compressed_kv_cla__moe_arch_mod__prompt_kernel_back_89:
    s_barrier
    v_mfma_f32_16x16x32_bf16 v[204:207], v[76:79], v[56:59], v[204:207]
    v_exp_f32 v103, v103
    v_mfma_f32_16x16x32_bf16 v[236:239], v[76:79], v[60:63], v[236:239]
    ds_read_b128 v[68:71], v2 offset:1024
    ds_read_b128 v[64:67], v2 offset:0
    v_mfma_f32_16x16x32_bf16 v[208:211], v[80:83], v[56:59], v[208:211]
    v_exp_f32 v108, v108
    v_mfma_f32_16x16x32_bf16 v[240:243], v[80:83], v[60:63], v[240:243]
    ds_read_b128 v[76:79], v2 offset:3072
    ds_read_b128 v[72:75], v2 offset:2048
    v_cvt_pk_bf16_f32 v51, v102, v103
    v_mfma_f32_16x16x32_bf16 v[212:215], v[84:87], v[56:59], v[212:215]
    v_exp_f32 v109, v109
    v_mfma_f32_16x16x32_bf16 v[244:247], v[84:87], v[60:63], v[244:247]
    ds_read_b128 v[80:83], v2 offset:4096
    v_mfma_f32_16x16x32_bf16 v[216:219], v[88:91], v[56:59], v[216:219]
    v_exp_f32 v110, v110
    v_mfma_f32_16x16x32_bf16 v[248:251], v[88:91], v[60:63], v[248:251]
    v_mfma_f32_16x16x32_bf16 v[32:35], v[36:39], v[60:63], v[32:35]
    ds_read_b128 v[84:87], v2 offset:5120
    v_cvt_pk_bf16_f32 v54, v108, v109
    v_mfma_f32_16x16x32_bf16 v[220:223], v[92:95], v[56:59], v[220:223]
    v_exp_f32 v111, v111
    v_mfma_f32_16x16x32_bf16 v[252:255], v[92:95], v[60:63], v[252:255]
    ds_read_b128 v[88:91], v2 offset:6144
    v_cvt_pk_bf16_f32 v55, v110, v111
    s_cmp_lg_u32 s40, 16
    s_cbranch_scc1 L_body0
    s_mov_b32 s4, s34
    s_and_b32 s5, s35, 0xffff
    s_mov_b32 s6, 7340032
    s_mov_b32 s7, 0x20000
    s_mov_b32 s8, s32
    s_and_b32 s9, s33, 0xffff
    s_mov_b32 s10, 8388608
    s_mov_b32 s11, 0x20000
    s_lshr_b32 s38, s2, 4
    s_mul_i32 s38, s38, 224
    s_and_b32 s39, s2, 15
    s_lshl_b32 s39, s39, 7
    v_lshrrev_b32 v25, 3, v1
    s_lshl_b32 s36, s28, 5
    s_add_u32 s36, s36, s38
    v_add_u32 v25, s36, v25
    v_mul_u32_u24 v25, 2048, v25
    v_add_u32 v25, s39, v25
    v_bfe_u32 v26, v1, 4, 1
    v_lshlrev_b32 v26, 1, v26
    v_and_b32 v27, 7, v1
    v_xor_b32 v26, v26, v27
    v_lshl_add_u32 v24, v26, 4, v25
    v_xor_b32 v26, 4, v26
    v_lshl_add_u32 v25, v26, 4, v25
    v_add_u32 v25, 15360, v25
    v_add_u32 v26, 30720, v24
    v_add_u32 v27, 30720, v25
    s_lshl_b32 s36, s28, 12
    s_add_u32 s36, s36, 131072
    s_cmp_lt_u32 s28, 7
    s_cselect_b32 m0, s36, 0x30000
    s_cselect_b32 s6, 7340032, 0
    buffer_load_dwordx4 v24, s[4:7], 0 offen offset:0 lds
    buffer_load_dwordx4 v25, s[4:7], 0 offen offset:1024 lds
    buffer_load_dwordx4 v26, s[4:7], 0 offen offset:2048 lds
    buffer_load_dwordx4 v27, s[4:7], 0 offen offset:3072 lds
    s_lshr_b32 s36, s2, 5
    s_add_u32 s36, s36, 48
    s_lshl_b32 s36, s36, 7
    v_mov_b32 v12, s36
    global_load_dword v11, v12, s[90:91] sc1
    s_sub_u32 s36, 32, s50
    s_cmp_lt_i32 s36, 0
    s_cbranch_scc0 L_recurrent_scan__compressed_kv_cla__moe_arch_mod__prompt_kernel_rare_98
L_recurrent_scan__compressed_kv_cla__moe_arch_mod__prompt_kernel_back_99:
    s_waitcnt lgkmcnt(5)
    v_mfma_f32_16x16x32_bf16 v[192:195], v[64:67], v[48:51], v[192:195]
    v_exp_f32 v112, v112
    v_mfma_f32_16x16x32_bf16 v[224:227], v[64:67], v[52:55], v[224:227]
    ds_read_b128 v[92:95], v3 offset:7168
    v_exp_f32 v113, v113
    v_mfma_f32_16x16x32_bf16 v[196:199], v[68:71], v[48:51], v[196:199]
    v_cvt_pk_bf16_f32 v56, v112, v113
    v_exp_f32 v114, v114
    v_mfma_f32_16x16x32_bf16 v[228:231], v[68:71], v[52:55], v[228:231]
    ds_read_b128 v[64:67], v3 offset:8192
    v_exp_f32 v115, v115
    s_waitcnt lgkmcnt(5)
    v_mfma_f32_16x16x32_bf16 v[200:203], v[72:75], v[48:51], v[200:203]
    v_cvt_pk_bf16_f32 v57, v114, v115
    v_exp_f32 v120, v120
    v_mfma_f32_16x16x32_bf16 v[232:235], v[72:75], v[52:55], v[232:235]
    v_mfma_f32_16x16x32_bf16 v[28:31], v[36:39], v[48:51], v[28:31]
    ds_read_b128 v[68:71], v3 offset:9216
    v_exp_f32 v121, v121
    v_mfma_f32_16x16x32_bf16 v[204:207], v[76:79], v[48:51], v[204:207]
    v_cvt_pk_bf16_f32 v60, v120, v121
    v_exp_f32 v122, v122
    v_mfma_f32_16x16x32_bf16 v[236:239], v[76:79], v[52:55], v[236:239]
    ds_read_b128 v[72:75], v3 offset:10240
    v_exp_f32 v123, v123
    s_waitcnt lgkmcnt(6)
    v_mfma_f32_16x16x32_bf16 v[208:211], v[80:83], v[48:51], v[208:211]
    v_cvt_pk_bf16_f32 v61, v122, v123
    v_exp_f32 v116, v116
    v_mfma_f32_16x16x32_bf16 v[240:243], v[80:83], v[52:55], v[240:243]
    ds_read_b128 v[76:79], v3 offset:11264
    v_exp_f32 v117, v117
    s_waitcnt lgkmcnt(6)
    v_mfma_f32_16x16x32_bf16 v[212:215], v[84:87], v[48:51], v[212:215]
    v_cvt_pk_bf16_f32 v58, v116, v117
    v_exp_f32 v118, v118
    v_mfma_f32_16x16x32_bf16 v[244:247], v[84:87], v[52:55], v[244:247]
    ds_read_b128 v[80:83], v3 offset:12288
    v_exp_f32 v119, v119
    s_waitcnt lgkmcnt(6)
    v_mfma_f32_16x16x32_bf16 v[216:219], v[88:91], v[48:51], v[216:219]
    v_cvt_pk_bf16_f32 v59, v118, v119
    v_exp_f32 v124, v124
    v_mfma_f32_16x16x32_bf16 v[248:251], v[88:91], v[52:55], v[248:251]
    v_mfma_f32_16x16x32_bf16 v[32:35], v[36:39], v[52:55], v[32:35]
    ds_read_b128 v[84:87], v3 offset:13312
    v_exp_f32 v125, v125
    s_waitcnt lgkmcnt(6)
    v_mfma_f32_16x16x32_bf16 v[220:223], v[92:95], v[48:51], v[220:223]
    v_cvt_pk_bf16_f32 v62, v124, v125
    v_exp_f32 v126, v126
    v_mfma_f32_16x16x32_bf16 v[252:255], v[92:95], v[52:55], v[252:255]
    ds_read_b128 v[88:91], v3 offset:14336
    v_exp_f32 v127, v127
    s_nop 0
    v_cvt_pk_bf16_f32 v63, v126, v127
    s_nop 1
    s_waitcnt lgkmcnt(6)
    v_mfma_f32_16x16x32_bf16 v[192:195], v[64:67], v[56:59], v[192:195]
    v_mfma_f32_16x16x32_bf16 v[224:227], v[64:67], v[60:63], v[224:227]
    ds_read_b128 v[92:95], v3 offset:15360
    s_waitcnt lgkmcnt(6)
    v_mfma_f32_16x16x32_bf16 v[196:199], v[68:71], v[56:59], v[196:199]
    v_mfma_f32_16x16x32_bf16 v[228:231], v[68:71], v[60:63], v[228:231]
    s_waitcnt lgkmcnt(5)
    v_mfma_f32_16x16x32_bf16 v[200:203], v[72:75], v[56:59], v[200:203]
    v_mfma_f32_16x16x32_bf16 v[232:235], v[72:75], v[60:63], v[232:235]
    v_mfma_f32_16x16x32_bf16 v[28:31], v[36:39], v[56:59], v[28:31]
    s_waitcnt lgkmcnt(4)
    v_mfma_f32_16x16x32_bf16 v[204:207], v[76:79], v[56:59], v[204:207]
    v_mfma_f32_16x16x32_bf16 v[236:239], v[76:79], v[60:63], v[236:239]
    s_waitcnt lgkmcnt(3)
    v_mfma_f32_16x16x32_bf16 v[208:211], v[80:83], v[56:59], v[208:211]
    v_mfma_f32_16x16x32_bf16 v[240:243], v[80:83], v[60:63], v[240:243]
    s_waitcnt lgkmcnt(2)
    v_mfma_f32_16x16x32_bf16 v[212:215], v[84:87], v[56:59], v[212:215]
    v_mfma_f32_16x16x32_bf16 v[244:247], v[84:87], v[60:63], v[244:247]
    s_waitcnt lgkmcnt(1)
    v_mfma_f32_16x16x32_bf16 v[216:219], v[88:91], v[56:59], v[216:219]
    v_mfma_f32_16x16x32_bf16 v[248:251], v[88:91], v[60:63], v[248:251]
    v_mfma_f32_16x16x32_bf16 v[32:35], v[36:39], v[60:63], v[32:35]
    s_waitcnt lgkmcnt(0)
    v_mfma_f32_16x16x32_bf16 v[220:223], v[92:95], v[56:59], v[220:223]
    v_mfma_f32_16x16x32_bf16 v[252:255], v[92:95], v[60:63], v[252:255]
    s_waitcnt vmcnt(0)
    v_readfirstlane_b32 s36, v11
    s_nop 0
    s_cmp_lt_u32 s36, 28
    s_cbranch_scc1 L_recurrent_scan__compressed_kv_cla__moe_arch_mod__prompt_kernel_rare_102
L_recurrent_scan__compressed_kv_cla__moe_arch_mod__prompt_kernel_back_103:
    s_lshr_b32 s36, s2, 4
    s_mul_i32 s36, s36, 7
    s_min_u32 s37, s28, 6
    s_add_u32 s36, s36, s37
    s_lshl_b32 s36, s36, 11
    s_add_u32 s36, s36, 58720256
    v_and_b32 v11, 15, v1
    v_lshlrev_b32 v11, 4, v11
    v_lshrrev_b32 v12, 4, v1
    v_lshl_add_u32 v11, v12, 9, v11
    buffer_load_dwordx4 v[96:99], v11, s[24:27], s36 offen offset:0 sc1
    buffer_load_dwordx4 v[100:103], v11, s[24:27], s36 offen offset:256 sc1
    s_lshl_b32 s37, s28, 13
    v_add_u32 v105, s37, v7
    v_xor_b32 v106, 32768, v105
    s_lshl_b32 s37, s28, 8
    s_add_u32 s37, s37, 159744
    v_lshl_add_u32 v107, v1, 2, s37
    v_xor_b32 v108, 1024, v107
    ds_write_b32 v107, v32
    s_mov_b32 s36, 0x5d800000
    v_cmp_nge_f32 vcc, s36, v28
    s_nop 0
    s_or_b64 s[52:53], s[52:53], vcc
    v_cmp_nge_f32 vcc, s36, v32
    s_nop 0
    s_or_b64 s[52:53], s[52:53], vcc
    s_or_b32 s36, s52, s53
    v_mov_b32 v110, s36
    s_lshl_b32 s37, s28, 2
    s_add_u32 s37, s37, 161792
    v_mov_b32 v111, s37
    ds_write_b32 v111, v110
    ds_write_b128 v105, v[224:227] offset:0
    ds_write_b128 v105, v[228:231] offset:1024
    ds_write_b128 v105, v[232:235] offset:2048
    ds_write_b128 v105, v[236:239] offset:3072
    ds_write_b128 v105, v[240:243] offset:4096
    ds_write_b128 v105, v[244:247] offset:5120
    ds_write_b128 v105, v[248:251] offset:6144
    ds_write_b128 v105, v[252:255] offset:7168
    v_mov_b32 v112, 161856
    v_mov_b32 v114, s56
    v_mov_b32 v115, s57
    v_mov_b32 v116, s58
    v_mov_b32 v117, s59
    ds_write_b128 v112, v[114:117]
    v_and_b32 v111, 7, v1
    v_lshlrev_b32 v111, 2, v111
    v_add_u32 v111, 161792, v111
    s_sub_u32 s36, 15, s30
    s_lshl_b32 s38, s36, 3
    s_and_b32 s37, s28, 3
    s_lshl_b32 s37, s37, 1
    s_add_u32 s38, s38, s37
    s_lshl_b32 s38, s38, 17
    s_lshl_b32 s37, s29, 12
    s_add_u32 s38, s38, s37
    s_waitcnt lgkmcnt(0)
    s_barrier
    ds_read_b32 v110, v111
    ds_read_b32 v109, v108
    ds_read_b128 v[64:67], v106 offset:0
    ds_read_b128 v[68:71], v106 offset:1024
    ds_read_b128 v[72:75], v106 offset:2048
    ds_read_b128 v[76:79], v106 offset:3072
    ds_read_b128 v[80:83], v106 offset:4096
    ds_read_b128 v[84:87], v106 offset:5120
    ds_read_b128 v[88:91], v106 offset:6144
    ds_read_b128 v[92:95], v106 offset:7168
    s_waitcnt lgkmcnt(8)
    v_add_f32 v109, v109, v28
    v_cmp_ne_u32 s[52:53], 0, v110
    v_rcp_f32 v109, v109
    s_nop 0
    v_mov_b32 v108, v109
    s_waitcnt lgkmcnt(6)
    v_pk_add_f32 v[192:193], v[192:193], v[64:65]
    v_pk_add_f32 v[194:195], v[194:195], v[66:67]
    v_pk_add_f32 v[196:197], v[196:197], v[68:69]
    v_pk_add_f32 v[198:199], v[198:199], v[70:71]
    v_pk_mul_f32 v[192:193], v[192:193], v[108:109]
    v_pk_mul_f32 v[194:195], v[194:195], v[108:109]
    v_pk_mul_f32 v[196:197], v[196:197], v[108:109]
    v_pk_mul_f32 v[198:199], v[198:199], v[108:109]
    v_cvt_pk_bf16_f32 v48, v192, v193
    v_cvt_pk_bf16_f32 v49, v194, v195
    v_cvt_pk_bf16_f32 v50, v196, v197
    v_cvt_pk_bf16_f32 v51, v198, v199
    buffer_store_dwordx4 v[48:51], v7, s[16:19], s38 offen offset:0 sc1
    s_waitcnt lgkmcnt(4)
    v_pk_add_f32 v[200:201], v[200:201], v[72:73]
    v_pk_add_f32 v[202:203], v[202:203], v[74:75]
    v_pk_add_f32 v[204:205], v[204:205], v[76:77]
    v_pk_add_f32 v[206:207], v[206:207], v[78:79]
    v_pk_mul_f32 v[200:201], v[200:201], v[108:109]
    v_pk_mul_f32 v[202:203], v[202:203], v[108:109]
    v_pk_mul_f32 v[204:205], v[204:205], v[108:109]
    v_pk_mul_f32 v[206:207], v[206:207], v[108:109]
    v_cvt_pk_bf16_f32 v52, v200, v201
    v_cvt_pk_bf16_f32 v53, v202, v203
    v_cvt_pk_bf16_f32 v54, v204, v205
    v_cvt_pk_bf16_f32 v55, v206, v207
    buffer_store_dwordx4 v[52:55], v7, s[16:19], s38 offen offset:1024 sc1
    s_waitcnt lgkmcnt(2)
    v_pk_add_f32 v[208:209], v[208:209], v[80:81]
    v_pk_add_f32 v[210:211], v[210:211], v[82:83]
    v_pk_add_f32 v[212:213], v[212:213], v[84:85]
    v_pk_add_f32 v[214:215], v[214:215], v[86:87]
    v_pk_mul_f32 v[208:209], v[208:209], v[108:109]
    v_pk_mul_f32 v[210:211], v[210:211], v[108:109]
    v_pk_mul_f32 v[212:213], v[212:213], v[108:109]
    v_pk_mul_f32 v[214:215], v[214:215], v[108:109]
    v_cvt_pk_bf16_f32 v56, v208, v209
    v_cvt_pk_bf16_f32 v57, v210, v211
    v_cvt_pk_bf16_f32 v58, v212, v213
    v_cvt_pk_bf16_f32 v59, v214, v215
    buffer_store_dwordx4 v[56:59], v7, s[16:19], s38 offen offset:2048 sc1
    s_waitcnt lgkmcnt(0)
    v_pk_add_f32 v[216:217], v[216:217], v[88:89]
    v_pk_add_f32 v[218:219], v[218:219], v[90:91]
    v_pk_add_f32 v[220:221], v[220:221], v[92:93]
    v_pk_add_f32 v[222:223], v[222:223], v[94:95]
    v_pk_mul_f32 v[216:217], v[216:217], v[108:109]
    v_pk_mul_f32 v[218:219], v[218:219], v[108:109]
    v_pk_mul_f32 v[220:221], v[220:221], v[108:109]
    v_pk_mul_f32 v[222:223], v[222:223], v[108:109]
    v_cvt_pk_bf16_f32 v60, v216, v217
    v_cvt_pk_bf16_f32 v61, v218, v219
    v_cvt_pk_bf16_f32 v62, v220, v221
    v_cvt_pk_bf16_f32 v63, v222, v223
    buffer_store_dwordx4 v[60:63], v7, s[16:19], s38 offen offset:3072 sc1
    s_cmp_eq_u64 s[52:53], 0
    s_cbranch_scc1 L_p3_done
    s_waitcnt vmcnt(0)
    v_mov_b32 v112, v96
    v_mov_b32 v113, v97
    v_mov_b32 v114, v98
    v_mov_b32 v115, v99
    v_mov_b32 v116, v100
    v_mov_b32 v117, v101
    v_mov_b32 v118, v102
    v_mov_b32 v119, v103
    v_mov_b32 v192, 0
    v_mov_b32 v193, 0
    v_mov_b32 v194, 0
    v_mov_b32 v195, 0
    v_mov_b32 v196, 0
    v_mov_b32 v197, 0
    v_mov_b32 v198, 0
    v_mov_b32 v199, 0
    v_mov_b32 v200, 0
    v_mov_b32 v201, 0
    v_mov_b32 v202, 0
    v_mov_b32 v203, 0
    v_mov_b32 v204, 0
    v_mov_b32 v205, 0
    v_mov_b32 v206, 0
    v_mov_b32 v207, 0
    v_mov_b32 v208, 0
    v_mov_b32 v209, 0
    v_mov_b32 v210, 0
    v_mov_b32 v211, 0
    v_mov_b32 v212, 0
    v_mov_b32 v213, 0
    v_mov_b32 v214, 0
    v_mov_b32 v215, 0
    v_mov_b32 v216, 0
    v_mov_b32 v217, 0
    v_mov_b32 v218, 0
    v_mov_b32 v219, 0
    v_mov_b32 v220, 0
    v_mov_b32 v221, 0
    v_mov_b32 v222, 0
    v_mov_b32 v223, 0
    v_mov_b32 v224, 0
    v_mov_b32 v225, 0
    v_mov_b32 v226, 0
    v_mov_b32 v227, 0
    v_mov_b32 v228, 0
    v_mov_b32 v229, 0
    v_mov_b32 v230, 0
    v_mov_b32 v231, 0
    v_mov_b32 v232, 0
    v_mov_b32 v233, 0
    v_mov_b32 v234, 0
    v_mov_b32 v235, 0
    v_mov_b32 v236, 0
    v_mov_b32 v237, 0
    v_mov_b32 v238, 0
    v_mov_b32 v239, 0
    v_mov_b32 v240, 0
    v_mov_b32 v241, 0
    v_mov_b32 v242, 0
    v_mov_b32 v243, 0
    v_mov_b32 v244, 0
    v_mov_b32 v245, 0
    v_mov_b32 v246, 0
    v_mov_b32 v247, 0
    v_mov_b32 v248, 0
    v_mov_b32 v249, 0
    v_mov_b32 v250, 0
    v_mov_b32 v251, 0
    v_mov_b32 v252, 0
    v_mov_b32 v253, 0
    v_mov_b32 v254, 0
    v_mov_b32 v255, 0
    v_mov_b32 v28, 0
    v_mov_b32 v40, 4048155338
    v_mov_b32 v32, 0
    v_mov_b32 v41, 4048155338
    s_lshl_b32 s43, s28, 12
    v_add_u32 v4, s43, v7
    s_mov_b32 s46, s45
    s_sub_u32 s40, 16, s30
    s_sub_u32 s39, 15, s30
    s_lshl_b32 s37, s39, 7
    s_and_b32 s36, s28, 3
    s_lshl_b32 s36, s36, 5
    s_add_u32 s36, s36, s37
    s_sub_u32 s50, 0, s36
L_recurrent_scan__compressed_kv_cla__moe_arch_mod__prompt_kernel_stile_104:
    s_waitcnt vmcnt(0) lgkmcnt(0)
    s_barrier
    s_mov_b32 m0, s43
    s_add_u32 s47, s46, 32768
    buffer_load_dwordx4 v4, s[12:15], s46 offen offset:0 sc1 lds
    buffer_load_dwordx4 v4, s[12:15], s46 offen offset:1024 sc1 lds
    buffer_load_dwordx4 v4, s[12:15], s46 offen offset:2048 sc1 lds
    buffer_load_dwordx4 v4, s[12:15], s46 offen offset:3072 sc1 lds
    s_add_u32 m0, s43, 32768
    s_add_u32 s46, s46, 65536
    buffer_load_dwordx4 v4, s[12:15], s47 offen offset:0 sc1 lds
    buffer_load_dwordx4 v4, s[12:15], s47 offen offset:1024 sc1 lds
    buffer_load_dwordx4 v4, s[12:15], s47 offen offset:2048 sc1 lds
    buffer_load_dwordx4 v4, s[12:15], s47 offen offset:3072 sc1 lds
    v_mov_b32 v2, v7
    s_mov_b32 s41, 4
    s_waitcnt vmcnt(0)
    s_barrier
L_recurrent_scan__compressed_kv_cla__moe_arch_mod__prompt_kernel_sunit_105:
    s_cmp_gt_i32 s50, 0
    s_cbranch_scc1 L_recurrent_scan__compressed_kv_cla__moe_arch_mod__prompt_kernel_snext_106
    ds_read_b128 v[64:67], v2 offset:0
    ds_read_b128 v[68:71], v2 offset:1024
    ds_read_b128 v[72:75], v2 offset:2048
    ds_read_b128 v[76:79], v2 offset:3072
    ds_read_b128 v[80:83], v2 offset:4096
    ds_read_b128 v[84:87], v2 offset:5120
    ds_read_b128 v[88:91], v2 offset:6144
    ds_read_b128 v[92:95], v2 offset:7168
    s_waitcnt lgkmcnt(0)
    v_mfma_f32_16x16x32_bf16 v[96:99], v[64:67], v[128:131], 0
    v_mfma_f32_16x16x32_bf16 v[104:107], v[64:67], v[144:147], 0
    v_mfma_f32_16x16x32_bf16 v[96:99], v[68:71], v[132:135], v[96:99]
    v_mfma_f32_16x16x32_bf16 v[104:107], v[68:71], v[148:151], v[104:107]
    v_mfma_f32_16x16x32_bf16 v[96:99], v[72:75], v[136:139], v[96:99]
    v_mfma_f32_16x16x32_bf16 v[104:107], v[72:75], v[152:155], v[104:107]
    v_mfma_f32_16x16x32_bf16 v[96:99], v[76:79], v[140:143], v[96:99]
    v_mfma_f32_16x16x32_bf16 v[104:107], v[76:79], v[156:159], v[104:107]
    v_mfma_f32_16x16x32_bf16 v[100:103], v[80:83], v[128:131], 0
    v_mfma_f32_16x16x32_bf16 v[108:111], v[80:83], v[144:147], 0
    v_mfma_f32_16x16x32_bf16 v[100:103], v[84:87], v[132:135], v[100:103]
    v_mfma_f32_16x16x32_bf16 v[108:111], v[84:87], v[148:151], v[108:111]
    v_mfma_f32_16x16x32_bf16 v[100:103], v[88:91], v[136:139], v[100:103]
    v_mfma_f32_16x16x32_bf16 v[108:111], v[88:91], v[152:155], v[108:111]
    v_mfma_f32_16x16x32_bf16 v[100:103], v[92:95], v[140:143], v[100:103]
    v_mfma_f32_16x16x32_bf16 v[108:111], v[92:95], v[156:159], v[108:111]
    ds_read_b128 v[64:67], v2 offset:32768
    ds_read_b128 v[68:71], v2 offset:33792
    ds_read_b128 v[72:75], v2 offset:34816
    ds_read_b128 v[76:79], v2 offset:35840
    ds_read_b128 v[80:83], v2 offset:36864
    ds_read_b128 v[84:87], v2 offset:37888
    ds_read_b128 v[88:91], v2 offset:38912
    ds_read_b128 v[92:95], v2 offset:39936
    s_nop 1
    s_cmp_lt_i32 s50, 0
    s_cbranch_scc0 L_recurrent_scan__compressed_kv_cla__moe_arch_mod__prompt_kernel_rare_107
L_recurrent_scan__compressed_kv_cla__moe_arch_mod__prompt_kernel_back_108:
    v_max3_f32 v22, v96, v97, v98
    v_max3_f32 v22, v22, v99, v100
    v_max3_f32 v22, v22, v101, v102
    v_max3_f32 v22, v22, v103, v40
    v_mov_b32 v24, v22
    s_nop 1
    v_permlane16_swap_b32 v22, v24
    s_nop 1
    v_max_f32 v22, v22, v24
    v_mov_b32 v24, v22
    s_nop 1
    v_permlane32_swap_b32 v22, v24
    s_nop 1
    v_max_f32 v22, v22, v24
    v_sub_f32 v25, v40, v22
    v_exp_f32 v25, v25
    v_mov_b32 v40, v22
    v_mul_f32 v28, v28, v25
    v_mul_f32 v192, v192, v25
    v_mul_f32 v193, v193, v25
    v_mul_f32 v194, v194, v25
    v_mul_f32 v195, v195, v25
    v_mul_f32 v196, v196, v25
    v_mul_f32 v197, v197, v25
    v_mul_f32 v198, v198, v25
    v_mul_f32 v199, v199, v25
    v_mul_f32 v200, v200, v25
    v_mul_f32 v201, v201, v25
    v_mul_f32 v202, v202, v25
    v_mul_f32 v203, v203, v25
    v_mul_f32 v204, v204, v25
    v_mul_f32 v205, v205, v25
    v_mul_f32 v206, v206, v25
    v_mul_f32 v207, v207, v25
    v_mul_f32 v208, v208, v25
    v_mul_f32 v209, v209, v25
    v_mul_f32 v210, v210, v25
    v_mul_f32 v211, v211, v25
    v_mul_f32 v212, v212, v25
    v_mul_f32 v213, v213, v25
    v_mul_f32 v214, v214, v25
    v_mul_f32 v215, v215, v25
    v_mul_f32 v216, v216, v25
    v_mul_f32 v217, v217, v25
    v_mul_f32 v218, v218, v25
    v_mul_f32 v219, v219, v25
    v_mul_f32 v220, v220, v25
    v_mul_f32 v221, v221, v25
    v_mul_f32 v222, v222, v25
    v_mul_f32 v223, v223, v25
    v_sub_f32 v96, v96, v22
    v_sub_f32 v97, v97, v22
    v_sub_f32 v98, v98, v22
    v_sub_f32 v99, v99, v22
    v_sub_f32 v100, v100, v22
    v_sub_f32 v101, v101, v22
    v_sub_f32 v102, v102, v22
    v_sub_f32 v103, v103, v22
    v_max3_f32 v23, v104, v105, v106
    v_max3_f32 v23, v23, v107, v108
    v_max3_f32 v23, v23, v109, v110
    v_max3_f32 v23, v23, v111, v41
    v_mov_b32 v24, v23
    s_nop 1
    v_permlane16_swap_b32 v23, v24
    s_nop 1
    v_max_f32 v23, v23, v24
    v_mov_b32 v24, v23
    s_nop 1
    v_permlane32_swap_b32 v23, v24
    s_nop 1
    v_max_f32 v23, v23, v24
    v_sub_f32 v25, v41, v23
    v_exp_f32 v25, v25
    v_mov_b32 v41, v23
    v_mul_f32 v32, v32, v25
    v_mul_f32 v224, v224, v25
    v_mul_f32 v225, v225, v25
    v_mul_f32 v226, v226, v25
    v_mul_f32 v227, v227, v25
    v_mul_f32 v228, v228, v25
    v_mul_f32 v229, v229, v25
    v_mul_f32 v230, v230, v25
    v_mul_f32 v231, v231, v25
    v_mul_f32 v232, v232, v25
    v_mul_f32 v233, v233, v25
    v_mul_f32 v234, v234, v25
    v_mul_f32 v235, v235, v25
    v_mul_f32 v236, v236, v25
    v_mul_f32 v237, v237, v25
    v_mul_f32 v238, v238, v25
    v_mul_f32 v239, v239, v25
    v_mul_f32 v240, v240, v25
    v_mul_f32 v241, v241, v25
    v_mul_f32 v242, v242, v25
    v_mul_f32 v243, v243, v25
    v_mul_f32 v244, v244, v25
    v_mul_f32 v245, v245, v25
    v_mul_f32 v246, v246, v25
    v_mul_f32 v247, v247, v25
    v_mul_f32 v248, v248, v25
    v_mul_f32 v249, v249, v25
    v_mul_f32 v250, v250, v25
    v_mul_f32 v251, v251, v25
    v_mul_f32 v252, v252, v25
    v_mul_f32 v253, v253, v25
    v_mul_f32 v254, v254, v25
    v_mul_f32 v255, v255, v25
    v_sub_f32 v104, v104, v23
    v_sub_f32 v105, v105, v23
    v_sub_f32 v106, v106, v23
    v_sub_f32 v107, v107, v23
    v_sub_f32 v108, v108, v23
    v_sub_f32 v109, v109, v23
    v_sub_f32 v110, v110, v23
    v_sub_f32 v111, v111, v23
    v_exp_f32 v96, v96
    v_exp_f32 v97, v97
    v_exp_f32 v98, v98
    v_exp_f32 v99, v99
    v_exp_f32 v104, v104
    v_exp_f32 v105, v105
    v_exp_f32 v106, v106
    v_exp_f32 v107, v107
    v_exp_f32 v100, v100
    v_exp_f32 v101, v101
    v_exp_f32 v102, v102
    v_exp_f32 v103, v103
    v_exp_f32 v108, v108
    v_exp_f32 v109, v109
    v_exp_f32 v110, v110
    v_exp_f32 v111, v111
    v_add_f32 v28, v28, v96
    v_add_f32 v28, v28, v97
    v_cvt_pk_bf16_f32 v48, v96, v97
    v_add_f32 v28, v28, v98
    v_add_f32 v28, v28, v99
    v_cvt_pk_bf16_f32 v49, v98, v99
    v_add_f32 v32, v32, v104
    v_add_f32 v32, v32, v105
    v_cvt_pk_bf16_f32 v52, v104, v105
    v_add_f32 v32, v32, v106
    v_add_f32 v32, v32, v107
    v_cvt_pk_bf16_f32 v53, v106, v107
    v_add_f32 v28, v28, v100
    v_add_f32 v28, v28, v101
    v_cvt_pk_bf16_f32 v50, v100, v101
    v_add_f32 v28, v28, v102
    v_add_f32 v28, v28, v103
    v_cvt_pk_bf16_f32 v51, v102, v103
    v_add_f32 v32, v32, v108
    v_add_f32 v32, v32, v109
    v_cvt_pk_bf16_f32 v54, v108, v109
    v_add_f32 v32, v32, v110
    v_add_f32 v32, v32, v111
    v_cvt_pk_bf16_f32 v55, v110, v111
    s_waitcnt lgkmcnt(0)
    s_nop 0
    v_mfma_f32_16x16x32_bf16 v[192:195], v[64:67], v[48:51], v[192:195]
    v_mfma_f32_16x16x32_bf16 v[224:227], v[64:67], v[52:55], v[224:227]
    v_mfma_f32_16x16x32_bf16 v[196:199], v[68:71], v[48:51], v[196:199]
    v_mfma_f32_16x16x32_bf16 v[228:231], v[68:71], v[52:55], v[228:231]
    v_mfma_f32_16x16x32_bf16 v[200:203], v[72:75], v[48:51], v[200:203]
    v_mfma_f32_16x16x32_bf16 v[232:235], v[72:75], v[52:55], v[232:235]
    v_mfma_f32_16x16x32_bf16 v[204:207], v[76:79], v[48:51], v[204:207]
    v_mfma_f32_16x16x32_bf16 v[236:239], v[76:79], v[52:55], v[236:239]
    v_mfma_f32_16x16x32_bf16 v[208:211], v[80:83], v[48:51], v[208:211]
    v_mfma_f32_16x16x32_bf16 v[240:243], v[80:83], v[52:55], v[240:243]
    v_mfma_f32_16x16x32_bf16 v[212:215], v[84:87], v[48:51], v[212:215]
    v_mfma_f32_16x16x32_bf16 v[244:247], v[84:87], v[52:55], v[244:247]
    v_mfma_f32_16x16x32_bf16 v[216:219], v[88:91], v[48:51], v[216:219]
    v_mfma_f32_16x16x32_bf16 v[248:251], v[88:91], v[52:55], v[248:251]
    v_mfma_f32_16x16x32_bf16 v[220:223], v[92:95], v[48:51], v[220:223]
    v_mfma_f32_16x16x32_bf16 v[252:255], v[92:95], v[52:55], v[252:255]
L_recurrent_scan__compressed_kv_cla__moe_arch_mod__prompt_kernel_snext_106:
    v_add_u32 v2, 8192, v2
    s_add_u32 s50, s50, 32
    s_sub_u32 s41, s41, 1
    s_cmp_lg_u32 s41, 0
    s_cbranch_scc1 L_recurrent_scan__compressed_kv_cla__moe_arch_mod__prompt_kernel_sunit_105
    s_sub_u32 s40, s40, 1
    s_cmp_lg_u32 s40, 0
    s_cbranch_scc1 L_recurrent_scan__compressed_kv_cla__moe_arch_mod__prompt_kernel_stile_104
    v_mov_b32 v20, v28
    s_nop 1
    v_permlane16_swap_b32 v28, v20
    s_nop 1
    v_add_f32 v28, v28, v20
    v_mov_b32 v20, v28
    s_nop 1
    v_permlane32_swap_b32 v28, v20
    s_nop 1
    v_add_f32 v28, v28, v20
    v_mov_b32 v20, v32
    s_nop 1
    v_permlane16_swap_b32 v32, v20
    s_nop 1
    v_add_f32 v32, v32, v20
    v_mov_b32 v20, v32
    s_nop 1
    v_permlane32_swap_b32 v32, v20
    s_nop 1
    v_add_f32 v32, v32, v20
    s_mov_b32 s36, 0x5d800000
    v_cmp_nge_f32 vcc, s36, v28
    s_nop 0
    s_or_b64 s[52:53], s[52:53], vcc
    v_cmp_nge_f32 vcc, s36, v32
    s_nop 0
    s_or_b64 s[52:53], s[52:53], vcc
    v_rcp_f32 v20, v28
    v_rcp_f32 v22, v32
    s_lshl_b32 s38, s39, 3
    s_and_b32 s37, s28, 3
    s_lshl_b32 s37, s37, 1
    s_add_u32 s38, s38, s37
    s_lshl_b32 s38, s38, 17
    s_lshl_b32 s37, s29, 12
    s_add_u32 s38, s38, s37
    v_mov_b32 v21, v20
    v_mov_b32 v23, v22
    v_pk_mul_f32 v[192:193], v[192:193], v[20:21]
    v_pk_mul_f32 v[194:195], v[194:195], v[20:21]
    v_pk_mul_f32 v[196:197], v[196:197], v[20:21]
    v_pk_mul_f32 v[198:199], v[198:199], v[20:21]
    v_cvt_pk_bf16_f32 v192, v192, v193
    v_cvt_pk_bf16_f32 v193, v194, v195
    v_cvt_pk_bf16_f32 v194, v196, v197
    v_cvt_pk_bf16_f32 v195, v198, v199
    buffer_store_dwordx4 v[192:195], v7, s[16:19], s38 offen offset:0 sc1
    v_pk_mul_f32 v[200:201], v[200:201], v[20:21]
    v_pk_mul_f32 v[202:203], v[202:203], v[20:21]
    v_pk_mul_f32 v[204:205], v[204:205], v[20:21]
    v_pk_mul_f32 v[206:207], v[206:207], v[20:21]
    v_cvt_pk_bf16_f32 v200, v200, v201
    v_cvt_pk_bf16_f32 v201, v202, v203
    v_cvt_pk_bf16_f32 v202, v204, v205
    v_cvt_pk_bf16_f32 v203, v206, v207
    buffer_store_dwordx4 v[200:203], v7, s[16:19], s38 offen offset:1024 sc1
    v_pk_mul_f32 v[208:209], v[208:209], v[20:21]
    v_pk_mul_f32 v[210:211], v[210:211], v[20:21]
    v_pk_mul_f32 v[212:213], v[212:213], v[20:21]
    v_pk_mul_f32 v[214:215], v[214:215], v[20:21]
    v_cvt_pk_bf16_f32 v208, v208, v209
    v_cvt_pk_bf16_f32 v209, v210, v211
    v_cvt_pk_bf16_f32 v210, v212, v213
    v_cvt_pk_bf16_f32 v211, v214, v215
    buffer_store_dwordx4 v[208:211], v7, s[16:19], s38 offen offset:2048 sc1
    v_pk_mul_f32 v[216:217], v[216:217], v[20:21]
    v_pk_mul_f32 v[218:219], v[218:219], v[20:21]
    v_pk_mul_f32 v[220:221], v[220:221], v[20:21]
    v_pk_mul_f32 v[222:223], v[222:223], v[20:21]
    v_cvt_pk_bf16_f32 v216, v216, v217
    v_cvt_pk_bf16_f32 v217, v218, v219
    v_cvt_pk_bf16_f32 v218, v220, v221
    v_cvt_pk_bf16_f32 v219, v222, v223
    buffer_store_dwordx4 v[216:219], v7, s[16:19], s38 offen offset:3072 sc1
    s_add_u32 s38, s38, 131072
    v_pk_mul_f32 v[224:225], v[224:225], v[22:23]
    v_pk_mul_f32 v[226:227], v[226:227], v[22:23]
    v_pk_mul_f32 v[228:229], v[228:229], v[22:23]
    v_pk_mul_f32 v[230:231], v[230:231], v[22:23]
    v_cvt_pk_bf16_f32 v224, v224, v225
    v_cvt_pk_bf16_f32 v225, v226, v227
    v_cvt_pk_bf16_f32 v226, v228, v229
    v_cvt_pk_bf16_f32 v227, v230, v231
    buffer_store_dwordx4 v[224:227], v7, s[16:19], s38 offen offset:0 sc1
    v_pk_mul_f32 v[232:233], v[232:233], v[22:23]
    v_pk_mul_f32 v[234:235], v[234:235], v[22:23]
    v_pk_mul_f32 v[236:237], v[236:237], v[22:23]
    v_pk_mul_f32 v[238:239], v[238:239], v[22:23]
    v_cvt_pk_bf16_f32 v232, v232, v233
    v_cvt_pk_bf16_f32 v233, v234, v235
    v_cvt_pk_bf16_f32 v234, v236, v237
    v_cvt_pk_bf16_f32 v235, v238, v239
    buffer_store_dwordx4 v[232:235], v7, s[16:19], s38 offen offset:1024 sc1
    v_pk_mul_f32 v[240:241], v[240:241], v[22:23]
    v_pk_mul_f32 v[242:243], v[242:243], v[22:23]
    v_pk_mul_f32 v[244:245], v[244:245], v[22:23]
    v_pk_mul_f32 v[246:247], v[246:247], v[22:23]
    v_cvt_pk_bf16_f32 v240, v240, v241
    v_cvt_pk_bf16_f32 v241, v242, v243
    v_cvt_pk_bf16_f32 v242, v244, v245
    v_cvt_pk_bf16_f32 v243, v246, v247
    buffer_store_dwordx4 v[240:243], v7, s[16:19], s38 offen offset:2048 sc1
    v_pk_mul_f32 v[248:249], v[248:249], v[22:23]
    v_pk_mul_f32 v[250:251], v[250:251], v[22:23]
    v_pk_mul_f32 v[252:253], v[252:253], v[22:23]
    v_pk_mul_f32 v[254:255], v[254:255], v[22:23]
    v_cvt_pk_bf16_f32 v248, v248, v249
    v_cvt_pk_bf16_f32 v249, v250, v251
    v_cvt_pk_bf16_f32 v250, v252, v253
    v_cvt_pk_bf16_f32 v251, v254, v255
    buffer_store_dwordx4 v[248:251], v7, s[16:19], s38 offen offset:3072 sc1
    v_mov_b32 v96, v112
    v_mov_b32 v97, v113
    v_mov_b32 v98, v114
    v_mov_b32 v99, v115
    v_mov_b32 v100, v116
    v_mov_b32 v101, v117
    v_mov_b32 v102, v118
    v_mov_b32 v103, v119
    s_branch L_p3_done
L_recurrent_scan__compressed_kv_cla__moe_arch_mod__prompt_kernel_rare_1:
    s_mul_i32 s36, s28, 12288
    s_add_u32 s36, s36, 61865984
    v_lshl_add_u32 v16, v1, 4, s36
    v_mov_b32 v108, 0
    v_mov_b32 v109, 0
    v_mov_b32 v110, 0
    v_mov_b32 v111, 0
    global_store_dwordx4 v16, v[108:111], s[90:91] sc1
    v_add_u32 v16, 1024, v16
    global_store_dwordx4 v16, v[108:111], s[90:91] sc1
    v_add_u32 v16, 1024, v16
    global_store_dwordx4 v16, v[108:111], s[90:91] sc1
    v_add_u32 v16, 1024, v16
    global_store_dwordx4 v16, v[108:111], s[90:91] sc1
    v_add_u32 v16, 1024, v16
    global_store_dwordx4 v16, v[108:111], s[90:91] sc1
    v_add_u32 v16, 1024, v16
    global_store_dwordx4 v16, v[108:111], s[90:91] sc1
    v_add_u32 v16, 1024, v16
    global_store_dwordx4 v16, v[108:111], s[90:91] sc1
    v_add_u32 v16, 1024, v16
    global_store_dwordx4 v16, v[108:111], s[90:91] sc1
    v_add_u32 v16, 1024, v16
    global_store_dwordx4 v16, v[108:111], s[90:91] sc1
    v_add_u32 v16, 1024, v16
    global_store_dwordx4 v16, v[108:111], s[90:91] sc1
    v_add_u32 v16, 1024, v16
    global_store_dwordx4 v16, v[108:111], s[90:91] sc1
    v_add_u32 v16, 1024, v16
    global_store_dwordx4 v16, v[108:111], s[90:91] sc1
    v_add_u32 v16, 1024, v16
    s_branch L_recurrent_scan__compressed_kv_cla__moe_arch_mod__prompt_kernel_back_2
L_recurrent_scan__compressed_kv_cla__moe_arch_mod__prompt_kernel_rare_3:
    v_mov_b32 v19, 1
    s_mov_b64 exec, 1
    global_store_dword v118, v19, s[88:89] sc1
    s_mov_b64 exec, -1
    s_branch L_recurrent_scan__compressed_kv_cla__moe_arch_mod__prompt_kernel_back_4
L_recurrent_scan__compressed_kv_cla__moe_arch_mod__prompt_kernel_rare_5:
    v_lshrrev_b32 v3, 4, v1
    s_lshl_b32 s37, s28, 4
    v_add_u32 v19, s37, v3
    v_lshlrev_b32 v19, 13, v19
    s_lshl_b32 s37, s29, 8
    v_add_u32 v19, s37, v19
    v_and_b32 v16, 15, v1
    v_lshlrev_b32 v3, 1, v3
    v_xor_b32 v16, v16, v3
    v_lshl_add_u32 v2, v16, 4, v19
    v_add_u32 v3, 31744, v2
    v_xor_b32 v16, 8, v16
    v_lshl_add_u32 v4, v16, 4, v19
    v_add_u32 v4, 63488, v4
    v_add_u32 v5, 31744, v4
    s_mov_b32 s4, s96
    s_and_b32 s5, s97, 0xffff
    s_mov_b32 s6, 8388608
    s_mov_b32 s7, 0x20000
    s_mov_b32 s31, 0
    s_mov_b32 s40, 1048576
    s_mov_b64 s[8:9], s[4:5]
    s_mov_b32 s10, s6
    s_mov_b32 s32, 2097152
    v_mov_b32 v6, v2
    v_mov_b32 v7, v3
    v_mov_b32 v8, v4
    v_mov_b32 v9, v5
    s_branch L_recurrent_scan__compressed_kv_cla__moe_arch_mod__prompt_kernel_back_6
L_recurrent_scan__compressed_kv_cla__moe_arch_mod__prompt_kernel_w0_7:
    s_cmp_eq_u32 s35, 0
    s_cbranch_scc0 L_recurrent_scan__compressed_kv_cla__moe_arch_mod__prompt_kernel_swn_10
    v_and_b32 v16, 7, v1
    v_lshrrev_b32 v18, 3, v1
    v_mul_u32_u24 v19, 2064, v16
    v_lshl_add_u32 v19, v18, 4, v19
    s_lshl_b32 s36, s28, 8
    s_add_u32 s36, s36, 131072
    v_add_u32 v19, s36, v19
    ds_read_b128 v[120:123], v19
    ds_read_b128 v[124:127], v19 offset:128
    v_lshlrev_b32 v16, 4, v16
    v_lshl_add_u32 v16, v18, 8, v16
    s_lshr_b32 s36, s2, 1
    s_lshl_b32 s36, s36, 15
    s_and_b32 s37, s2, 1
    s_lshl_b32 s37, s37, 7
    s_add_u32 s36, s36, s37
    s_lshl_b32 s37, s28, 12
    s_add_u32 s36, s36, s37
    s_waitcnt lgkmcnt(0)
    buffer_store_dwordx4 v[120:123], v16, s[24:27], s36 offen sc1
    buffer_store_dwordx4 v[124:127], v16, s[24:27], s36 offen offset:2048 sc1
    s_waitcnt vmcnt(2)
    s_branch L_recurrent_scan__compressed_kv_cla__moe_arch_mod__prompt_kernel_swend_9
L_recurrent_scan__compressed_kv_cla__moe_arch_mod__prompt_kernel_swn_10:
    s_waitcnt vmcnt(2)
L_recurrent_scan__compressed_kv_cla__moe_arch_mod__prompt_kernel_swend_9:
    s_branch L_recurrent_scan__compressed_kv_cla__moe_arch_mod__prompt_kernel_w0b_8
L_recurrent_scan__compressed_kv_cla__moe_arch_mod__prompt_kernel_rare_13:
    s_cmp_eq_u32 s35, 0
    s_cbranch_scc0 L_recurrent_scan__compressed_kv_cla__moe_arch_mod__prompt_kernel_swn_12
    global_load_dword v116, v118, s[88:89] sc1
    s_branch L_recurrent_scan__compressed_kv_cla__moe_arch_mod__prompt_kernel_swend_11
L_recurrent_scan__compressed_kv_cla__moe_arch_mod__prompt_kernel_swn_12:
    v_and_b32 v117, 15, v1
    v_add_u32 v117, 112, v117
    v_lshlrev_b32 v117, 7, v117
    global_load_dword v116, v117, s[90:91] sc1
L_recurrent_scan__compressed_kv_cla__moe_arch_mod__prompt_kernel_swend_11:
    s_branch L_recurrent_scan__compressed_kv_cla__moe_arch_mod__prompt_kernel_back_14
L_recurrent_scan__compressed_kv_cla__moe_arch_mod__prompt_kernel_rare_19:
    s_mov_b32 s61, 0x40000
L_recurrent_scan__compressed_kv_cla__moe_arch_mod__prompt_kernel_spin_17:
    s_sub_u32 s61, s61, 1
    s_cbranch_scc1 L_recurrent_scan__compressed_kv_cla__moe_arch_mod__prompt_kernel_spinx_18
    s_sleep 8
    global_load_dword v116, v118, s[88:89] sc1
    s_waitcnt vmcnt(0)
    v_readfirstlane_b32 s36, v116
    s_nop 0
    s_cmp_lt_u32 s36, 1
    s_cbranch_scc1 L_recurrent_scan__compressed_kv_cla__moe_arch_mod__prompt_kernel_spin_17
L_recurrent_scan__compressed_kv_cla__moe_arch_mod__prompt_kernel_spinx_18:
    s_branch L_recurrent_scan__compressed_kv_cla__moe_arch_mod__prompt_kernel_back_20
L_recurrent_scan__compressed_kv_cla__moe_arch_mod__prompt_kernel_w0_15:
    s_waitcnt vmcnt(0)
    s_cmp_eq_u32 s35, 0
    s_cbranch_scc0 L_recurrent_scan__compressed_kv_cla__moe_arch_mod__prompt_kernel_swn_24
    v_readfirstlane_b32 s36, v116
    s_nop 0
    s_cmp_lt_u32 s36, 1
    s_cbranch_scc1 L_recurrent_scan__compressed_kv_cla__moe_arch_mod__prompt_kernel_rare_19
L_recurrent_scan__compressed_kv_cla__moe_arch_mod__prompt_kernel_back_20:
    s_branch L_recurrent_scan__compressed_kv_cla__moe_arch_mod__prompt_kernel_swend_23
L_recurrent_scan__compressed_kv_cla__moe_arch_mod__prompt_kernel_swn_24:
    s_mov_b32 s61, 0x40000
L_recurrent_scan__compressed_kv_cla__moe_arch_mod__prompt_kernel_lspin_21:
    v_cmp_gt_u32 vcc, 16, v116
    s_nop 0
    s_cmp_eq_u64 vcc, 0
    s_cbranch_scc1 L_recurrent_scan__compressed_kv_cla__moe_arch_mod__prompt_kernel_lspinx_22
    s_sub_u32 s61, s61, 1
    s_cbranch_scc1 L_recurrent_scan__compressed_kv_cla__moe_arch_mod__prompt_kernel_lspinx_22
    s_sleep 8
    global_load_dword v116, v117, s[90:91] sc1
    s_waitcnt vmcnt(0)
    s_branch L_recurrent_scan__compressed_kv_cla__moe_arch_mod__prompt_kernel_lspin_21
L_recurrent_scan__compressed_kv_cla__moe_arch_mod__prompt_kernel_lspinx_22:
L_recurrent_scan__compressed_kv_cla__moe_arch_mod__prompt_kernel_swend_23:
    s_branch L_recurrent_scan__compressed_kv_cla__moe_arch_mod__prompt_kernel_w0b_16
L_recurrent_scan__compressed_kv_cla__moe_arch_mod__prompt_kernel_rare_25:
    s_lshr_b32 s36, s2, 4
    s_add_u32 s36, s36, 112
    s_lshl_b32 s36, s36, 7
    v_mov_b32 v16, s36
    v_mov_b32 v19, 1
    s_mov_b64 exec, 1
    global_atomic_add v16, v19, s[90:91]
    s_mov_b64 exec, -1
    s_nop 3
    s_branch L_recurrent_scan__compressed_kv_cla__moe_arch_mod__prompt_kernel_back_26
L_recurrent_scan__compressed_kv_cla__moe_arch_mod__prompt_kernel_w0_27:
    s_cmp_eq_u32 s35, 0
    s_cbranch_scc0 L_recurrent_scan__compressed_kv_cla__moe_arch_mod__prompt_kernel_swn_30
    s_waitcnt vmcnt(2)
    s_branch L_recurrent_scan__compressed_kv_cla__moe_arch_mod__prompt_kernel_swend_29
L_recurrent_scan__compressed_kv_cla__moe_arch_mod__prompt_kernel_swn_30:
    s_waitcnt vmcnt(2)
L_recurrent_scan__compressed_kv_cla__moe_arch_mod__prompt_kernel_swend_29:
    s_branch L_recurrent_scan__compressed_kv_cla__moe_arch_mod__prompt_kernel_w0b_28
L_recurrent_scan__compressed_kv_cla__moe_arch_mod__prompt_kernel_rare_32:
    v_and_b32 v16, 7, v1
    v_lshrrev_b32 v18, 3, v1
    v_mul_u32_u24 v19, 2064, v16
    v_lshl_add_u32 v19, v18, 4, v19
    s_lshl_b32 s36, s28, 8
    s_add_u32 s36, s36, 131072
    v_add_u32 v19, s36, v19
    ds_read_b128 v[120:123], v19
    ds_read_b128 v[124:127], v19 offset:128
    v_lshlrev_b32 v16, 4, v16
    v_lshl_add_u32 v16, v18, 8, v16
    s_lshr_b32 s36, s2, 1
    s_lshl_b32 s36, s36, 15
    s_and_b32 s37, s2, 1
    s_lshl_b32 s37, s37, 7
    s_add_u32 s36, s36, s37
    s_lshl_b32 s37, s28, 12
    s_add_u32 s36, s36, s37
    s_waitcnt lgkmcnt(0)
    buffer_store_dwordx4 v[120:123], v16, s[24:27], s36 offen sc1
    buffer_store_dwordx4 v[124:127], v16, s[24:27], s36 offen offset:2048 sc1
    s_cmp_eq_u32 s28, 7
    s_cbranch_scc0 L_recurrent_scan__compressed_kv_cla__moe_arch_mod__prompt_kernel_l7_31
    v_and_b32 v120, 7, v1
    v_lshlrev_b32 v120, 3, v120
    v_add_u32 v121, 147712, v120
    ds_read_b64 v[122:123], v121
    ds_read_b32 v124, v121 offset:64
    s_lshl_b32 s36, s2, 6
    s_add_u32 s36, s36, 4194304
    s_lshl_b32 s37, s2, 3
    s_add_u32 s37, s37, 4276224
    s_waitcnt lgkmcnt(0)
    v_mov_b32 v126, v124
    s_nop 1
    v_max_u32_dpp v126, v126, v126 quad_perm:[1,0,3,2] row_mask:0xf bank_mask:0xf
    s_nop 1
    v_max_u32_dpp v126, v126, v126 quad_perm:[2,3,0,1] row_mask:0xf bank_mask:0xf
    s_nop 1
    v_max_u32_dpp v126, v126, v126 row_half_mirror row_mask:0xf bank_mask:0xf
    v_cmp_eq_u32 vcc, v126, v124
    s_nop 1
    v_cndmask_b32 v127, v124, v118, vcc
    s_nop 1
    v_max_u32_dpp v127, v127, v127 quad_perm:[1,0,3,2] row_mask:0xf bank_mask:0xf
    s_nop 1
    v_max_u32_dpp v127, v127, v127 quad_perm:[2,3,0,1] row_mask:0xf bank_mask:0xf
    s_nop 1
    v_max_u32_dpp v127, v127, v127 row_half_mirror row_mask:0xf bank_mask:0xf
    s_mov_b64 exec, 0xff
    buffer_store_dwordx2 v[122:123], v120, s[24:27], s36 offen sc1
    s_mov_b64 exec, 1
    buffer_store_dwordx2 v[126:127], v120, s[24:27], s37 offen sc1
    s_mov_b64 exec, -1
    s_nop 3
L_recurrent_scan__compressed_kv_cla__moe_arch_mod__prompt_kernel_l7_31:
    s_branch L_recurrent_scan__compressed_kv_cla__moe_arch_mod__prompt_kernel_back_33
L_recurrent_scan__compressed_kv_cla__moe_arch_mod__prompt_kernel_rare_36:
    v_lshrrev_b32 v3, 4, v1
    s_lshl_b32 s37, s28, 4
    v_add_u32 v19, s37, v3
    v_lshlrev_b32 v19, 13, v19
    s_lshl_b32 s37, s29, 8
    v_add_u32 v19, s37, v19
    v_and_b32 v16, 15, v1
    v_lshlrev_b32 v3, 1, v3
    v_xor_b32 v16, v16, v3
    v_lshl_add_u32 v2, v16, 4, v19
    v_add_u32 v3, 31744, v2
    v_xor_b32 v16, 8, v16
    v_lshl_add_u32 v4, v16, 4, v19
    v_add_u32 v4, 63488, v4
    v_add_u32 v5, 31744, v4
    s_mov_b32 s4, s96
    s_and_b32 s5, s97, 0xffff
    s_mov_b32 s6, 8388608
    s_mov_b32 s7, 0x20000
    s_mov_b32 s31, 0
    s_mov_b32 s40, 1048576
    s_mov_b64 s[8:9], s[4:5]
    s_mov_b32 s10, s6
    s_mov_b32 s32, 2097152
    v_mov_b32 v6, v2
    v_mov_b32 v7, v3
    v_mov_b32 v8, v4
    v_mov_b32 v9, v5
    s_branch L_recurrent_scan__compressed_kv_cla__moe_arch_mod__prompt_kernel_back_37
L_recurrent_scan__compressed_kv_cla__moe_arch_mod__prompt_kernel_rare_42:
    s_mov_b32 s61, 0x40000
L_recurrent_scan__compressed_kv_cla__moe_arch_mod__prompt_kernel_spin_40:
    s_sub_u32 s61, s61, 1
    s_cbranch_scc1 L_recurrent_scan__compressed_kv_cla__moe_arch_mod__prompt_kernel_spinx_41
    s_sleep 8
    global_load_dword v56, v57, s[90:91] sc1
    s_waitcnt vmcnt(0)
    v_readfirstlane_b32 s36, v56
    s_nop 0
    s_cmp_lt_u32 s36, 1
    s_cbranch_scc1 L_recurrent_scan__compressed_kv_cla__moe_arch_mod__prompt_kernel_spin_40
L_recurrent_scan__compressed_kv_cla__moe_arch_mod__prompt_kernel_spinx_41:
    s_branch L_recurrent_scan__compressed_kv_cla__moe_arch_mod__prompt_kernel_back_43
L_recurrent_scan__compressed_kv_cla__moe_arch_mod__prompt_kernel_rare_48:
    s_cmp_lt_u32 s28, 4
    s_cbranch_scc0 L_recurrent_scan__compressed_kv_cla__moe_arch_mod__prompt_kernel_ng_45
    s_cmp_eq_u32 s35, 2
    s_cbranch_scc0 L_recurrent_scan__compressed_kv_cla__moe_arch_mod__prompt_kernel_swn_47
    s_mov_b32 s6, 0
    s_mov_b32 s34, 0x30000
    s_branch L_recurrent_scan__compressed_kv_cla__moe_arch_mod__prompt_kernel_swend_46
L_recurrent_scan__compressed_kv_cla__moe_arch_mod__prompt_kernel_swn_47:
    s_mov_b64 s[4:5], s[12:13]
    s_mov_b32 s6, s14
    s_mov_b32 s31, s45
    s_mov_b32 s40, 32768
    s_mov_b32 s34, s33
    v_add_u32 v2, s33, v58
    v_mov_b32 v3, v2
    v_mov_b32 v4, v2
    v_mov_b32 v5, v2
    s_cmp_eq_u32 s28, 0
    s_cbranch_scc0 L_recurrent_scan__compressed_kv_cla__moe_arch_mod__prompt_kernel_g_44
    s_waitcnt vmcnt(10)
    v_readfirstlane_b32 s36, v56
    s_nop 0
    s_cmp_lt_u32 s36, 1
    s_cbranch_scc1 L_recurrent_scan__compressed_kv_cla__moe_arch_mod__prompt_kernel_rare_42
L_recurrent_scan__compressed_kv_cla__moe_arch_mod__prompt_kernel_back_43:
L_recurrent_scan__compressed_kv_cla__moe_arch_mod__prompt_kernel_g_44:
L_recurrent_scan__compressed_kv_cla__moe_arch_mod__prompt_kernel_swend_46:
L_recurrent_scan__compressed_kv_cla__moe_arch_mod__prompt_kernel_ng_45:
    s_branch L_recurrent_scan__compressed_kv_cla__moe_arch_mod__prompt_kernel_back_49
L_recurrent_scan__compressed_kv_cla__moe_arch_mod__prompt_kernel_rare_54:
    s_cmp_eq_u32 s35, 3
    s_cbranch_scc0 L_recurrent_scan__compressed_kv_cla__moe_arch_mod__prompt_kernel_nv0_50
    s_cmp_eq_u32 s28, 0
    s_cbranch_scc0 L_recurrent_scan__compressed_kv_cla__moe_arch_mod__prompt_kernel_g_39
    s_add_u32 s36, s29, 64
    s_lshl_b32 s36, s36, 7
    v_mov_b32 v57, s36
    global_load_dword v56, v57, s[90:91] sc1
L_recurrent_scan__compressed_kv_cla__moe_arch_mod__prompt_kernel_g_39:
L_recurrent_scan__compressed_kv_cla__moe_arch_mod__prompt_kernel_nv0_50:
    s_cmp_ge_u32 s28, 4
    s_cbranch_scc0 L_recurrent_scan__compressed_kv_cla__moe_arch_mod__prompt_kernel_ng_51
    s_cmp_eq_u32 s35, 2
    s_cbranch_scc0 L_recurrent_scan__compressed_kv_cla__moe_arch_mod__prompt_kernel_swn_53
    s_mov_b32 s6, 0
    s_mov_b32 s34, 0x30000
    s_branch L_recurrent_scan__compressed_kv_cla__moe_arch_mod__prompt_kernel_swend_52
L_recurrent_scan__compressed_kv_cla__moe_arch_mod__prompt_kernel_swn_53:
    s_mov_b64 s[4:5], s[12:13]
    s_mov_b32 s6, s14
    s_mov_b32 s31, s45
    s_mov_b32 s40, 32768
    s_mov_b32 s34, s33
    v_add_u32 v2, s33, v58
    v_mov_b32 v3, v2
    v_mov_b32 v4, v2
    v_mov_b32 v5, v2
L_recurrent_scan__compressed_kv_cla__moe_arch_mod__prompt_kernel_swend_52:
L_recurrent_scan__compressed_kv_cla__moe_arch_mod__prompt_kernel_ng_51:
    s_branch L_recurrent_scan__compressed_kv_cla__moe_arch_mod__prompt_kernel_back_55
L_recurrent_scan__compressed_kv_cla__moe_arch_mod__prompt_kernel_rare_60:
    s_cmp_eq_u32 s35, 3
    s_cbranch_scc0 L_recurrent_scan__compressed_kv_cla__moe_arch_mod__prompt_kernel_nv0_56
    s_add_u32 s34, s33, 32768
L_recurrent_scan__compressed_kv_cla__moe_arch_mod__prompt_kernel_nv0_56:
    s_cmp_ge_u32 s28, 4
    s_cbranch_scc0 L_recurrent_scan__compressed_kv_cla__moe_arch_mod__prompt_kernel_ng_57
    s_cmp_eq_u32 s35, 2
    s_cbranch_scc0 L_recurrent_scan__compressed_kv_cla__moe_arch_mod__prompt_kernel_swn_59
    s_add_u32 s36, s28, s30
    s_cmp_eq_u32 s36, 4
    s_cbranch_scc0 L_recurrent_scan__compressed_kv_cla__moe_arch_mod__prompt_kernel_g_38
    s_add_u32 s36, s29, 64
    s_lshl_b32 s36, s36, 7
    v_mov_b32 v62, s36
    v_mov_b32 v63, 1
    s_mov_b64 exec, 1
    global_atomic_add v62, v63, s[90:91]
    s_mov_b64 exec, -1
    s_nop 3
L_recurrent_scan__compressed_kv_cla__moe_arch_mod__prompt_kernel_g_38:
    s_branch L_recurrent_scan__compressed_kv_cla__moe_arch_mod__prompt_kernel_swend_58
L_recurrent_scan__compressed_kv_cla__moe_arch_mod__prompt_kernel_swn_59:
L_recurrent_scan__compressed_kv_cla__moe_arch_mod__prompt_kernel_swend_58:
L_recurrent_scan__compressed_kv_cla__moe_arch_mod__prompt_kernel_ng_57:
    s_branch L_recurrent_scan__compressed_kv_cla__moe_arch_mod__prompt_kernel_back_61
L_recurrent_scan__compressed_kv_cla__moe_arch_mod__prompt_kernel_rare_62:
    s_waitcnt vmcnt(18)
    s_branch L_recurrent_scan__compressed_kv_cla__moe_arch_mod__prompt_kernel_back_63
L_recurrent_scan__compressed_kv_cla__moe_arch_mod__prompt_kernel_rare_64:
    s_lshl_b32 s36, s39, 1
    s_add_u32 s36, s36, s38
    s_add_u32 s37, s36, s39
    buffer_store_dwordx4 v[160:163], v58, s[16:19], s36 offen sc1
    buffer_store_dwordx4 v[164:167], v59, s[16:19], s36 offen sc1
    buffer_store_dwordx4 v[168:171], v60, s[16:19], s36 offen sc1
    buffer_store_dwordx4 v[172:175], v61, s[16:19], s36 offen sc1
    buffer_store_dwordx4 v[176:179], v58, s[16:19], s37 offen sc1
    buffer_store_dwordx4 v[180:183], v59, s[16:19], s37 offen sc1
    buffer_store_dwordx4 v[184:187], v60, s[16:19], s37 offen sc1
    buffer_store_dwordx4 v[188:191], v61, s[16:19], s37 offen sc1
    s_branch L_recurrent_scan__compressed_kv_cla__moe_arch_mod__prompt_kernel_back_65
L_recurrent_scan__compressed_kv_cla__moe_arch_mod__prompt_kernel_rare_66:
    s_lshl_b32 s36, s29, 7
    v_mov_b32 v13, s36
    global_load_dword v14, v13, s[90:91] sc1
    s_branch L_recurrent_scan__compressed_kv_cla__moe_arch_mod__prompt_kernel_back_67
L_recurrent_scan__compressed_kv_cla__moe_arch_mod__prompt_kernel_rare_72:
    s_mov_b32 s41, 32768
    s_cmp_eq_u32 s40, 15
    s_cbranch_scc0 L_recurrent_scan__compressed_kv_cla__moe_arch_mod__prompt_kernel_r_68
    s_mov_b32 s41, 65536
    s_mov_b32 s49, 0x1ffff
    s_sub_u32 s36, 0, s50
    s_cmp_lt_i32 s36, 0
    s_cbranch_scc1 L_recurrent_scan__compressed_kv_cla__moe_arch_mod__prompt_kernel_nm_71
    v_mov_b32 v20, 4048155338
    v_subrev_u32 v21, s36, v18
    v_cmp_gt_i32 s[20:21], 0, v21
    v_cmp_gt_i32 s[22:23], 1, v21
    v_cmp_gt_i32 s[62:63], 2, v21
    v_cmp_gt_i32 vcc, 3, v21
    v_cndmask_b32 v96, v96, v20, s[20:21]
    v_cndmask_b32 v97, v97, v20, s[22:23]
    v_cndmask_b32 v98, v98, v20, s[62:63]
    v_cndmask_b32 v99, v99, v20, vcc
    v_cmp_gt_i32 s[20:21], 16, v21
    v_cmp_gt_i32 s[22:23], 17, v21
    v_cmp_gt_i32 s[62:63], 18, v21
    v_cmp_gt_i32 vcc, 19, v21
    v_cndmask_b32 v100, v100, v20, s[20:21]
    v_cndmask_b32 v101, v101, v20, s[22:23]
    v_cndmask_b32 v102, v102, v20, s[62:63]
    v_cndmask_b32 v103, v103, v20, vcc
    v_cmp_gt_i32 s[20:21], -16, v21
    v_cmp_gt_i32 s[22:23], -15, v21
    v_cmp_gt_i32 s[62:63], -14, v21
    v_cmp_gt_i32 vcc, -13, v21
    v_cndmask_b32 v104, v104, v20, s[20:21]
    v_cndmask_b32 v105, v105, v20, s[22:23]
    v_cndmask_b32 v106, v106, v20, s[62:63]
    v_cndmask_b32 v107, v107, v20, vcc
    v_cmp_gt_i32 s[20:21], 0, v21
    v_cmp_gt_i32 s[22:23], 1, v21
    v_cmp_gt_i32 s[62:63], 2, v21
    v_cmp_gt_i32 vcc, 3, v21
    v_cndmask_b32 v108, v108, v20, s[20:21]
    v_cndmask_b32 v109, v109, v20, s[22:23]
    v_cndmask_b32 v110, v110, v20, s[62:63]
    v_cndmask_b32 v111, v111, v20, vcc
L_recurrent_scan__compressed_kv_cla__moe_arch_mod__prompt_kernel_nm_71:
L_recurrent_scan__compressed_kv_cla__moe_arch_mod__prompt_kernel_r_68:
    s_branch L_recurrent_scan__compressed_kv_cla__moe_arch_mod__prompt_kernel_back_73
L_recurrent_scan__compressed_kv_cla__moe_arch_mod__prompt_kernel_rare_82:
    s_mov_b32 s61, 0x40000
L_recurrent_scan__compressed_kv_cla__moe_arch_mod__prompt_kernel_spin_80:
    s_sub_u32 s61, s61, 1
    s_cbranch_scc1 L_recurrent_scan__compressed_kv_cla__moe_arch_mod__prompt_kernel_spinx_81
    s_sleep 8
    global_load_dword v14, v13, s[90:91] sc1
    s_waitcnt vmcnt(0)
    v_readfirstlane_b32 s36, v14
    s_nop 0
    s_cmp_lt_u32 s36, 7
    s_cbranch_scc1 L_recurrent_scan__compressed_kv_cla__moe_arch_mod__prompt_kernel_spin_80
L_recurrent_scan__compressed_kv_cla__moe_arch_mod__prompt_kernel_spinx_81:
    s_branch L_recurrent_scan__compressed_kv_cla__moe_arch_mod__prompt_kernel_back_83
L_recurrent_scan__compressed_kv_cla__moe_arch_mod__prompt_kernel_rare_88:
    s_cmp_eq_u32 s40, 1
    s_cbranch_scc0 L_recurrent_scan__compressed_kv_cla__moe_arch_mod__prompt_kernel_swn_85
    v_readfirstlane_b32 s36, v14
    s_nop 0
    s_cmp_lt_u32 s36, 7
    s_cbranch_scc1 L_recurrent_scan__compressed_kv_cla__moe_arch_mod__prompt_kernel_rare_82
L_recurrent_scan__compressed_kv_cla__moe_arch_mod__prompt_kernel_back_83:
    s_branch L_recurrent_scan__compressed_kv_cla__moe_arch_mod__prompt_kernel_swend_84
L_recurrent_scan__compressed_kv_cla__moe_arch_mod__prompt_kernel_swn_85:
    s_cmp_eq_u32 s40, 2
    s_cbranch_scc0 L_recurrent_scan__compressed_kv_cla__moe_arch_mod__prompt_kernel_swn_86
    s_mov_b32 s36, 4276224
    buffer_load_dwordx4 v[160:163], v7, s[24:27], s36 offen offset:0 sc1
    buffer_load_dwordx4 v[164:167], v7, s[24:27], s36 offen offset:1024 sc1
    s_branch L_recurrent_scan__compressed_kv_cla__moe_arch_mod__prompt_kernel_swend_84
L_recurrent_scan__compressed_kv_cla__moe_arch_mod__prompt_kernel_swn_86:
    s_cmp_eq_u32 s40, 3
    s_cbranch_scc0 L_recurrent_scan__compressed_kv_cla__moe_arch_mod__prompt_kernel_swn_87
    v_max_u32 v24, v160, v161
    v_min_u32 v25, v160, v161
    v_med3_u32 v25, v24, v25, v162
    v_max_u32 v24, v24, v162
    v_med3_u32 v25, v24, v25, v163
    v_max_u32 v24, v24, v163
    v_med3_u32 v25, v24, v25, v164
    v_max_u32 v24, v24, v164
    v_med3_u32 v25, v24, v25, v165
    v_max_u32 v24, v24, v165
    v_med3_u32 v25, v24, v25, v166
    v_max_u32 v24, v24, v166
    v_med3_u32 v25, v24, v25, v167
    v_max_u32 v24, v24, v167
    v_mov_b32 v26, v24
    s_nop 1
    v_max_u32_dpp v26, v26, v26 quad_perm:[1,0,3,2] row_mask:0xf bank_mask:0xf
    s_nop 1
    v_max_u32_dpp v26, v26, v26 quad_perm:[2,3,0,1] row_mask:0xf bank_mask:0xf
    s_nop 1
    v_max_u32_dpp v26, v26, v26 row_half_mirror row_mask:0xf bank_mask:0xf
    s_nop 1
    v_max_u32_dpp v26, v26, v26 row_mirror row_mask:0xf bank_mask:0xf
    s_nop 0
    v_readlane_b32 s20, v26, 0
    v_readlane_b32 s21, v26, 16
    v_readlane_b32 s22, v26, 32
    v_readlane_b32 s23, v26, 48
    s_max_u32 s20, s20, s21
    s_max_u32 s22, s22, s23
    s_max_u32 s20, s20, s22
    s_mov_b32 s58, s20
    v_cmp_eq_u32 vcc, s58, v24
    s_nop 1
    v_cndmask_b32 v26, v24, v25, vcc
    s_nop 1
    v_max_u32_dpp v26, v26, v26 quad_perm:[1,0,3,2] row_mask:0xf bank_mask:0xf
    s_nop 1
    v_max_u32_dpp v26, v26, v26 quad_perm:[2,3,0,1] row_mask:0xf bank_mask:0xf
    s_nop 1
    v_max_u32_dpp v26, v26, v26 row_half_mirror row_mask:0xf bank_mask:0xf
    s_nop 1
    v_max_u32_dpp v26, v26, v26 row_mirror row_mask:0xf bank_mask:0xf
    s_nop 0
    v_readlane_b32 s20, v26, 0
    v_readlane_b32 s21, v26, 16
    v_readlane_b32 s22, v26, 32
    v_readlane_b32 s23, v26, 48
    s_max_u32 s20, s20, s21
    s_max_u32 s22, s22, s23
    s_max_u32 s20, s20, s22
    s_mov_b32 s59, s20
    s_and_b32 s36, s58, 0xffff
    s_sub_u32 s56, 0xffff, s36
    s_and_b32 s36, s59, 0xffff
    s_sub_u32 s57, 0xffff, s36
    v_and_b32 v24, 1, v1
    v_mov_b32 v25, s56
    v_mov_b32 v26, s57
    v_cmp_eq_u32 vcc, 1, v24
    s_nop 1
    v_cndmask_b32 v25, v25, v26, vcc
    v_lshrrev_b32 v26, 4, v25
    v_lshlrev_b32 v26, 15, v26
    v_and_b32 v25, 15, v25
    v_lshl_add_u32 v26, v25, 4, v26
    v_lshrrev_b32 v27, 4, v1
    v_lshl_add_u32 v26, v27, 8, v26
    s_and_b32 s36, s3, 3
    s_lshl_b32 s36, s36, 13
    s_add_u32 s37, s36, 4096
    s_mov_b32 exec_lo, 0x00030003
    s_mov_b32 exec_hi, 0x00030003
    buffer_load_dwordx4 v[160:163], v26, s[24:27], s36 offen offset:0 sc1
    buffer_load_dwordx4 v[164:167], v26, s[24:27], s36 offen offset:1024 sc1
    buffer_load_dwordx4 v[168:171], v26, s[24:27], s36 offen offset:2048 sc1
    buffer_load_dwordx4 v[172:175], v26, s[24:27], s36 offen offset:3072 sc1
    buffer_load_dwordx4 v[176:179], v26, s[24:27], s37 offen offset:0 sc1
    buffer_load_dwordx4 v[180:183], v26, s[24:27], s37 offen offset:1024 sc1
    buffer_load_dwordx4 v[184:187], v26, s[24:27], s37 offen offset:2048 sc1
    buffer_load_dwordx4 v[188:191], v26, s[24:27], s37 offen offset:3072 sc1
    s_mov_b64 exec, -1
    s_branch L_recurrent_scan__compressed_kv_cla__moe_arch_mod__prompt_kernel_swend_84
L_recurrent_scan__compressed_kv_cla__moe_arch_mod__prompt_kernel_swn_87:
    s_sub_u32 s38, s40, s60
    s_cmp_eq_u32 s38, 0
    s_cbranch_scc0 L_recurrent_scan__compressed_kv_cla__moe_arch_mod__prompt_kernel_swn_76
    s_and_b32 s20, s3, 3
    s_lshl_b32 s20, s20, 8
    s_lshl_b32 s21, s28, 5
    s_add_u32 s20, s20, s21
    s_lshr_b32 s21, s3, 2
    s_lshl_b32 s21, s21, 7
    v_lshrrev_b32 v25, 3, v1
    s_lshl_b32 s36, s28, 5
    s_add_u32 s36, s36, s20
    v_add_u32 v25, s36, v25
    v_mul_u32_u24 v25, 7168, v25
    v_add_u32 v25, s21, v25
    v_bfe_u32 v26, v1, 4, 1
    v_lshlrev_b32 v26, 1, v26
    v_and_b32 v27, 7, v1
    v_xor_b32 v26, v26, v27
    v_lshl_add_u32 v24, v26, 4, v25
    v_xor_b32 v26, 4, v26
    v_lshl_add_u32 v25, v26, 4, v25
    v_add_u32 v25, 56320, v25
    v_add_u32 v26, 112640, v24
    v_add_u32 v27, 112640, v25
    s_lshl_b32 s36, s28, 13
    s_add_u32 m0, s36, 131072
    s_mov_b32 s37, 229376
    buffer_load_dwordx4 v24, s[4:7], 0 offen offset:0 nt lds
    buffer_load_dwordx4 v25, s[4:7], 0 offen offset:1024 nt lds
    buffer_load_dwordx4 v26, s[4:7], 0 offen offset:2048 nt lds
    buffer_load_dwordx4 v27, s[4:7], 0 offen offset:3072 nt lds
    s_add_u32 m0, s36, 135168
    s_nop 0
    buffer_load_dwordx4 v24, s[4:7], s37 offen offset:0 nt lds
    buffer_load_dwordx4 v25, s[4:7], s37 offen offset:1024 nt lds
    buffer_load_dwordx4 v26, s[4:7], s37 offen offset:2048 nt lds
    buffer_load_dwordx4 v27, s[4:7], s37 offen offset:3072 nt lds
    s_branch L_recurrent_scan__compressed_kv_cla__moe_arch_mod__prompt_kernel_swend_75
L_recurrent_scan__compressed_kv_cla__moe_arch_mod__prompt_kernel_swn_76:
    s_cmp_eq_u32 s38, 2
    s_cbranch_scc0 L_recurrent_scan__compressed_kv_cla__moe_arch_mod__prompt_kernel_swn_77
    v_lshrrev_b32 v8, 4, v1
    v_bfe_u32 v5, v1, 2, 2
    v_lshl_add_u32 v5, v8, 3, v5
    v_lshlrev_b32 v5, 7, v5
    v_and_b32 v9, 3, v1
    v_lshl_add_u32 v5, v9, 3, v5
    v_bfe_u32 v9, v1, 3, 2
    v_xor_b32 v9, s28, v9
    v_lshl_add_u32 v5, v9, 5, v5
    v_add_u32 v5, 131072, v5
    ds_read_b64_tr_b16 v[14:15], v5 offset:0
    ds_read_b64_tr_b16 v[16:17], v5 offset:512
    ds_read_b64_tr_b16 v[20:21], v5 offset:4096
    ds_read_b64_tr_b16 v[22:23], v5 offset:4608
    ds_read_b64_tr_b16 v[24:25], v5 offset:8192
    ds_read_b64_tr_b16 v[26:27], v5 offset:8704
    s_and_b32 s36, s3, 3
    s_lshl_b32 s36, s36, 6
    s_lshr_b32 s37, s3, 2
    s_lshl_b32 s37, s37, 12
    s_add_u32 s36, s36, s37
    s_lshl_b32 s37, s28, 10
    s_add_u32 s36, s36, s37
    s_add_u32 s36, s36, 58720256
    v_and_b32 v9, 1, v1
    v_lshlrev_b32 v9, 4, v9
    v_lshl_add_u32 v9, v8, 8, v9
    s_waitcnt lgkmcnt(4)
    v_mfma_f32_16x16x32_bf16 v[10:13], v[14:17], v[160:163], 0
    ds_read_b64_tr_b16 v[14:15], v5 offset:12288
    ds_read_b64_tr_b16 v[16:17], v5 offset:12800
    s_waitcnt lgkmcnt(4)
    v_mfma_f32_16x16x32_bf16 v[10:13], v[20:23], v[164:167], v[10:13]
    ds_read_b64_tr_b16 v[20:21], v5 offset:16384
    ds_read_b64_tr_b16 v[22:23], v5 offset:16896
    s_waitcnt lgkmcnt(4)
    v_mfma_f32_16x16x32_bf16 v[10:13], v[24:27], v[168:171], v[10:13]
    ds_read_b64_tr_b16 v[24:25], v5 offset:20480
    ds_read_b64_tr_b16 v[26:27], v5 offset:20992
    s_waitcnt lgkmcnt(4)
    v_mfma_f32_16x16x32_bf16 v[10:13], v[14:17], v[172:175], v[10:13]
    ds_read_b64_tr_b16 v[14:15], v5 offset:24576
    ds_read_b64_tr_b16 v[16:17], v5 offset:25088
    s_waitcnt lgkmcnt(4)
    v_mfma_f32_16x16x32_bf16 v[10:13], v[20:23], v[176:179], v[10:13]
    ds_read_b64_tr_b16 v[20:21], v5 offset:28672
    ds_read_b64_tr_b16 v[22:23], v5 offset:29184
    s_waitcnt lgkmcnt(4)
    v_mfma_f32_16x16x32_bf16 v[10:13], v[24:27], v[180:183], v[10:13]
    s_waitcnt lgkmcnt(2)
    v_mfma_f32_16x16x32_bf16 v[10:13], v[14:17], v[184:187], v[10:13]
    s_waitcnt lgkmcnt(0)
    v_mfma_f32_16x16x32_bf16 v[10:13], v[20:23], v[188:191], v[10:13]
    s_nop 5
    s_mov_b32 exec_lo, 0x00030003
    s_mov_b32 exec_hi, 0x00030003
    buffer_store_dwordx4 v[10:13], v9, s[24:27], s36 offen sc1
    s_mov_b64 exec, -1
    s_nop 1
    s_branch L_recurrent_scan__compressed_kv_cla__moe_arch_mod__prompt_kernel_swend_75
L_recurrent_scan__compressed_kv_cla__moe_arch_mod__prompt_kernel_swn_77:
    s_cmp_eq_u32 s38, 3
    s_cbranch_scc0 L_recurrent_scan__compressed_kv_cla__moe_arch_mod__prompt_kernel_swn_78
    s_and_b32 s20, s3, 3
    s_lshl_b32 s20, s20, 8
    s_lshl_b32 s21, s28, 5
    s_add_u32 s20, s20, s21
    s_lshr_b32 s21, s3, 2
    s_lshl_b32 s21, s21, 7
    v_lshrrev_b32 v25, 3, v1
    s_lshl_b32 s36, s28, 5
    s_add_u32 s36, s36, s20
    v_add_u32 v25, s36, v25
    v_mul_u32_u24 v25, 7168, v25
    v_add_u32 v25, s21, v25
    v_bfe_u32 v26, v1, 4, 1
    v_lshlrev_b32 v26, 1, v26
    v_and_b32 v27, 7, v1
    v_xor_b32 v26, v26, v27
    v_lshl_add_u32 v24, v26, 4, v25
    v_xor_b32 v26, 4, v26
    v_lshl_add_u32 v25, v26, 4, v25
    v_add_u32 v25, 56320, v25
    v_add_u32 v26, 112640, v24
    v_add_u32 v27, 112640, v25
    s_lshl_b32 s36, s28, 13
    s_add_u32 m0, s36, 131072
    s_mov_b32 s37, 229376
    buffer_load_dwordx4 v24, s[8:11], 0 offen offset:0 nt lds
    buffer_load_dwordx4 v25, s[8:11], 0 offen offset:1024 nt lds
    buffer_load_dwordx4 v26, s[8:11], 0 offen offset:2048 nt lds
    buffer_load_dwordx4 v27, s[8:11], 0 offen offset:3072 nt lds
    s_add_u32 m0, s36, 135168
    s_nop 0
    buffer_load_dwordx4 v24, s[8:11], s37 offen offset:0 nt lds
    buffer_load_dwordx4 v25, s[8:11], s37 offen offset:1024 nt lds
    buffer_load_dwordx4 v26, s[8:11], s37 offen offset:2048 nt lds
    buffer_load_dwordx4 v27, s[8:11], s37 offen offset:3072 nt lds
    s_branch L_recurrent_scan__compressed_kv_cla__moe_arch_mod__prompt_kernel_swend_75
L_recurrent_scan__compressed_kv_cla__moe_arch_mod__prompt_kernel_swn_78:
    s_cmp_eq_u32 s38, 5
    s_cbranch_scc0 L_recurrent_scan__compressed_kv_cla__moe_arch_mod__prompt_kernel_swn_79
    v_lshrrev_b32 v8, 4, v1
    v_bfe_u32 v5, v1, 2, 2
    v_lshl_add_u32 v5, v8, 3, v5
    v_lshlrev_b32 v5, 7, v5
    v_and_b32 v9, 3, v1
    v_lshl_add_u32 v5, v9, 3, v5
    v_bfe_u32 v9, v1, 3, 2
    v_xor_b32 v9, s28, v9
    v_lshl_add_u32 v5, v9, 5, v5
    v_add_u32 v5, 131072, v5
    ds_read_b64_tr_b16 v[14:15], v5 offset:0
    ds_read_b64_tr_b16 v[16:17], v5 offset:512
    ds_read_b64_tr_b16 v[20:21], v5 offset:4096
    ds_read_b64_tr_b16 v[22:23], v5 offset:4608
    ds_read_b64_tr_b16 v[24:25], v5 offset:8192
    ds_read_b64_tr_b16 v[26:27], v5 offset:8704
    s_and_b32 s36, s3, 3
    s_lshl_b32 s36, s36, 6
    s_lshr_b32 s37, s3, 2
    s_lshl_b32 s37, s37, 12
    s_add_u32 s36, s36, s37
    s_lshl_b32 s37, s28, 10
    s_add_u32 s36, s36, s37
    s_add_u32 s36, s36, 58720288
    v_and_b32 v9, 1, v1
    v_lshlrev_b32 v9, 4, v9
    v_lshl_add_u32 v9, v8, 8, v9
    s_waitcnt lgkmcnt(4)
    v_mfma_f32_16x16x32_bf16 v[10:13], v[14:17], v[160:163], 0
    ds_read_b64_tr_b16 v[14:15], v5 offset:12288
    ds_read_b64_tr_b16 v[16:17], v5 offset:12800
    s_waitcnt lgkmcnt(4)
    v_mfma_f32_16x16x32_bf16 v[10:13], v[20:23], v[164:167], v[10:13]
    ds_read_b64_tr_b16 v[20:21], v5 offset:16384
    ds_read_b64_tr_b16 v[22:23], v5 offset:16896
    s_waitcnt lgkmcnt(4)
    v_mfma_f32_16x16x32_bf16 v[10:13], v[24:27], v[168:171], v[10:13]
    ds_read_b64_tr_b16 v[24:25], v5 offset:20480
    ds_read_b64_tr_b16 v[26:27], v5 offset:20992
    s_waitcnt lgkmcnt(4)
    v_mfma_f32_16x16x32_bf16 v[10:13], v[14:17], v[172:175], v[10:13]
    ds_read_b64_tr_b16 v[14:15], v5 offset:24576
    ds_read_b64_tr_b16 v[16:17], v5 offset:25088
    s_waitcnt lgkmcnt(4)
    v_mfma_f32_16x16x32_bf16 v[10:13], v[20:23], v[176:179], v[10:13]
    ds_read_b64_tr_b16 v[20:21], v5 offset:28672
    ds_read_b64_tr_b16 v[22:23], v5 offset:29184
    s_waitcnt lgkmcnt(4)
    v_mfma_f32_16x16x32_bf16 v[10:13], v[24:27], v[180:183], v[10:13]
    s_waitcnt lgkmcnt(2)
    v_mfma_f32_16x16x32_bf16 v[10:13], v[14:17], v[184:187], v[10:13]
    s_waitcnt lgkmcnt(0)
    v_mfma_f32_16x16x32_bf16 v[10:13], v[20:23], v[188:191], v[10:13]
    s_nop 5
    s_mov_b32 exec_lo, 0x00030003
    s_mov_b32 exec_hi, 0x00030003
    buffer_store_dwordx4 v[10:13], v9, s[24:27], s36 offen sc1
    s_mov_b64 exec, -1
    s_nop 1
    s_branch L_recurrent_scan__compressed_kv_cla__moe_arch_mod__prompt_kernel_swend_75
L_recurrent_scan__compressed_kv_cla__moe_arch_mod__prompt_kernel_swn_79:
    s_mul_i32 s36, s3, 2341
    s_lshr_b32 s36, s36, 16
    s_add_u32 s36, s36, 48
    s_lshl_b32 s36, s36, 7
    v_mov_b32 v20, s36
    v_mov_b32 v21, 1
    s_mov_b64 exec, 1
    global_atomic_add v20, v21, s[90:91]
    s_mov_b64 exec, -1
    s_nop 3
L_recurrent_scan__compressed_kv_cla__moe_arch_mod__prompt_kernel_swend_75:
L_recurrent_scan__compressed_kv_cla__moe_arch_mod__prompt_kernel_swend_84:
    s_branch L_recurrent_scan__compressed_kv_cla__moe_arch_mod__prompt_kernel_back_89
L_recurrent_scan__compressed_kv_cla__moe_arch_mod__prompt_kernel_rare_98:
    v_mov_b32 v20, 4048155338
    v_subrev_u32 v21, s36, v18
    v_cmp_gt_i32 s[20:21], 0, v21
    v_cmp_gt_i32 s[22:23], 1, v21
    v_cmp_gt_i32 s[62:63], 2, v21
    v_cmp_gt_i32 vcc, 3, v21
    v_cndmask_b32 v112, v112, v20, s[20:21]
    v_cndmask_b32 v113, v113, v20, s[22:23]
    v_cndmask_b32 v114, v114, v20, s[62:63]
    v_cndmask_b32 v115, v115, v20, vcc
    v_cmp_gt_i32 s[20:21], 16, v21
    v_cmp_gt_i32 s[22:23], 17, v21
    v_cmp_gt_i32 s[62:63], 18, v21
    v_cmp_gt_i32 vcc, 19, v21
    v_cndmask_b32 v116, v116, v20, s[20:21]
    v_cndmask_b32 v117, v117, v20, s[22:23]
    v_cndmask_b32 v118, v118, v20, s[62:63]
    v_cndmask_b32 v119, v119, v20, vcc
    v_cmp_gt_i32 s[20:21], -16, v21
    v_cmp_gt_i32 s[22:23], -15, v21
    v_cmp_gt_i32 s[62:63], -14, v21
    v_cmp_gt_i32 vcc, -13, v21
    v_cndmask_b32 v120, v120, v20, s[20:21]
    v_cndmask_b32 v121, v121, v20, s[22:23]
    v_cndmask_b32 v122, v122, v20, s[62:63]
    v_cndmask_b32 v123, v123, v20, vcc
    v_cmp_gt_i32 s[20:21], 0, v21
    v_cmp_gt_i32 s[22:23], 1, v21
    v_cmp_gt_i32 s[62:63], 2, v21
    v_cmp_gt_i32 vcc, 3, v21
    v_cndmask_b32 v124, v124, v20, s[20:21]
    v_cndmask_b32 v125, v125, v20, s[22:23]
    v_cndmask_b32 v126, v126, v20, s[62:63]
    v_cndmask_b32 v127, v127, v20, vcc
    s_branch L_recurrent_scan__compressed_kv_cla__moe_arch_mod__prompt_kernel_back_99
L_recurrent_scan__compressed_kv_cla__moe_arch_mod__prompt_kernel_rare_102:
    s_mov_b32 s61, 0x40000
L_recurrent_scan__compressed_kv_cla__moe_arch_mod__prompt_kernel_spin_100:
    s_sub_u32 s61, s61, 1
    s_cbranch_scc1 L_recurrent_scan__compressed_kv_cla__moe_arch_mod__prompt_kernel_spinx_101
    s_sleep 8
    global_load_dword v11, v12, s[90:91] sc1
    s_waitcnt vmcnt(0)
    v_readfirstlane_b32 s36, v11
    s_nop 0
    s_cmp_lt_u32 s36, 28
    s_cbranch_scc1 L_recurrent_scan__compressed_kv_cla__moe_arch_mod__prompt_kernel_spin_100
L_recurrent_scan__compressed_kv_cla__moe_arch_mod__prompt_kernel_spinx_101:
    s_branch L_recurrent_scan__compressed_kv_cla__moe_arch_mod__prompt_kernel_back_103
L_recurrent_scan__compressed_kv_cla__moe_arch_mod__prompt_kernel_rare_107:
    v_mov_b32 v20, 4048155338
    v_subrev_u32 v21, s50, v18
    v_cmp_gt_i32 s[20:21], 0, v21
    v_cmp_gt_i32 s[22:23], 1, v21
    v_cmp_gt_i32 s[62:63], 2, v21
    v_cmp_gt_i32 vcc, 3, v21
    v_cndmask_b32 v96, v96, v20, s[20:21]
    v_cndmask_b32 v97, v97, v20, s[22:23]
    v_cndmask_b32 v98, v98, v20, s[62:63]
    v_cndmask_b32 v99, v99, v20, vcc
    v_cmp_gt_i32 s[20:21], 16, v21
    v_cmp_gt_i32 s[22:23], 17, v21
    v_cmp_gt_i32 s[62:63], 18, v21
    v_cmp_gt_i32 vcc, 19, v21
    v_cndmask_b32 v100, v100, v20, s[20:21]
    v_cndmask_b32 v101, v101, v20, s[22:23]
    v_cndmask_b32 v102, v102, v20, s[62:63]
    v_cndmask_b32 v103, v103, v20, vcc
    v_cmp_gt_i32 s[20:21], -16, v21
    v_cmp_gt_i32 s[22:23], -15, v21
    v_cmp_gt_i32 s[62:63], -14, v21
    v_cmp_gt_i32 vcc, -13, v21
    v_cndmask_b32 v104, v104, v20, s[20:21]
    v_cndmask_b32 v105, v105, v20, s[22:23]
    v_cndmask_b32 v106, v106, v20, s[62:63]
    v_cndmask_b32 v107, v107, v20, vcc
    v_cmp_gt_i32 s[20:21], 0, v21
    v_cmp_gt_i32 s[22:23], 1, v21
    v_cmp_gt_i32 s[62:63], 2, v21
    v_cmp_gt_i32 vcc, 3, v21
    v_cndmask_b32 v108, v108, v20, s[20:21]
    v_cndmask_b32 v109, v109, v20, s[22:23]
    v_cndmask_b32 v110, v110, v20, s[62:63]
    v_cndmask_b32 v111, v111, v20, vcc
    s_branch L_recurrent_scan__compressed_kv_cla__moe_arch_mod__prompt_kernel_back_108
L_grp1:
    v_mov_b32 v20, 1040356334
    v_mov_b32 v21, v20
    s_and_b32 s37, s28, 3
    s_lshl_b32 s37, s37, 13
    v_lshlrev_b32 v7, 4, v1
    v_add_u32 v4, s37, v7
    v_add_u32 v6, 4096, v4
    v_add_u32 v19, 131072, v4
    s_add_u32 s43, s37, 32768
    s_add_u32 s44, s37, 98304
    s_waitcnt vmcnt(4) lgkmcnt(0)
    v_pk_mul_f32 v[192:193], v[192:193], v[20:21]
    v_pk_mul_f32 v[194:195], v[194:195], v[20:21]
    v_pk_mul_f32 v[196:197], v[196:197], v[20:21]
    v_pk_mul_f32 v[198:199], v[198:199], v[20:21]
    v_cvt_pk_bf16_f32 v128, v192, v193
    v_cvt_pk_bf16_f32 v129, v194, v195
    v_cvt_pk_bf16_f32 v130, v196, v197
    v_cvt_pk_bf16_f32 v131, v198, v199
    v_pk_mul_f32 v[200:201], v[200:201], v[20:21]
    v_pk_mul_f32 v[202:203], v[202:203], v[20:21]
    v_pk_mul_f32 v[204:205], v[204:205], v[20:21]
    v_pk_mul_f32 v[206:207], v[206:207], v[20:21]
    v_cvt_pk_bf16_f32 v132, v200, v201
    v_cvt_pk_bf16_f32 v133, v202, v203
    v_cvt_pk_bf16_f32 v134, v204, v205
    v_cvt_pk_bf16_f32 v135, v206, v207
    v_pk_mul_f32 v[208:209], v[208:209], v[20:21]
    v_pk_mul_f32 v[210:211], v[210:211], v[20:21]
    v_pk_mul_f32 v[212:213], v[212:213], v[20:21]
    v_pk_mul_f32 v[214:215], v[214:215], v[20:21]
    v_cvt_pk_bf16_f32 v136, v208, v209
    v_cvt_pk_bf16_f32 v137, v210, v211
    v_cvt_pk_bf16_f32 v138, v212, v213
    v_cvt_pk_bf16_f32 v139, v214, v215
    v_pk_mul_f32 v[216:217], v[216:217], v[20:21]
    v_pk_mul_f32 v[218:219], v[218:219], v[20:21]
    v_pk_mul_f32 v[220:221], v[220:221], v[20:21]
    v_pk_mul_f32 v[222:223], v[222:223], v[20:21]
    v_cvt_pk_bf16_f32 v140, v216, v217
    v_cvt_pk_bf16_f32 v141, v218, v219
    v_cvt_pk_bf16_f32 v142, v220, v221
    v_cvt_pk_bf16_f32 v143, v222, v223
    v_pk_mul_f32 v[224:225], v[224:225], v[20:21]
    v_pk_mul_f32 v[226:227], v[226:227], v[20:21]
    v_pk_mul_f32 v[228:229], v[228:229], v[20:21]
    v_pk_mul_f32 v[230:231], v[230:231], v[20:21]
    v_cvt_pk_bf16_f32 v144, v224, v225
    v_cvt_pk_bf16_f32 v145, v226, v227
    v_cvt_pk_bf16_f32 v146, v228, v229
    v_cvt_pk_bf16_f32 v147, v230, v231
    v_pk_mul_f32 v[232:233], v[232:233], v[20:21]
    v_pk_mul_f32 v[234:235], v[234:235], v[20:21]
    v_pk_mul_f32 v[236:237], v[236:237], v[20:21]
    v_pk_mul_f32 v[238:239], v[238:239], v[20:21]
    v_cvt_pk_bf16_f32 v148, v232, v233
    v_cvt_pk_bf16_f32 v149, v234, v235
    v_cvt_pk_bf16_f32 v150, v236, v237
    v_cvt_pk_bf16_f32 v151, v238, v239
    v_pk_mul_f32 v[240:241], v[240:241], v[20:21]
    v_pk_mul_f32 v[242:243], v[242:243], v[20:21]
    v_pk_mul_f32 v[244:245], v[244:245], v[20:21]
    v_pk_mul_f32 v[246:247], v[246:247], v[20:21]
    v_cvt_pk_bf16_f32 v152, v240, v241
    v_cvt_pk_bf16_f32 v153, v242, v243
    v_cvt_pk_bf16_f32 v154, v244, v245
    v_cvt_pk_bf16_f32 v155, v246, v247
    v_pk_mul_f32 v[248:249], v[248:249], v[20:21]
    v_pk_mul_f32 v[250:251], v[250:251], v[20:21]
    v_pk_mul_f32 v[252:253], v[252:253], v[20:21]
    v_pk_mul_f32 v[254:255], v[254:255], v[20:21]
    v_cvt_pk_bf16_f32 v156, v248, v249
    v_cvt_pk_bf16_f32 v157, v250, v251
    v_cvt_pk_bf16_f32 v158, v252, v253
    v_cvt_pk_bf16_f32 v159, v254, v255
    v_mov_b32 v2, v7
    v_and_b32 v21, 15, v1
    v_lshrrev_b32 v22, 4, v1
    v_lshlrev_b32 v22, 2, v22
    v_sub_u32 v18, v21, v22
    s_mov_b32 s40, 0
    s_mov_b32 s41, 16384
    s_mov_b32 s49, 0xffff
    s_lshl_b32 s51, s30, 1
    s_add_u32 s51, s51, 1
    s_and_b32 s50, s28, 3
    s_lshl_b32 s50, s50, 5
    v_mov_b32 v36, 0x3f803f80
    v_mov_b32 v37, 0x3f803f80
    v_mov_b32 v38, 0x3f803f80
    v_mov_b32 v39, 0x3f803f80
    s_lshl_b32 s42, 7, s51
    s_lshr_b32 s42, s42, 2
    s_or_b32 s42, s42, 0x8001
    s_mov_b64 s[52:53], 0
    s_waitcnt lgkmcnt(0)
    s_barrier
    ds_read_b128 v[160:163], v19 offset:0
    ds_read_b128 v[164:167], v19 offset:1024
    ds_read_b128 v[168:171], v19 offset:2048
    ds_read_b128 v[172:175], v19 offset:3072
    ds_read_b128 v[176:179], v19 offset:4096
    ds_read_b128 v[180:183], v19 offset:5120
    ds_read_b128 v[184:187], v19 offset:6144
    ds_read_b128 v[188:191], v19 offset:7168
    s_add_u32 s16, s54, 41943040
    s_addc_u32 s17, s55, 0
    s_and_b32 s17, s17, 0xffff
    s_mov_b32 s18, 16777216
    s_mov_b32 s19, 0x20000
    s_cmp_eq_u32 s28, 4
    s_cbranch_scc1 L_recurrent_scan__compressed_kv_cla__moe_arch_mod__prompt_kernel_rare_109
L_recurrent_scan__compressed_kv_cla__moe_arch_mod__prompt_kernel_back_110:
    s_sub_u32 s36, s2, 128
    s_lshl_b32 s36, s36, 1
    s_and_b32 s37, s28, 1
    s_add_u32 s36, s36, s37
    s_cmp_lt_u32 s28, 6
    s_cselect_b64 s[4:5], s[32:33], s[34:35]
    s_cselect_b32 s37, 32, 28
    s_lshl_b32 s37, s37, 3
    s_cmp_lt_u32 s36, s37
    s_cselect_b32 s6, 32768, 0
    s_cselect_b32 s36, s36, 0
    s_sub_u32 s37, s37, s36
    s_lshl_b32 s37, s37, 15
    s_min_u32 s6, s6, s37
    s_lshl_b32 s36, s36, 15
    s_add_u32 s4, s4, s36
    s_addc_u32 s5, s5, 0
    s_and_b32 s5, s5, 0xffff
    s_mov_b32 s7, 0x20000
    v_cmp_gt_u32 vcc, 20, v1
    v_lshlrev_b32 v13, 7, v1
    v_mov_b32 v12, 0x100000
    v_cndmask_b32 v13, v12, v13, vcc
    s_mov_b32 s48, 0
    s_cmp_eq_u32 s28, 5
    s_cselect_b32 s36, 0x1000, 0
    s_or_b32 s42, s42, s36
    ds_read_b128 v[64:67], v2 offset:0
    ds_read_b128 v[68:71], v2 offset:1024
    ds_read_b128 v[72:75], v2 offset:2048
    ds_read_b128 v[76:79], v2 offset:3072
    ds_read_b128 v[80:83], v2 offset:4096
    ds_read_b128 v[84:87], v2 offset:5120
    ds_read_b128 v[88:91], v2 offset:6144
    ds_read_b128 v[92:95], v2 offset:7168
    s_waitcnt lgkmcnt(7)
    v_mfma_f32_16x16x32_bf16 v[96:99], v[64:67], v[128:131], 0
    v_mov_b64 v[192:193], 0
    v_mov_b64 v[194:195], 0
    v_mfma_f32_16x16x32_bf16 v[104:107], v[64:67], v[144:147], 0
    ds_read_b128 v[64:67], v2 offset:8192
    v_mov_b64 v[196:197], 0
    v_mov_b64 v[198:199], 0
    s_waitcnt lgkmcnt(7)
    v_mfma_f32_16x16x32_bf16 v[96:99], v[68:71], v[132:135], v[96:99]
    v_mov_b64 v[200:201], 0
    v_mov_b64 v[202:203], 0
    v_mfma_f32_16x16x32_bf16 v[104:107], v[68:71], v[148:151], v[104:107]
    ds_read_b128 v[68:71], v2 offset:9216
    v_mov_b64 v[204:205], 0
    v_mov_b64 v[206:207], 0
    s_waitcnt lgkmcnt(7)
    v_mfma_f32_16x16x32_bf16 v[96:99], v[72:75], v[136:139], v[96:99]
    v_mov_b64 v[208:209], 0
    v_mfma_f32_16x16x32_bf16 v[104:107], v[72:75], v[152:155], v[104:107]
    ds_read_b128 v[72:75], v2 offset:10240
    v_mov_b64 v[210:211], 0
    v_mov_b64 v[212:213], 0
    s_waitcnt lgkmcnt(7)
    v_mfma_f32_16x16x32_bf16 v[96:99], v[76:79], v[140:143], v[96:99]
    v_mov_b64 v[214:215], 0
    v_mov_b64 v[216:217], 0
    v_mfma_f32_16x16x32_bf16 v[104:107], v[76:79], v[156:159], v[104:107]
    ds_read_b128 v[76:79], v2 offset:11264
    v_mov_b64 v[218:219], 0
    v_mov_b64 v[220:221], 0
    s_waitcnt lgkmcnt(7)
    v_mfma_f32_16x16x32_bf16 v[100:103], v[80:83], v[128:131], 0
    v_mov_b64 v[222:223], 0
    v_mov_b64 v[224:225], 0
    v_mfma_f32_16x16x32_bf16 v[108:111], v[80:83], v[144:147], 0
    ds_read_b128 v[80:83], v2 offset:12288
    v_mov_b64 v[226:227], 0
    s_waitcnt lgkmcnt(7)
    v_mfma_f32_16x16x32_bf16 v[100:103], v[84:87], v[132:135], v[100:103]
    v_mov_b64 v[228:229], 0
    v_mov_b64 v[230:231], 0
    v_mfma_f32_16x16x32_bf16 v[108:111], v[84:87], v[148:151], v[108:111]
    ds_read_b128 v[84:87], v2 offset:13312
    v_mov_b64 v[232:233], 0
    v_mov_b64 v[234:235], 0
    s_waitcnt lgkmcnt(7)
    v_mfma_f32_16x16x32_bf16 v[100:103], v[88:91], v[136:139], v[100:103]
    v_mov_b64 v[236:237], 0
    v_mov_b64 v[238:239], 0
    v_mfma_f32_16x16x32_bf16 v[108:111], v[88:91], v[152:155], v[108:111]
    ds_read_b128 v[88:91], v2 offset:14336
    v_mov_b64 v[240:241], 0
    v_mov_b64 v[242:243], 0
    s_waitcnt lgkmcnt(7)
    v_mfma_f32_16x16x32_bf16 v[100:103], v[92:95], v[140:143], v[100:103]
    v_mov_b64 v[244:245], 0
    v_mfma_f32_16x16x32_bf16 v[108:111], v[92:95], v[156:159], v[108:111]
    ds_read_b128 v[92:95], v2 offset:15360
    v_mov_b64 v[246:247], 0
    v_mov_b64 v[248:249], 0
    s_waitcnt lgkmcnt(7)
    v_mfma_f32_16x16x32_bf16 v[112:115], v[64:67], v[128:131], 0
    v_mov_b64 v[250:251], 0
    v_mov_b64 v[252:253], 0
    v_mfma_f32_16x16x32_bf16 v[120:123], v[64:67], v[144:147], 0
    v_mov_b64 v[254:255], 0
    v_mov_b64 v[28:29], 0
    s_waitcnt lgkmcnt(6)
    v_mfma_f32_16x16x32_bf16 v[112:115], v[68:71], v[132:135], v[112:115]
    v_mov_b64 v[30:31], 0
    v_mov_b64 v[32:33], 0
    v_mfma_f32_16x16x32_bf16 v[120:123], v[68:71], v[148:151], v[120:123]
    v_mov_b64 v[34:35], 0
    s_waitcnt lgkmcnt(5)
    v_mfma_f32_16x16x32_bf16 v[112:115], v[72:75], v[136:139], v[112:115]
    s_add_u32 s36, s30, s50
    s_cmp_eq_u32 s36, 0
    s_cbranch_scc1 L_recurrent_scan__compressed_kv_cla__moe_arch_mod__prompt_kernel_rare_112
L_recurrent_scan__compressed_kv_cla__moe_arch_mod__prompt_kernel_back_113:
    v_mfma_f32_16x16x32_bf16 v[120:123], v[72:75], v[152:155], v[120:123]
    v_max3_f32 v22, v96, v97, v98
    v_max3_f32 v23, v104, v105, v106
    s_waitcnt lgkmcnt(4)
    v_mfma_f32_16x16x32_bf16 v[112:115], v[76:79], v[140:143], v[112:115]
    v_max3_f32 v22, v22, v99, v100
    v_max3_f32 v23, v23, v107, v108
    v_mfma_f32_16x16x32_bf16 v[120:123], v[76:79], v[156:159], v[120:123]
    v_max3_f32 v22, v22, v101, v102
    v_max3_f32 v23, v23, v109, v110
    s_waitcnt lgkmcnt(3)
    v_mfma_f32_16x16x32_bf16 v[116:119], v[80:83], v[128:131], 0
    v_max_f32 v22, v22, v103
    v_max_f32 v23, v23, v111
    v_mfma_f32_16x16x32_bf16 v[124:127], v[80:83], v[144:147], 0
    v_mov_b32 v24, v22
    v_mov_b32 v25, v23
    s_waitcnt lgkmcnt(2)
    v_mfma_f32_16x16x32_bf16 v[116:119], v[84:87], v[132:135], v[116:119]
    v_permlane16_swap_b32 v22, v24
    v_permlane16_swap_b32 v23, v25
    v_mfma_f32_16x16x32_bf16 v[124:127], v[84:87], v[148:151], v[124:127]
    v_max_f32 v22, v22, v24
    v_max_f32 v23, v23, v25
    s_waitcnt lgkmcnt(1)
    v_mfma_f32_16x16x32_bf16 v[116:119], v[88:91], v[136:139], v[116:119]
    v_mov_b32 v24, v22
    v_mov_b32 v25, v23
    v_mfma_f32_16x16x32_bf16 v[124:127], v[88:91], v[152:155], v[124:127]
    v_permlane32_swap_b32 v22, v24
    v_permlane32_swap_b32 v23, v25
    s_waitcnt lgkmcnt(0)
    v_mfma_f32_16x16x32_bf16 v[116:119], v[92:95], v[140:143], v[116:119]
    v_max_f32 v22, v22, v24
    v_max_f32 v23, v23, v25
    v_mfma_f32_16x16x32_bf16 v[124:127], v[92:95], v[156:159], v[124:127]
    v_sub_f32 v40, 0, v22
    v_sub_f32 v41, 0, v22
    v_sub_f32 v42, 0, v22
    v_sub_f32 v43, 0, v22
    v_sub_f32 v44, 0, v23
    v_sub_f32 v45, 0, v23
    v_sub_f32 v46, 0, v23
    v_sub_f32 v47, 0, v23
    v_add_u32 v3, 65536, v2
    v_add_u32 v2, s41, v2
    v_and_b32 v2, s49, v2
    s_waitcnt vmcnt(1)
    s_cmp_eq_u32 s28, 4
    s_cbranch_scc1 L_recurrent_scan__compressed_kv_cla__moe_arch_mod__prompt_kernel_pw_114
    s_waitcnt vmcnt(0)
L_recurrent_scan__compressed_kv_cla__moe_arch_mod__prompt_kernel_pw_114:
    s_barrier
    ds_read_b128 v[64:67], v2 offset:0
    ds_read_b128 v[68:71], v2 offset:1024
    ds_read_b128 v[72:75], v2 offset:2048
    ds_read_b128 v[76:79], v2 offset:3072
    ds_read_b128 v[80:83], v2 offset:4096
    ds_read_b128 v[84:87], v2 offset:5120
    ds_read_b128 v[88:91], v2 offset:6144
    v_pk_add_f32 v[96:97], v[96:97], v[40:41]
    v_pk_add_f32 v[98:99], v[98:99], v[40:41]
    v_pk_add_f32 v[100:101], v[100:101], v[40:41]
    v_pk_add_f32 v[102:103], v[102:103], v[40:41]
    v_pk_add_f32 v[104:105], v[104:105], v[44:45]
    v_pk_add_f32 v[106:107], v[106:107], v[44:45]
    v_pk_add_f32 v[108:109], v[108:109], v[44:45]
    v_pk_add_f32 v[110:111], v[110:111], v[44:45]
    v_pk_add_f32 v[112:113], v[112:113], v[40:41]
    v_pk_add_f32 v[114:115], v[114:115], v[40:41]
    v_pk_add_f32 v[116:117], v[116:117], v[40:41]
    v_pk_add_f32 v[118:119], v[118:119], v[40:41]
    v_pk_add_f32 v[120:121], v[120:121], v[44:45]
    v_pk_add_f32 v[122:123], v[122:123], v[44:45]
    v_pk_add_f32 v[124:125], v[124:125], v[44:45]
    v_pk_add_f32 v[126:127], v[126:127], v[44:45]
    v_exp_f32 v96, v96
    v_exp_f32 v97, v97
    v_exp_f32 v98, v98
    v_exp_f32 v99, v99
    v_exp_f32 v104, v104
    v_exp_f32 v105, v105
    v_exp_f32 v106, v106
    v_exp_f32 v107, v107
    v_exp_f32 v100, v100
    v_exp_f32 v101, v101
    v_exp_f32 v102, v102
    v_exp_f32 v103, v103
    v_exp_f32 v108, v108
    v_exp_f32 v109, v109
    v_exp_f32 v110, v110
    v_exp_f32 v111, v111
    v_cvt_pk_bf16_f32 v48, v96, v97
    v_cvt_pk_bf16_f32 v49, v98, v99
    v_cvt_pk_bf16_f32 v52, v104, v105
    v_cvt_pk_bf16_f32 v53, v106, v107
    v_cvt_pk_bf16_f32 v50, v100, v101
    v_cvt_pk_bf16_f32 v51, v102, v103
    v_cvt_pk_bf16_f32 v54, v108, v109
    v_cvt_pk_bf16_f32 v55, v110, v111
    .p2align 6
L_body1:
    s_bitcmp1_b32 s42, s40
    s_cbranch_scc1 L_recurrent_scan__compressed_kv_cla__moe_arch_mod__prompt_kernel_rare_119
L_recurrent_scan__compressed_kv_cla__moe_arch_mod__prompt_kernel_back_120:
    s_waitcnt lgkmcnt(5)
    v_mfma_f32_16x16x32_bf16 v[96:99], v[64:67], v[128:131], v[40:43]
    v_exp_f32 v112, v112
    v_mfma_f32_16x16x32_bf16 v[104:107], v[64:67], v[144:147], v[44:47]
    ds_read_b128 v[92:95], v2 offset:7168
    v_mfma_f32_16x16x32_bf16 v[96:99], v[68:71], v[132:135], v[96:99]
    v_exp_f32 v113, v113
    v_mfma_f32_16x16x32_bf16 v[104:107], v[68:71], v[148:151], v[104:107]
    ds_read_b128 v[64:67], v3 offset:0
    s_waitcnt lgkmcnt(5)
    v_mfma_f32_16x16x32_bf16 v[96:99], v[72:75], v[136:139], v[96:99]
    v_exp_f32 v114, v114
    v_mfma_f32_16x16x32_bf16 v[104:107], v[72:75], v[152:155], v[104:107]
    ds_read_b128 v[68:71], v3 offset:1024
    v_cvt_pk_bf16_f32 v56, v112, v113
    v_mfma_f32_16x16x32_bf16 v[96:99], v[76:79], v[140:143], v[96:99]
    v_exp_f32 v115, v115
    v_mfma_f32_16x16x32_bf16 v[104:107], v[76:79], v[156:159], v[104:107]
    ds_read_b128 v[72:75], v3 offset:2048
    s_waitcnt lgkmcnt(5)
    v_mfma_f32_16x16x32_bf16 v[100:103], v[80:83], v[128:131], v[40:43]
    v_exp_f32 v120, v120
    v_mfma_f32_16x16x32_bf16 v[108:111], v[80:83], v[144:147], v[44:47]
    ds_read_b128 v[76:79], v3 offset:3072
    v_cvt_pk_bf16_f32 v57, v114, v115
    v_mfma_f32_16x16x32_bf16 v[100:103], v[84:87], v[132:135], v[100:103]
    v_exp_f32 v121, v121
    v_mfma_f32_16x16x32_bf16 v[108:111], v[84:87], v[148:151], v[108:111]
    ds_read_b128 v[80:83], v3 offset:4096
    s_waitcnt lgkmcnt(5)
    v_mfma_f32_16x16x32_bf16 v[100:103], v[88:91], v[136:139], v[100:103]
    v_exp_f32 v122, v122
    v_mfma_f32_16x16x32_bf16 v[108:111], v[88:91], v[152:155], v[108:111]
    ds_read_b128 v[84:87], v3 offset:5120
    v_cvt_pk_bf16_f32 v60, v120, v121
    v_mfma_f32_16x16x32_bf16 v[100:103], v[92:95], v[140:143], v[100:103]
    v_exp_f32 v123, v123
    v_mfma_f32_16x16x32_bf16 v[108:111], v[92:95], v[156:159], v[108:111]
    ds_read_b128 v[88:91], v3 offset:6144
    s_waitcnt lgkmcnt(5)
    v_mfma_f32_16x16x32_bf16 v[192:195], v[64:67], v[48:51], v[192:195]
    v_exp_f32 v116, v116
    v_mfma_f32_16x16x32_bf16 v[224:227], v[64:67], v[52:55], v[224:227]
    ds_read_b128 v[92:95], v3 offset:7168
    v_cvt_pk_bf16_f32 v61, v122, v123
    v_mfma_f32_16x16x32_bf16 v[196:199], v[68:71], v[48:51], v[196:199]
    v_exp_f32 v117, v117
    v_mfma_f32_16x16x32_bf16 v[228:231], v[68:71], v[52:55], v[228:231]
    ds_read_b128 v[64:67], v2 offset:8192
    s_waitcnt lgkmcnt(5)
    v_mfma_f32_16x16x32_bf16 v[200:203], v[72:75], v[48:51], v[200:203]
    v_exp_f32 v118, v118
    v_mfma_f32_16x16x32_bf16 v[232:235], v[72:75], v[52:55], v[232:235]
    v_mfma_f32_16x16x32_bf16 v[28:31], v[36:39], v[48:51], v[28:31]
    ds_read_b128 v[68:71], v2 offset:9216
    v_cvt_pk_bf16_f32 v58, v116, v117
    v_mfma_f32_16x16x32_bf16 v[204:207], v[76:79], v[48:51], v[204:207]
    v_exp_f32 v119, v119
    v_mfma_f32_16x16x32_bf16 v[236:239], v[76:79], v[52:55], v[236:239]
    ds_read_b128 v[72:75], v2 offset:10240
    s_waitcnt lgkmcnt(5)
    v_mfma_f32_16x16x32_bf16 v[208:211], v[80:83], v[48:51], v[208:211]
    v_exp_f32 v124, v124
    buffer_load_dword v0, v13, s[4:7], s48 offen
    s_add_u32 s48, s48, 2560
    v_mfma_f32_16x16x32_bf16 v[240:243], v[80:83], v[52:55], v[240:243]
    ds_read_b128 v[76:79], v2 offset:11264
    v_cvt_pk_bf16_f32 v59, v118, v119
    v_mfma_f32_16x16x32_bf16 v[212:215], v[84:87], v[48:51], v[212:215]
    v_exp_f32 v125, v125
    v_mfma_f32_16x16x32_bf16 v[244:247], v[84:87], v[52:55], v[244:247]
    ds_read_b128 v[80:83], v2 offset:12288
    s_waitcnt lgkmcnt(5)
    v_mfma_f32_16x16x32_bf16 v[216:219], v[88:91], v[48:51], v[216:219]
    v_exp_f32 v126, v126
    v_mfma_f32_16x16x32_bf16 v[248:251], v[88:91], v[52:55], v[248:251]
    v_mfma_f32_16x16x32_bf16 v[32:35], v[36:39], v[52:55], v[32:35]
    ds_read_b128 v[84:87], v2 offset:13312
    v_cvt_pk_bf16_f32 v62, v124, v125
    v_mfma_f32_16x16x32_bf16 v[220:223], v[92:95], v[48:51], v[220:223]
    v_exp_f32 v127, v127
    v_mfma_f32_16x16x32_bf16 v[252:255], v[92:95], v[52:55], v[252:255]
    ds_read_b128 v[88:91], v2 offset:14336
    v_cvt_pk_bf16_f32 v63, v126, v127
    s_bitcmp1_b32 s42, s40
    s_cbranch_scc1 L_recurrent_scan__compressed_kv_cla__moe_arch_mod__prompt_kernel_rare_122
L_recurrent_scan__compressed_kv_cla__moe_arch_mod__prompt_kernel_back_123:
    s_waitcnt lgkmcnt(5)
    v_mfma_f32_16x16x32_bf16 v[112:115], v[64:67], v[128:131], v[40:43]
    v_exp_f32 v96, v96
    v_mfma_f32_16x16x32_bf16 v[120:123], v[64:67], v[144:147], v[44:47]
    ds_read_b128 v[92:95], v2 offset:15360
    v_mfma_f32_16x16x32_bf16 v[112:115], v[68:71], v[132:135], v[112:115]
    v_exp_f32 v97, v97
    v_mfma_f32_16x16x32_bf16 v[120:123], v[68:71], v[148:151], v[120:123]
    ds_read_b128 v[64:67], v3 offset:8192
    s_waitcnt lgkmcnt(5)
    v_mfma_f32_16x16x32_bf16 v[112:115], v[72:75], v[136:139], v[112:115]
    v_exp_f32 v98, v98
    v_mfma_f32_16x16x32_bf16 v[120:123], v[72:75], v[152:155], v[120:123]
    ds_read_b128 v[68:71], v3 offset:9216
    v_cvt_pk_bf16_f32 v48, v96, v97
    v_mfma_f32_16x16x32_bf16 v[112:115], v[76:79], v[140:143], v[112:115]
    v_exp_f32 v99, v99
    v_mfma_f32_16x16x32_bf16 v[120:123], v[76:79], v[156:159], v[120:123]
    ds_read_b128 v[72:75], v3 offset:10240
    s_waitcnt lgkmcnt(5)
    v_mfma_f32_16x16x32_bf16 v[116:119], v[80:83], v[128:131], v[40:43]
    v_exp_f32 v104, v104
    v_mfma_f32_16x16x32_bf16 v[124:127], v[80:83], v[144:147], v[44:47]
    ds_read_b128 v[76:79], v3 offset:11264
    v_cvt_pk_bf16_f32 v49, v98, v99
    v_mfma_f32_16x16x32_bf16 v[116:119], v[84:87], v[132:135], v[116:119]
    v_exp_f32 v105, v105
    v_mfma_f32_16x16x32_bf16 v[124:127], v[84:87], v[148:151], v[124:127]
    ds_read_b128 v[80:83], v3 offset:12288
    s_waitcnt lgkmcnt(5)
    v_mfma_f32_16x16x32_bf16 v[116:119], v[88:91], v[136:139], v[116:119]
    v_exp_f32 v106, v106
    v_mfma_f32_16x16x32_bf16 v[124:127], v[88:91], v[152:155], v[124:127]
    ds_read_b128 v[84:87], v3 offset:13312
    v_cvt_pk_bf16_f32 v52, v104, v105
    v_mfma_f32_16x16x32_bf16 v[116:119], v[92:95], v[140:143], v[116:119]
    v_exp_f32 v107, v107
    v_mfma_f32_16x16x32_bf16 v[124:127], v[92:95], v[156:159], v[124:127]
    ds_read_b128 v[88:91], v3 offset:14336
    s_waitcnt lgkmcnt(5)
    v_mfma_f32_16x16x32_bf16 v[192:195], v[64:67], v[56:59], v[192:195]
    v_exp_f32 v100, v100
    v_mfma_f32_16x16x32_bf16 v[224:227], v[64:67], v[60:63], v[224:227]
    ds_read_b128 v[92:95], v3 offset:15360
    v_cvt_pk_bf16_f32 v53, v106, v107
    v_mfma_f32_16x16x32_bf16 v[196:199], v[68:71], v[56:59], v[196:199]
    v_exp_f32 v101, v101
    v_mfma_f32_16x16x32_bf16 v[228:231], v[68:71], v[60:63], v[228:231]
    v_add_u32 v3, 65536, v2
    v_add_u32 v2, s41, v2
    s_waitcnt lgkmcnt(4)
    v_mfma_f32_16x16x32_bf16 v[200:203], v[72:75], v[56:59], v[200:203]
    v_exp_f32 v102, v102
    v_and_b32 v2, s49, v2
    v_mfma_f32_16x16x32_bf16 v[232:235], v[72:75], v[60:63], v[232:235]
    v_mfma_f32_16x16x32_bf16 v[28:31], v[36:39], v[56:59], v[28:31]
    v_cvt_pk_bf16_f32 v50, v100, v101
    s_waitcnt lgkmcnt(0)
    s_barrier
    v_mfma_f32_16x16x32_bf16 v[204:207], v[76:79], v[56:59], v[204:207]
    v_exp_f32 v103, v103
    v_mfma_f32_16x16x32_bf16 v[236:239], v[76:79], v[60:63], v[236:239]
    ds_read_b128 v[68:71], v2 offset:1024
    ds_read_b128 v[64:67], v2 offset:0
    v_mfma_f32_16x16x32_bf16 v[208:211], v[80:83], v[56:59], v[208:211]
    v_exp_f32 v108, v108
    v_mfma_f32_16x16x32_bf16 v[240:243], v[80:83], v[60:63], v[240:243]
    ds_read_b128 v[76:79], v2 offset:3072
    ds_read_b128 v[72:75], v2 offset:2048
    v_cvt_pk_bf16_f32 v51, v102, v103
    v_mfma_f32_16x16x32_bf16 v[212:215], v[84:87], v[56:59], v[212:215]
    v_exp_f32 v109, v109
    v_mfma_f32_16x16x32_bf16 v[244:247], v[84:87], v[60:63], v[244:247]
    ds_read_b128 v[80:83], v2 offset:4096
    v_mfma_f32_16x16x32_bf16 v[216:219], v[88:91], v[56:59], v[216:219]
    v_exp_f32 v110, v110
    v_mfma_f32_16x16x32_bf16 v[248:251], v[88:91], v[60:63], v[248:251]
    v_mfma_f32_16x16x32_bf16 v[32:35], v[36:39], v[60:63], v[32:35]
    ds_read_b128 v[84:87], v2 offset:5120
    v_cvt_pk_bf16_f32 v54, v108, v109
    v_mfma_f32_16x16x32_bf16 v[220:223], v[92:95], v[56:59], v[220:223]
    v_exp_f32 v111, v111
    v_mfma_f32_16x16x32_bf16 v[252:255], v[92:95], v[60:63], v[252:255]
    ds_read_b128 v[88:91], v2 offset:6144
    v_cvt_pk_bf16_f32 v55, v110, v111
    s_bitcmp1_b32 s42, s40
    s_cbranch_scc1 L_recurrent_scan__compressed_kv_cla__moe_arch_mod__prompt_kernel_rare_132
L_recurrent_scan__compressed_kv_cla__moe_arch_mod__prompt_kernel_back_133:
    s_add_u32 s40, s40, 1
    s_cmp_lg_u32 s40, 16
    s_cbranch_scc1 L_body1
    s_mov_b32 s4, s34
    s_and_b32 s5, s35, 0xffff
    s_mov_b32 s6, 7340032
    s_mov_b32 s7, 0x20000
    s_mov_b32 s8, s32
    s_and_b32 s9, s33, 0xffff
    s_mov_b32 s10, 8388608
    s_mov_b32 s11, 0x20000
    s_lshr_b32 s38, s2, 4
    s_mul_i32 s38, s38, 224
    s_and_b32 s39, s2, 15
    s_lshl_b32 s39, s39, 7
    v_lshrrev_b32 v25, 3, v1
    s_lshl_b32 s36, s28, 5
    s_add_u32 s36, s36, s38
    v_add_u32 v25, s36, v25
    v_mul_u32_u24 v25, 2048, v25
    v_add_u32 v25, s39, v25
    v_bfe_u32 v26, v1, 4, 1
    v_lshlrev_b32 v26, 1, v26
    v_and_b32 v27, 7, v1
    v_xor_b32 v26, v26, v27
    v_lshl_add_u32 v24, v26, 4, v25
    v_xor_b32 v26, 4, v26
    v_lshl_add_u32 v25, v26, 4, v25
    v_add_u32 v25, 15360, v25
    v_add_u32 v26, 30720, v24
    v_add_u32 v27, 30720, v25
    s_lshl_b32 s36, s28, 12
    s_add_u32 s36, s36, 131072
    s_cmp_lt_u32 s28, 7
    s_cselect_b32 m0, s36, 0x30000
    s_cselect_b32 s6, 7340032, 0
    buffer_load_dwordx4 v24, s[4:7], 0 offen offset:0 lds
    buffer_load_dwordx4 v25, s[4:7], 0 offen offset:1024 lds
    buffer_load_dwordx4 v26, s[4:7], 0 offen offset:2048 lds
    buffer_load_dwordx4 v27, s[4:7], 0 offen offset:3072 lds
    s_lshr_b32 s36, s2, 5
    s_add_u32 s36, s36, 48
    s_lshl_b32 s36, s36, 7
    v_mov_b32 v12, s36
    global_load_dword v11, v12, s[90:91] sc1
    s_sub_u32 s36, 96, s50
    s_cmp_lt_i32 s36, 0
    s_cbranch_scc0 L_recurrent_scan__compressed_kv_cla__moe_arch_mod__prompt_kernel_rare_125
L_recurrent_scan__compressed_kv_cla__moe_arch_mod__prompt_kernel_back_126:
    s_waitcnt lgkmcnt(5)
    v_mfma_f32_16x16x32_bf16 v[192:195], v[64:67], v[48:51], v[192:195]
    v_exp_f32 v112, v112
    v_mfma_f32_16x16x32_bf16 v[224:227], v[64:67], v[52:55], v[224:227]
    ds_read_b128 v[92:95], v3 offset:7168
    v_exp_f32 v113, v113
    v_mfma_f32_16x16x32_bf16 v[196:199], v[68:71], v[48:51], v[196:199]
    v_cvt_pk_bf16_f32 v56, v112, v113
    v_exp_f32 v114, v114
    v_mfma_f32_16x16x32_bf16 v[228:231], v[68:71], v[52:55], v[228:231]
    ds_read_b128 v[64:67], v3 offset:8192
    v_exp_f32 v115, v115
    s_waitcnt lgkmcnt(5)
    v_mfma_f32_16x16x32_bf16 v[200:203], v[72:75], v[48:51], v[200:203]
    v_cvt_pk_bf16_f32 v57, v114, v115
    v_exp_f32 v120, v120
    v_mfma_f32_16x16x32_bf16 v[232:235], v[72:75], v[52:55], v[232:235]
    v_mfma_f32_16x16x32_bf16 v[28:31], v[36:39], v[48:51], v[28:31]
    ds_read_b128 v[68:71], v3 offset:9216
    v_exp_f32 v121, v121
    v_mfma_f32_16x16x32_bf16 v[204:207], v[76:79], v[48:51], v[204:207]
    v_cvt_pk_bf16_f32 v60, v120, v121
    v_exp_f32 v122, v122
    v_mfma_f32_16x16x32_bf16 v[236:239], v[76:79], v[52:55], v[236:239]
    ds_read_b128 v[72:75], v3 offset:10240
    v_exp_f32 v123, v123
    s_waitcnt lgkmcnt(6)
    v_mfma_f32_16x16x32_bf16 v[208:211], v[80:83], v[48:51], v[208:211]
    v_cvt_pk_bf16_f32 v61, v122, v123
    v_exp_f32 v116, v116
    v_mfma_f32_16x16x32_bf16 v[240:243], v[80:83], v[52:55], v[240:243]
    ds_read_b128 v[76:79], v3 offset:11264
    v_exp_f32 v117, v117
    s_waitcnt lgkmcnt(6)
    v_mfma_f32_16x16x32_bf16 v[212:215], v[84:87], v[48:51], v[212:215]
    v_cvt_pk_bf16_f32 v58, v116, v117
    v_exp_f32 v118, v118
    v_mfma_f32_16x16x32_bf16 v[244:247], v[84:87], v[52:55], v[244:247]
    ds_read_b128 v[80:83], v3 offset:12288
    v_exp_f32 v119, v119
    s_waitcnt lgkmcnt(6)
    v_mfma_f32_16x16x32_bf16 v[216:219], v[88:91], v[48:51], v[216:219]
    v_cvt_pk_bf16_f32 v59, v118, v119
    v_exp_f32 v124, v124
    v_mfma_f32_16x16x32_bf16 v[248:251], v[88:91], v[52:55], v[248:251]
    v_mfma_f32_16x16x32_bf16 v[32:35], v[36:39], v[52:55], v[32:35]
    ds_read_b128 v[84:87], v3 offset:13312
    v_exp_f32 v125, v125
    s_waitcnt lgkmcnt(6)
    v_mfma_f32_16x16x32_bf16 v[220:223], v[92:95], v[48:51], v[220:223]
    v_cvt_pk_bf16_f32 v62, v124, v125
    v_exp_f32 v126, v126
    v_mfma_f32_16x16x32_bf16 v[252:255], v[92:95], v[52:55], v[252:255]
    ds_read_b128 v[88:91], v3 offset:14336
    v_exp_f32 v127, v127
    s_nop 0
    v_cvt_pk_bf16_f32 v63, v126, v127
    s_nop 1
    s_waitcnt lgkmcnt(6)
    v_mfma_f32_16x16x32_bf16 v[192:195], v[64:67], v[56:59], v[192:195]
    v_mfma_f32_16x16x32_bf16 v[224:227], v[64:67], v[60:63], v[224:227]
    ds_read_b128 v[92:95], v3 offset:15360
    s_waitcnt lgkmcnt(6)
    v_mfma_f32_16x16x32_bf16 v[196:199], v[68:71], v[56:59], v[196:199]
    v_mfma_f32_16x16x32_bf16 v[228:231], v[68:71], v[60:63], v[228:231]
    s_waitcnt lgkmcnt(5)
    v_mfma_f32_16x16x32_bf16 v[200:203], v[72:75], v[56:59], v[200:203]
    v_mfma_f32_16x16x32_bf16 v[232:235], v[72:75], v[60:63], v[232:235]
    v_mfma_f32_16x16x32_bf16 v[28:31], v[36:39], v[56:59], v[28:31]
    s_waitcnt lgkmcnt(4)
    v_mfma_f32_16x16x32_bf16 v[204:207], v[76:79], v[56:59], v[204:207]
    v_mfma_f32_16x16x32_bf16 v[236:239], v[76:79], v[60:63], v[236:239]
    s_waitcnt lgkmcnt(3)
    v_mfma_f32_16x16x32_bf16 v[208:211], v[80:83], v[56:59], v[208:211]
    v_mfma_f32_16x16x32_bf16 v[240:243], v[80:83], v[60:63], v[240:243]
    s_waitcnt lgkmcnt(2)
    v_mfma_f32_16x16x32_bf16 v[212:215], v[84:87], v[56:59], v[212:215]
    v_mfma_f32_16x16x32_bf16 v[244:247], v[84:87], v[60:63], v[244:247]
    s_waitcnt lgkmcnt(1)
    v_mfma_f32_16x16x32_bf16 v[216:219], v[88:91], v[56:59], v[216:219]
    v_mfma_f32_16x16x32_bf16 v[248:251], v[88:91], v[60:63], v[248:251]
    v_mfma_f32_16x16x32_bf16 v[32:35], v[36:39], v[60:63], v[32:35]
    s_waitcnt lgkmcnt(0)
    v_mfma_f32_16x16x32_bf16 v[220:223], v[92:95], v[56:59], v[220:223]
    v_mfma_f32_16x16x32_bf16 v[252:255], v[92:95], v[60:63], v[252:255]
    s_waitcnt vmcnt(0)
    v_readfirstlane_b32 s36, v11
    s_nop 0
    s_cmp_lt_u32 s36, 28
    s_cbranch_scc1 L_recurrent_scan__compressed_kv_cla__moe_arch_mod__prompt_kernel_rare_136
L_recurrent_scan__compressed_kv_cla__moe_arch_mod__prompt_kernel_back_137:
    s_lshr_b32 s36, s2, 4
    s_mul_i32 s36, s36, 7
    s_min_u32 s37, s28, 6
    s_add_u32 s36, s36, s37
    s_lshl_b32 s36, s36, 11
    s_add_u32 s36, s36, 58720256
    v_and_b32 v11, 15, v1
    v_lshlrev_b32 v11, 4, v11
    v_lshrrev_b32 v12, 4, v1
    v_lshl_add_u32 v11, v12, 9, v11
    buffer_load_dwordx4 v[96:99], v11, s[24:27], s36 offen offset:0 sc1
    buffer_load_dwordx4 v[100:103], v11, s[24:27], s36 offen offset:256 sc1
    s_lshl_b32 s37, s28, 13
    v_add_u32 v105, s37, v7
    v_xor_b32 v106, 32768, v105
    s_lshl_b32 s37, s28, 8
    s_add_u32 s37, s37, 159744
    v_lshl_add_u32 v107, v1, 2, s37
    v_xor_b32 v108, 1024, v107
    ds_write_b32 v107, v28
    s_mov_b32 s36, 0x5d800000
    v_cmp_nge_f32 vcc, s36, v28
    s_nop 0
    s_or_b64 s[52:53], s[52:53], vcc
    v_cmp_nge_f32 vcc, s36, v32
    s_nop 0
    s_or_b64 s[52:53], s[52:53], vcc
    s_or_b32 s36, s52, s53
    v_mov_b32 v110, s36
    s_lshl_b32 s37, s28, 2
    s_add_u32 s37, s37, 161792
    v_mov_b32 v111, s37
    ds_write_b32 v111, v110
    ds_write_b128 v105, v[192:195] offset:0
    ds_write_b128 v105, v[196:199] offset:1024
    ds_write_b128 v105, v[200:203] offset:2048
    ds_write_b128 v105, v[204:207] offset:3072
    ds_write_b128 v105, v[208:211] offset:4096
    ds_write_b128 v105, v[212:215] offset:5120
    ds_write_b128 v105, v[216:219] offset:6144
    ds_write_b128 v105, v[220:223] offset:7168
    v_mov_b32 v112, 161856
    v_and_b32 v111, 7, v1
    v_lshlrev_b32 v111, 2, v111
    v_add_u32 v111, 161792, v111
    s_sub_u32 s36, 15, s30
    s_lshl_b32 s38, s36, 3
    s_and_b32 s37, s28, 3
    s_lshl_b32 s37, s37, 1
    s_add_u32 s38, s38, s37
    s_add_u32 s38, s38, 1
    s_lshl_b32 s38, s38, 17
    s_lshl_b32 s37, s29, 12
    s_add_u32 s38, s38, s37
    s_waitcnt lgkmcnt(0)
    s_barrier
    ds_read_b128 v[114:117], v112
    ds_read_b32 v110, v111
    ds_read_b32 v109, v108
    ds_read_b128 v[64:67], v106 offset:0
    ds_read_b128 v[68:71], v106 offset:1024
    ds_read_b128 v[72:75], v106 offset:2048
    ds_read_b128 v[76:79], v106 offset:3072
    ds_read_b128 v[80:83], v106 offset:4096
    ds_read_b128 v[84:87], v106 offset:5120
    ds_read_b128 v[88:91], v106 offset:6144
    ds_read_b128 v[92:95], v106 offset:7168
    s_waitcnt lgkmcnt(8)
    v_add_f32 v109, v109, v32
    v_cmp_ne_u32 s[52:53], 0, v110
    v_readfirstlane_b32 s56, v114
    v_readfirstlane_b32 s57, v115
    v_readfirstlane_b32 s58, v116
    v_readfirstlane_b32 s59, v117
    v_rcp_f32 v109, v109
    s_nop 0
    v_mov_b32 v108, v109
    s_waitcnt lgkmcnt(6)
    v_pk_add_f32 v[224:225], v[224:225], v[64:65]
    v_pk_add_f32 v[226:227], v[226:227], v[66:67]
    v_pk_add_f32 v[228:229], v[228:229], v[68:69]
    v_pk_add_f32 v[230:231], v[230:231], v[70:71]
    v_pk_mul_f32 v[224:225], v[224:225], v[108:109]
    v_pk_mul_f32 v[226:227], v[226:227], v[108:109]
    v_pk_mul_f32 v[228:229], v[228:229], v[108:109]
    v_pk_mul_f32 v[230:231], v[230:231], v[108:109]
    v_cvt_pk_bf16_f32 v48, v224, v225
    v_cvt_pk_bf16_f32 v49, v226, v227
    v_cvt_pk_bf16_f32 v50, v228, v229
    v_cvt_pk_bf16_f32 v51, v230, v231
    buffer_store_dwordx4 v[48:51], v7, s[16:19], s38 offen offset:0 sc1
    s_waitcnt lgkmcnt(4)
    v_pk_add_f32 v[232:233], v[232:233], v[72:73]
    v_pk_add_f32 v[234:235], v[234:235], v[74:75]
    v_pk_add_f32 v[236:237], v[236:237], v[76:77]
    v_pk_add_f32 v[238:239], v[238:239], v[78:79]
    v_pk_mul_f32 v[232:233], v[232:233], v[108:109]
    v_pk_mul_f32 v[234:235], v[234:235], v[108:109]
    v_pk_mul_f32 v[236:237], v[236:237], v[108:109]
    v_pk_mul_f32 v[238:239], v[238:239], v[108:109]
    v_cvt_pk_bf16_f32 v52, v232, v233
    v_cvt_pk_bf16_f32 v53, v234, v235
    v_cvt_pk_bf16_f32 v54, v236, v237
    v_cvt_pk_bf16_f32 v55, v238, v239
    buffer_store_dwordx4 v[52:55], v7, s[16:19], s38 offen offset:1024 sc1
    s_waitcnt lgkmcnt(2)
    v_pk_add_f32 v[240:241], v[240:241], v[80:81]
    v_pk_add_f32 v[242:243], v[242:243], v[82:83]
    v_pk_add_f32 v[244:245], v[244:245], v[84:85]
    v_pk_add_f32 v[246:247], v[246:247], v[86:87]
    v_pk_mul_f32 v[240:241], v[240:241], v[108:109]
    v_pk_mul_f32 v[242:243], v[242:243], v[108:109]
    v_pk_mul_f32 v[244:245], v[244:245], v[108:109]
    v_pk_mul_f32 v[246:247], v[246:247], v[108:109]
    v_cvt_pk_bf16_f32 v56, v240, v241
    v_cvt_pk_bf16_f32 v57, v242, v243
    v_cvt_pk_bf16_f32 v58, v244, v245
    v_cvt_pk_bf16_f32 v59, v246, v247
    buffer_store_dwordx4 v[56:59], v7, s[16:19], s38 offen offset:2048 sc1
    s_waitcnt lgkmcnt(0)
    v_pk_add_f32 v[248:249], v[248:249], v[88:89]
    v_pk_add_f32 v[250:251], v[250:251], v[90:91]
    v_pk_add_f32 v[252:253], v[252:253], v[92:93]
    v_pk_add_f32 v[254:255], v[254:255], v[94:95]
    v_pk_mul_f32 v[248:249], v[248:249], v[108:109]
    v_pk_mul_f32 v[250:251], v[250:251], v[108:109]
    v_pk_mul_f32 v[252:253], v[252:253], v[108:109]
    v_pk_mul_f32 v[254:255], v[254:255], v[108:109]
    v_cvt_pk_bf16_f32 v60, v248, v249
    v_cvt_pk_bf16_f32 v61, v250, v251
    v_cvt_pk_bf16_f32 v62, v252, v253
    v_cvt_pk_bf16_f32 v63, v254, v255
    buffer_store_dwordx4 v[60:63], v7, s[16:19], s38 offen offset:3072 sc1
    s_cmp_eq_u64 s[52:53], 0
    s_cbranch_scc1 L_p3_done
    s_waitcnt vmcnt(0)
    v_mov_b32 v112, v96
    v_mov_b32 v113, v97
    v_mov_b32 v114, v98
    v_mov_b32 v115, v99
    v_mov_b32 v116, v100
    v_mov_b32 v117, v101
    v_mov_b32 v118, v102
    v_mov_b32 v119, v103
    v_swap_b32 v128, v160
    v_swap_b32 v129, v161
    v_swap_b32 v130, v162
    v_swap_b32 v131, v163
    v_swap_b32 v132, v164
    v_swap_b32 v133, v165
    v_swap_b32 v134, v166
    v_swap_b32 v135, v167
    v_swap_b32 v136, v168
    v_swap_b32 v137, v169
    v_swap_b32 v138, v170
    v_swap_b32 v139, v171
    v_swap_b32 v140, v172
    v_swap_b32 v141, v173
    v_swap_b32 v142, v174
    v_swap_b32 v143, v175
    v_swap_b32 v144, v176
    v_swap_b32 v145, v177
    v_swap_b32 v146, v178
    v_swap_b32 v147, v179
    v_swap_b32 v148, v180
    v_swap_b32 v149, v181
    v_swap_b32 v150, v182
    v_swap_b32 v151, v183
    v_swap_b32 v152, v184
    v_swap_b32 v153, v185
    v_swap_b32 v154, v186
    v_swap_b32 v155, v187
    v_swap_b32 v156, v188
    v_swap_b32 v157, v189
    v_swap_b32 v158, v190
    v_swap_b32 v159, v191
    v_mov_b32 v192, 0
    v_mov_b32 v193, 0
    v_mov_b32 v194, 0
    v_mov_b32 v195, 0
    v_mov_b32 v196, 0
    v_mov_b32 v197, 0
    v_mov_b32 v198, 0
    v_mov_b32 v199, 0
    v_mov_b32 v200, 0
    v_mov_b32 v201, 0
    v_mov_b32 v202, 0
    v_mov_b32 v203, 0
    v_mov_b32 v204, 0
    v_mov_b32 v205, 0
    v_mov_b32 v206, 0
    v_mov_b32 v207, 0
    v_mov_b32 v208, 0
    v_mov_b32 v209, 0
    v_mov_b32 v210, 0
    v_mov_b32 v211, 0
    v_mov_b32 v212, 0
    v_mov_b32 v213, 0
    v_mov_b32 v214, 0
    v_mov_b32 v215, 0
    v_mov_b32 v216, 0
    v_mov_b32 v217, 0
    v_mov_b32 v218, 0
    v_mov_b32 v219, 0
    v_mov_b32 v220, 0
    v_mov_b32 v221, 0
    v_mov_b32 v222, 0
    v_mov_b32 v223, 0
    v_mov_b32 v224, 0
    v_mov_b32 v225, 0
    v_mov_b32 v226, 0
    v_mov_b32 v227, 0
    v_mov_b32 v228, 0
    v_mov_b32 v229, 0
    v_mov_b32 v230, 0
    v_mov_b32 v231, 0
    v_mov_b32 v232, 0
    v_mov_b32 v233, 0
    v_mov_b32 v234, 0
    v_mov_b32 v235, 0
    v_mov_b32 v236, 0
    v_mov_b32 v237, 0
    v_mov_b32 v238, 0
    v_mov_b32 v239, 0
    v_mov_b32 v240, 0
    v_mov_b32 v241, 0
    v_mov_b32 v242, 0
    v_mov_b32 v243, 0
    v_mov_b32 v244, 0
    v_mov_b32 v245, 0
    v_mov_b32 v246, 0
    v_mov_b32 v247, 0
    v_mov_b32 v248, 0
    v_mov_b32 v249, 0
    v_mov_b32 v250, 0
    v_mov_b32 v251, 0
    v_mov_b32 v252, 0
    v_mov_b32 v253, 0
    v_mov_b32 v254, 0
    v_mov_b32 v255, 0
    v_mov_b32 v28, 0
    v_mov_b32 v40, 4048155338
    v_mov_b32 v32, 0
    v_mov_b32 v41, 4048155338
    s_lshl_b32 s43, s28, 12
    v_add_u32 v4, s43, v7
    s_mov_b32 s46, s45
    s_sub_u32 s40, 16, s30
    s_mov_b32 s39, s30
    s_lshl_b32 s37, s39, 7
    s_and_b32 s36, s28, 3
    s_lshl_b32 s36, s36, 5
    s_add_u32 s36, s36, s37
    s_sub_u32 s50, 0, s36
L_recurrent_scan__compressed_kv_cla__moe_arch_mod__prompt_kernel_stile_138:
    s_waitcnt vmcnt(0) lgkmcnt(0)
    s_barrier
    s_mov_b32 m0, s43
    s_add_u32 s47, s46, 32768
    buffer_load_dwordx4 v4, s[12:15], s46 offen offset:0 sc1 lds
    buffer_load_dwordx4 v4, s[12:15], s46 offen offset:1024 sc1 lds
    buffer_load_dwordx4 v4, s[12:15], s46 offen offset:2048 sc1 lds
    buffer_load_dwordx4 v4, s[12:15], s46 offen offset:3072 sc1 lds
    s_add_u32 m0, s43, 32768
    s_add_u32 s46, s46, 65536
    buffer_load_dwordx4 v4, s[12:15], s47 offen offset:0 sc1 lds
    buffer_load_dwordx4 v4, s[12:15], s47 offen offset:1024 sc1 lds
    buffer_load_dwordx4 v4, s[12:15], s47 offen offset:2048 sc1 lds
    buffer_load_dwordx4 v4, s[12:15], s47 offen offset:3072 sc1 lds
    v_mov_b32 v2, v7
    s_mov_b32 s41, 4
    s_waitcnt vmcnt(0)
    s_barrier
L_recurrent_scan__compressed_kv_cla__moe_arch_mod__prompt_kernel_sunit_139:
    s_cmp_gt_i32 s50, 0
    s_cbranch_scc1 L_recurrent_scan__compressed_kv_cla__moe_arch_mod__prompt_kernel_snext_140
    ds_read_b128 v[64:67], v2 offset:0
    ds_read_b128 v[68:71], v2 offset:1024
    ds_read_b128 v[72:75], v2 offset:2048
    ds_read_b128 v[76:79], v2 offset:3072
    ds_read_b128 v[80:83], v2 offset:4096
    ds_read_b128 v[84:87], v2 offset:5120
    ds_read_b128 v[88:91], v2 offset:6144
    ds_read_b128 v[92:95], v2 offset:7168
    s_waitcnt lgkmcnt(0)
    v_mfma_f32_16x16x32_bf16 v[96:99], v[64:67], v[128:131], 0
    v_mfma_f32_16x16x32_bf16 v[104:107], v[64:67], v[144:147], 0
    v_mfma_f32_16x16x32_bf16 v[96:99], v[68:71], v[132:135], v[96:99]
    v_mfma_f32_16x16x32_bf16 v[104:107], v[68:71], v[148:151], v[104:107]
    v_mfma_f32_16x16x32_bf16 v[96:99], v[72:75], v[136:139], v[96:99]
    v_mfma_f32_16x16x32_bf16 v[104:107], v[72:75], v[152:155], v[104:107]
    v_mfma_f32_16x16x32_bf16 v[96:99], v[76:79], v[140:143], v[96:99]
    v_mfma_f32_16x16x32_bf16 v[104:107], v[76:79], v[156:159], v[104:107]
    v_mfma_f32_16x16x32_bf16 v[100:103], v[80:83], v[128:131], 0
    v_mfma_f32_16x16x32_bf16 v[108:111], v[80:83], v[144:147], 0
    v_mfma_f32_16x16x32_bf16 v[100:103], v[84:87], v[132:135], v[100:103]
    v_mfma_f32_16x16x32_bf16 v[108:111], v[84:87], v[148:151], v[108:111]
    v_mfma_f32_16x16x32_bf16 v[100:103], v[88:91], v[136:139], v[100:103]
    v_mfma_f32_16x16x32_bf16 v[108:111], v[88:91], v[152:155], v[108:111]
    v_mfma_f32_16x16x32_bf16 v[100:103], v[92:95], v[140:143], v[100:103]
    v_mfma_f32_16x16x32_bf16 v[108:111], v[92:95], v[156:159], v[108:111]
    ds_read_b128 v[64:67], v2 offset:32768
    ds_read_b128 v[68:71], v2 offset:33792
    ds_read_b128 v[72:75], v2 offset:34816
    ds_read_b128 v[76:79], v2 offset:35840
    ds_read_b128 v[80:83], v2 offset:36864
    ds_read_b128 v[84:87], v2 offset:37888
    ds_read_b128 v[88:91], v2 offset:38912
    ds_read_b128 v[92:95], v2 offset:39936
    s_nop 1
    s_cmp_lt_i32 s50, 0
    s_cbranch_scc0 L_recurrent_scan__compressed_kv_cla__moe_arch_mod__prompt_kernel_rare_141
L_recurrent_scan__compressed_kv_cla__moe_arch_mod__prompt_kernel_back_142:
    v_max3_f32 v22, v96, v97, v98
    v_max3_f32 v22, v22, v99, v100
    v_max3_f32 v22, v22, v101, v102
    v_max3_f32 v22, v22, v103, v40
    v_mov_b32 v24, v22
    s_nop 1
    v_permlane16_swap_b32 v22, v24
    s_nop 1
    v_max_f32 v22, v22, v24
    v_mov_b32 v24, v22
    s_nop 1
    v_permlane32_swap_b32 v22, v24
    s_nop 1
    v_max_f32 v22, v22, v24
    v_sub_f32 v25, v40, v22
    v_exp_f32 v25, v25
    v_mov_b32 v40, v22
    v_mul_f32 v28, v28, v25
    v_mul_f32 v192, v192, v25
    v_mul_f32 v193, v193, v25
    v_mul_f32 v194, v194, v25
    v_mul_f32 v195, v195, v25
    v_mul_f32 v196, v196, v25
    v_mul_f32 v197, v197, v25
    v_mul_f32 v198, v198, v25
    v_mul_f32 v199, v199, v25
    v_mul_f32 v200, v200, v25
    v_mul_f32 v201, v201, v25
    v_mul_f32 v202, v202, v25
    v_mul_f32 v203, v203, v25
    v_mul_f32 v204, v204, v25
    v_mul_f32 v205, v205, v25
    v_mul_f32 v206, v206, v25
    v_mul_f32 v207, v207, v25
    v_mul_f32 v208, v208, v25
    v_mul_f32 v209, v209, v25
    v_mul_f32 v210, v210, v25
    v_mul_f32 v211, v211, v25
    v_mul_f32 v212, v212, v25
    v_mul_f32 v213, v213, v25
    v_mul_f32 v214, v214, v25
    v_mul_f32 v215, v215, v25
    v_mul_f32 v216, v216, v25
    v_mul_f32 v217, v217, v25
    v_mul_f32 v218, v218, v25
    v_mul_f32 v219, v219, v25
    v_mul_f32 v220, v220, v25
    v_mul_f32 v221, v221, v25
    v_mul_f32 v222, v222, v25
    v_mul_f32 v223, v223, v25
    v_sub_f32 v96, v96, v22
    v_sub_f32 v97, v97, v22
    v_sub_f32 v98, v98, v22
    v_sub_f32 v99, v99, v22
    v_sub_f32 v100, v100, v22
    v_sub_f32 v101, v101, v22
    v_sub_f32 v102, v102, v22
    v_sub_f32 v103, v103, v22
    v_max3_f32 v23, v104, v105, v106
    v_max3_f32 v23, v23, v107, v108
    v_max3_f32 v23, v23, v109, v110
    v_max3_f32 v23, v23, v111, v41
    v_mov_b32 v24, v23
    s_nop 1
    v_permlane16_swap_b32 v23, v24
    s_nop 1
    v_max_f32 v23, v23, v24
    v_mov_b32 v24, v23
    s_nop 1
    v_permlane32_swap_b32 v23, v24
    s_nop 1
    v_max_f32 v23, v23, v24
    v_sub_f32 v25, v41, v23
    v_exp_f32 v25, v25
    v_mov_b32 v41, v23
    v_mul_f32 v32, v32, v25
    v_mul_f32 v224, v224, v25
    v_mul_f32 v225, v225, v25
    v_mul_f32 v226, v226, v25
    v_mul_f32 v227, v227, v25
    v_mul_f32 v228, v228, v25
    v_mul_f32 v229, v229, v25
    v_mul_f32 v230, v230, v25
    v_mul_f32 v231, v231, v25
    v_mul_f32 v232, v232, v25
    v_mul_f32 v233, v233, v25
    v_mul_f32 v234, v234, v25
    v_mul_f32 v235, v235, v25
    v_mul_f32 v236, v236, v25
    v_mul_f32 v237, v237, v25
    v_mul_f32 v238, v238, v25
    v_mul_f32 v239, v239, v25
    v_mul_f32 v240, v240, v25
    v_mul_f32 v241, v241, v25
    v_mul_f32 v242, v242, v25
    v_mul_f32 v243, v243, v25
    v_mul_f32 v244, v244, v25
    v_mul_f32 v245, v245, v25
    v_mul_f32 v246, v246, v25
    v_mul_f32 v247, v247, v25
    v_mul_f32 v248, v248, v25
    v_mul_f32 v249, v249, v25
    v_mul_f32 v250, v250, v25
    v_mul_f32 v251, v251, v25
    v_mul_f32 v252, v252, v25
    v_mul_f32 v253, v253, v25
    v_mul_f32 v254, v254, v25
    v_mul_f32 v255, v255, v25
    v_sub_f32 v104, v104, v23
    v_sub_f32 v105, v105, v23
    v_sub_f32 v106, v106, v23
    v_sub_f32 v107, v107, v23
    v_sub_f32 v108, v108, v23
    v_sub_f32 v109, v109, v23
    v_sub_f32 v110, v110, v23
    v_sub_f32 v111, v111, v23
    v_exp_f32 v96, v96
    v_exp_f32 v97, v97
    v_exp_f32 v98, v98
    v_exp_f32 v99, v99
    v_exp_f32 v104, v104
    v_exp_f32 v105, v105
    v_exp_f32 v106, v106
    v_exp_f32 v107, v107
    v_exp_f32 v100, v100
    v_exp_f32 v101, v101
    v_exp_f32 v102, v102
    v_exp_f32 v103, v103
    v_exp_f32 v108, v108
    v_exp_f32 v109, v109
    v_exp_f32 v110, v110
    v_exp_f32 v111, v111
    v_add_f32 v28, v28, v96
    v_add_f32 v28, v28, v97
    v_cvt_pk_bf16_f32 v48, v96, v97
    v_add_f32 v28, v28, v98
    v_add_f32 v28, v28, v99
    v_cvt_pk_bf16_f32 v49, v98, v99
    v_add_f32 v32, v32, v104
    v_add_f32 v32, v32, v105
    v_cvt_pk_bf16_f32 v52, v104, v105
    v_add_f32 v32, v32, v106
    v_add_f32 v32, v32, v107
    v_cvt_pk_bf16_f32 v53, v106, v107
    v_add_f32 v28, v28, v100
    v_add_f32 v28, v28, v101
    v_cvt_pk_bf16_f32 v50, v100, v101
    v_add_f32 v28, v28, v102
    v_add_f32 v28, v28, v103
    v_cvt_pk_bf16_f32 v51, v102, v103
    v_add_f32 v32, v32, v108
    v_add_f32 v32, v32, v109
    v_cvt_pk_bf16_f32 v54, v108, v109
    v_add_f32 v32, v32, v110
    v_add_f32 v32, v32, v111
    v_cvt_pk_bf16_f32 v55, v110, v111
    s_waitcnt lgkmcnt(0)
    s_nop 0
    v_mfma_f32_16x16x32_bf16 v[192:195], v[64:67], v[48:51], v[192:195]
    v_mfma_f32_16x16x32_bf16 v[224:227], v[64:67], v[52:55], v[224:227]
    v_mfma_f32_16x16x32_bf16 v[196:199], v[68:71], v[48:51], v[196:199]
    v_mfma_f32_16x16x32_bf16 v[228:231], v[68:71], v[52:55], v[228:231]
    v_mfma_f32_16x16x32_bf16 v[200:203], v[72:75], v[48:51], v[200:203]
    v_mfma_f32_16x16x32_bf16 v[232:235], v[72:75], v[52:55], v[232:235]
    v_mfma_f32_16x16x32_bf16 v[204:207], v[76:79], v[48:51], v[204:207]
    v_mfma_f32_16x16x32_bf16 v[236:239], v[76:79], v[52:55], v[236:239]
    v_mfma_f32_16x16x32_bf16 v[208:211], v[80:83], v[48:51], v[208:211]
    v_mfma_f32_16x16x32_bf16 v[240:243], v[80:83], v[52:55], v[240:243]
    v_mfma_f32_16x16x32_bf16 v[212:215], v[84:87], v[48:51], v[212:215]
    v_mfma_f32_16x16x32_bf16 v[244:247], v[84:87], v[52:55], v[244:247]
    v_mfma_f32_16x16x32_bf16 v[216:219], v[88:91], v[48:51], v[216:219]
    v_mfma_f32_16x16x32_bf16 v[248:251], v[88:91], v[52:55], v[248:251]
    v_mfma_f32_16x16x32_bf16 v[220:223], v[92:95], v[48:51], v[220:223]
    v_mfma_f32_16x16x32_bf16 v[252:255], v[92:95], v[52:55], v[252:255]
L_recurrent_scan__compressed_kv_cla__moe_arch_mod__prompt_kernel_snext_140:
    v_add_u32 v2, 8192, v2
    s_add_u32 s50, s50, 32
    s_sub_u32 s41, s41, 1
    s_cmp_lg_u32 s41, 0
    s_cbranch_scc1 L_recurrent_scan__compressed_kv_cla__moe_arch_mod__prompt_kernel_sunit_139
    s_sub_u32 s40, s40, 1
    s_cmp_lg_u32 s40, 0
    s_cbranch_scc1 L_recurrent_scan__compressed_kv_cla__moe_arch_mod__prompt_kernel_stile_138
    v_mov_b32 v20, v28
    s_nop 1
    v_permlane16_swap_b32 v28, v20
    s_nop 1
    v_add_f32 v28, v28, v20
    v_mov_b32 v20, v28
    s_nop 1
    v_permlane32_swap_b32 v28, v20
    s_nop 1
    v_add_f32 v28, v28, v20
    v_mov_b32 v20, v32
    s_nop 1
    v_permlane16_swap_b32 v32, v20
    s_nop 1
    v_add_f32 v32, v32, v20
    v_mov_b32 v20, v32
    s_nop 1
    v_permlane32_swap_b32 v32, v20
    s_nop 1
    v_add_f32 v32, v32, v20
    s_mov_b32 s36, 0x5d800000
    v_cmp_nge_f32 vcc, s36, v28
    s_nop 0
    s_or_b64 s[52:53], s[52:53], vcc
    v_cmp_nge_f32 vcc, s36, v32
    s_nop 0
    s_or_b64 s[52:53], s[52:53], vcc
    v_rcp_f32 v20, v28
    v_rcp_f32 v22, v32
    s_lshl_b32 s38, s39, 3
    s_and_b32 s37, s28, 3
    s_lshl_b32 s37, s37, 1
    s_add_u32 s38, s38, s37
    s_lshl_b32 s38, s38, 17
    s_lshl_b32 s37, s29, 12
    s_add_u32 s38, s38, s37
    v_mov_b32 v21, v20
    v_mov_b32 v23, v22
    v_pk_mul_f32 v[192:193], v[192:193], v[20:21]
    v_pk_mul_f32 v[194:195], v[194:195], v[20:21]
    v_pk_mul_f32 v[196:197], v[196:197], v[20:21]
    v_pk_mul_f32 v[198:199], v[198:199], v[20:21]
    v_cvt_pk_bf16_f32 v192, v192, v193
    v_cvt_pk_bf16_f32 v193, v194, v195
    v_cvt_pk_bf16_f32 v194, v196, v197
    v_cvt_pk_bf16_f32 v195, v198, v199
    buffer_store_dwordx4 v[192:195], v7, s[16:19], s38 offen offset:0 sc1
    v_pk_mul_f32 v[200:201], v[200:201], v[20:21]
    v_pk_mul_f32 v[202:203], v[202:203], v[20:21]
    v_pk_mul_f32 v[204:205], v[204:205], v[20:21]
    v_pk_mul_f32 v[206:207], v[206:207], v[20:21]
    v_cvt_pk_bf16_f32 v200, v200, v201
    v_cvt_pk_bf16_f32 v201, v202, v203
    v_cvt_pk_bf16_f32 v202, v204, v205
    v_cvt_pk_bf16_f32 v203, v206, v207
    buffer_store_dwordx4 v[200:203], v7, s[16:19], s38 offen offset:1024 sc1
    v_pk_mul_f32 v[208:209], v[208:209], v[20:21]
    v_pk_mul_f32 v[210:211], v[210:211], v[20:21]
    v_pk_mul_f32 v[212:213], v[212:213], v[20:21]
    v_pk_mul_f32 v[214:215], v[214:215], v[20:21]
    v_cvt_pk_bf16_f32 v208, v208, v209
    v_cvt_pk_bf16_f32 v209, v210, v211
    v_cvt_pk_bf16_f32 v210, v212, v213
    v_cvt_pk_bf16_f32 v211, v214, v215
    buffer_store_dwordx4 v[208:211], v7, s[16:19], s38 offen offset:2048 sc1
    v_pk_mul_f32 v[216:217], v[216:217], v[20:21]
    v_pk_mul_f32 v[218:219], v[218:219], v[20:21]
    v_pk_mul_f32 v[220:221], v[220:221], v[20:21]
    v_pk_mul_f32 v[222:223], v[222:223], v[20:21]
    v_cvt_pk_bf16_f32 v216, v216, v217
    v_cvt_pk_bf16_f32 v217, v218, v219
    v_cvt_pk_bf16_f32 v218, v220, v221
    v_cvt_pk_bf16_f32 v219, v222, v223
    buffer_store_dwordx4 v[216:219], v7, s[16:19], s38 offen offset:3072 sc1
    s_add_u32 s38, s38, 131072
    v_pk_mul_f32 v[224:225], v[224:225], v[22:23]
    v_pk_mul_f32 v[226:227], v[226:227], v[22:23]
    v_pk_mul_f32 v[228:229], v[228:229], v[22:23]
    v_pk_mul_f32 v[230:231], v[230:231], v[22:23]
    v_cvt_pk_bf16_f32 v224, v224, v225
    v_cvt_pk_bf16_f32 v225, v226, v227
    v_cvt_pk_bf16_f32 v226, v228, v229
    v_cvt_pk_bf16_f32 v227, v230, v231
    buffer_store_dwordx4 v[224:227], v7, s[16:19], s38 offen offset:0 sc1
    v_pk_mul_f32 v[232:233], v[232:233], v[22:23]
    v_pk_mul_f32 v[234:235], v[234:235], v[22:23]
    v_pk_mul_f32 v[236:237], v[236:237], v[22:23]
    v_pk_mul_f32 v[238:239], v[238:239], v[22:23]
    v_cvt_pk_bf16_f32 v232, v232, v233
    v_cvt_pk_bf16_f32 v233, v234, v235
    v_cvt_pk_bf16_f32 v234, v236, v237
    v_cvt_pk_bf16_f32 v235, v238, v239
    buffer_store_dwordx4 v[232:235], v7, s[16:19], s38 offen offset:1024 sc1
    v_pk_mul_f32 v[240:241], v[240:241], v[22:23]
    v_pk_mul_f32 v[242:243], v[242:243], v[22:23]
    v_pk_mul_f32 v[244:245], v[244:245], v[22:23]
    v_pk_mul_f32 v[246:247], v[246:247], v[22:23]
    v_cvt_pk_bf16_f32 v240, v240, v241
    v_cvt_pk_bf16_f32 v241, v242, v243
    v_cvt_pk_bf16_f32 v242, v244, v245
    v_cvt_pk_bf16_f32 v243, v246, v247
    buffer_store_dwordx4 v[240:243], v7, s[16:19], s38 offen offset:2048 sc1
    v_pk_mul_f32 v[248:249], v[248:249], v[22:23]
    v_pk_mul_f32 v[250:251], v[250:251], v[22:23]
    v_pk_mul_f32 v[252:253], v[252:253], v[22:23]
    v_pk_mul_f32 v[254:255], v[254:255], v[22:23]
    v_cvt_pk_bf16_f32 v248, v248, v249
    v_cvt_pk_bf16_f32 v249, v250, v251
    v_cvt_pk_bf16_f32 v250, v252, v253
    v_cvt_pk_bf16_f32 v251, v254, v255
    buffer_store_dwordx4 v[248:251], v7, s[16:19], s38 offen offset:3072 sc1
    v_mov_b32 v96, v112
    v_mov_b32 v97, v113
    v_mov_b32 v98, v114
    v_mov_b32 v99, v115
    v_mov_b32 v100, v116
    v_mov_b32 v101, v117
    v_mov_b32 v102, v118
    v_mov_b32 v103, v119
    s_branch L_p3_done
L_recurrent_scan__compressed_kv_cla__moe_arch_mod__prompt_kernel_rare_109:
    s_lshl_b32 s36, s29, 7
    s_cmp_eq_u32 s30, 0
    s_cselect_b32 s37, 4, 0
    s_add_u32 s36, s36, s37
    v_mov_b32 v20, s36
    v_mov_b32 v21, 1
    s_mov_b64 exec, 1
    global_atomic_add v20, v21, s[90:91]
    s_mov_b64 exec, -1
    s_nop 3
    s_branch L_recurrent_scan__compressed_kv_cla__moe_arch_mod__prompt_kernel_back_110
L_recurrent_scan__compressed_kv_cla__moe_arch_mod__prompt_kernel_rare_112:
    s_cmp_lt_i32 s36, 0
    s_cbranch_scc1 L_recurrent_scan__compressed_kv_cla__moe_arch_mod__prompt_kernel_nm_111
    v_mov_b32 v20, 4048155338
    v_subrev_u32 v21, s36, v18
    v_cmp_gt_i32 s[20:21], 0, v21
    v_cmp_gt_i32 s[22:23], 1, v21
    v_cmp_gt_i32 s[62:63], 2, v21
    v_cmp_gt_i32 vcc, 3, v21
    v_cndmask_b32 v96, v96, v20, s[20:21]
    v_cndmask_b32 v97, v97, v20, s[22:23]
    v_cndmask_b32 v98, v98, v20, s[62:63]
    v_cndmask_b32 v99, v99, v20, vcc
    v_cmp_gt_i32 s[20:21], 16, v21
    v_cmp_gt_i32 s[22:23], 17, v21
    v_cmp_gt_i32 s[62:63], 18, v21
    v_cmp_gt_i32 vcc, 19, v21
    v_cndmask_b32 v100, v100, v20, s[20:21]
    v_cndmask_b32 v101, v101, v20, s[22:23]
    v_cndmask_b32 v102, v102, v20, s[62:63]
    v_cndmask_b32 v103, v103, v20, vcc
    v_cmp_gt_i32 s[20:21], -16, v21
    v_cmp_gt_i32 s[22:23], -15, v21
    v_cmp_gt_i32 s[62:63], -14, v21
    v_cmp_gt_i32 vcc, -13, v21
    v_cndmask_b32 v104, v104, v20, s[20:21]
    v_cndmask_b32 v105, v105, v20, s[22:23]
    v_cndmask_b32 v106, v106, v20, s[62:63]
    v_cndmask_b32 v107, v107, v20, vcc
    v_cmp_gt_i32 s[20:21], 0, v21
    v_cmp_gt_i32 s[22:23], 1, v21
    v_cmp_gt_i32 s[62:63], 2, v21
    v_cmp_gt_i32 vcc, 3, v21
    v_cndmask_b32 v108, v108, v20, s[20:21]
    v_cndmask_b32 v109, v109, v20, s[22:23]
    v_cndmask_b32 v110, v110, v20, s[62:63]
    v_cndmask_b32 v111, v111, v20, vcc
L_recurrent_scan__compressed_kv_cla__moe_arch_mod__prompt_kernel_nm_111:
    s_branch L_recurrent_scan__compressed_kv_cla__moe_arch_mod__prompt_kernel_back_113
L_recurrent_scan__compressed_kv_cla__moe_arch_mod__prompt_kernel_rare_119:
    s_add_u32 s36, s40, 1
    s_sub_u32 s36, s36, s51
    s_cmp_lt_u32 s36, 2
    s_cbranch_scc0 L_recurrent_scan__compressed_kv_cla__moe_arch_mod__prompt_kernel_r_115
    s_lshl_b32 s36, s36, 6
    s_add_u32 s36, s36, 32
    s_sub_u32 s36, s36, s50
    s_cmp_lt_i32 s36, 0
    s_cbranch_scc1 L_recurrent_scan__compressed_kv_cla__moe_arch_mod__prompt_kernel_nm_118
    v_mov_b32 v20, 4048155338
    v_subrev_u32 v21, s36, v18
    v_cmp_gt_i32 s[20:21], 0, v21
    v_cmp_gt_i32 s[22:23], 1, v21
    v_cmp_gt_i32 s[62:63], 2, v21
    v_cmp_gt_i32 vcc, 3, v21
    v_cndmask_b32 v112, v112, v20, s[20:21]
    v_cndmask_b32 v113, v113, v20, s[22:23]
    v_cndmask_b32 v114, v114, v20, s[62:63]
    v_cndmask_b32 v115, v115, v20, vcc
    v_cmp_gt_i32 s[20:21], 16, v21
    v_cmp_gt_i32 s[22:23], 17, v21
    v_cmp_gt_i32 s[62:63], 18, v21
    v_cmp_gt_i32 vcc, 19, v21
    v_cndmask_b32 v116, v116, v20, s[20:21]
    v_cndmask_b32 v117, v117, v20, s[22:23]
    v_cndmask_b32 v118, v118, v20, s[62:63]
    v_cndmask_b32 v119, v119, v20, vcc
    v_cmp_gt_i32 s[20:21], -16, v21
    v_cmp_gt_i32 s[22:23], -15, v21
    v_cmp_gt_i32 s[62:63], -14, v21
    v_cmp_gt_i32 vcc, -13, v21
    v_cndmask_b32 v120, v120, v20, s[20:21]
    v_cndmask_b32 v121, v121, v20, s[22:23]
    v_cndmask_b32 v122, v122, v20, s[62:63]
    v_cndmask_b32 v123, v123, v20, vcc
    v_cmp_gt_i32 s[20:21], 0, v21
    v_cmp_gt_i32 s[22:23], 1, v21
    v_cmp_gt_i32 s[62:63], 2, v21
    v_cmp_gt_i32 vcc, 3, v21
    v_cndmask_b32 v124, v124, v20, s[20:21]
    v_cndmask_b32 v125, v125, v20, s[22:23]
    v_cndmask_b32 v126, v126, v20, s[62:63]
    v_cndmask_b32 v127, v127, v20, vcc
L_recurrent_scan__compressed_kv_cla__moe_arch_mod__prompt_kernel_nm_118:
L_recurrent_scan__compressed_kv_cla__moe_arch_mod__prompt_kernel_r_115:
    s_branch L_recurrent_scan__compressed_kv_cla__moe_arch_mod__prompt_kernel_back_120
L_recurrent_scan__compressed_kv_cla__moe_arch_mod__prompt_kernel_rare_122:
    s_add_u32 s36, s40, 2
    s_sub_u32 s36, s36, s51
    s_cmp_eq_u32 s36, 1
    s_cselect_b32 s41, 0x8000, s41
    s_cmp_eq_u32 s40, 15
    s_cbranch_scc0 L_recurrent_scan__compressed_kv_cla__moe_arch_mod__prompt_kernel_r_116
    s_mov_b32 s41, 65536
    s_mov_b32 s49, 0x1ffff
    s_mov_b32 s36, 1
L_recurrent_scan__compressed_kv_cla__moe_arch_mod__prompt_kernel_r_116:
    s_cmp_lt_u32 s36, 2
    s_cbranch_scc0 L_recurrent_scan__compressed_kv_cla__moe_arch_mod__prompt_kernel_r_117
    s_lshl_b32 s36, s36, 6
    s_sub_u32 s36, s36, s50
    s_cmp_lt_i32 s36, 0
    s_cbranch_scc1 L_recurrent_scan__compressed_kv_cla__moe_arch_mod__prompt_kernel_nm_121
    v_mov_b32 v20, 4048155338
    v_subrev_u32 v21, s36, v18
    v_cmp_gt_i32 s[20:21], 0, v21
    v_cmp_gt_i32 s[22:23], 1, v21
    v_cmp_gt_i32 s[62:63], 2, v21
    v_cmp_gt_i32 vcc, 3, v21
    v_cndmask_b32 v96, v96, v20, s[20:21]
    v_cndmask_b32 v97, v97, v20, s[22:23]
    v_cndmask_b32 v98, v98, v20, s[62:63]
    v_cndmask_b32 v99, v99, v20, vcc
    v_cmp_gt_i32 s[20:21], 16, v21
    v_cmp_gt_i32 s[22:23], 17, v21
    v_cmp_gt_i32 s[62:63], 18, v21
    v_cmp_gt_i32 vcc, 19, v21
    v_cndmask_b32 v100, v100, v20, s[20:21]
    v_cndmask_b32 v101, v101, v20, s[22:23]
    v_cndmask_b32 v102, v102, v20, s[62:63]
    v_cndmask_b32 v103, v103, v20, vcc
    v_cmp_gt_i32 s[20:21], -16, v21
    v_cmp_gt_i32 s[22:23], -15, v21
    v_cmp_gt_i32 s[62:63], -14, v21
    v_cmp_gt_i32 vcc, -13, v21
    v_cndmask_b32 v104, v104, v20, s[20:21]
    v_cndmask_b32 v105, v105, v20, s[22:23]
    v_cndmask_b32 v106, v106, v20, s[62:63]
    v_cndmask_b32 v107, v107, v20, vcc
    v_cmp_gt_i32 s[20:21], 0, v21
    v_cmp_gt_i32 s[22:23], 1, v21
    v_cmp_gt_i32 s[62:63], 2, v21
    v_cmp_gt_i32 vcc, 3, v21
    v_cndmask_b32 v108, v108, v20, s[20:21]
    v_cndmask_b32 v109, v109, v20, s[22:23]
    v_cndmask_b32 v110, v110, v20, s[62:63]
    v_cndmask_b32 v111, v111, v20, vcc
L_recurrent_scan__compressed_kv_cla__moe_arch_mod__prompt_kernel_nm_121:
L_recurrent_scan__compressed_kv_cla__moe_arch_mod__prompt_kernel_r_117:
    s_branch L_recurrent_scan__compressed_kv_cla__moe_arch_mod__prompt_kernel_back_123
L_recurrent_scan__compressed_kv_cla__moe_arch_mod__prompt_kernel_rare_125:
    v_mov_b32 v20, 4048155338
    v_subrev_u32 v21, s36, v18
    v_cmp_gt_i32 s[20:21], 0, v21
    v_cmp_gt_i32 s[22:23], 1, v21
    v_cmp_gt_i32 s[62:63], 2, v21
    v_cmp_gt_i32 vcc, 3, v21
    v_cndmask_b32 v112, v112, v20, s[20:21]
    v_cndmask_b32 v113, v113, v20, s[22:23]
    v_cndmask_b32 v114, v114, v20, s[62:63]
    v_cndmask_b32 v115, v115, v20, vcc
    v_cmp_gt_i32 s[20:21], 16, v21
    v_cmp_gt_i32 s[22:23], 17, v21
    v_cmp_gt_i32 s[62:63], 18, v21
    v_cmp_gt_i32 vcc, 19, v21
    v_cndmask_b32 v116, v116, v20, s[20:21]
    v_cndmask_b32 v117, v117, v20, s[22:23]
    v_cndmask_b32 v118, v118, v20, s[62:63]
    v_cndmask_b32 v119, v119, v20, vcc
    v_cmp_gt_i32 s[20:21], -16, v21
    v_cmp_gt_i32 s[22:23], -15, v21
    v_cmp_gt_i32 s[62:63], -14, v21
    v_cmp_gt_i32 vcc, -13, v21
    v_cndmask_b32 v120, v120, v20, s[20:21]
    v_cndmask_b32 v121, v121, v20, s[22:23]
    v_cndmask_b32 v122, v122, v20, s[62:63]
    v_cndmask_b32 v123, v123, v20, vcc
    v_cmp_gt_i32 s[20:21], 0, v21
    v_cmp_gt_i32 s[22:23], 1, v21
    v_cmp_gt_i32 s[62:63], 2, v21
    v_cmp_gt_i32 vcc, 3, v21
    v_cndmask_b32 v124, v124, v20, s[20:21]
    v_cndmask_b32 v125, v125, v20, s[22:23]
    v_cndmask_b32 v126, v126, v20, s[62:63]
    v_cndmask_b32 v127, v127, v20, vcc
    s_branch L_recurrent_scan__compressed_kv_cla__moe_arch_mod__prompt_kernel_back_126
L_recurrent_scan__compressed_kv_cla__moe_arch_mod__prompt_kernel_rare_132:
    s_cmp_eq_u32 s40, 0
    s_cbranch_scc0 L_recurrent_scan__compressed_kv_cla__moe_arch_mod__prompt_kernel_nm_127
    ds_read_b64 v[14:15], v19
    s_waitcnt lgkmcnt(0)
L_recurrent_scan__compressed_kv_cla__moe_arch_mod__prompt_kernel_nm_127:
    s_cmp_eq_u32 s40, 12
    s_cbranch_scc0 L_recurrent_scan__compressed_kv_cla__moe_arch_mod__prompt_kernel_bh_130
    s_getpc_b64 s[36:37]
L_recurrent_scan__compressed_kv_cla__moe_arch_mod__prompt_kernel_pc_131:
    s_sub_u32 s36, s36, L_recurrent_scan__compressed_kv_cla__moe_arch_mod__prompt_kernel_pc_131-L_pc
    s_subb_u32 s37, s37, 0
    s_lshr_b32 s38, s2, 3
    s_lshl_b32 s38, s38, 7
    v_lshl_add_u32 v26, v1, 12, s38
    v_min_u32 v26, L_end-L_pc-4, v26
    v_mov_b32 v27, s37
    v_add_co_u32 v26, vcc, s36, v26
    s_mov_b64 exec, 0xffff
    s_nop 0
    v_addc_co_u32 v27, vcc, 0, v27, vcc
    global_load_dword v0, v[26:27], off
    s_mov_b64 exec, -1
    s_nop 1
L_recurrent_scan__compressed_kv_cla__moe_arch_mod__prompt_kernel_bh_130:
    s_add_u32 s36, s40, 1
    s_cmp_eq_u32 s36, s51
    s_cbranch_scc0 L_recurrent_scan__compressed_kv_cla__moe_arch_mod__prompt_kernel_ns_128
    v_swap_b32 v128, v160
    v_swap_b32 v129, v161
    v_swap_b32 v130, v162
    v_swap_b32 v131, v163
    v_swap_b32 v132, v164
    v_swap_b32 v133, v165
    v_swap_b32 v134, v166
    v_swap_b32 v135, v167
    v_swap_b32 v136, v168
    v_swap_b32 v137, v169
    v_swap_b32 v138, v170
    v_swap_b32 v139, v171
    v_swap_b32 v140, v172
    v_swap_b32 v141, v173
    v_swap_b32 v142, v174
    v_swap_b32 v143, v175
    v_swap_b32 v144, v176
    v_swap_b32 v145, v177
    v_swap_b32 v146, v178
    v_swap_b32 v147, v179
    v_swap_b32 v148, v180
    v_swap_b32 v149, v181
    v_swap_b32 v150, v182
    v_swap_b32 v151, v183
    v_swap_b32 v152, v184
    v_swap_b32 v153, v185
    v_swap_b32 v154, v186
    v_swap_b32 v155, v187
    v_swap_b32 v156, v188
    v_swap_b32 v157, v189
    v_swap_b32 v158, v190
    v_swap_b32 v159, v191
    v_mov_b32 v40, v14
    v_mov_b32 v41, v14
    v_mov_b32 v42, v14
    v_mov_b32 v43, v14
    v_mov_b32 v44, v15
    v_mov_b32 v45, v15
    v_mov_b32 v46, v15
    v_mov_b32 v47, v15
    s_nop 1
L_recurrent_scan__compressed_kv_cla__moe_arch_mod__prompt_kernel_ns_128:
    s_cmp_eq_u32 s40, s51
    s_cbranch_scc0 L_recurrent_scan__compressed_kv_cla__moe_arch_mod__prompt_kernel_ne_129
    s_nop 4
    s_mov_b32 s36, 0x5d800000
    v_cmp_nge_f32 vcc, s36, v28
    s_nop 0
    s_or_b64 s[52:53], s[52:53], vcc
    v_cmp_nge_f32 vcc, s36, v32
    s_nop 0
    s_or_b64 s[52:53], s[52:53], vcc
    v_rcp_f32 v20, v28
    v_rcp_f32 v22, v32
    s_lshl_b32 s38, s30, 3
    s_and_b32 s37, s28, 3
    s_lshl_b32 s37, s37, 1
    s_add_u32 s38, s38, s37
    s_lshl_b32 s38, s38, 17
    s_lshl_b32 s37, s29, 12
    s_add_u32 s38, s38, s37
    v_mov_b32 v21, v20
    v_mov_b32 v23, v22
    v_pk_mul_f32 v[192:193], v[192:193], v[20:21]
    v_pk_mul_f32 v[194:195], v[194:195], v[20:21]
    v_pk_mul_f32 v[196:197], v[196:197], v[20:21]
    v_pk_mul_f32 v[198:199], v[198:199], v[20:21]
    v_cvt_pk_bf16_f32 v192, v192, v193
    v_cvt_pk_bf16_f32 v193, v194, v195
    v_cvt_pk_bf16_f32 v194, v196, v197
    v_cvt_pk_bf16_f32 v195, v198, v199
    buffer_store_dwordx4 v[192:195], v7, s[16:19], s38 offen offset:0 sc1
    v_pk_mul_f32 v[200:201], v[200:201], v[20:21]
    v_pk_mul_f32 v[202:203], v[202:203], v[20:21]
    v_pk_mul_f32 v[204:205], v[204:205], v[20:21]
    v_pk_mul_f32 v[206:207], v[206:207], v[20:21]
    v_cvt_pk_bf16_f32 v200, v200, v201
    v_cvt_pk_bf16_f32 v201, v202, v203
    v_cvt_pk_bf16_f32 v202, v204, v205
    v_cvt_pk_bf16_f32 v203, v206, v207
    buffer_store_dwordx4 v[200:203], v7, s[16:19], s38 offen offset:1024 sc1
    v_pk_mul_f32 v[208:209], v[208:209], v[20:21]
    v_pk_mul_f32 v[210:211], v[210:211], v[20:21]
    v_pk_mul_f32 v[212:213], v[212:213], v[20:21]
    v_pk_mul_f32 v[214:215], v[214:215], v[20:21]
    v_cvt_pk_bf16_f32 v208, v208, v209
    v_cvt_pk_bf16_f32 v209, v210, v211
    v_cvt_pk_bf16_f32 v210, v212, v213
    v_cvt_pk_bf16_f32 v211, v214, v215
    buffer_store_dwordx4 v[208:211], v7, s[16:19], s38 offen offset:2048 sc1
    v_pk_mul_f32 v[216:217], v[216:217], v[20:21]
    v_pk_mul_f32 v[218:219], v[218:219], v[20:21]
    v_pk_mul_f32 v[220:221], v[220:221], v[20:21]
    v_pk_mul_f32 v[222:223], v[222:223], v[20:21]
    v_cvt_pk_bf16_f32 v216, v216, v217
    v_cvt_pk_bf16_f32 v217, v218, v219
    v_cvt_pk_bf16_f32 v218, v220, v221
    v_cvt_pk_bf16_f32 v219, v222, v223
    buffer_store_dwordx4 v[216:219], v7, s[16:19], s38 offen offset:3072 sc1
    s_add_u32 s38, s38, 131072
    v_pk_mul_f32 v[224:225], v[224:225], v[22:23]
    v_pk_mul_f32 v[226:227], v[226:227], v[22:23]
    v_pk_mul_f32 v[228:229], v[228:229], v[22:23]
    v_pk_mul_f32 v[230:231], v[230:231], v[22:23]
    v_cvt_pk_bf16_f32 v224, v224, v225
    v_cvt_pk_bf16_f32 v225, v226, v227
    v_cvt_pk_bf16_f32 v226, v228, v229
    v_cvt_pk_bf16_f32 v227, v230, v231
    buffer_store_dwordx4 v[224:227], v7, s[16:19], s38 offen offset:0 sc1
    v_pk_mul_f32 v[232:233], v[232:233], v[22:23]
    v_pk_mul_f32 v[234:235], v[234:235], v[22:23]
    v_pk_mul_f32 v[236:237], v[236:237], v[22:23]
    v_pk_mul_f32 v[238:239], v[238:239], v[22:23]
    v_cvt_pk_bf16_f32 v232, v232, v233
    v_cvt_pk_bf16_f32 v233, v234, v235
    v_cvt_pk_bf16_f32 v234, v236, v237
    v_cvt_pk_bf16_f32 v235, v238, v239
    buffer_store_dwordx4 v[232:235], v7, s[16:19], s38 offen offset:1024 sc1
    v_pk_mul_f32 v[240:241], v[240:241], v[22:23]
    v_pk_mul_f32 v[242:243], v[242:243], v[22:23]
    v_pk_mul_f32 v[244:245], v[244:245], v[22:23]
    v_pk_mul_f32 v[246:247], v[246:247], v[22:23]
    v_cvt_pk_bf16_f32 v240, v240, v241
    v_cvt_pk_bf16_f32 v241, v242, v243
    v_cvt_pk_bf16_f32 v242, v244, v245
    v_cvt_pk_bf16_f32 v243, v246, v247
    buffer_store_dwordx4 v[240:243], v7, s[16:19], s38 offen offset:2048 sc1
    v_pk_mul_f32 v[248:249], v[248:249], v[22:23]
    v_pk_mul_f32 v[250:251], v[250:251], v[22:23]
    v_pk_mul_f32 v[252:253], v[252:253], v[22:23]
    v_pk_mul_f32 v[254:255], v[254:255], v[22:23]
    v_cvt_pk_bf16_f32 v248, v248, v249
    v_cvt_pk_bf16_f32 v249, v250, v251
    v_cvt_pk_bf16_f32 v250, v252, v253
    v_cvt_pk_bf16_f32 v251, v254, v255
    buffer_store_dwordx4 v[248:251], v7, s[16:19], s38 offen offset:3072 sc1
    v_mov_b64 v[28:29], 0
    v_mov_b64 v[30:31], 0
    v_mov_b64 v[32:33], 0
    v_mov_b64 v[34:35], 0
    v_mov_b64 v[192:193], 0
    v_mov_b64 v[194:195], 0
    v_mov_b64 v[196:197], 0
    v_mov_b64 v[198:199], 0
    v_mov_b64 v[200:201], 0
    v_mov_b64 v[202:203], 0
    v_mov_b64 v[204:205], 0
    v_mov_b64 v[206:207], 0
    v_mov_b64 v[208:209], 0
    v_mov_b64 v[210:211], 0
    v_mov_b64 v[212:213], 0
    v_mov_b64 v[214:215], 0
    v_mov_b64 v[216:217], 0
    v_mov_b64 v[218:219], 0
    v_mov_b64 v[220:221], 0
    v_mov_b64 v[222:223], 0
    v_mov_b64 v[224:225], 0
    v_mov_b64 v[226:227], 0
    v_mov_b64 v[228:229], 0
    v_mov_b64 v[230:231], 0
    v_mov_b64 v[232:233], 0
    v_mov_b64 v[234:235], 0
    v_mov_b64 v[236:237], 0
    v_mov_b64 v[238:239], 0
    v_mov_b64 v[240:241], 0
    v_mov_b64 v[242:243], 0
    v_mov_b64 v[244:245], 0
    v_mov_b64 v[246:247], 0
    v_mov_b64 v[248:249], 0
    v_mov_b64 v[250:251], 0
    v_mov_b64 v[252:253], 0
    v_mov_b64 v[254:255], 0
L_recurrent_scan__compressed_kv_cla__moe_arch_mod__prompt_kernel_ne_129:
    s_branch L_recurrent_scan__compressed_kv_cla__moe_arch_mod__prompt_kernel_back_133
L_recurrent_scan__compressed_kv_cla__moe_arch_mod__prompt_kernel_rare_136:
    s_mov_b32 s61, 0x40000
L_recurrent_scan__compressed_kv_cla__moe_arch_mod__prompt_kernel_spin_134:
    s_sub_u32 s61, s61, 1
    s_cbranch_scc1 L_recurrent_scan__compressed_kv_cla__moe_arch_mod__prompt_kernel_spinx_135
    s_sleep 8
    global_load_dword v11, v12, s[90:91] sc1
    s_waitcnt vmcnt(0)
    v_readfirstlane_b32 s36, v11
    s_nop 0
    s_cmp_lt_u32 s36, 28
    s_cbranch_scc1 L_recurrent_scan__compressed_kv_cla__moe_arch_mod__prompt_kernel_spin_134
L_recurrent_scan__compressed_kv_cla__moe_arch_mod__prompt_kernel_spinx_135:
    s_branch L_recurrent_scan__compressed_kv_cla__moe_arch_mod__prompt_kernel_back_137
L_recurrent_scan__compressed_kv_cla__moe_arch_mod__prompt_kernel_rare_141:
    v_mov_b32 v20, 4048155338
    v_subrev_u32 v21, s50, v18
    v_cmp_gt_i32 s[20:21], 0, v21
    v_cmp_gt_i32 s[22:23], 1, v21
    v_cmp_gt_i32 s[62:63], 2, v21
    v_cmp_gt_i32 vcc, 3, v21
    v_cndmask_b32 v96, v96, v20, s[20:21]
    v_cndmask_b32 v97, v97, v20, s[22:23]
    v_cndmask_b32 v98, v98, v20, s[62:63]
    v_cndmask_b32 v99, v99, v20, vcc
    v_cmp_gt_i32 s[20:21], 16, v21
    v_cmp_gt_i32 s[22:23], 17, v21
    v_cmp_gt_i32 s[62:63], 18, v21
    v_cmp_gt_i32 vcc, 19, v21
    v_cndmask_b32 v100, v100, v20, s[20:21]
    v_cndmask_b32 v101, v101, v20, s[22:23]
    v_cndmask_b32 v102, v102, v20, s[62:63]
    v_cndmask_b32 v103, v103, v20, vcc
    v_cmp_gt_i32 s[20:21], -16, v21
    v_cmp_gt_i32 s[22:23], -15, v21
    v_cmp_gt_i32 s[62:63], -14, v21
    v_cmp_gt_i32 vcc, -13, v21
    v_cndmask_b32 v104, v104, v20, s[20:21]
    v_cndmask_b32 v105, v105, v20, s[22:23]
    v_cndmask_b32 v106, v106, v20, s[62:63]
    v_cndmask_b32 v107, v107, v20, vcc
    v_cmp_gt_i32 s[20:21], 0, v21
    v_cmp_gt_i32 s[22:23], 1, v21
    v_cmp_gt_i32 s[62:63], 2, v21
    v_cmp_gt_i32 vcc, 3, v21
    v_cndmask_b32 v108, v108, v20, s[20:21]
    v_cndmask_b32 v109, v109, v20, s[22:23]
    v_cndmask_b32 v110, v110, v20, s[62:63]
    v_cndmask_b32 v111, v111, v20, vcc
    s_branch L_recurrent_scan__compressed_kv_cla__moe_arch_mod__prompt_kernel_back_142
L_p3_done:
    s_waitcnt vmcnt(4)
    s_and_b32 s36, s2, 7
    s_lshl_b32 s36, s36, 2
    s_sub_u32 s40, 47, s30
    s_lshl_b32 s40, s40, 7
    s_add_u32 s40, s40, s36
    s_add_u32 s41, s30, 32
    s_lshl_b32 s41, s41, 7
    s_add_u32 s41, s41, s36
    s_and_b32 s63, s30, 1
    s_bfe_u32 s36, s2, 0x10002
    s_lshl_b32 s36, s36, 3
    s_add_u32 s30, s30, s36
    s_and_b32 s29, s29, 15
    s_and_b32 s36, s28, 3
    s_lshl_b32 s37, s29, 2
    s_add_u32 s36, s36, s37
    s_lshl_b32 s36, s36, 18
    s_lshr_b32 s37, s28, 2
    s_lshl_b32 s37, s37, 12
    s_add_u32 s36, s36, s37
    s_lshl_b32 s37, s63, 16
    s_add_u32 s36, s36, s37
    s_lshr_b32 s37, s28, 2
    s_lshl_b32 s37, s37, 17
    s_add_u32 s36, s36, s37
    v_lshl_add_u32 v2, v1, 4, s36
    v_xor_b32 v3, 131072, v2
    v_lshrrev_b32 v19, 4, v1
    s_lshr_b32 s36, s28, 2
    s_lshl_b32 s36, s36, 7
    s_and_b32 s37, s28, 3
    s_lshl_b32 s37, s37, 4
    s_add_u32 s36, s36, s37
    s_lshl_b32 s33, s36, 8
    s_lshl_b32 s37, s63, 11
    s_add_u32 s36, s36, s37
    v_add_u32 v18, s36, v19
    v_lshlrev_b32 v18, 11, v18
    s_lshr_b32 s36, s30, 1
    s_lshl_b32 s36, s36, 8
    v_add_u32 v18, s36, v18
    v_lshlrev_b32 v20, 1, v19
    v_and_b32 v21, 15, v1
    v_xor_b32 v20, v20, v21
    v_lshl_add_u32 v6, v20, 4, v18
    v_xor_b32 v20, 8, v20
    v_lshl_add_u32 v7, v20, 4, v18
    v_add_u32 v7, 7168, v7
    v_add_u32 v8, 14336, v6
    v_add_u32 v9, 14336, v7
    s_add_u32 s36, s2, 1
    s_and_b32 s62, s36, 3
    s_lshl_b32 s31, s62, 14
    s_lshl_b32 s32, s62, 20
    s_waitcnt vmcnt(0)
    s_barrier
    s_cmp_eq_u32 s28, 0
    s_cbranch_scc1 L_recurrent_scan__compressed_kv_cla__moe_arch_mod__prompt_kernel_rare_143
L_recurrent_scan__compressed_kv_cla__moe_arch_mod__prompt_kernel_back_144:
    s_bitcmp1_b32 0x70, s28
    s_cbranch_scc1 L_recurrent_scan__compressed_kv_cla__moe_arch_mod__prompt_kernel_f2m_170
L_recurrent_scan__compressed_kv_cla__moe_arch_mod__prompt_kernel_f2a_171:
    s_mov_b32 s34, s33
    s_add_u32 m0, s34, 65536
    s_nop 0
    buffer_load_dwordx4 v6, s[8:11], s32 offen offset:0 lds
    buffer_load_dwordx4 v7, s[8:11], s32 offen offset:1024 lds
    buffer_load_dwordx4 v8, s[8:11], s32 offen offset:2048 lds
    buffer_load_dwordx4 v9, s[8:11], s32 offen offset:3072 lds
    s_add_u32 s32, s32, 131072
    s_add_u32 m0, s34, 81920
    s_nop 0
    buffer_load_dwordx4 v6, s[8:11], s32 offen offset:0 lds
    buffer_load_dwordx4 v7, s[8:11], s32 offen offset:1024 lds
    buffer_load_dwordx4 v8, s[8:11], s32 offen offset:2048 lds
    buffer_load_dwordx4 v9, s[8:11], s32 offen offset:3072 lds
    s_add_u32 s32, s32, 393216
    s_and_b32 s32, s32, 0x3fffff
    s_add_u32 m0, s34, 0
    s_nop 0
    buffer_load_dwordx4 v6, s[8:11], s32 offen offset:0 lds
    buffer_load_dwordx4 v7, s[8:11], s32 offen offset:1024 lds
    buffer_load_dwordx4 v8, s[8:11], s32 offen offset:2048 lds
    buffer_load_dwordx4 v9, s[8:11], s32 offen offset:3072 lds
    s_add_u32 s32, s32, 131072
    s_add_u32 m0, s34, 16384
    s_nop 0
    buffer_load_dwordx4 v6, s[8:11], s32 offen offset:0 lds
    buffer_load_dwordx4 v7, s[8:11], s32 offen offset:1024 lds
    buffer_load_dwordx4 v8, s[8:11], s32 offen offset:2048 lds
    buffer_load_dwordx4 v9, s[8:11], s32 offen offset:3072 lds
    s_add_u32 s32, s32, 393216
    s_and_b32 s32, s32, 0x3fffff
    s_cmp_lt_u32 s28, 4
    s_cbranch_scc1 L_recurrent_scan__compressed_kv_cla__moe_arch_mod__prompt_kernel_f2m_170
L_recurrent_scan__compressed_kv_cla__moe_arch_mod__prompt_kernel_f2b_172:
    s_add_u32 s4, s54, 41943040
    s_addc_u32 s5, s55, 0
    s_and_b32 s5, s5, 0xffff
    s_mov_b32 s6, 16777216
    s_mov_b32 s7, 0x20000
    s_mov_b32 s16, s96
    s_and_b32 s17, s97, 0xffff
    s_mov_b32 s18, 4194304
    s_mov_b32 s19, 0x20000
    s_mov_b32 s20, s98
    s_and_b32 s21, s99, 0xffff
    s_mov_b32 s22, 4194304
    s_mov_b32 s23, 0x20000
    s_lshl_b32 s36, s29, 7
    s_and_b32 s37, s28, 3
    s_lshl_b32 s37, s37, 5
    s_add_u32 s36, s36, s37
    s_lshr_b32 s37, s28, 2
    s_lshl_b32 s37, s37, 4
    s_add_u32 s38, s36, s37
    v_and_b32 v17, 15, v1
    v_add_u32 v14, s38, v17
    v_lshlrev_b32 v16, 3, v14
    v_lshrrev_b32 v15, 3, v1
    v_add_u32 v15, s38, v15
    v_lshlrev_b32 v15, 11, v15
    v_and_b32 v4, 7, v1
    v_lshl_add_u32 v15, v4, 4, v15
    s_lshl_b32 s36, s30, 7
    v_add_u32 v15, s36, v15
    s_lshl_b32 s36, s28, 12
    s_add_u32 s42, s36, 131072
    v_lshl_add_u32 v17, v17, 7, s42
    v_lshl_add_u32 v17, v19, 3, v17
    v_bfe_u32 v20, v1, 2, 2
    v_lshl_add_u32 v18, v19, 2, v20
    v_and_b32 v20, 7, v18
    s_lshl_b32 s36, s63, 2
    s_xor_b32 s36, s36, 4
    v_xor_b32 v20, s36, v20
    v_lshlrev_b32 v18, 8, v18
    s_lshr_b32 s36, s28, 2
    s_lshl_b32 s36, s36, 15
    s_add_u32 s36, s36, 65536
    v_add_u32 v18, s36, v18
    v_and_b32 v21, 3, v1
    v_lshl_add_u32 v18, v21, 3, v18
    v_xor_b32 v21, 0, v20
    v_lshl_add_u32 v50, v21, 5, v18
    v_xor_b32 v21, 1, v20
    v_lshl_add_u32 v51, v21, 5, v18
    v_xor_b32 v21, 2, v20
    v_lshl_add_u32 v52, v21, 5, v18
    v_xor_b32 v21, 3, v20
    v_lshl_add_u32 v53, v21, 5, v18
    v_xor_b32 v21, 4, v20
    v_lshl_add_u32 v54, v21, 5, v18
    v_xor_b32 v21, 5, v20
    v_lshl_add_u32 v55, v21, 5, v18
    v_xor_b32 v21, 6, v20
    v_lshl_add_u32 v56, v21, 5, v18
    v_xor_b32 v21, 7, v20
    v_lshl_add_u32 v57, v21, 5, v18
    v_mov_b64 v[192:193], 0
    v_mov_b64 v[194:195], 0
    v_mov_b64 v[196:197], 0
    v_mov_b64 v[198:199], 0
    v_mov_b64 v[200:201], 0
    v_mov_b64 v[202:203], 0
    v_mov_b64 v[204:205], 0
    v_mov_b64 v[206:207], 0
    v_mov_b64 v[208:209], 0
    v_mov_b64 v[210:211], 0
    v_mov_b64 v[212:213], 0
    v_mov_b64 v[214:215], 0
    v_mov_b64 v[216:217], 0
    v_mov_b64 v[218:219], 0
    v_mov_b64 v[220:221], 0
    v_mov_b64 v[222:223], 0
    v_mov_b64 v[224:225], 0
    v_mov_b64 v[226:227], 0
    v_mov_b64 v[228:229], 0
    v_mov_b64 v[230:231], 0
    v_mov_b64 v[232:233], 0
    v_mov_b64 v[234:235], 0
    v_mov_b64 v[236:237], 0
    v_mov_b64 v[238:239], 0
    v_mov_b64 v[240:241], 0
    v_mov_b64 v[242:243], 0
    v_mov_b64 v[244:245], 0
    v_mov_b64 v[246:247], 0
    v_mov_b64 v[248:249], 0
    v_mov_b64 v[250:251], 0
    v_mov_b64 v[252:253], 0
    v_mov_b64 v[254:255], 0
    s_mov_b32 s60, 15
    s_cmp_eq_u32 s28, 3
    s_cbranch_scc0 L_recurrent_scan__compressed_kv_cla__moe_arch_mod__prompt_kernel_w7j_173
    v_add_u32 v58, s62, v1
    v_and_b32 v58, 3, v58
    s_add_u32 s36, s29, 32
    s_lshl_b32 s36, s36, 7
    s_lshl_b32 s37, s63, 4
    s_add_u32 s36, s36, s37
    v_lshl_add_u32 v58, v58, 2, s36
    s_mov_b32 s61, 0x40000
L_recurrent_scan__compressed_kv_cla__moe_arch_mod__prompt_kernel_cspin_174:
    s_sub_u32 s61, s61, 1
    s_cbranch_scc1 L_recurrent_scan__compressed_kv_cla__moe_arch_mod__prompt_kernel_cspinx_175
    global_load_dword v59, v58, s[90:91] sc1
    s_waitcnt vmcnt(0)
L_recurrent_scan__compressed_kv_cla__moe_arch_mod__prompt_kernel_cchk_176:
    v_cmp_le_u32 vcc, 4, v59
    s_nop 0
    s_and_b32 s60, vcc_lo, 15
    s_and_b32 s36, s60, 3
    s_cmp_eq_u32 s36, 3
    s_cbranch_scc1 L_recurrent_scan__compressed_kv_cla__moe_arch_mod__prompt_kernel_cspinx_175
    s_sleep 6
    s_branch L_recurrent_scan__compressed_kv_cla__moe_arch_mod__prompt_kernel_cspin_174
L_recurrent_scan__compressed_kv_cla__moe_arch_mod__prompt_kernel_cspinx_175:
L_recurrent_scan__compressed_kv_cla__moe_arch_mod__prompt_kernel_w7j_173:
    s_waitcnt vmcnt(12)
    s_waitcnt lgkmcnt(0)
    s_barrier
    buffer_load_dwordx4 v[128:131], v2, s[4:7], s31 offen offset:0 sc1
    buffer_load_dwordx4 v[132:135], v3, s[4:7], s31 offen offset:0 sc1
    buffer_load_dwordx4 v[136:139], v2, s[4:7], s31 offen offset:1024 sc1
    buffer_load_dwordx4 v[140:143], v3, s[4:7], s31 offen offset:1024 sc1
    buffer_load_dwordx4 v[144:147], v2, s[4:7], s31 offen offset:2048 sc1
    buffer_load_dwordx4 v[148:151], v3, s[4:7], s31 offen offset:2048 sc1
    buffer_load_dwordx4 v[152:155], v2, s[4:7], s31 offen offset:3072 sc1
    buffer_load_dwordx4 v[156:159], v3, s[4:7], s31 offen offset:3072 sc1
    s_add_u32 s31, s31, 8192
    s_and_b32 s31, s31, 0xffff
    s_cmp_lt_u32 s28, 4
    s_cbranch_scc0 L_recurrent_scan__compressed_kv_cla__moe_arch_mod__prompt_kernel_g_145
    s_lshl_b32 s36, s28, 10
    s_add_u32 s36, s36, 131072
    v_lshl_add_u32 v28, v1, 4, s36
    ds_read_b128 v[96:99], v28 offset:0
    ds_read_b128 v[100:103], v28 offset:4096
    ds_read_b128 v[104:107], v28 offset:8192
    ds_read_b128 v[108:111], v28 offset:12288
    ds_read_b128 v[112:115], v28 offset:16384
    ds_read_b128 v[116:119], v28 offset:20480
    ds_read_b128 v[120:123], v28 offset:24576
    s_lshr_b32 s36, s2, 4
    s_lshl_b32 s36, s36, 13
    s_and_b32 s37, s2, 15
    s_lshl_b32 s37, s37, 8
    s_add_u32 s36, s36, s37
    s_lshl_b32 s37, s28, 6
    s_add_u32 s36, s36, s37
    s_add_u32 s36, s36, 59768832
    v_and_b32 v28, 1, v1
    v_lshlrev_b32 v28, 12, v28
    v_lshl_add_u32 v28, v19, 4, v28
    s_waitcnt lgkmcnt(0)
    v_add_f32 v96, v96, v100
    v_add_f32 v97, v97, v101
    v_add_f32 v98, v98, v102
    v_add_f32 v99, v99, v103
    v_add_f32 v96, v96, v104
    v_add_f32 v97, v97, v105
    v_add_f32 v98, v98, v106
    v_add_f32 v99, v99, v107
    v_add_f32 v96, v96, v108
    v_add_f32 v97, v97, v109
    v_add_f32 v98, v98, v110
    v_add_f32 v99, v99, v111
    v_add_f32 v96, v96, v112
    v_add_f32 v97, v97, v113
    v_add_f32 v98, v98, v114
    v_add_f32 v99, v99, v115
    v_add_f32 v96, v96, v116
    v_add_f32 v97, v97, v117
    v_add_f32 v98, v98, v118
    v_add_f32 v99, v99, v119
    v_add_f32 v96, v96, v120
    v_add_f32 v97, v97, v121
    v_add_f32 v98, v98, v122
    v_add_f32 v99, v99, v123
    s_mov_b32 exec_lo, 0x00030003
    s_mov_b32 exec_hi, 0x00030003
    buffer_store_dwordx4 v[96:99], v28, s[24:27], s36 offen sc1
    s_mov_b64 exec, -1
    s_nop 3
L_recurrent_scan__compressed_kv_cla__moe_arch_mod__prompt_kernel_g_145:
    v_lshlrev_b32 v22, 4, v1
    v_add_u32 v20, s42, v22
    v_xor_b32 v21, 16384, v20
    s_lshl_b32 s36, s2, 15
    s_lshl_b32 s37, s28, 12
    s_add_u32 s36, s36, s37
    s_add_u32 s36, s36, 67108864
    s_mov_b32 s41, s36
    s_xor_b32 s39, s36, 1048576
    s_add_u32 s40, s2, 128
    s_lshl_b32 s40, s40, 7
    ds_read_b64_tr_b16 v[64:65], v50 offset:0
    ds_read_b64_tr_b16 v[66:67], v50 offset:4096
    ds_read_b64_tr_b16 v[68:69], v51 offset:0
    ds_read_b64_tr_b16 v[70:71], v51 offset:4096
    ds_read_b64_tr_b16 v[72:73], v52 offset:0
    ds_read_b64_tr_b16 v[74:75], v52 offset:4096
    ds_read_b64_tr_b16 v[76:77], v53 offset:0
    ds_read_b64_tr_b16 v[78:79], v53 offset:4096
    ds_read_b64_tr_b16 v[80:81], v54 offset:0
    ds_read_b64_tr_b16 v[82:83], v54 offset:4096
    ds_read_b64_tr_b16 v[84:85], v55 offset:0
    ds_read_b64_tr_b16 v[86:87], v55 offset:4096
    s_mov_b32 s35, 0
    s_waitcnt vmcnt(0)
    buffer_load_dwordx4 v[160:163], v2, s[4:7], s31 offen offset:0 sc1
    buffer_load_dwordx4 v[164:167], v3, s[4:7], s31 offen offset:0 sc1
    buffer_load_dwordx4 v[168:171], v2, s[4:7], s31 offen offset:1024 sc1
    buffer_load_dwordx4 v[172:175], v3, s[4:7], s31 offen offset:1024 sc1
    .p2align 6
L_p4_loop:
    s_cmp_lg_u32 s35, 0
    s_cbranch_scc1 L_recurrent_scan__compressed_kv_cla__moe_arch_mod__prompt_kernel_rare_153
L_recurrent_scan__compressed_kv_cla__moe_arch_mod__prompt_kernel_back_154:
    s_waitcnt lgkmcnt(8)
    s_waitcnt vmcnt(22)
    v_mfma_f32_16x16x32_bf16 v[192:195], v[64:67], v[128:131], v[192:195]
    ds_read_b64_tr_b16 v[88:89], v56 offset:0
    v_mfma_f32_16x16x32_bf16 v[224:227], v[64:67], v[132:135], v[224:227]
    ds_read_b64_tr_b16 v[90:91], v56 offset:4096
    v_mfma_f32_16x16x32_bf16 v[196:199], v[68:71], v[128:131], v[196:199]
    ds_read_b64_tr_b16 v[92:93], v57 offset:0
    v_mfma_f32_16x16x32_bf16 v[228:231], v[68:71], v[132:135], v[228:231]
    ds_read_b64_tr_b16 v[94:95], v57 offset:4096
    buffer_load_dwordx4 v[176:179], v2, s[4:7], s31 offen offset:2048 sc1
    s_waitcnt lgkmcnt(8)
    v_mfma_f32_16x16x32_bf16 v[200:203], v[72:75], v[128:131], v[200:203]
    ds_read_b64_tr_b16 v[64:65], v50 offset:8192
    v_mfma_f32_16x16x32_bf16 v[232:235], v[72:75], v[132:135], v[232:235]
    ds_read_b64_tr_b16 v[66:67], v50 offset:12288
    v_mfma_f32_16x16x32_bf16 v[204:207], v[76:79], v[128:131], v[204:207]
    ds_read_b64_tr_b16 v[68:69], v51 offset:8192
    v_mfma_f32_16x16x32_bf16 v[236:239], v[76:79], v[132:135], v[236:239]
    ds_read_b64_tr_b16 v[70:71], v51 offset:12288
    s_waitcnt lgkmcnt(8)
    v_mfma_f32_16x16x32_bf16 v[208:211], v[80:83], v[128:131], v[208:211]
    ds_read_b64_tr_b16 v[72:73], v52 offset:8192
    v_mfma_f32_16x16x32_bf16 v[240:243], v[80:83], v[132:135], v[240:243]
    ds_read_b64_tr_b16 v[74:75], v52 offset:12288
    buffer_load_dwordx4 v[180:183], v3, s[4:7], s31 offen offset:2048 sc1
    v_mfma_f32_16x16x32_bf16 v[212:215], v[84:87], v[128:131], v[212:215]
    ds_read_b64_tr_b16 v[76:77], v53 offset:8192
    v_mfma_f32_16x16x32_bf16 v[244:247], v[84:87], v[132:135], v[244:247]
    ds_read_b64_tr_b16 v[78:79], v53 offset:12288
    s_waitcnt lgkmcnt(8)
    v_mfma_f32_16x16x32_bf16 v[216:219], v[88:91], v[128:131], v[216:219]
    ds_read_b64_tr_b16 v[80:81], v54 offset:8192
    v_mfma_f32_16x16x32_bf16 v[248:251], v[88:91], v[132:135], v[248:251]
    ds_read_b64_tr_b16 v[82:83], v54 offset:12288
    v_mfma_f32_16x16x32_bf16 v[220:223], v[92:95], v[128:131], v[220:223]
    ds_read_b64_tr_b16 v[84:85], v55 offset:8192
    v_mfma_f32_16x16x32_bf16 v[252:255], v[92:95], v[132:135], v[252:255]
    ds_read_b64_tr_b16 v[86:87], v55 offset:12288
    s_waitcnt lgkmcnt(8)
    s_waitcnt vmcnt(22)
    v_mfma_f32_16x16x32_bf16 v[192:195], v[64:67], v[136:139], v[192:195]
    ds_read_b64_tr_b16 v[88:89], v56 offset:8192
    v_mfma_f32_16x16x32_bf16 v[224:227], v[64:67], v[140:143], v[224:227]
    ds_read_b64_tr_b16 v[90:91], v56 offset:12288
    buffer_load_dwordx4 v[184:187], v2, s[4:7], s31 offen offset:3072 sc1
    v_mfma_f32_16x16x32_bf16 v[196:199], v[68:71], v[136:139], v[196:199]
    ds_read_b64_tr_b16 v[92:93], v57 offset:8192
    v_mfma_f32_16x16x32_bf16 v[228:231], v[68:71], v[140:143], v[228:231]
    ds_read_b64_tr_b16 v[94:95], v57 offset:12288
    s_waitcnt lgkmcnt(8)
    v_mfma_f32_16x16x32_bf16 v[200:203], v[72:75], v[136:139], v[200:203]
    v_mfma_f32_16x16x32_bf16 v[232:235], v[72:75], v[140:143], v[232:235]
    buffer_load_dwordx4 v[188:191], v3, s[4:7], s31 offen offset:3072 sc1
    s_add_u32 s31, s31, 8192
    s_and_b32 s31, s31, 0xffff
    v_mfma_f32_16x16x32_bf16 v[204:207], v[76:79], v[136:139], v[204:207]
    v_mfma_f32_16x16x32_bf16 v[236:239], v[76:79], v[140:143], v[236:239]
    s_waitcnt lgkmcnt(0)
    s_waitcnt vmcnt(20)
    s_barrier
    v_mfma_f32_16x16x32_bf16 v[208:211], v[80:83], v[136:139], v[208:211]
    ds_read_b64_tr_b16 v[64:65], v50 offset:16384
    ds_read_b64_tr_b16 v[66:67], v50 offset:20480
    v_mfma_f32_16x16x32_bf16 v[240:243], v[80:83], v[140:143], v[240:243]
    ds_read_b64_tr_b16 v[68:69], v51 offset:16384
    ds_read_b64_tr_b16 v[70:71], v51 offset:20480
    s_add_u32 m0, s34, 65536
    v_mfma_f32_16x16x32_bf16 v[212:215], v[84:87], v[136:139], v[212:215]
    ds_read_b64_tr_b16 v[72:73], v52 offset:16384
    ds_read_b64_tr_b16 v[74:75], v52 offset:20480
    buffer_load_dwordx4 v6, s[8:11], s32 offen offset:0 lds
    v_mfma_f32_16x16x32_bf16 v[244:247], v[84:87], v[140:143], v[244:247]
    ds_read_b64_tr_b16 v[76:77], v53 offset:16384
    ds_read_b64_tr_b16 v[78:79], v53 offset:20480
    v_mfma_f32_16x16x32_bf16 v[216:219], v[88:91], v[136:139], v[216:219]
    ds_read_b64_tr_b16 v[80:81], v54 offset:16384
    ds_read_b64_tr_b16 v[82:83], v54 offset:20480
    buffer_load_dwordx4 v7, s[8:11], s32 offen offset:1024 lds
    v_mfma_f32_16x16x32_bf16 v[248:251], v[88:91], v[140:143], v[248:251]
    v_mfma_f32_16x16x32_bf16 v[220:223], v[92:95], v[136:139], v[220:223]
    ds_read_b64_tr_b16 v[84:85], v55 offset:16384
    ds_read_b64_tr_b16 v[86:87], v55 offset:20480
    buffer_load_dwordx4 v8, s[8:11], s32 offen offset:2048 lds
    v_mfma_f32_16x16x32_bf16 v[252:255], v[92:95], v[140:143], v[252:255]
    buffer_load_dwordx4 v9, s[8:11], s32 offen offset:3072 lds
    s_add_u32 s32, s32, 131072
    s_waitcnt lgkmcnt(8)
    s_waitcnt vmcnt(22)
    v_mfma_f32_16x16x32_bf16 v[192:195], v[64:67], v[144:147], v[192:195]
    ds_read_b64_tr_b16 v[88:89], v56 offset:16384
    v_mfma_f32_16x16x32_bf16 v[224:227], v[64:67], v[148:151], v[224:227]
    ds_read_b64_tr_b16 v[90:91], v56 offset:20480
    v_mfma_f32_16x16x32_bf16 v[196:199], v[68:71], v[144:147], v[196:199]
    ds_read_b64_tr_b16 v[92:93], v57 offset:16384
    v_mfma_f32_16x16x32_bf16 v[228:231], v[68:71], v[148:151], v[228:231]
    ds_read_b64_tr_b16 v[94:95], v57 offset:20480
    buffer_load_dwordx4 v[128:131], v2, s[4:7], s31 offen offset:0 sc1
    s_waitcnt lgkmcnt(8)
    v_mfma_f32_16x16x32_bf16 v[200:203], v[72:75], v[144:147], v[200:203]
    ds_read_b64_tr_b16 v[64:65], v50 offset:24576
    v_mfma_f32_16x16x32_bf16 v[232:235], v[72:75], v[148:151], v[232:235]
    ds_read_b64_tr_b16 v[66:67], v50 offset:28672
    v_xor_b32 v50, 65536, v50
    v_mfma_f32_16x16x32_bf16 v[204:207], v[76:79], v[144:147], v[204:207]
    ds_read_b64_tr_b16 v[68:69], v51 offset:24576
    v_mfma_f32_16x16x32_bf16 v[236:239], v[76:79], v[148:151], v[236:239]
    ds_read_b64_tr_b16 v[70:71], v51 offset:28672
    v_xor_b32 v51, 65536, v51
    s_waitcnt lgkmcnt(8)
    v_mfma_f32_16x16x32_bf16 v[208:211], v[80:83], v[144:147], v[208:211]
    ds_read_b64_tr_b16 v[72:73], v52 offset:24576
    v_mfma_f32_16x16x32_bf16 v[240:243], v[80:83], v[148:151], v[240:243]
    ds_read_b64_tr_b16 v[74:75], v52 offset:28672
    v_xor_b32 v52, 65536, v52
    buffer_load_dwordx4 v[132:135], v3, s[4:7], s31 offen offset:0 sc1
    v_mfma_f32_16x16x32_bf16 v[212:215], v[84:87], v[144:147], v[212:215]
    ds_read_b64_tr_b16 v[76:77], v53 offset:24576
    v_mfma_f32_16x16x32_bf16 v[244:247], v[84:87], v[148:151], v[244:247]
    ds_read_b64_tr_b16 v[78:79], v53 offset:28672
    v_xor_b32 v53, 65536, v53
    s_waitcnt lgkmcnt(8)
    v_mfma_f32_16x16x32_bf16 v[216:219], v[88:91], v[144:147], v[216:219]
    ds_read_b64_tr_b16 v[80:81], v54 offset:24576
    v_mfma_f32_16x16x32_bf16 v[248:251], v[88:91], v[148:151], v[248:251]
    ds_read_b64_tr_b16 v[82:83], v54 offset:28672
    v_xor_b32 v54, 65536, v54
    v_mfma_f32_16x16x32_bf16 v[220:223], v[92:95], v[144:147], v[220:223]
    ds_read_b64_tr_b16 v[84:85], v55 offset:24576
    v_mfma_f32_16x16x32_bf16 v[252:255], v[92:95], v[148:151], v[252:255]
    ds_read_b64_tr_b16 v[86:87], v55 offset:28672
    v_xor_b32 v55, 65536, v55
    s_waitcnt lgkmcnt(8)
    s_waitcnt vmcnt(22)
    v_mfma_f32_16x16x32_bf16 v[192:195], v[64:67], v[152:155], v[192:195]
    ds_read_b64_tr_b16 v[88:89], v56 offset:24576
    v_mfma_f32_16x16x32_bf16 v[224:227], v[64:67], v[156:159], v[224:227]
    ds_read_b64_tr_b16 v[90:91], v56 offset:28672
    v_xor_b32 v56, 65536, v56
    buffer_load_dwordx4 v[136:139], v2, s[4:7], s31 offen offset:1024 sc1
    v_mfma_f32_16x16x32_bf16 v[196:199], v[68:71], v[152:155], v[196:199]
    ds_read_b64_tr_b16 v[92:93], v57 offset:24576
    v_mfma_f32_16x16x32_bf16 v[228:231], v[68:71], v[156:159], v[228:231]
    ds_read_b64_tr_b16 v[94:95], v57 offset:28672
    v_xor_b32 v57, 65536, v57
    s_waitcnt lgkmcnt(8)
    v_mfma_f32_16x16x32_bf16 v[200:203], v[72:75], v[152:155], v[200:203]
    v_mfma_f32_16x16x32_bf16 v[232:235], v[72:75], v[156:159], v[232:235]
    buffer_load_dwordx4 v[140:143], v3, s[4:7], s31 offen offset:1024 sc1
    v_mfma_f32_16x16x32_bf16 v[204:207], v[76:79], v[152:155], v[204:207]
    v_mfma_f32_16x16x32_bf16 v[236:239], v[76:79], v[156:159], v[236:239]
    s_waitcnt lgkmcnt(0)
    s_waitcnt vmcnt(20)
    s_barrier
    v_mfma_f32_16x16x32_bf16 v[208:211], v[80:83], v[152:155], v[208:211]
    ds_read_b64_tr_b16 v[64:65], v50 offset:0
    ds_read_b64_tr_b16 v[66:67], v50 offset:4096
    v_mfma_f32_16x16x32_bf16 v[240:243], v[80:83], v[156:159], v[240:243]
    ds_read_b64_tr_b16 v[68:69], v51 offset:0
    ds_read_b64_tr_b16 v[70:71], v51 offset:4096
    s_add_u32 m0, s34, 81920
    v_mfma_f32_16x16x32_bf16 v[212:215], v[84:87], v[152:155], v[212:215]
    ds_read_b64_tr_b16 v[72:73], v52 offset:0
    ds_read_b64_tr_b16 v[74:75], v52 offset:4096
    buffer_load_dwordx4 v6, s[8:11], s32 offen offset:0 lds
    v_mfma_f32_16x16x32_bf16 v[244:247], v[84:87], v[156:159], v[244:247]
    ds_read_b64_tr_b16 v[76:77], v53 offset:0
    ds_read_b64_tr_b16 v[78:79], v53 offset:4096
    v_mfma_f32_16x16x32_bf16 v[216:219], v[88:91], v[152:155], v[216:219]
    ds_read_b64_tr_b16 v[80:81], v54 offset:0
    ds_read_b64_tr_b16 v[82:83], v54 offset:4096
    buffer_load_dwordx4 v7, s[8:11], s32 offen offset:1024 lds
    v_mfma_f32_16x16x32_bf16 v[248:251], v[88:91], v[156:159], v[248:251]
    v_mfma_f32_16x16x32_bf16 v[220:223], v[92:95], v[152:155], v[220:223]
    ds_read_b64_tr_b16 v[84:85], v55 offset:0
    ds_read_b64_tr_b16 v[86:87], v55 offset:4096
    buffer_load_dwordx4 v8, s[8:11], s32 offen offset:2048 lds
    v_mfma_f32_16x16x32_bf16 v[252:255], v[92:95], v[156:159], v[252:255]
    buffer_load_dwordx4 v9, s[8:11], s32 offen offset:3072 lds
    s_add_u32 s32, s32, 393216
    s_and_b32 s32, s32, 0x3fffff
    s_cmp_eq_u32 s35, 2
    s_cbranch_scc1 L_recurrent_scan__compressed_kv_cla__moe_arch_mod__prompt_kernel_rare_156
L_recurrent_scan__compressed_kv_cla__moe_arch_mod__prompt_kernel_back_157:
    s_waitcnt lgkmcnt(8)
    s_waitcnt vmcnt(18)
    v_mfma_f32_16x16x32_bf16 v[192:195], v[64:67], v[160:163], v[192:195]
    ds_read_b64_tr_b16 v[88:89], v56 offset:0
    v_mfma_f32_16x16x32_bf16 v[224:227], v[64:67], v[164:167], v[224:227]
    ds_read_b64_tr_b16 v[90:91], v56 offset:4096
    v_mfma_f32_16x16x32_bf16 v[196:199], v[68:71], v[160:163], v[196:199]
    ds_read_b64_tr_b16 v[92:93], v57 offset:0
    v_mfma_f32_16x16x32_bf16 v[228:231], v[68:71], v[164:167], v[228:231]
    ds_read_b64_tr_b16 v[94:95], v57 offset:4096
    buffer_load_dwordx4 v[144:147], v2, s[4:7], s31 offen offset:2048 sc1
    s_waitcnt lgkmcnt(8)
    v_mfma_f32_16x16x32_bf16 v[200:203], v[72:75], v[160:163], v[200:203]
    ds_read_b64_tr_b16 v[64:65], v50 offset:8192
    v_mfma_f32_16x16x32_bf16 v[232:235], v[72:75], v[164:167], v[232:235]
    ds_read_b64_tr_b16 v[66:67], v50 offset:12288
    v_mfma_f32_16x16x32_bf16 v[204:207], v[76:79], v[160:163], v[204:207]
    ds_read_b64_tr_b16 v[68:69], v51 offset:8192
    v_mfma_f32_16x16x32_bf16 v[236:239], v[76:79], v[164:167], v[236:239]
    ds_read_b64_tr_b16 v[70:71], v51 offset:12288
    s_waitcnt lgkmcnt(8)
    v_mfma_f32_16x16x32_bf16 v[208:211], v[80:83], v[160:163], v[208:211]
    ds_read_b64_tr_b16 v[72:73], v52 offset:8192
    v_mfma_f32_16x16x32_bf16 v[240:243], v[80:83], v[164:167], v[240:243]
    ds_read_b64_tr_b16 v[74:75], v52 offset:12288
    buffer_load_dwordx4 v[148:151], v3, s[4:7], s31 offen offset:2048 sc1
    v_mfma_f32_16x16x32_bf16 v[212:215], v[84:87], v[160:163], v[212:215]
    ds_read_b64_tr_b16 v[76:77], v53 offset:8192
    v_mfma_f32_16x16x32_bf16 v[244:247], v[84:87], v[164:167], v[244:247]
    ds_read_b64_tr_b16 v[78:79], v53 offset:12288
    s_waitcnt lgkmcnt(8)
    v_mfma_f32_16x16x32_bf16 v[216:219], v[88:91], v[160:163], v[216:219]
    ds_read_b64_tr_b16 v[80:81], v54 offset:8192
    v_mfma_f32_16x16x32_bf16 v[248:251], v[88:91], v[164:167], v[248:251]
    ds_read_b64_tr_b16 v[82:83], v54 offset:12288
    v_mfma_f32_16x16x32_bf16 v[220:223], v[92:95], v[160:163], v[220:223]
    ds_read_b64_tr_b16 v[84:85], v55 offset:8192
    v_mfma_f32_16x16x32_bf16 v[252:255], v[92:95], v[164:167], v[252:255]
    ds_read_b64_tr_b16 v[86:87], v55 offset:12288
    s_waitcnt lgkmcnt(8)
    s_waitcnt vmcnt(18)
    v_mfma_f32_16x16x32_bf16 v[192:195], v[64:67], v[168:171], v[192:195]
    ds_read_b64_tr_b16 v[88:89], v56 offset:8192
    v_mfma_f32_16x16x32_bf16 v[224:227], v[64:67], v[172:175], v[224:227]
    ds_read_b64_tr_b16 v[90:91], v56 offset:12288
    buffer_load_dwordx4 v[152:155], v2, s[4:7], s31 offen offset:3072 sc1
    v_mfma_f32_16x16x32_bf16 v[196:199], v[68:71], v[168:171], v[196:199]
    ds_read_b64_tr_b16 v[92:93], v57 offset:8192
    v_mfma_f32_16x16x32_bf16 v[228:231], v[68:71], v[172:175], v[228:231]
    ds_read_b64_tr_b16 v[94:95], v57 offset:12288
    s_waitcnt lgkmcnt(8)
    v_mfma_f32_16x16x32_bf16 v[200:203], v[72:75], v[168:171], v[200:203]
    v_mfma_f32_16x16x32_bf16 v[232:235], v[72:75], v[172:175], v[232:235]
    buffer_load_dwordx4 v[156:159], v3, s[4:7], s31 offen offset:3072 sc1
    s_add_u32 s31, s31, 8192
    s_and_b32 s31, s31, 0xffff
    v_mfma_f32_16x16x32_bf16 v[204:207], v[76:79], v[168:171], v[204:207]
    v_mfma_f32_16x16x32_bf16 v[236:239], v[76:79], v[172:175], v[236:239]
    s_cmp_lt_u32 s60, 15
    s_cbranch_scc1 L_recurrent_scan__compressed_kv_cla__moe_arch_mod__prompt_kernel_rare_158
L_recurrent_scan__compressed_kv_cla__moe_arch_mod__prompt_kernel_back_159:
    s_waitcnt lgkmcnt(0)
    s_barrier
    v_mfma_f32_16x16x32_bf16 v[208:211], v[80:83], v[168:171], v[208:211]
    ds_read_b64_tr_b16 v[64:65], v50 offset:16384
    ds_read_b64_tr_b16 v[66:67], v50 offset:20480
    v_mfma_f32_16x16x32_bf16 v[240:243], v[80:83], v[172:175], v[240:243]
    ds_read_b64_tr_b16 v[68:69], v51 offset:16384
    ds_read_b64_tr_b16 v[70:71], v51 offset:20480
    s_add_u32 m0, s34, 0
    v_mfma_f32_16x16x32_bf16 v[212:215], v[84:87], v[168:171], v[212:215]
    ds_read_b64_tr_b16 v[72:73], v52 offset:16384
    ds_read_b64_tr_b16 v[74:75], v52 offset:20480
    buffer_load_dwordx4 v6, s[8:11], s32 offen offset:0 lds
    v_mfma_f32_16x16x32_bf16 v[244:247], v[84:87], v[172:175], v[244:247]
    ds_read_b64_tr_b16 v[76:77], v53 offset:16384
    ds_read_b64_tr_b16 v[78:79], v53 offset:20480
    v_mfma_f32_16x16x32_bf16 v[216:219], v[88:91], v[168:171], v[216:219]
    ds_read_b64_tr_b16 v[80:81], v54 offset:16384
    ds_read_b64_tr_b16 v[82:83], v54 offset:20480
    buffer_load_dwordx4 v7, s[8:11], s32 offen offset:1024 lds
    v_mfma_f32_16x16x32_bf16 v[248:251], v[88:91], v[172:175], v[248:251]
    v_mfma_f32_16x16x32_bf16 v[220:223], v[92:95], v[168:171], v[220:223]
    ds_read_b64_tr_b16 v[84:85], v55 offset:16384
    ds_read_b64_tr_b16 v[86:87], v55 offset:20480
    buffer_load_dwordx4 v8, s[8:11], s32 offen offset:2048 lds
    v_mfma_f32_16x16x32_bf16 v[252:255], v[92:95], v[172:175], v[252:255]
    buffer_load_dwordx4 v9, s[8:11], s32 offen offset:3072 lds
    s_add_u32 s32, s32, 131072
    s_waitcnt lgkmcnt(8)
    s_waitcnt vmcnt(22)
    v_mfma_f32_16x16x32_bf16 v[192:195], v[64:67], v[176:179], v[192:195]
    ds_read_b64_tr_b16 v[88:89], v56 offset:16384
    v_mfma_f32_16x16x32_bf16 v[224:227], v[64:67], v[180:183], v[224:227]
    ds_read_b64_tr_b16 v[90:91], v56 offset:20480
    v_mfma_f32_16x16x32_bf16 v[196:199], v[68:71], v[176:179], v[196:199]
    ds_read_b64_tr_b16 v[92:93], v57 offset:16384
    v_mfma_f32_16x16x32_bf16 v[228:231], v[68:71], v[180:183], v[228:231]
    ds_read_b64_tr_b16 v[94:95], v57 offset:20480
    buffer_load_dwordx4 v[160:163], v2, s[4:7], s31 offen offset:0 sc1
    s_waitcnt lgkmcnt(8)
    v_mfma_f32_16x16x32_bf16 v[200:203], v[72:75], v[176:179], v[200:203]
    ds_read_b64_tr_b16 v[64:65], v50 offset:24576
    v_mfma_f32_16x16x32_bf16 v[232:235], v[72:75], v[180:183], v[232:235]
    ds_read_b64_tr_b16 v[66:67], v50 offset:28672
    v_xor_b32 v50, 65536, v50
    v_mfma_f32_16x16x32_bf16 v[204:207], v[76:79], v[176:179], v[204:207]
    ds_read_b64_tr_b16 v[68:69], v51 offset:24576
    v_mfma_f32_16x16x32_bf16 v[236:239], v[76:79], v[180:183], v[236:239]
    ds_read_b64_tr_b16 v[70:71], v51 offset:28672
    v_xor_b32 v51, 65536, v51
    s_waitcnt lgkmcnt(8)
    v_mfma_f32_16x16x32_bf16 v[208:211], v[80:83], v[176:179], v[208:211]
    ds_read_b64_tr_b16 v[72:73], v52 offset:24576
    v_mfma_f32_16x16x32_bf16 v[240:243], v[80:83], v[180:183], v[240:243]
    ds_read_b64_tr_b16 v[74:75], v52 offset:28672
    v_xor_b32 v52, 65536, v52
    buffer_load_dwordx4 v[164:167], v3, s[4:7], s31 offen offset:0 sc1
    v_mfma_f32_16x16x32_bf16 v[212:215], v[84:87], v[176:179], v[212:215]
    ds_read_b64_tr_b16 v[76:77], v53 offset:24576
    v_mfma_f32_16x16x32_bf16 v[244:247], v[84:87], v[180:183], v[244:247]
    ds_read_b64_tr_b16 v[78:79], v53 offset:28672
    v_xor_b32 v53, 65536, v53
    s_waitcnt lgkmcnt(8)
    v_mfma_f32_16x16x32_bf16 v[216:219], v[88:91], v[176:179], v[216:219]
    ds_read_b64_tr_b16 v[80:81], v54 offset:24576
    v_mfma_f32_16x16x32_bf16 v[248:251], v[88:91], v[180:183], v[248:251]
    ds_read_b64_tr_b16 v[82:83], v54 offset:28672
    v_xor_b32 v54, 65536, v54
    v_mfma_f32_16x16x32_bf16 v[220:223], v[92:95], v[176:179], v[220:223]
    ds_read_b64_tr_b16 v[84:85], v55 offset:24576
    v_mfma_f32_16x16x32_bf16 v[252:255], v[92:95], v[180:183], v[252:255]
    ds_read_b64_tr_b16 v[86:87], v55 offset:28672
    v_xor_b32 v55, 65536, v55
    s_waitcnt lgkmcnt(8)
    s_waitcnt vmcnt(22)
    v_mfma_f32_16x16x32_bf16 v[192:195], v[64:67], v[184:187], v[192:195]
    ds_read_b64_tr_b16 v[88:89], v56 offset:24576
    v_mfma_f32_16x16x32_bf16 v[224:227], v[64:67], v[188:191], v[224:227]
    ds_read_b64_tr_b16 v[90:91], v56 offset:28672
    v_xor_b32 v56, 65536, v56
    buffer_load_dwordx4 v[168:171], v2, s[4:7], s31 offen offset:1024 sc1
    v_mfma_f32_16x16x32_bf16 v[196:199], v[68:71], v[184:187], v[196:199]
    ds_read_b64_tr_b16 v[92:93], v57 offset:24576
    v_mfma_f32_16x16x32_bf16 v[228:231], v[68:71], v[188:191], v[228:231]
    ds_read_b64_tr_b16 v[94:95], v57 offset:28672
    v_xor_b32 v57, 65536, v57
    s_waitcnt lgkmcnt(8)
    v_mfma_f32_16x16x32_bf16 v[200:203], v[72:75], v[184:187], v[200:203]
    v_mfma_f32_16x16x32_bf16 v[232:235], v[72:75], v[188:191], v[232:235]
    buffer_load_dwordx4 v[172:175], v3, s[4:7], s31 offen offset:1024 sc1
    v_mfma_f32_16x16x32_bf16 v[204:207], v[76:79], v[184:187], v[204:207]
    v_mfma_f32_16x16x32_bf16 v[236:239], v[76:79], v[188:191], v[236:239]
    s_cmp_lt_u32 s60, 15
    s_cbranch_scc1 L_recurrent_scan__compressed_kv_cla__moe_arch_mod__prompt_kernel_rare_168
L_recurrent_scan__compressed_kv_cla__moe_arch_mod__prompt_kernel_back_169:
    s_waitcnt lgkmcnt(0)
    s_waitcnt vmcnt(20)
    s_barrier
    v_mfma_f32_16x16x32_bf16 v[208:211], v[80:83], v[184:187], v[208:211]
    ds_read_b64_tr_b16 v[64:65], v50 offset:0
    ds_read_b64_tr_b16 v[66:67], v50 offset:4096
    v_mfma_f32_16x16x32_bf16 v[240:243], v[80:83], v[188:191], v[240:243]
    ds_read_b64_tr_b16 v[68:69], v51 offset:0
    ds_read_b64_tr_b16 v[70:71], v51 offset:4096
    s_add_u32 m0, s34, 16384
    v_mfma_f32_16x16x32_bf16 v[212:215], v[84:87], v[184:187], v[212:215]
    ds_read_b64_tr_b16 v[72:73], v52 offset:0
    ds_read_b64_tr_b16 v[74:75], v52 offset:4096
    buffer_load_dwordx4 v6, s[8:11], s32 offen offset:0 lds
    v_mfma_f32_16x16x32_bf16 v[244:247], v[84:87], v[188:191], v[244:247]
    ds_read_b64_tr_b16 v[76:77], v53 offset:0
    ds_read_b64_tr_b16 v[78:79], v53 offset:4096
    v_mfma_f32_16x16x32_bf16 v[216:219], v[88:91], v[184:187], v[216:219]
    ds_read_b64_tr_b16 v[80:81], v54 offset:0
    ds_read_b64_tr_b16 v[82:83], v54 offset:4096
    buffer_load_dwordx4 v7, s[8:11], s32 offen offset:1024 lds
    v_mfma_f32_16x16x32_bf16 v[248:251], v[88:91], v[188:191], v[248:251]
    v_mfma_f32_16x16x32_bf16 v[220:223], v[92:95], v[184:187], v[220:223]
    ds_read_b64_tr_b16 v[84:85], v55 offset:0
    ds_read_b64_tr_b16 v[86:87], v55 offset:4096
    buffer_load_dwordx4 v8, s[8:11], s32 offen offset:2048 lds
    v_mfma_f32_16x16x32_bf16 v[252:255], v[92:95], v[188:191], v[252:255]
    buffer_load_dwordx4 v9, s[8:11], s32 offen offset:3072 lds
    s_add_u32 s32, s32, 393216
    s_and_b32 s32, s32, 0x3fffff
    s_add_u32 s35, s35, 1
    s_cmp_lt_u32 s35, 3
    s_cbranch_scc1 L_p4_loop
    s_sub_u32 s36, s56, s38
    s_sub_u32 s37, s57, s38
    s_min_u32 s36, s36, s37
    s_cmp_lt_u32 s36, 16
    s_cbranch_scc1 L_recurrent_scan__compressed_kv_cla__moe_arch_mod__prompt_kernel_rare_177
L_recurrent_scan__compressed_kv_cla__moe_arch_mod__prompt_kernel_back_178:
    s_xor_b32 s37, s40, 4096
    v_mov_b32 v5, s37
    s_waitcnt vmcnt(16)
    ds_read_b64 v[40:41], v17 offset:0
    ds_read_b64 v[42:43], v17 offset:32
    ds_read_b64 v[44:45], v17 offset:64
    ds_read_b64 v[46:47], v17 offset:96
    s_waitcnt lgkmcnt(12)
    v_mfma_f32_16x16x32_bf16 v[192:195], v[64:67], v[128:131], v[192:195]
    ds_read_b64_tr_b16 v[88:89], v56 offset:0
    v_mfma_f32_16x16x32_bf16 v[224:227], v[64:67], v[132:135], v[224:227]
    ds_read_b64_tr_b16 v[90:91], v56 offset:4096
    buffer_load_dwordx4 v[176:179], v2, s[4:7], s31 offen offset:2048 sc1
    v_mfma_f32_16x16x32_bf16 v[196:199], v[68:71], v[128:131], v[196:199]
    ds_read_b64_tr_b16 v[92:93], v57 offset:0
    v_mfma_f32_16x16x32_bf16 v[228:231], v[68:71], v[132:135], v[228:231]
    ds_read_b64_tr_b16 v[94:95], v57 offset:4096
    s_waitcnt lgkmcnt(12)
    v_mfma_f32_16x16x32_bf16 v[200:203], v[72:75], v[128:131], v[200:203]
    ds_read_b64_tr_b16 v[64:65], v50 offset:8192
    buffer_load_dwordx4 v[180:183], v3, s[4:7], s31 offen offset:2048 sc1
    v_mfma_f32_16x16x32_bf16 v[232:235], v[72:75], v[132:135], v[232:235]
    ds_read_b64_tr_b16 v[66:67], v50 offset:12288
    v_mfma_f32_16x16x32_bf16 v[204:207], v[76:79], v[128:131], v[204:207]
    ds_read_b64_tr_b16 v[68:69], v51 offset:8192
    v_mfma_f32_16x16x32_bf16 v[236:239], v[76:79], v[132:135], v[236:239]
    ds_read_b64_tr_b16 v[70:71], v51 offset:12288
    buffer_load_dwordx4 v[184:187], v2, s[4:7], s31 offen offset:3072 sc1
    s_waitcnt lgkmcnt(12)
    s_waitcnt lgkmcnt(8)
    v_mfma_f32_16x16x32_bf16 v[208:211], v[80:83], v[128:131], v[208:211]
    ds_read_b64_tr_b16 v[72:73], v52 offset:8192
    v_lshlrev_b32 v96, 16, v40
    v_and_b32 v97, 0xffff0000, v40
    v_sub_f32 v112, v96, v48
    v_sub_f32 v113, v97, v48
    v_mfma_f32_16x16x32_bf16 v[240:243], v[80:83], v[132:135], v[240:243]
    ds_read_b64_tr_b16 v[74:75], v52 offset:12288
    v_cvt_pk_bf16_f32 v10, v112, v113
    v_lshlrev_b32 v112, 16, v10
    v_and_b32 v113, 0xffff0000, v10
    v_mul_f32 v112, v112, v49
    v_mfma_f32_16x16x32_bf16 v[212:215], v[84:87], v[128:131], v[212:215]
    ds_read_b64_tr_b16 v[76:77], v53 offset:8192
    buffer_load_dwordx4 v[188:191], v3, s[4:7], s31 offen offset:3072 sc1
    v_mul_f32 v113, v113, v49
    v_cvt_pk_bf16_f32 v10, v112, v113
    v_mfma_f32_16x16x32_bf16 v[244:247], v[84:87], v[132:135], v[244:247]
    ds_read_b64_tr_b16 v[78:79], v53 offset:12288
    v_lshlrev_b32 v112, 16, v10
    v_and_b32 v113, 0xffff0000, v10
    v_mul_f32 v11, 0xbfb8aa3b, v112
    v_mul_f32 v12, 0xbfb8aa3b, v113
    s_barrier
    s_waitcnt lgkmcnt(8)
    v_mfma_f32_16x16x32_bf16 v[216:219], v[88:91], v[128:131], v[216:219]
    ds_read_b64_tr_b16 v[80:81], v50 offset:16384
    v_exp_f32 v11, v11
    v_exp_f32 v12, v12
    v_mfma_f32_16x16x32_bf16 v[248:251], v[88:91], v[132:135], v[248:251]
    ds_read_b64_tr_b16 v[82:83], v50 offset:20480
    v_add_f32 v11, 1.0, v11
    v_add_f32 v12, 1.0, v12
    v_rcp_f32 v11, v11
    v_rcp_f32 v12, v12
    v_mfma_f32_16x16x32_bf16 v[220:223], v[92:95], v[128:131], v[220:223]
    ds_read_b64_tr_b16 v[84:85], v51 offset:16384
    v_mul_f32 v112, v112, v11
    v_mul_f32 v113, v113, v12
    v_mfma_f32_16x16x32_bf16 v[252:255], v[92:95], v[132:135], v[252:255]
    ds_read_b64_tr_b16 v[86:87], v51 offset:20480
    v_cvt_pk_bf16_f32 v10, v112, v113
    v_lshlrev_b32 v112, 16, v10
    v_and_b32 v113, 0xffff0000, v10
    v_lshlrev_b32 v98, 16, v41
    s_waitcnt lgkmcnt(8)
    v_mfma_f32_16x16x32_bf16 v[192:195], v[64:67], v[136:139], v[192:195]
    ds_read_b64_tr_b16 v[88:89], v52 offset:16384
    v_and_b32 v99, 0xffff0000, v41
    v_sub_f32 v114, v98, v48
    v_sub_f32 v115, v99, v48
    v_cvt_pk_bf16_f32 v10, v114, v115
    v_mfma_f32_16x16x32_bf16 v[224:227], v[64:67], v[140:143], v[224:227]
    ds_read_b64_tr_b16 v[90:91], v52 offset:20480
    v_lshlrev_b32 v114, 16, v10
    v_and_b32 v115, 0xffff0000, v10
    v_mfma_f32_16x16x32_bf16 v[196:199], v[68:71], v[136:139], v[196:199]
    ds_read_b64_tr_b16 v[92:93], v53 offset:16384
    v_mul_f32 v114, v114, v49
    v_mul_f32 v115, v115, v49
    v_cvt_pk_bf16_f32 v10, v114, v115
    v_lshlrev_b32 v114, 16, v10
    v_mfma_f32_16x16x32_bf16 v[228:231], v[68:71], v[140:143], v[228:231]
    ds_read_b64_tr_b16 v[94:95], v53 offset:20480
    v_and_b32 v115, 0xffff0000, v10
    v_mul_f32 v11, 0xbfb8aa3b, v114
    s_waitcnt lgkmcnt(8)
    v_mfma_f32_16x16x32_bf16 v[200:203], v[72:75], v[136:139], v[200:203]
    ds_read_b64_tr_b16 v[64:65], v50 offset:24576
    v_mul_f32 v12, 0xbfb8aa3b, v115
    v_exp_f32 v11, v11
    v_exp_f32 v12, v12
    v_add_f32 v11, 1.0, v11
    v_mfma_f32_16x16x32_bf16 v[232:235], v[72:75], v[140:143], v[232:235]
    ds_read_b64_tr_b16 v[66:67], v50 offset:28672
    v_xor_b32 v50, 65536, v50
    v_add_f32 v12, 1.0, v12
    v_rcp_f32 v11, v11
    v_mfma_f32_16x16x32_bf16 v[204:207], v[76:79], v[136:139], v[204:207]
    ds_read_b64_tr_b16 v[68:69], v51 offset:24576
    v_rcp_f32 v12, v12
    v_mul_f32 v114, v114, v11
    v_mul_f32 v115, v115, v12
    v_cvt_pk_bf16_f32 v10, v114, v115
    v_mfma_f32_16x16x32_bf16 v[236:239], v[76:79], v[140:143], v[236:239]
    ds_read_b64_tr_b16 v[70:71], v51 offset:28672
    v_xor_b32 v51, 65536, v51
    v_lshlrev_b32 v114, 16, v10
    v_and_b32 v115, 0xffff0000, v10
    s_waitcnt lgkmcnt(8)
    s_waitcnt vmcnt(18)
    v_mfma_f32_16x16x32_bf16 v[192:195], v[80:83], v[144:147], v[192:195]
    ds_read_b64_tr_b16 v[72:73], v52 offset:24576
    v_lshlrev_b32 v100, 16, v42
    v_and_b32 v101, 0xffff0000, v42
    v_sub_f32 v116, v100, v48
    v_sub_f32 v117, v101, v48
    v_mfma_f32_16x16x32_bf16 v[224:227], v[80:83], v[148:151], v[224:227]
    ds_read_b64_tr_b16 v[74:75], v52 offset:28672
    v_xor_b32 v52, 65536, v52
    v_cvt_pk_bf16_f32 v10, v116, v117
    v_lshlrev_b32 v116, 16, v10
    v_and_b32 v117, 0xffff0000, v10
    v_mul_f32 v116, v116, v49
    v_mfma_f32_16x16x32_bf16 v[196:199], v[84:87], v[144:147], v[196:199]
    ds_read_b64_tr_b16 v[76:77], v53 offset:24576
    v_mul_f32 v117, v117, v49
    v_cvt_pk_bf16_f32 v10, v116, v117
    v_mfma_f32_16x16x32_bf16 v[228:231], v[84:87], v[148:151], v[228:231]
    ds_read_b64_tr_b16 v[78:79], v53 offset:28672
    v_xor_b32 v53, 65536, v53
    v_lshlrev_b32 v116, 16, v10
    v_and_b32 v117, 0xffff0000, v10
    v_mul_f32 v11, 0xbfb8aa3b, v116
    v_mul_f32 v12, 0xbfb8aa3b, v117
    s_waitcnt vmcnt(12)
    s_barrier
    s_waitcnt lgkmcnt(8)
    v_mfma_f32_16x16x32_bf16 v[200:203], v[88:91], v[144:147], v[200:203]
    ds_read_b64_tr_b16 v[80:81], v50 offset:0
    v_exp_f32 v11, v11
    v_exp_f32 v12, v12
    v_mfma_f32_16x16x32_bf16 v[232:235], v[88:91], v[148:151], v[232:235]
    ds_read_b64_tr_b16 v[82:83], v50 offset:4096
    v_add_f32 v11, 1.0, v11
    v_add_f32 v12, 1.0, v12
    v_rcp_f32 v11, v11
    v_rcp_f32 v12, v12
    v_mfma_f32_16x16x32_bf16 v[204:207], v[92:95], v[144:147], v[204:207]
    ds_read_b64_tr_b16 v[84:85], v51 offset:0
    v_mul_f32 v116, v116, v11
    v_mul_f32 v117, v117, v12
    v_mfma_f32_16x16x32_bf16 v[236:239], v[92:95], v[148:151], v[236:239]
    ds_read_b64_tr_b16 v[86:87], v51 offset:4096
    v_cvt_pk_bf16_f32 v10, v116, v117
    v_lshlrev_b32 v116, 16, v10
    v_and_b32 v117, 0xffff0000, v10
    v_lshlrev_b32 v102, 16, v43
    s_waitcnt lgkmcnt(8)
    v_mfma_f32_16x16x32_bf16 v[192:195], v[64:67], v[152:155], v[192:195]
    ds_read_b64_tr_b16 v[88:89], v52 offset:0
    v_and_b32 v103, 0xffff0000, v43
    v_sub_f32 v118, v102, v48
    v_sub_f32 v119, v103, v48
    v_cvt_pk_bf16_f32 v10, v118, v119
    v_mfma_f32_16x16x32_bf16 v[224:227], v[64:67], v[156:159], v[224:227]
    ds_read_b64_tr_b16 v[90:91], v52 offset:4096
    v_lshlrev_b32 v118, 16, v10
    v_and_b32 v119, 0xffff0000, v10
    v_mfma_f32_16x16x32_bf16 v[196:199], v[68:71], v[152:155], v[196:199]
    ds_read_b64_tr_b16 v[92:93], v53 offset:0
    v_mul_f32 v118, v118, v49
    v_mul_f32 v119, v119, v49
    v_cvt_pk_bf16_f32 v10, v118, v119
    v_lshlrev_b32 v118, 16, v10
    v_mfma_f32_16x16x32_bf16 v[228:231], v[68:71], v[156:159], v[228:231]
    ds_read_b64_tr_b16 v[94:95], v53 offset:4096
    v_and_b32 v119, 0xffff0000, v10
    v_mul_f32 v11, 0xbfb8aa3b, v118
    s_waitcnt lgkmcnt(8)
    v_mfma_f32_16x16x32_bf16 v[200:203], v[72:75], v[152:155], v[200:203]
    ds_read_b64_tr_b16 v[64:65], v50 offset:8192
    v_mul_f32 v12, 0xbfb8aa3b, v119
    v_exp_f32 v11, v11
    v_exp_f32 v12, v12
    v_add_f32 v11, 1.0, v11
    v_mfma_f32_16x16x32_bf16 v[232:235], v[72:75], v[156:159], v[232:235]
    ds_read_b64_tr_b16 v[66:67], v50 offset:12288
    v_add_f32 v12, 1.0, v12
    v_rcp_f32 v11, v11
    v_mfma_f32_16x16x32_bf16 v[204:207], v[76:79], v[152:155], v[204:207]
    ds_read_b64_tr_b16 v[68:69], v51 offset:8192
    v_rcp_f32 v12, v12
    v_mul_f32 v118, v118, v11
    v_mul_f32 v119, v119, v12
    v_cvt_pk_bf16_f32 v10, v118, v119
    v_mfma_f32_16x16x32_bf16 v[236:239], v[76:79], v[156:159], v[236:239]
    ds_read_b64_tr_b16 v[70:71], v51 offset:12288
    v_lshlrev_b32 v118, 16, v10
    v_and_b32 v119, 0xffff0000, v10
    s_waitcnt lgkmcnt(8)
    s_waitcnt vmcnt(10)
    v_mfma_f32_16x16x32_bf16 v[192:195], v[80:83], v[160:163], v[192:195]
    ds_read_b64_tr_b16 v[72:73], v52 offset:8192
    v_lshlrev_b32 v104, 16, v44
    v_and_b32 v105, 0xffff0000, v44
    v_sub_f32 v120, v104, v48
    v_sub_f32 v121, v105, v48
    v_mfma_f32_16x16x32_bf16 v[224:227], v[80:83], v[164:167], v[224:227]
    ds_read_b64_tr_b16 v[74:75], v52 offset:12288
    v_cvt_pk_bf16_f32 v10, v120, v121
    v_lshlrev_b32 v120, 16, v10
    v_and_b32 v121, 0xffff0000, v10
    v_mul_f32 v120, v120, v49
    v_mfma_f32_16x16x32_bf16 v[196:199], v[84:87], v[160:163], v[196:199]
    ds_read_b64_tr_b16 v[76:77], v53 offset:8192
    v_mul_f32 v121, v121, v49
    v_cvt_pk_bf16_f32 v10, v120, v121
    v_mfma_f32_16x16x32_bf16 v[228:231], v[84:87], v[164:167], v[228:231]
    ds_read_b64_tr_b16 v[78:79], v53 offset:12288
    v_lshlrev_b32 v120, 16, v10
    v_and_b32 v121, 0xffff0000, v10
    v_mul_f32 v11, 0xbfb8aa3b, v120
    v_mul_f32 v12, 0xbfb8aa3b, v121
    s_waitcnt vmcnt(4)
    s_barrier
    s_waitcnt lgkmcnt(8)
    v_mfma_f32_16x16x32_bf16 v[200:203], v[88:91], v[160:163], v[200:203]
    ds_read_b64_tr_b16 v[80:81], v50 offset:16384
    v_exp_f32 v11, v11
    v_exp_f32 v12, v12
    v_mfma_f32_16x16x32_bf16 v[232:235], v[88:91], v[164:167], v[232:235]
    ds_read_b64_tr_b16 v[82:83], v50 offset:20480
    v_add_f32 v11, 1.0, v11
    v_add_f32 v12, 1.0, v12
    v_rcp_f32 v11, v11
    v_rcp_f32 v12, v12
    v_mfma_f32_16x16x32_bf16 v[204:207], v[92:95], v[160:163], v[204:207]
    ds_read_b64_tr_b16 v[84:85], v51 offset:16384
    v_mul_f32 v120, v120, v11
    v_mul_f32 v121, v121, v12
    v_mfma_f32_16x16x32_bf16 v[236:239], v[92:95], v[164:167], v[236:239]
    ds_read_b64_tr_b16 v[86:87], v51 offset:20480
    v_cvt_pk_bf16_f32 v10, v120, v121
    v_lshlrev_b32 v120, 16, v10
    v_and_b32 v121, 0xffff0000, v10
    v_lshlrev_b32 v106, 16, v45
    s_waitcnt lgkmcnt(8)
    v_mfma_f32_16x16x32_bf16 v[192:195], v[64:67], v[168:171], v[192:195]
    ds_read_b64_tr_b16 v[88:89], v52 offset:16384
    v_and_b32 v107, 0xffff0000, v45
    v_sub_f32 v122, v106, v48
    v_sub_f32 v123, v107, v48
    v_cvt_pk_bf16_f32 v10, v122, v123
    v_mfma_f32_16x16x32_bf16 v[224:227], v[64:67], v[172:175], v[224:227]
    ds_read_b64_tr_b16 v[90:91], v52 offset:20480
    v_lshlrev_b32 v122, 16, v10
    v_and_b32 v123, 0xffff0000, v10
    v_mfma_f32_16x16x32_bf16 v[196:199], v[68:71], v[168:171], v[196:199]
    ds_read_b64_tr_b16 v[92:93], v53 offset:16384
    v_mul_f32 v122, v122, v49
    v_mul_f32 v123, v123, v49
    v_cvt_pk_bf16_f32 v10, v122, v123
    v_lshlrev_b32 v122, 16, v10
    v_mfma_f32_16x16x32_bf16 v[228:231], v[68:71], v[172:175], v[228:231]
    ds_read_b64_tr_b16 v[94:95], v53 offset:20480
    v_and_b32 v123, 0xffff0000, v10
    v_mul_f32 v11, 0xbfb8aa3b, v122
    s_waitcnt lgkmcnt(8)
    v_mfma_f32_16x16x32_bf16 v[200:203], v[72:75], v[168:171], v[200:203]
    ds_read_b64_tr_b16 v[64:65], v50 offset:24576
    v_mul_f32 v12, 0xbfb8aa3b, v123
    v_exp_f32 v11, v11
    v_exp_f32 v12, v12
    v_add_f32 v11, 1.0, v11
    v_mfma_f32_16x16x32_bf16 v[232:235], v[72:75], v[172:175], v[232:235]
    ds_read_b64_tr_b16 v[66:67], v50 offset:28672
    v_add_f32 v12, 1.0, v12
    v_rcp_f32 v11, v11
    v_mfma_f32_16x16x32_bf16 v[204:207], v[76:79], v[168:171], v[204:207]
    ds_read_b64_tr_b16 v[68:69], v51 offset:24576
    v_rcp_f32 v12, v12
    v_mul_f32 v122, v122, v11
    v_mul_f32 v123, v123, v12
    v_cvt_pk_bf16_f32 v10, v122, v123
    v_mfma_f32_16x16x32_bf16 v[236:239], v[76:79], v[172:175], v[236:239]
    ds_read_b64_tr_b16 v[70:71], v51 offset:28672
    v_lshlrev_b32 v122, 16, v10
    v_and_b32 v123, 0xffff0000, v10
    s_waitcnt lgkmcnt(8)
    s_waitcnt vmcnt(2)
    v_mfma_f32_16x16x32_bf16 v[192:195], v[80:83], v[176:179], v[192:195]
    ds_read_b64_tr_b16 v[72:73], v52 offset:24576
    v_lshlrev_b32 v108, 16, v46
    v_and_b32 v109, 0xffff0000, v46
    v_sub_f32 v124, v108, v48
    v_sub_f32 v125, v109, v48
    v_mfma_f32_16x16x32_bf16 v[224:227], v[80:83], v[180:183], v[224:227]
    ds_read_b64_tr_b16 v[74:75], v52 offset:28672
    v_cvt_pk_bf16_f32 v10, v124, v125
    v_lshlrev_b32 v124, 16, v10
    v_and_b32 v125, 0xffff0000, v10
    v_mul_f32 v124, v124, v49
    v_mfma_f32_16x16x32_bf16 v[196:199], v[84:87], v[176:179], v[196:199]
    ds_read_b64_tr_b16 v[76:77], v53 offset:24576
    v_mul_f32 v125, v125, v49
    v_cvt_pk_bf16_f32 v10, v124, v125
    v_mfma_f32_16x16x32_bf16 v[228:231], v[84:87], v[180:183], v[228:231]
    ds_read_b64_tr_b16 v[78:79], v53 offset:28672
    v_lshlrev_b32 v124, 16, v10
    v_and_b32 v125, 0xffff0000, v10
    v_mul_f32 v11, 0xbfb8aa3b, v124
    v_mul_f32 v12, 0xbfb8aa3b, v125
    s_waitcnt lgkmcnt(8)
    v_mfma_f32_16x16x32_bf16 v[200:203], v[88:91], v[176:179], v[200:203]
    ds_read_b64_tr_b16 v[80:81], v54 offset:8192
    v_exp_f32 v11, v11
    v_exp_f32 v12, v12
    v_mfma_f32_16x16x32_bf16 v[232:235], v[88:91], v[180:183], v[232:235]
    ds_read_b64_tr_b16 v[82:83], v54 offset:12288
    v_add_f32 v11, 1.0, v11
    v_add_f32 v12, 1.0, v12
    v_rcp_f32 v11, v11
    v_rcp_f32 v12, v12
    v_mfma_f32_16x16x32_bf16 v[204:207], v[92:95], v[176:179], v[204:207]
    ds_read_b64_tr_b16 v[84:85], v55 offset:8192
    v_mul_f32 v124, v124, v11
    v_mul_f32 v125, v125, v12
    v_mfma_f32_16x16x32_bf16 v[236:239], v[92:95], v[180:183], v[236:239]
    ds_read_b64_tr_b16 v[86:87], v55 offset:12288
    v_cvt_pk_bf16_f32 v10, v124, v125
    v_lshlrev_b32 v124, 16, v10
    v_and_b32 v125, 0xffff0000, v10
    v_lshlrev_b32 v110, 16, v47
    s_waitcnt lgkmcnt(8)
    s_waitcnt vmcnt(0)
    v_mfma_f32_16x16x32_bf16 v[192:195], v[64:67], v[184:187], v[192:195]
    ds_read_b64_tr_b16 v[88:89], v56 offset:8192
    v_and_b32 v111, 0xffff0000, v47
    v_sub_f32 v126, v110, v48
    v_sub_f32 v127, v111, v48
    v_cvt_pk_bf16_f32 v10, v126, v127
    v_mfma_f32_16x16x32_bf16 v[224:227], v[64:67], v[188:191], v[224:227]
    ds_read_b64_tr_b16 v[90:91], v56 offset:12288
    v_lshlrev_b32 v126, 16, v10
    v_and_b32 v127, 0xffff0000, v10
    v_mfma_f32_16x16x32_bf16 v[196:199], v[68:71], v[184:187], v[196:199]
    ds_read_b64_tr_b16 v[92:93], v57 offset:8192
    v_mul_f32 v126, v126, v49
    v_mul_f32 v127, v127, v49
    v_cvt_pk_bf16_f32 v10, v126, v127
    v_lshlrev_b32 v126, 16, v10
    v_mfma_f32_16x16x32_bf16 v[228:231], v[68:71], v[188:191], v[228:231]
    ds_read_b64_tr_b16 v[94:95], v57 offset:12288
    v_and_b32 v127, 0xffff0000, v10
    v_mul_f32 v11, 0xbfb8aa3b, v126
    s_waitcnt lgkmcnt(8)
    v_mfma_f32_16x16x32_bf16 v[200:203], v[72:75], v[184:187], v[200:203]
    ds_read_b64_tr_b16 v[64:65], v54 offset:16384
    v_mul_f32 v12, 0xbfb8aa3b, v127
    v_exp_f32 v11, v11
    v_exp_f32 v12, v12
    v_add_f32 v11, 1.0, v11
    v_mfma_f32_16x16x32_bf16 v[232:235], v[72:75], v[188:191], v[232:235]
    ds_read_b64_tr_b16 v[66:67], v54 offset:20480
    v_add_f32 v12, 1.0, v12
    v_rcp_f32 v11, v11
    v_mfma_f32_16x16x32_bf16 v[204:207], v[76:79], v[184:187], v[204:207]
    ds_read_b64_tr_b16 v[68:69], v55 offset:16384
    v_rcp_f32 v12, v12
    v_mul_f32 v126, v126, v11
    v_mul_f32 v127, v127, v12
    v_cvt_pk_bf16_f32 v10, v126, v127
    v_mfma_f32_16x16x32_bf16 v[236:239], v[76:79], v[188:191], v[236:239]
    ds_read_b64_tr_b16 v[70:71], v55 offset:20480
    v_lshlrev_b32 v126, 16, v10
    v_and_b32 v127, 0xffff0000, v10
    s_waitcnt lgkmcnt(8)
    v_mfma_f32_16x16x32_bf16 v[208:211], v[80:83], v[136:139], v[208:211]
    ds_read_b64_tr_b16 v[72:73], v56 offset:16384
    v_mfma_f32_16x16x32_bf16 v[240:243], v[80:83], v[140:143], v[240:243]
    ds_read_b64_tr_b16 v[74:75], v56 offset:20480
    v_mfma_f32_16x16x32_bf16 v[212:215], v[84:87], v[136:139], v[212:215]
    ds_read_b64_tr_b16 v[76:77], v57 offset:16384
    ds_write_b128 v20, v[224:227] offset:0
    v_mfma_f32_16x16x32_bf16 v[244:247], v[84:87], v[140:143], v[244:247]
    ds_read_b64_tr_b16 v[78:79], v57 offset:20480
    ds_write_b128 v20, v[228:231] offset:1024
    s_waitcnt lgkmcnt(10)
    v_mfma_f32_16x16x32_bf16 v[216:219], v[88:91], v[136:139], v[216:219]
    ds_read_b64_tr_b16 v[80:81], v54 offset:24576
    ds_write_b128 v20, v[232:235] offset:2048
    v_mfma_f32_16x16x32_bf16 v[248:251], v[88:91], v[140:143], v[248:251]
    ds_read_b64_tr_b16 v[82:83], v54 offset:28672
    v_xor_b32 v54, 65536, v54
    ds_write_b128 v20, v[236:239] offset:3072
    v_mfma_f32_16x16x32_bf16 v[220:223], v[92:95], v[136:139], v[220:223]
    ds_read_b64_tr_b16 v[84:85], v55 offset:24576
    v_mfma_f32_16x16x32_bf16 v[252:255], v[92:95], v[140:143], v[252:255]
    ds_read_b64_tr_b16 v[86:87], v55 offset:28672
    v_xor_b32 v55, 65536, v55
    s_waitcnt lgkmcnt(12)
    v_mfma_f32_16x16x32_bf16 v[208:211], v[64:67], v[144:147], v[208:211]
    ds_read_b64_tr_b16 v[88:89], v56 offset:24576
    v_mfma_f32_16x16x32_bf16 v[240:243], v[64:67], v[148:151], v[240:243]
    ds_read_b64_tr_b16 v[90:91], v56 offset:28672
    v_xor_b32 v56, 65536, v56
    v_mfma_f32_16x16x32_bf16 v[212:215], v[68:71], v[144:147], v[212:215]
    ds_read_b64_tr_b16 v[92:93], v57 offset:24576
    s_waitcnt lgkmcnt(5)
    s_barrier
    v_mfma_f32_16x16x32_bf16 v[244:247], v[68:71], v[148:151], v[244:247]
    ds_read_b64_tr_b16 v[94:95], v57 offset:28672
    v_xor_b32 v57, 65536, v57
    ds_read_b128 v[224:227], v21 offset:0
    ds_read_b128 v[228:231], v21 offset:1024
    v_mfma_f32_16x16x32_bf16 v[216:219], v[72:75], v[144:147], v[216:219]
    ds_read_b64_tr_b16 v[64:65], v54 offset:0
    ds_read_b128 v[232:235], v21 offset:2048
    ds_read_b128 v[236:239], v21 offset:3072
    v_mfma_f32_16x16x32_bf16 v[248:251], v[72:75], v[148:151], v[248:251]
    ds_read_b64_tr_b16 v[66:67], v54 offset:4096
    v_mfma_f32_16x16x32_bf16 v[220:223], v[76:79], v[144:147], v[220:223]
    ds_read_b64_tr_b16 v[68:69], v55 offset:0
    v_mfma_f32_16x16x32_bf16 v[252:255], v[76:79], v[148:151], v[252:255]
    ds_read_b64_tr_b16 v[70:71], v55 offset:4096
    s_waitcnt lgkmcnt(12)
    v_mfma_f32_16x16x32_bf16 v[208:211], v[80:83], v[152:155], v[208:211]
    ds_read_b64_tr_b16 v[72:73], v56 offset:0
    s_waitcnt lgkmcnt(8)
    v_add_f32 v192, v192, v224
    v_add_f32 v193, v193, v225
    v_mfma_f32_16x16x32_bf16 v[240:243], v[80:83], v[156:159], v[240:243]
    ds_read_b64_tr_b16 v[74:75], v56 offset:4096
    v_add_f32 v194, v194, v226
    v_add_f32 v195, v195, v227
    buffer_store_dwordx4 v[192:195], v22, s[24:27], s41 offen offset:0 sc1
    v_mfma_f32_16x16x32_bf16 v[212:215], v[84:87], v[152:155], v[212:215]
    ds_read_b64_tr_b16 v[76:77], v57 offset:0
    s_waitcnt lgkmcnt(9)
    v_add_f32 v196, v196, v228
    v_add_f32 v197, v197, v229
    v_mfma_f32_16x16x32_bf16 v[244:247], v[84:87], v[156:159], v[244:247]
    ds_read_b64_tr_b16 v[78:79], v57 offset:4096
    v_add_f32 v198, v198, v230
    v_add_f32 v199, v199, v231
    buffer_store_dwordx4 v[196:199], v22, s[24:27], s41 offen offset:1024 sc1
    v_mfma_f32_16x16x32_bf16 v[216:219], v[88:91], v[152:155], v[216:219]
    ds_read_b64_tr_b16 v[80:81], v54 offset:8192
    s_waitcnt lgkmcnt(9)
    v_add_f32 v200, v200, v232
    v_add_f32 v201, v201, v233
    v_mfma_f32_16x16x32_bf16 v[248:251], v[88:91], v[156:159], v[248:251]
    ds_read_b64_tr_b16 v[82:83], v54 offset:12288
    v_add_f32 v202, v202, v234
    v_add_f32 v203, v203, v235
    buffer_store_dwordx4 v[200:203], v22, s[24:27], s41 offen offset:2048 sc1
    v_mfma_f32_16x16x32_bf16 v[220:223], v[92:95], v[152:155], v[220:223]
    ds_read_b64_tr_b16 v[84:85], v55 offset:8192
    s_waitcnt lgkmcnt(10)
    v_add_f32 v204, v204, v236
    v_add_f32 v205, v205, v237
    v_mfma_f32_16x16x32_bf16 v[252:255], v[92:95], v[156:159], v[252:255]
    ds_read_b64_tr_b16 v[86:87], v55 offset:12288
    v_add_f32 v206, v206, v238
    v_add_f32 v207, v207, v239
    buffer_store_dwordx4 v[204:207], v22, s[24:27], s41 offen offset:3072 sc1
    s_waitcnt lgkmcnt(8)
    v_mfma_f32_16x16x32_bf16 v[208:211], v[64:67], v[160:163], v[208:211]
    ds_read_b64_tr_b16 v[88:89], v56 offset:8192
    v_mfma_f32_16x16x32_bf16 v[240:243], v[64:67], v[164:167], v[240:243]
    ds_read_b64_tr_b16 v[90:91], v56 offset:12288
    v_mfma_f32_16x16x32_bf16 v[212:215], v[68:71], v[160:163], v[212:215]
    ds_read_b64_tr_b16 v[92:93], v57 offset:8192
    v_mfma_f32_16x16x32_bf16 v[244:247], v[68:71], v[164:167], v[244:247]
    ds_read_b64_tr_b16 v[94:95], v57 offset:12288
    s_waitcnt lgkmcnt(8)
    v_mfma_f32_16x16x32_bf16 v[216:219], v[72:75], v[160:163], v[216:219]
    ds_read_b64_tr_b16 v[64:65], v54 offset:16384
    v_mfma_f32_16x16x32_bf16 v[248:251], v[72:75], v[164:167], v[248:251]
    ds_read_b64_tr_b16 v[66:67], v54 offset:20480
    v_mfma_f32_16x16x32_bf16 v[220:223], v[76:79], v[160:163], v[220:223]
    ds_read_b64_tr_b16 v[68:69], v55 offset:16384
    v_mfma_f32_16x16x32_bf16 v[252:255], v[76:79], v[164:167], v[252:255]
    ds_read_b64_tr_b16 v[70:71], v55 offset:20480
    s_waitcnt lgkmcnt(8)
    v_mfma_f32_16x16x32_bf16 v[208:211], v[80:83], v[168:171], v[208:211]
    ds_read_b64_tr_b16 v[72:73], v56 offset:16384
    v_mfma_f32_16x16x32_bf16 v[240:243], v[80:83], v[172:175], v[240:243]
    ds_read_b64_tr_b16 v[74:75], v56 offset:20480
    v_mfma_f32_16x16x32_bf16 v[212:215], v[84:87], v[168:171], v[212:215]
    ds_read_b64_tr_b16 v[76:77], v57 offset:16384
    v_mfma_f32_16x16x32_bf16 v[244:247], v[84:87], v[172:175], v[244:247]
    ds_read_b64_tr_b16 v[78:79], v57 offset:20480
    s_waitcnt lgkmcnt(8)
    v_mfma_f32_16x16x32_bf16 v[216:219], v[88:91], v[168:171], v[216:219]
    ds_read_b64_tr_b16 v[80:81], v54 offset:24576
    v_mfma_f32_16x16x32_bf16 v[248:251], v[88:91], v[172:175], v[248:251]
    ds_read_b64_tr_b16 v[82:83], v54 offset:28672
    v_mfma_f32_16x16x32_bf16 v[220:223], v[92:95], v[168:171], v[220:223]
    ds_read_b64_tr_b16 v[84:85], v55 offset:24576
    v_mfma_f32_16x16x32_bf16 v[252:255], v[92:95], v[172:175], v[252:255]
    ds_read_b64_tr_b16 v[86:87], v55 offset:28672
    s_waitcnt lgkmcnt(8)
    v_mfma_f32_16x16x32_bf16 v[208:211], v[64:67], v[176:179], v[208:211]
    ds_read_b64_tr_b16 v[88:89], v56 offset:24576
    v_mfma_f32_16x16x32_bf16 v[240:243], v[64:67], v[180:183], v[240:243]
    ds_read_b64_tr_b16 v[90:91], v56 offset:28672
    v_mfma_f32_16x16x32_bf16 v[212:215], v[68:71], v[176:179], v[212:215]
    ds_read_b64_tr_b16 v[92:93], v57 offset:24576
    v_mfma_f32_16x16x32_bf16 v[244:247], v[68:71], v[180:183], v[244:247]
    ds_read_b64_tr_b16 v[94:95], v57 offset:28672
    s_waitcnt lgkmcnt(8)
    v_mfma_f32_16x16x32_bf16 v[216:219], v[72:75], v[176:179], v[216:219]
    v_mfma_f32_16x16x32_bf16 v[248:251], v[72:75], v[180:183], v[248:251]
    v_mfma_f32_16x16x32_bf16 v[220:223], v[76:79], v[176:179], v[220:223]
    v_mfma_f32_16x16x32_bf16 v[252:255], v[76:79], v[180:183], v[252:255]
    s_waitcnt lgkmcnt(4)
    v_mfma_f32_16x16x32_bf16 v[208:211], v[80:83], v[184:187], v[208:211]
    v_mfma_f32_16x16x32_bf16 v[240:243], v[80:83], v[188:191], v[240:243]
    v_mfma_f32_16x16x32_bf16 v[212:215], v[84:87], v[184:187], v[212:215]
    s_lshr_b32 s36, s28, 2
    s_lshl_b32 s36, s36, 15
    s_and_b32 s37, s28, 3
    v_mfma_f32_16x16x32_bf16 v[244:247], v[84:87], v[188:191], v[244:247]
    s_lshl_b32 s37, s37, 12
    s_add_u32 s36, s36, s37
    s_add_u32 s36, s36, 65536
    s_waitcnt lgkmcnt(0)
    v_mfma_f32_16x16x32_bf16 v[216:219], v[88:91], v[184:187], v[216:219]
    v_add_u32 v20, s36, v22
    v_xor_b32 v21, 32768, v20
    v_mfma_f32_16x16x32_bf16 v[248:251], v[88:91], v[188:191], v[248:251]
    v_mfma_f32_16x16x32_bf16 v[220:223], v[92:95], v[184:187], v[220:223]
    v_mfma_f32_16x16x32_bf16 v[252:255], v[92:95], v[188:191], v[252:255]
    s_waitcnt vmcnt(0)
    v_mov_b32 v4, s40
    v_mov_b32 v13, 1
    s_mov_b64 exec, 1
    global_atomic_add v4, v13, s[90:91]
    s_mov_b64 exec, -1
    s_nop 3
    s_nop 4
    ds_write_b128 v20, v[240:243] offset:0
    ds_write_b128 v20, v[244:247] offset:1024
    ds_write_b128 v20, v[248:251] offset:2048
    ds_write_b128 v20, v[252:255] offset:3072
    s_sub_u32 s36, s56, s38
    s_sub_u32 s37, s57, s38
    s_min_u32 s36, s36, s37
    s_cmp_lt_u32 s36, 16
    s_cbranch_scc1 L_recurrent_scan__compressed_kv_cla__moe_arch_mod__prompt_kernel_rare_179
L_recurrent_scan__compressed_kv_cla__moe_arch_mod__prompt_kernel_back_180:
    s_cmp_eq_u32 s28, 3
    s_cbranch_scc1 L_recurrent_scan__compressed_kv_cla__moe_arch_mod__prompt_kernel_rare_183
L_recurrent_scan__compressed_kv_cla__moe_arch_mod__prompt_kernel_back_184:
    s_waitcnt lgkmcnt(0)
    s_barrier
    buffer_load_dwordx4 v[64:67], v22, s[24:27], s39 offen offset:0 sc1
    buffer_load_dwordx4 v[68:71], v22, s[24:27], s39 offen offset:1024 sc1
    buffer_load_dwordx4 v[72:75], v22, s[24:27], s39 offen offset:2048 sc1
    buffer_load_dwordx4 v[76:79], v22, s[24:27], s39 offen offset:3072 sc1
    ds_read_b128 v[128:131], v21 offset:0
    ds_read_b128 v[132:135], v21 offset:1024
    ds_read_b128 v[136:139], v21 offset:2048
    ds_read_b128 v[140:143], v21 offset:3072
    s_waitcnt lgkmcnt(3)
    v_pk_add_f32 v[128:129], v[128:129], v[208:209]
    v_pk_add_f32 v[130:131], v[130:131], v[210:211]
    s_waitcnt lgkmcnt(2)
    v_pk_add_f32 v[132:133], v[132:133], v[212:213]
    v_pk_add_f32 v[134:135], v[134:135], v[214:215]
    s_waitcnt lgkmcnt(1)
    v_pk_add_f32 v[136:137], v[136:137], v[216:217]
    v_pk_add_f32 v[138:139], v[138:139], v[218:219]
    s_waitcnt lgkmcnt(0)
    v_pk_add_f32 v[140:141], v[140:141], v[220:221]
    v_pk_add_f32 v[142:143], v[142:143], v[222:223]
    s_waitcnt vmcnt(3)
    v_pk_add_f32 v[128:129], v[128:129], v[64:65]
    v_cvt_pk_bf16_f32 v23, v128, v129
    v_lshlrev_b32 v128, 16, v23
    v_and_b32 v129, 0xffff0000, v23
    v_pk_mul_f32 v[128:129], v[128:129], v[112:113]
    v_cvt_pk_bf16_f32 v23, v128, v129
    v_lshlrev_b32 v128, 16, v23
    v_and_b32 v129, 0xffff0000, v23
    v_pk_add_f32 v[128:129], v[128:129], v[96:97]
    v_cvt_pk_bf16_f32 v80, v128, v129
    v_pk_add_f32 v[130:131], v[130:131], v[66:67]
    v_cvt_pk_bf16_f32 v23, v130, v131
    v_lshlrev_b32 v130, 16, v23
    v_and_b32 v131, 0xffff0000, v23
    v_pk_mul_f32 v[130:131], v[130:131], v[114:115]
    v_cvt_pk_bf16_f32 v23, v130, v131
    v_lshlrev_b32 v130, 16, v23
    v_and_b32 v131, 0xffff0000, v23
    v_pk_add_f32 v[130:131], v[130:131], v[98:99]
    v_cvt_pk_bf16_f32 v81, v130, v131
    ds_write_b64 v17, v[80:81] offset:0
    s_waitcnt vmcnt(2)
    v_pk_add_f32 v[132:133], v[132:133], v[68:69]
    v_cvt_pk_bf16_f32 v23, v132, v133
    v_lshlrev_b32 v132, 16, v23
    v_and_b32 v133, 0xffff0000, v23
    v_pk_mul_f32 v[132:133], v[132:133], v[116:117]
    v_cvt_pk_bf16_f32 v23, v132, v133
    v_lshlrev_b32 v132, 16, v23
    v_and_b32 v133, 0xffff0000, v23
    v_pk_add_f32 v[132:133], v[132:133], v[100:101]
    v_cvt_pk_bf16_f32 v82, v132, v133
    v_pk_add_f32 v[134:135], v[134:135], v[70:71]
    v_cvt_pk_bf16_f32 v23, v134, v135
    v_lshlrev_b32 v134, 16, v23
    v_and_b32 v135, 0xffff0000, v23
    v_pk_mul_f32 v[134:135], v[134:135], v[118:119]
    v_cvt_pk_bf16_f32 v23, v134, v135
    v_lshlrev_b32 v134, 16, v23
    v_and_b32 v135, 0xffff0000, v23
    v_pk_add_f32 v[134:135], v[134:135], v[102:103]
    v_cvt_pk_bf16_f32 v83, v134, v135
    ds_write_b64 v17, v[82:83] offset:32
    s_waitcnt vmcnt(1)
    v_pk_add_f32 v[136:137], v[136:137], v[72:73]
    v_cvt_pk_bf16_f32 v23, v136, v137
    v_lshlrev_b32 v136, 16, v23
    v_and_b32 v137, 0xffff0000, v23
    v_pk_mul_f32 v[136:137], v[136:137], v[120:121]
    v_cvt_pk_bf16_f32 v23, v136, v137
    v_lshlrev_b32 v136, 16, v23
    v_and_b32 v137, 0xffff0000, v23
    v_pk_add_f32 v[136:137], v[136:137], v[104:105]
    v_cvt_pk_bf16_f32 v84, v136, v137
    v_pk_add_f32 v[138:139], v[138:139], v[74:75]
    v_cvt_pk_bf16_f32 v23, v138, v139
    v_lshlrev_b32 v138, 16, v23
    v_and_b32 v139, 0xffff0000, v23
    v_pk_mul_f32 v[138:139], v[138:139], v[122:123]
    v_cvt_pk_bf16_f32 v23, v138, v139
    v_lshlrev_b32 v138, 16, v23
    v_and_b32 v139, 0xffff0000, v23
    v_pk_add_f32 v[138:139], v[138:139], v[106:107]
    v_cvt_pk_bf16_f32 v85, v138, v139
    ds_write_b64 v17, v[84:85] offset:64
    s_waitcnt vmcnt(0)
    v_pk_add_f32 v[140:141], v[140:141], v[76:77]
    v_cvt_pk_bf16_f32 v23, v140, v141
    v_lshlrev_b32 v140, 16, v23
    v_and_b32 v141, 0xffff0000, v23
    v_pk_mul_f32 v[140:141], v[140:141], v[124:125]
    v_cvt_pk_bf16_f32 v23, v140, v141
    v_lshlrev_b32 v140, 16, v23
    v_and_b32 v141, 0xffff0000, v23
    v_pk_add_f32 v[140:141], v[140:141], v[108:109]
    v_cvt_pk_bf16_f32 v86, v140, v141
    v_pk_add_f32 v[142:143], v[142:143], v[78:79]
    v_cvt_pk_bf16_f32 v23, v142, v143
    v_lshlrev_b32 v142, 16, v23
    v_and_b32 v143, 0xffff0000, v23
    v_pk_mul_f32 v[142:143], v[142:143], v[126:127]
    v_cvt_pk_bf16_f32 v23, v142, v143
    v_lshlrev_b32 v142, 16, v23
    v_and_b32 v143, 0xffff0000, v23
    v_pk_add_f32 v[142:143], v[142:143], v[110:111]
    v_cvt_pk_bf16_f32 v87, v142, v143
    ds_write_b64 v17, v[86:87] offset:96
    v_add_u32 v22, s42, v22
    s_mov_b32 s36, 16384
    s_waitcnt lgkmcnt(0)
    ds_read_b128 v[64:67], v22
    ds_read_b128 v[68:71], v22 offset:1024
    s_waitcnt lgkmcnt(1)
    buffer_store_dwordx4 v[64:67], v15, s[20:23], 0 offen sc1
    s_waitcnt lgkmcnt(0)
    buffer_store_dwordx4 v[68:71], v15, s[20:23], s36 offen sc1
    s_endpgm
L_recurrent_scan__compressed_kv_cla__moe_arch_mod__prompt_kernel_rare_143:
    v_mov_b32 v26, s40
    v_mov_b32 v28, 1
    v_writelane_b32 v26, s41, 1
    s_mov_b64 exec, 3
    global_atomic_add v26, v28, s[90:91]
    s_mov_b64 exec, -1
    s_branch L_recurrent_scan__compressed_kv_cla__moe_arch_mod__prompt_kernel_back_144
L_recurrent_scan__compressed_kv_cla__moe_arch_mod__prompt_kernel_rt1_rare_3:
    s_mov_b32 s61, 0x40000
L_recurrent_scan__compressed_kv_cla__moe_arch_mod__prompt_kernel_rt1_spin_1:
    s_sub_u32 s61, s61, 1
    s_cbranch_scc1 L_recurrent_scan__compressed_kv_cla__moe_arch_mod__prompt_kernel_rt1_spinx_2
    s_sleep 1
    global_load_dword v61, v60, s[90:91] sc1
    s_waitcnt vmcnt(0)
    v_readfirstlane_b32 s36, v61
    s_nop 0
    s_cmp_lt_u32 s36, 16
    s_cbranch_scc1 L_recurrent_scan__compressed_kv_cla__moe_arch_mod__prompt_kernel_rt1_spin_1
L_recurrent_scan__compressed_kv_cla__moe_arch_mod__prompt_kernel_rt1_spinx_2:
    s_branch L_recurrent_scan__compressed_kv_cla__moe_arch_mod__prompt_kernel_rt1_back_4
L_recurrent_scan__compressed_kv_cla__moe_arch_mod__prompt_kernel_rare_153:
    s_cmp_eq_u32 s35, 1
    s_cbranch_scc0 L_recurrent_scan__compressed_kv_cla__moe_arch_mod__prompt_kernel_swn_152
    s_cmp_eq_u32 s28, 0
    s_cbranch_scc0 L_recurrent_scan__compressed_kv_cla__moe_arch_mod__prompt_kernel_g_146
    s_and_b32 s36, s2, 15
    s_add_u32 s36, s36, 96
    s_lshl_b32 s36, s36, 7
    v_mov_b32 v26, s36
    v_mov_b32 v27, 1
    s_mov_b64 exec, 1
    global_atomic_add v26, v27, s[90:91]
    s_mov_b64 exec, -1
    s_nop 3
L_recurrent_scan__compressed_kv_cla__moe_arch_mod__prompt_kernel_g_146:
    s_branch L_recurrent_scan__compressed_kv_cla__moe_arch_mod__prompt_kernel_swend_151
L_recurrent_scan__compressed_kv_cla__moe_arch_mod__prompt_kernel_swn_152:
    s_sub_u32 s36, s56, s38
    s_sub_u32 s37, s57, s38
    s_min_u32 s36, s36, s37
    s_cmp_lt_u32 s36, 16
    s_cbranch_scc0 L_recurrent_scan__compressed_kv_cla__moe_arch_mod__prompt_kernel_nrt_147
    s_add_u32 s36, s30, 96
    s_lshl_b32 s36, s36, 7
    v_mov_b32 v60, s36
    global_load_dword v61, v60, s[90:91] sc1
L_recurrent_scan__compressed_kv_cla__moe_arch_mod__prompt_kernel_nrt_147:
    s_mov_b32 m0, s42
    s_mov_b32 s36, 15360
    buffer_load_dwordx4 v15, s[16:19], 0 offen lds
    buffer_load_dwordx4 v15, s[16:19], s36 offen offset:1024 lds
    s_mov_b32 s36, 4194304
    buffer_load_dwordx2 v[48:49], v16, s[24:27], s36 offen sc1
L_recurrent_scan__compressed_kv_cla__moe_arch_mod__prompt_kernel_swend_151:
    s_branch L_recurrent_scan__compressed_kv_cla__moe_arch_mod__prompt_kernel_back_154
L_recurrent_scan__compressed_kv_cla__moe_arch_mod__prompt_kernel_rare_156:
    s_cmp_eq_u32 s28, 0
    s_cbranch_scc0 L_recurrent_scan__compressed_kv_cla__moe_arch_mod__prompt_kernel_g_150
    s_mov_b32 s43, s38
    s_getpc_b64 s[36:37]
L_recurrent_scan__compressed_kv_cla__moe_arch_mod__prompt_kernel_pc_149:
    s_sub_u32 s36, s36, L_recurrent_scan__compressed_kv_cla__moe_arch_mod__prompt_kernel_pc_149-L_pc
    s_subb_u32 s37, s37, 0
    s_lshr_b32 s38, s2, 3
    s_lshl_b32 s38, s38, 7
    v_lshl_add_u32 v4, v1, 12, s38
    v_min_u32 v4, L_end-L_pc-4, v4
    v_mov_b32 v5, s37
    v_add_co_u32 v4, vcc, s36, v4
    s_mov_b64 exec, 0xffff
    s_nop 0
    v_addc_co_u32 v5, vcc, 0, v5, vcc
    global_load_dword v63, v[4:5], off
    s_mov_b64 exec, -1
    s_nop 1
    s_mov_b32 s38, s43
L_recurrent_scan__compressed_kv_cla__moe_arch_mod__prompt_kernel_g_150:
    s_sub_u32 s36, s56, s38
    s_sub_u32 s37, s57, s38
    s_min_u32 s36, s36, s37
    s_cmp_lt_u32 s36, 16
    s_cbranch_scc0 L_recurrent_scan__compressed_kv_cla__moe_arch_mod__prompt_kernel_nrt_148
    s_waitcnt vmcnt(16)
    v_readfirstlane_b32 s36, v61
    s_nop 0
    s_cmp_lt_u32 s36, 16
    s_cbranch_scc1 L_recurrent_scan__compressed_kv_cla__moe_arch_mod__prompt_kernel_rt1_rare_3
L_recurrent_scan__compressed_kv_cla__moe_arch_mod__prompt_kernel_rt1_back_4:
    s_lshl_b32 s37, s30, 8
    s_add_u32 s36, s37, 59768832
    s_add_u32 s37, s36, 4096
    v_and_b32 v60, 15, v1
    v_lshlrev_b32 v60, 13, v60
    v_lshl_add_u32 v60, v19, 4, v60
    buffer_load_dwordx4 v[96:99], v60, s[24:27], s36 offen offset:0 sc1
    buffer_load_dwordx4 v[100:103], v60, s[24:27], s36 offen offset:64 sc1
    buffer_load_dwordx4 v[104:107], v60, s[24:27], s36 offen offset:128 sc1
    buffer_load_dwordx4 v[108:111], v60, s[24:27], s36 offen offset:192 sc1
    buffer_load_dwordx4 v[112:115], v60, s[24:27], s37 offen offset:0 sc1
    buffer_load_dwordx4 v[116:119], v60, s[24:27], s37 offen offset:64 sc1
    buffer_load_dwordx4 v[120:123], v60, s[24:27], s37 offen offset:128 sc1
    buffer_load_dwordx4 v[124:127], v60, s[24:27], s37 offen offset:192 sc1
L_recurrent_scan__compressed_kv_cla__moe_arch_mod__prompt_kernel_nrt_148:
L_recurrent_scan__compressed_kv_cla__moe_arch_mod__prompt_kernel_swend_155:
    s_branch L_recurrent_scan__compressed_kv_cla__moe_arch_mod__prompt_kernel_back_157
L_recurrent_scan__compressed_kv_cla__moe_arch_mod__prompt_kernel_rare_158:
    global_load_dword v59, v58, s[90:91] sc1
    s_branch L_recurrent_scan__compressed_kv_cla__moe_arch_mod__prompt_kernel_back_159
L_recurrent_scan__compressed_kv_cla__moe_arch_mod__prompt_kernel_rare_168:
    s_cmp_eq_u32 s35, 0
    s_cbranch_scc0 L_recurrent_scan__compressed_kv_cla__moe_arch_mod__prompt_kernel_swn_167
    s_mov_b32 s61, 0x40000
    s_waitcnt vmcnt(8)
    s_branch L_recurrent_scan__compressed_kv_cla__moe_arch_mod__prompt_kernel_cchk_162
L_recurrent_scan__compressed_kv_cla__moe_arch_mod__prompt_kernel_cspin_160:
    s_sub_u32 s61, s61, 1
    s_cbranch_scc1 L_recurrent_scan__compressed_kv_cla__moe_arch_mod__prompt_kernel_cspinx_161
    global_load_dword v59, v58, s[90:91] sc1
    s_waitcnt vmcnt(0)
L_recurrent_scan__compressed_kv_cla__moe_arch_mod__prompt_kernel_cchk_162:
    v_cmp_le_u32 vcc, 4, v59
    s_nop 0
    s_and_b32 s60, vcc_lo, 15
    s_and_b32 s36, s60, 7
    s_cmp_eq_u32 s36, 7
    s_cbranch_scc1 L_recurrent_scan__compressed_kv_cla__moe_arch_mod__prompt_kernel_cspinx_161
    s_sleep 6
    s_branch L_recurrent_scan__compressed_kv_cla__moe_arch_mod__prompt_kernel_cspin_160
L_recurrent_scan__compressed_kv_cla__moe_arch_mod__prompt_kernel_cspinx_161:
    s_branch L_recurrent_scan__compressed_kv_cla__moe_arch_mod__prompt_kernel_swend_166
L_recurrent_scan__compressed_kv_cla__moe_arch_mod__prompt_kernel_swn_167:
    s_mov_b32 s61, 0x40000
    s_waitcnt vmcnt(8)
    s_branch L_recurrent_scan__compressed_kv_cla__moe_arch_mod__prompt_kernel_cchk_165
L_recurrent_scan__compressed_kv_cla__moe_arch_mod__prompt_kernel_cspin_163:
    s_sub_u32 s61, s61, 1
    s_cbranch_scc1 L_recurrent_scan__compressed_kv_cla__moe_arch_mod__prompt_kernel_cspinx_164
    global_load_dword v59, v58, s[90:91] sc1
    s_waitcnt vmcnt(0)
L_recurrent_scan__compressed_kv_cla__moe_arch_mod__prompt_kernel_cchk_165:
    v_cmp_le_u32 vcc, 4, v59
    s_nop 0
    s_and_b32 s60, vcc_lo, 15
    s_and_b32 s36, s60, 15
    s_cmp_eq_u32 s36, 15
    s_cbranch_scc1 L_recurrent_scan__compressed_kv_cla__moe_arch_mod__prompt_kernel_cspinx_164
    s_sleep 6
    s_branch L_recurrent_scan__compressed_kv_cla__moe_arch_mod__prompt_kernel_cspin_163
L_recurrent_scan__compressed_kv_cla__moe_arch_mod__prompt_kernel_cspinx_164:
L_recurrent_scan__compressed_kv_cla__moe_arch_mod__prompt_kernel_swend_166:
    s_branch L_recurrent_scan__compressed_kv_cla__moe_arch_mod__prompt_kernel_back_169
L_recurrent_scan__compressed_kv_cla__moe_arch_mod__prompt_kernel_f2m_170:
    v_lshrrev_b32 v28, 4, v1
    v_bfe_u32 v26, v1, 2, 2
    v_lshl_add_u32 v26, v28, 3, v26
    v_lshlrev_b32 v26, 7, v26
    v_and_b32 v27, 3, v1
    v_lshl_add_u32 v26, v27, 3, v26
    v_bfe_u32 v27, v1, 3, 2
    s_lshl_b32 s36, s28, 12
    s_add_u32 s36, s36, 131072
    v_add_u32 v26, s36, v26
    v_xor_b32 v28, 0, v27
    v_lshl_add_u32 v28, v28, 5, v26
    ds_read_b64_tr_b16 v[112:113], v28 offset:0
    ds_read_b64_tr_b16 v[114:115], v28 offset:512
    v_xor_b32 v28, 1, v27
    v_lshl_add_u32 v28, v28, 5, v26
    ds_read_b64_tr_b16 v[116:117], v28 offset:0
    ds_read_b64_tr_b16 v[118:119], v28 offset:512
    v_xor_b32 v28, 2, v27
    v_lshl_add_u32 v28, v28, 5, v26
    ds_read_b64_tr_b16 v[120:121], v28 offset:0
    ds_read_b64_tr_b16 v[122:123], v28 offset:512
    v_xor_b32 v28, 3, v27
    v_lshl_add_u32 v28, v28, 5, v26
    ds_read_b64_tr_b16 v[124:125], v28 offset:0
    ds_read_b64_tr_b16 v[126:127], v28 offset:512
    v_add_f32_dpp v96, v96, v96 row_ror:4 row_mask:0xf bank_mask:0xf
    v_add_f32_dpp v97, v97, v97 row_ror:4 row_mask:0xf bank_mask:0xf
    v_add_f32_dpp v98, v98, v98 row_ror:4 row_mask:0xf bank_mask:0xf
    v_add_f32_dpp v99, v99, v99 row_ror:4 row_mask:0xf bank_mask:0xf
    v_add_f32_dpp v100, v100, v100 row_ror:4 row_mask:0xf bank_mask:0xf
    v_add_f32_dpp v101, v101, v101 row_ror:4 row_mask:0xf bank_mask:0xf
    v_add_f32_dpp v102, v102, v102 row_ror:4 row_mask:0xf bank_mask:0xf
    v_add_f32_dpp v103, v103, v103 row_ror:4 row_mask:0xf bank_mask:0xf
    v_add_f32_dpp v96, v96, v96 row_ror:8 row_mask:0xf bank_mask:0xf
    v_add_f32_dpp v97, v97, v97 row_ror:8 row_mask:0xf bank_mask:0xf
    v_add_f32_dpp v98, v98, v98 row_ror:8 row_mask:0xf bank_mask:0xf
    v_add_f32_dpp v99, v99, v99 row_ror:8 row_mask:0xf bank_mask:0xf
    v_add_f32_dpp v100, v100, v100 row_ror:8 row_mask:0xf bank_mask:0xf
    v_add_f32_dpp v101, v101, v101 row_ror:8 row_mask:0xf bank_mask:0xf
    v_add_f32_dpp v102, v102, v102 row_ror:8 row_mask:0xf bank_mask:0xf
    v_add_f32_dpp v103, v103, v103 row_ror:8 row_mask:0xf bank_mask:0xf
    v_cvt_pk_bf16_f32 v29, v96, v97
    v_lshlrev_b32 v96, 16, v29
    v_and_b32 v97, 0xffff0000, v29
    v_cvt_pk_bf16_f32 v29, v98, v99
    v_lshlrev_b32 v98, 16, v29
    v_and_b32 v99, 0xffff0000, v29
    v_cvt_pk_bf16_f32 v29, v100, v101
    v_lshlrev_b32 v100, 16, v29
    v_and_b32 v101, 0xffff0000, v29
    v_cvt_pk_bf16_f32 v29, v102, v103
    v_lshlrev_b32 v102, 16, v29
    v_and_b32 v103, 0xffff0000, v29
    v_mul_f32 v104, 0xbfb8aa3b, v96
    v_mul_f32 v105, 0xbfb8aa3b, v97
    v_mul_f32 v106, 0xbfb8aa3b, v98
    v_mul_f32 v107, 0xbfb8aa3b, v99
    v_mul_f32 v108, 0xbfb8aa3b, v100
    v_mul_f32 v109, 0xbfb8aa3b, v101
    v_mul_f32 v110, 0xbfb8aa3b, v102
    v_mul_f32 v111, 0xbfb8aa3b, v103
    v_exp_f32 v104, v104
    v_exp_f32 v105, v105
    v_exp_f32 v106, v106
    v_exp_f32 v107, v107
    v_exp_f32 v108, v108
    v_exp_f32 v109, v109
    v_exp_f32 v110, v110
    v_exp_f32 v111, v111
    v_add_f32 v104, 1.0, v104
    v_add_f32 v105, 1.0, v105
    v_add_f32 v106, 1.0, v106
    v_add_f32 v107, 1.0, v107
    v_add_f32 v108, 1.0, v108
    v_add_f32 v109, 1.0, v109
    v_add_f32 v110, 1.0, v110
    v_add_f32 v111, 1.0, v111
    v_rcp_f32 v104, v104
    v_rcp_f32 v105, v105
    v_rcp_f32 v106, v106
    v_rcp_f32 v107, v107
    v_rcp_f32 v108, v108
    v_rcp_f32 v109, v109
    v_rcp_f32 v110, v110
    v_rcp_f32 v111, v111
    v_mul_f32 v104, v96, v104
    v_mul_f32 v105, v97, v105
    v_mul_f32 v106, v98, v106
    v_mul_f32 v107, v99, v107
    v_mul_f32 v108, v100, v108
    v_mul_f32 v109, v101, v109
    v_mul_f32 v110, v102, v110
    v_mul_f32 v111, v103, v111
    v_cvt_pk_bf16_f32 v29, v104, v105
    v_lshlrev_b32 v104, 16, v29
    v_and_b32 v105, 0xffff0000, v29
    v_cvt_pk_bf16_f32 v29, v106, v107
    v_lshlrev_b32 v106, 16, v29
    v_and_b32 v107, 0xffff0000, v29
    v_cvt_pk_bf16_f32 v29, v108, v109
    v_lshlrev_b32 v108, 16, v29
    v_and_b32 v109, 0xffff0000, v29
    v_cvt_pk_bf16_f32 v29, v110, v111
    v_lshlrev_b32 v110, 16, v29
    v_and_b32 v111, 0xffff0000, v29
    v_mul_f32_dpp v96, v96, v104 quad_perm:[2,3,0,1] row_mask:0xf bank_mask:0xf
    v_mul_f32_dpp v97, v97, v105 quad_perm:[2,3,0,1] row_mask:0xf bank_mask:0xf
    v_mul_f32_dpp v98, v98, v106 quad_perm:[2,3,0,1] row_mask:0xf bank_mask:0xf
    v_mul_f32_dpp v99, v99, v107 quad_perm:[2,3,0,1] row_mask:0xf bank_mask:0xf
    v_mul_f32_dpp v100, v100, v108 quad_perm:[2,3,0,1] row_mask:0xf bank_mask:0xf
    v_mul_f32_dpp v101, v101, v109 quad_perm:[2,3,0,1] row_mask:0xf bank_mask:0xf
    v_mul_f32_dpp v102, v102, v110 quad_perm:[2,3,0,1] row_mask:0xf bank_mask:0xf
    v_mul_f32_dpp v103, v103, v111 quad_perm:[2,3,0,1] row_mask:0xf bank_mask:0xf
    v_cvt_pk_bf16_f32 v36, v96, v97
    v_cvt_pk_bf16_f32 v37, v98, v99
    v_cvt_pk_bf16_f32 v38, v100, v101
    v_cvt_pk_bf16_f32 v39, v102, v103
    s_waitcnt lgkmcnt(0)
    v_lshl_add_u32 v28, v1, 4, s36
    v_mfma_f32_16x16x32_bf16 v[96:99], v[112:115], v[36:39], 0
    v_mfma_f32_16x16x32_bf16 v[100:103], v[116:119], v[36:39], 0
    v_mfma_f32_16x16x32_bf16 v[104:107], v[120:123], v[36:39], 0
    v_mfma_f32_16x16x32_bf16 v[108:111], v[124:127], v[36:39], 0
    s_nop 7
    ds_write_b128 v28, v[96:99] offset:0
    ds_write_b128 v28, v[100:103] offset:1024
    ds_write_b128 v28, v[104:107] offset:2048
    ds_write_b128 v28, v[108:111] offset:3072
    s_cmp_lt_u32 s28, 4
    s_cbranch_scc1 L_recurrent_scan__compressed_kv_cla__moe_arch_mod__prompt_kernel_f2b_172
    s_branch L_recurrent_scan__compressed_kv_cla__moe_arch_mod__prompt_kernel_f2a_171
L_recurrent_scan__compressed_kv_cla__moe_arch_mod__prompt_kernel_rare_177:
    v_mov_b64 v[24:25], 0
    v_mov_b64 v[26:27], 0
    v_mov_b64 v[28:29], 0
    v_mov_b64 v[30:31], 0
    v_mov_b64 v[32:33], 0
    v_mov_b64 v[34:35], 0
    v_mov_b64 v[36:37], 0
    v_mov_b64 v[38:39], 0
    s_waitcnt vmcnt(16)
    s_sub_u32 s36, s56, s38
    s_cmp_lt_u32 s36, 16
    s_cbranch_scc0 L_recurrent_scan__compressed_kv_cla__moe_arch_mod__prompt_kernel_rt2_noy_1
    s_and_b32 s36, s58, 0xffff0000
    s_cmp_lt_i32 s36, 0
    s_cselect_b32 s37, 0x80000000, -1
    s_xor_b32 s36, s36, s37
    s_and_b32 s36, s36, 0xffff0000
    v_mov_b32 v62, s36
    v_mul_f32 v62, 0xbfb8aa3b, v62
    v_exp_f32 v62, v62
    s_nop 0
    v_add_f32 v62, 1.0, v62
    v_rcp_f32 v62, v62
    s_nop 0
    v_cvt_pk_bf16_f32 v62, v62, v62
    v_lshlrev_b32 v62, 16, v62
    v_add_f32_dpp v96, v96, v96 quad_perm:[1,0,3,2] row_mask:0xf bank_mask:0xf
    v_add_f32_dpp v97, v97, v97 quad_perm:[1,0,3,2] row_mask:0xf bank_mask:0xf
    v_add_f32_dpp v98, v98, v98 quad_perm:[1,0,3,2] row_mask:0xf bank_mask:0xf
    v_add_f32_dpp v99, v99, v99 quad_perm:[1,0,3,2] row_mask:0xf bank_mask:0xf
    v_add_f32_dpp v100, v100, v100 quad_perm:[1,0,3,2] row_mask:0xf bank_mask:0xf
    v_add_f32_dpp v101, v101, v101 quad_perm:[1,0,3,2] row_mask:0xf bank_mask:0xf
    v_add_f32_dpp v102, v102, v102 quad_perm:[1,0,3,2] row_mask:0xf bank_mask:0xf
    v_add_f32_dpp v103, v103, v103 quad_perm:[1,0,3,2] row_mask:0xf bank_mask:0xf
    v_add_f32_dpp v104, v104, v104 quad_perm:[1,0,3,2] row_mask:0xf bank_mask:0xf
    v_add_f32_dpp v105, v105, v105 quad_perm:[1,0,3,2] row_mask:0xf bank_mask:0xf
    v_add_f32_dpp v106, v106, v106 quad_perm:[1,0,3,2] row_mask:0xf bank_mask:0xf
    v_add_f32_dpp v107, v107, v107 quad_perm:[1,0,3,2] row_mask:0xf bank_mask:0xf
    v_add_f32_dpp v108, v108, v108 quad_perm:[1,0,3,2] row_mask:0xf bank_mask:0xf
    v_add_f32_dpp v109, v109, v109 quad_perm:[1,0,3,2] row_mask:0xf bank_mask:0xf
    v_add_f32_dpp v110, v110, v110 quad_perm:[1,0,3,2] row_mask:0xf bank_mask:0xf
    v_add_f32_dpp v111, v111, v111 quad_perm:[1,0,3,2] row_mask:0xf bank_mask:0xf
    v_add_f32_dpp v96, v96, v96 quad_perm:[2,3,0,1] row_mask:0xf bank_mask:0xf
    v_add_f32_dpp v97, v97, v97 quad_perm:[2,3,0,1] row_mask:0xf bank_mask:0xf
    v_add_f32_dpp v98, v98, v98 quad_perm:[2,3,0,1] row_mask:0xf bank_mask:0xf
    v_add_f32_dpp v99, v99, v99 quad_perm:[2,3,0,1] row_mask:0xf bank_mask:0xf
    v_add_f32_dpp v100, v100, v100 quad_perm:[2,3,0,1] row_mask:0xf bank_mask:0xf
    v_add_f32_dpp v101, v101, v101 quad_perm:[2,3,0,1] row_mask:0xf bank_mask:0xf
    v_add_f32_dpp v102, v102, v102 quad_perm:[2,3,0,1] row_mask:0xf bank_mask:0xf
    v_add_f32_dpp v103, v103, v103 quad_perm:[2,3,0,1] row_mask:0xf bank_mask:0xf
    v_add_f32_dpp v104, v104, v104 quad_perm:[2,3,0,1] row_mask:0xf bank_mask:0xf
    v_add_f32_dpp v105, v105, v105 quad_perm:[2,3,0,1] row_mask:0xf bank_mask:0xf
    v_add_f32_dpp v106, v106, v106 quad_perm:[2,3,0,1] row_mask:0xf bank_mask:0xf
    v_add_f32_dpp v107, v107, v107 quad_perm:[2,3,0,1] row_mask:0xf bank_mask:0xf
    v_add_f32_dpp v108, v108, v108 quad_perm:[2,3,0,1] row_mask:0xf bank_mask:0xf
    v_add_f32_dpp v109, v109, v109 quad_perm:[2,3,0,1] row_mask:0xf bank_mask:0xf
    v_add_f32_dpp v110, v110, v110 quad_perm:[2,3,0,1] row_mask:0xf bank_mask:0xf
    v_add_f32_dpp v111, v111, v111 quad_perm:[2,3,0,1] row_mask:0xf bank_mask:0xf
    v_add_f32_dpp v96, v96, v96 row_half_mirror row_mask:0xf bank_mask:0xf
    v_add_f32_dpp v97, v97, v97 row_half_mirror row_mask:0xf bank_mask:0xf
    v_add_f32_dpp v98, v98, v98 row_half_mirror row_mask:0xf bank_mask:0xf
    v_add_f32_dpp v99, v99, v99 row_half_mirror row_mask:0xf bank_mask:0xf
    v_add_f32_dpp v100, v100, v100 row_half_mirror row_mask:0xf bank_mask:0xf
    v_add_f32_dpp v101, v101, v101 row_half_mirror row_mask:0xf bank_mask:0xf
    v_add_f32_dpp v102, v102, v102 row_half_mirror row_mask:0xf bank_mask:0xf
    v_add_f32_dpp v103, v103, v103 row_half_mirror row_mask:0xf bank_mask:0xf
    v_add_f32_dpp v104, v104, v104 row_half_mirror row_mask:0xf bank_mask:0xf
    v_add_f32_dpp v105, v105, v105 row_half_mirror row_mask:0xf bank_mask:0xf
    v_add_f32_dpp v106, v106, v106 row_half_mirror row_mask:0xf bank_mask:0xf
    v_add_f32_dpp v107, v107, v107 row_half_mirror row_mask:0xf bank_mask:0xf
    v_add_f32_dpp v108, v108, v108 row_half_mirror row_mask:0xf bank_mask:0xf
    v_add_f32_dpp v109, v109, v109 row_half_mirror row_mask:0xf bank_mask:0xf
    v_add_f32_dpp v110, v110, v110 row_half_mirror row_mask:0xf bank_mask:0xf
    v_add_f32_dpp v111, v111, v111 row_half_mirror row_mask:0xf bank_mask:0xf
    v_add_f32_dpp v96, v96, v96 row_mirror row_mask:0xf bank_mask:0xf
    v_add_f32_dpp v97, v97, v97 row_mirror row_mask:0xf bank_mask:0xf
    v_add_f32_dpp v98, v98, v98 row_mirror row_mask:0xf bank_mask:0xf
    v_add_f32_dpp v99, v99, v99 row_mirror row_mask:0xf bank_mask:0xf
    v_add_f32_dpp v100, v100, v100 row_mirror row_mask:0xf bank_mask:0xf
    v_add_f32_dpp v101, v101, v101 row_mirror row_mask:0xf bank_mask:0xf
    v_add_f32_dpp v102, v102, v102 row_mirror row_mask:0xf bank_mask:0xf
    v_add_f32_dpp v103, v103, v103 row_mirror row_mask:0xf bank_mask:0xf
    v_add_f32_dpp v104, v104, v104 row_mirror row_mask:0xf bank_mask:0xf
    v_add_f32_dpp v105, v105, v105 row_mirror row_mask:0xf bank_mask:0xf
    v_add_f32_dpp v106, v106, v106 row_mirror row_mask:0xf bank_mask:0xf
    v_add_f32_dpp v107, v107, v107 row_mirror row_mask:0xf bank_mask:0xf
    v_add_f32_dpp v108, v108, v108 row_mirror row_mask:0xf bank_mask:0xf
    v_add_f32_dpp v109, v109, v109 row_mirror row_mask:0xf bank_mask:0xf
    v_add_f32_dpp v110, v110, v110 row_mirror row_mask:0xf bank_mask:0xf
    v_add_f32_dpp v111, v111, v111 row_mirror row_mask:0xf bank_mask:0xf
    v_cmp_eq_u32 vcc, s56, v14
    v_cvt_pk_bf16_f32 v63, v96, v97
    v_lshlrev_b32 v96, 16, v63
    v_and_b32 v97, 0xffff0000, v63
    v_mul_f32 v96, v62, v96
    v_mul_f32 v97, v62, v97
    v_cvt_pk_bf16_f32 v63, v96, v97
    v_lshlrev_b32 v96, 16, v63
    v_and_b32 v97, 0xffff0000, v63
    v_cndmask_b32 v24, v24, v96, vcc
    v_cndmask_b32 v25, v25, v97, vcc
    v_cvt_pk_bf16_f32 v63, v98, v99
    v_lshlrev_b32 v98, 16, v63
    v_and_b32 v99, 0xffff0000, v63
    v_mul_f32 v98, v62, v98
    v_mul_f32 v99, v62, v99
    v_cvt_pk_bf16_f32 v63, v98, v99
    v_lshlrev_b32 v98, 16, v63
    v_and_b32 v99, 0xffff0000, v63
    v_cndmask_b32 v26, v26, v98, vcc
    v_cndmask_b32 v27, v27, v99, vcc
    v_cvt_pk_bf16_f32 v63, v100, v101
    v_lshlrev_b32 v100, 16, v63
    v_and_b32 v101, 0xffff0000, v63
    v_mul_f32 v100, v62, v100
    v_mul_f32 v101, v62, v101
    v_cvt_pk_bf16_f32 v63, v100, v101
    v_lshlrev_b32 v100, 16, v63
    v_and_b32 v101, 0xffff0000, v63
    v_cndmask_b32 v28, v28, v100, vcc
    v_cndmask_b32 v29, v29, v101, vcc
    v_cvt_pk_bf16_f32 v63, v102, v103
    v_lshlrev_b32 v102, 16, v63
    v_and_b32 v103, 0xffff0000, v63
    v_mul_f32 v102, v62, v102
    v_mul_f32 v103, v62, v103
    v_cvt_pk_bf16_f32 v63, v102, v103
    v_lshlrev_b32 v102, 16, v63
    v_and_b32 v103, 0xffff0000, v63
    v_cndmask_b32 v30, v30, v102, vcc
    v_cndmask_b32 v31, v31, v103, vcc
    v_cvt_pk_bf16_f32 v63, v104, v105
    v_lshlrev_b32 v104, 16, v63
    v_and_b32 v105, 0xffff0000, v63
    v_mul_f32 v104, v62, v104
    v_mul_f32 v105, v62, v105
    v_cvt_pk_bf16_f32 v63, v104, v105
    v_lshlrev_b32 v104, 16, v63
    v_and_b32 v105, 0xffff0000, v63
    v_cndmask_b32 v32, v32, v104, vcc
    v_cndmask_b32 v33, v33, v105, vcc
    v_cvt_pk_bf16_f32 v63, v106, v107
    v_lshlrev_b32 v106, 16, v63
    v_and_b32 v107, 0xffff0000, v63
    v_mul_f32 v106, v62, v106
    v_mul_f32 v107, v62, v107
    v_cvt_pk_bf16_f32 v63, v106, v107
    v_lshlrev_b32 v106, 16, v63
    v_and_b32 v107, 0xffff0000, v63
    v_cndmask_b32 v34, v34, v106, vcc
    v_cndmask_b32 v35, v35, v107, vcc
    v_cvt_pk_bf16_f32 v63, v108, v109
    v_lshlrev_b32 v108, 16, v63
    v_and_b32 v109, 0xffff0000, v63
    v_mul_f32 v108, v62, v108
    v_mul_f32 v109, v62, v109
    v_cvt_pk_bf16_f32 v63, v108, v109
    v_lshlrev_b32 v108, 16, v63
    v_and_b32 v109, 0xffff0000, v63
    v_cndmask_b32 v36, v36, v108, vcc
    v_cndmask_b32 v37, v37, v109, vcc
    v_cvt_pk_bf16_f32 v63, v110, v111
    v_lshlrev_b32 v110, 16, v63
    v_and_b32 v111, 0xffff0000, v63
    v_mul_f32 v110, v62, v110
    v_mul_f32 v111, v62, v111
    v_cvt_pk_bf16_f32 v63, v110, v111
    v_lshlrev_b32 v110, 16, v63
    v_and_b32 v111, 0xffff0000, v63
    v_cndmask_b32 v38, v38, v110, vcc
    v_cndmask_b32 v39, v39, v111, vcc
L_recurrent_scan__compressed_kv_cla__moe_arch_mod__prompt_kernel_rt2_noy_1:
    s_sub_u32 s36, s57, s38
    s_cmp_lt_u32 s36, 16
    s_cbranch_scc0 L_recurrent_scan__compressed_kv_cla__moe_arch_mod__prompt_kernel_rt2_noy_2
    s_and_b32 s36, s59, 0xffff0000
    s_cmp_lt_i32 s36, 0
    s_cselect_b32 s37, 0x80000000, -1
    s_xor_b32 s36, s36, s37
    s_and_b32 s36, s36, 0xffff0000
    v_mov_b32 v62, s36
    v_mul_f32 v62, 0xbfb8aa3b, v62
    v_exp_f32 v62, v62
    s_nop 0
    v_add_f32 v62, 1.0, v62
    v_rcp_f32 v62, v62
    s_nop 0
    v_cvt_pk_bf16_f32 v62, v62, v62
    v_lshlrev_b32 v62, 16, v62
    v_add_f32_dpp v112, v112, v112 quad_perm:[1,0,3,2] row_mask:0xf bank_mask:0xf
    v_add_f32_dpp v113, v113, v113 quad_perm:[1,0,3,2] row_mask:0xf bank_mask:0xf
    v_add_f32_dpp v114, v114, v114 quad_perm:[1,0,3,2] row_mask:0xf bank_mask:0xf
    v_add_f32_dpp v115, v115, v115 quad_perm:[1,0,3,2] row_mask:0xf bank_mask:0xf
    v_add_f32_dpp v116, v116, v116 quad_perm:[1,0,3,2] row_mask:0xf bank_mask:0xf
    v_add_f32_dpp v117, v117, v117 quad_perm:[1,0,3,2] row_mask:0xf bank_mask:0xf
    v_add_f32_dpp v118, v118, v118 quad_perm:[1,0,3,2] row_mask:0xf bank_mask:0xf
    v_add_f32_dpp v119, v119, v119 quad_perm:[1,0,3,2] row_mask:0xf bank_mask:0xf
    v_add_f32_dpp v120, v120, v120 quad_perm:[1,0,3,2] row_mask:0xf bank_mask:0xf
    v_add_f32_dpp v121, v121, v121 quad_perm:[1,0,3,2] row_mask:0xf bank_mask:0xf
    v_add_f32_dpp v122, v122, v122 quad_perm:[1,0,3,2] row_mask:0xf bank_mask:0xf
    v_add_f32_dpp v123, v123, v123 quad_perm:[1,0,3,2] row_mask:0xf bank_mask:0xf
    v_add_f32_dpp v124, v124, v124 quad_perm:[1,0,3,2] row_mask:0xf bank_mask:0xf
    v_add_f32_dpp v125, v125, v125 quad_perm:[1,0,3,2] row_mask:0xf bank_mask:0xf
    v_add_f32_dpp v126, v126, v126 quad_perm:[1,0,3,2] row_mask:0xf bank_mask:0xf
    v_add_f32_dpp v127, v127, v127 quad_perm:[1,0,3,2] row_mask:0xf bank_mask:0xf
    v_add_f32_dpp v112, v112, v112 quad_perm:[2,3,0,1] row_mask:0xf bank_mask:0xf
    v_add_f32_dpp v113, v113, v113 quad_perm:[2,3,0,1] row_mask:0xf bank_mask:0xf
    v_add_f32_dpp v114, v114, v114 quad_perm:[2,3,0,1] row_mask:0xf bank_mask:0xf
    v_add_f32_dpp v115, v115, v115 quad_perm:[2,3,0,1] row_mask:0xf bank_mask:0xf
    v_add_f32_dpp v116, v116, v116 quad_perm:[2,3,0,1] row_mask:0xf bank_mask:0xf
    v_add_f32_dpp v117, v117, v117 quad_perm:[2,3,0,1] row_mask:0xf bank_mask:0xf
    v_add_f32_dpp v118, v118, v118 quad_perm:[2,3,0,1] row_mask:0xf bank_mask:0xf
    v_add_f32_dpp v119, v119, v119 quad_perm:[2,3,0,1] row_mask:0xf bank_mask:0xf
    v_add_f32_dpp v120, v120, v120 quad_perm:[2,3,0,1] row_mask:0xf bank_mask:0xf
    v_add_f32_dpp v121, v121, v121 quad_perm:[2,3,0,1] row_mask:0xf bank_mask:0xf
    v_add_f32_dpp v122, v122, v122 quad_perm:[2,3,0,1] row_mask:0xf bank_mask:0xf
    v_add_f32_dpp v123, v123, v123 quad_perm:[2,3,0,1] row_mask:0xf bank_mask:0xf
    v_add_f32_dpp v124, v124, v124 quad_perm:[2,3,0,1] row_mask:0xf bank_mask:0xf
    v_add_f32_dpp v125, v125, v125 quad_perm:[2,3,0,1] row_mask:0xf bank_mask:0xf
    v_add_f32_dpp v126, v126, v126 quad_perm:[2,3,0,1] row_mask:0xf bank_mask:0xf
    v_add_f32_dpp v127, v127, v127 quad_perm:[2,3,0,1] row_mask:0xf bank_mask:0xf
    v_add_f32_dpp v112, v112, v112 row_half_mirror row_mask:0xf bank_mask:0xf
    v_add_f32_dpp v113, v113, v113 row_half_mirror row_mask:0xf bank_mask:0xf
    v_add_f32_dpp v114, v114, v114 row_half_mirror row_mask:0xf bank_mask:0xf
    v_add_f32_dpp v115, v115, v115 row_half_mirror row_mask:0xf bank_mask:0xf
    v_add_f32_dpp v116, v116, v116 row_half_mirror row_mask:0xf bank_mask:0xf
    v_add_f32_dpp v117, v117, v117 row_half_mirror row_mask:0xf bank_mask:0xf
    v_add_f32_dpp v118, v118, v118 row_half_mirror row_mask:0xf bank_mask:0xf
    v_add_f32_dpp v119, v119, v119 row_half_mirror row_mask:0xf bank_mask:0xf
    v_add_f32_dpp v120, v120, v120 row_half_mirror row_mask:0xf bank_mask:0xf
    v_add_f32_dpp v121, v121, v121 row_half_mirror row_mask:0xf bank_mask:0xf
    v_add_f32_dpp v122, v122, v122 row_half_mirror row_mask:0xf bank_mask:0xf
    v_add_f32_dpp v123, v123, v123 row_half_mirror row_mask:0xf bank_mask:0xf
    v_add_f32_dpp v124, v124, v124 row_half_mirror row_mask:0xf bank_mask:0xf
    v_add_f32_dpp v125, v125, v125 row_half_mirror row_mask:0xf bank_mask:0xf
    v_add_f32_dpp v126, v126, v126 row_half_mirror row_mask:0xf bank_mask:0xf
    v_add_f32_dpp v127, v127, v127 row_half_mirror row_mask:0xf bank_mask:0xf
    v_add_f32_dpp v112, v112, v112 row_mirror row_mask:0xf bank_mask:0xf
    v_add_f32_dpp v113, v113, v113 row_mirror row_mask:0xf bank_mask:0xf
    v_add_f32_dpp v114, v114, v114 row_mirror row_mask:0xf bank_mask:0xf
    v_add_f32_dpp v115, v115, v115 row_mirror row_mask:0xf bank_mask:0xf
    v_add_f32_dpp v116, v116, v116 row_mirror row_mask:0xf bank_mask:0xf
    v_add_f32_dpp v117, v117, v117 row_mirror row_mask:0xf bank_mask:0xf
    v_add_f32_dpp v118, v118, v118 row_mirror row_mask:0xf bank_mask:0xf
    v_add_f32_dpp v119, v119, v119 row_mirror row_mask:0xf bank_mask:0xf
    v_add_f32_dpp v120, v120, v120 row_mirror row_mask:0xf bank_mask:0xf
    v_add_f32_dpp v121, v121, v121 row_mirror row_mask:0xf bank_mask:0xf
    v_add_f32_dpp v122, v122, v122 row_mirror row_mask:0xf bank_mask:0xf
    v_add_f32_dpp v123, v123, v123 row_mirror row_mask:0xf bank_mask:0xf
    v_add_f32_dpp v124, v124, v124 row_mirror row_mask:0xf bank_mask:0xf
    v_add_f32_dpp v125, v125, v125 row_mirror row_mask:0xf bank_mask:0xf
    v_add_f32_dpp v126, v126, v126 row_mirror row_mask:0xf bank_mask:0xf
    v_add_f32_dpp v127, v127, v127 row_mirror row_mask:0xf bank_mask:0xf
    v_cmp_eq_u32 vcc, s57, v14
    v_cvt_pk_bf16_f32 v63, v112, v113
    v_lshlrev_b32 v112, 16, v63
    v_and_b32 v113, 0xffff0000, v63
    v_mul_f32 v112, v62, v112
    v_mul_f32 v113, v62, v113
    v_cvt_pk_bf16_f32 v63, v112, v113
    v_lshlrev_b32 v112, 16, v63
    v_and_b32 v113, 0xffff0000, v63
    v_cndmask_b32 v24, v24, v112, vcc
    v_cndmask_b32 v25, v25, v113, vcc
    v_cvt_pk_bf16_f32 v63, v114, v115
    v_lshlrev_b32 v114, 16, v63
    v_and_b32 v115, 0xffff0000, v63
    v_mul_f32 v114, v62, v114
    v_mul_f32 v115, v62, v115
    v_cvt_pk_bf16_f32 v63, v114, v115
    v_lshlrev_b32 v114, 16, v63
    v_and_b32 v115, 0xffff0000, v63
    v_cndmask_b32 v26, v26, v114, vcc
    v_cndmask_b32 v27, v27, v115, vcc
    v_cvt_pk_bf16_f32 v63, v116, v117
    v_lshlrev_b32 v116, 16, v63
    v_and_b32 v117, 0xffff0000, v63
    v_mul_f32 v116, v62, v116
    v_mul_f32 v117, v62, v117
    v_cvt_pk_bf16_f32 v63, v116, v117
    v_lshlrev_b32 v116, 16, v63
    v_and_b32 v117, 0xffff0000, v63
    v_cndmask_b32 v28, v28, v116, vcc
    v_cndmask_b32 v29, v29, v117, vcc
    v_cvt_pk_bf16_f32 v63, v118, v119
    v_lshlrev_b32 v118, 16, v63
    v_and_b32 v119, 0xffff0000, v63
    v_mul_f32 v118, v62, v118
    v_mul_f32 v119, v62, v119
    v_cvt_pk_bf16_f32 v63, v118, v119
    v_lshlrev_b32 v118, 16, v63
    v_and_b32 v119, 0xffff0000, v63
    v_cndmask_b32 v30, v30, v118, vcc
    v_cndmask_b32 v31, v31, v119, vcc
    v_cvt_pk_bf16_f32 v63, v120, v121
    v_lshlrev_b32 v120, 16, v63
    v_and_b32 v121, 0xffff0000, v63
    v_mul_f32 v120, v62, v120
    v_mul_f32 v121, v62, v121
    v_cvt_pk_bf16_f32 v63, v120, v121
    v_lshlrev_b32 v120, 16, v63
    v_and_b32 v121, 0xffff0000, v63
    v_cndmask_b32 v32, v32, v120, vcc
    v_cndmask_b32 v33, v33, v121, vcc
    v_cvt_pk_bf16_f32 v63, v122, v123
    v_lshlrev_b32 v122, 16, v63
    v_and_b32 v123, 0xffff0000, v63
    v_mul_f32 v122, v62, v122
    v_mul_f32 v123, v62, v123
    v_cvt_pk_bf16_f32 v63, v122, v123
    v_lshlrev_b32 v122, 16, v63
    v_and_b32 v123, 0xffff0000, v63
    v_cndmask_b32 v34, v34, v122, vcc
    v_cndmask_b32 v35, v35, v123, vcc
    v_cvt_pk_bf16_f32 v63, v124, v125
    v_lshlrev_b32 v124, 16, v63
    v_and_b32 v125, 0xffff0000, v63
    v_mul_f32 v124, v62, v124
    v_mul_f32 v125, v62, v125
    v_cvt_pk_bf16_f32 v63, v124, v125
    v_lshlrev_b32 v124, 16, v63
    v_and_b32 v125, 0xffff0000, v63
    v_cndmask_b32 v36, v36, v124, vcc
    v_cndmask_b32 v37, v37, v125, vcc
    v_cvt_pk_bf16_f32 v63, v126, v127
    v_lshlrev_b32 v126, 16, v63
    v_and_b32 v127, 0xffff0000, v63
    v_mul_f32 v126, v62, v126
    v_mul_f32 v127, v62, v127
    v_cvt_pk_bf16_f32 v63, v126, v127
    v_lshlrev_b32 v126, 16, v63
    v_and_b32 v127, 0xffff0000, v63
    v_cndmask_b32 v38, v38, v126, vcc
    v_cndmask_b32 v39, v39, v127, vcc
L_recurrent_scan__compressed_kv_cla__moe_arch_mod__prompt_kernel_rt2_noy_2:
    s_branch L_recurrent_scan__compressed_kv_cla__moe_arch_mod__prompt_kernel_back_178
L_recurrent_scan__compressed_kv_cla__moe_arch_mod__prompt_kernel_rare_179:
    v_lshlrev_b32 v96, 16, v40
    v_and_b32 v97, 0xffff0000, v40
    v_sub_f32 v112, v96, v48
    v_sub_f32 v113, v97, v48
    v_cvt_pk_bf16_f32 v10, v112, v113
    v_lshlrev_b32 v112, 16, v10
    v_and_b32 v113, 0xffff0000, v10
    v_mul_f32 v112, v112, v49
    v_mul_f32 v113, v113, v49
    v_cvt_pk_bf16_f32 v10, v112, v113
    v_lshlrev_b32 v112, 16, v10
    v_and_b32 v113, 0xffff0000, v10
    v_add_f32 v112, v112, v24
    v_add_f32 v113, v113, v25
    v_cvt_pk_bf16_f32 v10, v112, v113
    v_lshlrev_b32 v112, 16, v10
    v_and_b32 v113, 0xffff0000, v10
    v_mul_f32 v11, 0xbfb8aa3b, v112
    v_mul_f32 v12, 0xbfb8aa3b, v113
    v_exp_f32 v11, v11
    v_exp_f32 v12, v12
    s_nop 0
    v_add_f32 v11, 1.0, v11
    v_add_f32 v12, 1.0, v12
    v_rcp_f32 v11, v11
    v_rcp_f32 v12, v12
    s_nop 0
    v_mul_f32 v112, v112, v11
    v_mul_f32 v113, v113, v12
    v_cvt_pk_bf16_f32 v10, v112, v113
    v_lshlrev_b32 v112, 16, v10
    v_and_b32 v113, 0xffff0000, v10
    v_lshlrev_b32 v98, 16, v41
    v_and_b32 v99, 0xffff0000, v41
    v_sub_f32 v114, v98, v48
    v_sub_f32 v115, v99, v48
    v_cvt_pk_bf16_f32 v10, v114, v115
    v_lshlrev_b32 v114, 16, v10
    v_and_b32 v115, 0xffff0000, v10
    v_mul_f32 v114, v114, v49
    v_mul_f32 v115, v115, v49
    v_cvt_pk_bf16_f32 v10, v114, v115
    v_lshlrev_b32 v114, 16, v10
    v_and_b32 v115, 0xffff0000, v10
    v_add_f32 v114, v114, v26
    v_add_f32 v115, v115, v27
    v_cvt_pk_bf16_f32 v10, v114, v115
    v_lshlrev_b32 v114, 16, v10
    v_and_b32 v115, 0xffff0000, v10
    v_mul_f32 v11, 0xbfb8aa3b, v114
    v_mul_f32 v12, 0xbfb8aa3b, v115
    v_exp_f32 v11, v11
    v_exp_f32 v12, v12
    s_nop 0
    v_add_f32 v11, 1.0, v11
    v_add_f32 v12, 1.0, v12
    v_rcp_f32 v11, v11
    v_rcp_f32 v12, v12
    s_nop 0
    v_mul_f32 v114, v114, v11
    v_mul_f32 v115, v115, v12
    v_cvt_pk_bf16_f32 v10, v114, v115
    v_lshlrev_b32 v114, 16, v10
    v_and_b32 v115, 0xffff0000, v10
    v_lshlrev_b32 v100, 16, v42
    v_and_b32 v101, 0xffff0000, v42
    v_sub_f32 v116, v100, v48
    v_sub_f32 v117, v101, v48
    v_cvt_pk_bf16_f32 v10, v116, v117
    v_lshlrev_b32 v116, 16, v10
    v_and_b32 v117, 0xffff0000, v10
    v_mul_f32 v116, v116, v49
    v_mul_f32 v117, v117, v49
    v_cvt_pk_bf16_f32 v10, v116, v117
    v_lshlrev_b32 v116, 16, v10
    v_and_b32 v117, 0xffff0000, v10
    v_add_f32 v116, v116, v28
    v_add_f32 v117, v117, v29
    v_cvt_pk_bf16_f32 v10, v116, v117
    v_lshlrev_b32 v116, 16, v10
    v_and_b32 v117, 0xffff0000, v10
    v_mul_f32 v11, 0xbfb8aa3b, v116
    v_mul_f32 v12, 0xbfb8aa3b, v117
    v_exp_f32 v11, v11
    v_exp_f32 v12, v12
    s_nop 0
    v_add_f32 v11, 1.0, v11
    v_add_f32 v12, 1.0, v12
    v_rcp_f32 v11, v11
    v_rcp_f32 v12, v12
    s_nop 0
    v_mul_f32 v116, v116, v11
    v_mul_f32 v117, v117, v12
    v_cvt_pk_bf16_f32 v10, v116, v117
    v_lshlrev_b32 v116, 16, v10
    v_and_b32 v117, 0xffff0000, v10
    v_lshlrev_b32 v102, 16, v43
    v_and_b32 v103, 0xffff0000, v43
    v_sub_f32 v118, v102, v48
    v_sub_f32 v119, v103, v48
    v_cvt_pk_bf16_f32 v10, v118, v119
    v_lshlrev_b32 v118, 16, v10
    v_and_b32 v119, 0xffff0000, v10
    v_mul_f32 v118, v118, v49
    v_mul_f32 v119, v119, v49
    v_cvt_pk_bf16_f32 v10, v118, v119
    v_lshlrev_b32 v118, 16, v10
    v_and_b32 v119, 0xffff0000, v10
    v_add_f32 v118, v118, v30
    v_add_f32 v119, v119, v31
    v_cvt_pk_bf16_f32 v10, v118, v119
    v_lshlrev_b32 v118, 16, v10
    v_and_b32 v119, 0xffff0000, v10
    v_mul_f32 v11, 0xbfb8aa3b, v118
    v_mul_f32 v12, 0xbfb8aa3b, v119
    v_exp_f32 v11, v11
    v_exp_f32 v12, v12
    s_nop 0
    v_add_f32 v11, 1.0, v11
    v_add_f32 v12, 1.0, v12
    v_rcp_f32 v11, v11
    v_rcp_f32 v12, v12
    s_nop 0
    v_mul_f32 v118, v118, v11
    v_mul_f32 v119, v119, v12
    v_cvt_pk_bf16_f32 v10, v118, v119
    v_lshlrev_b32 v118, 16, v10
    v_and_b32 v119, 0xffff0000, v10
    v_lshlrev_b32 v104, 16, v44
    v_and_b32 v105, 0xffff0000, v44
    v_sub_f32 v120, v104, v48
    v_sub_f32 v121, v105, v48
    v_cvt_pk_bf16_f32 v10, v120, v121
    v_lshlrev_b32 v120, 16, v10
    v_and_b32 v121, 0xffff0000, v10
    v_mul_f32 v120, v120, v49
    v_mul_f32 v121, v121, v49
    v_cvt_pk_bf16_f32 v10, v120, v121
    v_lshlrev_b32 v120, 16, v10
    v_and_b32 v121, 0xffff0000, v10
    v_add_f32 v120, v120, v32
    v_add_f32 v121, v121, v33
    v_cvt_pk_bf16_f32 v10, v120, v121
    v_lshlrev_b32 v120, 16, v10
    v_and_b32 v121, 0xffff0000, v10
    v_mul_f32 v11, 0xbfb8aa3b, v120
    v_mul_f32 v12, 0xbfb8aa3b, v121
    v_exp_f32 v11, v11
    v_exp_f32 v12, v12
    s_nop 0
    v_add_f32 v11, 1.0, v11
    v_add_f32 v12, 1.0, v12
    v_rcp_f32 v11, v11
    v_rcp_f32 v12, v12
    s_nop 0
    v_mul_f32 v120, v120, v11
    v_mul_f32 v121, v121, v12
    v_cvt_pk_bf16_f32 v10, v120, v121
    v_lshlrev_b32 v120, 16, v10
    v_and_b32 v121, 0xffff0000, v10
    v_lshlrev_b32 v106, 16, v45
    v_and_b32 v107, 0xffff0000, v45
    v_sub_f32 v122, v106, v48
    v_sub_f32 v123, v107, v48
    v_cvt_pk_bf16_f32 v10, v122, v123
    v_lshlrev_b32 v122, 16, v10
    v_and_b32 v123, 0xffff0000, v10
    v_mul_f32 v122, v122, v49
    v_mul_f32 v123, v123, v49
    v_cvt_pk_bf16_f32 v10, v122, v123
    v_lshlrev_b32 v122, 16, v10
    v_and_b32 v123, 0xffff0000, v10
    v_add_f32 v122, v122, v34
    v_add_f32 v123, v123, v35
    v_cvt_pk_bf16_f32 v10, v122, v123
    v_lshlrev_b32 v122, 16, v10
    v_and_b32 v123, 0xffff0000, v10
    v_mul_f32 v11, 0xbfb8aa3b, v122
    v_mul_f32 v12, 0xbfb8aa3b, v123
    v_exp_f32 v11, v11
    v_exp_f32 v12, v12
    s_nop 0
    v_add_f32 v11, 1.0, v11
    v_add_f32 v12, 1.0, v12
    v_rcp_f32 v11, v11
    v_rcp_f32 v12, v12
    s_nop 0
    v_mul_f32 v122, v122, v11
    v_mul_f32 v123, v123, v12
    v_cvt_pk_bf16_f32 v10, v122, v123
    v_lshlrev_b32 v122, 16, v10
    v_and_b32 v123, 0xffff0000, v10
    v_lshlrev_b32 v108, 16, v46
    v_and_b32 v109, 0xffff0000, v46
    v_sub_f32 v124, v108, v48
    v_sub_f32 v125, v109, v48
    v_cvt_pk_bf16_f32 v10, v124, v125
    v_lshlrev_b32 v124, 16, v10
    v_and_b32 v125, 0xffff0000, v10
    v_mul_f32 v124, v124, v49
    v_mul_f32 v125, v125, v49
    v_cvt_pk_bf16_f32 v10, v124, v125
    v_lshlrev_b32 v124, 16, v10
    v_and_b32 v125, 0xffff0000, v10
    v_add_f32 v124, v124, v36
    v_add_f32 v125, v125, v37
    v_cvt_pk_bf16_f32 v10, v124, v125
    v_lshlrev_b32 v124, 16, v10
    v_and_b32 v125, 0xffff0000, v10
    v_mul_f32 v11, 0xbfb8aa3b, v124
    v_mul_f32 v12, 0xbfb8aa3b, v125
    v_exp_f32 v11, v11
    v_exp_f32 v12, v12
    s_nop 0
    v_add_f32 v11, 1.0, v11
    v_add_f32 v12, 1.0, v12
    v_rcp_f32 v11, v11
    v_rcp_f32 v12, v12
    s_nop 0
    v_mul_f32 v124, v124, v11
    v_mul_f32 v125, v125, v12
    v_cvt_pk_bf16_f32 v10, v124, v125
    v_lshlrev_b32 v124, 16, v10
    v_and_b32 v125, 0xffff0000, v10
    v_lshlrev_b32 v110, 16, v47
    v_and_b32 v111, 0xffff0000, v47
    v_sub_f32 v126, v110, v48
    v_sub_f32 v127, v111, v48
    v_cvt_pk_bf16_f32 v10, v126, v127
    v_lshlrev_b32 v126, 16, v10
    v_and_b32 v127, 0xffff0000, v10
    v_mul_f32 v126, v126, v49
    v_mul_f32 v127, v127, v49
    v_cvt_pk_bf16_f32 v10, v126, v127
    v_lshlrev_b32 v126, 16, v10
    v_and_b32 v127, 0xffff0000, v10
    v_add_f32 v126, v126, v38
    v_add_f32 v127, v127, v39
    v_cvt_pk_bf16_f32 v10, v126, v127
    v_lshlrev_b32 v126, 16, v10
    v_and_b32 v127, 0xffff0000, v10
    v_mul_f32 v11, 0xbfb8aa3b, v126
    v_mul_f32 v12, 0xbfb8aa3b, v127
    v_exp_f32 v11, v11
    v_exp_f32 v12, v12
    s_nop 0
    v_add_f32 v11, 1.0, v11
    v_add_f32 v12, 1.0, v12
    v_rcp_f32 v11, v11
    v_rcp_f32 v12, v12
    s_nop 0
    v_mul_f32 v126, v126, v11
    v_mul_f32 v127, v127, v12
    v_cvt_pk_bf16_f32 v10, v126, v127
    v_lshlrev_b32 v126, 16, v10
    v_and_b32 v127, 0xffff0000, v10
    s_branch L_recurrent_scan__compressed_kv_cla__moe_arch_mod__prompt_kernel_back_180
L_recurrent_scan__compressed_kv_cla__moe_arch_mod__prompt_kernel_rare_183:
    s_mov_b32 s61, 0x40000
L_recurrent_scan__compressed_kv_cla__moe_arch_mod__prompt_kernel_spin_181:
    s_sub_u32 s61, s61, 1
    s_cbranch_scc1 L_recurrent_scan__compressed_kv_cla__moe_arch_mod__prompt_kernel_spinx_182
    s_sleep 1
    global_load_dword v23, v5, s[90:91] sc1
    s_waitcnt vmcnt(0)
    v_readfirstlane_b32 s36, v23
    s_nop 0
    s_cmp_lt_u32 s36, 8
    s_cbranch_scc1 L_recurrent_scan__compressed_kv_cla__moe_arch_mod__prompt_kernel_spin_181
L_recurrent_scan__compressed_kv_cla__moe_arch_mod__prompt_kernel_spinx_182:
    s_branch L_recurrent_scan__compressed_kv_cla__moe_arch_mod__prompt_kernel_back_184
L_end:
    s_endpgm
.section .rodata,"a"
.p2align 6
.amdhsa_kernel recurrent_scan__compressed_kv_cla__moe_arch_mod__prompt_kernel
  .amdhsa_next_free_vgpr 256
  .amdhsa_next_free_sgpr 102
  .amdhsa_accum_offset 256
  .amdhsa_group_segment_fixed_size 0
  .amdhsa_kernarg_size 112
  .amdhsa_user_sgpr_count 2
  .amdhsa_user_sgpr_kernarg_segment_ptr 1
  .amdhsa_system_sgpr_workgroup_id_x 1
.end_amdhsa_kernel
```

```asm
; @launch kernel=recurrent_scan__compressed_kv_cla__moe_arch_mod__prompt_kernel grid=(256,1,1) block=(512,1,1) lds=163840
.amdgcn_target "amdgcn-amd-amdhsa--gfx950"
.text
.globl recurrent_scan__compressed_kv_cla__moe_arch_mod__prompt_kernel
.p2align 8
.type recurrent_scan__compressed_kv_cla__moe_arch_mod__prompt_kernel,@function
recurrent_scan__compressed_kv_cla__moe_arch_mod__prompt_kernel:
    s_cmp_ge_u32 s2, 256
    s_cbranch_scc1 L_end
    s_load_dwordx4 s[44:47], s[0:1], 0
    s_load_dwordx2 s[52:53], s[0:1], 56
    s_load_dwordx4 s[48:51], s[0:1], 24
    s_getpc_b64 s[36:37]
L_pc:
    s_lshr_b32 s38, s2, 3
    s_lshl_b32 s38, s38, 7
    v_lshl_add_u32 v16, v0, 12, s38
    v_cmp_gt_u32 vcc, L_end-L_pc-4, v16
    v_mov_b32 v17, s37
    s_and_b64 exec, exec, vcc
    s_cbranch_execz L_nocpf
    v_add_co_u32 v16, vcc, s36, v16
    s_nop 1
    v_addc_co_u32 v17, vcc, 0, v17, vcc
    global_load_dword v119, v[16:17], off
L_nocpf:
    s_mov_b64 exec, -1
    v_lshrrev_b32 v16, 6, v0
    v_and_b32 v1, 63, v0
    v_readfirstlane_b32 s28, v16
    v_lshlrev_b32 v116, 4, v1
    s_lshl_b32 s42, s2, 3
    s_cmp_lt_u32 s28, 4
    s_cbranch_scc1 L_nox
    s_add_u32 s43, s42, s28
    s_sub_u32 s42, s43, 4
    v_lshl_add_u32 v18, s42, 11, v116
    v_add_u32 v19, 8192, v18
    s_waitcnt lgkmcnt(0)
    global_load_dwordx4 v[20:23], v18, s[44:45]
    global_load_dwordx4 v[24:27], v18, s[44:45] offset:1024
    global_load_dwordx4 v[28:31], v19, s[44:45]
    global_load_dwordx4 v[32:35], v19, s[44:45] offset:1024
    global_load_dwordx4 v[36:39], v116, s[52:53]
    global_load_dwordx4 v[40:43], v116, s[52:53] offset:1024
    s_barrier
L_nox:
    s_load_dwordx4 s[88:91], s[0:1], 96
    s_load_dwordx4 s[92:95], s[0:1], 64
    s_load_dwordx2 s[96:97], s[0:1], 16
    s_and_b32 s29, s2, 7
    s_lshl_b32 s29, s29, 2
    s_lshr_b32 s29, 0x75643120, s29
    s_and_b32 s29, s29, 7
    s_lshl_b32 s29, s29, 2
    s_bfe_u32 s36, s2, 0x20003
    s_add_u32 s29, s29, s36
    s_lshr_b32 s30, s2, 5
    v_lshrrev_b32 v16, 3, v1
    s_lshl_b32 s36, s30, 8
    s_lshl_b32 s37, s28, 5
    s_add_u32 s36, s36, s37
    v_add_u32 v16, s36, v16
    v_lshlrev_b32 v16, 10, v16
    v_lshrrev_b32 v18, 4, v1
    v_and_b32 v19, 7, v1
    v_xor_b32 v19, v19, v18
    v_lshl_add_u32 v2, v19, 4, v16
    v_xor_b32 v19, 4, v19
    v_lshl_add_u32 v3, v19, 4, v16
    v_add_u32 v3, 7168, v3
    v_add_u32 v4, 14336, v2
    v_add_u32 v5, 14336, v3
    s_and_b32 s36, s28, 3
    s_lshl_b32 s37, s36, 4
    v_add_u32 v16, s37, v18
    v_lshlrev_b32 v16, 13, v16
    s_lshl_b32 s37, s29, 8
    v_add_u32 v16, s37, v16
    v_and_b32 v19, 15, v1
    v_lshlrev_b32 v18, 1, v18
    v_xor_b32 v19, v19, v18
    v_lshl_add_u32 v6, v19, 4, v16
    v_add_u32 v7, 31744, v6
    v_xor_b32 v19, 8, v19
    v_lshl_add_u32 v8, v19, 4, v16
    v_add_u32 v8, 63488, v8
    v_add_u32 v9, 31744, v8
    s_lshl_b32 s33, s28, 12
    s_add_u32 s34, s33, 65536
    s_mov_b32 s31, 0
    s_mov_b32 s32, 0
    s_mov_b32 s40, 128
    s_mov_b32 s41, 524288
    s_waitcnt lgkmcnt(0)
    s_mov_b32 s4, s46
    s_and_b32 s5, s47, 0xffff
    s_mov_b32 s6, 2097152
    s_mov_b32 s7, 0x20000
    s_mov_b32 s8, s48
    s_and_b32 s9, s49, 0xffff
    s_mov_b32 s10, 4194304
    s_mov_b32 s11, 0x20000
    s_mov_b32 s20, s50
    s_and_b32 s21, s51, 0xffff
    s_mov_b32 s22, 4194304
    s_mov_b32 s23, 0x20000
    s_cmp_lt_u32 s28, 4
    s_cbranch_scc0 L_pro_s
    s_barrier
    s_cmp_eq_u32 s2, 0
    s_cbranch_scc1 L_recurrent_scan__compressed_kv_cla__moe_arch_mod__prompt_kernel_rare_1
L_recurrent_scan__compressed_kv_cla__moe_arch_mod__prompt_kernel_back_2:
    s_add_u32 m0, s33, 0
    s_add_u32 s36, s31, 131072
    buffer_load_dwordx4 v2, s[4:7], s31 offen offset:0 lds
    buffer_load_dwordx4 v3, s[4:7], s31 offen offset:1024 lds
    buffer_load_dwordx4 v4, s[4:7], s31 offen offset:2048 lds
    buffer_load_dwordx4 v5, s[4:7], s31 offen offset:3072 lds
    s_add_u32 m0, s34, 0
    s_nop 0
    buffer_load_dwordx4 v6, s[8:11], s32 offen offset:0 nt lds
    buffer_load_dwordx4 v7, s[8:11], s32 offen offset:1024 nt lds
    buffer_load_dwordx4 v8, s[8:11], s32 offen offset:2048 nt lds
    buffer_load_dwordx4 v9, s[8:11], s32 offen offset:3072 nt lds
    s_add_u32 m0, s33, 16384
    s_nop 0
    buffer_load_dwordx4 v2, s[4:7], s36 offen offset:0 lds
    buffer_load_dwordx4 v3, s[4:7], s36 offen offset:1024 lds
    buffer_load_dwordx4 v4, s[4:7], s36 offen offset:2048 lds
    buffer_load_dwordx4 v5, s[4:7], s36 offen offset:3072 lds
    s_add_u32 m0, s34, 16384
    s_nop 0
    buffer_load_dwordx4 v6, s[20:23], s32 offen offset:0 nt lds
    buffer_load_dwordx4 v7, s[20:23], s32 offen offset:1024 nt lds
    buffer_load_dwordx4 v8, s[20:23], s32 offen offset:2048 nt lds
    buffer_load_dwordx4 v9, s[20:23], s32 offen offset:3072 nt lds
    s_add_u32 s31, s31, s40
    s_add_u32 s32, s32, s41
L_pro_s:
    s_add_u32 s54, s90, 0
    s_addc_u32 s55, s91, 0
    s_add_u32 s12, s54, 8388608
    s_addc_u32 s13, s55, 0
    s_and_b32 s13, s13, 0xffff
    s_mov_b32 s14, 33554432
    s_mov_b32 s15, 0x20000
    s_mov_b32 s24, s54
    s_and_b32 s25, s55, 0xffff
    s_mov_b32 s26, 83886080
    s_mov_b32 s27, 0x20000
    s_add_u32 s90, s54, 61865984
    s_addc_u32 s91, s55, 0
    v_and_b32 v16, 15, v1
    v_lshrrev_b32 v17, 4, v1
    s_bfe_u32 s36, s28, 0x10001
    s_lshl_b32 s36, s36, 14
    v_lshl_add_u32 v18, v16, 7, s36
    v_lshrrev_b32 v19, 1, v16
    v_xor_b32 v19, v19, v17
    v_lshl_add_u32 v10, v19, 4, v18
    v_xor_b32 v19, 4, v19
    v_lshl_add_u32 v11, v19, 4, v18
    v_lshrrev_b32 v16, 2, v16
    v_lshl_add_u32 v18, v17, 3, v16
    v_lshlrev_b32 v18, 8, v18
    s_lshr_b32 s36, s28, 2
    s_lshl_b32 s36, s36, 14
    s_add_u32 s36, s36, 65536
    v_add_u32 v18, s36, v18
    v_and_b32 v19, 3, v1
    v_lshl_add_u32 v18, v19, 3, v18
    v_and_b32 v17, 1, v17
    v_lshl_add_u32 v16, v17, 2, v16
    s_and_b32 s36, s28, 1
    s_lshl_b32 s36, s36, 2
    s_add_u32 s37, s36, 0
    v_xor_b32 v19, s37, v16
    v_lshl_add_u32 v12, v19, 5, v18
    s_add_u32 s37, s36, 1
    v_xor_b32 v19, s37, v16
    v_lshl_add_u32 v13, v19, 5, v18
    s_add_u32 s37, s36, 2
    v_xor_b32 v19, s37, v16
    v_lshl_add_u32 v14, v19, 5, v18
    s_add_u32 s37, s36, 3
    v_xor_b32 v19, s37, v16
    v_lshl_add_u32 v15, v19, 5, v18
    v_mov_b64 v[128:129], 0
    v_mov_b64 v[130:131], 0
    v_mov_b64 v[132:133], 0
    v_mov_b64 v[134:135], 0
    v_mov_b64 v[136:137], 0
    v_mov_b64 v[138:139], 0
    v_mov_b64 v[140:141], 0
    v_mov_b64 v[142:143], 0
    v_mov_b64 v[144:145], 0
    v_mov_b64 v[146:147], 0
    v_mov_b64 v[148:149], 0
    v_mov_b64 v[150:151], 0
    v_mov_b64 v[152:153], 0
    v_mov_b64 v[154:155], 0
    v_mov_b64 v[156:157], 0
    v_mov_b64 v[158:159], 0
    v_mov_b64 v[160:161], 0
    v_mov_b64 v[162:163], 0
    v_mov_b64 v[164:165], 0
    v_mov_b64 v[166:167], 0
    v_mov_b64 v[168:169], 0
    v_mov_b64 v[170:171], 0
    v_mov_b64 v[172:173], 0
    v_mov_b64 v[174:175], 0
    v_mov_b64 v[176:177], 0
    v_mov_b64 v[178:179], 0
    v_mov_b64 v[180:181], 0
    v_mov_b64 v[182:183], 0
    v_mov_b64 v[184:185], 0
    v_mov_b64 v[186:187], 0
    v_mov_b64 v[188:189], 0
    v_mov_b64 v[190:191], 0
    v_mov_b64 v[192:193], 0
    v_mov_b64 v[194:195], 0
    v_mov_b64 v[196:197], 0
    v_mov_b64 v[198:199], 0
    v_mov_b64 v[200:201], 0
    v_mov_b64 v[202:203], 0
    v_mov_b64 v[204:205], 0
    v_mov_b64 v[206:207], 0
    v_mov_b64 v[208:209], 0
    v_mov_b64 v[210:211], 0
    v_mov_b64 v[212:213], 0
    v_mov_b64 v[214:215], 0
    v_mov_b64 v[216:217], 0
    v_mov_b64 v[218:219], 0
    v_mov_b64 v[220:221], 0
    v_mov_b64 v[222:223], 0
    v_mov_b64 v[224:225], 0
    v_mov_b64 v[226:227], 0
    v_mov_b64 v[228:229], 0
    v_mov_b64 v[230:231], 0
    v_mov_b64 v[232:233], 0
    v_mov_b64 v[234:235], 0
    v_mov_b64 v[236:237], 0
    v_mov_b64 v[238:239], 0
    v_mov_b64 v[240:241], 0
    v_mov_b64 v[242:243], 0
    v_mov_b64 v[244:245], 0
    v_mov_b64 v[246:247], 0
    v_mov_b64 v[248:249], 0
    v_mov_b64 v[250:251], 0
    v_mov_b64 v[252:253], 0
    v_mov_b64 v[254:255], 0
    v_mov_b32 v118, 0
    v_mov_b32 v117, 0
    s_lshl_b32 s36, s30, 7
    s_lshl_b32 s37, s28, 4
    s_add_u32 s36, s36, s37
    v_bfe_u32 v17, v1, 1, 4
    v_add_u32 v17, s36, v17
    v_lshlrev_b32 v17, 13, v17
    v_and_b32 v19, 1, v1
    v_lshl_add_u32 v17, v19, 7, v17
    s_lshl_b32 s36, s29, 8
    v_add_u32 v17, s36, v17
    s_mov_b32 s45, 32768
    s_cmp_lt_u32 s28, 4
    s_cbranch_scc0 L_pro_b
    s_add_u32 m0, s33, 32768
    s_add_u32 s36, s31, 131072
    buffer_load_dwordx4 v2, s[4:7], s31 offen offset:0 lds
    buffer_load_dwordx4 v3, s[4:7], s31 offen offset:1024 lds
    buffer_load_dwordx4 v4, s[4:7], s31 offen offset:2048 lds
    buffer_load_dwordx4 v5, s[4:7], s31 offen offset:3072 lds
    s_add_u32 m0, s34, 32768
    s_nop 0
    buffer_load_dwordx4 v6, s[8:11], s32 offen offset:0 nt lds
    buffer_load_dwordx4 v7, s[8:11], s32 offen offset:1024 nt lds
    buffer_load_dwordx4 v8, s[8:11], s32 offen offset:2048 nt lds
    buffer_load_dwordx4 v9, s[8:11], s32 offen offset:3072 nt lds
    s_add_u32 m0, s33, 49152
    s_nop 0
    buffer_load_dwordx4 v2, s[4:7], s36 offen offset:0 lds
    buffer_load_dwordx4 v3, s[4:7], s36 offen offset:1024 lds
    buffer_load_dwordx4 v4, s[4:7], s36 offen offset:2048 lds
    buffer_load_dwordx4 v5, s[4:7], s36 offen offset:3072 lds
    s_add_u32 m0, s34, 49152
    s_nop 0
    buffer_load_dwordx4 v6, s[20:23], s32 offen offset:0 nt lds
    buffer_load_dwordx4 v7, s[20:23], s32 offen offset:1024 nt lds
    buffer_load_dwordx4 v8, s[20:23], s32 offen offset:2048 nt lds
    buffer_load_dwordx4 v9, s[20:23], s32 offen offset:3072 nt lds
    s_add_u32 s31, s31, s40
    s_add_u32 s32, s32, s41
    s_waitcnt vmcnt(16)
    s_branch L_pro_j
L_pro_b:
    s_mov_b64 s[8:9], s[20:21]
    s_mov_b32 s31, 256
    s_mov_b32 s32, 1048576
    s_and_b32 s60, s28, 3
    s_waitcnt vmcnt(0)
    s_mov_b32 s3, 0
L_ln:
    v_lshlrev_b32 v44, 16, v36
    v_and_b32 v45, 0xffff0000, v36
    v_lshlrev_b32 v46, 16, v37
    v_and_b32 v47, 0xffff0000, v37
    v_lshlrev_b32 v48, 16, v38
    v_and_b32 v49, 0xffff0000, v38
    v_lshlrev_b32 v50, 16, v39
    v_and_b32 v51, 0xffff0000, v39
    v_lshlrev_b32 v52, 16, v40
    v_and_b32 v53, 0xffff0000, v40
    v_lshlrev_b32 v54, 16, v41
    v_and_b32 v55, 0xffff0000, v41
    v_lshlrev_b32 v56, 16, v42
    v_and_b32 v57, 0xffff0000, v42
    v_lshlrev_b32 v58, 16, v43
    v_and_b32 v59, 0xffff0000, v43
    v_lshlrev_b32 v60, 16, v20
    v_lshlrev_b32 v76, 16, v28
    v_and_b32 v61, 0xffff0000, v20
    v_and_b32 v77, 0xffff0000, v28
    v_lshlrev_b32 v62, 16, v21
    v_lshlrev_b32 v78, 16, v29
    v_and_b32 v63, 0xffff0000, v21
    v_and_b32 v79, 0xffff0000, v29
    v_lshlrev_b32 v64, 16, v22
    v_lshlrev_b32 v80, 16, v30
    v_and_b32 v65, 0xffff0000, v22
    v_and_b32 v81, 0xffff0000, v30
    v_lshlrev_b32 v66, 16, v23
    v_lshlrev_b32 v82, 16, v31
    v_and_b32 v67, 0xffff0000, v23
    v_and_b32 v83, 0xffff0000, v31
    v_lshlrev_b32 v68, 16, v24
    v_lshlrev_b32 v84, 16, v32
    v_and_b32 v69, 0xffff0000, v24
    v_and_b32 v85, 0xffff0000, v32
    v_lshlrev_b32 v70, 16, v25
    v_lshlrev_b32 v86, 16, v33
    v_and_b32 v71, 0xffff0000, v25
    v_and_b32 v87, 0xffff0000, v33
    v_lshlrev_b32 v72, 16, v26
    v_lshlrev_b32 v88, 16, v34
    v_and_b32 v73, 0xffff0000, v26
    v_and_b32 v89, 0xffff0000, v34
    v_lshlrev_b32 v74, 16, v27
    v_lshlrev_b32 v90, 16, v35
    v_and_b32 v75, 0xffff0000, v27
    v_and_b32 v91, 0xffff0000, v35
    v_pk_add_f32 v[92:93], v[60:61], v[62:63]
    v_pk_add_f32 v[100:101], v[76:77], v[78:79]
    v_pk_add_f32 v[92:93], v[92:93], v[64:65]
    v_pk_add_f32 v[100:101], v[100:101], v[80:81]
    v_pk_add_f32 v[92:93], v[92:93], v[66:67]
    v_pk_add_f32 v[100:101], v[100:101], v[82:83]
    v_pk_add_f32 v[92:93], v[92:93], v[68:69]
    v_pk_add_f32 v[100:101], v[100:101], v[84:85]
    v_pk_add_f32 v[92:93], v[92:93], v[70:71]
    v_pk_add_f32 v[100:101], v[100:101], v[86:87]
    v_pk_add_f32 v[92:93], v[92:93], v[72:73]
    v_pk_add_f32 v[100:101], v[100:101], v[88:89]
    v_pk_add_f32 v[92:93], v[92:93], v[74:75]
    v_pk_add_f32 v[100:101], v[100:101], v[90:91]
    v_add_f32 v92, v92, v93
    v_add_f32 v100, v100, v101
    s_nop 0
    v_add_f32_dpp v92, v92, v92 quad_perm:[1,0,3,2] row_mask:0xf bank_mask:0xf
    v_add_f32_dpp v100, v100, v100 quad_perm:[1,0,3,2] row_mask:0xf bank_mask:0xf
    s_nop 0
    v_add_f32_dpp v92, v92, v92 quad_perm:[2,3,0,1] row_mask:0xf bank_mask:0xf
    v_add_f32_dpp v100, v100, v100 quad_perm:[2,3,0,1] row_mask:0xf bank_mask:0xf
    s_nop 0
    v_add_f32_dpp v92, v92, v92 row_half_mirror row_mask:0xf bank_mask:0xf
    v_add_f32_dpp v100, v100, v100 row_half_mirror row_mask:0xf bank_mask:0xf
    s_nop 0
    v_add_f32_dpp v92, v92, v92 row_mirror row_mask:0xf bank_mask:0xf
    v_add_f32_dpp v100, v100, v100 row_mirror row_mask:0xf bank_mask:0xf
    v_readlane_b32 s36, v92, 0
    v_readlane_b32 s56, v100, 0
    v_readlane_b32 s37, v92, 16
    v_readlane_b32 s57, v100, 16
    v_readlane_b32 s38, v92, 32
    v_readlane_b32 s58, v100, 32
    v_readlane_b32 s39, v92, 48
    v_readlane_b32 s59, v100, 48
    v_mov_b32 v96, s36
    v_mov_b32 v104, s56
    v_add_f32 v96, s37, v96
    v_add_f32 v104, s57, v104
    v_add_f32 v96, s38, v96
    v_add_f32 v104, s58, v104
    v_add_f32 v96, s39, v96
    v_add_f32 v104, s59, v104
    v_mul_f32 v96, 0xba800000, v96
    v_mul_f32 v104, 0xba800000, v104
    v_mov_b32 v97, v96
    v_mov_b32 v105, v104
    v_pk_add_f32 v[94:95], v[60:61], v[96:97]
    v_pk_add_f32 v[102:103], v[76:77], v[104:105]
    v_pk_mul_f32 v[92:93], v[94:95], v[94:95]
    v_pk_mul_f32 v[100:101], v[102:103], v[102:103]
    v_pk_add_f32 v[94:95], v[62:63], v[96:97]
    v_pk_add_f32 v[102:103], v[78:79], v[104:105]
    v_pk_fma_f32 v[92:93], v[94:95], v[94:95], v[92:93]
    v_pk_fma_f32 v[100:101], v[102:103], v[102:103], v[100:101]
    v_pk_add_f32 v[94:95], v[64:65], v[96:97]
    v_pk_add_f32 v[102:103], v[80:81], v[104:105]
    v_pk_fma_f32 v[92:93], v[94:95], v[94:95], v[92:93]
    v_pk_fma_f32 v[100:101], v[102:103], v[102:103], v[100:101]
    v_pk_add_f32 v[94:95], v[66:67], v[96:97]
    v_pk_add_f32 v[102:103], v[82:83], v[104:105]
    v_pk_fma_f32 v[92:93], v[94:95], v[94:95], v[92:93]
    v_pk_fma_f32 v[100:101], v[102:103], v[102:103], v[100:101]
    v_pk_add_f32 v[94:95], v[68:69], v[96:97]
    v_pk_add_f32 v[102:103], v[84:85], v[104:105]
    v_pk_fma_f32 v[92:93], v[94:95], v[94:95], v[92:93]
    v_pk_fma_f32 v[100:101], v[102:103], v[102:103], v[100:101]
    v_pk_add_f32 v[94:95], v[70:71], v[96:97]
    v_pk_add_f32 v[102:103], v[86:87], v[104:105]
    v_pk_fma_f32 v[92:93], v[94:95], v[94:95], v[92:93]
    v_pk_fma_f32 v[100:101], v[102:103], v[102:103], v[100:101]
    v_pk_add_f32 v[94:95], v[72:73], v[96:97]
    v_pk_add_f32 v[102:103], v[88:89], v[104:105]
    v_pk_fma_f32 v[92:93], v[94:95], v[94:95], v[92:93]
    v_pk_fma_f32 v[100:101], v[102:103], v[102:103], v[100:101]
    v_pk_add_f32 v[94:95], v[74:75], v[96:97]
    v_pk_add_f32 v[102:103], v[90:91], v[104:105]
    v_pk_fma_f32 v[92:93], v[94:95], v[94:95], v[92:93]
    v_pk_fma_f32 v[100:101], v[102:103], v[102:103], v[100:101]
    v_add_f32 v92, v92, v93
    v_add_f32 v100, v100, v101
    s_nop 0
    v_add_f32_dpp v92, v92, v92 quad_perm:[1,0,3,2] row_mask:0xf bank_mask:0xf
    v_add_f32_dpp v100, v100, v100 quad_perm:[1,0,3,2] row_mask:0xf bank_mask:0xf
    s_nop 0
    v_add_f32_dpp v92, v92, v92 quad_perm:[2,3,0,1] row_mask:0xf bank_mask:0xf
    v_add_f32_dpp v100, v100, v100 quad_perm:[2,3,0,1] row_mask:0xf bank_mask:0xf
    s_nop 0
    v_add_f32_dpp v92, v92, v92 row_half_mirror row_mask:0xf bank_mask:0xf
    v_add_f32_dpp v100, v100, v100 row_half_mirror row_mask:0xf bank_mask:0xf
    s_nop 0
    v_add_f32_dpp v92, v92, v92 row_mirror row_mask:0xf bank_mask:0xf
    v_add_f32_dpp v100, v100, v100 row_mirror row_mask:0xf bank_mask:0xf
    v_readlane_b32 s36, v92, 0
    v_readlane_b32 s56, v100, 0
    v_readlane_b32 s37, v92, 16
    v_readlane_b32 s57, v100, 16
    v_readlane_b32 s38, v92, 32
    v_readlane_b32 s58, v100, 32
    v_readlane_b32 s39, v92, 48
    v_readlane_b32 s59, v100, 48
    v_mov_b32 v94, s36
    v_mov_b32 v102, s56
    v_add_f32 v94, s37, v94
    v_add_f32 v102, s57, v102
    v_add_f32 v94, s38, v94
    v_add_f32 v102, s58, v102
    v_add_f32 v94, s39, v94
    v_add_f32 v102, s59, v102
    v_mul_f32 v94, 0x3a800000, v94
    v_mul_f32 v102, 0x3a800000, v102
    v_cvt_pk_bf16_f32 v95, v96, v94
    v_cvt_pk_bf16_f32 v103, v104, v102
    v_lshlrev_b32 v96, 16, v95
    v_lshlrev_b32 v104, 16, v103
    v_and_b32 v94, 0xffff0000, v95
    v_and_b32 v102, 0xffff0000, v103
    v_add_f32 v94, 0x3727c5ac, v94
    v_add_f32 v102, 0x3727c5ac, v102
    v_cvt_pk_bf16_f32 v94, v94, v94
    v_cvt_pk_bf16_f32 v102, v102, v102
    v_lshlrev_b32 v94, 16, v94
    v_lshlrev_b32 v102, 16, v102
    v_sqrt_f32 v94, v94
    v_sqrt_f32 v102, v102
    v_mov_b32 v97, v96
    v_mov_b32 v105, v104
    v_cvt_pk_bf16_f32 v94, v94, v94
    v_cvt_pk_bf16_f32 v102, v102, v102
    v_lshlrev_b32 v94, 16, v94
    v_lshlrev_b32 v102, 16, v102
    v_rcp_f32 v99, v94
    v_rcp_f32 v107, v102
    v_fma_f32 v95, -v94, v99, 1.0
    v_fma_f32 v103, -v102, v107, 1.0
    v_fma_f32 v99, v95, v99, v99
    v_fma_f32 v107, v103, v107, v107
    v_mov_b32 v98, v99
    v_mov_b32 v106, v107
    v_pk_add_f32 v[60:61], v[60:61], v[96:97]
    v_pk_add_f32 v[76:77], v[76:77], v[104:105]
    v_cvt_pk_bf16_f32 v94, v60, v61
    v_cvt_pk_bf16_f32 v102, v76, v77
    v_lshlrev_b32 v60, 16, v94
    v_lshlrev_b32 v76, 16, v102
    v_and_b32 v61, 0xffff0000, v94
    v_and_b32 v77, 0xffff0000, v102
    v_pk_mul_f32 v[60:61], v[60:61], v[98:99]
    v_pk_mul_f32 v[76:77], v[76:77], v[106:107]
    v_cvt_pk_bf16_f32 v108, v60, v61
    v_cvt_pk_bf16_f32 v120, v76, v77
    v_lshlrev_b32 v60, 16, v108
    v_lshlrev_b32 v76, 16, v120
    v_and_b32 v61, 0xffff0000, v108
    v_and_b32 v77, 0xffff0000, v120
    v_pk_mul_f32 v[92:93], v[60:61], v[44:45]
    v_pk_mul_f32 v[100:101], v[76:77], v[44:45]
    v_pk_add_f32 v[62:63], v[62:63], v[96:97]
    v_pk_add_f32 v[78:79], v[78:79], v[104:105]
    v_cvt_pk_bf16_f32 v94, v62, v63
    v_cvt_pk_bf16_f32 v102, v78, v79
    v_lshlrev_b32 v62, 16, v94
    v_lshlrev_b32 v78, 16, v102
    v_and_b32 v63, 0xffff0000, v94
    v_and_b32 v79, 0xffff0000, v102
    v_pk_mul_f32 v[62:63], v[62:63], v[98:99]
    v_pk_mul_f32 v[78:79], v[78:79], v[106:107]
    v_cvt_pk_bf16_f32 v109, v62, v63
    v_cvt_pk_bf16_f32 v121, v78, v79
    v_lshlrev_b32 v62, 16, v109
    v_lshlrev_b32 v78, 16, v121
    v_and_b32 v63, 0xffff0000, v109
    v_and_b32 v79, 0xffff0000, v121
    v_pk_fma_f32 v[92:93], v[62:63], v[46:47], v[92:93]
    v_pk_fma_f32 v[100:101], v[78:79], v[46:47], v[100:101]
    v_pk_add_f32 v[64:65], v[64:65], v[96:97]
    v_pk_add_f32 v[80:81], v[80:81], v[104:105]
    v_cvt_pk_bf16_f32 v94, v64, v65
    v_cvt_pk_bf16_f32 v102, v80, v81
    v_lshlrev_b32 v64, 16, v94
    v_lshlrev_b32 v80, 16, v102
    v_and_b32 v65, 0xffff0000, v94
    v_and_b32 v81, 0xffff0000, v102
    v_pk_mul_f32 v[64:65], v[64:65], v[98:99]
    v_pk_mul_f32 v[80:81], v[80:81], v[106:107]
    v_cvt_pk_bf16_f32 v110, v64, v65
    v_cvt_pk_bf16_f32 v122, v80, v81
    v_lshlrev_b32 v64, 16, v110
    v_lshlrev_b32 v80, 16, v122
    v_and_b32 v65, 0xffff0000, v110
    v_and_b32 v81, 0xffff0000, v122
    v_pk_fma_f32 v[92:93], v[64:65], v[48:49], v[92:93]
    v_pk_fma_f32 v[100:101], v[80:81], v[48:49], v[100:101]
    v_pk_add_f32 v[66:67], v[66:67], v[96:97]
    v_pk_add_f32 v[82:83], v[82:83], v[104:105]
    v_cvt_pk_bf16_f32 v94, v66, v67
    v_cvt_pk_bf16_f32 v102, v82, v83
    v_lshlrev_b32 v66, 16, v94
    v_lshlrev_b32 v82, 16, v102
    v_and_b32 v67, 0xffff0000, v94
    v_and_b32 v83, 0xffff0000, v102
    v_pk_mul_f32 v[66:67], v[66:67], v[98:99]
    v_pk_mul_f32 v[82:83], v[82:83], v[106:107]
    v_cvt_pk_bf16_f32 v111, v66, v67
    v_cvt_pk_bf16_f32 v123, v82, v83
    v_lshlrev_b32 v66, 16, v111
    v_lshlrev_b32 v82, 16, v123
    v_and_b32 v67, 0xffff0000, v111
    v_and_b32 v83, 0xffff0000, v123
    v_pk_fma_f32 v[92:93], v[66:67], v[50:51], v[92:93]
    v_pk_fma_f32 v[100:101], v[82:83], v[50:51], v[100:101]
    v_pk_add_f32 v[68:69], v[68:69], v[96:97]
    v_pk_add_f32 v[84:85], v[84:85], v[104:105]
    v_cvt_pk_bf16_f32 v94, v68, v69
    v_cvt_pk_bf16_f32 v102, v84, v85
    v_lshlrev_b32 v68, 16, v94
    v_lshlrev_b32 v84, 16, v102
    v_and_b32 v69, 0xffff0000, v94
    v_and_b32 v85, 0xffff0000, v102
    v_pk_mul_f32 v[68:69], v[68:69], v[98:99]
    v_pk_mul_f32 v[84:85], v[84:85], v[106:107]
    v_cvt_pk_bf16_f32 v112, v68, v69
    v_cvt_pk_bf16_f32 v124, v84, v85
    v_lshlrev_b32 v68, 16, v112
    v_lshlrev_b32 v84, 16, v124
    v_and_b32 v69, 0xffff0000, v112
    v_and_b32 v85, 0xffff0000, v124
    v_pk_fma_f32 v[92:93], v[68:69], v[52:53], v[92:93]
    v_pk_fma_f32 v[100:101], v[84:85], v[52:53], v[100:101]
    v_pk_add_f32 v[70:71], v[70:71], v[96:97]
    v_pk_add_f32 v[86:87], v[86:87], v[104:105]
    v_cvt_pk_bf16_f32 v94, v70, v71
    v_cvt_pk_bf16_f32 v102, v86, v87
    v_lshlrev_b32 v70, 16, v94
    v_lshlrev_b32 v86, 16, v102
    v_and_b32 v71, 0xffff0000, v94
    v_and_b32 v87, 0xffff0000, v102
    v_pk_mul_f32 v[70:71], v[70:71], v[98:99]
    v_pk_mul_f32 v[86:87], v[86:87], v[106:107]
    v_cvt_pk_bf16_f32 v113, v70, v71
    v_cvt_pk_bf16_f32 v125, v86, v87
    v_lshlrev_b32 v70, 16, v113
    v_lshlrev_b32 v86, 16, v125
    v_and_b32 v71, 0xffff0000, v113
    v_and_b32 v87, 0xffff0000, v125
    v_pk_fma_f32 v[92:93], v[70:71], v[54:55], v[92:93]
    v_pk_fma_f32 v[100:101], v[86:87], v[54:55], v[100:101]
    v_pk_add_f32 v[72:73], v[72:73], v[96:97]
    v_pk_add_f32 v[88:89], v[88:89], v[104:105]
    v_cvt_pk_bf16_f32 v94, v72, v73
    v_cvt_pk_bf16_f32 v102, v88, v89
    v_lshlrev_b32 v72, 16, v94
    v_lshlrev_b32 v88, 16, v102
    v_and_b32 v73, 0xffff0000, v94
    v_and_b32 v89, 0xffff0000, v102
    v_pk_mul_f32 v[72:73], v[72:73], v[98:99]
    v_pk_mul_f32 v[88:89], v[88:89], v[106:107]
    v_cvt_pk_bf16_f32 v114, v72, v73
    v_cvt_pk_bf16_f32 v126, v88, v89
    v_lshlrev_b32 v72, 16, v114
    v_lshlrev_b32 v88, 16, v126
    v_and_b32 v73, 0xffff0000, v114
    v_and_b32 v89, 0xffff0000, v126
    v_pk_fma_f32 v[92:93], v[72:73], v[56:57], v[92:93]
    v_pk_fma_f32 v[100:101], v[88:89], v[56:57], v[100:101]
    v_pk_add_f32 v[74:75], v[74:75], v[96:97]
    v_pk_add_f32 v[90:91], v[90:91], v[104:105]
    v_cvt_pk_bf16_f32 v94, v74, v75
    v_cvt_pk_bf16_f32 v102, v90, v91
    v_lshlrev_b32 v74, 16, v94
    v_lshlrev_b32 v90, 16, v102
    v_and_b32 v75, 0xffff0000, v94
    v_and_b32 v91, 0xffff0000, v102
    v_pk_mul_f32 v[74:75], v[74:75], v[98:99]
    v_pk_mul_f32 v[90:91], v[90:91], v[106:107]
    v_cvt_pk_bf16_f32 v115, v74, v75
    v_cvt_pk_bf16_f32 v127, v90, v91
    v_lshlrev_b32 v74, 16, v115
    v_lshlrev_b32 v90, 16, v127
    v_and_b32 v75, 0xffff0000, v115
    v_and_b32 v91, 0xffff0000, v127
    v_pk_fma_f32 v[92:93], v[74:75], v[58:59], v[92:93]
    v_pk_fma_f32 v[100:101], v[90:91], v[58:59], v[100:101]
    v_add_f32 v92, v92, v93
    v_add_f32 v100, v100, v101
    v_xor_b32 v98, 0x80000000, v96
    v_xor_b32 v106, 0x80000000, v104
    s_mul_i32 s36, s60, 2064
    s_mul_i32 s56, s28, 2064
    s_add_u32 s36, s36, 131072
    s_add_u32 s56, s56, 131072
    v_lshl_add_u32 v95, v1, 4, s36
    v_lshl_add_u32 v103, v1, 4, s56
    ds_write_b128 v95, v[108:111]
    ds_write_b128 v103, v[120:123]
    ds_write_b128 v95, v[112:115] offset:1024
    ds_write_b128 v103, v[124:127] offset:1024
    s_nop 0
    v_add_f32_dpp v92, v92, v92 quad_perm:[1,0,3,2] row_mask:0xf bank_mask:0xf
    v_add_f32_dpp v100, v100, v100 quad_perm:[1,0,3,2] row_mask:0xf bank_mask:0xf
    s_nop 0
    v_add_f32_dpp v92, v92, v92 quad_perm:[2,3,0,1] row_mask:0xf bank_mask:0xf
    v_add_f32_dpp v100, v100, v100 quad_perm:[2,3,0,1] row_mask:0xf bank_mask:0xf
    s_nop 0
    v_add_f32_dpp v92, v92, v92 row_half_mirror row_mask:0xf bank_mask:0xf
    v_add_f32_dpp v100, v100, v100 row_half_mirror row_mask:0xf bank_mask:0xf
    s_nop 0
    v_add_f32_dpp v92, v92, v92 row_mirror row_mask:0xf bank_mask:0xf
    v_add_f32_dpp v100, v100, v100 row_mirror row_mask:0xf bank_mask:0xf
    v_readlane_b32 s36, v92, 0
    v_readlane_b32 s56, v100, 0
    v_readlane_b32 s37, v92, 16
    v_readlane_b32 s57, v100, 16
    v_readlane_b32 s38, v92, 32
    v_readlane_b32 s58, v100, 32
    v_readlane_b32 s39, v92, 48
    v_readlane_b32 s59, v100, 48
    v_mov_b32 v93, s36
    v_mov_b32 v101, s56
    v_add_f32 v93, s37, v93
    v_add_f32 v101, s57, v101
    v_add_f32 v93, s38, v93
    v_add_f32 v101, s58, v101
    v_add_f32 v93, s39, v93
    v_add_f32 v101, s59, v101
    v_cvt_pk_bf16_f32 v93, v93, v93
    v_cvt_pk_bf16_f32 v101, v101, v101
    v_lshlrev_b32 v93, 16, v93
    v_lshlrev_b32 v101, 16, v101
    v_ashrrev_i32 v95, 31, v93
    v_ashrrev_i32 v103, 31, v101
    v_or_b32 v95, 0x80000000, v95
    v_or_b32 v103, 0x80000000, v103
    v_xor_b32 v95, v93, v95
    v_xor_b32 v103, v101, v103
    v_and_b32 v95, 0xffff0000, v95
    v_and_b32 v103, 0xffff0000, v103
    s_sub_u32 s36, 0xffff, s42
    s_sub_u32 s56, 0xffff, s43
    v_or_b32 v95, s36, v95
    v_or_b32 v103, s56, v103
    s_lshl_b32 s37, s60, 3
    s_lshl_b32 s57, s28, 3
    s_add_u32 s37, s37, 147712
    s_add_u32 s57, s57, 147712
    v_mov_b32 v94, s37
    v_mov_b32 v102, s57
    ds_write_b64 v94, v[98:99]
    ds_write_b64 v102, v[106:107]
    ds_write_b32 v94, v95 offset:64
    ds_write_b32 v102, v103 offset:64
    s_waitcnt vmcnt(0) lgkmcnt(0)
    s_cmp_eq_u32 s3, 0
    s_mov_b32 s3, 0
    s_cbranch_scc0 L_ln
L_pro_j:
    s_barrier
    ds_read_b128 v[20:23], v10 offset:0
    ds_read_b64_tr_b16 v[52:53], v12 offset:0
    ds_read_b64_tr_b16 v[54:55], v12 offset:1024
    ds_read_b64_tr_b16 v[56:57], v13 offset:0
    ds_read_b64_tr_b16 v[58:59], v13 offset:1024
    ds_read_b64_tr_b16 v[60:61], v14 offset:0
    ds_read_b64_tr_b16 v[62:63], v14 offset:1024
    ds_read_b64_tr_b16 v[64:65], v15 offset:0
    ds_read_b64_tr_b16 v[66:67], v15 offset:1024
    ds_read_b128 v[24:27], v10 offset:2048
    ds_read_b128 v[28:31], v10 offset:4096
    ds_read_b128 v[32:35], v10 offset:6144
    ds_read_b128 v[36:39], v10 offset:8192
    ds_read_b128 v[40:43], v10 offset:10240
    ds_read_b128 v[44:47], v10 offset:12288
    ds_read_b128 v[48:51], v10 offset:14336
    s_add_u32 s36, s2, s28
    s_cmp_eq_u32 s36, 0
    s_cbranch_scc1 L_recurrent_scan__compressed_kv_cla__moe_arch_mod__prompt_kernel_rare_3
L_recurrent_scan__compressed_kv_cla__moe_arch_mod__prompt_kernel_back_4:
    s_mov_b32 s35, 0
    s_cmp_eq_u32 s28, 0
    s_cselect_b32 s43, 9, 0
    s_cselect_b32 s44, 2, 1
    s_cmp_lt_u32 s28, 4
    s_cbranch_scc0 L_kv_vloop
    .p2align 6
L_kv_kloop:
    s_waitcnt lgkmcnt(0)
    v_mfma_f32_16x16x32_bf16 v[128:131], v[52:55], v[20:23], v[128:131]
    ds_read_b128 v[68:71], v11 offset:0
    v_mfma_f32_16x16x32_bf16 v[132:135], v[56:59], v[20:23], v[132:135]
    ds_read_b64_tr_b16 v[100:101], v12 offset:8192
    v_mfma_f32_16x16x32_bf16 v[136:139], v[60:63], v[20:23], v[136:139]
    ds_read_b64_tr_b16 v[102:103], v12 offset:9216
    v_mfma_f32_16x16x32_bf16 v[140:143], v[64:67], v[20:23], v[140:143]
    ds_read_b64_tr_b16 v[104:105], v13 offset:8192
    v_mfma_f32_16x16x32_bf16 v[144:147], v[52:55], v[24:27], v[144:147]
    ds_read_b64_tr_b16 v[106:107], v13 offset:9216
    v_mfma_f32_16x16x32_bf16 v[148:151], v[56:59], v[24:27], v[148:151]
    ds_read_b64_tr_b16 v[108:109], v14 offset:8192
    v_mfma_f32_16x16x32_bf16 v[152:155], v[60:63], v[24:27], v[152:155]
    ds_read_b64_tr_b16 v[110:111], v14 offset:9216
    v_mfma_f32_16x16x32_bf16 v[156:159], v[64:67], v[24:27], v[156:159]
    ds_read_b64_tr_b16 v[112:113], v15 offset:8192
    v_mfma_f32_16x16x32_bf16 v[160:163], v[52:55], v[28:31], v[160:163]
    ds_read_b64_tr_b16 v[114:115], v15 offset:9216
    v_mfma_f32_16x16x32_bf16 v[164:167], v[56:59], v[28:31], v[164:167]
    ds_read_b128 v[72:75], v11 offset:2048
    v_mfma_f32_16x16x32_bf16 v[168:171], v[60:63], v[28:31], v[168:171]
    ds_read_b128 v[76:79], v11 offset:4096
    v_mfma_f32_16x16x32_bf16 v[172:175], v[64:67], v[28:31], v[172:175]
    ds_read_b128 v[80:83], v11 offset:6144
    v_mfma_f32_16x16x32_bf16 v[176:179], v[52:55], v[32:35], v[176:179]
    ds_read_b128 v[84:87], v11 offset:8192
    v_mfma_f32_16x16x32_bf16 v[180:183], v[56:59], v[32:35], v[180:183]
    ds_read_b128 v[88:91], v11 offset:10240
    v_mfma_f32_16x16x32_bf16 v[184:187], v[60:63], v[32:35], v[184:187]
    ds_read_b128 v[92:95], v11 offset:12288
    v_mfma_f32_16x16x32_bf16 v[188:191], v[64:67], v[32:35], v[188:191]
    ds_read_b128 v[96:99], v11 offset:14336
    v_mfma_f32_16x16x32_bf16 v[192:195], v[52:55], v[36:39], v[192:195]
    v_mfma_f32_16x16x32_bf16 v[196:199], v[56:59], v[36:39], v[196:199]
    v_mfma_f32_16x16x32_bf16 v[200:203], v[60:63], v[36:39], v[200:203]
    v_mfma_f32_16x16x32_bf16 v[204:207], v[64:67], v[36:39], v[204:207]
    v_mfma_f32_16x16x32_bf16 v[208:211], v[52:55], v[40:43], v[208:211]
    v_mfma_f32_16x16x32_bf16 v[212:215], v[56:59], v[40:43], v[212:215]
    v_mfma_f32_16x16x32_bf16 v[216:219], v[60:63], v[40:43], v[216:219]
    v_mfma_f32_16x16x32_bf16 v[220:223], v[64:67], v[40:43], v[220:223]
    v_mfma_f32_16x16x32_bf16 v[224:227], v[52:55], v[44:47], v[224:227]
    v_mfma_f32_16x16x32_bf16 v[228:231], v[56:59], v[44:47], v[228:231]
    v_mfma_f32_16x16x32_bf16 v[232:235], v[60:63], v[44:47], v[232:235]
    v_mfma_f32_16x16x32_bf16 v[236:239], v[64:67], v[44:47], v[236:239]
    v_mfma_f32_16x16x32_bf16 v[240:243], v[52:55], v[48:51], v[240:243]
    v_mfma_f32_16x16x32_bf16 v[244:247], v[56:59], v[48:51], v[244:247]
    v_mfma_f32_16x16x32_bf16 v[248:251], v[60:63], v[48:51], v[248:251]
    v_mfma_f32_16x16x32_bf16 v[252:255], v[64:67], v[48:51], v[252:255]
    s_cmp_eq_u32 s35, 3
    s_cbranch_scc1 L_recurrent_scan__compressed_kv_cla__moe_arch_mod__prompt_kernel_rare_5
L_recurrent_scan__compressed_kv_cla__moe_arch_mod__prompt_kernel_back_6:
    s_cmp_lt_u32 s35, s44
    s_cbranch_scc1 L_recurrent_scan__compressed_kv_cla__moe_arch_mod__prompt_kernel_w0_7
    s_waitcnt vmcnt(1)
L_recurrent_scan__compressed_kv_cla__moe_arch_mod__prompt_kernel_w0b_8:
    s_waitcnt lgkmcnt(0)
    s_barrier
    v_mfma_f32_16x16x32_bf16 v[128:131], v[100:103], v[68:71], v[128:131]
    ds_read_b128 v[20:23], v10 offset:32768
    s_add_u32 m0, s33, 0
    v_mfma_f32_16x16x32_bf16 v[132:135], v[104:107], v[68:71], v[132:135]
    ds_read_b64_tr_b16 v[52:53], v12 offset:32768
    buffer_load_dwordx4 v2, s[4:7], s31 offen offset:0 lds
    v_mfma_f32_16x16x32_bf16 v[136:139], v[108:111], v[68:71], v[136:139]
    ds_read_b64_tr_b16 v[54:55], v12 offset:33792
    v_mfma_f32_16x16x32_bf16 v[140:143], v[112:115], v[68:71], v[140:143]
    ds_read_b64_tr_b16 v[56:57], v13 offset:32768
    v_mfma_f32_16x16x32_bf16 v[144:147], v[100:103], v[72:75], v[144:147]
    ds_read_b64_tr_b16 v[58:59], v13 offset:33792
    buffer_load_dwordx4 v3, s[4:7], s31 offen offset:1024 lds
    v_mfma_f32_16x16x32_bf16 v[148:151], v[104:107], v[72:75], v[148:151]
    ds_read_b64_tr_b16 v[60:61], v14 offset:32768
    v_mfma_f32_16x16x32_bf16 v[152:155], v[108:111], v[72:75], v[152:155]
    ds_read_b64_tr_b16 v[62:63], v14 offset:33792
    v_mfma_f32_16x16x32_bf16 v[156:159], v[112:115], v[72:75], v[156:159]
    ds_read_b64_tr_b16 v[64:65], v15 offset:32768
    buffer_load_dwordx4 v4, s[4:7], s31 offen offset:2048 lds
    v_mfma_f32_16x16x32_bf16 v[160:163], v[100:103], v[76:79], v[160:163]
    ds_read_b64_tr_b16 v[66:67], v15 offset:33792
    v_mfma_f32_16x16x32_bf16 v[164:167], v[104:107], v[76:79], v[164:167]
    ds_read_b128 v[24:27], v10 offset:34816
    v_mfma_f32_16x16x32_bf16 v[168:171], v[108:111], v[76:79], v[168:171]
    ds_read_b128 v[28:31], v10 offset:36864
    buffer_load_dwordx4 v5, s[4:7], s31 offen offset:3072 lds
    v_mfma_f32_16x16x32_bf16 v[172:175], v[112:115], v[76:79], v[172:175]
    ds_read_b128 v[32:35], v10 offset:38912
    v_mfma_f32_16x16x32_bf16 v[176:179], v[100:103], v[80:83], v[176:179]
    ds_read_b128 v[36:39], v10 offset:40960
    s_add_u32 m0, s34, 0
    v_mfma_f32_16x16x32_bf16 v[180:183], v[104:107], v[80:83], v[180:183]
    ds_read_b128 v[40:43], v10 offset:43008
    buffer_load_dwordx4 v6, s[8:11], s32 offen offset:0 nt lds
    v_mfma_f32_16x16x32_bf16 v[184:187], v[108:111], v[80:83], v[184:187]
    ds_read_b128 v[44:47], v10 offset:45056
    v_mfma_f32_16x16x32_bf16 v[188:191], v[112:115], v[80:83], v[188:191]
    ds_read_b128 v[48:51], v10 offset:47104
    v_mfma_f32_16x16x32_bf16 v[192:195], v[100:103], v[84:87], v[192:195]
    buffer_load_dwordx4 v7, s[8:11], s32 offen offset:1024 nt lds
    v_mfma_f32_16x16x32_bf16 v[196:199], v[104:107], v[84:87], v[196:199]
    v_mfma_f32_16x16x32_bf16 v[200:203], v[108:111], v[84:87], v[200:203]
    v_mfma_f32_16x16x32_bf16 v[204:207], v[112:115], v[84:87], v[204:207]
    buffer_load_dwordx4 v8, s[8:11], s32 offen offset:2048 nt lds
    v_mfma_f32_16x16x32_bf16 v[208:211], v[100:103], v[88:91], v[208:211]
    v_mfma_f32_16x16x32_bf16 v[212:215], v[104:107], v[88:91], v[212:215]
    v_mfma_f32_16x16x32_bf16 v[216:219], v[108:111], v[88:91], v[216:219]
    buffer_load_dwordx4 v9, s[8:11], s32 offen offset:3072 nt lds
    v_mfma_f32_16x16x32_bf16 v[220:223], v[112:115], v[88:91], v[220:223]
    v_mfma_f32_16x16x32_bf16 v[224:227], v[100:103], v[92:95], v[224:227]
    v_mfma_f32_16x16x32_bf16 v[228:231], v[104:107], v[92:95], v[228:231]
    v_mfma_f32_16x16x32_bf16 v[232:235], v[108:111], v[92:95], v[232:235]
    v_mfma_f32_16x16x32_bf16 v[236:239], v[112:115], v[92:95], v[236:239]
    v_mfma_f32_16x16x32_bf16 v[240:243], v[100:103], v[96:99], v[240:243]
    v_mfma_f32_16x16x32_bf16 v[244:247], v[104:107], v[96:99], v[244:247]
    v_mfma_f32_16x16x32_bf16 v[248:251], v[108:111], v[96:99], v[248:251]
    v_mfma_f32_16x16x32_bf16 v[252:255], v[112:115], v[96:99], v[252:255]
    s_bitcmp1_b32 3, s35
    s_cselect_b32 exec_lo, 255, 1
    s_mov_b32 exec_hi, 0
    global_load_dword v0, v17, s[96:97]
    s_mov_b64 exec, -1
    s_cselect_b32 s36, s45, 0
    v_add_u32 v17, s36, v17
    v_min_u32 v17, 8388480, v17
    s_nop 1
    s_add_u32 s31, s31, s40
    s_add_u32 s32, s32, s41
    s_waitcnt lgkmcnt(0)
    v_mfma_f32_16x16x32_bf16 v[128:131], v[52:55], v[20:23], v[128:131]
    ds_read_b128 v[68:71], v11 offset:32768
    v_mfma_f32_16x16x32_bf16 v[132:135], v[56:59], v[20:23], v[132:135]
    ds_read_b64_tr_b16 v[100:101], v12 offset:40960
    v_mfma_f32_16x16x32_bf16 v[136:139], v[60:63], v[20:23], v[136:139]
    ds_read_b64_tr_b16 v[102:103], v12 offset:41984
    v_mfma_f32_16x16x32_bf16 v[140:143], v[64:67], v[20:23], v[140:143]
    ds_read_b64_tr_b16 v[104:105], v13 offset:40960
    v_mfma_f32_16x16x32_bf16 v[144:147], v[52:55], v[24:27], v[144:147]
    ds_read_b64_tr_b16 v[106:107], v13 offset:41984
    v_mfma_f32_16x16x32_bf16 v[148:151], v[56:59], v[24:27], v[148:151]
    ds_read_b64_tr_b16 v[108:109], v14 offset:40960
    v_mfma_f32_16x16x32_bf16 v[152:155], v[60:63], v[24:27], v[152:155]
    ds_read_b64_tr_b16 v[110:111], v14 offset:41984
    v_mfma_f32_16x16x32_bf16 v[156:159], v[64:67], v[24:27], v[156:159]
    ds_read_b64_tr_b16 v[112:113], v15 offset:40960
    v_mfma_f32_16x16x32_bf16 v[160:163], v[52:55], v[28:31], v[160:163]
    ds_read_b64_tr_b16 v[114:115], v15 offset:41984
    v_mfma_f32_16x16x32_bf16 v[164:167], v[56:59], v[28:31], v[164:167]
    ds_read_b128 v[72:75], v11 offset:34816
    v_mfma_f32_16x16x32_bf16 v[168:171], v[60:63], v[28:31], v[168:171]
    ds_read_b128 v[76:79], v11 offset:36864
    v_mfma_f32_16x16x32_bf16 v[172:175], v[64:67], v[28:31], v[172:175]
    ds_read_b128 v[80:83], v11 offset:38912
    v_mfma_f32_16x16x32_bf16 v[176:179], v[52:55], v[32:35], v[176:179]
    ds_read_b128 v[84:87], v11 offset:40960
    v_mfma_f32_16x16x32_bf16 v[180:183], v[56:59], v[32:35], v[180:183]
    ds_read_b128 v[88:91], v11 offset:43008
    v_mfma_f32_16x16x32_bf16 v[184:187], v[60:63], v[32:35], v[184:187]
    ds_read_b128 v[92:95], v11 offset:45056
    v_mfma_f32_16x16x32_bf16 v[188:191], v[64:67], v[32:35], v[188:191]
    ds_read_b128 v[96:99], v11 offset:47104
    v_mfma_f32_16x16x32_bf16 v[192:195], v[52:55], v[36:39], v[192:195]
    v_mfma_f32_16x16x32_bf16 v[196:199], v[56:59], v[36:39], v[196:199]
    v_mfma_f32_16x16x32_bf16 v[200:203], v[60:63], v[36:39], v[200:203]
    v_mfma_f32_16x16x32_bf16 v[204:207], v[64:67], v[36:39], v[204:207]
    v_mfma_f32_16x16x32_bf16 v[208:211], v[52:55], v[40:43], v[208:211]
    s_bitcmp1_b32 s43, s35
    s_cbranch_scc1 L_recurrent_scan__compressed_kv_cla__moe_arch_mod__prompt_kernel_rare_13
L_recurrent_scan__compressed_kv_cla__moe_arch_mod__prompt_kernel_back_14:
    v_mfma_f32_16x16x32_bf16 v[212:215], v[56:59], v[40:43], v[212:215]
    v_mfma_f32_16x16x32_bf16 v[216:219], v[60:63], v[40:43], v[216:219]
    v_mfma_f32_16x16x32_bf16 v[220:223], v[64:67], v[40:43], v[220:223]
    v_mfma_f32_16x16x32_bf16 v[224:227], v[52:55], v[44:47], v[224:227]
    v_mfma_f32_16x16x32_bf16 v[228:231], v[56:59], v[44:47], v[228:231]
    v_mfma_f32_16x16x32_bf16 v[232:235], v[60:63], v[44:47], v[232:235]
    v_mfma_f32_16x16x32_bf16 v[236:239], v[64:67], v[44:47], v[236:239]
    v_mfma_f32_16x16x32_bf16 v[240:243], v[52:55], v[48:51], v[240:243]
    v_mfma_f32_16x16x32_bf16 v[244:247], v[56:59], v[48:51], v[244:247]
    v_mfma_f32_16x16x32_bf16 v[248:251], v[60:63], v[48:51], v[248:251]
    v_mfma_f32_16x16x32_bf16 v[252:255], v[64:67], v[48:51], v[252:255]
    s_bitcmp1_b32 s43, s35
    s_cbranch_scc1 L_recurrent_scan__compressed_kv_cla__moe_arch_mod__prompt_kernel_w0_15
    s_waitcnt vmcnt(1)
L_recurrent_scan__compressed_kv_cla__moe_arch_mod__prompt_kernel_w0b_16:
    s_waitcnt lgkmcnt(0)
    s_cmp_eq_u32 s35, 3
    s_barrier
    s_cbranch_scc1 L_p1_fin0
    v_mfma_f32_16x16x32_bf16 v[128:131], v[100:103], v[68:71], v[128:131]
    ds_read_b128 v[20:23], v10 offset:0
    s_add_u32 m0, s33, 32768
    v_mfma_f32_16x16x32_bf16 v[132:135], v[104:107], v[68:71], v[132:135]
    ds_read_b64_tr_b16 v[52:53], v12 offset:0
    buffer_load_dwordx4 v2, s[4:7], s31 offen offset:0 lds
    v_mfma_f32_16x16x32_bf16 v[136:139], v[108:111], v[68:71], v[136:139]
    ds_read_b64_tr_b16 v[54:55], v12 offset:1024
    v_mfma_f32_16x16x32_bf16 v[140:143], v[112:115], v[68:71], v[140:143]
    ds_read_b64_tr_b16 v[56:57], v13 offset:0
    v_mfma_f32_16x16x32_bf16 v[144:147], v[100:103], v[72:75], v[144:147]
    ds_read_b64_tr_b16 v[58:59], v13 offset:1024
    buffer_load_dwordx4 v3, s[4:7], s31 offen offset:1024 lds
    v_mfma_f32_16x16x32_bf16 v[148:151], v[104:107], v[72:75], v[148:151]
    ds_read_b64_tr_b16 v[60:61], v14 offset:0
    v_mfma_f32_16x16x32_bf16 v[152:155], v[108:111], v[72:75], v[152:155]
    ds_read_b64_tr_b16 v[62:63], v14 offset:1024
    v_mfma_f32_16x16x32_bf16 v[156:159], v[112:115], v[72:75], v[156:159]
    ds_read_b64_tr_b16 v[64:65], v15 offset:0
    buffer_load_dwordx4 v4, s[4:7], s31 offen offset:2048 lds
    v_mfma_f32_16x16x32_bf16 v[160:163], v[100:103], v[76:79], v[160:163]
    ds_read_b64_tr_b16 v[66:67], v15 offset:1024
    v_mfma_f32_16x16x32_bf16 v[164:167], v[104:107], v[76:79], v[164:167]
    ds_read_b128 v[24:27], v10 offset:2048
    v_mfma_f32_16x16x32_bf16 v[168:171], v[108:111], v[76:79], v[168:171]
    ds_read_b128 v[28:31], v10 offset:4096
    buffer_load_dwordx4 v5, s[4:7], s31 offen offset:3072 lds
    v_mfma_f32_16x16x32_bf16 v[172:175], v[112:115], v[76:79], v[172:175]
    ds_read_b128 v[32:35], v10 offset:6144
    v_mfma_f32_16x16x32_bf16 v[176:179], v[100:103], v[80:83], v[176:179]
    ds_read_b128 v[36:39], v10 offset:8192
    s_add_u32 m0, s34, 32768
    v_mfma_f32_16x16x32_bf16 v[180:183], v[104:107], v[80:83], v[180:183]
    ds_read_b128 v[40:43], v10 offset:10240
    buffer_load_dwordx4 v6, s[8:11], s32 offen offset:0 nt lds
    v_mfma_f32_16x16x32_bf16 v[184:187], v[108:111], v[80:83], v[184:187]
    ds_read_b128 v[44:47], v10 offset:12288
    v_mfma_f32_16x16x32_bf16 v[188:191], v[112:115], v[80:83], v[188:191]
    ds_read_b128 v[48:51], v10 offset:14336
    v_mfma_f32_16x16x32_bf16 v[192:195], v[100:103], v[84:87], v[192:195]
    buffer_load_dwordx4 v7, s[8:11], s32 offen offset:1024 nt lds
    v_mfma_f32_16x16x32_bf16 v[196:199], v[104:107], v[84:87], v[196:199]
    v_mfma_f32_16x16x32_bf16 v[200:203], v[108:111], v[84:87], v[200:203]
    v_mfma_f32_16x16x32_bf16 v[204:207], v[112:115], v[84:87], v[204:207]
    buffer_load_dwordx4 v8, s[8:11], s32 offen offset:2048 nt lds
    v_mfma_f32_16x16x32_bf16 v[208:211], v[100:103], v[88:91], v[208:211]
    v_mfma_f32_16x16x32_bf16 v[212:215], v[104:107], v[88:91], v[212:215]
    v_mfma_f32_16x16x32_bf16 v[216:219], v[108:111], v[88:91], v[216:219]
    buffer_load_dwordx4 v9, s[8:11], s32 offen offset:3072 nt lds
    v_mfma_f32_16x16x32_bf16 v[220:223], v[112:115], v[88:91], v[220:223]
    v_mfma_f32_16x16x32_bf16 v[224:227], v[100:103], v[92:95], v[224:227]
    v_mfma_f32_16x16x32_bf16 v[228:231], v[104:107], v[92:95], v[228:231]
    v_mfma_f32_16x16x32_bf16 v[232:235], v[108:111], v[92:95], v[232:235]
    v_mfma_f32_16x16x32_bf16 v[236:239], v[112:115], v[92:95], v[236:239]
    v_mfma_f32_16x16x32_bf16 v[240:243], v[100:103], v[96:99], v[240:243]
    v_mfma_f32_16x16x32_bf16 v[244:247], v[104:107], v[96:99], v[244:247]
    v_mfma_f32_16x16x32_bf16 v[248:251], v[108:111], v[96:99], v[248:251]
    s_add_u32 s36, s35, s28
    s_cmp_eq_u32 s36, 0
    s_cbranch_scc1 L_recurrent_scan__compressed_kv_cla__moe_arch_mod__prompt_kernel_rare_25
L_recurrent_scan__compressed_kv_cla__moe_arch_mod__prompt_kernel_back_26:
    v_mfma_f32_16x16x32_bf16 v[252:255], v[112:115], v[96:99], v[252:255]
    s_bitcmp1_b32 3, s35
    s_cselect_b32 exec_lo, 255, 1
    s_mov_b32 exec_hi, 0
    global_load_dword v0, v17, s[96:97]
    s_mov_b64 exec, -1
    s_cselect_b32 s36, s45, 0
    v_add_u32 v17, s36, v17
    v_min_u32 v17, 8388480, v17
    s_nop 1
    s_add_u32 s31, s31, s40
    s_add_u32 s32, s32, s41
    s_add_u32 s35, s35, 1
    s_branch L_kv_kloop
L_p1_fin0:
    v_mfma_f32_16x16x32_bf16 v[128:131], v[100:103], v[68:71], v[128:131]
    s_and_b32 s36, s28, 3
    s_sub_u32 s37, 15, s30
    s_cmp_lt_u32 s28, 4
    s_cselect_b32 s37, s37, s30
    s_lshl_b32 s37, s37, 2
    s_add_u32 s37, s37, s36
    s_lshl_b32 s37, s37, 16
    v_lshl_add_u32 v6, v1, 4, s37
    v_add_u32 v7, 32768, v6
    s_mov_b32 s32, 0
    s_mov_b32 s8, s54
    s_and_b32 s9, s55, 0xffff
    s_mov_b32 s10, 4194304
    s_mov_b32 s11, 0x20000
    v_mfma_f32_16x16x32_bf16 v[132:135], v[104:107], v[68:71], v[132:135]
    buffer_load_dwordx4 v[24:27], v6, s[8:11], s32 offen offset:0 sc1
    v_mfma_f32_16x16x32_bf16 v[136:139], v[108:111], v[68:71], v[136:139]
    v_lshrrev_b32 v18, 4, v1
    v_mfma_f32_16x16x32_bf16 v[140:143], v[112:115], v[68:71], v[140:143]
    v_bfe_u32 v20, v1, 2, 2
    v_mfma_f32_16x16x32_bf16 v[144:147], v[100:103], v[72:75], v[144:147]
    v_lshl_add_u32 v19, v18, 3, v20
    v_mfma_f32_16x16x32_bf16 v[148:151], v[104:107], v[72:75], v[148:151]
    buffer_load_dwordx4 v[28:31], v7, s[8:11], s32 offen offset:0 sc1
    v_lshlrev_b32 v19, 8, v19
    v_mfma_f32_16x16x32_bf16 v[152:155], v[108:111], v[72:75], v[152:155]
    v_and_b32 v21, 3, v1
    v_mfma_f32_16x16x32_bf16 v[156:159], v[112:115], v[72:75], v[156:159]
    v_lshl_add_u32 v19, v21, 3, v19
    v_mfma_f32_16x16x32_bf16 v[160:163], v[100:103], v[76:79], v[160:163]
    v_and_b32 v21, 1, v18
    v_mfma_f32_16x16x32_bf16 v[164:167], v[104:107], v[76:79], v[164:167]
    buffer_load_dwordx4 v[32:35], v6, s[8:11], s32 offen offset:1024 sc1
    v_lshl_add_u32 v20, v21, 2, v20
    v_mfma_f32_16x16x32_bf16 v[168:171], v[108:111], v[76:79], v[168:171]
    v_xor_b32 v21, 0, v20
    v_mfma_f32_16x16x32_bf16 v[172:175], v[112:115], v[76:79], v[172:175]
    v_lshl_add_u32 v10, v21, 5, v19
    v_mfma_f32_16x16x32_bf16 v[176:179], v[100:103], v[80:83], v[176:179]
    v_xor_b32 v21, 1, v20
    v_mfma_f32_16x16x32_bf16 v[180:183], v[104:107], v[80:83], v[180:183]
    buffer_load_dwordx4 v[36:39], v7, s[8:11], s32 offen offset:1024 sc1
    v_lshl_add_u32 v11, v21, 5, v19
    v_mfma_f32_16x16x32_bf16 v[184:187], v[108:111], v[80:83], v[184:187]
    v_xor_b32 v21, 2, v20
    v_mfma_f32_16x16x32_bf16 v[188:191], v[112:115], v[80:83], v[188:191]
    v_lshl_add_u32 v12, v21, 5, v19
    v_mfma_f32_16x16x32_bf16 v[192:195], v[100:103], v[84:87], v[192:195]
    v_xor_b32 v21, 3, v20
    v_mfma_f32_16x16x32_bf16 v[196:199], v[104:107], v[84:87], v[196:199]
    buffer_load_dwordx4 v[40:43], v6, s[8:11], s32 offen offset:2048 sc1
    v_lshl_add_u32 v13, v21, 5, v19
    v_mfma_f32_16x16x32_bf16 v[200:203], v[108:111], v[84:87], v[200:203]
    v_xor_b32 v21, 4, v20
    v_mfma_f32_16x16x32_bf16 v[204:207], v[112:115], v[84:87], v[204:207]
    v_lshl_add_u32 v14, v21, 5, v19
    v_mfma_f32_16x16x32_bf16 v[208:211], v[100:103], v[88:91], v[208:211]
    v_xor_b32 v21, 5, v20
    v_mfma_f32_16x16x32_bf16 v[212:215], v[104:107], v[88:91], v[212:215]
    buffer_load_dwordx4 v[44:47], v7, s[8:11], s32 offen offset:2048 sc1
    v_lshl_add_u32 v15, v21, 5, v19
    v_mfma_f32_16x16x32_bf16 v[216:219], v[108:111], v[88:91], v[216:219]
    v_xor_b32 v21, 6, v20
    v_mfma_f32_16x16x32_bf16 v[220:223], v[112:115], v[88:91], v[220:223]
    v_lshl_add_u32 v16, v21, 5, v19
    v_mfma_f32_16x16x32_bf16 v[224:227], v[100:103], v[92:95], v[224:227]
    v_xor_b32 v21, 7, v20
    v_mfma_f32_16x16x32_bf16 v[228:231], v[104:107], v[92:95], v[228:231]
    buffer_load_dwordx4 v[48:51], v6, s[8:11], s32 offen offset:3072 sc1
    v_lshl_add_u32 v17, v21, 5, v19
    v_mfma_f32_16x16x32_bf16 v[232:235], v[108:111], v[92:95], v[232:235]
    s_lshl_b32 s45, s29, 20
    v_mfma_f32_16x16x32_bf16 v[236:239], v[112:115], v[92:95], v[236:239]
    v_mfma_f32_16x16x32_bf16 v[240:243], v[100:103], v[96:99], v[240:243]
    v_mfma_f32_16x16x32_bf16 v[244:247], v[104:107], v[96:99], v[244:247]
    buffer_load_dwordx4 v[52:55], v7, s[8:11], s32 offen offset:3072 sc1
    v_mfma_f32_16x16x32_bf16 v[248:251], v[108:111], v[96:99], v[248:251]
    v_mfma_f32_16x16x32_bf16 v[252:255], v[112:115], v[96:99], v[252:255]
    s_branch L_p1_done
    .p2align 6
L_kv_vloop:
    s_waitcnt lgkmcnt(0)
    v_mfma_f32_16x16x32_bf16 v[128:131], v[20:23], v[52:55], v[128:131]
    ds_read_b128 v[68:71], v11 offset:0
    v_mfma_f32_16x16x32_bf16 v[160:163], v[20:23], v[56:59], v[160:163]
    ds_read_b64_tr_b16 v[100:101], v12 offset:8192
    v_mfma_f32_16x16x32_bf16 v[192:195], v[20:23], v[60:63], v[192:195]
    ds_read_b64_tr_b16 v[102:103], v12 offset:9216
    v_mfma_f32_16x16x32_bf16 v[224:227], v[20:23], v[64:67], v[224:227]
    ds_read_b64_tr_b16 v[104:105], v13 offset:8192
    v_mfma_f32_16x16x32_bf16 v[132:135], v[24:27], v[52:55], v[132:135]
    ds_read_b64_tr_b16 v[106:107], v13 offset:9216
    v_mfma_f32_16x16x32_bf16 v[164:167], v[24:27], v[56:59], v[164:167]
    ds_read_b64_tr_b16 v[108:109], v14 offset:8192
    v_mfma_f32_16x16x32_bf16 v[196:199], v[24:27], v[60:63], v[196:199]
    ds_read_b64_tr_b16 v[110:111], v14 offset:9216
    v_mfma_f32_16x16x32_bf16 v[228:231], v[24:27], v[64:67], v[228:231]
    ds_read_b64_tr_b16 v[112:113], v15 offset:8192
    v_mfma_f32_16x16x32_bf16 v[136:139], v[28:31], v[52:55], v[136:139]
    ds_read_b64_tr_b16 v[114:115], v15 offset:9216
    v_mfma_f32_16x16x32_bf16 v[168:171], v[28:31], v[56:59], v[168:171]
    ds_read_b128 v[72:75], v11 offset:2048
    v_mfma_f32_16x16x32_bf16 v[200:203], v[28:31], v[60:63], v[200:203]
    ds_read_b128 v[76:79], v11 offset:4096
    v_mfma_f32_16x16x32_bf16 v[232:235], v[28:31], v[64:67], v[232:235]
    ds_read_b128 v[80:83], v11 offset:6144
    v_mfma_f32_16x16x32_bf16 v[140:143], v[32:35], v[52:55], v[140:143]
    ds_read_b128 v[84:87], v11 offset:8192
    v_mfma_f32_16x16x32_bf16 v[172:175], v[32:35], v[56:59], v[172:175]
    ds_read_b128 v[88:91], v11 offset:10240
    v_mfma_f32_16x16x32_bf16 v[204:207], v[32:35], v[60:63], v[204:207]
    ds_read_b128 v[92:95], v11 offset:12288
    v_mfma_f32_16x16x32_bf16 v[236:239], v[32:35], v[64:67], v[236:239]
    ds_read_b128 v[96:99], v11 offset:14336
    v_mfma_f32_16x16x32_bf16 v[144:147], v[36:39], v[52:55], v[144:147]
    v_mfma_f32_16x16x32_bf16 v[176:179], v[36:39], v[56:59], v[176:179]
    v_mfma_f32_16x16x32_bf16 v[208:211], v[36:39], v[60:63], v[208:211]
    v_mfma_f32_16x16x32_bf16 v[240:243], v[36:39], v[64:67], v[240:243]
    v_mfma_f32_16x16x32_bf16 v[148:151], v[40:43], v[52:55], v[148:151]
    v_mfma_f32_16x16x32_bf16 v[180:183], v[40:43], v[56:59], v[180:183]
    v_mfma_f32_16x16x32_bf16 v[212:215], v[40:43], v[60:63], v[212:215]
    v_mfma_f32_16x16x32_bf16 v[244:247], v[40:43], v[64:67], v[244:247]
    v_mfma_f32_16x16x32_bf16 v[152:155], v[44:47], v[52:55], v[152:155]
    v_mfma_f32_16x16x32_bf16 v[184:187], v[44:47], v[56:59], v[184:187]
    v_mfma_f32_16x16x32_bf16 v[216:219], v[44:47], v[60:63], v[216:219]
    v_mfma_f32_16x16x32_bf16 v[248:251], v[44:47], v[64:67], v[248:251]
    v_mfma_f32_16x16x32_bf16 v[156:159], v[48:51], v[52:55], v[156:159]
    v_mfma_f32_16x16x32_bf16 v[188:191], v[48:51], v[56:59], v[188:191]
    v_mfma_f32_16x16x32_bf16 v[220:223], v[48:51], v[60:63], v[220:223]
    v_mfma_f32_16x16x32_bf16 v[252:255], v[48:51], v[64:67], v[252:255]
    s_cmp_lt_u32 s35, s44
    s_cbranch_scc1 L_recurrent_scan__compressed_kv_cla__moe_arch_mod__prompt_kernel_w0_27
    s_waitcnt vmcnt(1)
L_recurrent_scan__compressed_kv_cla__moe_arch_mod__prompt_kernel_w0b_28:
    s_waitcnt lgkmcnt(0)
    s_barrier
    s_add_u32 m0, s33, 0
    s_nop 0
    buffer_load_dwordx4 v2, s[4:7], s31 offen offset:0 lds
    buffer_load_dwordx4 v3, s[4:7], s31 offen offset:1024 lds
    buffer_load_dwordx4 v4, s[4:7], s31 offen offset:2048 lds
    buffer_load_dwordx4 v5, s[4:7], s31 offen offset:3072 lds
    s_add_u32 m0, s34, 0
    s_nop 0
    buffer_load_dwordx4 v6, s[8:11], s32 offen offset:0 nt lds
    buffer_load_dwordx4 v7, s[8:11], s32 offen offset:1024 nt lds
    buffer_load_dwordx4 v8, s[8:11], s32 offen offset:2048 nt lds
    buffer_load_dwordx4 v9, s[8:11], s32 offen offset:3072 nt lds
    s_add_u32 s31, s31, s40
    s_add_u32 s32, s32, s41
    s_cmp_eq_u32 s35, 0
    s_cbranch_scc1 L_recurrent_scan__compressed_kv_cla__moe_arch_mod__prompt_kernel_rare_32
L_recurrent_scan__compressed_kv_cla__moe_arch_mod__prompt_kernel_back_33:
    v_mfma_f32_16x16x32_bf16 v[128:131], v[68:71], v[100:103], v[128:131]
    ds_read_b128 v[20:23], v10 offset:32768
    v_mfma_f32_16x16x32_bf16 v[160:163], v[68:71], v[104:107], v[160:163]
    ds_read_b64_tr_b16 v[52:53], v12 offset:32768
    v_mfma_f32_16x16x32_bf16 v[192:195], v[68:71], v[108:111], v[192:195]
    ds_read_b64_tr_b16 v[54:55], v12 offset:33792
    v_mfma_f32_16x16x32_bf16 v[224:227], v[68:71], v[112:115], v[224:227]
    ds_read_b64_tr_b16 v[56:57], v13 offset:32768
    v_mfma_f32_16x16x32_bf16 v[132:135], v[72:75], v[100:103], v[132:135]
    ds_read_b64_tr_b16 v[58:59], v13 offset:33792
    v_mfma_f32_16x16x32_bf16 v[164:167], v[72:75], v[104:107], v[164:167]
    ds_read_b64_tr_b16 v[60:61], v14 offset:32768
    v_mfma_f32_16x16x32_bf16 v[196:199], v[72:75], v[108:111], v[196:199]
    ds_read_b64_tr_b16 v[62:63], v14 offset:33792
    v_mfma_f32_16x16x32_bf16 v[228:231], v[72:75], v[112:115], v[228:231]
    ds_read_b64_tr_b16 v[64:65], v15 offset:32768
    v_mfma_f32_16x16x32_bf16 v[136:139], v[76:79], v[100:103], v[136:139]
    ds_read_b64_tr_b16 v[66:67], v15 offset:33792
    v_mfma_f32_16x16x32_bf16 v[168:171], v[76:79], v[104:107], v[168:171]
    ds_read_b128 v[24:27], v10 offset:34816
    v_mfma_f32_16x16x32_bf16 v[200:203], v[76:79], v[108:111], v[200:203]
    ds_read_b128 v[28:31], v10 offset:36864
    v_mfma_f32_16x16x32_bf16 v[232:235], v[76:79], v[112:115], v[232:235]
    ds_read_b128 v[32:35], v10 offset:38912
    v_mfma_f32_16x16x32_bf16 v[140:143], v[80:83], v[100:103], v[140:143]
    ds_read_b128 v[36:39], v10 offset:40960
    v_mfma_f32_16x16x32_bf16 v[172:175], v[80:83], v[104:107], v[172:175]
    ds_read_b128 v[40:43], v10 offset:43008
    v_mfma_f32_16x16x32_bf16 v[204:207], v[80:83], v[108:111], v[204:207]
    ds_read_b128 v[44:47], v10 offset:45056
    v_mfma_f32_16x16x32_bf16 v[236:239], v[80:83], v[112:115], v[236:239]
    ds_read_b128 v[48:51], v10 offset:47104
    v_mfma_f32_16x16x32_bf16 v[144:147], v[84:87], v[100:103], v[144:147]
    v_mfma_f32_16x16x32_bf16 v[176:179], v[84:87], v[104:107], v[176:179]
    v_mfma_f32_16x16x32_bf16 v[208:211], v[84:87], v[108:111], v[208:211]
    v_mfma_f32_16x16x32_bf16 v[240:243], v[84:87], v[112:115], v[240:243]
    v_mfma_f32_16x16x32_bf16 v[148:151], v[88:91], v[100:103], v[148:151]
    v_mfma_f32_16x16x32_bf16 v[180:183], v[88:91], v[104:107], v[180:183]
    v_mfma_f32_16x16x32_bf16 v[212:215], v[88:91], v[108:111], v[212:215]
    v_mfma_f32_16x16x32_bf16 v[244:247], v[88:91], v[112:115], v[244:247]
    v_mfma_f32_16x16x32_bf16 v[152:155], v[92:95], v[100:103], v[152:155]
    v_mfma_f32_16x16x32_bf16 v[184:187], v[92:95], v[104:107], v[184:187]
    v_mfma_f32_16x16x32_bf16 v[216:219], v[92:95], v[108:111], v[216:219]
    v_mfma_f32_16x16x32_bf16 v[248:251], v[92:95], v[112:115], v[248:251]
    v_mfma_f32_16x16x32_bf16 v[156:159], v[96:99], v[100:103], v[156:159]
    v_mfma_f32_16x16x32_bf16 v[188:191], v[96:99], v[104:107], v[188:191]
    v_mfma_f32_16x16x32_bf16 v[220:223], v[96:99], v[108:111], v[220:223]
    v_mfma_f32_16x16x32_bf16 v[252:255], v[96:99], v[112:115], v[252:255]
    s_bitcmp1_b32 3, s35
    s_cselect_b32 exec_lo, 255, 1
    s_mov_b32 exec_hi, 0
    global_load_dword v0, v17, s[96:97]
    s_mov_b64 exec, -1
    s_cselect_b32 s36, s45, 0
    v_add_u32 v17, s36, v17
    v_min_u32 v17, 8388480, v17
    s_nop 1
    s_waitcnt lgkmcnt(0)
    v_mfma_f32_16x16x32_bf16 v[128:131], v[20:23], v[52:55], v[128:131]
    ds_read_b128 v[68:71], v11 offset:32768
    v_mfma_f32_16x16x32_bf16 v[160:163], v[20:23], v[56:59], v[160:163]
    ds_read_b64_tr_b16 v[100:101], v12 offset:40960
    v_mfma_f32_16x16x32_bf16 v[192:195], v[20:23], v[60:63], v[192:195]
    ds_read_b64_tr_b16 v[102:103], v12 offset:41984
    v_mfma_f32_16x16x32_bf16 v[224:227], v[20:23], v[64:67], v[224:227]
    ds_read_b64_tr_b16 v[104:105], v13 offset:40960
    v_mfma_f32_16x16x32_bf16 v[132:135], v[24:27], v[52:55], v[132:135]
    ds_read_b64_tr_b16 v[106:107], v13 offset:41984
    v_mfma_f32_16x16x32_bf16 v[164:167], v[24:27], v[56:59], v[164:167]
    ds_read_b64_tr_b16 v[108:109], v14 offset:40960
    v_mfma_f32_16x16x32_bf16 v[196:199], v[24:27], v[60:63], v[196:199]
    ds_read_b64_tr_b16 v[110:111], v14 offset:41984
    v_mfma_f32_16x16x32_bf16 v[228:231], v[24:27], v[64:67], v[228:231]
    ds_read_b64_tr_b16 v[112:113], v15 offset:40960
    v_mfma_f32_16x16x32_bf16 v[136:139], v[28:31], v[52:55], v[136:139]
    ds_read_b64_tr_b16 v[114:115], v15 offset:41984
    v_mfma_f32_16x16x32_bf16 v[168:171], v[28:31], v[56:59], v[168:171]
    ds_read_b128 v[72:75], v11 offset:34816
    v_mfma_f32_16x16x32_bf16 v[200:203], v[28:31], v[60:63], v[200:203]
    ds_read_b128 v[76:79], v11 offset:36864
    v_mfma_f32_16x16x32_bf16 v[232:235], v[28:31], v[64:67], v[232:235]
    ds_read_b128 v[80:83], v11 offset:38912
    v_mfma_f32_16x16x32_bf16 v[140:143], v[32:35], v[52:55], v[140:143]
    ds_read_b128 v[84:87], v11 offset:40960
    v_mfma_f32_16x16x32_bf16 v[172:175], v[32:35], v[56:59], v[172:175]
    ds_read_b128 v[88:91], v11 offset:43008
    v_mfma_f32_16x16x32_bf16 v[204:207], v[32:35], v[60:63], v[204:207]
    ds_read_b128 v[92:95], v11 offset:45056
    v_mfma_f32_16x16x32_bf16 v[236:239], v[32:35], v[64:67], v[236:239]
    ds_read_b128 v[96:99], v11 offset:47104
    v_mfma_f32_16x16x32_bf16 v[144:147], v[36:39], v[52:55], v[144:147]
    v_mfma_f32_16x16x32_bf16 v[176:179], v[36:39], v[56:59], v[176:179]
    v_mfma_f32_16x16x32_bf16 v[208:211], v[36:39], v[60:63], v[208:211]
    v_mfma_f32_16x16x32_bf16 v[240:243], v[36:39], v[64:67], v[240:243]
    v_mfma_f32_16x16x32_bf16 v[148:151], v[40:43], v[52:55], v[148:151]
    v_mfma_f32_16x16x32_bf16 v[180:183], v[40:43], v[56:59], v[180:183]
    v_mfma_f32_16x16x32_bf16 v[212:215], v[40:43], v[60:63], v[212:215]
    v_mfma_f32_16x16x32_bf16 v[244:247], v[40:43], v[64:67], v[244:247]
    v_mfma_f32_16x16x32_bf16 v[152:155], v[44:47], v[52:55], v[152:155]
    v_mfma_f32_16x16x32_bf16 v[184:187], v[44:47], v[56:59], v[184:187]
    v_mfma_f32_16x16x32_bf16 v[216:219], v[44:47], v[60:63], v[216:219]
    v_mfma_f32_16x16x32_bf16 v[248:251], v[44:47], v[64:67], v[248:251]
    v_mfma_f32_16x16x32_bf16 v[156:159], v[48:51], v[52:55], v[156:159]
    v_mfma_f32_16x16x32_bf16 v[188:191], v[48:51], v[56:59], v[188:191]
    v_mfma_f32_16x16x32_bf16 v[220:223], v[48:51], v[60:63], v[220:223]
    v_mfma_f32_16x16x32_bf16 v[252:255], v[48:51], v[64:67], v[252:255]
    s_waitcnt vmcnt(1) lgkmcnt(0)
    s_cmp_eq_u32 s35, 3
    s_barrier
    s_cbranch_scc1 L_p1_fin1
    s_add_u32 m0, s33, 32768
    s_nop 0
    buffer_load_dwordx4 v2, s[4:7], s31 offen offset:0 lds
    buffer_load_dwordx4 v3, s[4:7], s31 offen offset:1024 lds
    buffer_load_dwordx4 v4, s[4:7], s31 offen offset:2048 lds
    buffer_load_dwordx4 v5, s[4:7], s31 offen offset:3072 lds
    s_add_u32 m0, s34, 32768
    s_nop 0
    buffer_load_dwordx4 v6, s[8:11], s32 offen offset:0 nt lds
    buffer_load_dwordx4 v7, s[8:11], s32 offen offset:1024 nt lds
    buffer_load_dwordx4 v8, s[8:11], s32 offen offset:2048 nt lds
    buffer_load_dwordx4 v9, s[8:11], s32 offen offset:3072 nt lds
    s_add_u32 s31, s31, s40
    s_add_u32 s32, s32, s41
    s_cmp_eq_u32 s35, 2
    s_cbranch_scc1 L_recurrent_scan__compressed_kv_cla__moe_arch_mod__prompt_kernel_rare_36
L_recurrent_scan__compressed_kv_cla__moe_arch_mod__prompt_kernel_back_37:
    v_mfma_f32_16x16x32_bf16 v[128:131], v[68:71], v[100:103], v[128:131]
    ds_read_b128 v[20:23], v10 offset:0
    v_mfma_f32_16x16x32_bf16 v[160:163], v[68:71], v[104:107], v[160:163]
    ds_read_b64_tr_b16 v[52:53], v12 offset:0
    v_mfma_f32_16x16x32_bf16 v[192:195], v[68:71], v[108:111], v[192:195]
    ds_read_b64_tr_b16 v[54:55], v12 offset:1024
    v_mfma_f32_16x16x32_bf16 v[224:227], v[68:71], v[112:115], v[224:227]
    ds_read_b64_tr_b16 v[56:57], v13 offset:0
    v_mfma_f32_16x16x32_bf16 v[132:135], v[72:75], v[100:103], v[132:135]
    ds_read_b64_tr_b16 v[58:59], v13 offset:1024
    v_mfma_f32_16x16x32_bf16 v[164:167], v[72:75], v[104:107], v[164:167]
    ds_read_b64_tr_b16 v[60:61], v14 offset:0
    v_mfma_f32_16x16x32_bf16 v[196:199], v[72:75], v[108:111], v[196:199]
    ds_read_b64_tr_b16 v[62:63], v14 offset:1024
    v_mfma_f32_16x16x32_bf16 v[228:231], v[72:75], v[112:115], v[228:231]
    ds_read_b64_tr_b16 v[64:65], v15 offset:0
    v_mfma_f32_16x16x32_bf16 v[136:139], v[76:79], v[100:103], v[136:139]
    ds_read_b64_tr_b16 v[66:67], v15 offset:1024
    v_mfma_f32_16x16x32_bf16 v[168:171], v[76:79], v[104:107], v[168:171]
    ds_read_b128 v[24:27], v10 offset:2048
    v_mfma_f32_16x16x32_bf16 v[200:203], v[76:79], v[108:111], v[200:203]
    ds_read_b128 v[28:31], v10 offset:4096
    v_mfma_f32_16x16x32_bf16 v[232:235], v[76:79], v[112:115], v[232:235]
    ds_read_b128 v[32:35], v10 offset:6144
    v_mfma_f32_16x16x32_bf16 v[140:143], v[80:83], v[100:103], v[140:143]
    ds_read_b128 v[36:39], v10 offset:8192
    v_mfma_f32_16x16x32_bf16 v[172:175], v[80:83], v[104:107], v[172:175]
    ds_read_b128 v[40:43], v10 offset:10240
    v_mfma_f32_16x16x32_bf16 v[204:207], v[80:83], v[108:111], v[204:207]
    ds_read_b128 v[44:47], v10 offset:12288
    v_mfma_f32_16x16x32_bf16 v[236:239], v[80:83], v[112:115], v[236:239]
    ds_read_b128 v[48:51], v10 offset:14336
    v_mfma_f32_16x16x32_bf16 v[144:147], v[84:87], v[100:103], v[144:147]
    v_mfma_f32_16x16x32_bf16 v[176:179], v[84:87], v[104:107], v[176:179]
    v_mfma_f32_16x16x32_bf16 v[208:211], v[84:87], v[108:111], v[208:211]
    v_mfma_f32_16x16x32_bf16 v[240:243], v[84:87], v[112:115], v[240:243]
    v_mfma_f32_16x16x32_bf16 v[148:151], v[88:91], v[100:103], v[148:151]
    v_mfma_f32_16x16x32_bf16 v[180:183], v[88:91], v[104:107], v[180:183]
    v_mfma_f32_16x16x32_bf16 v[212:215], v[88:91], v[108:111], v[212:215]
    v_mfma_f32_16x16x32_bf16 v[244:247], v[88:91], v[112:115], v[244:247]
    v_mfma_f32_16x16x32_bf16 v[152:155], v[92:95], v[100:103], v[152:155]
    v_mfma_f32_16x16x32_bf16 v[184:187], v[92:95], v[104:107], v[184:187]
    v_mfma_f32_16x16x32_bf16 v[216:219], v[92:95], v[108:111], v[216:219]
    v_mfma_f32_16x16x32_bf16 v[248:251], v[92:95], v[112:115], v[248:251]
    v_mfma_f32_16x16x32_bf16 v[156:159], v[96:99], v[100:103], v[156:159]
    v_mfma_f32_16x16x32_bf16 v[188:191], v[96:99], v[104:107], v[188:191]
    v_mfma_f32_16x16x32_bf16 v[220:223], v[96:99], v[108:111], v[220:223]
    v_mfma_f32_16x16x32_bf16 v[252:255], v[96:99], v[112:115], v[252:255]
    s_bitcmp1_b32 3, s35
    s_cselect_b32 exec_lo, 255, 1
    s_mov_b32 exec_hi, 0
    global_load_dword v0, v17, s[96:97]
    s_mov_b64 exec, -1
    s_cselect_b32 s36, s45, 0
    v_add_u32 v17, s36, v17
    v_min_u32 v17, 8388480, v17
    s_nop 1
    s_add_u32 s35, s35, 1
    s_branch L_kv_vloop
L_p1_fin1:
    s_and_b32 s36, s28, 3
    s_sub_u32 s37, 15, s30
    s_cmp_lt_u32 s28, 4
    s_cselect_b32 s37, s37, s30
    s_lshl_b32 s37, s37, 2
    s_add_u32 s37, s37, s36
    s_lshl_b32 s37, s37, 16
    v_lshl_add_u32 v6, v1, 4, s37
    v_add_u32 v7, 32768, v6
    s_mov_b32 s32, 0
    s_mov_b32 s8, s54
    s_and_b32 s9, s55, 0xffff
    s_mov_b32 s10, 4194304
    s_mov_b32 s11, 0x20000
    v_mfma_f32_16x16x32_bf16 v[128:131], v[68:71], v[100:103], v[128:131]
    v_mfma_f32_16x16x32_bf16 v[160:163], v[68:71], v[104:107], v[160:163]
    buffer_load_dwordx4 v[24:27], v6, s[8:11], s32 offen offset:0 sc1
    v_mfma_f32_16x16x32_bf16 v[192:195], v[68:71], v[108:111], v[192:195]
    v_lshrrev_b32 v18, 4, v1
    v_mfma_f32_16x16x32_bf16 v[224:227], v[68:71], v[112:115], v[224:227]
    v_bfe_u32 v20, v1, 2, 2
    v_mfma_f32_16x16x32_bf16 v[132:135], v[72:75], v[100:103], v[132:135]
    v_lshl_add_u32 v19, v18, 3, v20
    v_mfma_f32_16x16x32_bf16 v[164:167], v[72:75], v[104:107], v[164:167]
    buffer_load_dwordx4 v[28:31], v7, s[8:11], s32 offen offset:0 sc1
    v_lshlrev_b32 v19, 8, v19
    v_mfma_f32_16x16x32_bf16 v[196:199], v[72:75], v[108:111], v[196:199]
    v_and_b32 v21, 3, v1
    v_mfma_f32_16x16x32_bf16 v[228:231], v[72:75], v[112:115], v[228:231]
    v_lshl_add_u32 v19, v21, 3, v19
    v_mfma_f32_16x16x32_bf16 v[136:139], v[76:79], v[100:103], v[136:139]
    v_and_b32 v21, 1, v18
    v_mfma_f32_16x16x32_bf16 v[168:171], v[76:79], v[104:107], v[168:171]
    buffer_load_dwordx4 v[32:35], v6, s[8:11], s32 offen offset:1024 sc1
    v_lshl_add_u32 v20, v21, 2, v20
    v_mfma_f32_16x16x32_bf16 v[200:203], v[76:79], v[108:111], v[200:203]
    v_xor_b32 v21, 0, v20
    v_mfma_f32_16x16x32_bf16 v[232:235], v[76:79], v[112:115], v[232:235]
    v_lshl_add_u32 v10, v21, 5, v19
    v_mfma_f32_16x16x32_bf16 v[140:143], v[80:83], v[100:103], v[140:143]
    v_xor_b32 v21, 1, v20
    v_mfma_f32_16x16x32_bf16 v[172:175], v[80:83], v[104:107], v[172:175]
    buffer_load_dwordx4 v[36:39], v7, s[8:11], s32 offen offset:1024 sc1
    v_lshl_add_u32 v11, v21, 5, v19
    v_mfma_f32_16x16x32_bf16 v[204:207], v[80:83], v[108:111], v[204:207]
    v_xor_b32 v21, 2, v20
    v_mfma_f32_16x16x32_bf16 v[236:239], v[80:83], v[112:115], v[236:239]
    v_lshl_add_u32 v12, v21, 5, v19
    v_mfma_f32_16x16x32_bf16 v[144:147], v[84:87], v[100:103], v[144:147]
    v_xor_b32 v21, 3, v20
    v_mfma_f32_16x16x32_bf16 v[176:179], v[84:87], v[104:107], v[176:179]
    buffer_load_dwordx4 v[40:43], v6, s[8:11], s32 offen offset:2048 sc1
    v_lshl_add_u32 v13, v21, 5, v19
    v_mfma_f32_16x16x32_bf16 v[208:211], v[84:87], v[108:111], v[208:211]
    v_xor_b32 v21, 4, v20
    v_mfma_f32_16x16x32_bf16 v[240:243], v[84:87], v[112:115], v[240:243]
    v_lshl_add_u32 v14, v21, 5, v19
    v_mfma_f32_16x16x32_bf16 v[148:151], v[88:91], v[100:103], v[148:151]
    v_xor_b32 v21, 5, v20
    v_mfma_f32_16x16x32_bf16 v[180:183], v[88:91], v[104:107], v[180:183]
    buffer_load_dwordx4 v[44:47], v7, s[8:11], s32 offen offset:2048 sc1
    v_lshl_add_u32 v15, v21, 5, v19
    v_mfma_f32_16x16x32_bf16 v[212:215], v[88:91], v[108:111], v[212:215]
    v_xor_b32 v21, 6, v20
    v_mfma_f32_16x16x32_bf16 v[244:247], v[88:91], v[112:115], v[244:247]
    v_lshl_add_u32 v16, v21, 5, v19
    v_mfma_f32_16x16x32_bf16 v[152:155], v[92:95], v[100:103], v[152:155]
    v_xor_b32 v21, 7, v20
    v_mfma_f32_16x16x32_bf16 v[184:187], v[92:95], v[104:107], v[184:187]
    buffer_load_dwordx4 v[48:51], v6, s[8:11], s32 offen offset:3072 sc1
    v_lshl_add_u32 v17, v21, 5, v19
    v_mfma_f32_16x16x32_bf16 v[216:219], v[92:95], v[108:111], v[216:219]
    s_lshl_b32 s45, s29, 20
    v_mfma_f32_16x16x32_bf16 v[248:251], v[92:95], v[112:115], v[248:251]
    v_mfma_f32_16x16x32_bf16 v[156:159], v[96:99], v[100:103], v[156:159]
    v_mfma_f32_16x16x32_bf16 v[188:191], v[96:99], v[104:107], v[188:191]
    buffer_load_dwordx4 v[52:55], v7, s[8:11], s32 offen offset:3072 sc1
    v_mfma_f32_16x16x32_bf16 v[220:223], v[96:99], v[108:111], v[220:223]
    v_mfma_f32_16x16x32_bf16 v[252:255], v[96:99], v[112:115], v[252:255]
L_p1_done:
    s_waitcnt vmcnt(8)
    ds_read_b64_tr_b16 v[64:65], v10 offset:0
    ds_read_b64_tr_b16 v[66:67], v10 offset:1024
    ds_read_b64_tr_b16 v[68:69], v11 offset:0
    ds_read_b64_tr_b16 v[70:71], v11 offset:1024
    ds_read_b64_tr_b16 v[72:73], v12 offset:0
    ds_read_b64_tr_b16 v[74:75], v12 offset:1024
    ds_read_b64_tr_b16 v[76:77], v13 offset:0
    ds_read_b64_tr_b16 v[78:79], v13 offset:1024
    ds_read_b64_tr_b16 v[80:81], v14 offset:0
    ds_read_b64_tr_b16 v[82:83], v14 offset:1024
    ds_read_b64_tr_b16 v[84:85], v15 offset:0
    ds_read_b64_tr_b16 v[86:87], v15 offset:1024
    s_add_u32 m0, s33, 32768
    s_add_u32 s32, s32, 4096
    v_cvt_pk_bf16_f32 v128, v128, v129
    v_cvt_pk_bf16_f32 v129, v130, v131
    v_cvt_pk_bf16_f32 v130, v132, v133
    v_cvt_pk_bf16_f32 v131, v134, v135
    buffer_load_dwordx4 v2, s[4:7], s31 offen offset:0 lds
    v_cvt_pk_bf16_f32 v132, v136, v137
    v_cvt_pk_bf16_f32 v133, v138, v139
    v_cvt_pk_bf16_f32 v134, v140, v141
    v_cvt_pk_bf16_f32 v135, v142, v143
    buffer_load_dwordx4 v3, s[4:7], s31 offen offset:1024 lds
    v_cvt_pk_bf16_f32 v136, v144, v145
    v_cvt_pk_bf16_f32 v137, v146, v147
    v_cvt_pk_bf16_f32 v138, v148, v149
    v_cvt_pk_bf16_f32 v139, v150, v151
    buffer_load_dwordx4 v4, s[4:7], s31 offen offset:2048 lds
    v_cvt_pk_bf16_f32 v140, v152, v153
    v_cvt_pk_bf16_f32 v141, v154, v155
    v_cvt_pk_bf16_f32 v142, v156, v157
    v_cvt_pk_bf16_f32 v143, v158, v159
    buffer_load_dwordx4 v5, s[4:7], s31 offen offset:3072 lds
    v_cvt_pk_bf16_f32 v144, v160, v161
    v_cvt_pk_bf16_f32 v145, v162, v163
    v_cvt_pk_bf16_f32 v146, v164, v165
    v_cvt_pk_bf16_f32 v147, v166, v167
    s_add_u32 m0, s34, 32768
    s_mov_b32 s31, 3145728
    v_cvt_pk_bf16_f32 v148, v168, v169
    v_cvt_pk_bf16_f32 v149, v170, v171
    v_cvt_pk_bf16_f32 v150, v172, v173
    v_cvt_pk_bf16_f32 v151, v174, v175
    buffer_load_dwordx4 v2, s[4:7], s31 offen offset:0 lds
    v_cvt_pk_bf16_f32 v152, v176, v177
    v_cvt_pk_bf16_f32 v153, v178, v179
    v_cvt_pk_bf16_f32 v154, v180, v181
    v_cvt_pk_bf16_f32 v155, v182, v183
    buffer_load_dwordx4 v3, s[4:7], s31 offen offset:1024 lds
    v_cvt_pk_bf16_f32 v156, v184, v185
    v_cvt_pk_bf16_f32 v157, v186, v187
    v_cvt_pk_bf16_f32 v158, v188, v189
    v_cvt_pk_bf16_f32 v159, v190, v191
    buffer_load_dwordx4 v4, s[4:7], s31 offen offset:2048 lds
    v_cvt_pk_bf16_f32 v160, v192, v193
    v_cvt_pk_bf16_f32 v161, v194, v195
    v_cvt_pk_bf16_f32 v162, v196, v197
    v_cvt_pk_bf16_f32 v163, v198, v199
    buffer_load_dwordx4 v5, s[4:7], s31 offen offset:3072 lds
    v_cvt_pk_bf16_f32 v164, v200, v201
    v_cvt_pk_bf16_f32 v165, v202, v203
    v_cvt_pk_bf16_f32 v166, v204, v205
    v_cvt_pk_bf16_f32 v167, v206, v207
    s_add_u32 s31, s31, s40
    s_mov_b32 s34, s33
    v_cvt_pk_bf16_f32 v168, v208, v209
    v_cvt_pk_bf16_f32 v169, v210, v211
    v_cvt_pk_bf16_f32 v170, v212, v213
    v_cvt_pk_bf16_f32 v171, v214, v215
    buffer_load_dwordx4 v[96:99], v6, s[8:11], s32 offen offset:0 sc1
    v_cvt_pk_bf16_f32 v172, v216, v217
    v_cvt_pk_bf16_f32 v173, v218, v219
    v_cvt_pk_bf16_f32 v174, v220, v221
    v_cvt_pk_bf16_f32 v175, v222, v223
    buffer_load_dwordx4 v[100:103], v7, s[8:11], s32 offen offset:0 sc1
    v_cvt_pk_bf16_f32 v176, v224, v225
    v_cvt_pk_bf16_f32 v177, v226, v227
    v_cvt_pk_bf16_f32 v178, v228, v229
    v_cvt_pk_bf16_f32 v179, v230, v231
    buffer_load_dwordx4 v[104:107], v6, s[8:11], s32 offen offset:1024 sc1
    v_cvt_pk_bf16_f32 v180, v232, v233
    v_cvt_pk_bf16_f32 v181, v234, v235
    v_cvt_pk_bf16_f32 v182, v236, v237
    v_cvt_pk_bf16_f32 v183, v238, v239
    buffer_load_dwordx4 v[108:111], v7, s[8:11], s32 offen offset:1024 sc1
    v_cvt_pk_bf16_f32 v184, v240, v241
    v_cvt_pk_bf16_f32 v185, v242, v243
    v_cvt_pk_bf16_f32 v186, v244, v245
    v_cvt_pk_bf16_f32 v187, v246, v247
    buffer_load_dwordx4 v[112:115], v6, s[8:11], s32 offen offset:2048 sc1
    v_cvt_pk_bf16_f32 v188, v248, v249
    v_cvt_pk_bf16_f32 v189, v250, v251
    v_cvt_pk_bf16_f32 v190, v252, v253
    v_cvt_pk_bf16_f32 v191, v254, v255
    s_lshl_b32 s38, s29, 20
    s_lshl_b32 s37, s30, 17
    s_add_u32 s38, s38, s37
    s_bfe_u32 s37, s28, 0x10001
    s_lshl_b32 s37, s37, 16
    s_add_u32 s38, s38, s37
    s_lshr_b32 s36, s28, 2
    s_lshl_b32 s37, s36, 15
    s_add_u32 s38, s38, s37
    s_and_b32 s37, s28, 1
    s_add_u32 s36, s36, 11
    s_lshl_b32 s37, s37, s36
    s_add_u32 s38, s38, s37
    s_cmp_lt_u32 s28, 4
    s_cselect_b32 s36, 4, 32
    s_cselect_b32 s37, 16, 64
    s_cselect_b32 s39, 32, 4
    s_lshl_b32 s36, s36, 8
    s_lshl_b32 s37, s37, 8
    s_lshl_b32 s39, s39, 8
    s_mov_b64 s[16:17], s[12:13]
    s_mov_b64 s[18:19], s[14:15]
    s_cmp_eq_u32 s30, 0
    s_cselect_b32 s52, 2, 4
    v_lshlrev_b32 v58, 4, v1
    v_add_u32 v59, s36, v58
    v_add_u32 v60, s37, v58
    v_add_u32 v61, s36, v60
    v_mov_b64 v[192:193], 0
    v_mov_b64 v[194:195], 0
    v_mov_b64 v[196:197], 0
    v_mov_b64 v[198:199], 0
    v_mov_b64 v[200:201], 0
    v_mov_b64 v[202:203], 0
    v_mov_b64 v[204:205], 0
    v_mov_b64 v[206:207], 0
    v_mov_b64 v[208:209], 0
    v_mov_b64 v[210:211], 0
    v_mov_b64 v[212:213], 0
    v_mov_b64 v[214:215], 0
    v_mov_b64 v[216:217], 0
    v_mov_b64 v[218:219], 0
    v_mov_b64 v[220:221], 0
    v_mov_b64 v[222:223], 0
    v_mov_b64 v[224:225], 0
    v_mov_b64 v[226:227], 0
    v_mov_b64 v[228:229], 0
    v_mov_b64 v[230:231], 0
    v_mov_b64 v[232:233], 0
    v_mov_b64 v[234:235], 0
    v_mov_b64 v[236:237], 0
    v_mov_b64 v[238:239], 0
    v_mov_b64 v[240:241], 0
    v_mov_b64 v[242:243], 0
    v_mov_b64 v[244:245], 0
    v_mov_b64 v[246:247], 0
    v_mov_b64 v[248:249], 0
    v_mov_b64 v[250:251], 0
    v_mov_b64 v[252:253], 0
    v_mov_b64 v[254:255], 0
    buffer_load_dwordx4 v[116:119], v7, s[8:11], s32 offen offset:2048 sc1
    s_mov_b32 s35, 0
    s_waitcnt vmcnt(14)
    s_cmp_eq_u32 s30, 0
    s_cbranch_scc1 L_recurrent_scan__compressed_kv_cla__moe_arch_mod__prompt_kernel_rare_64
L_recurrent_scan__compressed_kv_cla__moe_arch_mod__prompt_kernel_back_65:
    .p2align 6
L_p2_loop:
    s_cmp_ge_u32 s35, 2
    s_cbranch_scc1 L_recurrent_scan__compressed_kv_cla__moe_arch_mod__prompt_kernel_rare_54
L_recurrent_scan__compressed_kv_cla__moe_arch_mod__prompt_kernel_back_55:
    s_waitcnt lgkmcnt(8)
    s_waitcnt vmcnt(23)
    v_mfma_f32_16x16x32_bf16 v[192:195], v[64:67], v[24:27], v[192:195]
    ds_read_b64_tr_b16 v[88:89], v16 offset:0
    v_mfma_f32_16x16x32_bf16 v[224:227], v[64:67], v[28:31], v[224:227]
    ds_read_b64_tr_b16 v[90:91], v16 offset:1024
    v_mfma_f32_16x16x32_bf16 v[196:199], v[68:71], v[24:27], v[196:199]
    ds_read_b64_tr_b16 v[92:93], v17 offset:0
    buffer_load_dwordx4 v[120:123], v6, s[8:11], s32 offen offset:3072 sc1
    v_mfma_f32_16x16x32_bf16 v[228:231], v[68:71], v[28:31], v[228:231]
    ds_read_b64_tr_b16 v[94:95], v17 offset:1024
    s_waitcnt lgkmcnt(8)
    v_mfma_f32_16x16x32_bf16 v[200:203], v[72:75], v[24:27], v[200:203]
    ds_read_b64_tr_b16 v[64:65], v10 offset:8192
    v_mfma_f32_16x16x32_bf16 v[232:235], v[72:75], v[28:31], v[232:235]
    ds_read_b64_tr_b16 v[66:67], v10 offset:9216
    v_mfma_f32_16x16x32_bf16 v[204:207], v[76:79], v[24:27], v[204:207]
    ds_read_b64_tr_b16 v[68:69], v11 offset:8192
    buffer_load_dwordx4 v[124:127], v7, s[8:11], s32 offen offset:3072 sc1
    v_mfma_f32_16x16x32_bf16 v[236:239], v[76:79], v[28:31], v[236:239]
    ds_read_b64_tr_b16 v[70:71], v11 offset:9216
    s_add_u32 s32, s32, 4096
    s_waitcnt lgkmcnt(8)
    v_mfma_f32_16x16x32_bf16 v[208:211], v[80:83], v[24:27], v[208:211]
    ds_read_b64_tr_b16 v[72:73], v12 offset:8192
    s_cmp_lt_u32 s35, 3
    s_cselect_b32 s10, 4194304, 0
    v_mfma_f32_16x16x32_bf16 v[240:243], v[80:83], v[28:31], v[240:243]
    ds_read_b64_tr_b16 v[74:75], v12 offset:9216
    s_cmp_lt_u32 s35, s52
    s_cselect_b32 s18, s18, 0
    v_mfma_f32_16x16x32_bf16 v[212:215], v[84:87], v[24:27], v[212:215]
    ds_read_b64_tr_b16 v[76:77], v13 offset:8192
    buffer_store_dwordx4 v[128:131], v58, s[16:19], s38 offen sc1
    v_mfma_f32_16x16x32_bf16 v[244:247], v[84:87], v[28:31], v[244:247]
    ds_read_b64_tr_b16 v[78:79], v13 offset:9216
    s_waitcnt lgkmcnt(8)
    v_mfma_f32_16x16x32_bf16 v[216:219], v[88:91], v[24:27], v[216:219]
    ds_read_b64_tr_b16 v[80:81], v14 offset:8192
    v_mov_b64 v[128:129], v[144:145]
    v_mfma_f32_16x16x32_bf16 v[248:251], v[88:91], v[28:31], v[248:251]
    ds_read_b64_tr_b16 v[82:83], v14 offset:9216
    v_mfma_f32_16x16x32_bf16 v[220:223], v[92:95], v[24:27], v[220:223]
    ds_read_b64_tr_b16 v[84:85], v15 offset:8192
    v_mov_b64 v[130:131], v[146:147]
    v_mfma_f32_16x16x32_bf16 v[252:255], v[92:95], v[28:31], v[252:255]
    ds_read_b64_tr_b16 v[86:87], v15 offset:9216
    s_waitcnt lgkmcnt(8)
    s_waitcnt vmcnt(23)
    v_mfma_f32_16x16x32_bf16 v[192:195], v[64:67], v[32:35], v[192:195]
    ds_read_b64_tr_b16 v[88:89], v16 offset:8192
    v_mov_b64 v[144:145], v[160:161]
    v_mfma_f32_16x16x32_bf16 v[224:227], v[64:67], v[36:39], v[224:227]
    ds_read_b64_tr_b16 v[90:91], v16 offset:9216
    v_mfma_f32_16x16x32_bf16 v[196:199], v[68:71], v[32:35], v[196:199]
    ds_read_b64_tr_b16 v[92:93], v17 offset:8192
    buffer_load_dwordx4 v[24:27], v6, s[8:11], s32 offen offset:0 sc1
    v_mov_b64 v[146:147], v[162:163]
    v_mfma_f32_16x16x32_bf16 v[228:231], v[68:71], v[36:39], v[228:231]
    ds_read_b64_tr_b16 v[94:95], v17 offset:9216
    s_waitcnt lgkmcnt(8)
    v_mfma_f32_16x16x32_bf16 v[200:203], v[72:75], v[32:35], v[200:203]
    ds_read_b64_tr_b16 v[64:65], v10 offset:16384
    v_mov_b64 v[160:161], v[176:177]
    v_mfma_f32_16x16x32_bf16 v[232:235], v[72:75], v[36:39], v[232:235]
    ds_read_b64_tr_b16 v[66:67], v10 offset:17408
    v_mfma_f32_16x16x32_bf16 v[204:207], v[76:79], v[32:35], v[204:207]
    ds_read_b64_tr_b16 v[68:69], v11 offset:16384
    buffer_load_dwordx4 v[28:31], v7, s[8:11], s32 offen offset:0 sc1
    v_mov_b64 v[162:163], v[178:179]
    v_mfma_f32_16x16x32_bf16 v[236:239], v[76:79], v[36:39], v[236:239]
    ds_read_b64_tr_b16 v[70:71], v11 offset:17408
    s_waitcnt lgkmcnt(8)
    v_mfma_f32_16x16x32_bf16 v[208:211], v[80:83], v[32:35], v[208:211]
    ds_read_b64_tr_b16 v[72:73], v12 offset:16384
    v_mfma_f32_16x16x32_bf16 v[240:243], v[80:83], v[36:39], v[240:243]
    ds_read_b64_tr_b16 v[74:75], v12 offset:17408
    v_mfma_f32_16x16x32_bf16 v[212:215], v[84:87], v[32:35], v[212:215]
    ds_read_b64_tr_b16 v[76:77], v13 offset:16384
    v_mfma_f32_16x16x32_bf16 v[244:247], v[84:87], v[36:39], v[244:247]
    ds_read_b64_tr_b16 v[78:79], v13 offset:17408
    s_waitcnt lgkmcnt(8)
    v_mfma_f32_16x16x32_bf16 v[216:219], v[88:91], v[32:35], v[216:219]
    ds_read_b64_tr_b16 v[80:81], v14 offset:16384
    v_mfma_f32_16x16x32_bf16 v[248:251], v[88:91], v[36:39], v[248:251]
    ds_read_b64_tr_b16 v[82:83], v14 offset:17408
    v_mfma_f32_16x16x32_bf16 v[220:223], v[92:95], v[32:35], v[220:223]
    ds_read_b64_tr_b16 v[84:85], v15 offset:16384
    buffer_store_dwordx4 v[132:135], v59, s[16:19], s38 offen sc1
    v_mfma_f32_16x16x32_bf16 v[252:255], v[92:95], v[36:39], v[252:255]
    ds_read_b64_tr_b16 v[86:87], v15 offset:17408
    s_waitcnt lgkmcnt(8)
    s_waitcnt vmcnt(24)
    v_mfma_f32_16x16x32_bf16 v[192:195], v[64:67], v[40:43], v[192:195]
    ds_read_b64_tr_b16 v[88:89], v16 offset:16384
    v_mov_b64 v[132:133], v[148:149]
    v_mfma_f32_16x16x32_bf16 v[224:227], v[64:67], v[44:47], v[224:227]
    ds_read_b64_tr_b16 v[90:91], v16 offset:17408
    v_mfma_f32_16x16x32_bf16 v[196:199], v[68:71], v[40:43], v[196:199]
    ds_read_b64_tr_b16 v[92:93], v17 offset:16384
    buffer_load_dwordx4 v[32:35], v6, s[8:11], s32 offen offset:1024 sc1
    v_mov_b64 v[134:135], v[150:151]
    v_mfma_f32_16x16x32_bf16 v[228:231], v[68:71], v[44:47], v[228:231]
    ds_read_b64_tr_b16 v[94:95], v17 offset:17408
    s_waitcnt lgkmcnt(8)
    v_mfma_f32_16x16x32_bf16 v[200:203], v[72:75], v[40:43], v[200:203]
    ds_read_b64_tr_b16 v[64:65], v10 offset:24576
    v_mov_b64 v[148:149], v[164:165]
    v_mfma_f32_16x16x32_bf16 v[232:235], v[72:75], v[44:47], v[232:235]
    ds_read_b64_tr_b16 v[66:67], v10 offset:25600
    v_mfma_f32_16x16x32_bf16 v[204:207], v[76:79], v[40:43], v[204:207]
    ds_read_b64_tr_b16 v[68:69], v11 offset:24576
    buffer_load_dwordx4 v[36:39], v7, s[8:11], s32 offen offset:1024 sc1
    v_mov_b64 v[150:151], v[166:167]
    v_mfma_f32_16x16x32_bf16 v[236:239], v[76:79], v[44:47], v[236:239]
    ds_read_b64_tr_b16 v[70:71], v11 offset:25600
    s_waitcnt lgkmcnt(8)
    v_mfma_f32_16x16x32_bf16 v[208:211], v[80:83], v[40:43], v[208:211]
    ds_read_b64_tr_b16 v[72:73], v12 offset:24576
    v_mov_b64 v[164:165], v[180:181]
    v_mfma_f32_16x16x32_bf16 v[240:243], v[80:83], v[44:47], v[240:243]
    ds_read_b64_tr_b16 v[74:75], v12 offset:25600
    v_mfma_f32_16x16x32_bf16 v[212:215], v[84:87], v[40:43], v[212:215]
    ds_read_b64_tr_b16 v[76:77], v13 offset:24576
    v_mov_b64 v[166:167], v[182:183]
    v_mfma_f32_16x16x32_bf16 v[244:247], v[84:87], v[44:47], v[244:247]
    ds_read_b64_tr_b16 v[78:79], v13 offset:25600
    s_waitcnt lgkmcnt(8)
    v_mfma_f32_16x16x32_bf16 v[216:219], v[88:91], v[40:43], v[216:219]
    ds_read_b64_tr_b16 v[80:81], v14 offset:24576
    v_mfma_f32_16x16x32_bf16 v[248:251], v[88:91], v[44:47], v[248:251]
    ds_read_b64_tr_b16 v[82:83], v14 offset:25600
    v_mfma_f32_16x16x32_bf16 v[220:223], v[92:95], v[40:43], v[220:223]
    ds_read_b64_tr_b16 v[84:85], v15 offset:24576
    v_mfma_f32_16x16x32_bf16 v[252:255], v[92:95], v[44:47], v[252:255]
    ds_read_b64_tr_b16 v[86:87], v15 offset:25600
    s_waitcnt lgkmcnt(8)
    s_waitcnt vmcnt(20)
    v_mfma_f32_16x16x32_bf16 v[192:195], v[64:67], v[48:51], v[192:195]
    ds_read_b64_tr_b16 v[88:89], v16 offset:24576
    v_mfma_f32_16x16x32_bf16 v[224:227], v[64:67], v[52:55], v[224:227]
    ds_read_b64_tr_b16 v[90:91], v16 offset:25600
    v_mfma_f32_16x16x32_bf16 v[196:199], v[68:71], v[48:51], v[196:199]
    ds_read_b64_tr_b16 v[92:93], v17 offset:24576
    buffer_load_dwordx4 v[40:43], v6, s[8:11], s32 offen offset:2048 sc1
    v_mfma_f32_16x16x32_bf16 v[228:231], v[68:71], v[52:55], v[228:231]
    ds_read_b64_tr_b16 v[94:95], v17 offset:25600
    s_waitcnt lgkmcnt(8)
    v_mfma_f32_16x16x32_bf16 v[200:203], v[72:75], v[48:51], v[200:203]
    v_mfma_f32_16x16x32_bf16 v[232:235], v[72:75], v[52:55], v[232:235]
    v_mfma_f32_16x16x32_bf16 v[204:207], v[76:79], v[48:51], v[204:207]
    buffer_load_dwordx4 v[44:47], v7, s[8:11], s32 offen offset:2048 sc1
    v_mfma_f32_16x16x32_bf16 v[236:239], v[76:79], v[52:55], v[236:239]
    s_cmp_ge_u32 s35, 2
    s_cbranch_scc1 L_recurrent_scan__compressed_kv_cla__moe_arch_mod__prompt_kernel_rare_48
L_recurrent_scan__compressed_kv_cla__moe_arch_mod__prompt_kernel_back_49:
    s_waitcnt lgkmcnt(0)
    s_waitcnt vmcnt(20)
    s_cmp_eq_u32 s35, s52
    s_cbranch_scc1 L_recurrent_scan__compressed_kv_cla__moe_arch_mod__prompt_kernel_rare_62
L_recurrent_scan__compressed_kv_cla__moe_arch_mod__prompt_kernel_back_63:
    s_barrier
    v_mfma_f32_16x16x32_bf16 v[208:211], v[80:83], v[48:51], v[208:211]
    ds_read_b64_tr_b16 v[64:65], v10 offset:32768
    ds_read_b64_tr_b16 v[66:67], v10 offset:33792
    v_mfma_f32_16x16x32_bf16 v[240:243], v[80:83], v[52:55], v[240:243]
    ds_read_b64_tr_b16 v[68:69], v11 offset:32768
    ds_read_b64_tr_b16 v[70:71], v11 offset:33792
    v_mfma_f32_16x16x32_bf16 v[212:215], v[84:87], v[48:51], v[212:215]
    ds_read_b64_tr_b16 v[72:73], v12 offset:32768
    ds_read_b64_tr_b16 v[74:75], v12 offset:33792
    v_mfma_f32_16x16x32_bf16 v[244:247], v[84:87], v[52:55], v[244:247]
    ds_read_b64_tr_b16 v[76:77], v13 offset:32768
    ds_read_b64_tr_b16 v[78:79], v13 offset:33792
    s_add_u32 m0, s34, 0
    v_mfma_f32_16x16x32_bf16 v[216:219], v[88:91], v[48:51], v[216:219]
    ds_read_b64_tr_b16 v[80:81], v14 offset:32768
    ds_read_b64_tr_b16 v[82:83], v14 offset:33792
    buffer_load_dwordx4 v2, s[4:7], s31 offen offset:0 sc1 lds
    v_mfma_f32_16x16x32_bf16 v[248:251], v[88:91], v[52:55], v[248:251]
    buffer_load_dwordx4 v3, s[4:7], s31 offen offset:1024 sc1 lds
    v_mfma_f32_16x16x32_bf16 v[220:223], v[92:95], v[48:51], v[220:223]
    ds_read_b64_tr_b16 v[84:85], v15 offset:32768
    ds_read_b64_tr_b16 v[86:87], v15 offset:33792
    buffer_load_dwordx4 v4, s[4:7], s31 offen offset:2048 sc1 lds
    v_mfma_f32_16x16x32_bf16 v[252:255], v[92:95], v[52:55], v[252:255]
    buffer_load_dwordx4 v5, s[4:7], s31 offen offset:3072 sc1 lds
    s_add_u32 s31, s31, s40
    s_cmp_ge_u32 s35, 2
    s_cbranch_scc1 L_recurrent_scan__compressed_kv_cla__moe_arch_mod__prompt_kernel_rare_60
L_recurrent_scan__compressed_kv_cla__moe_arch_mod__prompt_kernel_back_61:
    s_waitcnt lgkmcnt(8)
    s_waitcnt vmcnt(18)
    v_mfma_f32_16x16x32_bf16 v[192:195], v[64:67], v[96:99], v[192:195]
    ds_read_b64_tr_b16 v[88:89], v16 offset:32768
    v_mfma_f32_16x16x32_bf16 v[224:227], v[64:67], v[100:103], v[224:227]
    ds_read_b64_tr_b16 v[90:91], v16 offset:33792
    v_mfma_f32_16x16x32_bf16 v[196:199], v[68:71], v[96:99], v[196:199]
    ds_read_b64_tr_b16 v[92:93], v17 offset:32768
    buffer_load_dwordx4 v[48:51], v6, s[8:11], s32 offen offset:3072 sc1
    v_mfma_f32_16x16x32_bf16 v[228:231], v[68:71], v[100:103], v[228:231]
    ds_read_b64_tr_b16 v[94:95], v17 offset:33792
    s_waitcnt lgkmcnt(8)
    v_mfma_f32_16x16x32_bf16 v[200:203], v[72:75], v[96:99], v[200:203]
    ds_read_b64_tr_b16 v[64:65], v10 offset:40960
    v_mfma_f32_16x16x32_bf16 v[232:235], v[72:75], v[100:103], v[232:235]
    ds_read_b64_tr_b16 v[66:67], v10 offset:41984
    v_mfma_f32_16x16x32_bf16 v[204:207], v[76:79], v[96:99], v[204:207]
    ds_read_b64_tr_b16 v[68:69], v11 offset:40960
    buffer_load_dwordx4 v[52:55], v7, s[8:11], s32 offen offset:3072 sc1
    v_mfma_f32_16x16x32_bf16 v[236:239], v[76:79], v[100:103], v[236:239]
    ds_read_b64_tr_b16 v[70:71], v11 offset:41984
    s_add_u32 s32, s32, 4096
    s_waitcnt lgkmcnt(8)
    v_mfma_f32_16x16x32_bf16 v[208:211], v[80:83], v[96:99], v[208:211]
    ds_read_b64_tr_b16 v[72:73], v12 offset:40960
    v_mfma_f32_16x16x32_bf16 v[240:243], v[80:83], v[100:103], v[240:243]
    ds_read_b64_tr_b16 v[74:75], v12 offset:41984
    v_mfma_f32_16x16x32_bf16 v[212:215], v[84:87], v[96:99], v[212:215]
    ds_read_b64_tr_b16 v[76:77], v13 offset:40960
    buffer_store_dwordx4 v[136:139], v60, s[16:19], s38 offen sc1
    v_mfma_f32_16x16x32_bf16 v[244:247], v[84:87], v[100:103], v[244:247]
    ds_read_b64_tr_b16 v[78:79], v13 offset:41984
    s_waitcnt lgkmcnt(8)
    v_mfma_f32_16x16x32_bf16 v[216:219], v[88:91], v[96:99], v[216:219]
    ds_read_b64_tr_b16 v[80:81], v14 offset:40960
    v_mov_b64 v[136:137], v[152:153]
    v_mfma_f32_16x16x32_bf16 v[248:251], v[88:91], v[100:103], v[248:251]
    ds_read_b64_tr_b16 v[82:83], v14 offset:41984
    v_mfma_f32_16x16x32_bf16 v[220:223], v[92:95], v[96:99], v[220:223]
    ds_read_b64_tr_b16 v[84:85], v15 offset:40960
    v_mov_b64 v[138:139], v[154:155]
    v_mfma_f32_16x16x32_bf16 v[252:255], v[92:95], v[100:103], v[252:255]
    ds_read_b64_tr_b16 v[86:87], v15 offset:41984
    s_waitcnt lgkmcnt(8)
    s_waitcnt vmcnt(19)
    v_mfma_f32_16x16x32_bf16 v[192:195], v[64:67], v[104:107], v[192:195]
    ds_read_b64_tr_b16 v[88:89], v16 offset:40960
    v_mov_b64 v[152:153], v[168:169]
    v_mfma_f32_16x16x32_bf16 v[224:227], v[64:67], v[108:111], v[224:227]
    ds_read_b64_tr_b16 v[90:91], v16 offset:41984
    v_mfma_f32_16x16x32_bf16 v[196:199], v[68:71], v[104:107], v[196:199]
    ds_read_b64_tr_b16 v[92:93], v17 offset:40960
    buffer_load_dwordx4 v[96:99], v6, s[8:11], s32 offen offset:0 sc1
    v_mov_b64 v[154:155], v[170:171]
    v_mfma_f32_16x16x32_bf16 v[228:231], v[68:71], v[108:111], v[228:231]
    ds_read_b64_tr_b16 v[94:95], v17 offset:41984
    s_waitcnt lgkmcnt(8)
    v_mfma_f32_16x16x32_bf16 v[200:203], v[72:75], v[104:107], v[200:203]
    ds_read_b64_tr_b16 v[64:65], v10 offset:49152
    v_mov_b64 v[168:169], v[184:185]
    v_mfma_f32_16x16x32_bf16 v[232:235], v[72:75], v[108:111], v[232:235]
    ds_read_b64_tr_b16 v[66:67], v10 offset:50176
    v_mfma_f32_16x16x32_bf16 v[204:207], v[76:79], v[104:107], v[204:207]
    ds_read_b64_tr_b16 v[68:69], v11 offset:49152
    buffer_load_dwordx4 v[100:103], v7, s[8:11], s32 offen offset:0 sc1
    v_mov_b64 v[170:171], v[186:187]
    v_mfma_f32_16x16x32_bf16 v[236:239], v[76:79], v[108:111], v[236:239]
    ds_read_b64_tr_b16 v[70:71], v11 offset:50176
    s_waitcnt lgkmcnt(8)
    v_mfma_f32_16x16x32_bf16 v[208:211], v[80:83], v[104:107], v[208:211]
    ds_read_b64_tr_b16 v[72:73], v12 offset:49152
    v_mfma_f32_16x16x32_bf16 v[240:243], v[80:83], v[108:111], v[240:243]
    ds_read_b64_tr_b16 v[74:75], v12 offset:50176
    v_mfma_f32_16x16x32_bf16 v[212:215], v[84:87], v[104:107], v[212:215]
    ds_read_b64_tr_b16 v[76:77], v13 offset:49152
    v_mfma_f32_16x16x32_bf16 v[244:247], v[84:87], v[108:111], v[244:247]
    ds_read_b64_tr_b16 v[78:79], v13 offset:50176
    s_waitcnt lgkmcnt(8)
    v_mfma_f32_16x16x32_bf16 v[216:219], v[88:91], v[104:107], v[216:219]
    ds_read_b64_tr_b16 v[80:81], v14 offset:49152
    v_mfma_f32_16x16x32_bf16 v[248:251], v[88:91], v[108:111], v[248:251]
    ds_read_b64_tr_b16 v[82:83], v14 offset:50176
    v_mfma_f32_16x16x32_bf16 v[220:223], v[92:95], v[104:107], v[220:223]
    ds_read_b64_tr_b16 v[84:85], v15 offset:49152
    buffer_store_dwordx4 v[140:143], v61, s[16:19], s38 offen sc1
    v_mfma_f32_16x16x32_bf16 v[252:255], v[92:95], v[108:111], v[252:255]
    ds_read_b64_tr_b16 v[86:87], v15 offset:50176
    s_add_u32 s38, s38, s39
    s_waitcnt lgkmcnt(8)
    s_waitcnt vmcnt(20)
    v_mfma_f32_16x16x32_bf16 v[192:195], v[64:67], v[112:115], v[192:195]
    ds_read_b64_tr_b16 v[88:89], v16 offset:49152
    v_mov_b64 v[140:141], v[156:157]
    v_mfma_f32_16x16x32_bf16 v[224:227], v[64:67], v[116:119], v[224:227]
    ds_read_b64_tr_b16 v[90:91], v16 offset:50176
    v_mfma_f32_16x16x32_bf16 v[196:199], v[68:71], v[112:115], v[196:199]
    ds_read_b64_tr_b16 v[92:93], v17 offset:49152
    buffer_load_dwordx4 v[104:107], v6, s[8:11], s32 offen offset:1024 sc1
    v_mov_b64 v[142:143], v[158:159]
    v_mfma_f32_16x16x32_bf16 v[228:231], v[68:71], v[116:119], v[228:231]
    ds_read_b64_tr_b16 v[94:95], v17 offset:50176
    s_waitcnt lgkmcnt(8)
    v_mfma_f32_16x16x32_bf16 v[200:203], v[72:75], v[112:115], v[200:203]
    ds_read_b64_tr_b16 v[64:65], v10 offset:57344
    v_mov_b64 v[156:157], v[172:173]
    v_mfma_f32_16x16x32_bf16 v[232:235], v[72:75], v[116:119], v[232:235]
    ds_read_b64_tr_b16 v[66:67], v10 offset:58368
    v_xor_b32 v10, 65536, v10
    v_mfma_f32_16x16x32_bf16 v[204:207], v[76:79], v[112:115], v[204:207]
    ds_read_b64_tr_b16 v[68:69], v11 offset:57344
    buffer_load_dwordx4 v[108:111], v7, s[8:11], s32 offen offset:1024 sc1
    v_mov_b64 v[158:159], v[174:175]
    v_mfma_f32_16x16x32_bf16 v[236:239], v[76:79], v[116:119], v[236:239]
    ds_read_b64_tr_b16 v[70:71], v11 offset:58368
    v_xor_b32 v11, 65536, v11
    s_waitcnt lgkmcnt(8)
    v_mfma_f32_16x16x32_bf16 v[208:211], v[80:83], v[112:115], v[208:211]
    ds_read_b64_tr_b16 v[72:73], v12 offset:57344
    v_mov_b64 v[172:173], v[188:189]
    v_mfma_f32_16x16x32_bf16 v[240:243], v[80:83], v[116:119], v[240:243]
    ds_read_b64_tr_b16 v[74:75], v12 offset:58368
    v_xor_b32 v12, 65536, v12
    v_mfma_f32_16x16x32_bf16 v[212:215], v[84:87], v[112:115], v[212:215]
    ds_read_b64_tr_b16 v[76:77], v13 offset:57344
    v_mov_b64 v[174:175], v[190:191]
    v_mfma_f32_16x16x32_bf16 v[244:247], v[84:87], v[116:119], v[244:247]
    ds_read_b64_tr_b16 v[78:79], v13 offset:58368
    v_xor_b32 v13, 65536, v13
    s_waitcnt lgkmcnt(8)
    v_mfma_f32_16x16x32_bf16 v[216:219], v[88:91], v[112:115], v[216:219]
    ds_read_b64_tr_b16 v[80:81], v14 offset:57344
    v_mfma_f32_16x16x32_bf16 v[248:251], v[88:91], v[116:119], v[248:251]
    ds_read_b64_tr_b16 v[82:83], v14 offset:58368
    v_xor_b32 v14, 65536, v14
    v_mfma_f32_16x16x32_bf16 v[220:223], v[92:95], v[112:115], v[220:223]
    ds_read_b64_tr_b16 v[84:85], v15 offset:57344
    v_mfma_f32_16x16x32_bf16 v[252:255], v[92:95], v[116:119], v[252:255]
    ds_read_b64_tr_b16 v[86:87], v15 offset:58368
    v_xor_b32 v15, 65536, v15
    s_waitcnt lgkmcnt(8)
    s_waitcnt vmcnt(20)
    v_mfma_f32_16x16x32_bf16 v[192:195], v[64:67], v[120:123], v[192:195]
    ds_read_b64_tr_b16 v[88:89], v16 offset:57344
    v_mfma_f32_16x16x32_bf16 v[224:227], v[64:67], v[124:127], v[224:227]
    ds_read_b64_tr_b16 v[90:91], v16 offset:58368
    v_xor_b32 v16, 65536, v16
    v_mfma_f32_16x16x32_bf16 v[196:199], v[68:71], v[120:123], v[196:199]
    ds_read_b64_tr_b16 v[92:93], v17 offset:57344
    buffer_load_dwordx4 v[112:115], v6, s[8:11], s32 offen offset:2048 sc1
    v_mfma_f32_16x16x32_bf16 v[228:231], v[68:71], v[124:127], v[228:231]
    ds_read_b64_tr_b16 v[94:95], v17 offset:58368
    v_xor_b32 v17, 65536, v17
    s_waitcnt lgkmcnt(8)
    v_mfma_f32_16x16x32_bf16 v[200:203], v[72:75], v[120:123], v[200:203]
    v_mfma_f32_16x16x32_bf16 v[232:235], v[72:75], v[124:127], v[232:235]
    v_mfma_f32_16x16x32_bf16 v[204:207], v[76:79], v[120:123], v[204:207]
    buffer_load_dwordx4 v[116:119], v7, s[8:11], s32 offen offset:2048 sc1
    v_mfma_f32_16x16x32_bf16 v[236:239], v[76:79], v[124:127], v[236:239]
    s_waitcnt lgkmcnt(0)
    s_barrier
    v_mfma_f32_16x16x32_bf16 v[208:211], v[80:83], v[120:123], v[208:211]
    ds_read_b64_tr_b16 v[64:65], v10 offset:0
    ds_read_b64_tr_b16 v[66:67], v10 offset:1024
    v_mfma_f32_16x16x32_bf16 v[240:243], v[80:83], v[124:127], v[240:243]
    ds_read_b64_tr_b16 v[68:69], v11 offset:0
    ds_read_b64_tr_b16 v[70:71], v11 offset:1024
    v_mfma_f32_16x16x32_bf16 v[212:215], v[84:87], v[120:123], v[212:215]
    ds_read_b64_tr_b16 v[72:73], v12 offset:0
    ds_read_b64_tr_b16 v[74:75], v12 offset:1024
    v_mfma_f32_16x16x32_bf16 v[244:247], v[84:87], v[124:127], v[244:247]
    ds_read_b64_tr_b16 v[76:77], v13 offset:0
    ds_read_b64_tr_b16 v[78:79], v13 offset:1024
    s_add_u32 m0, s34, 32768
    v_mfma_f32_16x16x32_bf16 v[216:219], v[88:91], v[120:123], v[216:219]
    ds_read_b64_tr_b16 v[80:81], v14 offset:0
    ds_read_b64_tr_b16 v[82:83], v14 offset:1024
    buffer_load_dwordx4 v2, s[4:7], s31 offen offset:0 sc1 lds
    v_mfma_f32_16x16x32_bf16 v[248:251], v[88:91], v[124:127], v[248:251]
    buffer_load_dwordx4 v3, s[4:7], s31 offen offset:1024 sc1 lds
    v_mfma_f32_16x16x32_bf16 v[220:223], v[92:95], v[120:123], v[220:223]
    ds_read_b64_tr_b16 v[84:85], v15 offset:0
    ds_read_b64_tr_b16 v[86:87], v15 offset:1024
    buffer_load_dwordx4 v4, s[4:7], s31 offen offset:2048 sc1 lds
    v_mfma_f32_16x16x32_bf16 v[252:255], v[92:95], v[124:127], v[252:255]
    buffer_load_dwordx4 v5, s[4:7], s31 offen offset:3072 sc1 lds
    s_add_u32 s31, s31, s40
    s_xor_b32 s34, s34, 65536
    s_add_u32 s35, s35, 1
    s_cmp_lt_u32 s35, 4
    s_cbranch_scc1 L_p2_loop
    s_load_dwordx2 s[32:33], s[0:1], 40
    s_load_dwordx2 s[34:35], s[0:1], 80
    s_load_dwordx2 s[96:97], s[0:1], 0
    s_load_dwordx2 s[98:99], s[0:1], 88
    s_cmp_lt_u32 s28, 4
    s_cbranch_scc0 L_grp1
    v_mov_b32 v20, 1040356334
    v_mov_b32 v21, v20
    s_and_b32 s37, s28, 3
    s_lshl_b32 s37, s37, 13
    v_lshlrev_b32 v7, 4, v1
    v_add_u32 v4, s37, v7
    v_add_u32 v6, 4096, v4
    v_add_u32 v19, 131072, v4
    s_add_u32 s43, s37, 32768
    s_add_u32 s44, s37, 98304
    s_waitcnt vmcnt(4) lgkmcnt(0)
    v_pk_mul_f32 v[192:193], v[192:193], v[20:21]
    v_pk_mul_f32 v[194:195], v[194:195], v[20:21]
    v_pk_mul_f32 v[196:197], v[196:197], v[20:21]
    v_pk_mul_f32 v[198:199], v[198:199], v[20:21]
    v_cvt_pk_bf16_f32 v128, v192, v193
    v_cvt_pk_bf16_f32 v129, v194, v195
    v_cvt_pk_bf16_f32 v130, v196, v197
    v_cvt_pk_bf16_f32 v131, v198, v199
    ds_write_b128 v19, v[128:131] offset:0
    v_pk_mul_f32 v[200:201], v[200:201], v[20:21]
    v_pk_mul_f32 v[202:203], v[202:203], v[20:21]
    v_pk_mul_f32 v[204:205], v[204:205], v[20:21]
    v_pk_mul_f32 v[206:207], v[206:207], v[20:21]
    v_cvt_pk_bf16_f32 v132, v200, v201
    v_cvt_pk_bf16_f32 v133, v202, v203
    v_cvt_pk_bf16_f32 v134, v204, v205
    v_cvt_pk_bf16_f32 v135, v206, v207
    ds_write_b128 v19, v[132:135] offset:1024
    v_pk_mul_f32 v[208:209], v[208:209], v[20:21]
    v_pk_mul_f32 v[210:211], v[210:211], v[20:21]
    v_pk_mul_f32 v[212:213], v[212:213], v[20:21]
    v_pk_mul_f32 v[214:215], v[214:215], v[20:21]
    v_cvt_pk_bf16_f32 v136, v208, v209
    v_cvt_pk_bf16_f32 v137, v210, v211
    v_cvt_pk_bf16_f32 v138, v212, v213
    v_cvt_pk_bf16_f32 v139, v214, v215
    ds_write_b128 v19, v[136:139] offset:2048
    v_pk_mul_f32 v[216:217], v[216:217], v[20:21]
    v_pk_mul_f32 v[218:219], v[218:219], v[20:21]
    v_pk_mul_f32 v[220:221], v[220:221], v[20:21]
    v_pk_mul_f32 v[222:223], v[222:223], v[20:21]
    v_cvt_pk_bf16_f32 v140, v216, v217
    v_cvt_pk_bf16_f32 v141, v218, v219
    v_cvt_pk_bf16_f32 v142, v220, v221
    v_cvt_pk_bf16_f32 v143, v222, v223
    ds_write_b128 v19, v[140:143] offset:3072
    v_pk_mul_f32 v[224:225], v[224:225], v[20:21]
    v_pk_mul_f32 v[226:227], v[226:227], v[20:21]
    v_pk_mul_f32 v[228:229], v[228:229], v[20:21]
    v_pk_mul_f32 v[230:231], v[230:231], v[20:21]
    v_cvt_pk_bf16_f32 v144, v224, v225
    v_cvt_pk_bf16_f32 v145, v226, v227
    v_cvt_pk_bf16_f32 v146, v228, v229
    v_cvt_pk_bf16_f32 v147, v230, v231
    ds_write_b128 v19, v[144:147] offset:4096
    v_pk_mul_f32 v[232:233], v[232:233], v[20:21]
    v_pk_mul_f32 v[234:235], v[234:235], v[20:21]
    v_pk_mul_f32 v[236:237], v[236:237], v[20:21]
    v_pk_mul_f32 v[238:239], v[238:239], v[20:21]
    v_cvt_pk_bf16_f32 v148, v232, v233
    v_cvt_pk_bf16_f32 v149, v234, v235
    v_cvt_pk_bf16_f32 v150, v236, v237
    v_cvt_pk_bf16_f32 v151, v238, v239
    ds_write_b128 v19, v[148:151] offset:5120
    v_pk_mul_f32 v[240:241], v[240:241], v[20:21]
    v_pk_mul_f32 v[242:243], v[242:243], v[20:21]
    v_pk_mul_f32 v[244:245], v[244:245], v[20:21]
    v_pk_mul_f32 v[246:247], v[246:247], v[20:21]
    v_cvt_pk_bf16_f32 v152, v240, v241
    v_cvt_pk_bf16_f32 v153, v242, v243
    v_cvt_pk_bf16_f32 v154, v244, v245
    v_cvt_pk_bf16_f32 v155, v246, v247
    ds_write_b128 v19, v[152:155] offset:6144
    v_pk_mul_f32 v[248:249], v[248:249], v[20:21]
    v_pk_mul_f32 v[250:251], v[250:251], v[20:21]
    v_pk_mul_f32 v[252:253], v[252:253], v[20:21]
    v_pk_mul_f32 v[254:255], v[254:255], v[20:21]
    v_cvt_pk_bf16_f32 v156, v248, v249
    v_cvt_pk_bf16_f32 v157, v250, v251
    v_cvt_pk_bf16_f32 v158, v252, v253
    v_cvt_pk_bf16_f32 v159, v254, v255
    ds_write_b128 v19, v[156:159] offset:7168
    v_mov_b32 v2, v7
    v_and_b32 v21, 15, v1
    v_lshrrev_b32 v22, 4, v1
    v_lshlrev_b32 v22, 2, v22
    v_sub_u32 v18, v21, v22
    s_mov_b32 s40, 0
    s_mov_b32 s41, 16384
    s_mov_b32 s49, 0xffff
    s_lshl_b32 s51, s30, 1
    s_add_u32 s51, s51, 1
    s_and_b32 s50, s28, 3
    s_lshl_b32 s50, s50, 5
    v_mov_b32 v36, 0x3f803f80
    v_mov_b32 v37, 0x3f803f80
    v_mov_b32 v38, 0x3f803f80
    v_mov_b32 v39, 0x3f803f80
    s_lshl_b32 s31, 1, s51
    s_or_b32 s31, s31, 0x8000
    s_add_u32 s36, s51, 1
    s_lshl_b32 s36, -1, s36
    s_or_b32 s48, s36, 0xaaaaaaab
    s_and_b32 s48, s48, 0x7fff
    s_or_b32 s39, s36, 0x55555555
    s_and_b32 s39, s39, 0xffff
    s_add_u32 s46, s45, 65536
    s_add_u32 s47, s45, 98304
    s_mov_b64 s[52:53], 0
    s_waitcnt lgkmcnt(0)
    s_barrier
    s_add_u32 s16, s54, 41943040
    s_addc_u32 s17, s55, 0
    s_and_b32 s17, s17, 0xffff
    s_mov_b32 s18, 16777216
    s_mov_b32 s19, 0x20000
    s_mov_b32 s4, s92
    s_and_b32 s5, s93, 0xffff
    s_mov_b32 s6, 7340032
    s_mov_b32 s7, 0x20000
    s_mov_b32 s8, s94
    s_and_b32 s9, s95, 0xffff
    s_mov_b32 s10, 7340032
    s_mov_b32 s11, 0x20000
    s_and_b32 s60, s29, 3
    s_add_u32 s60, s60, 4
    s_sub_u32 s3, s2, 32
    s_cmp_eq_u32 s28, 0
    s_cselect_b32 s36, 0xad, 0x2d
    s_cselect_b32 s42, 14, 12
    s_cmp_lt_u32 s3, 224
    s_cselect_b32 s36, s36, 0
    s_lshl_b32 s36, s36, s60
    s_or_b32 s42, s42, s36
    ds_read_b128 v[64:67], v2 offset:0
    ds_read_b128 v[68:71], v2 offset:1024
    ds_read_b128 v[72:75], v2 offset:2048
    ds_read_b128 v[76:79], v2 offset:3072
    ds_read_b128 v[80:83], v2 offset:4096
    ds_read_b128 v[84:87], v2 offset:5120
    ds_read_b128 v[88:91], v2 offset:6144
    ds_read_b128 v[92:95], v2 offset:7168
    s_waitcnt lgkmcnt(7)
    v_mfma_f32_16x16x32_bf16 v[96:99], v[64:67], v[128:131], 0
    v_mov_b64 v[192:193], 0
    v_mov_b64 v[194:195], 0
    v_mfma_f32_16x16x32_bf16 v[104:107], v[64:67], v[144:147], 0
    ds_read_b128 v[64:67], v2 offset:8192
    v_mov_b64 v[196:197], 0
    v_mov_b64 v[198:199], 0
    s_waitcnt lgkmcnt(7)
    v_mfma_f32_16x16x32_bf16 v[96:99], v[68:71], v[132:135], v[96:99]
    v_mov_b64 v[200:201], 0
    v_mov_b64 v[202:203], 0
    v_mfma_f32_16x16x32_bf16 v[104:107], v[68:71], v[148:151], v[104:107]
    ds_read_b128 v[68:71], v2 offset:9216
    v_mov_b64 v[204:205], 0
    v_mov_b64 v[206:207], 0
    s_waitcnt lgkmcnt(7)
    v_mfma_f32_16x16x32_bf16 v[96:99], v[72:75], v[136:139], v[96:99]
    v_mov_b64 v[208:209], 0
    v_mfma_f32_16x16x32_bf16 v[104:107], v[72:75], v[152:155], v[104:107]
    ds_read_b128 v[72:75], v2 offset:10240
    v_mov_b64 v[210:211], 0
    v_mov_b64 v[212:213], 0
    s_waitcnt lgkmcnt(7)
    v_mfma_f32_16x16x32_bf16 v[96:99], v[76:79], v[140:143], v[96:99]
    v_mov_b64 v[214:215], 0
    v_mov_b64 v[216:217], 0
    v_mfma_f32_16x16x32_bf16 v[104:107], v[76:79], v[156:159], v[104:107]
    ds_read_b128 v[76:79], v2 offset:11264
    v_mov_b64 v[218:219], 0
    v_mov_b64 v[220:221], 0
    s_waitcnt lgkmcnt(7)
    v_mfma_f32_16x16x32_bf16 v[100:103], v[80:83], v[128:131], 0
    v_mov_b64 v[222:223], 0
    v_mov_b64 v[224:225], 0
    v_mfma_f32_16x16x32_bf16 v[108:111], v[80:83], v[144:147], 0
    ds_read_b128 v[80:83], v2 offset:12288
    v_mov_b64 v[226:227], 0
    s_waitcnt lgkmcnt(7)
    v_mfma_f32_16x16x32_bf16 v[100:103], v[84:87], v[132:135], v[100:103]
    v_mov_b64 v[228:229], 0
    v_mov_b64 v[230:231], 0
    v_mfma_f32_16x16x32_bf16 v[108:111], v[84:87], v[148:151], v[108:111]
    ds_read_b128 v[84:87], v2 offset:13312
    v_mov_b64 v[232:233], 0
    v_mov_b64 v[234:235], 0
    s_waitcnt lgkmcnt(7)
    v_mfma_f32_16x16x32_bf16 v[100:103], v[88:91], v[136:139], v[100:103]
    v_mov_b64 v[236:237], 0
    v_mov_b64 v[238:239], 0
    v_mfma_f32_16x16x32_bf16 v[108:111], v[88:91], v[152:155], v[108:111]
    ds_read_b128 v[88:91], v2 offset:14336
    v_mov_b64 v[240:241], 0
    v_mov_b64 v[242:243], 0
    s_waitcnt lgkmcnt(7)
    v_mfma_f32_16x16x32_bf16 v[100:103], v[92:95], v[140:143], v[100:103]
    v_mov_b64 v[244:245], 0
    v_mfma_f32_16x16x32_bf16 v[108:111], v[92:95], v[156:159], v[108:111]
    ds_read_b128 v[92:95], v2 offset:15360
    v_mov_b64 v[246:247], 0
    v_mov_b64 v[248:249], 0
    s_waitcnt lgkmcnt(7)
    v_mfma_f32_16x16x32_bf16 v[112:115], v[64:67], v[128:131], 0
    v_mov_b64 v[250:251], 0
    v_mov_b64 v[252:253], 0
    v_mfma_f32_16x16x32_bf16 v[120:123], v[64:67], v[144:147], 0
    v_mov_b64 v[254:255], 0
    v_mov_b64 v[28:29], 0
    s_waitcnt lgkmcnt(6)
    v_mfma_f32_16x16x32_bf16 v[112:115], v[68:71], v[132:135], v[112:115]
    v_mov_b64 v[30:31], 0
    v_mov_b64 v[32:33], 0
    v_mfma_f32_16x16x32_bf16 v[120:123], v[68:71], v[148:151], v[120:123]
    v_mov_b64 v[34:35], 0
    s_waitcnt lgkmcnt(5)
    v_mfma_f32_16x16x32_bf16 v[112:115], v[72:75], v[136:139], v[112:115]
    v_mfma_f32_16x16x32_bf16 v[120:123], v[72:75], v[152:155], v[120:123]
    v_max3_f32 v22, v96, v97, v98
    v_max3_f32 v23, v104, v105, v106
    s_waitcnt lgkmcnt(4)
    v_mfma_f32_16x16x32_bf16 v[112:115], v[76:79], v[140:143], v[112:115]
    v_max3_f32 v22, v22, v99, v100
    v_max3_f32 v23, v23, v107, v108
    v_mfma_f32_16x16x32_bf16 v[120:123], v[76:79], v[156:159], v[120:123]
    v_max3_f32 v22, v22, v101, v102
    v_max3_f32 v23, v23, v109, v110
    s_waitcnt lgkmcnt(3)
    v_mfma_f32_16x16x32_bf16 v[116:119], v[80:83], v[128:131], 0
    v_max_f32 v22, v22, v103
    v_max_f32 v23, v23, v111
    v_mfma_f32_16x16x32_bf16 v[124:127], v[80:83], v[144:147], 0
    v_mov_b32 v24, v22
    v_mov_b32 v25, v23
    s_waitcnt lgkmcnt(2)
    v_mfma_f32_16x16x32_bf16 v[116:119], v[84:87], v[132:135], v[116:119]
    v_permlane16_swap_b32 v22, v24
    v_permlane16_swap_b32 v23, v25
    v_mfma_f32_16x16x32_bf16 v[124:127], v[84:87], v[148:151], v[124:127]
    v_max_f32 v22, v22, v24
    v_max_f32 v23, v23, v25
    s_waitcnt lgkmcnt(1)
    v_mfma_f32_16x16x32_bf16 v[116:119], v[88:91], v[136:139], v[116:119]
    v_mov_b32 v24, v22
    v_mov_b32 v25, v23
    v_mfma_f32_16x16x32_bf16 v[124:127], v[88:91], v[152:155], v[124:127]
    v_permlane32_swap_b32 v22, v24
    v_permlane32_swap_b32 v23, v25
    s_waitcnt lgkmcnt(0)
    v_mfma_f32_16x16x32_bf16 v[116:119], v[92:95], v[140:143], v[116:119]
    v_max_f32 v22, v22, v24
    v_max_f32 v23, v23, v25
    v_mfma_f32_16x16x32_bf16 v[124:127], v[92:95], v[156:159], v[124:127]
    v_sub_f32 v40, 0, v22
    v_sub_f32 v41, 0, v22
    v_sub_f32 v42, 0, v22
    v_sub_f32 v43, 0, v22
    v_sub_f32 v44, 0, v23
    v_sub_f32 v45, 0, v23
    v_sub_f32 v46, 0, v23
    v_sub_f32 v47, 0, v23
    v_add_u32 v3, 65536, v2
    v_add_u32 v2, s41, v2
    v_and_b32 v2, s49, v2
    s_waitcnt vmcnt(0)
    s_barrier
    s_cmp_eq_u32 s28, 0
    s_cbranch_scc1 L_recurrent_scan__compressed_kv_cla__moe_arch_mod__prompt_kernel_rare_66
L_recurrent_scan__compressed_kv_cla__moe_arch_mod__prompt_kernel_back_67:
    ds_read_b128 v[64:67], v2 offset:0
    ds_read_b128 v[68:71], v2 offset:1024
    ds_read_b128 v[72:75], v2 offset:2048
    ds_read_b128 v[76:79], v2 offset:3072
    ds_read_b128 v[80:83], v2 offset:4096
    ds_read_b128 v[84:87], v2 offset:5120
    ds_read_b128 v[88:91], v2 offset:6144
    ds_write_b32 v19, v40
    ds_write_b32 v19, v44 offset:4
    v_pk_add_f32 v[96:97], v[96:97], v[40:41]
    v_pk_add_f32 v[98:99], v[98:99], v[40:41]
    v_pk_add_f32 v[100:101], v[100:101], v[40:41]
    v_pk_add_f32 v[102:103], v[102:103], v[40:41]
    v_pk_add_f32 v[104:105], v[104:105], v[44:45]
    v_pk_add_f32 v[106:107], v[106:107], v[44:45]
    v_pk_add_f32 v[108:109], v[108:109], v[44:45]
    v_pk_add_f32 v[110:111], v[110:111], v[44:45]
    v_pk_add_f32 v[112:113], v[112:113], v[40:41]
    v_pk_add_f32 v[114:115], v[114:115], v[40:41]
    v_pk_add_f32 v[116:117], v[116:117], v[40:41]
    v_pk_add_f32 v[118:119], v[118:119], v[40:41]
    v_pk_add_f32 v[120:121], v[120:121], v[44:45]
    v_pk_add_f32 v[122:123], v[122:123], v[44:45]
    v_pk_add_f32 v[124:125], v[124:125], v[44:45]
    v_pk_add_f32 v[126:127], v[126:127], v[44:45]
    v_exp_f32 v96, v96
    v_exp_f32 v97, v97
    v_exp_f32 v98, v98
    v_exp_f32 v99, v99
    v_exp_f32 v104, v104
    v_exp_f32 v105, v105
    v_exp_f32 v106, v106
    v_exp_f32 v107, v107
    v_exp_f32 v100, v100
    v_exp_f32 v101, v101
    v_exp_f32 v102, v102
    v_exp_f32 v103, v103
    v_exp_f32 v108, v108
    v_exp_f32 v109, v109
    v_exp_f32 v110, v110
    v_exp_f32 v111, v111
    v_cvt_pk_bf16_f32 v48, v96, v97
    v_cvt_pk_bf16_f32 v49, v98, v99
    v_cvt_pk_bf16_f32 v52, v104, v105
    v_cvt_pk_bf16_f32 v53, v106, v107
    v_cvt_pk_bf16_f32 v50, v100, v101
    v_cvt_pk_bf16_f32 v51, v102, v103
    v_cvt_pk_bf16_f32 v54, v108, v109
    v_cvt_pk_bf16_f32 v55, v110, v111
    .p2align 6
L_body0:
    s_waitcnt lgkmcnt(5)
    v_mfma_f32_16x16x32_bf16 v[96:99], v[64:67], v[128:131], v[40:43]
    v_exp_f32 v112, v112
    v_mfma_f32_16x16x32_bf16 v[104:107], v[64:67], v[144:147], v[44:47]
    ds_read_b128 v[92:95], v2 offset:7168
    s_bitcmp1_b32 s48, s40
    s_cbranch_scc0 L_recurrent_scan__compressed_kv_cla__moe_arch_mod__prompt_kernel_nodma_90
    s_add_u32 m0, s43, 0
    s_nop 0
    buffer_load_dwordx4 v4, s[12:15], s46 offen offset:0 sc1 lds
    buffer_load_dwordx4 v4, s[12:15], s46 offen offset:1024 sc1 lds
L_recurrent_scan__compressed_kv_cla__moe_arch_mod__prompt_kernel_nodma_90:
    v_mfma_f32_16x16x32_bf16 v[96:99], v[68:71], v[132:135], v[96:99]
    v_exp_f32 v113, v113
    v_mfma_f32_16x16x32_bf16 v[104:107], v[68:71], v[148:151], v[104:107]
    ds_read_b128 v[64:67], v3 offset:0
    s_waitcnt lgkmcnt(5)
    v_mfma_f32_16x16x32_bf16 v[96:99], v[72:75], v[136:139], v[96:99]
    v_exp_f32 v114, v114
    v_mfma_f32_16x16x32_bf16 v[104:107], v[72:75], v[152:155], v[104:107]
    ds_read_b128 v[68:71], v3 offset:1024
    v_cvt_pk_bf16_f32 v56, v112, v113
    s_bitcmp1_b32 s48, s40
    s_cbranch_scc0 L_recurrent_scan__compressed_kv_cla__moe_arch_mod__prompt_kernel_nodma_91
    s_add_u32 m0, s43, 0
    s_nop 0
    buffer_load_dwordx4 v4, s[12:15], s46 offen offset:2048 sc1 lds
    buffer_load_dwordx4 v4, s[12:15], s46 offen offset:3072 sc1 lds
L_recurrent_scan__compressed_kv_cla__moe_arch_mod__prompt_kernel_nodma_91:
    v_mfma_f32_16x16x32_bf16 v[96:99], v[76:79], v[140:143], v[96:99]
    v_exp_f32 v115, v115
    v_mfma_f32_16x16x32_bf16 v[104:107], v[76:79], v[156:159], v[104:107]
    ds_read_b128 v[72:75], v3 offset:2048
    s_waitcnt lgkmcnt(5)
    v_mfma_f32_16x16x32_bf16 v[100:103], v[80:83], v[128:131], v[40:43]
    v_exp_f32 v120, v120
    v_mfma_f32_16x16x32_bf16 v[108:111], v[80:83], v[144:147], v[44:47]
    ds_read_b128 v[76:79], v3 offset:3072
    v_cvt_pk_bf16_f32 v57, v114, v115
    v_mfma_f32_16x16x32_bf16 v[100:103], v[84:87], v[132:135], v[100:103]
    v_exp_f32 v121, v121
    v_mfma_f32_16x16x32_bf16 v[108:111], v[84:87], v[148:151], v[108:111]
    ds_read_b128 v[80:83], v3 offset:4096
    s_bitcmp1_b32 s48, s40
    s_cbranch_scc0 L_recurrent_scan__compressed_kv_cla__moe_arch_mod__prompt_kernel_nodma_92
    s_add_u32 m0, s43, 4096
    s_nop 0
    buffer_load_dwordx4 v6, s[12:15], s46 offen offset:0 sc1 lds
    buffer_load_dwordx4 v6, s[12:15], s46 offen offset:1024 sc1 lds
L_recurrent_scan__compressed_kv_cla__moe_arch_mod__prompt_kernel_nodma_92:
    s_waitcnt lgkmcnt(5)
    v_mfma_f32_16x16x32_bf16 v[100:103], v[88:91], v[136:139], v[100:103]
    v_exp_f32 v122, v122
    v_mfma_f32_16x16x32_bf16 v[108:111], v[88:91], v[152:155], v[108:111]
    ds_read_b128 v[84:87], v3 offset:5120
    v_cvt_pk_bf16_f32 v60, v120, v121
    v_mfma_f32_16x16x32_bf16 v[100:103], v[92:95], v[140:143], v[100:103]
    v_exp_f32 v123, v123
    v_mfma_f32_16x16x32_bf16 v[108:111], v[92:95], v[156:159], v[108:111]
    ds_read_b128 v[88:91], v3 offset:6144
    s_bitcmp1_b32 s48, s40
    s_cbranch_scc0 L_recurrent_scan__compressed_kv_cla__moe_arch_mod__prompt_kernel_nodma_93
    s_add_u32 m0, s43, 4096
    s_nop 0
    buffer_load_dwordx4 v6, s[12:15], s46 offen offset:2048 sc1 lds
    buffer_load_dwordx4 v6, s[12:15], s46 offen offset:3072 sc1 lds
    s_add_u32 s46, s46, 65536
    s_xor_b32 s43, s43, 32768
L_recurrent_scan__compressed_kv_cla__moe_arch_mod__prompt_kernel_nodma_93:
    s_waitcnt lgkmcnt(5)
    v_mfma_f32_16x16x32_bf16 v[192:195], v[64:67], v[48:51], v[192:195]
    v_exp_f32 v116, v116
    v_mfma_f32_16x16x32_bf16 v[224:227], v[64:67], v[52:55], v[224:227]
    ds_read_b128 v[92:95], v3 offset:7168
    v_cvt_pk_bf16_f32 v61, v122, v123
    v_mfma_f32_16x16x32_bf16 v[196:199], v[68:71], v[48:51], v[196:199]
    v_exp_f32 v117, v117
    v_mfma_f32_16x16x32_bf16 v[228:231], v[68:71], v[52:55], v[228:231]
    ds_read_b128 v[64:67], v2 offset:8192
    s_waitcnt lgkmcnt(5)
    v_mfma_f32_16x16x32_bf16 v[200:203], v[72:75], v[48:51], v[200:203]
    v_exp_f32 v118, v118
    v_mfma_f32_16x16x32_bf16 v[232:235], v[72:75], v[52:55], v[232:235]
    v_mfma_f32_16x16x32_bf16 v[28:31], v[36:39], v[48:51], v[28:31]
    ds_read_b128 v[68:71], v2 offset:9216
    v_cvt_pk_bf16_f32 v58, v116, v117
    s_bitcmp1_b32 s39, s40
    s_cbranch_scc0 L_recurrent_scan__compressed_kv_cla__moe_arch_mod__prompt_kernel_nodma_94
    s_add_u32 m0, s44, 0
    s_nop 0
    buffer_load_dwordx4 v4, s[12:15], s47 offen offset:0 sc1 lds
    buffer_load_dwordx4 v4, s[12:15], s47 offen offset:1024 sc1 lds
L_recurrent_scan__compressed_kv_cla__moe_arch_mod__prompt_kernel_nodma_94:
    v_mfma_f32_16x16x32_bf16 v[204:207], v[76:79], v[48:51], v[204:207]
    v_exp_f32 v119, v119
    v_mfma_f32_16x16x32_bf16 v[236:239], v[76:79], v[52:55], v[236:239]
    ds_read_b128 v[72:75], v2 offset:10240
    s_waitcnt lgkmcnt(5)
    v_mfma_f32_16x16x32_bf16 v[208:211], v[80:83], v[48:51], v[208:211]
    v_exp_f32 v124, v124
    v_mfma_f32_16x16x32_bf16 v[240:243], v[80:83], v[52:55], v[240:243]
    ds_read_b128 v[76:79], v2 offset:11264
    v_cvt_pk_bf16_f32 v59, v118, v119
    s_bitcmp1_b32 s39, s40
    s_cbranch_scc0 L_recurrent_scan__compressed_kv_cla__moe_arch_mod__prompt_kernel_nodma_95
    s_add_u32 m0, s44, 0
    s_nop 0
    buffer_load_dwordx4 v4, s[12:15], s47 offen offset:2048 sc1 lds
    buffer_load_dwordx4 v4, s[12:15], s47 offen offset:3072 sc1 lds
L_recurrent_scan__compressed_kv_cla__moe_arch_mod__prompt_kernel_nodma_95:
    v_mfma_f32_16x16x32_bf16 v[212:215], v[84:87], v[48:51], v[212:215]
    v_exp_f32 v125, v125
    v_mfma_f32_16x16x32_bf16 v[244:247], v[84:87], v[52:55], v[244:247]
    ds_read_b128 v[80:83], v2 offset:12288
    s_waitcnt lgkmcnt(5)
    v_mfma_f32_16x16x32_bf16 v[216:219], v[88:91], v[48:51], v[216:219]
    v_exp_f32 v126, v126
    v_mfma_f32_16x16x32_bf16 v[248:251], v[88:91], v[52:55], v[248:251]
    v_mfma_f32_16x16x32_bf16 v[32:35], v[36:39], v[52:55], v[32:35]
    ds_read_b128 v[84:87], v2 offset:13312
    v_cvt_pk_bf16_f32 v62, v124, v125
    v_mfma_f32_16x16x32_bf16 v[220:223], v[92:95], v[48:51], v[220:223]
    v_exp_f32 v127, v127
    v_mfma_f32_16x16x32_bf16 v[252:255], v[92:95], v[52:55], v[252:255]
    ds_read_b128 v[88:91], v2 offset:14336
    v_cvt_pk_bf16_f32 v63, v126, v127
    s_bitcmp1_b32 s39, s40
    s_cbranch_scc0 L_recurrent_scan__compressed_kv_cla__moe_arch_mod__prompt_kernel_nodma_96
    s_add_u32 m0, s44, 4096
    s_nop 0
    buffer_load_dwordx4 v6, s[12:15], s47 offen offset:0 sc1 lds
    buffer_load_dwordx4 v6, s[12:15], s47 offen offset:1024 sc1 lds
L_recurrent_scan__compressed_kv_cla__moe_arch_mod__prompt_kernel_nodma_96:
    s_bitcmp1_b32 s31, s40
    s_cbranch_scc1 L_recurrent_scan__compressed_kv_cla__moe_arch_mod__prompt_kernel_rare_72
L_recurrent_scan__compressed_kv_cla__moe_arch_mod__prompt_kernel_back_73:
    s_waitcnt lgkmcnt(5)
    v_mfma_f32_16x16x32_bf16 v[112:115], v[64:67], v[128:131], v[40:43]
    v_exp_f32 v96, v96
    v_mfma_f32_16x16x32_bf16 v[120:123], v[64:67], v[144:147], v[44:47]
    ds_read_b128 v[92:95], v2 offset:15360
    v_mfma_f32_16x16x32_bf16 v[112:115], v[68:71], v[132:135], v[112:115]
    v_exp_f32 v97, v97
    v_mfma_f32_16x16x32_bf16 v[120:123], v[68:71], v[148:151], v[120:123]
    ds_read_b128 v[64:67], v3 offset:8192
    s_bitcmp1_b32 s39, s40
    s_cbranch_scc0 L_recurrent_scan__compressed_kv_cla__moe_arch_mod__prompt_kernel_nodma_97
    s_add_u32 m0, s44, 4096
    s_nop 0
    buffer_load_dwordx4 v6, s[12:15], s47 offen offset:2048 sc1 lds
    buffer_load_dwordx4 v6, s[12:15], s47 offen offset:3072 sc1 lds
    s_add_u32 s47, s47, 65536
    s_xor_b32 s44, s44, 32768
L_recurrent_scan__compressed_kv_cla__moe_arch_mod__prompt_kernel_nodma_97:
    s_waitcnt lgkmcnt(5)
    v_mfma_f32_16x16x32_bf16 v[112:115], v[72:75], v[136:139], v[112:115]
    v_exp_f32 v98, v98
    v_mfma_f32_16x16x32_bf16 v[120:123], v[72:75], v[152:155], v[120:123]
    ds_read_b128 v[68:71], v3 offset:9216
    v_cvt_pk_bf16_f32 v48, v96, v97
    v_mfma_f32_16x16x32_bf16 v[112:115], v[76:79], v[140:143], v[112:115]
    v_exp_f32 v99, v99
    v_mfma_f32_16x16x32_bf16 v[120:123], v[76:79], v[156:159], v[120:123]
    ds_read_b128 v[72:75], v3 offset:10240
    s_waitcnt lgkmcnt(5)
    v_mfma_f32_16x16x32_bf16 v[116:119], v[80:83], v[128:131], v[40:43]
    v_exp_f32 v104, v104
    v_mfma_f32_16x16x32_bf16 v[124:127], v[80:83], v[144:147], v[44:47]
    ds_read_b128 v[76:79], v3 offset:11264
    v_cvt_pk_bf16_f32 v49, v98, v99
    v_mfma_f32_16x16x32_bf16 v[116:119], v[84:87], v[132:135], v[116:119]
    v_exp_f32 v105, v105
    v_mfma_f32_16x16x32_bf16 v[124:127], v[84:87], v[148:151], v[124:127]
    ds_read_b128 v[80:83], v3 offset:12288
    s_waitcnt lgkmcnt(5)
    v_mfma_f32_16x16x32_bf16 v[116:119], v[88:91], v[136:139], v[116:119]
    v_exp_f32 v106, v106
    v_mfma_f32_16x16x32_bf16 v[124:127], v[88:91], v[152:155], v[124:127]
    ds_read_b128 v[84:87], v3 offset:13312
    v_cvt_pk_bf16_f32 v52, v104, v105
    v_mfma_f32_16x16x32_bf16 v[116:119], v[92:95], v[140:143], v[116:119]
    v_exp_f32 v107, v107
    v_mfma_f32_16x16x32_bf16 v[124:127], v[92:95], v[156:159], v[124:127]
    ds_read_b128 v[88:91], v3 offset:14336
    s_waitcnt lgkmcnt(5)
    v_mfma_f32_16x16x32_bf16 v[192:195], v[64:67], v[56:59], v[192:195]
    v_exp_f32 v100, v100
    v_mfma_f32_16x16x32_bf16 v[224:227], v[64:67], v[60:63], v[224:227]
    ds_read_b128 v[92:95], v3 offset:15360
    v_cvt_pk_bf16_f32 v53, v106, v107
    v_mfma_f32_16x16x32_bf16 v[196:199], v[68:71], v[56:59], v[196:199]
    v_exp_f32 v101, v101
    v_mfma_f32_16x16x32_bf16 v[228:231], v[68:71], v[60:63], v[228:231]
    v_add_u32 v3, 65536, v2
    v_add_u32 v2, s41, v2
    s_waitcnt lgkmcnt(4)
    v_mfma_f32_16x16x32_bf16 v[200:203], v[72:75], v[56:59], v[200:203]
    v_exp_f32 v102, v102
    s_add_u32 s40, s40, 1
    v_and_b32 v2, s49, v2
    v_mfma_f32_16x16x32_bf16 v[232:235], v[72:75], v[60:63], v[232:235]
    v_mfma_f32_16x16x32_bf16 v[28:31], v[36:39], v[56:59], v[28:31]
    v_cvt_pk_bf16_f32 v50, v100, v101
    s_waitcnt vmcnt(8) lgkmcnt(0)
    s_cmp_le_u32 s40, s51
    s_cbranch_scc1 L_recurrent_scan__compressed_kv_cla__moe_arch_mod__prompt_kernel_rlx_74
    s_waitcnt vmcnt(0)
L_recurrent_scan__compressed_kv_cla__moe_arch_mod__prompt_kernel_rlx_74:
    s_bitcmp1_b32 s42, s40
    s_cbranch_scc1 L_recurrent_scan__compressed_kv_cla__moe_arch_mod__prompt_kernel_rare_88
L_recurrent_scan__compressed_kv_cla__moe_arch_mod__prompt_kernel_back_89:
    s_barrier
    v_mfma_f32_16x16x32_bf16 v[204:207], v[76:79], v[56:59], v[204:207]
    v_exp_f32 v103, v103
    v_mfma_f32_16x16x32_bf16 v[236:239], v[76:79], v[60:63], v[236:239]
    ds_read_b128 v[68:71], v2 offset:1024
    ds_read_b128 v[64:67], v2 offset:0
    v_mfma_f32_16x16x32_bf16 v[208:211], v[80:83], v[56:59], v[208:211]
    v_exp_f32 v108, v108
    v_mfma_f32_16x16x32_bf16 v[240:243], v[80:83], v[60:63], v[240:243]
    ds_read_b128 v[76:79], v2 offset:3072
    ds_read_b128 v[72:75], v2 offset:2048
    v_cvt_pk_bf16_f32 v51, v102, v103
    v_mfma_f32_16x16x32_bf16 v[212:215], v[84:87], v[56:59], v[212:215]
    v_exp_f32 v109, v109
    v_mfma_f32_16x16x32_bf16 v[244:247], v[84:87], v[60:63], v[244:247]
    ds_read_b128 v[80:83], v2 offset:4096
    v_mfma_f32_16x16x32_bf16 v[216:219], v[88:91], v[56:59], v[216:219]
    v_exp_f32 v110, v110
    v_mfma_f32_16x16x32_bf16 v[248:251], v[88:91], v[60:63], v[248:251]
    v_mfma_f32_16x16x32_bf16 v[32:35], v[36:39], v[60:63], v[32:35]
    ds_read_b128 v[84:87], v2 offset:5120
    v_cvt_pk_bf16_f32 v54, v108, v109
    v_mfma_f32_16x16x32_bf16 v[220:223], v[92:95], v[56:59], v[220:223]
    v_exp_f32 v111, v111
    v_mfma_f32_16x16x32_bf16 v[252:255], v[92:95], v[60:63], v[252:255]
    ds_read_b128 v[88:91], v2 offset:6144
    v_cvt_pk_bf16_f32 v55, v110, v111
    s_cmp_lg_u32 s40, 16
    s_cbranch_scc1 L_body0
    s_lshr_b32 s36, s2, 5
    s_add_u32 s36, s36, 48
    s_lshl_b32 s36, s36, 7
    v_mov_b32 v12, s36
    global_load_dword v11, v12, s[90:91] sc1
    s_sub_u32 s36, 32, s50
    s_cmp_lt_i32 s36, 0
    s_cbranch_scc0 L_recurrent_scan__compressed_kv_cla__moe_arch_mod__prompt_kernel_rare_98
L_recurrent_scan__compressed_kv_cla__moe_arch_mod__prompt_kernel_back_99:
    s_lshl_b32 s37, s28, 13
    v_add_u32 v5, s37, v7
    s_waitcnt lgkmcnt(5)
    v_mfma_f32_16x16x32_bf16 v[192:195], v[64:67], v[48:51], v[192:195]
    v_exp_f32 v112, v112
    v_mfma_f32_16x16x32_bf16 v[224:227], v[64:67], v[52:55], v[224:227]
    ds_read_b128 v[92:95], v3 offset:7168
    v_exp_f32 v113, v113
    v_mfma_f32_16x16x32_bf16 v[196:199], v[68:71], v[48:51], v[196:199]
    v_cvt_pk_bf16_f32 v56, v112, v113
    v_exp_f32 v114, v114
    v_mfma_f32_16x16x32_bf16 v[228:231], v[68:71], v[52:55], v[228:231]
    ds_read_b128 v[64:67], v3 offset:8192
    v_exp_f32 v115, v115
    s_waitcnt lgkmcnt(5)
    v_mfma_f32_16x16x32_bf16 v[200:203], v[72:75], v[48:51], v[200:203]
    v_cvt_pk_bf16_f32 v57, v114, v115
    v_exp_f32 v120, v120
    v_mfma_f32_16x16x32_bf16 v[232:235], v[72:75], v[52:55], v[232:235]
    v_mfma_f32_16x16x32_bf16 v[28:31], v[36:39], v[48:51], v[28:31]
    ds_read_b128 v[68:71], v3 offset:9216
    v_exp_f32 v121, v121
    v_mfma_f32_16x16x32_bf16 v[204:207], v[76:79], v[48:51], v[204:207]
    v_cvt_pk_bf16_f32 v60, v120, v121
    v_exp_f32 v122, v122
    v_mfma_f32_16x16x32_bf16 v[236:239], v[76:79], v[52:55], v[236:239]
    ds_read_b128 v[72:75], v3 offset:10240
    v_exp_f32 v123, v123
    s_waitcnt lgkmcnt(6)
    v_mfma_f32_16x16x32_bf16 v[208:211], v[80:83], v[48:51], v[208:211]
    v_cvt_pk_bf16_f32 v61, v122, v123
    v_exp_f32 v116, v116
    v_mfma_f32_16x16x32_bf16 v[240:243], v[80:83], v[52:55], v[240:243]
    ds_read_b128 v[76:79], v3 offset:11264
    v_exp_f32 v117, v117
    s_waitcnt lgkmcnt(6)
    v_mfma_f32_16x16x32_bf16 v[212:215], v[84:87], v[48:51], v[212:215]
    v_cvt_pk_bf16_f32 v58, v116, v117
    v_exp_f32 v118, v118
    v_mfma_f32_16x16x32_bf16 v[244:247], v[84:87], v[52:55], v[244:247]
    ds_read_b128 v[80:83], v3 offset:12288
    v_exp_f32 v119, v119
    s_waitcnt lgkmcnt(6)
    v_mfma_f32_16x16x32_bf16 v[216:219], v[88:91], v[48:51], v[216:219]
    v_cvt_pk_bf16_f32 v59, v118, v119
    v_exp_f32 v124, v124
    v_mfma_f32_16x16x32_bf16 v[248:251], v[88:91], v[52:55], v[248:251]
    v_mfma_f32_16x16x32_bf16 v[32:35], v[36:39], v[52:55], v[32:35]
    ds_read_b128 v[84:87], v3 offset:13312
    v_exp_f32 v125, v125
    s_waitcnt lgkmcnt(6)
    v_mfma_f32_16x16x32_bf16 v[220:223], v[92:95], v[48:51], v[220:223]
    v_cvt_pk_bf16_f32 v62, v124, v125
    v_exp_f32 v126, v126
    v_mfma_f32_16x16x32_bf16 v[252:255], v[92:95], v[52:55], v[252:255]
    ds_read_b128 v[88:91], v3 offset:14336
    v_exp_f32 v127, v127
    s_nop 0
    v_cvt_pk_bf16_f32 v63, v126, v127
    s_nop 1
    s_waitcnt lgkmcnt(6)
    v_mfma_f32_16x16x32_bf16 v[192:195], v[64:67], v[56:59], v[192:195]
    s_mov_b32 s4, s34
    s_and_b32 s5, s35, 0xffff
    s_mov_b32 s6, 7340032
    s_mov_b32 s7, 0x20000
    s_mov_b32 s8, s32
    v_mfma_f32_16x16x32_bf16 v[224:227], v[64:67], v[60:63], v[224:227]
    ds_read_b128 v[92:95], v3 offset:15360
    s_and_b32 s9, s33, 0xffff
    s_mov_b32 s10, 8388608
    s_mov_b32 s11, 0x20000
    s_lshr_b32 s38, s2, 4
    s_waitcnt lgkmcnt(6)
    v_mfma_f32_16x16x32_bf16 v[196:199], v[68:71], v[56:59], v[196:199]
    s_mul_i32 s38, s38, 224
    s_and_b32 s39, s2, 15
    s_lshl_b32 s39, s39, 7
    v_lshrrev_b32 v25, 3, v1
    s_lshl_b32 s36, s28, 5
    v_mfma_f32_16x16x32_bf16 v[228:231], v[68:71], v[60:63], v[228:231]
    s_add_u32 s36, s36, s38
    v_add_u32 v25, s36, v25
    v_mul_u32_u24 v25, 2048, v25
    v_add_u32 v25, s39, v25
    s_waitcnt lgkmcnt(5)
    v_mfma_f32_16x16x32_bf16 v[200:203], v[72:75], v[56:59], v[200:203]
    v_bfe_u32 v26, v1, 4, 1
    v_lshlrev_b32 v26, 1, v26
    v_and_b32 v27, 7, v1
    v_xor_b32 v26, v26, v27
    v_mfma_f32_16x16x32_bf16 v[232:235], v[72:75], v[60:63], v[232:235]
    v_mfma_f32_16x16x32_bf16 v[28:31], v[36:39], v[56:59], v[28:31]
    v_lshl_add_u32 v24, v26, 4, v25
    v_xor_b32 v26, 4, v26
    v_lshl_add_u32 v25, v26, 4, v25
    v_add_u32 v25, 15360, v25
    v_add_u32 v26, 30720, v24
    s_waitcnt lgkmcnt(4)
    v_mfma_f32_16x16x32_bf16 v[204:207], v[76:79], v[56:59], v[204:207]
    v_add_u32 v27, 30720, v25
    s_lshl_b32 s36, s28, 12
    s_add_u32 s36, s36, 131072
    s_cmp_lt_u32 s28, 7
    s_cselect_b32 m0, s36, 0x30000
    s_cselect_b32 s6, 7340032, 0
    v_mfma_f32_16x16x32_bf16 v[236:239], v[76:79], v[60:63], v[236:239]
    buffer_load_dwordx4 v24, s[4:7], 0 offen offset:0 lds
    buffer_load_dwordx4 v25, s[4:7], 0 offen offset:1024 lds
    buffer_load_dwordx4 v26, s[4:7], 0 offen offset:2048 lds
    buffer_load_dwordx4 v27, s[4:7], 0 offen offset:3072 lds
    s_waitcnt lgkmcnt(3)
    v_mfma_f32_16x16x32_bf16 v[208:211], v[80:83], v[56:59], v[208:211]
    v_mfma_f32_16x16x32_bf16 v[240:243], v[80:83], v[60:63], v[240:243]
    ds_write_b128 v5, v[224:227] offset:0
    s_waitcnt lgkmcnt(3)
    v_mfma_f32_16x16x32_bf16 v[212:215], v[84:87], v[56:59], v[212:215]
    v_mfma_f32_16x16x32_bf16 v[244:247], v[84:87], v[60:63], v[244:247]
    ds_write_b128 v5, v[228:231] offset:1024
    s_waitcnt lgkmcnt(3)
    v_mfma_f32_16x16x32_bf16 v[216:219], v[88:91], v[56:59], v[216:219]
    v_mfma_f32_16x16x32_bf16 v[248:251], v[88:91], v[60:63], v[248:251]
    v_mfma_f32_16x16x32_bf16 v[32:35], v[36:39], v[60:63], v[32:35]
    ds_write_b128 v5, v[232:235] offset:2048
    s_waitcnt lgkmcnt(3)
    v_mfma_f32_16x16x32_bf16 v[220:223], v[92:95], v[56:59], v[220:223]
    v_mfma_f32_16x16x32_bf16 v[252:255], v[92:95], v[60:63], v[252:255]
    ds_write_b128 v5, v[236:239] offset:3072
    ds_write_b128 v5, v[240:243] offset:4096
    ds_write_b128 v5, v[244:247] offset:5120
    v_xor_b32 v106, 32768, v5
    s_lshl_b32 s37, s28, 8
    s_add_u32 s37, s37, 159744
    v_lshl_add_u32 v107, v1, 2, s37
    v_xor_b32 v108, 1024, v107
    ds_write_b128 v5, v[248:251] offset:6144
    ds_write_b128 v5, v[252:255] offset:7168
    ds_write_b32 v107, v32
    s_mov_b32 s36, 0x5d800000
    v_cmp_nge_f32 vcc, s36, v28
    s_nop 0
    s_or_b64 s[52:53], s[52:53], vcc
    v_cmp_nge_f32 vcc, s36, v32
    s_nop 0
    s_or_b64 s[52:53], s[52:53], vcc
    s_or_b32 s36, s52, s53
    v_mov_b32 v110, s36
    s_lshl_b32 s37, s28, 2
    s_add_u32 s37, s37, 161792
    v_mov_b32 v111, s37
    ds_write_b32 v111, v110
    v_mov_b32 v112, 161856
    v_mov_b32 v114, s56
    v_mov_b32 v115, s57
    v_mov_b32 v116, s58
    v_mov_b32 v117, s59
    ds_write_b128 v112, v[114:117]
    v_and_b32 v111, 7, v1
    v_lshlrev_b32 v111, 2, v111
    v_add_u32 v111, 161792, v111
    s_sub_u32 s36, 15, s30
    s_lshl_b32 s38, s36, 3
    s_and_b32 s37, s28, 3
    s_lshl_b32 s37, s37, 1
    s_add_u32 s38, s38, s37
    s_lshl_b32 s38, s38, 17
    s_lshl_b32 s37, s29, 12
    s_add_u32 s38, s38, s37
    s_waitcnt vmcnt(4)
    v_readfirstlane_b32 s36, v11
    s_nop 0
    s_cmp_lt_u32 s36, 28
    s_cbranch_scc1 L_recurrent_scan__compressed_kv_cla__moe_arch_mod__prompt_kernel_rare_102
L_recurrent_scan__compressed_kv_cla__moe_arch_mod__prompt_kernel_back_103:
    s_lshr_b32 s36, s2, 4
    s_mul_i32 s36, s36, 7
    s_min_u32 s37, s28, 6
    s_add_u32 s36, s36, s37
    s_lshl_b32 s36, s36, 11
    s_add_u32 s36, s36, 58720256
    v_and_b32 v11, 15, v1
    v_lshlrev_b32 v11, 4, v11
    v_lshrrev_b32 v12, 4, v1
    v_lshl_add_u32 v11, v12, 9, v11
    buffer_load_dwordx4 v[96:99], v11, s[24:27], s36 offen offset:0 sc1
    buffer_load_dwordx4 v[100:103], v11, s[24:27], s36 offen offset:256 sc1
    s_waitcnt lgkmcnt(0)
    s_barrier
    ds_read_b32 v110, v111
    ds_read_b32 v109, v108
    ds_read_b128 v[64:67], v106 offset:0
    ds_read_b128 v[68:71], v106 offset:1024
    ds_read_b128 v[72:75], v106 offset:2048
    ds_read_b128 v[76:79], v106 offset:3072
    ds_read_b128 v[80:83], v106 offset:4096
    ds_read_b128 v[84:87], v106 offset:5120
    ds_read_b128 v[88:91], v106 offset:6144
    ds_read_b128 v[92:95], v106 offset:7168
    s_waitcnt lgkmcnt(8)
    v_add_f32 v109, v109, v28
    v_cmp_ne_u32 s[52:53], 0, v110
    v_rcp_f32 v109, v109
    s_nop 0
    v_mov_b32 v108, v109
    s_waitcnt lgkmcnt(6)
    v_pk_add_f32 v[192:193], v[192:193], v[64:65]
    v_pk_add_f32 v[194:195], v[194:195], v[66:67]
    v_pk_add_f32 v[196:197], v[196:197], v[68:69]
    v_pk_add_f32 v[198:199], v[198:199], v[70:71]
    v_pk_mul_f32 v[192:193], v[192:193], v[108:109]
    v_pk_mul_f32 v[194:195], v[194:195], v[108:109]
    v_pk_mul_f32 v[196:197], v[196:197], v[108:109]
    v_pk_mul_f32 v[198:199], v[198:199], v[108:109]
    v_cvt_pk_bf16_f32 v48, v192, v193
    v_cvt_pk_bf16_f32 v49, v194, v195
    v_cvt_pk_bf16_f32 v50, v196, v197
    v_cvt_pk_bf16_f32 v51, v198, v199
    buffer_store_dwordx4 v[48:51], v7, s[16:19], s38 offen offset:0 sc1
    s_waitcnt lgkmcnt(4)
    v_pk_add_f32 v[200:201], v[200:201], v[72:73]
    v_pk_add_f32 v[202:203], v[202:203], v[74:75]
    v_pk_add_f32 v[204:205], v[204:205], v[76:77]
    v_pk_add_f32 v[206:207], v[206:207], v[78:79]
    v_pk_mul_f32 v[200:201], v[200:201], v[108:109]
    v_pk_mul_f32 v[202:203], v[202:203], v[108:109]
    v_pk_mul_f32 v[204:205], v[204:205], v[108:109]
    v_pk_mul_f32 v[206:207], v[206:207], v[108:109]
    v_cvt_pk_bf16_f32 v52, v200, v201
    v_cvt_pk_bf16_f32 v53, v202, v203
    v_cvt_pk_bf16_f32 v54, v204, v205
    v_cvt_pk_bf16_f32 v55, v206, v207
    buffer_store_dwordx4 v[52:55], v7, s[16:19], s38 offen offset:1024 sc1
    s_waitcnt lgkmcnt(2)
    v_pk_add_f32 v[208:209], v[208:209], v[80:81]
    v_pk_add_f32 v[210:211], v[210:211], v[82:83]
    v_pk_add_f32 v[212:213], v[212:213], v[84:85]
    v_pk_add_f32 v[214:215], v[214:215], v[86:87]
    v_pk_mul_f32 v[208:209], v[208:209], v[108:109]
    v_pk_mul_f32 v[210:211], v[210:211], v[108:109]
    v_pk_mul_f32 v[212:213], v[212:213], v[108:109]
    v_pk_mul_f32 v[214:215], v[214:215], v[108:109]
    v_cvt_pk_bf16_f32 v56, v208, v209
    v_cvt_pk_bf16_f32 v57, v210, v211
    v_cvt_pk_bf16_f32 v58, v212, v213
    v_cvt_pk_bf16_f32 v59, v214, v215
    buffer_store_dwordx4 v[56:59], v7, s[16:19], s38 offen offset:2048 sc1
    s_waitcnt lgkmcnt(0)
    v_pk_add_f32 v[216:217], v[216:217], v[88:89]
    v_pk_add_f32 v[218:219], v[218:219], v[90:91]
    v_pk_add_f32 v[220:221], v[220:221], v[92:93]
    v_pk_add_f32 v[222:223], v[222:223], v[94:95]
    v_pk_mul_f32 v[216:217], v[216:217], v[108:109]
    v_pk_mul_f32 v[218:219], v[218:219], v[108:109]
    v_pk_mul_f32 v[220:221], v[220:221], v[108:109]
    v_pk_mul_f32 v[222:223], v[222:223], v[108:109]
    v_cvt_pk_bf16_f32 v60, v216, v217
    v_cvt_pk_bf16_f32 v61, v218, v219
    v_cvt_pk_bf16_f32 v62, v220, v221
    v_cvt_pk_bf16_f32 v63, v222, v223
    buffer_store_dwordx4 v[60:63], v7, s[16:19], s38 offen offset:3072 sc1
    s_cmp_eq_u64 s[52:53], 0
    s_cbranch_scc1 L_p3_done
    s_waitcnt vmcnt(0)
    v_mov_b32 v112, v96
    v_mov_b32 v113, v97
    v_mov_b32 v114, v98
    v_mov_b32 v115, v99
    v_mov_b32 v116, v100
    v_mov_b32 v117, v101
    v_mov_b32 v118, v102
    v_mov_b32 v119, v103
    v_mov_b32 v192, 0
    v_mov_b32 v193, 0
    v_mov_b32 v194, 0
    v_mov_b32 v195, 0
    v_mov_b32 v196, 0
    v_mov_b32 v197, 0
    v_mov_b32 v198, 0
    v_mov_b32 v199, 0
    v_mov_b32 v200, 0
    v_mov_b32 v201, 0
    v_mov_b32 v202, 0
    v_mov_b32 v203, 0
    v_mov_b32 v204, 0
    v_mov_b32 v205, 0
    v_mov_b32 v206, 0
    v_mov_b32 v207, 0
    v_mov_b32 v208, 0
    v_mov_b32 v209, 0
    v_mov_b32 v210, 0
    v_mov_b32 v211, 0
    v_mov_b32 v212, 0
    v_mov_b32 v213, 0
    v_mov_b32 v214, 0
    v_mov_b32 v215, 0
    v_mov_b32 v216, 0
    v_mov_b32 v217, 0
    v_mov_b32 v218, 0
    v_mov_b32 v219, 0
    v_mov_b32 v220, 0
    v_mov_b32 v221, 0
    v_mov_b32 v222, 0
    v_mov_b32 v223, 0
    v_mov_b32 v224, 0
    v_mov_b32 v225, 0
    v_mov_b32 v226, 0
    v_mov_b32 v227, 0
    v_mov_b32 v228, 0
    v_mov_b32 v229, 0
    v_mov_b32 v230, 0
    v_mov_b32 v231, 0
    v_mov_b32 v232, 0
    v_mov_b32 v233, 0
    v_mov_b32 v234, 0
    v_mov_b32 v235, 0
    v_mov_b32 v236, 0
    v_mov_b32 v237, 0
    v_mov_b32 v238, 0
    v_mov_b32 v239, 0
    v_mov_b32 v240, 0
    v_mov_b32 v241, 0
    v_mov_b32 v242, 0
    v_mov_b32 v243, 0
    v_mov_b32 v244, 0
    v_mov_b32 v245, 0
    v_mov_b32 v246, 0
    v_mov_b32 v247, 0
    v_mov_b32 v248, 0
    v_mov_b32 v249, 0
    v_mov_b32 v250, 0
    v_mov_b32 v251, 0
    v_mov_b32 v252, 0
    v_mov_b32 v253, 0
    v_mov_b32 v254, 0
    v_mov_b32 v255, 0
    v_mov_b32 v28, 0
    v_mov_b32 v40, 4048155338
    v_mov_b32 v32, 0
    v_mov_b32 v41, 4048155338
    s_lshl_b32 s43, s28, 12
    v_add_u32 v4, s43, v7
    s_mov_b32 s46, s45
    s_sub_u32 s40, 16, s30
    s_sub_u32 s39, 15, s30
    s_lshl_b32 s37, s39, 7
    s_and_b32 s36, s28, 3
    s_lshl_b32 s36, s36, 5
    s_add_u32 s36, s36, s37
    s_sub_u32 s50, 0, s36
L_recurrent_scan__compressed_kv_cla__moe_arch_mod__prompt_kernel_stile_104:
    s_waitcnt vmcnt(0) lgkmcnt(0)
    s_barrier
    s_mov_b32 m0, s43
    s_add_u32 s47, s46, 32768
    buffer_load_dwordx4 v4, s[12:15], s46 offen offset:0 sc1 lds
    buffer_load_dwordx4 v4, s[12:15], s46 offen offset:1024 sc1 lds
    buffer_load_dwordx4 v4, s[12:15], s46 offen offset:2048 sc1 lds
    buffer_load_dwordx4 v4, s[12:15], s46 offen offset:3072 sc1 lds
    s_add_u32 m0, s43, 32768
    s_add_u32 s46, s46, 65536
    buffer_load_dwordx4 v4, s[12:15], s47 offen offset:0 sc1 lds
    buffer_load_dwordx4 v4, s[12:15], s47 offen offset:1024 sc1 lds
    buffer_load_dwordx4 v4, s[12:15], s47 offen offset:2048 sc1 lds
    buffer_load_dwordx4 v4, s[12:15], s47 offen offset:3072 sc1 lds
    v_mov_b32 v2, v7
    s_mov_b32 s41, 4
    s_waitcnt vmcnt(0)
    s_barrier
L_recurrent_scan__compressed_kv_cla__moe_arch_mod__prompt_kernel_sunit_105:
    s_cmp_gt_i32 s50, 0
    s_cbranch_scc1 L_recurrent_scan__compressed_kv_cla__moe_arch_mod__prompt_kernel_snext_106
    ds_read_b128 v[64:67], v2 offset:0
    ds_read_b128 v[68:71], v2 offset:1024
    ds_read_b128 v[72:75], v2 offset:2048
    ds_read_b128 v[76:79], v2 offset:3072
    ds_read_b128 v[80:83], v2 offset:4096
    ds_read_b128 v[84:87], v2 offset:5120
    ds_read_b128 v[88:91], v2 offset:6144
    ds_read_b128 v[92:95], v2 offset:7168
    s_waitcnt lgkmcnt(0)
    v_mfma_f32_16x16x32_bf16 v[96:99], v[64:67], v[128:131], 0
    v_mfma_f32_16x16x32_bf16 v[104:107], v[64:67], v[144:147], 0
    v_mfma_f32_16x16x32_bf16 v[96:99], v[68:71], v[132:135], v[96:99]
    v_mfma_f32_16x16x32_bf16 v[104:107], v[68:71], v[148:151], v[104:107]
    v_mfma_f32_16x16x32_bf16 v[96:99], v[72:75], v[136:139], v[96:99]
    v_mfma_f32_16x16x32_bf16 v[104:107], v[72:75], v[152:155], v[104:107]
    v_mfma_f32_16x16x32_bf16 v[96:99], v[76:79], v[140:143], v[96:99]
    v_mfma_f32_16x16x32_bf16 v[104:107], v[76:79], v[156:159], v[104:107]
    v_mfma_f32_16x16x32_bf16 v[100:103], v[80:83], v[128:131], 0
    v_mfma_f32_16x16x32_bf16 v[108:111], v[80:83], v[144:147], 0
    v_mfma_f32_16x16x32_bf16 v[100:103], v[84:87], v[132:135], v[100:103]
    v_mfma_f32_16x16x32_bf16 v[108:111], v[84:87], v[148:151], v[108:111]
    v_mfma_f32_16x16x32_bf16 v[100:103], v[88:91], v[136:139], v[100:103]
    v_mfma_f32_16x16x32_bf16 v[108:111], v[88:91], v[152:155], v[108:111]
    v_mfma_f32_16x16x32_bf16 v[100:103], v[92:95], v[140:143], v[100:103]
    v_mfma_f32_16x16x32_bf16 v[108:111], v[92:95], v[156:159], v[108:111]
    ds_read_b128 v[64:67], v2 offset:32768
    ds_read_b128 v[68:71], v2 offset:33792
    ds_read_b128 v[72:75], v2 offset:34816
    ds_read_b128 v[76:79], v2 offset:35840
    ds_read_b128 v[80:83], v2 offset:36864
    ds_read_b128 v[84:87], v2 offset:37888
    ds_read_b128 v[88:91], v2 offset:38912
    ds_read_b128 v[92:95], v2 offset:39936
    s_nop 1
    s_cmp_lt_i32 s50, 0
    s_cbranch_scc0 L_recurrent_scan__compressed_kv_cla__moe_arch_mod__prompt_kernel_rare_107
L_recurrent_scan__compressed_kv_cla__moe_arch_mod__prompt_kernel_back_108:
    v_max3_f32 v22, v96, v97, v98
    v_max3_f32 v22, v22, v99, v100
    v_max3_f32 v22, v22, v101, v102
    v_max3_f32 v22, v22, v103, v40
    v_mov_b32 v24, v22
    s_nop 1
    v_permlane16_swap_b32 v22, v24
    s_nop 1
    v_max_f32 v22, v22, v24
    v_mov_b32 v24, v22
    s_nop 1
    v_permlane32_swap_b32 v22, v24
    s_nop 1
    v_max_f32 v22, v22, v24
    v_sub_f32 v25, v40, v22
    v_exp_f32 v25, v25
    v_mov_b32 v40, v22
    v_mul_f32 v28, v28, v25
    v_mul_f32 v192, v192, v25
    v_mul_f32 v193, v193, v25
    v_mul_f32 v194, v194, v25
    v_mul_f32 v195, v195, v25
    v_mul_f32 v196, v196, v25
    v_mul_f32 v197, v197, v25
    v_mul_f32 v198, v198, v25
    v_mul_f32 v199, v199, v25
    v_mul_f32 v200, v200, v25
    v_mul_f32 v201, v201, v25
    v_mul_f32 v202, v202, v25
    v_mul_f32 v203, v203, v25
    v_mul_f32 v204, v204, v25
    v_mul_f32 v205, v205, v25
    v_mul_f32 v206, v206, v25
    v_mul_f32 v207, v207, v25
    v_mul_f32 v208, v208, v25
    v_mul_f32 v209, v209, v25
    v_mul_f32 v210, v210, v25
    v_mul_f32 v211, v211, v25
    v_mul_f32 v212, v212, v25
    v_mul_f32 v213, v213, v25
    v_mul_f32 v214, v214, v25
    v_mul_f32 v215, v215, v25
    v_mul_f32 v216, v216, v25
    v_mul_f32 v217, v217, v25
    v_mul_f32 v218, v218, v25
    v_mul_f32 v219, v219, v25
    v_mul_f32 v220, v220, v25
    v_mul_f32 v221, v221, v25
    v_mul_f32 v222, v222, v25
    v_mul_f32 v223, v223, v25
    v_sub_f32 v96, v96, v22
    v_sub_f32 v97, v97, v22
    v_sub_f32 v98, v98, v22
    v_sub_f32 v99, v99, v22
    v_sub_f32 v100, v100, v22
    v_sub_f32 v101, v101, v22
    v_sub_f32 v102, v102, v22
    v_sub_f32 v103, v103, v22
    v_max3_f32 v23, v104, v105, v106
    v_max3_f32 v23, v23, v107, v108
    v_max3_f32 v23, v23, v109, v110
    v_max3_f32 v23, v23, v111, v41
    v_mov_b32 v24, v23
    s_nop 1
    v_permlane16_swap_b32 v23, v24
    s_nop 1
    v_max_f32 v23, v23, v24
    v_mov_b32 v24, v23
    s_nop 1
    v_permlane32_swap_b32 v23, v24
    s_nop 1
    v_max_f32 v23, v23, v24
    v_sub_f32 v25, v41, v23
    v_exp_f32 v25, v25
    v_mov_b32 v41, v23
    v_mul_f32 v32, v32, v25
    v_mul_f32 v224, v224, v25
    v_mul_f32 v225, v225, v25
    v_mul_f32 v226, v226, v25
    v_mul_f32 v227, v227, v25
    v_mul_f32 v228, v228, v25
    v_mul_f32 v229, v229, v25
    v_mul_f32 v230, v230, v25
    v_mul_f32 v231, v231, v25
    v_mul_f32 v232, v232, v25
    v_mul_f32 v233, v233, v25
    v_mul_f32 v234, v234, v25
    v_mul_f32 v235, v235, v25
    v_mul_f32 v236, v236, v25
    v_mul_f32 v237, v237, v25
    v_mul_f32 v238, v238, v25
    v_mul_f32 v239, v239, v25
    v_mul_f32 v240, v240, v25
    v_mul_f32 v241, v241, v25
    v_mul_f32 v242, v242, v25
    v_mul_f32 v243, v243, v25
    v_mul_f32 v244, v244, v25
    v_mul_f32 v245, v245, v25
    v_mul_f32 v246, v246, v25
    v_mul_f32 v247, v247, v25
    v_mul_f32 v248, v248, v25
    v_mul_f32 v249, v249, v25
    v_mul_f32 v250, v250, v25
    v_mul_f32 v251, v251, v25
    v_mul_f32 v252, v252, v25
    v_mul_f32 v253, v253, v25
    v_mul_f32 v254, v254, v25
    v_mul_f32 v255, v255, v25
    v_sub_f32 v104, v104, v23
    v_sub_f32 v105, v105, v23
    v_sub_f32 v106, v106, v23
    v_sub_f32 v107, v107, v23
    v_sub_f32 v108, v108, v23
    v_sub_f32 v109, v109, v23
    v_sub_f32 v110, v110, v23
    v_sub_f32 v111, v111, v23
    v_exp_f32 v96, v96
    v_exp_f32 v97, v97
    v_exp_f32 v98, v98
    v_exp_f32 v99, v99
    v_exp_f32 v104, v104
    v_exp_f32 v105, v105
    v_exp_f32 v106, v106
    v_exp_f32 v107, v107
    v_exp_f32 v100, v100
    v_exp_f32 v101, v101
    v_exp_f32 v102, v102
    v_exp_f32 v103, v103
    v_exp_f32 v108, v108
    v_exp_f32 v109, v109
    v_exp_f32 v110, v110
    v_exp_f32 v111, v111
    v_add_f32 v28, v28, v96
    v_add_f32 v28, v28, v97
    v_cvt_pk_bf16_f32 v48, v96, v97
    v_add_f32 v28, v28, v98
    v_add_f32 v28, v28, v99
    v_cvt_pk_bf16_f32 v49, v98, v99
    v_add_f32 v32, v32, v104
    v_add_f32 v32, v32, v105
    v_cvt_pk_bf16_f32 v52, v104, v105
    v_add_f32 v32, v32, v106
    v_add_f32 v32, v32, v107
    v_cvt_pk_bf16_f32 v53, v106, v107
    v_add_f32 v28, v28, v100
    v_add_f32 v28, v28, v101
    v_cvt_pk_bf16_f32 v50, v100, v101
    v_add_f32 v28, v28, v102
    v_add_f32 v28, v28, v103
    v_cvt_pk_bf16_f32 v51, v102, v103
    v_add_f32 v32, v32, v108
    v_add_f32 v32, v32, v109
    v_cvt_pk_bf16_f32 v54, v108, v109
    v_add_f32 v32, v32, v110
    v_add_f32 v32, v32, v111
    v_cvt_pk_bf16_f32 v55, v110, v111
    s_waitcnt lgkmcnt(0)
    s_nop 0
    v_mfma_f32_16x16x32_bf16 v[192:195], v[64:67], v[48:51], v[192:195]
    v_mfma_f32_16x16x32_bf16 v[224:227], v[64:67], v[52:55], v[224:227]
    v_mfma_f32_16x16x32_bf16 v[196:199], v[68:71], v[48:51], v[196:199]
    v_mfma_f32_16x16x32_bf16 v[228:231], v[68:71], v[52:55], v[228:231]
    v_mfma_f32_16x16x32_bf16 v[200:203], v[72:75], v[48:51], v[200:203]
    v_mfma_f32_16x16x32_bf16 v[232:235], v[72:75], v[52:55], v[232:235]
    v_mfma_f32_16x16x32_bf16 v[204:207], v[76:79], v[48:51], v[204:207]
    v_mfma_f32_16x16x32_bf16 v[236:239], v[76:79], v[52:55], v[236:239]
    v_mfma_f32_16x16x32_bf16 v[208:211], v[80:83], v[48:51], v[208:211]
    v_mfma_f32_16x16x32_bf16 v[240:243], v[80:83], v[52:55], v[240:243]
    v_mfma_f32_16x16x32_bf16 v[212:215], v[84:87], v[48:51], v[212:215]
    v_mfma_f32_16x16x32_bf16 v[244:247], v[84:87], v[52:55], v[244:247]
    v_mfma_f32_16x16x32_bf16 v[216:219], v[88:91], v[48:51], v[216:219]
    v_mfma_f32_16x16x32_bf16 v[248:251], v[88:91], v[52:55], v[248:251]
    v_mfma_f32_16x16x32_bf16 v[220:223], v[92:95], v[48:51], v[220:223]
    v_mfma_f32_16x16x32_bf16 v[252:255], v[92:95], v[52:55], v[252:255]
L_recurrent_scan__compressed_kv_cla__moe_arch_mod__prompt_kernel_snext_106:
    v_add_u32 v2, 8192, v2
    s_add_u32 s50, s50, 32
    s_sub_u32 s41, s41, 1
    s_cmp_lg_u32 s41, 0
    s_cbranch_scc1 L_recurrent_scan__compressed_kv_cla__moe_arch_mod__prompt_kernel_sunit_105
    s_sub_u32 s40, s40, 1
    s_cmp_lg_u32 s40, 0
    s_cbranch_scc1 L_recurrent_scan__compressed_kv_cla__moe_arch_mod__prompt_kernel_stile_104
    v_mov_b32 v20, v28
    s_nop 1
    v_permlane16_swap_b32 v28, v20
    s_nop 1
    v_add_f32 v28, v28, v20
    v_mov_b32 v20, v28
    s_nop 1
    v_permlane32_swap_b32 v28, v20
    s_nop 1
    v_add_f32 v28, v28, v20
    v_mov_b32 v20, v32
    s_nop 1
    v_permlane16_swap_b32 v32, v20
    s_nop 1
    v_add_f32 v32, v32, v20
    v_mov_b32 v20, v32
    s_nop 1
    v_permlane32_swap_b32 v32, v20
    s_nop 1
    v_add_f32 v32, v32, v20
    s_mov_b32 s36, 0x5d800000
    v_cmp_nge_f32 vcc, s36, v28
    s_nop 0
    s_or_b64 s[52:53], s[52:53], vcc
    v_cmp_nge_f32 vcc, s36, v32
    s_nop 0
    s_or_b64 s[52:53], s[52:53], vcc
    v_rcp_f32 v20, v28
    v_rcp_f32 v22, v32
    s_lshl_b32 s38, s39, 3
    s_and_b32 s37, s28, 3
    s_lshl_b32 s37, s37, 1
    s_add_u32 s38, s38, s37
    s_lshl_b32 s38, s38, 17
    s_lshl_b32 s37, s29, 12
    s_add_u32 s38, s38, s37
    v_mov_b32 v21, v20
    v_mov_b32 v23, v22
    v_pk_mul_f32 v[192:193], v[192:193], v[20:21]
    v_pk_mul_f32 v[194:195], v[194:195], v[20:21]
    v_pk_mul_f32 v[196:197], v[196:197], v[20:21]
    v_pk_mul_f32 v[198:199], v[198:199], v[20:21]
    v_cvt_pk_bf16_f32 v192, v192, v193
    v_cvt_pk_bf16_f32 v193, v194, v195
    v_cvt_pk_bf16_f32 v194, v196, v197
    v_cvt_pk_bf16_f32 v195, v198, v199
    buffer_store_dwordx4 v[192:195], v7, s[16:19], s38 offen offset:0 sc1
    v_pk_mul_f32 v[200:201], v[200:201], v[20:21]
    v_pk_mul_f32 v[202:203], v[202:203], v[20:21]
    v_pk_mul_f32 v[204:205], v[204:205], v[20:21]
    v_pk_mul_f32 v[206:207], v[206:207], v[20:21]
    v_cvt_pk_bf16_f32 v200, v200, v201
    v_cvt_pk_bf16_f32 v201, v202, v203
    v_cvt_pk_bf16_f32 v202, v204, v205
    v_cvt_pk_bf16_f32 v203, v206, v207
    buffer_store_dwordx4 v[200:203], v7, s[16:19], s38 offen offset:1024 sc1
    v_pk_mul_f32 v[208:209], v[208:209], v[20:21]
    v_pk_mul_f32 v[210:211], v[210:211], v[20:21]
    v_pk_mul_f32 v[212:213], v[212:213], v[20:21]
    v_pk_mul_f32 v[214:215], v[214:215], v[20:21]
    v_cvt_pk_bf16_f32 v208, v208, v209
    v_cvt_pk_bf16_f32 v209, v210, v211
    v_cvt_pk_bf16_f32 v210, v212, v213
    v_cvt_pk_bf16_f32 v211, v214, v215
    buffer_store_dwordx4 v[208:211], v7, s[16:19], s38 offen offset:2048 sc1
    v_pk_mul_f32 v[216:217], v[216:217], v[20:21]
    v_pk_mul_f32 v[218:219], v[218:219], v[20:21]
    v_pk_mul_f32 v[220:221], v[220:221], v[20:21]
    v_pk_mul_f32 v[222:223], v[222:223], v[20:21]
    v_cvt_pk_bf16_f32 v216, v216, v217
    v_cvt_pk_bf16_f32 v217, v218, v219
    v_cvt_pk_bf16_f32 v218, v220, v221
    v_cvt_pk_bf16_f32 v219, v222, v223
    buffer_store_dwordx4 v[216:219], v7, s[16:19], s38 offen offset:3072 sc1
    s_add_u32 s38, s38, 131072
    v_pk_mul_f32 v[224:225], v[224:225], v[22:23]
    v_pk_mul_f32 v[226:227], v[226:227], v[22:23]
    v_pk_mul_f32 v[228:229], v[228:229], v[22:23]
    v_pk_mul_f32 v[230:231], v[230:231], v[22:23]
    v_cvt_pk_bf16_f32 v224, v224, v225
    v_cvt_pk_bf16_f32 v225, v226, v227
    v_cvt_pk_bf16_f32 v226, v228, v229
    v_cvt_pk_bf16_f32 v227, v230, v231
    buffer_store_dwordx4 v[224:227], v7, s[16:19], s38 offen offset:0 sc1
    v_pk_mul_f32 v[232:233], v[232:233], v[22:23]
    v_pk_mul_f32 v[234:235], v[234:235], v[22:23]
    v_pk_mul_f32 v[236:237], v[236:237], v[22:23]
    v_pk_mul_f32 v[238:239], v[238:239], v[22:23]
    v_cvt_pk_bf16_f32 v232, v232, v233
    v_cvt_pk_bf16_f32 v233, v234, v235
    v_cvt_pk_bf16_f32 v234, v236, v237
    v_cvt_pk_bf16_f32 v235, v238, v239
    buffer_store_dwordx4 v[232:235], v7, s[16:19], s38 offen offset:1024 sc1
    v_pk_mul_f32 v[240:241], v[240:241], v[22:23]
    v_pk_mul_f32 v[242:243], v[242:243], v[22:23]
    v_pk_mul_f32 v[244:245], v[244:245], v[22:23]
    v_pk_mul_f32 v[246:247], v[246:247], v[22:23]
    v_cvt_pk_bf16_f32 v240, v240, v241
    v_cvt_pk_bf16_f32 v241, v242, v243
    v_cvt_pk_bf16_f32 v242, v244, v245
    v_cvt_pk_bf16_f32 v243, v246, v247
    buffer_store_dwordx4 v[240:243], v7, s[16:19], s38 offen offset:2048 sc1
    v_pk_mul_f32 v[248:249], v[248:249], v[22:23]
    v_pk_mul_f32 v[250:251], v[250:251], v[22:23]
    v_pk_mul_f32 v[252:253], v[252:253], v[22:23]
    v_pk_mul_f32 v[254:255], v[254:255], v[22:23]
    v_cvt_pk_bf16_f32 v248, v248, v249
    v_cvt_pk_bf16_f32 v249, v250, v251
    v_cvt_pk_bf16_f32 v250, v252, v253
    v_cvt_pk_bf16_f32 v251, v254, v255
    buffer_store_dwordx4 v[248:251], v7, s[16:19], s38 offen offset:3072 sc1
    v_mov_b32 v96, v112
    v_mov_b32 v97, v113
    v_mov_b32 v98, v114
    v_mov_b32 v99, v115
    v_mov_b32 v100, v116
    v_mov_b32 v101, v117
    v_mov_b32 v102, v118
    v_mov_b32 v103, v119
    s_branch L_p3_done
L_recurrent_scan__compressed_kv_cla__moe_arch_mod__prompt_kernel_rare_1:
    s_mul_i32 s36, s28, 12288
    s_add_u32 s36, s36, 61865984
    v_lshl_add_u32 v16, v1, 4, s36
    v_mov_b32 v108, 0
    v_mov_b32 v109, 0
    v_mov_b32 v110, 0
    v_mov_b32 v111, 0
    global_store_dwordx4 v16, v[108:111], s[90:91] sc1
    v_add_u32 v16, 1024, v16
    global_store_dwordx4 v16, v[108:111], s[90:91] sc1
    v_add_u32 v16, 1024, v16
    global_store_dwordx4 v16, v[108:111], s[90:91] sc1
    v_add_u32 v16, 1024, v16
    global_store_dwordx4 v16, v[108:111], s[90:91] sc1
    v_add_u32 v16, 1024, v16
    global_store_dwordx4 v16, v[108:111], s[90:91] sc1
    v_add_u32 v16, 1024, v16
    global_store_dwordx4 v16, v[108:111], s[90:91] sc1
    v_add_u32 v16, 1024, v16
    global_store_dwordx4 v16, v[108:111], s[90:91] sc1
    v_add_u32 v16, 1024, v16
    global_store_dwordx4 v16, v[108:111], s[90:91] sc1
    v_add_u32 v16, 1024, v16
    global_store_dwordx4 v16, v[108:111], s[90:91] sc1
    v_add_u32 v16, 1024, v16
    global_store_dwordx4 v16, v[108:111], s[90:91] sc1
    v_add_u32 v16, 1024, v16
    global_store_dwordx4 v16, v[108:111], s[90:91] sc1
    v_add_u32 v16, 1024, v16
    global_store_dwordx4 v16, v[108:111], s[90:91] sc1
    v_add_u32 v16, 1024, v16
    s_branch L_recurrent_scan__compressed_kv_cla__moe_arch_mod__prompt_kernel_back_2
L_recurrent_scan__compressed_kv_cla__moe_arch_mod__prompt_kernel_rare_3:
    v_mov_b32 v19, 1
    s_mov_b64 exec, 1
    global_store_dword v118, v19, s[88:89] sc1
    s_mov_b64 exec, -1
    s_branch L_recurrent_scan__compressed_kv_cla__moe_arch_mod__prompt_kernel_back_4
L_recurrent_scan__compressed_kv_cla__moe_arch_mod__prompt_kernel_rare_5:
    v_lshrrev_b32 v3, 4, v1
    s_lshl_b32 s37, s28, 4
    v_add_u32 v19, s37, v3
    v_lshlrev_b32 v19, 13, v19
    s_lshl_b32 s37, s29, 8
    v_add_u32 v19, s37, v19
    v_and_b32 v16, 15, v1
    v_lshlrev_b32 v3, 1, v3
    v_xor_b32 v16, v16, v3
    v_lshl_add_u32 v2, v16, 4, v19
    v_add_u32 v3, 31744, v2
    v_xor_b32 v16, 8, v16
    v_lshl_add_u32 v4, v16, 4, v19
    v_add_u32 v4, 63488, v4
    v_add_u32 v5, 31744, v4
    s_mov_b32 s4, s96
    s_and_b32 s5, s97, 0xffff
    s_mov_b32 s6, 8388608
    s_mov_b32 s7, 0x20000
    s_mov_b32 s31, 0
    s_mov_b32 s40, 1048576
    s_mov_b64 s[8:9], s[4:5]
    s_mov_b32 s10, s6
    s_mov_b32 s32, 2097152
    v_mov_b32 v6, v2
    v_mov_b32 v7, v3
    v_mov_b32 v8, v4
    v_mov_b32 v9, v5
    s_branch L_recurrent_scan__compressed_kv_cla__moe_arch_mod__prompt_kernel_back_6
L_recurrent_scan__compressed_kv_cla__moe_arch_mod__prompt_kernel_w0_7:
    s_cmp_eq_u32 s35, 0
    s_cbranch_scc0 L_recurrent_scan__compressed_kv_cla__moe_arch_mod__prompt_kernel_swn_10
    v_and_b32 v16, 7, v1
    v_lshrrev_b32 v18, 3, v1
    v_mul_u32_u24 v19, 2064, v16
    v_lshl_add_u32 v19, v18, 4, v19
    s_lshl_b32 s36, s28, 8
    s_add_u32 s36, s36, 131072
    v_add_u32 v19, s36, v19
    ds_read_b128 v[120:123], v19
    ds_read_b128 v[124:127], v19 offset:128
    v_lshlrev_b32 v16, 4, v16
    v_lshl_add_u32 v16, v18, 8, v16
    s_lshr_b32 s36, s2, 1
    s_lshl_b32 s36, s36, 15
    s_and_b32 s37, s2, 1
    s_lshl_b32 s37, s37, 7
    s_add_u32 s36, s36, s37
    s_lshl_b32 s37, s28, 12
    s_add_u32 s36, s36, s37
    s_waitcnt lgkmcnt(0)
    buffer_store_dwordx4 v[120:123], v16, s[24:27], s36 offen sc1
    buffer_store_dwordx4 v[124:127], v16, s[24:27], s36 offen offset:2048 sc1
    s_waitcnt vmcnt(2)
    s_branch L_recurrent_scan__compressed_kv_cla__moe_arch_mod__prompt_kernel_swend_9
L_recurrent_scan__compressed_kv_cla__moe_arch_mod__prompt_kernel_swn_10:
    s_waitcnt vmcnt(2)
L_recurrent_scan__compressed_kv_cla__moe_arch_mod__prompt_kernel_swend_9:
    s_branch L_recurrent_scan__compressed_kv_cla__moe_arch_mod__prompt_kernel_w0b_8
L_recurrent_scan__compressed_kv_cla__moe_arch_mod__prompt_kernel_rare_13:
    s_cmp_eq_u32 s35, 0
    s_cbranch_scc0 L_recurrent_scan__compressed_kv_cla__moe_arch_mod__prompt_kernel_swn_12
    global_load_dword v116, v118, s[88:89] sc1
    s_branch L_recurrent_scan__compressed_kv_cla__moe_arch_mod__prompt_kernel_swend_11
L_recurrent_scan__compressed_kv_cla__moe_arch_mod__prompt_kernel_swn_12:
    v_and_b32 v117, 15, v1
    v_add_u32 v117, 112, v117
    v_lshlrev_b32 v117, 7, v117
    global_load_dword v116, v117, s[90:91] sc1
L_recurrent_scan__compressed_kv_cla__moe_arch_mod__prompt_kernel_swend_11:
    s_branch L_recurrent_scan__compressed_kv_cla__moe_arch_mod__prompt_kernel_back_14
L_recurrent_scan__compressed_kv_cla__moe_arch_mod__prompt_kernel_rare_19:
    s_mov_b32 s61, 0x40000
L_recurrent_scan__compressed_kv_cla__moe_arch_mod__prompt_kernel_spin_17:
    s_sub_u32 s61, s61, 1
    s_cbranch_scc1 L_recurrent_scan__compressed_kv_cla__moe_arch_mod__prompt_kernel_spinx_18
    s_sleep 8
    global_load_dword v116, v118, s[88:89] sc1
    s_waitcnt vmcnt(0)
    v_readfirstlane_b32 s36, v116
    s_nop 0
    s_cmp_lt_u32 s36, 1
    s_cbranch_scc1 L_recurrent_scan__compressed_kv_cla__moe_arch_mod__prompt_kernel_spin_17
L_recurrent_scan__compressed_kv_cla__moe_arch_mod__prompt_kernel_spinx_18:
    s_branch L_recurrent_scan__compressed_kv_cla__moe_arch_mod__prompt_kernel_back_20
L_recurrent_scan__compressed_kv_cla__moe_arch_mod__prompt_kernel_w0_15:
    s_waitcnt vmcnt(0)
    s_cmp_eq_u32 s35, 0
    s_cbranch_scc0 L_recurrent_scan__compressed_kv_cla__moe_arch_mod__prompt_kernel_swn_24
    v_readfirstlane_b32 s36, v116
    s_nop 0
    s_cmp_lt_u32 s36, 1
    s_cbranch_scc1 L_recurrent_scan__compressed_kv_cla__moe_arch_mod__prompt_kernel_rare_19
L_recurrent_scan__compressed_kv_cla__moe_arch_mod__prompt_kernel_back_20:
    s_branch L_recurrent_scan__compressed_kv_cla__moe_arch_mod__prompt_kernel_swend_23
L_recurrent_scan__compressed_kv_cla__moe_arch_mod__prompt_kernel_swn_24:
    s_mov_b32 s61, 0x40000
L_recurrent_scan__compressed_kv_cla__moe_arch_mod__prompt_kernel_lspin_21:
    v_cmp_gt_u32 vcc, 16, v116
    s_nop 0
    s_cmp_eq_u64 vcc, 0
    s_cbranch_scc1 L_recurrent_scan__compressed_kv_cla__moe_arch_mod__prompt_kernel_lspinx_22
    s_sub_u32 s61, s61, 1
    s_cbranch_scc1 L_recurrent_scan__compressed_kv_cla__moe_arch_mod__prompt_kernel_lspinx_22
    s_sleep 8
    global_load_dword v116, v117, s[90:91] sc1
    s_waitcnt vmcnt(0)
    s_branch L_recurrent_scan__compressed_kv_cla__moe_arch_mod__prompt_kernel_lspin_21
L_recurrent_scan__compressed_kv_cla__moe_arch_mod__prompt_kernel_lspinx_22:
L_recurrent_scan__compressed_kv_cla__moe_arch_mod__prompt_kernel_swend_23:
    s_branch L_recurrent_scan__compressed_kv_cla__moe_arch_mod__prompt_kernel_w0b_16
L_recurrent_scan__compressed_kv_cla__moe_arch_mod__prompt_kernel_rare_25:
    s_lshr_b32 s36, s2, 4
    s_add_u32 s36, s36, 112
    s_lshl_b32 s36, s36, 7
    v_mov_b32 v16, s36
    v_mov_b32 v19, 1
    s_mov_b64 exec, 1
    global_atomic_add v16, v19, s[90:91]
    s_mov_b64 exec, -1
    s_nop 3
    s_branch L_recurrent_scan__compressed_kv_cla__moe_arch_mod__prompt_kernel_back_26
L_recurrent_scan__compressed_kv_cla__moe_arch_mod__prompt_kernel_w0_27:
    s_cmp_eq_u32 s35, 0
    s_cbranch_scc0 L_recurrent_scan__compressed_kv_cla__moe_arch_mod__prompt_kernel_swn_30
    s_waitcnt vmcnt(2)
    s_branch L_recurrent_scan__compressed_kv_cla__moe_arch_mod__prompt_kernel_swend_29
L_recurrent_scan__compressed_kv_cla__moe_arch_mod__prompt_kernel_swn_30:
    s_waitcnt vmcnt(2)
L_recurrent_scan__compressed_kv_cla__moe_arch_mod__prompt_kernel_swend_29:
    s_branch L_recurrent_scan__compressed_kv_cla__moe_arch_mod__prompt_kernel_w0b_28
L_recurrent_scan__compressed_kv_cla__moe_arch_mod__prompt_kernel_rare_32:
    v_and_b32 v16, 7, v1
    v_lshrrev_b32 v18, 3, v1
    v_mul_u32_u24 v19, 2064, v16
    v_lshl_add_u32 v19, v18, 4, v19
    s_lshl_b32 s36, s28, 8
    s_add_u32 s36, s36, 131072
    v_add_u32 v19, s36, v19
    ds_read_b128 v[120:123], v19
    ds_read_b128 v[124:127], v19 offset:128
    v_lshlrev_b32 v16, 4, v16
    v_lshl_add_u32 v16, v18, 8, v16
    s_lshr_b32 s36, s2, 1
    s_lshl_b32 s36, s36, 15
    s_and_b32 s37, s2, 1
    s_lshl_b32 s37, s37, 7
    s_add_u32 s36, s36, s37
    s_lshl_b32 s37, s28, 12
    s_add_u32 s36, s36, s37
    s_waitcnt lgkmcnt(0)
    buffer_store_dwordx4 v[120:123], v16, s[24:27], s36 offen sc1
    buffer_store_dwordx4 v[124:127], v16, s[24:27], s36 offen offset:2048 sc1
    s_cmp_eq_u32 s28, 7
    s_cbranch_scc0 L_recurrent_scan__compressed_kv_cla__moe_arch_mod__prompt_kernel_l7_31
    v_and_b32 v120, 7, v1
    v_lshlrev_b32 v120, 3, v120
    v_add_u32 v121, 147712, v120
    ds_read_b64 v[122:123], v121
    ds_read_b32 v124, v121 offset:64
    s_lshl_b32 s36, s2, 6
    s_add_u32 s36, s36, 4194304
    s_lshl_b32 s37, s2, 3
    s_add_u32 s37, s37, 4276224
    s_waitcnt lgkmcnt(0)
    v_mov_b32 v126, v124
    s_nop 1
    v_max_u32_dpp v126, v126, v126 quad_perm:[1,0,3,2] row_mask:0xf bank_mask:0xf
    s_nop 1
    v_max_u32_dpp v126, v126, v126 quad_perm:[2,3,0,1] row_mask:0xf bank_mask:0xf
    s_nop 1
    v_max_u32_dpp v126, v126, v126 row_half_mirror row_mask:0xf bank_mask:0xf
    v_cmp_eq_u32 vcc, v126, v124
    s_nop 1
    v_cndmask_b32 v127, v124, v118, vcc
    s_nop 1
    v_max_u32_dpp v127, v127, v127 quad_perm:[1,0,3,2] row_mask:0xf bank_mask:0xf
    s_nop 1
    v_max_u32_dpp v127, v127, v127 quad_perm:[2,3,0,1] row_mask:0xf bank_mask:0xf
    s_nop 1
    v_max_u32_dpp v127, v127, v127 row_half_mirror row_mask:0xf bank_mask:0xf
    s_mov_b64 exec, 0xff
    buffer_store_dwordx2 v[122:123], v120, s[24:27], s36 offen sc1
    s_mov_b64 exec, 1
    buffer_store_dwordx2 v[126:127], v120, s[24:27], s37 offen sc1
    s_mov_b64 exec, -1
    s_nop 3
L_recurrent_scan__compressed_kv_cla__moe_arch_mod__prompt_kernel_l7_31:
    s_branch L_recurrent_scan__compressed_kv_cla__moe_arch_mod__prompt_kernel_back_33
L_recurrent_scan__compressed_kv_cla__moe_arch_mod__prompt_kernel_rare_36:
    v_lshrrev_b32 v3, 4, v1
    s_lshl_b32 s37, s28, 4
    v_add_u32 v19, s37, v3
    v_lshlrev_b32 v19, 13, v19
    s_lshl_b32 s37, s29, 8
    v_add_u32 v19, s37, v19
    v_and_b32 v16, 15, v1
    v_lshlrev_b32 v3, 1, v3
    v_xor_b32 v16, v16, v3
    v_lshl_add_u32 v2, v16, 4, v19
    v_add_u32 v3, 31744, v2
    v_xor_b32 v16, 8, v16
    v_lshl_add_u32 v4, v16, 4, v19
    v_add_u32 v4, 63488, v4
    v_add_u32 v5, 31744, v4
    s_mov_b32 s4, s96
    s_and_b32 s5, s97, 0xffff
    s_mov_b32 s6, 8388608
    s_mov_b32 s7, 0x20000
    s_mov_b32 s31, 0
    s_mov_b32 s40, 1048576
    s_mov_b64 s[8:9], s[4:5]
    s_mov_b32 s10, s6
    s_mov_b32 s32, 2097152
    v_mov_b32 v6, v2
    v_mov_b32 v7, v3
    v_mov_b32 v8, v4
    v_mov_b32 v9, v5
    s_branch L_recurrent_scan__compressed_kv_cla__moe_arch_mod__prompt_kernel_back_37
L_recurrent_scan__compressed_kv_cla__moe_arch_mod__prompt_kernel_rare_42:
    s_mov_b32 s61, 0x40000
L_recurrent_scan__compressed_kv_cla__moe_arch_mod__prompt_kernel_spin_40:
    s_sub_u32 s61, s61, 1
    s_cbranch_scc1 L_recurrent_scan__compressed_kv_cla__moe_arch_mod__prompt_kernel_spinx_41
    s_sleep 8
    global_load_dword v56, v57, s[90:91] sc1
    s_waitcnt vmcnt(0)
    v_readfirstlane_b32 s36, v56
    s_nop 0
    s_cmp_lt_u32 s36, 1
    s_cbranch_scc1 L_recurrent_scan__compressed_kv_cla__moe_arch_mod__prompt_kernel_spin_40
L_recurrent_scan__compressed_kv_cla__moe_arch_mod__prompt_kernel_spinx_41:
    s_branch L_recurrent_scan__compressed_kv_cla__moe_arch_mod__prompt_kernel_back_43
L_recurrent_scan__compressed_kv_cla__moe_arch_mod__prompt_kernel_rare_48:
    s_cmp_lt_u32 s28, 4
    s_cbranch_scc0 L_recurrent_scan__compressed_kv_cla__moe_arch_mod__prompt_kernel_ng_45
    s_cmp_eq_u32 s35, 2
    s_cbranch_scc0 L_recurrent_scan__compressed_kv_cla__moe_arch_mod__prompt_kernel_swn_47
    s_mov_b32 s6, 0
    s_mov_b32 s34, 0x30000
    s_branch L_recurrent_scan__compressed_kv_cla__moe_arch_mod__prompt_kernel_swend_46
L_recurrent_scan__compressed_kv_cla__moe_arch_mod__prompt_kernel_swn_47:
    s_mov_b64 s[4:5], s[12:13]
    s_mov_b32 s6, s14
    s_mov_b32 s31, s45
    s_mov_b32 s40, 32768
    s_mov_b32 s34, s33
    v_add_u32 v2, s33, v58
    v_mov_b32 v3, v2
    v_mov_b32 v4, v2
    v_mov_b32 v5, v2
    s_cmp_eq_u32 s28, 0
    s_cbranch_scc0 L_recurrent_scan__compressed_kv_cla__moe_arch_mod__prompt_kernel_g_44
    s_waitcnt vmcnt(10)
    v_readfirstlane_b32 s36, v56
    s_nop 0
    s_cmp_lt_u32 s36, 1
    s_cbranch_scc1 L_recurrent_scan__compressed_kv_cla__moe_arch_mod__prompt_kernel_rare_42
L_recurrent_scan__compressed_kv_cla__moe_arch_mod__prompt_kernel_back_43:
L_recurrent_scan__compressed_kv_cla__moe_arch_mod__prompt_kernel_g_44:
L_recurrent_scan__compressed_kv_cla__moe_arch_mod__prompt_kernel_swend_46:
L_recurrent_scan__compressed_kv_cla__moe_arch_mod__prompt_kernel_ng_45:
    s_branch L_recurrent_scan__compressed_kv_cla__moe_arch_mod__prompt_kernel_back_49
L_recurrent_scan__compressed_kv_cla__moe_arch_mod__prompt_kernel_rare_54:
    s_cmp_eq_u32 s35, 3
    s_cbranch_scc0 L_recurrent_scan__compressed_kv_cla__moe_arch_mod__prompt_kernel_nv0_50
    s_cmp_eq_u32 s28, 0
    s_cbranch_scc0 L_recurrent_scan__compressed_kv_cla__moe_arch_mod__prompt_kernel_g_39
    s_add_u32 s36, s29, 64
    s_lshl_b32 s36, s36, 7
    v_mov_b32 v57, s36
    global_load_dword v56, v57, s[90:91] sc1
L_recurrent_scan__compressed_kv_cla__moe_arch_mod__prompt_kernel_g_39:
L_recurrent_scan__compressed_kv_cla__moe_arch_mod__prompt_kernel_nv0_50:
    s_cmp_ge_u32 s28, 4
    s_cbranch_scc0 L_recurrent_scan__compressed_kv_cla__moe_arch_mod__prompt_kernel_ng_51
    s_cmp_eq_u32 s35, 2
    s_cbranch_scc0 L_recurrent_scan__compressed_kv_cla__moe_arch_mod__prompt_kernel_swn_53
    s_mov_b32 s6, 0
    s_mov_b32 s34, 0x30000
    s_branch L_recurrent_scan__compressed_kv_cla__moe_arch_mod__prompt_kernel_swend_52
L_recurrent_scan__compressed_kv_cla__moe_arch_mod__prompt_kernel_swn_53:
    s_mov_b64 s[4:5], s[12:13]
    s_mov_b32 s6, s14
    s_mov_b32 s31, s45
    s_mov_b32 s40, 32768
    s_mov_b32 s34, s33
    v_add_u32 v2, s33, v58
    v_mov_b32 v3, v2
    v_mov_b32 v4, v2
    v_mov_b32 v5, v2
L_recurrent_scan__compressed_kv_cla__moe_arch_mod__prompt_kernel_swend_52:
L_recurrent_scan__compressed_kv_cla__moe_arch_mod__prompt_kernel_ng_51:
    s_branch L_recurrent_scan__compressed_kv_cla__moe_arch_mod__prompt_kernel_back_55
L_recurrent_scan__compressed_kv_cla__moe_arch_mod__prompt_kernel_rare_60:
    s_cmp_eq_u32 s35, 3
    s_cbranch_scc0 L_recurrent_scan__compressed_kv_cla__moe_arch_mod__prompt_kernel_nv0_56
    s_add_u32 s34, s33, 32768
L_recurrent_scan__compressed_kv_cla__moe_arch_mod__prompt_kernel_nv0_56:
    s_cmp_ge_u32 s28, 4
    s_cbranch_scc0 L_recurrent_scan__compressed_kv_cla__moe_arch_mod__prompt_kernel_ng_57
    s_cmp_eq_u32 s35, 2
    s_cbranch_scc0 L_recurrent_scan__compressed_kv_cla__moe_arch_mod__prompt_kernel_swn_59
    s_add_u32 s36, s28, s30
    s_cmp_eq_u32 s36, 4
    s_cbranch_scc0 L_recurrent_scan__compressed_kv_cla__moe_arch_mod__prompt_kernel_g_38
    s_add_u32 s36, s29, 64
    s_lshl_b32 s36, s36, 7
    v_mov_b32 v62, s36
    v_mov_b32 v63, 1
    s_mov_b64 exec, 1
    global_atomic_add v62, v63, s[90:91]
    s_mov_b64 exec, -1
    s_nop 3
L_recurrent_scan__compressed_kv_cla__moe_arch_mod__prompt_kernel_g_38:
    s_branch L_recurrent_scan__compressed_kv_cla__moe_arch_mod__prompt_kernel_swend_58
L_recurrent_scan__compressed_kv_cla__moe_arch_mod__prompt_kernel_swn_59:
L_recurrent_scan__compressed_kv_cla__moe_arch_mod__prompt_kernel_swend_58:
L_recurrent_scan__compressed_kv_cla__moe_arch_mod__prompt_kernel_ng_57:
    s_branch L_recurrent_scan__compressed_kv_cla__moe_arch_mod__prompt_kernel_back_61
L_recurrent_scan__compressed_kv_cla__moe_arch_mod__prompt_kernel_rare_62:
    s_waitcnt vmcnt(18)
    s_branch L_recurrent_scan__compressed_kv_cla__moe_arch_mod__prompt_kernel_back_63
L_recurrent_scan__compressed_kv_cla__moe_arch_mod__prompt_kernel_rare_64:
    s_lshl_b32 s36, s39, 1
    s_add_u32 s36, s36, s38
    s_add_u32 s37, s36, s39
    buffer_store_dwordx4 v[160:163], v58, s[16:19], s36 offen sc1
    buffer_store_dwordx4 v[164:167], v59, s[16:19], s36 offen sc1
    buffer_store_dwordx4 v[168:171], v60, s[16:19], s36 offen sc1
    buffer_store_dwordx4 v[172:175], v61, s[16:19], s36 offen sc1
    buffer_store_dwordx4 v[176:179], v58, s[16:19], s37 offen sc1
    buffer_store_dwordx4 v[180:183], v59, s[16:19], s37 offen sc1
    buffer_store_dwordx4 v[184:187], v60, s[16:19], s37 offen sc1
    buffer_store_dwordx4 v[188:191], v61, s[16:19], s37 offen sc1
    s_branch L_recurrent_scan__compressed_kv_cla__moe_arch_mod__prompt_kernel_back_65
L_recurrent_scan__compressed_kv_cla__moe_arch_mod__prompt_kernel_rare_66:
    s_lshl_b32 s36, s29, 7
    v_mov_b32 v13, s36
    global_load_dword v14, v13, s[90:91] sc1
    s_branch L_recurrent_scan__compressed_kv_cla__moe_arch_mod__prompt_kernel_back_67
L_recurrent_scan__compressed_kv_cla__moe_arch_mod__prompt_kernel_rare_72:
    s_mov_b32 s41, 32768
    s_cmp_eq_u32 s40, 15
    s_cbranch_scc0 L_recurrent_scan__compressed_kv_cla__moe_arch_mod__prompt_kernel_r_68
    s_mov_b32 s41, 65536
    s_mov_b32 s49, 0x1ffff
    s_sub_u32 s36, 0, s50
    s_cmp_lt_i32 s36, 0
    s_cbranch_scc1 L_recurrent_scan__compressed_kv_cla__moe_arch_mod__prompt_kernel_nm_71
    v_mov_b32 v20, 4048155338
    v_subrev_u32 v21, s36, v18
    v_cmp_gt_i32 s[20:21], 0, v21
    v_cmp_gt_i32 s[22:23], 1, v21
    v_cmp_gt_i32 s[62:63], 2, v21
    v_cmp_gt_i32 vcc, 3, v21
    v_cndmask_b32 v96, v96, v20, s[20:21]
    v_cndmask_b32 v97, v97, v20, s[22:23]
    v_cndmask_b32 v98, v98, v20, s[62:63]
    v_cndmask_b32 v99, v99, v20, vcc
    v_cmp_gt_i32 s[20:21], 16, v21
    v_cmp_gt_i32 s[22:23], 17, v21
    v_cmp_gt_i32 s[62:63], 18, v21
    v_cmp_gt_i32 vcc, 19, v21
    v_cndmask_b32 v100, v100, v20, s[20:21]
    v_cndmask_b32 v101, v101, v20, s[22:23]
    v_cndmask_b32 v102, v102, v20, s[62:63]
    v_cndmask_b32 v103, v103, v20, vcc
    v_cmp_gt_i32 s[20:21], -16, v21
    v_cmp_gt_i32 s[22:23], -15, v21
    v_cmp_gt_i32 s[62:63], -14, v21
    v_cmp_gt_i32 vcc, -13, v21
    v_cndmask_b32 v104, v104, v20, s[20:21]
    v_cndmask_b32 v105, v105, v20, s[22:23]
    v_cndmask_b32 v106, v106, v20, s[62:63]
    v_cndmask_b32 v107, v107, v20, vcc
    v_cmp_gt_i32 s[20:21], 0, v21
    v_cmp_gt_i32 s[22:23], 1, v21
    v_cmp_gt_i32 s[62:63], 2, v21
    v_cmp_gt_i32 vcc, 3, v21
    v_cndmask_b32 v108, v108, v20, s[20:21]
    v_cndmask_b32 v109, v109, v20, s[22:23]
    v_cndmask_b32 v110, v110, v20, s[62:63]
    v_cndmask_b32 v111, v111, v20, vcc
L_recurrent_scan__compressed_kv_cla__moe_arch_mod__prompt_kernel_nm_71:
L_recurrent_scan__compressed_kv_cla__moe_arch_mod__prompt_kernel_r_68:
    s_branch L_recurrent_scan__compressed_kv_cla__moe_arch_mod__prompt_kernel_back_73
L_recurrent_scan__compressed_kv_cla__moe_arch_mod__prompt_kernel_rare_82:
    s_mov_b32 s61, 0x40000
L_recurrent_scan__compressed_kv_cla__moe_arch_mod__prompt_kernel_spin_80:
    s_sub_u32 s61, s61, 1
    s_cbranch_scc1 L_recurrent_scan__compressed_kv_cla__moe_arch_mod__prompt_kernel_spinx_81
    s_sleep 8
    global_load_dword v14, v13, s[90:91] sc1
    s_waitcnt vmcnt(0)
    v_readfirstlane_b32 s36, v14
    s_nop 0
    s_cmp_lt_u32 s36, 7
    s_cbranch_scc1 L_recurrent_scan__compressed_kv_cla__moe_arch_mod__prompt_kernel_spin_80
L_recurrent_scan__compressed_kv_cla__moe_arch_mod__prompt_kernel_spinx_81:
    s_branch L_recurrent_scan__compressed_kv_cla__moe_arch_mod__prompt_kernel_back_83
L_recurrent_scan__compressed_kv_cla__moe_arch_mod__prompt_kernel_rare_88:
    s_cmp_eq_u32 s40, 1
    s_cbranch_scc0 L_recurrent_scan__compressed_kv_cla__moe_arch_mod__prompt_kernel_swn_85
    v_readfirstlane_b32 s36, v14
    s_nop 0
    s_cmp_lt_u32 s36, 7
    s_cbranch_scc1 L_recurrent_scan__compressed_kv_cla__moe_arch_mod__prompt_kernel_rare_82
L_recurrent_scan__compressed_kv_cla__moe_arch_mod__prompt_kernel_back_83:
    s_branch L_recurrent_scan__compressed_kv_cla__moe_arch_mod__prompt_kernel_swend_84
L_recurrent_scan__compressed_kv_cla__moe_arch_mod__prompt_kernel_swn_85:
    s_cmp_eq_u32 s40, 2
    s_cbranch_scc0 L_recurrent_scan__compressed_kv_cla__moe_arch_mod__prompt_kernel_swn_86
    s_mov_b32 s36, 4276224
    buffer_load_dwordx4 v[160:163], v7, s[24:27], s36 offen offset:0 sc1
    buffer_load_dwordx4 v[164:167], v7, s[24:27], s36 offen offset:1024 sc1
    s_branch L_recurrent_scan__compressed_kv_cla__moe_arch_mod__prompt_kernel_swend_84
L_recurrent_scan__compressed_kv_cla__moe_arch_mod__prompt_kernel_swn_86:
    s_cmp_eq_u32 s40, 3
    s_cbranch_scc0 L_recurrent_scan__compressed_kv_cla__moe_arch_mod__prompt_kernel_swn_87
    v_max_u32 v24, v160, v161
    v_min_u32 v25, v160, v161
    v_med3_u32 v25, v24, v25, v162
    v_max_u32 v24, v24, v162
    v_med3_u32 v25, v24, v25, v163
    v_max_u32 v24, v24, v163
    v_med3_u32 v25, v24, v25, v164
    v_max_u32 v24, v24, v164
    v_med3_u32 v25, v24, v25, v165
    v_max_u32 v24, v24, v165
    v_med3_u32 v25, v24, v25, v166
    v_max_u32 v24, v24, v166
    v_med3_u32 v25, v24, v25, v167
    v_max_u32 v24, v24, v167
    v_mov_b32 v26, v24
    s_nop 1
    v_max_u32_dpp v26, v26, v26 quad_perm:[1,0,3,2] row_mask:0xf bank_mask:0xf
    s_nop 1
    v_max_u32_dpp v26, v26, v26 quad_perm:[2,3,0,1] row_mask:0xf bank_mask:0xf
    s_nop 1
    v_max_u32_dpp v26, v26, v26 row_half_mirror row_mask:0xf bank_mask:0xf
    s_nop 1
    v_max_u32_dpp v26, v26, v26 row_mirror row_mask:0xf bank_mask:0xf
    s_nop 0
    v_readlane_b32 s20, v26, 0
    v_readlane_b32 s21, v26, 16
    v_readlane_b32 s22, v26, 32
    v_readlane_b32 s23, v26, 48
    s_max_u32 s20, s20, s21
    s_max_u32 s22, s22, s23
    s_max_u32 s20, s20, s22
    s_mov_b32 s58, s20
    v_cmp_eq_u32 vcc, s58, v24
    s_nop 1
    v_cndmask_b32 v26, v24, v25, vcc
    s_nop 1
    v_max_u32_dpp v26, v26, v26 quad_perm:[1,0,3,2] row_mask:0xf bank_mask:0xf
    s_nop 1
    v_max_u32_dpp v26, v26, v26 quad_perm:[2,3,0,1] row_mask:0xf bank_mask:0xf
    s_nop 1
    v_max_u32_dpp v26, v26, v26 row_half_mirror row_mask:0xf bank_mask:0xf
    s_nop 1
    v_max_u32_dpp v26, v26, v26 row_mirror row_mask:0xf bank_mask:0xf
    s_nop 0
    v_readlane_b32 s20, v26, 0
    v_readlane_b32 s21, v26, 16
    v_readlane_b32 s22, v26, 32
    v_readlane_b32 s23, v26, 48
    s_max_u32 s20, s20, s21
    s_max_u32 s22, s22, s23
    s_max_u32 s20, s20, s22
    s_mov_b32 s59, s20
    s_and_b32 s36, s58, 0xffff
    s_sub_u32 s56, 0xffff, s36
    s_and_b32 s36, s59, 0xffff
    s_sub_u32 s57, 0xffff, s36
    v_and_b32 v24, 1, v1
    v_mov_b32 v25, s56
    v_mov_b32 v26, s57
    v_cmp_eq_u32 vcc, 1, v24
    s_nop 1
    v_cndmask_b32 v25, v25, v26, vcc
    v_lshrrev_b32 v26, 4, v25
    v_lshlrev_b32 v26, 15, v26
    v_and_b32 v25, 15, v25
    v_lshl_add_u32 v26, v25, 4, v26
    v_lshrrev_b32 v27, 4, v1
    v_lshl_add_u32 v26, v27, 8, v26
    s_and_b32 s36, s3, 3
    s_lshl_b32 s36, s36, 13
    s_add_u32 s37, s36, 4096
    s_mov_b32 exec_lo, 0x00030003
    s_mov_b32 exec_hi, 0x00030003
    buffer_load_dwordx4 v[160:163], v26, s[24:27], s36 offen offset:0 sc1
    buffer_load_dwordx4 v[164:167], v26, s[24:27], s36 offen offset:1024 sc1
    buffer_load_dwordx4 v[168:171], v26, s[24:27], s36 offen offset:2048 sc1
    buffer_load_dwordx4 v[172:175], v26, s[24:27], s36 offen offset:3072 sc1
    buffer_load_dwordx4 v[176:179], v26, s[24:27], s37 offen offset:0 sc1
    buffer_load_dwordx4 v[180:183], v26, s[24:27], s37 offen offset:1024 sc1
    buffer_load_dwordx4 v[184:187], v26, s[24:27], s37 offen offset:2048 sc1
    buffer_load_dwordx4 v[188:191], v26, s[24:27], s37 offen offset:3072 sc1
    s_mov_b64 exec, -1
    s_branch L_recurrent_scan__compressed_kv_cla__moe_arch_mod__prompt_kernel_swend_84
L_recurrent_scan__compressed_kv_cla__moe_arch_mod__prompt_kernel_swn_87:
    s_sub_u32 s38, s40, s60
    s_cmp_eq_u32 s38, 0
    s_cbranch_scc0 L_recurrent_scan__compressed_kv_cla__moe_arch_mod__prompt_kernel_swn_76
    s_and_b32 s20, s3, 3
    s_lshl_b32 s20, s20, 8
    s_lshl_b32 s21, s28, 5
    s_add_u32 s20, s20, s21
    s_lshr_b32 s21, s3, 2
    s_lshl_b32 s21, s21, 7
    v_lshrrev_b32 v25, 3, v1
    s_lshl_b32 s36, s28, 5
    s_add_u32 s36, s36, s20
    v_add_u32 v25, s36, v25
    v_mul_u32_u24 v25, 7168, v25
    v_add_u32 v25, s21, v25
    v_bfe_u32 v26, v1, 4, 1
    v_lshlrev_b32 v26, 1, v26
    v_and_b32 v27, 7, v1
    v_xor_b32 v26, v26, v27
    v_lshl_add_u32 v24, v26, 4, v25
    v_xor_b32 v26, 4, v26
    v_lshl_add_u32 v25, v26, 4, v25
    v_add_u32 v25, 56320, v25
    v_add_u32 v26, 112640, v24
    v_add_u32 v27, 112640, v25
    s_lshl_b32 s36, s28, 13
    s_add_u32 m0, s36, 131072
    s_mov_b32 s37, 229376
    buffer_load_dwordx4 v24, s[4:7], 0 offen offset:0 nt lds
    buffer_load_dwordx4 v25, s[4:7], 0 offen offset:1024 nt lds
    buffer_load_dwordx4 v26, s[4:7], 0 offen offset:2048 nt lds
    buffer_load_dwordx4 v27, s[4:7], 0 offen offset:3072 nt lds
    s_add_u32 m0, s36, 135168
    s_nop 0
    buffer_load_dwordx4 v24, s[4:7], s37 offen offset:0 nt lds
    buffer_load_dwordx4 v25, s[4:7], s37 offen offset:1024 nt lds
    buffer_load_dwordx4 v26, s[4:7], s37 offen offset:2048 nt lds
    buffer_load_dwordx4 v27, s[4:7], s37 offen offset:3072 nt lds
    s_branch L_recurrent_scan__compressed_kv_cla__moe_arch_mod__prompt_kernel_swend_75
L_recurrent_scan__compressed_kv_cla__moe_arch_mod__prompt_kernel_swn_76:
    s_cmp_eq_u32 s38, 2
    s_cbranch_scc0 L_recurrent_scan__compressed_kv_cla__moe_arch_mod__prompt_kernel_swn_77
    v_lshrrev_b32 v8, 4, v1
    v_bfe_u32 v5, v1, 2, 2
    v_lshl_add_u32 v5, v8, 3, v5
    v_lshlrev_b32 v5, 7, v5
    v_and_b32 v9, 3, v1
    v_lshl_add_u32 v5, v9, 3, v5
    v_bfe_u32 v9, v1, 3, 2
    v_xor_b32 v9, s28, v9
    v_lshl_add_u32 v5, v9, 5, v5
    v_add_u32 v5, 131072, v5
    ds_read_b64_tr_b16 v[14:15], v5 offset:0
    ds_read_b64_tr_b16 v[16:17], v5 offset:512
    ds_read_b64_tr_b16 v[20:21], v5 offset:4096
    ds_read_b64_tr_b16 v[22:23], v5 offset:4608
    ds_read_b64_tr_b16 v[24:25], v5 offset:8192
    ds_read_b64_tr_b16 v[26:27], v5 offset:8704
    s_and_b32 s36, s3, 3
    s_lshl_b32 s36, s36, 6
    s_lshr_b32 s37, s3, 2
    s_lshl_b32 s37, s37, 12
    s_add_u32 s36, s36, s37
    s_lshl_b32 s37, s28, 10
    s_add_u32 s36, s36, s37
    s_add_u32 s36, s36, 58720256
    v_and_b32 v9, 1, v1
    v_lshlrev_b32 v9, 4, v9
    v_lshl_add_u32 v9, v8, 8, v9
    s_waitcnt lgkmcnt(4)
    v_mfma_f32_16x16x32_bf16 v[10:13], v[14:17], v[160:163], 0
    ds_read_b64_tr_b16 v[14:15], v5 offset:12288
    ds_read_b64_tr_b16 v[16:17], v5 offset:12800
    s_waitcnt lgkmcnt(4)
    v_mfma_f32_16x16x32_bf16 v[10:13], v[20:23], v[164:167], v[10:13]
    ds_read_b64_tr_b16 v[20:21], v5 offset:16384
    ds_read_b64_tr_b16 v[22:23], v5 offset:16896
    s_waitcnt lgkmcnt(4)
    v_mfma_f32_16x16x32_bf16 v[10:13], v[24:27], v[168:171], v[10:13]
    ds_read_b64_tr_b16 v[24:25], v5 offset:20480
    ds_read_b64_tr_b16 v[26:27], v5 offset:20992
    s_waitcnt lgkmcnt(4)
    v_mfma_f32_16x16x32_bf16 v[10:13], v[14:17], v[172:175], v[10:13]
    ds_read_b64_tr_b16 v[14:15], v5 offset:24576
    ds_read_b64_tr_b16 v[16:17], v5 offset:25088
    s_waitcnt lgkmcnt(4)
    v_mfma_f32_16x16x32_bf16 v[10:13], v[20:23], v[176:179], v[10:13]
    ds_read_b64_tr_b16 v[20:21], v5 offset:28672
    ds_read_b64_tr_b16 v[22:23], v5 offset:29184
    s_waitcnt lgkmcnt(4)
    v_mfma_f32_16x16x32_bf16 v[10:13], v[24:27], v[180:183], v[10:13]
    s_waitcnt lgkmcnt(2)
    v_mfma_f32_16x16x32_bf16 v[10:13], v[14:17], v[184:187], v[10:13]
    s_waitcnt lgkmcnt(0)
    v_mfma_f32_16x16x32_bf16 v[10:13], v[20:23], v[188:191], v[10:13]
    s_nop 5
    s_mov_b32 exec_lo, 0x00030003
    s_mov_b32 exec_hi, 0x00030003
    buffer_store_dwordx4 v[10:13], v9, s[24:27], s36 offen sc1
    s_mov_b64 exec, -1
    s_nop 1
    s_branch L_recurrent_scan__compressed_kv_cla__moe_arch_mod__prompt_kernel_swend_75
L_recurrent_scan__compressed_kv_cla__moe_arch_mod__prompt_kernel_swn_77:
    s_cmp_eq_u32 s38, 3
    s_cbranch_scc0 L_recurrent_scan__compressed_kv_cla__moe_arch_mod__prompt_kernel_swn_78
    s_and_b32 s20, s3, 3
    s_lshl_b32 s20, s20, 8
    s_lshl_b32 s21, s28, 5
    s_add_u32 s20, s20, s21
    s_lshr_b32 s21, s3, 2
    s_lshl_b32 s21, s21, 7
    v_lshrrev_b32 v25, 3, v1
    s_lshl_b32 s36, s28, 5
    s_add_u32 s36, s36, s20
    v_add_u32 v25, s36, v25
    v_mul_u32_u24 v25, 7168, v25
    v_add_u32 v25, s21, v25
    v_bfe_u32 v26, v1, 4, 1
    v_lshlrev_b32 v26, 1, v26
    v_and_b32 v27, 7, v1
    v_xor_b32 v26, v26, v27
    v_lshl_add_u32 v24, v26, 4, v25
    v_xor_b32 v26, 4, v26
    v_lshl_add_u32 v25, v26, 4, v25
    v_add_u32 v25, 56320, v25
    v_add_u32 v26, 112640, v24
    v_add_u32 v27, 112640, v25
    s_lshl_b32 s36, s28, 13
    s_add_u32 m0, s36, 131072
    s_mov_b32 s37, 229376
    buffer_load_dwordx4 v24, s[8:11], 0 offen offset:0 nt lds
    buffer_load_dwordx4 v25, s[8:11], 0 offen offset:1024 nt lds
    buffer_load_dwordx4 v26, s[8:11], 0 offen offset:2048 nt lds
    buffer_load_dwordx4 v27, s[8:11], 0 offen offset:3072 nt lds
    s_add_u32 m0, s36, 135168
    s_nop 0
    buffer_load_dwordx4 v24, s[8:11], s37 offen offset:0 nt lds
    buffer_load_dwordx4 v25, s[8:11], s37 offen offset:1024 nt lds
    buffer_load_dwordx4 v26, s[8:11], s37 offen offset:2048 nt lds
    buffer_load_dwordx4 v27, s[8:11], s37 offen offset:3072 nt lds
    s_branch L_recurrent_scan__compressed_kv_cla__moe_arch_mod__prompt_kernel_swend_75
L_recurrent_scan__compressed_kv_cla__moe_arch_mod__prompt_kernel_swn_78:
    s_cmp_eq_u32 s38, 5
    s_cbranch_scc0 L_recurrent_scan__compressed_kv_cla__moe_arch_mod__prompt_kernel_swn_79
    v_lshrrev_b32 v8, 4, v1
    v_bfe_u32 v5, v1, 2, 2
    v_lshl_add_u32 v5, v8, 3, v5
    v_lshlrev_b32 v5, 7, v5
    v_and_b32 v9, 3, v1
    v_lshl_add_u32 v5, v9, 3, v5
    v_bfe_u32 v9, v1, 3, 2
    v_xor_b32 v9, s28, v9
    v_lshl_add_u32 v5, v9, 5, v5
    v_add_u32 v5, 131072, v5
    ds_read_b64_tr_b16 v[14:15], v5 offset:0
    ds_read_b64_tr_b16 v[16:17], v5 offset:512
    ds_read_b64_tr_b16 v[20:21], v5 offset:4096
    ds_read_b64_tr_b16 v[22:23], v5 offset:4608
    ds_read_b64_tr_b16 v[24:25], v5 offset:8192
    ds_read_b64_tr_b16 v[26:27], v5 offset:8704
    s_and_b32 s36, s3, 3
    s_lshl_b32 s36, s36, 6
    s_lshr_b32 s37, s3, 2
    s_lshl_b32 s37, s37, 12
    s_add_u32 s36, s36, s37
    s_lshl_b32 s37, s28, 10
    s_add_u32 s36, s36, s37
    s_add_u32 s36, s36, 58720288
    v_and_b32 v9, 1, v1
    v_lshlrev_b32 v9, 4, v9
    v_lshl_add_u32 v9, v8, 8, v9
    s_waitcnt lgkmcnt(4)
    v_mfma_f32_16x16x32_bf16 v[10:13], v[14:17], v[160:163], 0
    ds_read_b64_tr_b16 v[14:15], v5 offset:12288
    ds_read_b64_tr_b16 v[16:17], v5 offset:12800
    s_waitcnt lgkmcnt(4)
    v_mfma_f32_16x16x32_bf16 v[10:13], v[20:23], v[164:167], v[10:13]
    ds_read_b64_tr_b16 v[20:21], v5 offset:16384
    ds_read_b64_tr_b16 v[22:23], v5 offset:16896
    s_waitcnt lgkmcnt(4)
    v_mfma_f32_16x16x32_bf16 v[10:13], v[24:27], v[168:171], v[10:13]
    ds_read_b64_tr_b16 v[24:25], v5 offset:20480
    ds_read_b64_tr_b16 v[26:27], v5 offset:20992
    s_waitcnt lgkmcnt(4)
    v_mfma_f32_16x16x32_bf16 v[10:13], v[14:17], v[172:175], v[10:13]
    ds_read_b64_tr_b16 v[14:15], v5 offset:24576
    ds_read_b64_tr_b16 v[16:17], v5 offset:25088
    s_waitcnt lgkmcnt(4)
    v_mfma_f32_16x16x32_bf16 v[10:13], v[20:23], v[176:179], v[10:13]
    ds_read_b64_tr_b16 v[20:21], v5 offset:28672
    ds_read_b64_tr_b16 v[22:23], v5 offset:29184
    s_waitcnt lgkmcnt(4)
    v_mfma_f32_16x16x32_bf16 v[10:13], v[24:27], v[180:183], v[10:13]
    s_waitcnt lgkmcnt(2)
    v_mfma_f32_16x16x32_bf16 v[10:13], v[14:17], v[184:187], v[10:13]
    s_waitcnt lgkmcnt(0)
    v_mfma_f32_16x16x32_bf16 v[10:13], v[20:23], v[188:191], v[10:13]
    s_nop 5
    s_mov_b32 exec_lo, 0x00030003
    s_mov_b32 exec_hi, 0x00030003
    buffer_store_dwordx4 v[10:13], v9, s[24:27], s36 offen sc1
    s_mov_b64 exec, -1
    s_nop 1
    s_branch L_recurrent_scan__compressed_kv_cla__moe_arch_mod__prompt_kernel_swend_75
L_recurrent_scan__compressed_kv_cla__moe_arch_mod__prompt_kernel_swn_79:
    s_mul_i32 s36, s3, 2341
    s_lshr_b32 s36, s36, 16
    s_add_u32 s36, s36, 48
    s_lshl_b32 s36, s36, 7
    v_mov_b32 v20, s36
    v_mov_b32 v21, 1
    s_mov_b64 exec, 1
    global_atomic_add v20, v21, s[90:91]
    s_mov_b64 exec, -1
    s_nop 3
L_recurrent_scan__compressed_kv_cla__moe_arch_mod__prompt_kernel_swend_75:
L_recurrent_scan__compressed_kv_cla__moe_arch_mod__prompt_kernel_swend_84:
    s_branch L_recurrent_scan__compressed_kv_cla__moe_arch_mod__prompt_kernel_back_89
L_recurrent_scan__compressed_kv_cla__moe_arch_mod__prompt_kernel_rare_98:
    v_mov_b32 v20, 4048155338
    v_subrev_u32 v21, s36, v18
    v_cmp_gt_i32 s[20:21], 0, v21
    v_cmp_gt_i32 s[22:23], 1, v21
    v_cmp_gt_i32 s[62:63], 2, v21
    v_cmp_gt_i32 vcc, 3, v21
    v_cndmask_b32 v112, v112, v20, s[20:21]
    v_cndmask_b32 v113, v113, v20, s[22:23]
    v_cndmask_b32 v114, v114, v20, s[62:63]
    v_cndmask_b32 v115, v115, v20, vcc
    v_cmp_gt_i32 s[20:21], 16, v21
    v_cmp_gt_i32 s[22:23], 17, v21
    v_cmp_gt_i32 s[62:63], 18, v21
    v_cmp_gt_i32 vcc, 19, v21
    v_cndmask_b32 v116, v116, v20, s[20:21]
    v_cndmask_b32 v117, v117, v20, s[22:23]
    v_cndmask_b32 v118, v118, v20, s[62:63]
    v_cndmask_b32 v119, v119, v20, vcc
    v_cmp_gt_i32 s[20:21], -16, v21
    v_cmp_gt_i32 s[22:23], -15, v21
    v_cmp_gt_i32 s[62:63], -14, v21
    v_cmp_gt_i32 vcc, -13, v21
    v_cndmask_b32 v120, v120, v20, s[20:21]
    v_cndmask_b32 v121, v121, v20, s[22:23]
    v_cndmask_b32 v122, v122, v20, s[62:63]
    v_cndmask_b32 v123, v123, v20, vcc
    v_cmp_gt_i32 s[20:21], 0, v21
    v_cmp_gt_i32 s[22:23], 1, v21
    v_cmp_gt_i32 s[62:63], 2, v21
    v_cmp_gt_i32 vcc, 3, v21
    v_cndmask_b32 v124, v124, v20, s[20:21]
    v_cndmask_b32 v125, v125, v20, s[22:23]
    v_cndmask_b32 v126, v126, v20, s[62:63]
    v_cndmask_b32 v127, v127, v20, vcc
    s_branch L_recurrent_scan__compressed_kv_cla__moe_arch_mod__prompt_kernel_back_99
L_recurrent_scan__compressed_kv_cla__moe_arch_mod__prompt_kernel_rare_102:
    s_mov_b32 s61, 0x40000
L_recurrent_scan__compressed_kv_cla__moe_arch_mod__prompt_kernel_spin_100:
    s_sub_u32 s61, s61, 1
    s_cbranch_scc1 L_recurrent_scan__compressed_kv_cla__moe_arch_mod__prompt_kernel_spinx_101
    s_sleep 8
    global_load_dword v11, v12, s[90:91] sc1
    s_waitcnt vmcnt(0)
    v_readfirstlane_b32 s36, v11
    s_nop 0
    s_cmp_lt_u32 s36, 28
    s_cbranch_scc1 L_recurrent_scan__compressed_kv_cla__moe_arch_mod__prompt_kernel_spin_100
L_recurrent_scan__compressed_kv_cla__moe_arch_mod__prompt_kernel_spinx_101:
    s_branch L_recurrent_scan__compressed_kv_cla__moe_arch_mod__prompt_kernel_back_103
L_recurrent_scan__compressed_kv_cla__moe_arch_mod__prompt_kernel_rare_107:
    v_mov_b32 v20, 4048155338
    v_subrev_u32 v21, s50, v18
    v_cmp_gt_i32 s[20:21], 0, v21
    v_cmp_gt_i32 s[22:23], 1, v21
    v_cmp_gt_i32 s[62:63], 2, v21
    v_cmp_gt_i32 vcc, 3, v21
    v_cndmask_b32 v96, v96, v20, s[20:21]
    v_cndmask_b32 v97, v97, v20, s[22:23]
    v_cndmask_b32 v98, v98, v20, s[62:63]
    v_cndmask_b32 v99, v99, v20, vcc
    v_cmp_gt_i32 s[20:21], 16, v21
    v_cmp_gt_i32 s[22:23], 17, v21
    v_cmp_gt_i32 s[62:63], 18, v21
    v_cmp_gt_i32 vcc, 19, v21
    v_cndmask_b32 v100, v100, v20, s[20:21]
    v_cndmask_b32 v101, v101, v20, s[22:23]
    v_cndmask_b32 v102, v102, v20, s[62:63]
    v_cndmask_b32 v103, v103, v20, vcc
    v_cmp_gt_i32 s[20:21], -16, v21
    v_cmp_gt_i32 s[22:23], -15, v21
    v_cmp_gt_i32 s[62:63], -14, v21
    v_cmp_gt_i32 vcc, -13, v21
    v_cndmask_b32 v104, v104, v20, s[20:21]
    v_cndmask_b32 v105, v105, v20, s[22:23]
    v_cndmask_b32 v106, v106, v20, s[62:63]
    v_cndmask_b32 v107, v107, v20, vcc
    v_cmp_gt_i32 s[20:21], 0, v21
    v_cmp_gt_i32 s[22:23], 1, v21
    v_cmp_gt_i32 s[62:63], 2, v21
    v_cmp_gt_i32 vcc, 3, v21
    v_cndmask_b32 v108, v108, v20, s[20:21]
    v_cndmask_b32 v109, v109, v20, s[22:23]
    v_cndmask_b32 v110, v110, v20, s[62:63]
    v_cndmask_b32 v111, v111, v20, vcc
    s_branch L_recurrent_scan__compressed_kv_cla__moe_arch_mod__prompt_kernel_back_108
L_grp1:
    v_mov_b32 v20, 1040356334
    v_mov_b32 v21, v20
    s_and_b32 s37, s28, 3
    s_lshl_b32 s37, s37, 13
    v_lshlrev_b32 v7, 4, v1
    v_add_u32 v4, s37, v7
    v_add_u32 v6, 4096, v4
    v_add_u32 v19, 131072, v4
    s_add_u32 s43, s37, 32768
    s_add_u32 s44, s37, 98304
    s_waitcnt vmcnt(4) lgkmcnt(0)
    v_pk_mul_f32 v[192:193], v[192:193], v[20:21]
    v_pk_mul_f32 v[194:195], v[194:195], v[20:21]
    v_pk_mul_f32 v[196:197], v[196:197], v[20:21]
    v_pk_mul_f32 v[198:199], v[198:199], v[20:21]
    v_cvt_pk_bf16_f32 v128, v192, v193
    v_cvt_pk_bf16_f32 v129, v194, v195
    v_cvt_pk_bf16_f32 v130, v196, v197
    v_cvt_pk_bf16_f32 v131, v198, v199
    v_pk_mul_f32 v[200:201], v[200:201], v[20:21]
    v_pk_mul_f32 v[202:203], v[202:203], v[20:21]
    v_pk_mul_f32 v[204:205], v[204:205], v[20:21]
    v_pk_mul_f32 v[206:207], v[206:207], v[20:21]
    v_cvt_pk_bf16_f32 v132, v200, v201
    v_cvt_pk_bf16_f32 v133, v202, v203
    v_cvt_pk_bf16_f32 v134, v204, v205
    v_cvt_pk_bf16_f32 v135, v206, v207
    v_pk_mul_f32 v[208:209], v[208:209], v[20:21]
    v_pk_mul_f32 v[210:211], v[210:211], v[20:21]
    v_pk_mul_f32 v[212:213], v[212:213], v[20:21]
    v_pk_mul_f32 v[214:215], v[214:215], v[20:21]
    v_cvt_pk_bf16_f32 v136, v208, v209
    v_cvt_pk_bf16_f32 v137, v210, v211
    v_cvt_pk_bf16_f32 v138, v212, v213
    v_cvt_pk_bf16_f32 v139, v214, v215
    v_pk_mul_f32 v[216:217], v[216:217], v[20:21]
    v_pk_mul_f32 v[218:219], v[218:219], v[20:21]
    v_pk_mul_f32 v[220:221], v[220:221], v[20:21]
    v_pk_mul_f32 v[222:223], v[222:223], v[20:21]
    v_cvt_pk_bf16_f32 v140, v216, v217
    v_cvt_pk_bf16_f32 v141, v218, v219
    v_cvt_pk_bf16_f32 v142, v220, v221
    v_cvt_pk_bf16_f32 v143, v222, v223
    v_pk_mul_f32 v[224:225], v[224:225], v[20:21]
    v_pk_mul_f32 v[226:227], v[226:227], v[20:21]
    v_pk_mul_f32 v[228:229], v[228:229], v[20:21]
    v_pk_mul_f32 v[230:231], v[230:231], v[20:21]
    v_cvt_pk_bf16_f32 v144, v224, v225
    v_cvt_pk_bf16_f32 v145, v226, v227
    v_cvt_pk_bf16_f32 v146, v228, v229
    v_cvt_pk_bf16_f32 v147, v230, v231
    v_pk_mul_f32 v[232:233], v[232:233], v[20:21]
    v_pk_mul_f32 v[234:235], v[234:235], v[20:21]
    v_pk_mul_f32 v[236:237], v[236:237], v[20:21]
    v_pk_mul_f32 v[238:239], v[238:239], v[20:21]
    v_cvt_pk_bf16_f32 v148, v232, v233
    v_cvt_pk_bf16_f32 v149, v234, v235
    v_cvt_pk_bf16_f32 v150, v236, v237
    v_cvt_pk_bf16_f32 v151, v238, v239
    v_pk_mul_f32 v[240:241], v[240:241], v[20:21]
    v_pk_mul_f32 v[242:243], v[242:243], v[20:21]
    v_pk_mul_f32 v[244:245], v[244:245], v[20:21]
    v_pk_mul_f32 v[246:247], v[246:247], v[20:21]
    v_cvt_pk_bf16_f32 v152, v240, v241
    v_cvt_pk_bf16_f32 v153, v242, v243
    v_cvt_pk_bf16_f32 v154, v244, v245
    v_cvt_pk_bf16_f32 v155, v246, v247
    v_pk_mul_f32 v[248:249], v[248:249], v[20:21]
    v_pk_mul_f32 v[250:251], v[250:251], v[20:21]
    v_pk_mul_f32 v[252:253], v[252:253], v[20:21]
    v_pk_mul_f32 v[254:255], v[254:255], v[20:21]
    v_cvt_pk_bf16_f32 v156, v248, v249
    v_cvt_pk_bf16_f32 v157, v250, v251
    v_cvt_pk_bf16_f32 v158, v252, v253
    v_cvt_pk_bf16_f32 v159, v254, v255
    v_mov_b32 v2, v7
    v_and_b32 v21, 15, v1
    v_lshrrev_b32 v22, 4, v1
    v_lshlrev_b32 v22, 2, v22
    v_sub_u32 v18, v21, v22
    s_mov_b32 s40, 0
    s_mov_b32 s41, 16384
    s_mov_b32 s49, 0xffff
    s_lshl_b32 s51, s30, 1
    s_add_u32 s51, s51, 1
    s_and_b32 s50, s28, 3
    s_lshl_b32 s50, s50, 5
    v_mov_b32 v36, 0x3f803f80
    v_mov_b32 v37, 0x3f803f80
    v_mov_b32 v38, 0x3f803f80
    v_mov_b32 v39, 0x3f803f80
    s_lshl_b32 s42, 7, s51
    s_lshr_b32 s42, s42, 2
    s_or_b32 s42, s42, 0x8001
    s_mov_b64 s[52:53], 0
    s_waitcnt lgkmcnt(0)
    s_barrier
    ds_read_b128 v[160:163], v19 offset:0
    ds_read_b128 v[164:167], v19 offset:1024
    ds_read_b128 v[168:171], v19 offset:2048
    ds_read_b128 v[172:175], v19 offset:3072
    ds_read_b128 v[176:179], v19 offset:4096
    ds_read_b128 v[180:183], v19 offset:5120
    ds_read_b128 v[184:187], v19 offset:6144
    ds_read_b128 v[188:191], v19 offset:7168
    s_add_u32 s16, s54, 41943040
    s_addc_u32 s17, s55, 0
    s_and_b32 s17, s17, 0xffff
    s_mov_b32 s18, 16777216
    s_mov_b32 s19, 0x20000
    s_cmp_eq_u32 s28, 4
    s_cbranch_scc1 L_recurrent_scan__compressed_kv_cla__moe_arch_mod__prompt_kernel_rare_109
L_recurrent_scan__compressed_kv_cla__moe_arch_mod__prompt_kernel_back_110:
    s_sub_u32 s36, s2, 160
    s_lshl_b32 s36, s36, 1
    s_and_b32 s37, s28, 1
    s_add_u32 s36, s36, s37
    s_min_u32 s36, s36, 1024
    s_mul_i32 s36, s36, 43776
    s_cmp_lt_u32 s28, 6
    s_cselect_b64 s[4:5], s[32:33], s[34:35]
    s_cselect_b32 s37, 32, 28
    s_lshl_b32 s37, s37, 18
    s_min_u32 s36, s36, s37
    s_sub_u32 s6, s37, s36
    s_min_u32 s6, s6, 43776
    s_add_u32 s4, s4, s36
    s_addc_u32 s5, s5, 0
    s_and_b32 s5, s5, 0xffff
    s_mov_b32 s7, 0x20000
    v_cmp_gt_u32 vcc, 32, v1
    v_lshlrev_b32 v13, 7, v1
    v_mov_b32 v12, 0x100000
    v_cndmask_b32 v13, v12, v13, vcc
    s_mov_b32 s48, 0
    s_cmp_eq_u32 s28, 5
    s_cselect_b32 s36, 0x1000, 0
    s_or_b32 s42, s42, s36
    ds_read_b128 v[64:67], v2 offset:0
    ds_read_b128 v[68:71], v2 offset:1024
    ds_read_b128 v[72:75], v2 offset:2048
    ds_read_b128 v[76:79], v2 offset:3072
    ds_read_b128 v[80:83], v2 offset:4096
    ds_read_b128 v[84:87], v2 offset:5120
    ds_read_b128 v[88:91], v2 offset:6144
    ds_read_b128 v[92:95], v2 offset:7168
    s_waitcnt lgkmcnt(7)
    v_mfma_f32_16x16x32_bf16 v[96:99], v[64:67], v[128:131], 0
    v_mov_b64 v[192:193], 0
    v_mov_b64 v[194:195], 0
    v_mfma_f32_16x16x32_bf16 v[104:107], v[64:67], v[144:147], 0
    ds_read_b128 v[64:67], v2 offset:8192
    v_mov_b64 v[196:197], 0
    v_mov_b64 v[198:199], 0
    s_waitcnt lgkmcnt(7)
    v_mfma_f32_16x16x32_bf16 v[96:99], v[68:71], v[132:135], v[96:99]
    v_mov_b64 v[200:201], 0
    v_mov_b64 v[202:203], 0
    v_mfma_f32_16x16x32_bf16 v[104:107], v[68:71], v[148:151], v[104:107]
    ds_read_b128 v[68:71], v2 offset:9216
    v_mov_b64 v[204:205], 0
    v_mov_b64 v[206:207], 0
    s_waitcnt lgkmcnt(7)
    v_mfma_f32_16x16x32_bf16 v[96:99], v[72:75], v[136:139], v[96:99]
    v_mov_b64 v[208:209], 0
    v_mfma_f32_16x16x32_bf16 v[104:107], v[72:75], v[152:155], v[104:107]
    ds_read_b128 v[72:75], v2 offset:10240
    v_mov_b64 v[210:211], 0
    v_mov_b64 v[212:213], 0
    s_waitcnt lgkmcnt(7)
    v_mfma_f32_16x16x32_bf16 v[96:99], v[76:79], v[140:143], v[96:99]
    v_mov_b64 v[214:215], 0
    v_mov_b64 v[216:217], 0
    v_mfma_f32_16x16x32_bf16 v[104:107], v[76:79], v[156:159], v[104:107]
    ds_read_b128 v[76:79], v2 offset:11264
    v_mov_b64 v[218:219], 0
    v_mov_b64 v[220:221], 0
    s_waitcnt lgkmcnt(7)
    v_mfma_f32_16x16x32_bf16 v[100:103], v[80:83], v[128:131], 0
    v_mov_b64 v[222:223], 0
    v_mov_b64 v[224:225], 0
    v_mfma_f32_16x16x32_bf16 v[108:111], v[80:83], v[144:147], 0
    ds_read_b128 v[80:83], v2 offset:12288
    v_mov_b64 v[226:227], 0
    s_waitcnt lgkmcnt(7)
    v_mfma_f32_16x16x32_bf16 v[100:103], v[84:87], v[132:135], v[100:103]
    v_mov_b64 v[228:229], 0
    v_mov_b64 v[230:231], 0
    v_mfma_f32_16x16x32_bf16 v[108:111], v[84:87], v[148:151], v[108:111]
    ds_read_b128 v[84:87], v2 offset:13312
    v_mov_b64 v[232:233], 0
    v_mov_b64 v[234:235], 0
    s_waitcnt lgkmcnt(7)
    v_mfma_f32_16x16x32_bf16 v[100:103], v[88:91], v[136:139], v[100:103]
    v_mov_b64 v[236:237], 0
    v_mov_b64 v[238:239], 0
    v_mfma_f32_16x16x32_bf16 v[108:111], v[88:91], v[152:155], v[108:111]
    ds_read_b128 v[88:91], v2 offset:14336
    v_mov_b64 v[240:241], 0
    v_mov_b64 v[242:243], 0
    s_waitcnt lgkmcnt(7)
    v_mfma_f32_16x16x32_bf16 v[100:103], v[92:95], v[140:143], v[100:103]
    v_mov_b64 v[244:245], 0
    v_mfma_f32_16x16x32_bf16 v[108:111], v[92:95], v[156:159], v[108:111]
    ds_read_b128 v[92:95], v2 offset:15360
    v_mov_b64 v[246:247], 0
    v_mov_b64 v[248:249], 0
    s_waitcnt lgkmcnt(7)
    v_mfma_f32_16x16x32_bf16 v[112:115], v[64:67], v[128:131], 0
    v_mov_b64 v[250:251], 0
    v_mov_b64 v[252:253], 0
    v_mfma_f32_16x16x32_bf16 v[120:123], v[64:67], v[144:147], 0
    v_mov_b64 v[254:255], 0
    v_mov_b64 v[28:29], 0
    s_waitcnt lgkmcnt(6)
    v_mfma_f32_16x16x32_bf16 v[112:115], v[68:71], v[132:135], v[112:115]
    v_mov_b64 v[30:31], 0
    v_mov_b64 v[32:33], 0
    v_mfma_f32_16x16x32_bf16 v[120:123], v[68:71], v[148:151], v[120:123]
    v_mov_b64 v[34:35], 0
    s_waitcnt lgkmcnt(5)
    v_mfma_f32_16x16x32_bf16 v[112:115], v[72:75], v[136:139], v[112:115]
    s_add_u32 s36, s30, s50
    s_cmp_eq_u32 s36, 0
    s_cbranch_scc1 L_recurrent_scan__compressed_kv_cla__moe_arch_mod__prompt_kernel_rare_112
L_recurrent_scan__compressed_kv_cla__moe_arch_mod__prompt_kernel_back_113:
    v_mfma_f32_16x16x32_bf16 v[120:123], v[72:75], v[152:155], v[120:123]
    v_max3_f32 v22, v96, v97, v98
    v_max3_f32 v23, v104, v105, v106
    s_waitcnt lgkmcnt(4)
    v_mfma_f32_16x16x32_bf16 v[112:115], v[76:79], v[140:143], v[112:115]
    v_max3_f32 v22, v22, v99, v100
    v_max3_f32 v23, v23, v107, v108
    v_mfma_f32_16x16x32_bf16 v[120:123], v[76:79], v[156:159], v[120:123]
    v_max3_f32 v22, v22, v101, v102
    v_max3_f32 v23, v23, v109, v110
    s_waitcnt lgkmcnt(3)
    v_mfma_f32_16x16x32_bf16 v[116:119], v[80:83], v[128:131], 0
    v_max_f32 v22, v22, v103
    v_max_f32 v23, v23, v111
    v_mfma_f32_16x16x32_bf16 v[124:127], v[80:83], v[144:147], 0
    v_mov_b32 v24, v22
    v_mov_b32 v25, v23
    s_waitcnt lgkmcnt(2)
    v_mfma_f32_16x16x32_bf16 v[116:119], v[84:87], v[132:135], v[116:119]
    v_permlane16_swap_b32 v22, v24
    v_permlane16_swap_b32 v23, v25
    v_mfma_f32_16x16x32_bf16 v[124:127], v[84:87], v[148:151], v[124:127]
    v_max_f32 v22, v22, v24
    v_max_f32 v23, v23, v25
    s_waitcnt lgkmcnt(1)
    v_mfma_f32_16x16x32_bf16 v[116:119], v[88:91], v[136:139], v[116:119]
    v_mov_b32 v24, v22
    v_mov_b32 v25, v23
    v_mfma_f32_16x16x32_bf16 v[124:127], v[88:91], v[152:155], v[124:127]
    v_permlane32_swap_b32 v22, v24
    v_permlane32_swap_b32 v23, v25
    s_waitcnt lgkmcnt(0)
    v_mfma_f32_16x16x32_bf16 v[116:119], v[92:95], v[140:143], v[116:119]
    v_max_f32 v22, v22, v24
    v_max_f32 v23, v23, v25
    v_mfma_f32_16x16x32_bf16 v[124:127], v[92:95], v[156:159], v[124:127]
    v_sub_f32 v40, 0, v22
    v_sub_f32 v41, 0, v22
    v_sub_f32 v42, 0, v22
    v_sub_f32 v43, 0, v22
    v_sub_f32 v44, 0, v23
    v_sub_f32 v45, 0, v23
    v_sub_f32 v46, 0, v23
    v_sub_f32 v47, 0, v23
    v_add_u32 v3, 65536, v2
    v_add_u32 v2, s41, v2
    v_and_b32 v2, s49, v2
    s_waitcnt vmcnt(1)
    s_cmp_eq_u32 s28, 4
    s_cbranch_scc1 L_recurrent_scan__compressed_kv_cla__moe_arch_mod__prompt_kernel_pw_114
    s_waitcnt vmcnt(0)
L_recurrent_scan__compressed_kv_cla__moe_arch_mod__prompt_kernel_pw_114:
    s_barrier
    ds_read_b128 v[64:67], v2 offset:0
    ds_read_b128 v[68:71], v2 offset:1024
    ds_read_b128 v[72:75], v2 offset:2048
    ds_read_b128 v[76:79], v2 offset:3072
    ds_read_b128 v[80:83], v2 offset:4096
    ds_read_b128 v[84:87], v2 offset:5120
    ds_read_b128 v[88:91], v2 offset:6144
    v_pk_add_f32 v[96:97], v[96:97], v[40:41]
    v_pk_add_f32 v[98:99], v[98:99], v[40:41]
    v_pk_add_f32 v[100:101], v[100:101], v[40:41]
    v_pk_add_f32 v[102:103], v[102:103], v[40:41]
    v_pk_add_f32 v[104:105], v[104:105], v[44:45]
    v_pk_add_f32 v[106:107], v[106:107], v[44:45]
    v_pk_add_f32 v[108:109], v[108:109], v[44:45]
    v_pk_add_f32 v[110:111], v[110:111], v[44:45]
    v_pk_add_f32 v[112:113], v[112:113], v[40:41]
    v_pk_add_f32 v[114:115], v[114:115], v[40:41]
    v_pk_add_f32 v[116:117], v[116:117], v[40:41]
    v_pk_add_f32 v[118:119], v[118:119], v[40:41]
    v_pk_add_f32 v[120:121], v[120:121], v[44:45]
    v_pk_add_f32 v[122:123], v[122:123], v[44:45]
    v_pk_add_f32 v[124:125], v[124:125], v[44:45]
    v_pk_add_f32 v[126:127], v[126:127], v[44:45]
    v_exp_f32 v96, v96
    v_exp_f32 v97, v97
    v_exp_f32 v98, v98
    v_exp_f32 v99, v99
    v_exp_f32 v104, v104
    v_exp_f32 v105, v105
    v_exp_f32 v106, v106
    v_exp_f32 v107, v107
    v_exp_f32 v100, v100
    v_exp_f32 v101, v101
    v_exp_f32 v102, v102
    v_exp_f32 v103, v103
    v_exp_f32 v108, v108
    v_exp_f32 v109, v109
    v_exp_f32 v110, v110
    v_exp_f32 v111, v111
    v_cvt_pk_bf16_f32 v48, v96, v97
    v_cvt_pk_bf16_f32 v49, v98, v99
    v_cvt_pk_bf16_f32 v52, v104, v105
    v_cvt_pk_bf16_f32 v53, v106, v107
    v_cvt_pk_bf16_f32 v50, v100, v101
    v_cvt_pk_bf16_f32 v51, v102, v103
    v_cvt_pk_bf16_f32 v54, v108, v109
    v_cvt_pk_bf16_f32 v55, v110, v111
    .p2align 6
L_body1:
    s_bitcmp1_b32 s42, s40
    s_cbranch_scc1 L_recurrent_scan__compressed_kv_cla__moe_arch_mod__prompt_kernel_rare_119
L_recurrent_scan__compressed_kv_cla__moe_arch_mod__prompt_kernel_back_120:
    s_waitcnt lgkmcnt(5)
    v_mfma_f32_16x16x32_bf16 v[96:99], v[64:67], v[128:131], v[40:43]
    v_exp_f32 v112, v112
    v_mfma_f32_16x16x32_bf16 v[104:107], v[64:67], v[144:147], v[44:47]
    ds_read_b128 v[92:95], v2 offset:7168
    v_mfma_f32_16x16x32_bf16 v[96:99], v[68:71], v[132:135], v[96:99]
    v_exp_f32 v113, v113
    v_mfma_f32_16x16x32_bf16 v[104:107], v[68:71], v[148:151], v[104:107]
    ds_read_b128 v[64:67], v3 offset:0
    s_waitcnt lgkmcnt(5)
    v_mfma_f32_16x16x32_bf16 v[96:99], v[72:75], v[136:139], v[96:99]
    v_exp_f32 v114, v114
    v_mfma_f32_16x16x32_bf16 v[104:107], v[72:75], v[152:155], v[104:107]
    ds_read_b128 v[68:71], v3 offset:1024
    v_cvt_pk_bf16_f32 v56, v112, v113
    v_mfma_f32_16x16x32_bf16 v[96:99], v[76:79], v[140:143], v[96:99]
    v_exp_f32 v115, v115
    v_mfma_f32_16x16x32_bf16 v[104:107], v[76:79], v[156:159], v[104:107]
    ds_read_b128 v[72:75], v3 offset:2048
    s_waitcnt lgkmcnt(5)
    v_mfma_f32_16x16x32_bf16 v[100:103], v[80:83], v[128:131], v[40:43]
    v_exp_f32 v120, v120
    v_mfma_f32_16x16x32_bf16 v[108:111], v[80:83], v[144:147], v[44:47]
    ds_read_b128 v[76:79], v3 offset:3072
    v_cvt_pk_bf16_f32 v57, v114, v115
    v_mfma_f32_16x16x32_bf16 v[100:103], v[84:87], v[132:135], v[100:103]
    v_exp_f32 v121, v121
    v_mfma_f32_16x16x32_bf16 v[108:111], v[84:87], v[148:151], v[108:111]
    ds_read_b128 v[80:83], v3 offset:4096
    s_waitcnt lgkmcnt(5)
    v_mfma_f32_16x16x32_bf16 v[100:103], v[88:91], v[136:139], v[100:103]
    v_exp_f32 v122, v122
    v_mfma_f32_16x16x32_bf16 v[108:111], v[88:91], v[152:155], v[108:111]
    ds_read_b128 v[84:87], v3 offset:5120
    v_cvt_pk_bf16_f32 v60, v120, v121
    v_mfma_f32_16x16x32_bf16 v[100:103], v[92:95], v[140:143], v[100:103]
    v_exp_f32 v123, v123
    v_mfma_f32_16x16x32_bf16 v[108:111], v[92:95], v[156:159], v[108:111]
    ds_read_b128 v[88:91], v3 offset:6144
    s_waitcnt lgkmcnt(5)
    v_mfma_f32_16x16x32_bf16 v[192:195], v[64:67], v[48:51], v[192:195]
    v_exp_f32 v116, v116
    v_mfma_f32_16x16x32_bf16 v[224:227], v[64:67], v[52:55], v[224:227]
    ds_read_b128 v[92:95], v3 offset:7168
    v_cvt_pk_bf16_f32 v61, v122, v123
    v_mfma_f32_16x16x32_bf16 v[196:199], v[68:71], v[48:51], v[196:199]
    v_exp_f32 v117, v117
    v_mfma_f32_16x16x32_bf16 v[228:231], v[68:71], v[52:55], v[228:231]
    ds_read_b128 v[64:67], v2 offset:8192
    s_waitcnt lgkmcnt(5)
    v_mfma_f32_16x16x32_bf16 v[200:203], v[72:75], v[48:51], v[200:203]
    v_exp_f32 v118, v118
    v_mfma_f32_16x16x32_bf16 v[232:235], v[72:75], v[52:55], v[232:235]
    v_mfma_f32_16x16x32_bf16 v[28:31], v[36:39], v[48:51], v[28:31]
    ds_read_b128 v[68:71], v2 offset:9216
    v_cvt_pk_bf16_f32 v58, v116, v117
    v_mfma_f32_16x16x32_bf16 v[204:207], v[76:79], v[48:51], v[204:207]
    v_exp_f32 v119, v119
    v_mfma_f32_16x16x32_bf16 v[236:239], v[76:79], v[52:55], v[236:239]
    ds_read_b128 v[72:75], v2 offset:10240
    s_waitcnt lgkmcnt(5)
    v_mfma_f32_16x16x32_bf16 v[208:211], v[80:83], v[48:51], v[208:211]
    v_exp_f32 v124, v124
    buffer_load_dword v0, v13, s[4:7], s48 offen
    s_add_u32 s48, s48, 4096
    v_mfma_f32_16x16x32_bf16 v[240:243], v[80:83], v[52:55], v[240:243]
    ds_read_b128 v[76:79], v2 offset:11264
    v_cvt_pk_bf16_f32 v59, v118, v119
    v_mfma_f32_16x16x32_bf16 v[212:215], v[84:87], v[48:51], v[212:215]
    v_exp_f32 v125, v125
    v_mfma_f32_16x16x32_bf16 v[244:247], v[84:87], v[52:55], v[244:247]
    ds_read_b128 v[80:83], v2 offset:12288
    s_waitcnt lgkmcnt(5)
    v_mfma_f32_16x16x32_bf16 v[216:219], v[88:91], v[48:51], v[216:219]
    v_exp_f32 v126, v126
    v_mfma_f32_16x16x32_bf16 v[248:251], v[88:91], v[52:55], v[248:251]
    v_mfma_f32_16x16x32_bf16 v[32:35], v[36:39], v[52:55], v[32:35]
    ds_read_b128 v[84:87], v2 offset:13312
    v_cvt_pk_bf16_f32 v62, v124, v125
    v_mfma_f32_16x16x32_bf16 v[220:223], v[92:95], v[48:51], v[220:223]
    v_exp_f32 v127, v127
    v_mfma_f32_16x16x32_bf16 v[252:255], v[92:95], v[52:55], v[252:255]
    ds_read_b128 v[88:91], v2 offset:14336
    v_cvt_pk_bf16_f32 v63, v126, v127
    s_bitcmp1_b32 s42, s40
    s_cbranch_scc1 L_recurrent_scan__compressed_kv_cla__moe_arch_mod__prompt_kernel_rare_122
L_recurrent_scan__compressed_kv_cla__moe_arch_mod__prompt_kernel_back_123:
    s_waitcnt lgkmcnt(5)
    v_mfma_f32_16x16x32_bf16 v[112:115], v[64:67], v[128:131], v[40:43]
    v_exp_f32 v96, v96
    v_mfma_f32_16x16x32_bf16 v[120:123], v[64:67], v[144:147], v[44:47]
    ds_read_b128 v[92:95], v2 offset:15360
    v_mfma_f32_16x16x32_bf16 v[112:115], v[68:71], v[132:135], v[112:115]
    v_exp_f32 v97, v97
    v_mfma_f32_16x16x32_bf16 v[120:123], v[68:71], v[148:151], v[120:123]
    ds_read_b128 v[64:67], v3 offset:8192
    s_waitcnt lgkmcnt(5)
    v_mfma_f32_16x16x32_bf16 v[112:115], v[72:75], v[136:139], v[112:115]
    v_exp_f32 v98, v98
    v_mfma_f32_16x16x32_bf16 v[120:123], v[72:75], v[152:155], v[120:123]
    ds_read_b128 v[68:71], v3 offset:9216
    v_cvt_pk_bf16_f32 v48, v96, v97
    v_mfma_f32_16x16x32_bf16 v[112:115], v[76:79], v[140:143], v[112:115]
    v_exp_f32 v99, v99
    v_mfma_f32_16x16x32_bf16 v[120:123], v[76:79], v[156:159], v[120:123]
    ds_read_b128 v[72:75], v3 offset:10240
    s_waitcnt lgkmcnt(5)
    v_mfma_f32_16x16x32_bf16 v[116:119], v[80:83], v[128:131], v[40:43]
    v_exp_f32 v104, v104
    v_mfma_f32_16x16x32_bf16 v[124:127], v[80:83], v[144:147], v[44:47]
    ds_read_b128 v[76:79], v3 offset:11264
    v_cvt_pk_bf16_f32 v49, v98, v99
    v_mfma_f32_16x16x32_bf16 v[116:119], v[84:87], v[132:135], v[116:119]
    v_exp_f32 v105, v105
    v_mfma_f32_16x16x32_bf16 v[124:127], v[84:87], v[148:151], v[124:127]
    ds_read_b128 v[80:83], v3 offset:12288
    s_waitcnt lgkmcnt(5)
    v_mfma_f32_16x16x32_bf16 v[116:119], v[88:91], v[136:139], v[116:119]
    v_exp_f32 v106, v106
    v_mfma_f32_16x16x32_bf16 v[124:127], v[88:91], v[152:155], v[124:127]
    ds_read_b128 v[84:87], v3 offset:13312
    v_cvt_pk_bf16_f32 v52, v104, v105
    v_mfma_f32_16x16x32_bf16 v[116:119], v[92:95], v[140:143], v[116:119]
    v_exp_f32 v107, v107
    v_mfma_f32_16x16x32_bf16 v[124:127], v[92:95], v[156:159], v[124:127]
    ds_read_b128 v[88:91], v3 offset:14336
    s_waitcnt lgkmcnt(5)
    v_mfma_f32_16x16x32_bf16 v[192:195], v[64:67], v[56:59], v[192:195]
    v_exp_f32 v100, v100
    v_mfma_f32_16x16x32_bf16 v[224:227], v[64:67], v[60:63], v[224:227]
    ds_read_b128 v[92:95], v3 offset:15360
    v_cvt_pk_bf16_f32 v53, v106, v107
    v_mfma_f32_16x16x32_bf16 v[196:199], v[68:71], v[56:59], v[196:199]
    v_exp_f32 v101, v101
    v_mfma_f32_16x16x32_bf16 v[228:231], v[68:71], v[60:63], v[228:231]
    v_add_u32 v3, 65536, v2
    v_add_u32 v2, s41, v2
    s_waitcnt lgkmcnt(4)
    v_mfma_f32_16x16x32_bf16 v[200:203], v[72:75], v[56:59], v[200:203]
    v_exp_f32 v102, v102
    v_and_b32 v2, s49, v2
    v_mfma_f32_16x16x32_bf16 v[232:235], v[72:75], v[60:63], v[232:235]
    v_mfma_f32_16x16x32_bf16 v[28:31], v[36:39], v[56:59], v[28:31]
    v_cvt_pk_bf16_f32 v50, v100, v101
    s_waitcnt lgkmcnt(0)
    s_barrier
    v_mfma_f32_16x16x32_bf16 v[204:207], v[76:79], v[56:59], v[204:207]
    v_exp_f32 v103, v103
    v_mfma_f32_16x16x32_bf16 v[236:239], v[76:79], v[60:63], v[236:239]
    ds_read_b128 v[68:71], v2 offset:1024
    ds_read_b128 v[64:67], v2 offset:0
    v_mfma_f32_16x16x32_bf16 v[208:211], v[80:83], v[56:59], v[208:211]
    v_exp_f32 v108, v108
    v_mfma_f32_16x16x32_bf16 v[240:243], v[80:83], v[60:63], v[240:243]
    ds_read_b128 v[76:79], v2 offset:3072
    ds_read_b128 v[72:75], v2 offset:2048
    v_cvt_pk_bf16_f32 v51, v102, v103
    v_mfma_f32_16x16x32_bf16 v[212:215], v[84:87], v[56:59], v[212:215]
    v_exp_f32 v109, v109
    v_mfma_f32_16x16x32_bf16 v[244:247], v[84:87], v[60:63], v[244:247]
    ds_read_b128 v[80:83], v2 offset:4096
    v_mfma_f32_16x16x32_bf16 v[216:219], v[88:91], v[56:59], v[216:219]
    v_exp_f32 v110, v110
    v_mfma_f32_16x16x32_bf16 v[248:251], v[88:91], v[60:63], v[248:251]
    v_mfma_f32_16x16x32_bf16 v[32:35], v[36:39], v[60:63], v[32:35]
    ds_read_b128 v[84:87], v2 offset:5120
    v_cvt_pk_bf16_f32 v54, v108, v109
    v_mfma_f32_16x16x32_bf16 v[220:223], v[92:95], v[56:59], v[220:223]
    v_exp_f32 v111, v111
    v_mfma_f32_16x16x32_bf16 v[252:255], v[92:95], v[60:63], v[252:255]
    ds_read_b128 v[88:91], v2 offset:6144
    v_cvt_pk_bf16_f32 v55, v110, v111
    s_bitcmp1_b32 s42, s40
    s_cbranch_scc1 L_recurrent_scan__compressed_kv_cla__moe_arch_mod__prompt_kernel_rare_132
L_recurrent_scan__compressed_kv_cla__moe_arch_mod__prompt_kernel_back_133:
    s_add_u32 s40, s40, 1
    s_cmp_lg_u32 s40, 16
    s_cbranch_scc1 L_body1
    s_lshr_b32 s36, s2, 5
    s_add_u32 s36, s36, 48
    s_lshl_b32 s36, s36, 7
    v_mov_b32 v12, s36
    global_load_dword v11, v12, s[90:91] sc1
    s_sub_u32 s36, 96, s50
    s_cmp_lt_i32 s36, 0
    s_cbranch_scc0 L_recurrent_scan__compressed_kv_cla__moe_arch_mod__prompt_kernel_rare_125
L_recurrent_scan__compressed_kv_cla__moe_arch_mod__prompt_kernel_back_126:
    s_lshl_b32 s37, s28, 13
    v_add_u32 v5, s37, v7
    s_waitcnt lgkmcnt(5)
    v_mfma_f32_16x16x32_bf16 v[192:195], v[64:67], v[48:51], v[192:195]
    v_exp_f32 v112, v112
    v_mfma_f32_16x16x32_bf16 v[224:227], v[64:67], v[52:55], v[224:227]
    ds_read_b128 v[92:95], v3 offset:7168
    v_exp_f32 v113, v113
    v_mfma_f32_16x16x32_bf16 v[196:199], v[68:71], v[48:51], v[196:199]
    v_cvt_pk_bf16_f32 v56, v112, v113
    v_exp_f32 v114, v114
    v_mfma_f32_16x16x32_bf16 v[228:231], v[68:71], v[52:55], v[228:231]
    ds_read_b128 v[64:67], v3 offset:8192
    v_exp_f32 v115, v115
    s_waitcnt lgkmcnt(5)
    v_mfma_f32_16x16x32_bf16 v[200:203], v[72:75], v[48:51], v[200:203]
    v_cvt_pk_bf16_f32 v57, v114, v115
    v_exp_f32 v120, v120
    v_mfma_f32_16x16x32_bf16 v[232:235], v[72:75], v[52:55], v[232:235]
    v_mfma_f32_16x16x32_bf16 v[28:31], v[36:39], v[48:51], v[28:31]
    ds_read_b128 v[68:71], v3 offset:9216
    v_exp_f32 v121, v121
    v_mfma_f32_16x16x32_bf16 v[204:207], v[76:79], v[48:51], v[204:207]
    v_cvt_pk_bf16_f32 v60, v120, v121
    v_exp_f32 v122, v122
    v_mfma_f32_16x16x32_bf16 v[236:239], v[76:79], v[52:55], v[236:239]
    ds_read_b128 v[72:75], v3 offset:10240
    v_exp_f32 v123, v123
    s_waitcnt lgkmcnt(6)
    v_mfma_f32_16x16x32_bf16 v[208:211], v[80:83], v[48:51], v[208:211]
    v_cvt_pk_bf16_f32 v61, v122, v123
    v_exp_f32 v116, v116
    v_mfma_f32_16x16x32_bf16 v[240:243], v[80:83], v[52:55], v[240:243]
    ds_read_b128 v[76:79], v3 offset:11264
    v_exp_f32 v117, v117
    s_waitcnt lgkmcnt(6)
    v_mfma_f32_16x16x32_bf16 v[212:215], v[84:87], v[48:51], v[212:215]
    v_cvt_pk_bf16_f32 v58, v116, v117
    v_exp_f32 v118, v118
    v_mfma_f32_16x16x32_bf16 v[244:247], v[84:87], v[52:55], v[244:247]
    ds_read_b128 v[80:83], v3 offset:12288
    v_exp_f32 v119, v119
    s_waitcnt lgkmcnt(6)
    v_mfma_f32_16x16x32_bf16 v[216:219], v[88:91], v[48:51], v[216:219]
    v_cvt_pk_bf16_f32 v59, v118, v119
    v_exp_f32 v124, v124
    v_mfma_f32_16x16x32_bf16 v[248:251], v[88:91], v[52:55], v[248:251]
    v_mfma_f32_16x16x32_bf16 v[32:35], v[36:39], v[52:55], v[32:35]
    ds_read_b128 v[84:87], v3 offset:13312
    v_exp_f32 v125, v125
    s_waitcnt lgkmcnt(6)
    v_mfma_f32_16x16x32_bf16 v[220:223], v[92:95], v[48:51], v[220:223]
    v_cvt_pk_bf16_f32 v62, v124, v125
    v_exp_f32 v126, v126
    v_mfma_f32_16x16x32_bf16 v[252:255], v[92:95], v[52:55], v[252:255]
    ds_read_b128 v[88:91], v3 offset:14336
    v_exp_f32 v127, v127
    s_nop 0
    v_cvt_pk_bf16_f32 v63, v126, v127
    s_nop 1
    s_waitcnt lgkmcnt(6)
    v_mfma_f32_16x16x32_bf16 v[192:195], v[64:67], v[56:59], v[192:195]
    s_mov_b32 s4, s34
    s_and_b32 s5, s35, 0xffff
    s_mov_b32 s6, 7340032
    s_mov_b32 s7, 0x20000
    s_mov_b32 s8, s32
    v_mfma_f32_16x16x32_bf16 v[224:227], v[64:67], v[60:63], v[224:227]
    ds_read_b128 v[92:95], v3 offset:15360
    s_and_b32 s9, s33, 0xffff
    s_mov_b32 s10, 8388608
    s_mov_b32 s11, 0x20000
    s_lshr_b32 s38, s2, 4
    s_waitcnt lgkmcnt(6)
    v_mfma_f32_16x16x32_bf16 v[196:199], v[68:71], v[56:59], v[196:199]
    s_mul_i32 s38, s38, 224
    s_and_b32 s39, s2, 15
    s_lshl_b32 s39, s39, 7
    v_lshrrev_b32 v25, 3, v1
    s_lshl_b32 s36, s28, 5
    v_mfma_f32_16x16x32_bf16 v[228:231], v[68:71], v[60:63], v[228:231]
    s_add_u32 s36, s36, s38
    v_add_u32 v25, s36, v25
    v_mul_u32_u24 v25, 2048, v25
    v_add_u32 v25, s39, v25
    s_waitcnt lgkmcnt(5)
    v_mfma_f32_16x16x32_bf16 v[200:203], v[72:75], v[56:59], v[200:203]
    v_bfe_u32 v26, v1, 4, 1
    v_lshlrev_b32 v26, 1, v26
    v_and_b32 v27, 7, v1
    v_xor_b32 v26, v26, v27
    v_mfma_f32_16x16x32_bf16 v[232:235], v[72:75], v[60:63], v[232:235]
    v_mfma_f32_16x16x32_bf16 v[28:31], v[36:39], v[56:59], v[28:31]
    v_lshl_add_u32 v24, v26, 4, v25
    v_xor_b32 v26, 4, v26
    v_lshl_add_u32 v25, v26, 4, v25
    v_add_u32 v25, 15360, v25
    v_add_u32 v26, 30720, v24
    s_waitcnt lgkmcnt(4)
    v_mfma_f32_16x16x32_bf16 v[204:207], v[76:79], v[56:59], v[204:207]
    v_add_u32 v27, 30720, v25
    s_lshl_b32 s36, s28, 12
    s_add_u32 s36, s36, 131072
    s_cmp_lt_u32 s28, 7
    s_cselect_b32 m0, s36, 0x30000
    s_cselect_b32 s6, 7340032, 0
    v_mfma_f32_16x16x32_bf16 v[236:239], v[76:79], v[60:63], v[236:239]
    buffer_load_dwordx4 v24, s[4:7], 0 offen offset:0 lds
    buffer_load_dwordx4 v25, s[4:7], 0 offen offset:1024 lds
    buffer_load_dwordx4 v26, s[4:7], 0 offen offset:2048 lds
    buffer_load_dwordx4 v27, s[4:7], 0 offen offset:3072 lds
    s_waitcnt lgkmcnt(3)
    v_mfma_f32_16x16x32_bf16 v[208:211], v[80:83], v[56:59], v[208:211]
    v_mfma_f32_16x16x32_bf16 v[240:243], v[80:83], v[60:63], v[240:243]
    ds_write_b128 v5, v[192:195] offset:0
    s_waitcnt lgkmcnt(3)
    v_mfma_f32_16x16x32_bf16 v[212:215], v[84:87], v[56:59], v[212:215]
    v_mfma_f32_16x16x32_bf16 v[244:247], v[84:87], v[60:63], v[244:247]
    ds_write_b128 v5, v[196:199] offset:1024
    s_waitcnt lgkmcnt(3)
    v_mfma_f32_16x16x32_bf16 v[216:219], v[88:91], v[56:59], v[216:219]
    v_mfma_f32_16x16x32_bf16 v[248:251], v[88:91], v[60:63], v[248:251]
    v_mfma_f32_16x16x32_bf16 v[32:35], v[36:39], v[60:63], v[32:35]
    ds_write_b128 v5, v[200:203] offset:2048
    s_waitcnt lgkmcnt(3)
    v_mfma_f32_16x16x32_bf16 v[220:223], v[92:95], v[56:59], v[220:223]
    v_mfma_f32_16x16x32_bf16 v[252:255], v[92:95], v[60:63], v[252:255]
    ds_write_b128 v5, v[204:207] offset:3072
    ds_write_b128 v5, v[208:211] offset:4096
    ds_write_b128 v5, v[212:215] offset:5120
    v_xor_b32 v106, 32768, v5
    s_lshl_b32 s37, s28, 8
    s_add_u32 s37, s37, 159744
    v_lshl_add_u32 v107, v1, 2, s37
    v_xor_b32 v108, 1024, v107
    ds_write_b128 v5, v[216:219] offset:6144
    ds_write_b128 v5, v[220:223] offset:7168
    ds_write_b32 v107, v28
    s_mov_b32 s36, 0x5d800000
    v_cmp_nge_f32 vcc, s36, v28
    s_nop 0
    s_or_b64 s[52:53], s[52:53], vcc
    v_cmp_nge_f32 vcc, s36, v32
    s_nop 0
    s_or_b64 s[52:53], s[52:53], vcc
    s_or_b32 s36, s52, s53
    v_mov_b32 v110, s36
    s_lshl_b32 s37, s28, 2
    s_add_u32 s37, s37, 161792
    v_mov_b32 v111, s37
    ds_write_b32 v111, v110
    v_mov_b32 v112, 161856
    v_and_b32 v111, 7, v1
    v_lshlrev_b32 v111, 2, v111
    v_add_u32 v111, 161792, v111
    s_sub_u32 s36, 15, s30
    s_lshl_b32 s38, s36, 3
    s_and_b32 s37, s28, 3
    s_lshl_b32 s37, s37, 1
    s_add_u32 s38, s38, s37
    s_add_u32 s38, s38, 1
    s_lshl_b32 s38, s38, 17
    s_lshl_b32 s37, s29, 12
    s_add_u32 s38, s38, s37
    s_waitcnt vmcnt(4)
    v_readfirstlane_b32 s36, v11
    s_nop 0
    s_cmp_lt_u32 s36, 28
    s_cbranch_scc1 L_recurrent_scan__compressed_kv_cla__moe_arch_mod__prompt_kernel_rare_136
L_recurrent_scan__compressed_kv_cla__moe_arch_mod__prompt_kernel_back_137:
    s_lshr_b32 s36, s2, 4
    s_mul_i32 s36, s36, 7
    s_min_u32 s37, s28, 6
    s_add_u32 s36, s36, s37
    s_lshl_b32 s36, s36, 11
    s_add_u32 s36, s36, 58720256
    v_and_b32 v11, 15, v1
    v_lshlrev_b32 v11, 4, v11
    v_lshrrev_b32 v12, 4, v1
    v_lshl_add_u32 v11, v12, 9, v11
    buffer_load_dwordx4 v[96:99], v11, s[24:27], s36 offen offset:0 sc1
    buffer_load_dwordx4 v[100:103], v11, s[24:27], s36 offen offset:256 sc1
    s_waitcnt lgkmcnt(0)
    s_barrier
    ds_read_b128 v[114:117], v112
    ds_read_b32 v110, v111
    ds_read_b32 v109, v108
    ds_read_b128 v[64:67], v106 offset:0
    ds_read_b128 v[68:71], v106 offset:1024
    ds_read_b128 v[72:75], v106 offset:2048
    ds_read_b128 v[76:79], v106 offset:3072
    ds_read_b128 v[80:83], v106 offset:4096
    ds_read_b128 v[84:87], v106 offset:5120
    ds_read_b128 v[88:91], v106 offset:6144
    ds_read_b128 v[92:95], v106 offset:7168
    s_waitcnt lgkmcnt(8)
    v_add_f32 v109, v109, v32
    v_cmp_ne_u32 s[52:53], 0, v110
    v_readfirstlane_b32 s56, v114
    v_readfirstlane_b32 s57, v115
    v_readfirstlane_b32 s58, v116
    v_readfirstlane_b32 s59, v117
    v_rcp_f32 v109, v109
    s_nop 0
    v_mov_b32 v108, v109
    s_waitcnt lgkmcnt(6)
    v_pk_add_f32 v[224:225], v[224:225], v[64:65]
    v_pk_add_f32 v[226:227], v[226:227], v[66:67]
    v_pk_add_f32 v[228:229], v[228:229], v[68:69]
    v_pk_add_f32 v[230:231], v[230:231], v[70:71]
    v_pk_mul_f32 v[224:225], v[224:225], v[108:109]
    v_pk_mul_f32 v[226:227], v[226:227], v[108:109]
    v_pk_mul_f32 v[228:229], v[228:229], v[108:109]
    v_pk_mul_f32 v[230:231], v[230:231], v[108:109]
    v_cvt_pk_bf16_f32 v48, v224, v225
    v_cvt_pk_bf16_f32 v49, v226, v227
    v_cvt_pk_bf16_f32 v50, v228, v229
    v_cvt_pk_bf16_f32 v51, v230, v231
    buffer_store_dwordx4 v[48:51], v7, s[16:19], s38 offen offset:0 sc1
    s_waitcnt lgkmcnt(4)
    v_pk_add_f32 v[232:233], v[232:233], v[72:73]
    v_pk_add_f32 v[234:235], v[234:235], v[74:75]
    v_pk_add_f32 v[236:237], v[236:237], v[76:77]
    v_pk_add_f32 v[238:239], v[238:239], v[78:79]
    v_pk_mul_f32 v[232:233], v[232:233], v[108:109]
    v_pk_mul_f32 v[234:235], v[234:235], v[108:109]
    v_pk_mul_f32 v[236:237], v[236:237], v[108:109]
    v_pk_mul_f32 v[238:239], v[238:239], v[108:109]
    v_cvt_pk_bf16_f32 v52, v232, v233
    v_cvt_pk_bf16_f32 v53, v234, v235
    v_cvt_pk_bf16_f32 v54, v236, v237
    v_cvt_pk_bf16_f32 v55, v238, v239
    buffer_store_dwordx4 v[52:55], v7, s[16:19], s38 offen offset:1024 sc1
    s_waitcnt lgkmcnt(2)
    v_pk_add_f32 v[240:241], v[240:241], v[80:81]
    v_pk_add_f32 v[242:243], v[242:243], v[82:83]
    v_pk_add_f32 v[244:245], v[244:245], v[84:85]
    v_pk_add_f32 v[246:247], v[246:247], v[86:87]
    v_pk_mul_f32 v[240:241], v[240:241], v[108:109]
    v_pk_mul_f32 v[242:243], v[242:243], v[108:109]
    v_pk_mul_f32 v[244:245], v[244:245], v[108:109]
    v_pk_mul_f32 v[246:247], v[246:247], v[108:109]
    v_cvt_pk_bf16_f32 v56, v240, v241
    v_cvt_pk_bf16_f32 v57, v242, v243
    v_cvt_pk_bf16_f32 v58, v244, v245
    v_cvt_pk_bf16_f32 v59, v246, v247
    buffer_store_dwordx4 v[56:59], v7, s[16:19], s38 offen offset:2048 sc1
    s_waitcnt lgkmcnt(0)
    v_pk_add_f32 v[248:249], v[248:249], v[88:89]
    v_pk_add_f32 v[250:251], v[250:251], v[90:91]
    v_pk_add_f32 v[252:253], v[252:253], v[92:93]
    v_pk_add_f32 v[254:255], v[254:255], v[94:95]
    v_pk_mul_f32 v[248:249], v[248:249], v[108:109]
    v_pk_mul_f32 v[250:251], v[250:251], v[108:109]
    v_pk_mul_f32 v[252:253], v[252:253], v[108:109]
    v_pk_mul_f32 v[254:255], v[254:255], v[108:109]
    v_cvt_pk_bf16_f32 v60, v248, v249
    v_cvt_pk_bf16_f32 v61, v250, v251
    v_cvt_pk_bf16_f32 v62, v252, v253
    v_cvt_pk_bf16_f32 v63, v254, v255
    buffer_store_dwordx4 v[60:63], v7, s[16:19], s38 offen offset:3072 sc1
    s_cmp_eq_u64 s[52:53], 0
    s_cbranch_scc1 L_p3_done
    s_waitcnt vmcnt(0)
    v_mov_b32 v112, v96
    v_mov_b32 v113, v97
    v_mov_b32 v114, v98
    v_mov_b32 v115, v99
    v_mov_b32 v116, v100
    v_mov_b32 v117, v101
    v_mov_b32 v118, v102
    v_mov_b32 v119, v103
    v_swap_b32 v128, v160
    v_swap_b32 v129, v161
    v_swap_b32 v130, v162
    v_swap_b32 v131, v163
    v_swap_b32 v132, v164
    v_swap_b32 v133, v165
    v_swap_b32 v134, v166
    v_swap_b32 v135, v167
    v_swap_b32 v136, v168
    v_swap_b32 v137, v169
    v_swap_b32 v138, v170
    v_swap_b32 v139, v171
    v_swap_b32 v140, v172
    v_swap_b32 v141, v173
    v_swap_b32 v142, v174
    v_swap_b32 v143, v175
    v_swap_b32 v144, v176
    v_swap_b32 v145, v177
    v_swap_b32 v146, v178
    v_swap_b32 v147, v179
    v_swap_b32 v148, v180
    v_swap_b32 v149, v181
    v_swap_b32 v150, v182
    v_swap_b32 v151, v183
    v_swap_b32 v152, v184
    v_swap_b32 v153, v185
    v_swap_b32 v154, v186
    v_swap_b32 v155, v187
    v_swap_b32 v156, v188
    v_swap_b32 v157, v189
    v_swap_b32 v158, v190
    v_swap_b32 v159, v191
    v_mov_b32 v192, 0
    v_mov_b32 v193, 0
    v_mov_b32 v194, 0
    v_mov_b32 v195, 0
    v_mov_b32 v196, 0
    v_mov_b32 v197, 0
    v_mov_b32 v198, 0
    v_mov_b32 v199, 0
    v_mov_b32 v200, 0
    v_mov_b32 v201, 0
    v_mov_b32 v202, 0
    v_mov_b32 v203, 0
    v_mov_b32 v204, 0
    v_mov_b32 v205, 0
    v_mov_b32 v206, 0
    v_mov_b32 v207, 0
    v_mov_b32 v208, 0
    v_mov_b32 v209, 0
    v_mov_b32 v210, 0
    v_mov_b32 v211, 0
    v_mov_b32 v212, 0
    v_mov_b32 v213, 0
    v_mov_b32 v214, 0
    v_mov_b32 v215, 0
    v_mov_b32 v216, 0
    v_mov_b32 v217, 0
    v_mov_b32 v218, 0
    v_mov_b32 v219, 0
    v_mov_b32 v220, 0
    v_mov_b32 v221, 0
    v_mov_b32 v222, 0
    v_mov_b32 v223, 0
    v_mov_b32 v224, 0
    v_mov_b32 v225, 0
    v_mov_b32 v226, 0
    v_mov_b32 v227, 0
    v_mov_b32 v228, 0
    v_mov_b32 v229, 0
    v_mov_b32 v230, 0
    v_mov_b32 v231, 0
    v_mov_b32 v232, 0
    v_mov_b32 v233, 0
    v_mov_b32 v234, 0
    v_mov_b32 v235, 0
    v_mov_b32 v236, 0
    v_mov_b32 v237, 0
    v_mov_b32 v238, 0
    v_mov_b32 v239, 0
    v_mov_b32 v240, 0
    v_mov_b32 v241, 0
    v_mov_b32 v242, 0
    v_mov_b32 v243, 0
    v_mov_b32 v244, 0
    v_mov_b32 v245, 0
    v_mov_b32 v246, 0
    v_mov_b32 v247, 0
    v_mov_b32 v248, 0
    v_mov_b32 v249, 0
    v_mov_b32 v250, 0
    v_mov_b32 v251, 0
    v_mov_b32 v252, 0
    v_mov_b32 v253, 0
    v_mov_b32 v254, 0
    v_mov_b32 v255, 0
    v_mov_b32 v28, 0
    v_mov_b32 v40, 4048155338
    v_mov_b32 v32, 0
    v_mov_b32 v41, 4048155338
    s_lshl_b32 s43, s28, 12
    v_add_u32 v4, s43, v7
    s_mov_b32 s46, s45
    s_sub_u32 s40, 16, s30
    s_mov_b32 s39, s30
    s_lshl_b32 s37, s39, 7
    s_and_b32 s36, s28, 3
    s_lshl_b32 s36, s36, 5
    s_add_u32 s36, s36, s37
    s_sub_u32 s50, 0, s36
L_recurrent_scan__compressed_kv_cla__moe_arch_mod__prompt_kernel_stile_138:
    s_waitcnt vmcnt(0) lgkmcnt(0)
    s_barrier
    s_mov_b32 m0, s43
    s_add_u32 s47, s46, 32768
    buffer_load_dwordx4 v4, s[12:15], s46 offen offset:0 sc1 lds
    buffer_load_dwordx4 v4, s[12:15], s46 offen offset:1024 sc1 lds
    buffer_load_dwordx4 v4, s[12:15], s46 offen offset:2048 sc1 lds
    buffer_load_dwordx4 v4, s[12:15], s46 offen offset:3072 sc1 lds
    s_add_u32 m0, s43, 32768
    s_add_u32 s46, s46, 65536
    buffer_load_dwordx4 v4, s[12:15], s47 offen offset:0 sc1 lds
    buffer_load_dwordx4 v4, s[12:15], s47 offen offset:1024 sc1 lds
    buffer_load_dwordx4 v4, s[12:15], s47 offen offset:2048 sc1 lds
    buffer_load_dwordx4 v4, s[12:15], s47 offen offset:3072 sc1 lds
    v_mov_b32 v2, v7
    s_mov_b32 s41, 4
    s_waitcnt vmcnt(0)
    s_barrier
L_recurrent_scan__compressed_kv_cla__moe_arch_mod__prompt_kernel_sunit_139:
    s_cmp_gt_i32 s50, 0
    s_cbranch_scc1 L_recurrent_scan__compressed_kv_cla__moe_arch_mod__prompt_kernel_snext_140
    ds_read_b128 v[64:67], v2 offset:0
    ds_read_b128 v[68:71], v2 offset:1024
    ds_read_b128 v[72:75], v2 offset:2048
    ds_read_b128 v[76:79], v2 offset:3072
    ds_read_b128 v[80:83], v2 offset:4096
    ds_read_b128 v[84:87], v2 offset:5120
    ds_read_b128 v[88:91], v2 offset:6144
    ds_read_b128 v[92:95], v2 offset:7168
    s_waitcnt lgkmcnt(0)
    v_mfma_f32_16x16x32_bf16 v[96:99], v[64:67], v[128:131], 0
    v_mfma_f32_16x16x32_bf16 v[104:107], v[64:67], v[144:147], 0
    v_mfma_f32_16x16x32_bf16 v[96:99], v[68:71], v[132:135], v[96:99]
    v_mfma_f32_16x16x32_bf16 v[104:107], v[68:71], v[148:151], v[104:107]
    v_mfma_f32_16x16x32_bf16 v[96:99], v[72:75], v[136:139], v[96:99]
    v_mfma_f32_16x16x32_bf16 v[104:107], v[72:75], v[152:155], v[104:107]
    v_mfma_f32_16x16x32_bf16 v[96:99], v[76:79], v[140:143], v[96:99]
    v_mfma_f32_16x16x32_bf16 v[104:107], v[76:79], v[156:159], v[104:107]
    v_mfma_f32_16x16x32_bf16 v[100:103], v[80:83], v[128:131], 0
    v_mfma_f32_16x16x32_bf16 v[108:111], v[80:83], v[144:147], 0
    v_mfma_f32_16x16x32_bf16 v[100:103], v[84:87], v[132:135], v[100:103]
    v_mfma_f32_16x16x32_bf16 v[108:111], v[84:87], v[148:151], v[108:111]
    v_mfma_f32_16x16x32_bf16 v[100:103], v[88:91], v[136:139], v[100:103]
    v_mfma_f32_16x16x32_bf16 v[108:111], v[88:91], v[152:155], v[108:111]
    v_mfma_f32_16x16x32_bf16 v[100:103], v[92:95], v[140:143], v[100:103]
    v_mfma_f32_16x16x32_bf16 v[108:111], v[92:95], v[156:159], v[108:111]
    ds_read_b128 v[64:67], v2 offset:32768
    ds_read_b128 v[68:71], v2 offset:33792
    ds_read_b128 v[72:75], v2 offset:34816
    ds_read_b128 v[76:79], v2 offset:35840
    ds_read_b128 v[80:83], v2 offset:36864
    ds_read_b128 v[84:87], v2 offset:37888
    ds_read_b128 v[88:91], v2 offset:38912
    ds_read_b128 v[92:95], v2 offset:39936
    s_nop 1
    s_cmp_lt_i32 s50, 0
    s_cbranch_scc0 L_recurrent_scan__compressed_kv_cla__moe_arch_mod__prompt_kernel_rare_141
L_recurrent_scan__compressed_kv_cla__moe_arch_mod__prompt_kernel_back_142:
    v_max3_f32 v22, v96, v97, v98
    v_max3_f32 v22, v22, v99, v100
    v_max3_f32 v22, v22, v101, v102
    v_max3_f32 v22, v22, v103, v40
    v_mov_b32 v24, v22
    s_nop 1
    v_permlane16_swap_b32 v22, v24
    s_nop 1
    v_max_f32 v22, v22, v24
    v_mov_b32 v24, v22
    s_nop 1
    v_permlane32_swap_b32 v22, v24
    s_nop 1
    v_max_f32 v22, v22, v24
    v_sub_f32 v25, v40, v22
    v_exp_f32 v25, v25
    v_mov_b32 v40, v22
    v_mul_f32 v28, v28, v25
    v_mul_f32 v192, v192, v25
    v_mul_f32 v193, v193, v25
    v_mul_f32 v194, v194, v25
    v_mul_f32 v195, v195, v25
    v_mul_f32 v196, v196, v25
    v_mul_f32 v197, v197, v25
    v_mul_f32 v198, v198, v25
    v_mul_f32 v199, v199, v25
    v_mul_f32 v200, v200, v25
    v_mul_f32 v201, v201, v25
    v_mul_f32 v202, v202, v25
    v_mul_f32 v203, v203, v25
    v_mul_f32 v204, v204, v25
    v_mul_f32 v205, v205, v25
    v_mul_f32 v206, v206, v25
    v_mul_f32 v207, v207, v25
    v_mul_f32 v208, v208, v25
    v_mul_f32 v209, v209, v25
    v_mul_f32 v210, v210, v25
    v_mul_f32 v211, v211, v25
    v_mul_f32 v212, v212, v25
    v_mul_f32 v213, v213, v25
    v_mul_f32 v214, v214, v25
    v_mul_f32 v215, v215, v25
    v_mul_f32 v216, v216, v25
    v_mul_f32 v217, v217, v25
    v_mul_f32 v218, v218, v25
    v_mul_f32 v219, v219, v25
    v_mul_f32 v220, v220, v25
    v_mul_f32 v221, v221, v25
    v_mul_f32 v222, v222, v25
    v_mul_f32 v223, v223, v25
    v_sub_f32 v96, v96, v22
    v_sub_f32 v97, v97, v22
    v_sub_f32 v98, v98, v22
    v_sub_f32 v99, v99, v22
    v_sub_f32 v100, v100, v22
    v_sub_f32 v101, v101, v22
    v_sub_f32 v102, v102, v22
    v_sub_f32 v103, v103, v22
    v_max3_f32 v23, v104, v105, v106
    v_max3_f32 v23, v23, v107, v108
    v_max3_f32 v23, v23, v109, v110
    v_max3_f32 v23, v23, v111, v41
    v_mov_b32 v24, v23
    s_nop 1
    v_permlane16_swap_b32 v23, v24
    s_nop 1
    v_max_f32 v23, v23, v24
    v_mov_b32 v24, v23
    s_nop 1
    v_permlane32_swap_b32 v23, v24
    s_nop 1
    v_max_f32 v23, v23, v24
    v_sub_f32 v25, v41, v23
    v_exp_f32 v25, v25
    v_mov_b32 v41, v23
    v_mul_f32 v32, v32, v25
    v_mul_f32 v224, v224, v25
    v_mul_f32 v225, v225, v25
    v_mul_f32 v226, v226, v25
    v_mul_f32 v227, v227, v25
    v_mul_f32 v228, v228, v25
    v_mul_f32 v229, v229, v25
    v_mul_f32 v230, v230, v25
    v_mul_f32 v231, v231, v25
    v_mul_f32 v232, v232, v25
    v_mul_f32 v233, v233, v25
    v_mul_f32 v234, v234, v25
    v_mul_f32 v235, v235, v25
    v_mul_f32 v236, v236, v25
    v_mul_f32 v237, v237, v25
    v_mul_f32 v238, v238, v25
    v_mul_f32 v239, v239, v25
    v_mul_f32 v240, v240, v25
    v_mul_f32 v241, v241, v25
    v_mul_f32 v242, v242, v25
    v_mul_f32 v243, v243, v25
    v_mul_f32 v244, v244, v25
    v_mul_f32 v245, v245, v25
    v_mul_f32 v246, v246, v25
    v_mul_f32 v247, v247, v25
    v_mul_f32 v248, v248, v25
    v_mul_f32 v249, v249, v25
    v_mul_f32 v250, v250, v25
    v_mul_f32 v251, v251, v25
    v_mul_f32 v252, v252, v25
    v_mul_f32 v253, v253, v25
    v_mul_f32 v254, v254, v25
    v_mul_f32 v255, v255, v25
    v_sub_f32 v104, v104, v23
    v_sub_f32 v105, v105, v23
    v_sub_f32 v106, v106, v23
    v_sub_f32 v107, v107, v23
    v_sub_f32 v108, v108, v23
    v_sub_f32 v109, v109, v23
    v_sub_f32 v110, v110, v23
    v_sub_f32 v111, v111, v23
    v_exp_f32 v96, v96
    v_exp_f32 v97, v97
    v_exp_f32 v98, v98
    v_exp_f32 v99, v99
    v_exp_f32 v104, v104
    v_exp_f32 v105, v105
    v_exp_f32 v106, v106
    v_exp_f32 v107, v107
    v_exp_f32 v100, v100
    v_exp_f32 v101, v101
    v_exp_f32 v102, v102
    v_exp_f32 v103, v103
    v_exp_f32 v108, v108
    v_exp_f32 v109, v109
    v_exp_f32 v110, v110
    v_exp_f32 v111, v111
    v_add_f32 v28, v28, v96
    v_add_f32 v28, v28, v97
    v_cvt_pk_bf16_f32 v48, v96, v97
    v_add_f32 v28, v28, v98
    v_add_f32 v28, v28, v99
    v_cvt_pk_bf16_f32 v49, v98, v99
    v_add_f32 v32, v32, v104
    v_add_f32 v32, v32, v105
    v_cvt_pk_bf16_f32 v52, v104, v105
    v_add_f32 v32, v32, v106
    v_add_f32 v32, v32, v107
    v_cvt_pk_bf16_f32 v53, v106, v107
    v_add_f32 v28, v28, v100
    v_add_f32 v28, v28, v101
    v_cvt_pk_bf16_f32 v50, v100, v101
    v_add_f32 v28, v28, v102
    v_add_f32 v28, v28, v103
    v_cvt_pk_bf16_f32 v51, v102, v103
    v_add_f32 v32, v32, v108
    v_add_f32 v32, v32, v109
    v_cvt_pk_bf16_f32 v54, v108, v109
    v_add_f32 v32, v32, v110
    v_add_f32 v32, v32, v111
    v_cvt_pk_bf16_f32 v55, v110, v111
    s_waitcnt lgkmcnt(0)
    s_nop 0
    v_mfma_f32_16x16x32_bf16 v[192:195], v[64:67], v[48:51], v[192:195]
    v_mfma_f32_16x16x32_bf16 v[224:227], v[64:67], v[52:55], v[224:227]
    v_mfma_f32_16x16x32_bf16 v[196:199], v[68:71], v[48:51], v[196:199]
    v_mfma_f32_16x16x32_bf16 v[228:231], v[68:71], v[52:55], v[228:231]
    v_mfma_f32_16x16x32_bf16 v[200:203], v[72:75], v[48:51], v[200:203]
    v_mfma_f32_16x16x32_bf16 v[232:235], v[72:75], v[52:55], v[232:235]
    v_mfma_f32_16x16x32_bf16 v[204:207], v[76:79], v[48:51], v[204:207]
    v_mfma_f32_16x16x32_bf16 v[236:239], v[76:79], v[52:55], v[236:239]
    v_mfma_f32_16x16x32_bf16 v[208:211], v[80:83], v[48:51], v[208:211]
    v_mfma_f32_16x16x32_bf16 v[240:243], v[80:83], v[52:55], v[240:243]
    v_mfma_f32_16x16x32_bf16 v[212:215], v[84:87], v[48:51], v[212:215]
    v_mfma_f32_16x16x32_bf16 v[244:247], v[84:87], v[52:55], v[244:247]
    v_mfma_f32_16x16x32_bf16 v[216:219], v[88:91], v[48:51], v[216:219]
    v_mfma_f32_16x16x32_bf16 v[248:251], v[88:91], v[52:55], v[248:251]
    v_mfma_f32_16x16x32_bf16 v[220:223], v[92:95], v[48:51], v[220:223]
    v_mfma_f32_16x16x32_bf16 v[252:255], v[92:95], v[52:55], v[252:255]
L_recurrent_scan__compressed_kv_cla__moe_arch_mod__prompt_kernel_snext_140:
    v_add_u32 v2, 8192, v2
    s_add_u32 s50, s50, 32
    s_sub_u32 s41, s41, 1
    s_cmp_lg_u32 s41, 0
    s_cbranch_scc1 L_recurrent_scan__compressed_kv_cla__moe_arch_mod__prompt_kernel_sunit_139
    s_sub_u32 s40, s40, 1
    s_cmp_lg_u32 s40, 0
    s_cbranch_scc1 L_recurrent_scan__compressed_kv_cla__moe_arch_mod__prompt_kernel_stile_138
    v_mov_b32 v20, v28
    s_nop 1
    v_permlane16_swap_b32 v28, v20
    s_nop 1
    v_add_f32 v28, v28, v20
    v_mov_b32 v20, v28
    s_nop 1
    v_permlane32_swap_b32 v28, v20
    s_nop 1
    v_add_f32 v28, v28, v20
    v_mov_b32 v20, v32
    s_nop 1
    v_permlane16_swap_b32 v32, v20
    s_nop 1
    v_add_f32 v32, v32, v20
    v_mov_b32 v20, v32
    s_nop 1
    v_permlane32_swap_b32 v32, v20
    s_nop 1
    v_add_f32 v32, v32, v20
    s_mov_b32 s36, 0x5d800000
    v_cmp_nge_f32 vcc, s36, v28
    s_nop 0
    s_or_b64 s[52:53], s[52:53], vcc
    v_cmp_nge_f32 vcc, s36, v32
    s_nop 0
    s_or_b64 s[52:53], s[52:53], vcc
    v_rcp_f32 v20, v28
    v_rcp_f32 v22, v32
    s_lshl_b32 s38, s39, 3
    s_and_b32 s37, s28, 3
    s_lshl_b32 s37, s37, 1
    s_add_u32 s38, s38, s37
    s_lshl_b32 s38, s38, 17
    s_lshl_b32 s37, s29, 12
    s_add_u32 s38, s38, s37
    v_mov_b32 v21, v20
    v_mov_b32 v23, v22
    v_pk_mul_f32 v[192:193], v[192:193], v[20:21]
    v_pk_mul_f32 v[194:195], v[194:195], v[20:21]
    v_pk_mul_f32 v[196:197], v[196:197], v[20:21]
    v_pk_mul_f32 v[198:199], v[198:199], v[20:21]
    v_cvt_pk_bf16_f32 v192, v192, v193
    v_cvt_pk_bf16_f32 v193, v194, v195
    v_cvt_pk_bf16_f32 v194, v196, v197
    v_cvt_pk_bf16_f32 v195, v198, v199
    buffer_store_dwordx4 v[192:195], v7, s[16:19], s38 offen offset:0 sc1
    v_pk_mul_f32 v[200:201], v[200:201], v[20:21]
    v_pk_mul_f32 v[202:203], v[202:203], v[20:21]
    v_pk_mul_f32 v[204:205], v[204:205], v[20:21]
    v_pk_mul_f32 v[206:207], v[206:207], v[20:21]
    v_cvt_pk_bf16_f32 v200, v200, v201
    v_cvt_pk_bf16_f32 v201, v202, v203
    v_cvt_pk_bf16_f32 v202, v204, v205
    v_cvt_pk_bf16_f32 v203, v206, v207
    buffer_store_dwordx4 v[200:203], v7, s[16:19], s38 offen offset:1024 sc1
    v_pk_mul_f32 v[208:209], v[208:209], v[20:21]
    v_pk_mul_f32 v[210:211], v[210:211], v[20:21]
    v_pk_mul_f32 v[212:213], v[212:213], v[20:21]
    v_pk_mul_f32 v[214:215], v[214:215], v[20:21]
    v_cvt_pk_bf16_f32 v208, v208, v209
    v_cvt_pk_bf16_f32 v209, v210, v211
    v_cvt_pk_bf16_f32 v210, v212, v213
    v_cvt_pk_bf16_f32 v211, v214, v215
    buffer_store_dwordx4 v[208:211], v7, s[16:19], s38 offen offset:2048 sc1
    v_pk_mul_f32 v[216:217], v[216:217], v[20:21]
    v_pk_mul_f32 v[218:219], v[218:219], v[20:21]
    v_pk_mul_f32 v[220:221], v[220:221], v[20:21]
    v_pk_mul_f32 v[222:223], v[222:223], v[20:21]
    v_cvt_pk_bf16_f32 v216, v216, v217
    v_cvt_pk_bf16_f32 v217, v218, v219
    v_cvt_pk_bf16_f32 v218, v220, v221
    v_cvt_pk_bf16_f32 v219, v222, v223
    buffer_store_dwordx4 v[216:219], v7, s[16:19], s38 offen offset:3072 sc1
    s_add_u32 s38, s38, 131072
    v_pk_mul_f32 v[224:225], v[224:225], v[22:23]
    v_pk_mul_f32 v[226:227], v[226:227], v[22:23]
    v_pk_mul_f32 v[228:229], v[228:229], v[22:23]
    v_pk_mul_f32 v[230:231], v[230:231], v[22:23]
    v_cvt_pk_bf16_f32 v224, v224, v225
    v_cvt_pk_bf16_f32 v225, v226, v227
    v_cvt_pk_bf16_f32 v226, v228, v229
    v_cvt_pk_bf16_f32 v227, v230, v231
    buffer_store_dwordx4 v[224:227], v7, s[16:19], s38 offen offset:0 sc1
    v_pk_mul_f32 v[232:233], v[232:233], v[22:23]
    v_pk_mul_f32 v[234:235], v[234:235], v[22:23]
    v_pk_mul_f32 v[236:237], v[236:237], v[22:23]
    v_pk_mul_f32 v[238:239], v[238:239], v[22:23]
    v_cvt_pk_bf16_f32 v232, v232, v233
    v_cvt_pk_bf16_f32 v233, v234, v235
    v_cvt_pk_bf16_f32 v234, v236, v237
    v_cvt_pk_bf16_f32 v235, v238, v239
    buffer_store_dwordx4 v[232:235], v7, s[16:19], s38 offen offset:1024 sc1
    v_pk_mul_f32 v[240:241], v[240:241], v[22:23]
    v_pk_mul_f32 v[242:243], v[242:243], v[22:23]
    v_pk_mul_f32 v[244:245], v[244:245], v[22:23]
    v_pk_mul_f32 v[246:247], v[246:247], v[22:23]
    v_cvt_pk_bf16_f32 v240, v240, v241
    v_cvt_pk_bf16_f32 v241, v242, v243
    v_cvt_pk_bf16_f32 v242, v244, v245
    v_cvt_pk_bf16_f32 v243, v246, v247
    buffer_store_dwordx4 v[240:243], v7, s[16:19], s38 offen offset:2048 sc1
    v_pk_mul_f32 v[248:249], v[248:249], v[22:23]
    v_pk_mul_f32 v[250:251], v[250:251], v[22:23]
    v_pk_mul_f32 v[252:253], v[252:253], v[22:23]
    v_pk_mul_f32 v[254:255], v[254:255], v[22:23]
    v_cvt_pk_bf16_f32 v248, v248, v249
    v_cvt_pk_bf16_f32 v249, v250, v251
    v_cvt_pk_bf16_f32 v250, v252, v253
    v_cvt_pk_bf16_f32 v251, v254, v255
    buffer_store_dwordx4 v[248:251], v7, s[16:19], s38 offen offset:3072 sc1
    v_mov_b32 v96, v112
    v_mov_b32 v97, v113
    v_mov_b32 v98, v114
    v_mov_b32 v99, v115
    v_mov_b32 v100, v116
    v_mov_b32 v101, v117
    v_mov_b32 v102, v118
    v_mov_b32 v103, v119
    s_branch L_p3_done
L_recurrent_scan__compressed_kv_cla__moe_arch_mod__prompt_kernel_rare_109:
    s_lshl_b32 s36, s29, 7
    s_cmp_eq_u32 s30, 0
    s_cselect_b32 s37, 4, 0
    s_add_u32 s36, s36, s37
    v_mov_b32 v20, s36
    v_mov_b32 v21, 1
    s_mov_b64 exec, 1
    global_atomic_add v20, v21, s[90:91]
    s_mov_b64 exec, -1
    s_nop 3
    s_branch L_recurrent_scan__compressed_kv_cla__moe_arch_mod__prompt_kernel_back_110
L_recurrent_scan__compressed_kv_cla__moe_arch_mod__prompt_kernel_rare_112:
    s_cmp_lt_i32 s36, 0
    s_cbranch_scc1 L_recurrent_scan__compressed_kv_cla__moe_arch_mod__prompt_kernel_nm_111
    v_mov_b32 v20, 4048155338
    v_subrev_u32 v21, s36, v18
    v_cmp_gt_i32 s[20:21], 0, v21
    v_cmp_gt_i32 s[22:23], 1, v21
    v_cmp_gt_i32 s[62:63], 2, v21
    v_cmp_gt_i32 vcc, 3, v21
    v_cndmask_b32 v96, v96, v20, s[20:21]
    v_cndmask_b32 v97, v97, v20, s[22:23]
    v_cndmask_b32 v98, v98, v20, s[62:63]
    v_cndmask_b32 v99, v99, v20, vcc
    v_cmp_gt_i32 s[20:21], 16, v21
    v_cmp_gt_i32 s[22:23], 17, v21
    v_cmp_gt_i32 s[62:63], 18, v21
    v_cmp_gt_i32 vcc, 19, v21
    v_cndmask_b32 v100, v100, v20, s[20:21]
    v_cndmask_b32 v101, v101, v20, s[22:23]
    v_cndmask_b32 v102, v102, v20, s[62:63]
    v_cndmask_b32 v103, v103, v20, vcc
    v_cmp_gt_i32 s[20:21], -16, v21
    v_cmp_gt_i32 s[22:23], -15, v21
    v_cmp_gt_i32 s[62:63], -14, v21
    v_cmp_gt_i32 vcc, -13, v21
    v_cndmask_b32 v104, v104, v20, s[20:21]
    v_cndmask_b32 v105, v105, v20, s[22:23]
    v_cndmask_b32 v106, v106, v20, s[62:63]
    v_cndmask_b32 v107, v107, v20, vcc
    v_cmp_gt_i32 s[20:21], 0, v21
    v_cmp_gt_i32 s[22:23], 1, v21
    v_cmp_gt_i32 s[62:63], 2, v21
    v_cmp_gt_i32 vcc, 3, v21
    v_cndmask_b32 v108, v108, v20, s[20:21]
    v_cndmask_b32 v109, v109, v20, s[22:23]
    v_cndmask_b32 v110, v110, v20, s[62:63]
    v_cndmask_b32 v111, v111, v20, vcc
L_recurrent_scan__compressed_kv_cla__moe_arch_mod__prompt_kernel_nm_111:
    s_branch L_recurrent_scan__compressed_kv_cla__moe_arch_mod__prompt_kernel_back_113
L_recurrent_scan__compressed_kv_cla__moe_arch_mod__prompt_kernel_rare_119:
    s_add_u32 s36, s40, 1
    s_sub_u32 s36, s36, s51
    s_cmp_lt_u32 s36, 2
    s_cbranch_scc0 L_recurrent_scan__compressed_kv_cla__moe_arch_mod__prompt_kernel_r_115
    s_lshl_b32 s36, s36, 6
    s_add_u32 s36, s36, 32
    s_sub_u32 s36, s36, s50
    s_cmp_lt_i32 s36, 0
    s_cbranch_scc1 L_recurrent_scan__compressed_kv_cla__moe_arch_mod__prompt_kernel_nm_118
    v_mov_b32 v20, 4048155338
    v_subrev_u32 v21, s36, v18
    v_cmp_gt_i32 s[20:21], 0, v21
    v_cmp_gt_i32 s[22:23], 1, v21
    v_cmp_gt_i32 s[62:63], 2, v21
    v_cmp_gt_i32 vcc, 3, v21
    v_cndmask_b32 v112, v112, v20, s[20:21]
    v_cndmask_b32 v113, v113, v20, s[22:23]
    v_cndmask_b32 v114, v114, v20, s[62:63]
    v_cndmask_b32 v115, v115, v20, vcc
    v_cmp_gt_i32 s[20:21], 16, v21
    v_cmp_gt_i32 s[22:23], 17, v21
    v_cmp_gt_i32 s[62:63], 18, v21
    v_cmp_gt_i32 vcc, 19, v21
    v_cndmask_b32 v116, v116, v20, s[20:21]
    v_cndmask_b32 v117, v117, v20, s[22:23]
    v_cndmask_b32 v118, v118, v20, s[62:63]
    v_cndmask_b32 v119, v119, v20, vcc
    v_cmp_gt_i32 s[20:21], -16, v21
    v_cmp_gt_i32 s[22:23], -15, v21
    v_cmp_gt_i32 s[62:63], -14, v21
    v_cmp_gt_i32 vcc, -13, v21
    v_cndmask_b32 v120, v120, v20, s[20:21]
    v_cndmask_b32 v121, v121, v20, s[22:23]
    v_cndmask_b32 v122, v122, v20, s[62:63]
    v_cndmask_b32 v123, v123, v20, vcc
    v_cmp_gt_i32 s[20:21], 0, v21
    v_cmp_gt_i32 s[22:23], 1, v21
    v_cmp_gt_i32 s[62:63], 2, v21
    v_cmp_gt_i32 vcc, 3, v21
    v_cndmask_b32 v124, v124, v20, s[20:21]
    v_cndmask_b32 v125, v125, v20, s[22:23]
    v_cndmask_b32 v126, v126, v20, s[62:63]
    v_cndmask_b32 v127, v127, v20, vcc
L_recurrent_scan__compressed_kv_cla__moe_arch_mod__prompt_kernel_nm_118:
L_recurrent_scan__compressed_kv_cla__moe_arch_mod__prompt_kernel_r_115:
    s_branch L_recurrent_scan__compressed_kv_cla__moe_arch_mod__prompt_kernel_back_120
L_recurrent_scan__compressed_kv_cla__moe_arch_mod__prompt_kernel_rare_122:
    s_add_u32 s36, s40, 2
    s_sub_u32 s36, s36, s51
    s_cmp_eq_u32 s36, 1
    s_cselect_b32 s41, 0x8000, s41
    s_cmp_eq_u32 s40, 15
    s_cbranch_scc0 L_recurrent_scan__compressed_kv_cla__moe_arch_mod__prompt_kernel_r_116
    s_mov_b32 s41, 65536
    s_mov_b32 s49, 0x1ffff
    s_mov_b32 s36, 1
L_recurrent_scan__compressed_kv_cla__moe_arch_mod__prompt_kernel_r_116:
    s_cmp_lt_u32 s36, 2
    s_cbranch_scc0 L_recurrent_scan__compressed_kv_cla__moe_arch_mod__prompt_kernel_r_117
    s_lshl_b32 s36, s36, 6
    s_sub_u32 s36, s36, s50
    s_cmp_lt_i32 s36, 0
    s_cbranch_scc1 L_recurrent_scan__compressed_kv_cla__moe_arch_mod__prompt_kernel_nm_121
    v_mov_b32 v20, 4048155338
    v_subrev_u32 v21, s36, v18
    v_cmp_gt_i32 s[20:21], 0, v21
    v_cmp_gt_i32 s[22:23], 1, v21
    v_cmp_gt_i32 s[62:63], 2, v21
    v_cmp_gt_i32 vcc, 3, v21
    v_cndmask_b32 v96, v96, v20, s[20:21]
    v_cndmask_b32 v97, v97, v20, s[22:23]
    v_cndmask_b32 v98, v98, v20, s[62:63]
    v_cndmask_b32 v99, v99, v20, vcc
    v_cmp_gt_i32 s[20:21], 16, v21
    v_cmp_gt_i32 s[22:23], 17, v21
    v_cmp_gt_i32 s[62:63], 18, v21
    v_cmp_gt_i32 vcc, 19, v21
    v_cndmask_b32 v100, v100, v20, s[20:21]
    v_cndmask_b32 v101, v101, v20, s[22:23]
    v_cndmask_b32 v102, v102, v20, s[62:63]
    v_cndmask_b32 v103, v103, v20, vcc
    v_cmp_gt_i32 s[20:21], -16, v21
    v_cmp_gt_i32 s[22:23], -15, v21
    v_cmp_gt_i32 s[62:63], -14, v21
    v_cmp_gt_i32 vcc, -13, v21
    v_cndmask_b32 v104, v104, v20, s[20:21]
    v_cndmask_b32 v105, v105, v20, s[22:23]
    v_cndmask_b32 v106, v106, v20, s[62:63]
    v_cndmask_b32 v107, v107, v20, vcc
    v_cmp_gt_i32 s[20:21], 0, v21
    v_cmp_gt_i32 s[22:23], 1, v21
    v_cmp_gt_i32 s[62:63], 2, v21
    v_cmp_gt_i32 vcc, 3, v21
    v_cndmask_b32 v108, v108, v20, s[20:21]
    v_cndmask_b32 v109, v109, v20, s[22:23]
    v_cndmask_b32 v110, v110, v20, s[62:63]
    v_cndmask_b32 v111, v111, v20, vcc
L_recurrent_scan__compressed_kv_cla__moe_arch_mod__prompt_kernel_nm_121:
L_recurrent_scan__compressed_kv_cla__moe_arch_mod__prompt_kernel_r_117:
    s_branch L_recurrent_scan__compressed_kv_cla__moe_arch_mod__prompt_kernel_back_123
L_recurrent_scan__compressed_kv_cla__moe_arch_mod__prompt_kernel_rare_125:
    v_mov_b32 v20, 4048155338
    v_subrev_u32 v21, s36, v18
    v_cmp_gt_i32 s[20:21], 0, v21
    v_cmp_gt_i32 s[22:23], 1, v21
    v_cmp_gt_i32 s[62:63], 2, v21
    v_cmp_gt_i32 vcc, 3, v21
    v_cndmask_b32 v112, v112, v20, s[20:21]
    v_cndmask_b32 v113, v113, v20, s[22:23]
    v_cndmask_b32 v114, v114, v20, s[62:63]
    v_cndmask_b32 v115, v115, v20, vcc
    v_cmp_gt_i32 s[20:21], 16, v21
    v_cmp_gt_i32 s[22:23], 17, v21
    v_cmp_gt_i32 s[62:63], 18, v21
    v_cmp_gt_i32 vcc, 19, v21
    v_cndmask_b32 v116, v116, v20, s[20:21]
    v_cndmask_b32 v117, v117, v20, s[22:23]
    v_cndmask_b32 v118, v118, v20, s[62:63]
    v_cndmask_b32 v119, v119, v20, vcc
    v_cmp_gt_i32 s[20:21], -16, v21
    v_cmp_gt_i32 s[22:23], -15, v21
    v_cmp_gt_i32 s[62:63], -14, v21
    v_cmp_gt_i32 vcc, -13, v21
    v_cndmask_b32 v120, v120, v20, s[20:21]
    v_cndmask_b32 v121, v121, v20, s[22:23]
    v_cndmask_b32 v122, v122, v20, s[62:63]
    v_cndmask_b32 v123, v123, v20, vcc
    v_cmp_gt_i32 s[20:21], 0, v21
    v_cmp_gt_i32 s[22:23], 1, v21
    v_cmp_gt_i32 s[62:63], 2, v21
    v_cmp_gt_i32 vcc, 3, v21
    v_cndmask_b32 v124, v124, v20, s[20:21]
    v_cndmask_b32 v125, v125, v20, s[22:23]
    v_cndmask_b32 v126, v126, v20, s[62:63]
    v_cndmask_b32 v127, v127, v20, vcc
    s_branch L_recurrent_scan__compressed_kv_cla__moe_arch_mod__prompt_kernel_back_126
L_recurrent_scan__compressed_kv_cla__moe_arch_mod__prompt_kernel_rare_132:
    s_cmp_eq_u32 s40, 0
    s_cbranch_scc0 L_recurrent_scan__compressed_kv_cla__moe_arch_mod__prompt_kernel_nm_127
    ds_read_b64 v[14:15], v19
    s_waitcnt lgkmcnt(0)
L_recurrent_scan__compressed_kv_cla__moe_arch_mod__prompt_kernel_nm_127:
    s_cmp_eq_u32 s40, 12
    s_cbranch_scc0 L_recurrent_scan__compressed_kv_cla__moe_arch_mod__prompt_kernel_bh_130
    s_getpc_b64 s[36:37]
L_recurrent_scan__compressed_kv_cla__moe_arch_mod__prompt_kernel_pc_131:
    s_sub_u32 s36, s36, L_recurrent_scan__compressed_kv_cla__moe_arch_mod__prompt_kernel_pc_131-L_pc
    s_subb_u32 s37, s37, 0
    s_lshr_b32 s38, s2, 3
    s_lshl_b32 s38, s38, 7
    v_lshl_add_u32 v26, v1, 12, s38
    v_min_u32 v26, L_end-L_pc-4, v26
    v_mov_b32 v27, s37
    v_add_co_u32 v26, vcc, s36, v26
    s_mov_b64 exec, 0xffff
    s_nop 0
    v_addc_co_u32 v27, vcc, 0, v27, vcc
    global_load_dword v0, v[26:27], off
    s_mov_b64 exec, -1
    s_nop 1
L_recurrent_scan__compressed_kv_cla__moe_arch_mod__prompt_kernel_bh_130:
    s_add_u32 s36, s40, 1
    s_cmp_eq_u32 s36, s51
    s_cbranch_scc0 L_recurrent_scan__compressed_kv_cla__moe_arch_mod__prompt_kernel_ns_128
    v_swap_b32 v128, v160
    v_swap_b32 v129, v161
    v_swap_b32 v130, v162
    v_swap_b32 v131, v163
    v_swap_b32 v132, v164
    v_swap_b32 v133, v165
    v_swap_b32 v134, v166
    v_swap_b32 v135, v167
    v_swap_b32 v136, v168
    v_swap_b32 v137, v169
    v_swap_b32 v138, v170
    v_swap_b32 v139, v171
    v_swap_b32 v140, v172
    v_swap_b32 v141, v173
    v_swap_b32 v142, v174
    v_swap_b32 v143, v175
    v_swap_b32 v144, v176
    v_swap_b32 v145, v177
    v_swap_b32 v146, v178
    v_swap_b32 v147, v179
    v_swap_b32 v148, v180
    v_swap_b32 v149, v181
    v_swap_b32 v150, v182
    v_swap_b32 v151, v183
    v_swap_b32 v152, v184
    v_swap_b32 v153, v185
    v_swap_b32 v154, v186
    v_swap_b32 v155, v187
    v_swap_b32 v156, v188
    v_swap_b32 v157, v189
    v_swap_b32 v158, v190
    v_swap_b32 v159, v191
    v_mov_b32 v40, v14
    v_mov_b32 v41, v14
    v_mov_b32 v42, v14
    v_mov_b32 v43, v14
    v_mov_b32 v44, v15
    v_mov_b32 v45, v15
    v_mov_b32 v46, v15
    v_mov_b32 v47, v15
    s_nop 1
L_recurrent_scan__compressed_kv_cla__moe_arch_mod__prompt_kernel_ns_128:
    s_cmp_eq_u32 s40, s51
    s_cbranch_scc0 L_recurrent_scan__compressed_kv_cla__moe_arch_mod__prompt_kernel_ne_129
    s_nop 4
    s_mov_b32 s36, 0x5d800000
    v_cmp_nge_f32 vcc, s36, v28
    s_nop 0
    s_or_b64 s[52:53], s[52:53], vcc
    v_cmp_nge_f32 vcc, s36, v32
    s_nop 0
    s_or_b64 s[52:53], s[52:53], vcc
    v_rcp_f32 v20, v28
    v_rcp_f32 v22, v32
    s_lshl_b32 s38, s30, 3
    s_and_b32 s37, s28, 3
    s_lshl_b32 s37, s37, 1
    s_add_u32 s38, s38, s37
    s_lshl_b32 s38, s38, 17
    s_lshl_b32 s37, s29, 12
    s_add_u32 s38, s38, s37
    v_mov_b32 v21, v20
    v_mov_b32 v23, v22
    v_pk_mul_f32 v[192:193], v[192:193], v[20:21]
    v_pk_mul_f32 v[194:195], v[194:195], v[20:21]
    v_pk_mul_f32 v[196:197], v[196:197], v[20:21]
    v_pk_mul_f32 v[198:199], v[198:199], v[20:21]
    v_cvt_pk_bf16_f32 v192, v192, v193
    v_cvt_pk_bf16_f32 v193, v194, v195
    v_cvt_pk_bf16_f32 v194, v196, v197
    v_cvt_pk_bf16_f32 v195, v198, v199
    buffer_store_dwordx4 v[192:195], v7, s[16:19], s38 offen offset:0 sc1
    v_pk_mul_f32 v[200:201], v[200:201], v[20:21]
    v_pk_mul_f32 v[202:203], v[202:203], v[20:21]
    v_pk_mul_f32 v[204:205], v[204:205], v[20:21]
    v_pk_mul_f32 v[206:207], v[206:207], v[20:21]
    v_cvt_pk_bf16_f32 v200, v200, v201
    v_cvt_pk_bf16_f32 v201, v202, v203
    v_cvt_pk_bf16_f32 v202, v204, v205
    v_cvt_pk_bf16_f32 v203, v206, v207
    buffer_store_dwordx4 v[200:203], v7, s[16:19], s38 offen offset:1024 sc1
    v_pk_mul_f32 v[208:209], v[208:209], v[20:21]
    v_pk_mul_f32 v[210:211], v[210:211], v[20:21]
    v_pk_mul_f32 v[212:213], v[212:213], v[20:21]
    v_pk_mul_f32 v[214:215], v[214:215], v[20:21]
    v_cvt_pk_bf16_f32 v208, v208, v209
    v_cvt_pk_bf16_f32 v209, v210, v211
    v_cvt_pk_bf16_f32 v210, v212, v213
    v_cvt_pk_bf16_f32 v211, v214, v215
    buffer_store_dwordx4 v[208:211], v7, s[16:19], s38 offen offset:2048 sc1
    v_pk_mul_f32 v[216:217], v[216:217], v[20:21]
    v_pk_mul_f32 v[218:219], v[218:219], v[20:21]
    v_pk_mul_f32 v[220:221], v[220:221], v[20:21]
    v_pk_mul_f32 v[222:223], v[222:223], v[20:21]
    v_cvt_pk_bf16_f32 v216, v216, v217
    v_cvt_pk_bf16_f32 v217, v218, v219
    v_cvt_pk_bf16_f32 v218, v220, v221
    v_cvt_pk_bf16_f32 v219, v222, v223
    buffer_store_dwordx4 v[216:219], v7, s[16:19], s38 offen offset:3072 sc1
    s_add_u32 s38, s38, 131072
    v_pk_mul_f32 v[224:225], v[224:225], v[22:23]
    v_pk_mul_f32 v[226:227], v[226:227], v[22:23]
    v_pk_mul_f32 v[228:229], v[228:229], v[22:23]
    v_pk_mul_f32 v[230:231], v[230:231], v[22:23]
    v_cvt_pk_bf16_f32 v224, v224, v225
    v_cvt_pk_bf16_f32 v225, v226, v227
    v_cvt_pk_bf16_f32 v226, v228, v229
    v_cvt_pk_bf16_f32 v227, v230, v231
    buffer_store_dwordx4 v[224:227], v7, s[16:19], s38 offen offset:0 sc1
    v_pk_mul_f32 v[232:233], v[232:233], v[22:23]
    v_pk_mul_f32 v[234:235], v[234:235], v[22:23]
    v_pk_mul_f32 v[236:237], v[236:237], v[22:23]
    v_pk_mul_f32 v[238:239], v[238:239], v[22:23]
    v_cvt_pk_bf16_f32 v232, v232, v233
    v_cvt_pk_bf16_f32 v233, v234, v235
    v_cvt_pk_bf16_f32 v234, v236, v237
    v_cvt_pk_bf16_f32 v235, v238, v239
    buffer_store_dwordx4 v[232:235], v7, s[16:19], s38 offen offset:1024 sc1
    v_pk_mul_f32 v[240:241], v[240:241], v[22:23]
    v_pk_mul_f32 v[242:243], v[242:243], v[22:23]
    v_pk_mul_f32 v[244:245], v[244:245], v[22:23]
    v_pk_mul_f32 v[246:247], v[246:247], v[22:23]
    v_cvt_pk_bf16_f32 v240, v240, v241
    v_cvt_pk_bf16_f32 v241, v242, v243
    v_cvt_pk_bf16_f32 v242, v244, v245
    v_cvt_pk_bf16_f32 v243, v246, v247
    buffer_store_dwordx4 v[240:243], v7, s[16:19], s38 offen offset:2048 sc1
    v_pk_mul_f32 v[248:249], v[248:249], v[22:23]
    v_pk_mul_f32 v[250:251], v[250:251], v[22:23]
    v_pk_mul_f32 v[252:253], v[252:253], v[22:23]
    v_pk_mul_f32 v[254:255], v[254:255], v[22:23]
    v_cvt_pk_bf16_f32 v248, v248, v249
    v_cvt_pk_bf16_f32 v249, v250, v251
    v_cvt_pk_bf16_f32 v250, v252, v253
    v_cvt_pk_bf16_f32 v251, v254, v255
    buffer_store_dwordx4 v[248:251], v7, s[16:19], s38 offen offset:3072 sc1
    v_mov_b64 v[28:29], 0
    v_mov_b64 v[30:31], 0
    v_mov_b64 v[32:33], 0
    v_mov_b64 v[34:35], 0
    v_mov_b64 v[192:193], 0
    v_mov_b64 v[194:195], 0
    v_mov_b64 v[196:197], 0
    v_mov_b64 v[198:199], 0
    v_mov_b64 v[200:201], 0
    v_mov_b64 v[202:203], 0
    v_mov_b64 v[204:205], 0
    v_mov_b64 v[206:207], 0
    v_mov_b64 v[208:209], 0
    v_mov_b64 v[210:211], 0
    v_mov_b64 v[212:213], 0
    v_mov_b64 v[214:215], 0
    v_mov_b64 v[216:217], 0
    v_mov_b64 v[218:219], 0
    v_mov_b64 v[220:221], 0
    v_mov_b64 v[222:223], 0
    v_mov_b64 v[224:225], 0
    v_mov_b64 v[226:227], 0
    v_mov_b64 v[228:229], 0
    v_mov_b64 v[230:231], 0
    v_mov_b64 v[232:233], 0
    v_mov_b64 v[234:235], 0
    v_mov_b64 v[236:237], 0
    v_mov_b64 v[238:239], 0
    v_mov_b64 v[240:241], 0
    v_mov_b64 v[242:243], 0
    v_mov_b64 v[244:245], 0
    v_mov_b64 v[246:247], 0
    v_mov_b64 v[248:249], 0
    v_mov_b64 v[250:251], 0
    v_mov_b64 v[252:253], 0
    v_mov_b64 v[254:255], 0
L_recurrent_scan__compressed_kv_cla__moe_arch_mod__prompt_kernel_ne_129:
    s_branch L_recurrent_scan__compressed_kv_cla__moe_arch_mod__prompt_kernel_back_133
L_recurrent_scan__compressed_kv_cla__moe_arch_mod__prompt_kernel_rare_136:
    s_mov_b32 s61, 0x40000
L_recurrent_scan__compressed_kv_cla__moe_arch_mod__prompt_kernel_spin_134:
    s_sub_u32 s61, s61, 1
    s_cbranch_scc1 L_recurrent_scan__compressed_kv_cla__moe_arch_mod__prompt_kernel_spinx_135
    s_sleep 8
    global_load_dword v11, v12, s[90:91] sc1
    s_waitcnt vmcnt(0)
    v_readfirstlane_b32 s36, v11
    s_nop 0
    s_cmp_lt_u32 s36, 28
    s_cbranch_scc1 L_recurrent_scan__compressed_kv_cla__moe_arch_mod__prompt_kernel_spin_134
L_recurrent_scan__compressed_kv_cla__moe_arch_mod__prompt_kernel_spinx_135:
    s_branch L_recurrent_scan__compressed_kv_cla__moe_arch_mod__prompt_kernel_back_137
L_recurrent_scan__compressed_kv_cla__moe_arch_mod__prompt_kernel_rare_141:
    v_mov_b32 v20, 4048155338
    v_subrev_u32 v21, s50, v18
    v_cmp_gt_i32 s[20:21], 0, v21
    v_cmp_gt_i32 s[22:23], 1, v21
    v_cmp_gt_i32 s[62:63], 2, v21
    v_cmp_gt_i32 vcc, 3, v21
    v_cndmask_b32 v96, v96, v20, s[20:21]
    v_cndmask_b32 v97, v97, v20, s[22:23]
    v_cndmask_b32 v98, v98, v20, s[62:63]
    v_cndmask_b32 v99, v99, v20, vcc
    v_cmp_gt_i32 s[20:21], 16, v21
    v_cmp_gt_i32 s[22:23], 17, v21
    v_cmp_gt_i32 s[62:63], 18, v21
    v_cmp_gt_i32 vcc, 19, v21
    v_cndmask_b32 v100, v100, v20, s[20:21]
    v_cndmask_b32 v101, v101, v20, s[22:23]
    v_cndmask_b32 v102, v102, v20, s[62:63]
    v_cndmask_b32 v103, v103, v20, vcc
    v_cmp_gt_i32 s[20:21], -16, v21
    v_cmp_gt_i32 s[22:23], -15, v21
    v_cmp_gt_i32 s[62:63], -14, v21
    v_cmp_gt_i32 vcc, -13, v21
    v_cndmask_b32 v104, v104, v20, s[20:21]
    v_cndmask_b32 v105, v105, v20, s[22:23]
    v_cndmask_b32 v106, v106, v20, s[62:63]
    v_cndmask_b32 v107, v107, v20, vcc
    v_cmp_gt_i32 s[20:21], 0, v21
    v_cmp_gt_i32 s[22:23], 1, v21
    v_cmp_gt_i32 s[62:63], 2, v21
    v_cmp_gt_i32 vcc, 3, v21
    v_cndmask_b32 v108, v108, v20, s[20:21]
    v_cndmask_b32 v109, v109, v20, s[22:23]
    v_cndmask_b32 v110, v110, v20, s[62:63]
    v_cndmask_b32 v111, v111, v20, vcc
    s_branch L_recurrent_scan__compressed_kv_cla__moe_arch_mod__prompt_kernel_back_142
L_p3_done:
    s_and_b32 s36, s29, 28
    s_sub_u32 s40, 47, s30
    s_lshl_b32 s40, s40, 7
    s_add_u32 s40, s40, s36
    s_add_u32 s41, s30, 32
    s_lshl_b32 s41, s41, 7
    s_add_u32 s41, s41, s36
    s_lshr_b32 s63, s29, 4
    s_lshl_b32 s36, s30, 2
    s_lshr_b32 s30, 0x76534210, s36
    s_and_b32 s30, s30, 7
    s_and_b32 s36, s30, 4
    s_add_u32 s43, s30, s36
    s_lshl_b32 s36, s63, 2
    s_add_u32 s30, s43, s36
    s_and_b32 s29, s29, 15
    s_and_b32 s36, s28, 3
    s_lshl_b32 s37, s29, 2
    s_add_u32 s36, s36, s37
    s_lshl_b32 s36, s36, 18
    s_lshr_b32 s37, s28, 2
    s_lshl_b32 s37, s37, 12
    s_add_u32 s36, s36, s37
    s_lshl_b32 s37, s63, 16
    s_add_u32 s36, s36, s37
    s_lshr_b32 s37, s28, 2
    s_lshl_b32 s37, s37, 17
    s_add_u32 s36, s36, s37
    v_lshl_add_u32 v2, v1, 4, s36
    v_xor_b32 v3, 131072, v2
    v_lshrrev_b32 v19, 4, v1
    s_lshr_b32 s36, s28, 2
    s_lshl_b32 s36, s36, 7
    s_and_b32 s37, s28, 3
    s_lshl_b32 s37, s37, 4
    s_add_u32 s36, s36, s37
    s_lshl_b32 s33, s36, 8
    s_lshl_b32 s37, s63, 11
    s_add_u32 s36, s36, s37
    v_add_u32 v18, s36, v19
    v_lshlrev_b32 v18, 11, v18
    s_lshl_b32 s36, s43, 7
    v_add_u32 v18, s36, v18
    v_lshlrev_b32 v20, 1, v19
    v_and_b32 v21, 7, v1
    v_xor_b32 v20, v20, v21
    v_lshl_add_u32 v18, v20, 4, v18
    v_and_b32 v21, 8, v1
    v_lshl_add_u32 v6, v21, 6, v18
    v_xor_b32 v21, 8, v21
    v_lshl_add_u32 v7, v21, 6, v18
    v_add_u32 v7, 7168, v7
    v_add_u32 v8, 14336, v6
    v_add_u32 v9, 14336, v7
    s_add_u32 s36, s2, 1
    s_mov_b32 s62, 0
    s_lshl_b32 s31, s62, 14
    s_lshl_b32 s32, s62, 20
    s_add_u32 s4, s54, 41943040
    s_addc_u32 s5, s55, 0
    s_and_b32 s5, s5, 0xffff
    s_mov_b32 s6, 16777216
    s_mov_b32 s7, 0x20000
    s_mov_b32 s16, s96
    s_and_b32 s17, s97, 0xffff
    s_mov_b32 s18, 4194304
    s_mov_b32 s19, 0x20000
    s_mov_b32 s20, s98
    s_and_b32 s21, s99, 0xffff
    s_mov_b32 s22, 4194304
    s_mov_b32 s23, 0x20000
    s_lshl_b32 s36, s29, 7
    s_and_b32 s37, s28, 3
    s_lshl_b32 s37, s37, 5
    s_add_u32 s36, s36, s37
    s_lshr_b32 s37, s28, 2
    s_lshl_b32 s37, s37, 4
    s_add_u32 s38, s36, s37
    v_and_b32 v17, 15, v1
    v_add_u32 v14, s38, v17
    v_lshlrev_b32 v16, 3, v14
    v_lshrrev_b32 v15, 3, v1
    v_add_u32 v15, s38, v15
    v_lshlrev_b32 v15, 11, v15
    v_and_b32 v4, 7, v1
    v_lshl_add_u32 v15, v4, 4, v15
    s_lshl_b32 s36, s30, 7
    v_add_u32 v15, s36, v15
    s_lshl_b32 s36, s28, 12
    s_add_u32 s42, s36, 131072
    v_lshl_add_u32 v17, v17, 7, s42
    v_lshl_add_u32 v17, v19, 3, v17
    v_bfe_u32 v20, v1, 2, 2
    v_lshl_add_u32 v18, v19, 2, v20
    v_and_b32 v20, 7, v18
    s_lshl_b32 s36, s63, 2
    s_xor_b32 s36, s36, 4
    v_xor_b32 v20, s36, v20
    v_lshlrev_b32 v18, 8, v18
    s_lshr_b32 s36, s28, 2
    s_lshl_b32 s36, s36, 15
    s_add_u32 s36, s36, 65536
    v_add_u32 v18, s36, v18
    v_and_b32 v21, 3, v1
    v_lshl_add_u32 v18, v21, 3, v18
    v_xor_b32 v21, 0, v20
    v_lshl_add_u32 v50, v21, 5, v18
    v_xor_b32 v21, 1, v20
    v_lshl_add_u32 v51, v21, 5, v18
    v_xor_b32 v21, 2, v20
    v_lshl_add_u32 v52, v21, 5, v18
    v_xor_b32 v21, 3, v20
    v_lshl_add_u32 v53, v21, 5, v18
    v_xor_b32 v21, 4, v20
    v_lshl_add_u32 v54, v21, 5, v18
    v_xor_b32 v21, 5, v20
    v_lshl_add_u32 v55, v21, 5, v18
    v_xor_b32 v21, 6, v20
    v_lshl_add_u32 v56, v21, 5, v18
    v_xor_b32 v21, 7, v20
    v_lshl_add_u32 v57, v21, 5, v18
    v_mov_b64 v[192:193], 0
    v_mov_b64 v[194:195], 0
    v_mov_b64 v[196:197], 0
    v_mov_b64 v[198:199], 0
    v_mov_b64 v[200:201], 0
    v_mov_b64 v[202:203], 0
    v_mov_b64 v[204:205], 0
    v_mov_b64 v[206:207], 0
    v_mov_b64 v[208:209], 0
    v_mov_b64 v[210:211], 0
    v_mov_b64 v[212:213], 0
    v_mov_b64 v[214:215], 0
    v_mov_b64 v[216:217], 0
    v_mov_b64 v[218:219], 0
    v_mov_b64 v[220:221], 0
    v_mov_b64 v[222:223], 0
    v_mov_b64 v[224:225], 0
    v_mov_b64 v[226:227], 0
    v_mov_b64 v[228:229], 0
    v_mov_b64 v[230:231], 0
    v_mov_b64 v[232:233], 0
    v_mov_b64 v[234:235], 0
    v_mov_b64 v[236:237], 0
    v_mov_b64 v[238:239], 0
    v_mov_b64 v[240:241], 0
    v_mov_b64 v[242:243], 0
    v_mov_b64 v[244:245], 0
    v_mov_b64 v[246:247], 0
    v_mov_b64 v[248:249], 0
    v_mov_b64 v[250:251], 0
    v_mov_b64 v[252:253], 0
    v_mov_b64 v[254:255], 0
    s_waitcnt vmcnt(0)
    s_barrier
    s_cmp_eq_u32 s28, 0
    s_cbranch_scc1 L_recurrent_scan__compressed_kv_cla__moe_arch_mod__prompt_kernel_rare_143
L_recurrent_scan__compressed_kv_cla__moe_arch_mod__prompt_kernel_back_144:
    s_bitcmp1_b32 0x70, s28
    s_cbranch_scc1 L_recurrent_scan__compressed_kv_cla__moe_arch_mod__prompt_kernel_f2m_170
L_recurrent_scan__compressed_kv_cla__moe_arch_mod__prompt_kernel_f2a_171:
    s_mov_b32 s34, s33
    s_add_u32 m0, s34, 65536
    s_nop 0
    buffer_load_dwordx4 v6, s[8:11], s32 offen offset:0 lds
    buffer_load_dwordx4 v7, s[8:11], s32 offen offset:1024 lds
    buffer_load_dwordx4 v8, s[8:11], s32 offen offset:2048 lds
    buffer_load_dwordx4 v9, s[8:11], s32 offen offset:3072 lds
    s_add_u32 s32, s32, 131072
    s_add_u32 m0, s34, 81920
    s_nop 0
    buffer_load_dwordx4 v6, s[8:11], s32 offen offset:0 lds
    buffer_load_dwordx4 v7, s[8:11], s32 offen offset:1024 lds
    buffer_load_dwordx4 v8, s[8:11], s32 offen offset:2048 lds
    buffer_load_dwordx4 v9, s[8:11], s32 offen offset:3072 lds
    s_add_u32 s32, s32, 393216
    s_and_b32 s32, s32, 0x3fffff
    s_add_u32 m0, s34, 0
    s_nop 0
    buffer_load_dwordx4 v6, s[8:11], s32 offen offset:0 lds
    buffer_load_dwordx4 v7, s[8:11], s32 offen offset:1024 lds
    buffer_load_dwordx4 v8, s[8:11], s32 offen offset:2048 lds
    buffer_load_dwordx4 v9, s[8:11], s32 offen offset:3072 lds
    s_add_u32 s32, s32, 131072
    s_add_u32 m0, s34, 16384
    s_nop 0
    buffer_load_dwordx4 v6, s[8:11], s32 offen offset:0 lds
    buffer_load_dwordx4 v7, s[8:11], s32 offen offset:1024 lds
    buffer_load_dwordx4 v8, s[8:11], s32 offen offset:2048 lds
    buffer_load_dwordx4 v9, s[8:11], s32 offen offset:3072 lds
    s_add_u32 s32, s32, 393216
    s_and_b32 s32, s32, 0x3fffff
    s_cmp_lt_u32 s28, 4
    s_cbranch_scc1 L_recurrent_scan__compressed_kv_cla__moe_arch_mod__prompt_kernel_f2m_170
L_recurrent_scan__compressed_kv_cla__moe_arch_mod__prompt_kernel_f2b_172:
    s_mov_b32 s60, 15
    s_cmp_eq_u32 s28, 3
    s_cbranch_scc0 L_recurrent_scan__compressed_kv_cla__moe_arch_mod__prompt_kernel_w7j_173
    v_add_u32 v58, s62, v1
    v_and_b32 v58, 3, v58
    s_add_u32 s36, s29, 32
    s_lshl_b32 s36, s36, 7
    s_lshl_b32 s37, s63, 4
    s_add_u32 s36, s36, s37
    v_lshl_add_u32 v58, v58, 2, s36
    s_mov_b32 s61, 0x40000
L_recurrent_scan__compressed_kv_cla__moe_arch_mod__prompt_kernel_cspin_174:
    s_sub_u32 s61, s61, 1
    s_cbranch_scc1 L_recurrent_scan__compressed_kv_cla__moe_arch_mod__prompt_kernel_cspinx_175
    global_load_dword v59, v58, s[90:91] sc1
    s_waitcnt vmcnt(0)
L_recurrent_scan__compressed_kv_cla__moe_arch_mod__prompt_kernel_cchk_176:
    v_cmp_le_u32 vcc, 4, v59
    s_nop 0
    s_and_b32 s60, vcc_lo, 15
    s_and_b32 s36, s60, 3
    s_cmp_eq_u32 s36, 3
    s_cbranch_scc1 L_recurrent_scan__compressed_kv_cla__moe_arch_mod__prompt_kernel_cspinx_175
    s_sleep 6
    s_branch L_recurrent_scan__compressed_kv_cla__moe_arch_mod__prompt_kernel_cspin_174
L_recurrent_scan__compressed_kv_cla__moe_arch_mod__prompt_kernel_cspinx_175:
L_recurrent_scan__compressed_kv_cla__moe_arch_mod__prompt_kernel_w7j_173:
    s_waitcnt vmcnt(12)
    s_waitcnt lgkmcnt(0)
    s_barrier
    buffer_load_dwordx4 v[128:131], v2, s[4:7], s31 offen offset:0 sc1
    buffer_load_dwordx4 v[132:135], v3, s[4:7], s31 offen offset:0 sc1
    buffer_load_dwordx4 v[136:139], v2, s[4:7], s31 offen offset:1024 sc1
    buffer_load_dwordx4 v[140:143], v3, s[4:7], s31 offen offset:1024 sc1
    buffer_load_dwordx4 v[144:147], v2, s[4:7], s31 offen offset:2048 sc1
    buffer_load_dwordx4 v[148:151], v3, s[4:7], s31 offen offset:2048 sc1
    buffer_load_dwordx4 v[152:155], v2, s[4:7], s31 offen offset:3072 sc1
    buffer_load_dwordx4 v[156:159], v3, s[4:7], s31 offen offset:3072 sc1
    s_add_u32 s31, s31, 8192
    s_and_b32 s31, s31, 0xffff
    s_cmp_lt_u32 s28, 4
    s_cbranch_scc0 L_recurrent_scan__compressed_kv_cla__moe_arch_mod__prompt_kernel_g_145
    s_lshl_b32 s36, s28, 10
    s_add_u32 s36, s36, 131072
    v_lshl_add_u32 v28, v1, 4, s36
    ds_read_b128 v[96:99], v28 offset:0
    ds_read_b128 v[100:103], v28 offset:4096
    ds_read_b128 v[104:107], v28 offset:8192
    ds_read_b128 v[108:111], v28 offset:12288
    ds_read_b128 v[112:115], v28 offset:16384
    ds_read_b128 v[116:119], v28 offset:20480
    ds_read_b128 v[120:123], v28 offset:24576
    s_lshr_b32 s36, s2, 4
    s_lshl_b32 s36, s36, 13
    s_and_b32 s37, s2, 15
    s_lshl_b32 s37, s37, 8
    s_add_u32 s36, s36, s37
    s_lshl_b32 s37, s28, 6
    s_add_u32 s36, s36, s37
    s_add_u32 s36, s36, 59768832
    v_and_b32 v28, 1, v1
    v_lshlrev_b32 v28, 12, v28
    v_lshl_add_u32 v28, v19, 4, v28
    s_waitcnt lgkmcnt(0)
    v_add_f32 v96, v96, v100
    v_add_f32 v97, v97, v101
    v_add_f32 v98, v98, v102
    v_add_f32 v99, v99, v103
    v_add_f32 v96, v96, v104
    v_add_f32 v97, v97, v105
    v_add_f32 v98, v98, v106
    v_add_f32 v99, v99, v107
    v_add_f32 v96, v96, v108
    v_add_f32 v97, v97, v109
    v_add_f32 v98, v98, v110
    v_add_f32 v99, v99, v111
    v_add_f32 v96, v96, v112
    v_add_f32 v97, v97, v113
    v_add_f32 v98, v98, v114
    v_add_f32 v99, v99, v115
    v_add_f32 v96, v96, v116
    v_add_f32 v97, v97, v117
    v_add_f32 v98, v98, v118
    v_add_f32 v99, v99, v119
    v_add_f32 v96, v96, v120
    v_add_f32 v97, v97, v121
    v_add_f32 v98, v98, v122
    v_add_f32 v99, v99, v123
    s_mov_b32 exec_lo, 0x00030003
    s_mov_b32 exec_hi, 0x00030003
    buffer_store_dwordx4 v[96:99], v28, s[24:27], s36 offen sc1
    s_mov_b64 exec, -1
    s_nop 3
L_recurrent_scan__compressed_kv_cla__moe_arch_mod__prompt_kernel_g_145:
    v_lshlrev_b32 v22, 4, v1
    v_add_u32 v20, s42, v22
    v_xor_b32 v21, 16384, v20
    s_lshl_b32 s36, s2, 15
    s_lshl_b32 s37, s28, 12
    s_add_u32 s36, s36, s37
    s_add_u32 s36, s36, 67108864
    s_mov_b32 s41, s36
    s_xor_b32 s39, s36, 131072
    s_add_u32 s40, s2, 128
    s_lshl_b32 s40, s40, 7
    ds_read_b64_tr_b16 v[64:65], v50 offset:0
    ds_read_b64_tr_b16 v[66:67], v50 offset:4096
    ds_read_b64_tr_b16 v[68:69], v51 offset:0
    ds_read_b64_tr_b16 v[70:71], v51 offset:4096
    ds_read_b64_tr_b16 v[72:73], v52 offset:0
    ds_read_b64_tr_b16 v[74:75], v52 offset:4096
    ds_read_b64_tr_b16 v[76:77], v53 offset:0
    ds_read_b64_tr_b16 v[78:79], v53 offset:4096
    ds_read_b64_tr_b16 v[80:81], v54 offset:0
    ds_read_b64_tr_b16 v[82:83], v54 offset:4096
    ds_read_b64_tr_b16 v[84:85], v55 offset:0
    ds_read_b64_tr_b16 v[86:87], v55 offset:4096
    s_mov_b32 s35, 0
    s_waitcnt vmcnt(0)
    buffer_load_dwordx4 v[160:163], v2, s[4:7], s31 offen offset:0 sc1
    buffer_load_dwordx4 v[164:167], v3, s[4:7], s31 offen offset:0 sc1
    buffer_load_dwordx4 v[168:171], v2, s[4:7], s31 offen offset:1024 sc1
    buffer_load_dwordx4 v[172:175], v3, s[4:7], s31 offen offset:1024 sc1
    .p2align 6
L_p4_loop:
    s_cmp_lg_u32 s35, 0
    s_cbranch_scc1 L_recurrent_scan__compressed_kv_cla__moe_arch_mod__prompt_kernel_rare_153
L_recurrent_scan__compressed_kv_cla__moe_arch_mod__prompt_kernel_back_154:
    s_waitcnt lgkmcnt(8)
    s_waitcnt vmcnt(22)
    v_mfma_f32_16x16x32_bf16 v[192:195], v[64:67], v[128:131], v[192:195]
    ds_read_b64_tr_b16 v[88:89], v56 offset:0
    v_mfma_f32_16x16x32_bf16 v[224:227], v[64:67], v[132:135], v[224:227]
    ds_read_b64_tr_b16 v[90:91], v56 offset:4096
    v_mfma_f32_16x16x32_bf16 v[196:199], v[68:71], v[128:131], v[196:199]
    ds_read_b64_tr_b16 v[92:93], v57 offset:0
    v_mfma_f32_16x16x32_bf16 v[228:231], v[68:71], v[132:135], v[228:231]
    ds_read_b64_tr_b16 v[94:95], v57 offset:4096
    buffer_load_dwordx4 v[176:179], v2, s[4:7], s31 offen offset:2048 sc1
    s_waitcnt lgkmcnt(8)
    v_mfma_f32_16x16x32_bf16 v[200:203], v[72:75], v[128:131], v[200:203]
    ds_read_b64_tr_b16 v[64:65], v50 offset:8192
    v_mfma_f32_16x16x32_bf16 v[232:235], v[72:75], v[132:135], v[232:235]
    ds_read_b64_tr_b16 v[66:67], v50 offset:12288
    v_mfma_f32_16x16x32_bf16 v[204:207], v[76:79], v[128:131], v[204:207]
    ds_read_b64_tr_b16 v[68:69], v51 offset:8192
    v_mfma_f32_16x16x32_bf16 v[236:239], v[76:79], v[132:135], v[236:239]
    ds_read_b64_tr_b16 v[70:71], v51 offset:12288
    s_waitcnt lgkmcnt(8)
    v_mfma_f32_16x16x32_bf16 v[208:211], v[80:83], v[128:131], v[208:211]
    ds_read_b64_tr_b16 v[72:73], v52 offset:8192
    v_mfma_f32_16x16x32_bf16 v[240:243], v[80:83], v[132:135], v[240:243]
    ds_read_b64_tr_b16 v[74:75], v52 offset:12288
    buffer_load_dwordx4 v[180:183], v3, s[4:7], s31 offen offset:2048 sc1
    v_mfma_f32_16x16x32_bf16 v[212:215], v[84:87], v[128:131], v[212:215]
    ds_read_b64_tr_b16 v[76:77], v53 offset:8192
    v_mfma_f32_16x16x32_bf16 v[244:247], v[84:87], v[132:135], v[244:247]
    ds_read_b64_tr_b16 v[78:79], v53 offset:12288
    s_waitcnt lgkmcnt(8)
    v_mfma_f32_16x16x32_bf16 v[216:219], v[88:91], v[128:131], v[216:219]
    ds_read_b64_tr_b16 v[80:81], v54 offset:8192
    v_mfma_f32_16x16x32_bf16 v[248:251], v[88:91], v[132:135], v[248:251]
    ds_read_b64_tr_b16 v[82:83], v54 offset:12288
    v_mfma_f32_16x16x32_bf16 v[220:223], v[92:95], v[128:131], v[220:223]
    ds_read_b64_tr_b16 v[84:85], v55 offset:8192
    v_mfma_f32_16x16x32_bf16 v[252:255], v[92:95], v[132:135], v[252:255]
    ds_read_b64_tr_b16 v[86:87], v55 offset:12288
    s_waitcnt lgkmcnt(8)
    s_waitcnt vmcnt(22)
    v_mfma_f32_16x16x32_bf16 v[192:195], v[64:67], v[136:139], v[192:195]
    ds_read_b64_tr_b16 v[88:89], v56 offset:8192
    v_mfma_f32_16x16x32_bf16 v[224:227], v[64:67], v[140:143], v[224:227]
    ds_read_b64_tr_b16 v[90:91], v56 offset:12288
    buffer_load_dwordx4 v[184:187], v2, s[4:7], s31 offen offset:3072 sc1
    v_mfma_f32_16x16x32_bf16 v[196:199], v[68:71], v[136:139], v[196:199]
    ds_read_b64_tr_b16 v[92:93], v57 offset:8192
    v_mfma_f32_16x16x32_bf16 v[228:231], v[68:71], v[140:143], v[228:231]
    ds_read_b64_tr_b16 v[94:95], v57 offset:12288
    s_waitcnt lgkmcnt(8)
    v_mfma_f32_16x16x32_bf16 v[200:203], v[72:75], v[136:139], v[200:203]
    v_mfma_f32_16x16x32_bf16 v[232:235], v[72:75], v[140:143], v[232:235]
    buffer_load_dwordx4 v[188:191], v3, s[4:7], s31 offen offset:3072 sc1
    s_add_u32 s31, s31, 8192
    s_and_b32 s31, s31, 0xffff
    v_mfma_f32_16x16x32_bf16 v[204:207], v[76:79], v[136:139], v[204:207]
    v_mfma_f32_16x16x32_bf16 v[236:239], v[76:79], v[140:143], v[236:239]
    s_waitcnt lgkmcnt(0)
    s_waitcnt vmcnt(20)
    s_barrier
    v_mfma_f32_16x16x32_bf16 v[208:211], v[80:83], v[136:139], v[208:211]
    ds_read_b64_tr_b16 v[64:65], v50 offset:16384
    ds_read_b64_tr_b16 v[66:67], v50 offset:20480
    v_mfma_f32_16x16x32_bf16 v[240:243], v[80:83], v[140:143], v[240:243]
    ds_read_b64_tr_b16 v[68:69], v51 offset:16384
    ds_read_b64_tr_b16 v[70:71], v51 offset:20480
    s_add_u32 m0, s34, 65536
    v_mfma_f32_16x16x32_bf16 v[212:215], v[84:87], v[136:139], v[212:215]
    ds_read_b64_tr_b16 v[72:73], v52 offset:16384
    ds_read_b64_tr_b16 v[74:75], v52 offset:20480
    buffer_load_dwordx4 v6, s[8:11], s32 offen offset:0 lds
    v_mfma_f32_16x16x32_bf16 v[244:247], v[84:87], v[140:143], v[244:247]
    ds_read_b64_tr_b16 v[76:77], v53 offset:16384
    ds_read_b64_tr_b16 v[78:79], v53 offset:20480
    v_mfma_f32_16x16x32_bf16 v[216:219], v[88:91], v[136:139], v[216:219]
    ds_read_b64_tr_b16 v[80:81], v54 offset:16384
    ds_read_b64_tr_b16 v[82:83], v54 offset:20480
    buffer_load_dwordx4 v7, s[8:11], s32 offen offset:1024 lds
    v_mfma_f32_16x16x32_bf16 v[248:251], v[88:91], v[140:143], v[248:251]
    v_mfma_f32_16x16x32_bf16 v[220:223], v[92:95], v[136:139], v[220:223]
    ds_read_b64_tr_b16 v[84:85], v55 offset:16384
    ds_read_b64_tr_b16 v[86:87], v55 offset:20480
    buffer_load_dwordx4 v8, s[8:11], s32 offen offset:2048 lds
    v_mfma_f32_16x16x32_bf16 v[252:255], v[92:95], v[140:143], v[252:255]
    buffer_load_dwordx4 v9, s[8:11], s32 offen offset:3072 lds
    s_add_u32 s32, s32, 131072
    s_waitcnt lgkmcnt(8)
    s_waitcnt vmcnt(22)
    v_mfma_f32_16x16x32_bf16 v[192:195], v[64:67], v[144:147], v[192:195]
    ds_read_b64_tr_b16 v[88:89], v56 offset:16384
    v_mfma_f32_16x16x32_bf16 v[224:227], v[64:67], v[148:151], v[224:227]
    ds_read_b64_tr_b16 v[90:91], v56 offset:20480
    v_mfma_f32_16x16x32_bf16 v[196:199], v[68:71], v[144:147], v[196:199]
    ds_read_b64_tr_b16 v[92:93], v57 offset:16384
    v_mfma_f32_16x16x32_bf16 v[228:231], v[68:71], v[148:151], v[228:231]
    ds_read_b64_tr_b16 v[94:95], v57 offset:20480
    buffer_load_dwordx4 v[128:131], v2, s[4:7], s31 offen offset:0 sc1
    s_waitcnt lgkmcnt(8)
    v_mfma_f32_16x16x32_bf16 v[200:203], v[72:75], v[144:147], v[200:203]
    ds_read_b64_tr_b16 v[64:65], v50 offset:24576
    v_mfma_f32_16x16x32_bf16 v[232:235], v[72:75], v[148:151], v[232:235]
    ds_read_b64_tr_b16 v[66:67], v50 offset:28672
    v_xor_b32 v50, 65536, v50
    v_mfma_f32_16x16x32_bf16 v[204:207], v[76:79], v[144:147], v[204:207]
    ds_read_b64_tr_b16 v[68:69], v51 offset:24576
    v_mfma_f32_16x16x32_bf16 v[236:239], v[76:79], v[148:151], v[236:239]
    ds_read_b64_tr_b16 v[70:71], v51 offset:28672
    v_xor_b32 v51, 65536, v51
    s_waitcnt lgkmcnt(8)
    v_mfma_f32_16x16x32_bf16 v[208:211], v[80:83], v[144:147], v[208:211]
    ds_read_b64_tr_b16 v[72:73], v52 offset:24576
    v_mfma_f32_16x16x32_bf16 v[240:243], v[80:83], v[148:151], v[240:243]
    ds_read_b64_tr_b16 v[74:75], v52 offset:28672
    v_xor_b32 v52, 65536, v52
    buffer_load_dwordx4 v[132:135], v3, s[4:7], s31 offen offset:0 sc1
    v_mfma_f32_16x16x32_bf16 v[212:215], v[84:87], v[144:147], v[212:215]
    ds_read_b64_tr_b16 v[76:77], v53 offset:24576
    v_mfma_f32_16x16x32_bf16 v[244:247], v[84:87], v[148:151], v[244:247]
    ds_read_b64_tr_b16 v[78:79], v53 offset:28672
    v_xor_b32 v53, 65536, v53
    s_waitcnt lgkmcnt(8)
    v_mfma_f32_16x16x32_bf16 v[216:219], v[88:91], v[144:147], v[216:219]
    ds_read_b64_tr_b16 v[80:81], v54 offset:24576
    v_mfma_f32_16x16x32_bf16 v[248:251], v[88:91], v[148:151], v[248:251]
    ds_read_b64_tr_b16 v[82:83], v54 offset:28672
    v_xor_b32 v54, 65536, v54
    v_mfma_f32_16x16x32_bf16 v[220:223], v[92:95], v[144:147], v[220:223]
    ds_read_b64_tr_b16 v[84:85], v55 offset:24576
    v_mfma_f32_16x16x32_bf16 v[252:255], v[92:95], v[148:151], v[252:255]
    ds_read_b64_tr_b16 v[86:87], v55 offset:28672
    v_xor_b32 v55, 65536, v55
    s_waitcnt lgkmcnt(8)
    s_waitcnt vmcnt(22)
    v_mfma_f32_16x16x32_bf16 v[192:195], v[64:67], v[152:155], v[192:195]
    ds_read_b64_tr_b16 v[88:89], v56 offset:24576
    v_mfma_f32_16x16x32_bf16 v[224:227], v[64:67], v[156:159], v[224:227]
    ds_read_b64_tr_b16 v[90:91], v56 offset:28672
    v_xor_b32 v56, 65536, v56
    buffer_load_dwordx4 v[136:139], v2, s[4:7], s31 offen offset:1024 sc1
    v_mfma_f32_16x16x32_bf16 v[196:199], v[68:71], v[152:155], v[196:199]
    ds_read_b64_tr_b16 v[92:93], v57 offset:24576
    v_mfma_f32_16x16x32_bf16 v[228:231], v[68:71], v[156:159], v[228:231]
    ds_read_b64_tr_b16 v[94:95], v57 offset:28672
    v_xor_b32 v57, 65536, v57
    s_waitcnt lgkmcnt(8)
    v_mfma_f32_16x16x32_bf16 v[200:203], v[72:75], v[152:155], v[200:203]
    v_mfma_f32_16x16x32_bf16 v[232:235], v[72:75], v[156:159], v[232:235]
    buffer_load_dwordx4 v[140:143], v3, s[4:7], s31 offen offset:1024 sc1
    v_mfma_f32_16x16x32_bf16 v[204:207], v[76:79], v[152:155], v[204:207]
    v_mfma_f32_16x16x32_bf16 v[236:239], v[76:79], v[156:159], v[236:239]
    s_waitcnt lgkmcnt(0)
    s_waitcnt vmcnt(20)
    s_barrier
    v_mfma_f32_16x16x32_bf16 v[208:211], v[80:83], v[152:155], v[208:211]
    ds_read_b64_tr_b16 v[64:65], v50 offset:0
    ds_read_b64_tr_b16 v[66:67], v50 offset:4096
    v_mfma_f32_16x16x32_bf16 v[240:243], v[80:83], v[156:159], v[240:243]
    ds_read_b64_tr_b16 v[68:69], v51 offset:0
    ds_read_b64_tr_b16 v[70:71], v51 offset:4096
    s_add_u32 m0, s34, 81920
    v_mfma_f32_16x16x32_bf16 v[212:215], v[84:87], v[152:155], v[212:215]
    ds_read_b64_tr_b16 v[72:73], v52 offset:0
    ds_read_b64_tr_b16 v[74:75], v52 offset:4096
    buffer_load_dwordx4 v6, s[8:11], s32 offen offset:0 lds
    v_mfma_f32_16x16x32_bf16 v[244:247], v[84:87], v[156:159], v[244:247]
    ds_read_b64_tr_b16 v[76:77], v53 offset:0
    ds_read_b64_tr_b16 v[78:79], v53 offset:4096
    v_mfma_f32_16x16x32_bf16 v[216:219], v[88:91], v[152:155], v[216:219]
    ds_read_b64_tr_b16 v[80:81], v54 offset:0
    ds_read_b64_tr_b16 v[82:83], v54 offset:4096
    buffer_load_dwordx4 v7, s[8:11], s32 offen offset:1024 lds
    v_mfma_f32_16x16x32_bf16 v[248:251], v[88:91], v[156:159], v[248:251]
    v_mfma_f32_16x16x32_bf16 v[220:223], v[92:95], v[152:155], v[220:223]
    ds_read_b64_tr_b16 v[84:85], v55 offset:0
    ds_read_b64_tr_b16 v[86:87], v55 offset:4096
    buffer_load_dwordx4 v8, s[8:11], s32 offen offset:2048 lds
    v_mfma_f32_16x16x32_bf16 v[252:255], v[92:95], v[156:159], v[252:255]
    buffer_load_dwordx4 v9, s[8:11], s32 offen offset:3072 lds
    s_add_u32 s32, s32, 393216
    s_and_b32 s32, s32, 0x3fffff
    s_cmp_eq_u32 s35, 2
    s_cbranch_scc1 L_recurrent_scan__compressed_kv_cla__moe_arch_mod__prompt_kernel_rare_156
L_recurrent_scan__compressed_kv_cla__moe_arch_mod__prompt_kernel_back_157:
    s_waitcnt lgkmcnt(8)
    s_waitcnt vmcnt(18)
    v_mfma_f32_16x16x32_bf16 v[192:195], v[64:67], v[160:163], v[192:195]
    ds_read_b64_tr_b16 v[88:89], v56 offset:0
    v_mfma_f32_16x16x32_bf16 v[224:227], v[64:67], v[164:167], v[224:227]
    ds_read_b64_tr_b16 v[90:91], v56 offset:4096
    v_mfma_f32_16x16x32_bf16 v[196:199], v[68:71], v[160:163], v[196:199]
    ds_read_b64_tr_b16 v[92:93], v57 offset:0
    v_mfma_f32_16x16x32_bf16 v[228:231], v[68:71], v[164:167], v[228:231]
    ds_read_b64_tr_b16 v[94:95], v57 offset:4096
    buffer_load_dwordx4 v[144:147], v2, s[4:7], s31 offen offset:2048 sc1
    s_waitcnt lgkmcnt(8)
    v_mfma_f32_16x16x32_bf16 v[200:203], v[72:75], v[160:163], v[200:203]
    ds_read_b64_tr_b16 v[64:65], v50 offset:8192
    v_mfma_f32_16x16x32_bf16 v[232:235], v[72:75], v[164:167], v[232:235]
    ds_read_b64_tr_b16 v[66:67], v50 offset:12288
    v_mfma_f32_16x16x32_bf16 v[204:207], v[76:79], v[160:163], v[204:207]
    ds_read_b64_tr_b16 v[68:69], v51 offset:8192
    v_mfma_f32_16x16x32_bf16 v[236:239], v[76:79], v[164:167], v[236:239]
    ds_read_b64_tr_b16 v[70:71], v51 offset:12288
    s_waitcnt lgkmcnt(8)
    v_mfma_f32_16x16x32_bf16 v[208:211], v[80:83], v[160:163], v[208:211]
    ds_read_b64_tr_b16 v[72:73], v52 offset:8192
    v_mfma_f32_16x16x32_bf16 v[240:243], v[80:83], v[164:167], v[240:243]
    ds_read_b64_tr_b16 v[74:75], v52 offset:12288
    buffer_load_dwordx4 v[148:151], v3, s[4:7], s31 offen offset:2048 sc1
    v_mfma_f32_16x16x32_bf16 v[212:215], v[84:87], v[160:163], v[212:215]
    ds_read_b64_tr_b16 v[76:77], v53 offset:8192
    v_mfma_f32_16x16x32_bf16 v[244:247], v[84:87], v[164:167], v[244:247]
    ds_read_b64_tr_b16 v[78:79], v53 offset:12288
    s_waitcnt lgkmcnt(8)
    v_mfma_f32_16x16x32_bf16 v[216:219], v[88:91], v[160:163], v[216:219]
    ds_read_b64_tr_b16 v[80:81], v54 offset:8192
    v_mfma_f32_16x16x32_bf16 v[248:251], v[88:91], v[164:167], v[248:251]
    ds_read_b64_tr_b16 v[82:83], v54 offset:12288
    v_mfma_f32_16x16x32_bf16 v[220:223], v[92:95], v[160:163], v[220:223]
    ds_read_b64_tr_b16 v[84:85], v55 offset:8192
    v_mfma_f32_16x16x32_bf16 v[252:255], v[92:95], v[164:167], v[252:255]
    ds_read_b64_tr_b16 v[86:87], v55 offset:12288
    s_waitcnt lgkmcnt(8)
    s_waitcnt vmcnt(18)
    v_mfma_f32_16x16x32_bf16 v[192:195], v[64:67], v[168:171], v[192:195]
    ds_read_b64_tr_b16 v[88:89], v56 offset:8192
    v_mfma_f32_16x16x32_bf16 v[224:227], v[64:67], v[172:175], v[224:227]
    ds_read_b64_tr_b16 v[90:91], v56 offset:12288
    buffer_load_dwordx4 v[152:155], v2, s[4:7], s31 offen offset:3072 sc1
    v_mfma_f32_16x16x32_bf16 v[196:199], v[68:71], v[168:171], v[196:199]
    ds_read_b64_tr_b16 v[92:93], v57 offset:8192
    v_mfma_f32_16x16x32_bf16 v[228:231], v[68:71], v[172:175], v[228:231]
    ds_read_b64_tr_b16 v[94:95], v57 offset:12288
    s_waitcnt lgkmcnt(8)
    v_mfma_f32_16x16x32_bf16 v[200:203], v[72:75], v[168:171], v[200:203]
    v_mfma_f32_16x16x32_bf16 v[232:235], v[72:75], v[172:175], v[232:235]
    buffer_load_dwordx4 v[156:159], v3, s[4:7], s31 offen offset:3072 sc1
    s_add_u32 s31, s31, 8192
    s_and_b32 s31, s31, 0xffff
    v_mfma_f32_16x16x32_bf16 v[204:207], v[76:79], v[168:171], v[204:207]
    v_mfma_f32_16x16x32_bf16 v[236:239], v[76:79], v[172:175], v[236:239]
    s_cmp_lt_u32 s60, 15
    s_cbranch_scc1 L_recurrent_scan__compressed_kv_cla__moe_arch_mod__prompt_kernel_rare_158
L_recurrent_scan__compressed_kv_cla__moe_arch_mod__prompt_kernel_back_159:
    s_waitcnt lgkmcnt(0)
    s_barrier
    v_mfma_f32_16x16x32_bf16 v[208:211], v[80:83], v[168:171], v[208:211]
    ds_read_b64_tr_b16 v[64:65], v50 offset:16384
    ds_read_b64_tr_b16 v[66:67], v50 offset:20480
    v_mfma_f32_16x16x32_bf16 v[240:243], v[80:83], v[172:175], v[240:243]
    ds_read_b64_tr_b16 v[68:69], v51 offset:16384
    ds_read_b64_tr_b16 v[70:71], v51 offset:20480
    s_add_u32 m0, s34, 0
    v_mfma_f32_16x16x32_bf16 v[212:215], v[84:87], v[168:171], v[212:215]
    ds_read_b64_tr_b16 v[72:73], v52 offset:16384
    ds_read_b64_tr_b16 v[74:75], v52 offset:20480
    buffer_load_dwordx4 v6, s[8:11], s32 offen offset:0 lds
    v_mfma_f32_16x16x32_bf16 v[244:247], v[84:87], v[172:175], v[244:247]
    ds_read_b64_tr_b16 v[76:77], v53 offset:16384
    ds_read_b64_tr_b16 v[78:79], v53 offset:20480
    v_mfma_f32_16x16x32_bf16 v[216:219], v[88:91], v[168:171], v[216:219]
    ds_read_b64_tr_b16 v[80:81], v54 offset:16384
    ds_read_b64_tr_b16 v[82:83], v54 offset:20480
    buffer_load_dwordx4 v7, s[8:11], s32 offen offset:1024 lds
    v_mfma_f32_16x16x32_bf16 v[248:251], v[88:91], v[172:175], v[248:251]
    v_mfma_f32_16x16x32_bf16 v[220:223], v[92:95], v[168:171], v[220:223]
    ds_read_b64_tr_b16 v[84:85], v55 offset:16384
    ds_read_b64_tr_b16 v[86:87], v55 offset:20480
    buffer_load_dwordx4 v8, s[8:11], s32 offen offset:2048 lds
    v_mfma_f32_16x16x32_bf16 v[252:255], v[92:95], v[172:175], v[252:255]
    buffer_load_dwordx4 v9, s[8:11], s32 offen offset:3072 lds
    s_add_u32 s32, s32, 131072
    s_waitcnt lgkmcnt(8)
    s_waitcnt vmcnt(22)
    v_mfma_f32_16x16x32_bf16 v[192:195], v[64:67], v[176:179], v[192:195]
    ds_read_b64_tr_b16 v[88:89], v56 offset:16384
    v_mfma_f32_16x16x32_bf16 v[224:227], v[64:67], v[180:183], v[224:227]
    ds_read_b64_tr_b16 v[90:91], v56 offset:20480
    v_mfma_f32_16x16x32_bf16 v[196:199], v[68:71], v[176:179], v[196:199]
    ds_read_b64_tr_b16 v[92:93], v57 offset:16384
    v_mfma_f32_16x16x32_bf16 v[228:231], v[68:71], v[180:183], v[228:231]
    ds_read_b64_tr_b16 v[94:95], v57 offset:20480
    buffer_load_dwordx4 v[160:163], v2, s[4:7], s31 offen offset:0 sc1
    s_waitcnt lgkmcnt(8)
    v_mfma_f32_16x16x32_bf16 v[200:203], v[72:75], v[176:179], v[200:203]
    ds_read_b64_tr_b16 v[64:65], v50 offset:24576
    v_mfma_f32_16x16x32_bf16 v[232:235], v[72:75], v[180:183], v[232:235]
    ds_read_b64_tr_b16 v[66:67], v50 offset:28672
    v_xor_b32 v50, 65536, v50
    v_mfma_f32_16x16x32_bf16 v[204:207], v[76:79], v[176:179], v[204:207]
    ds_read_b64_tr_b16 v[68:69], v51 offset:24576
    v_mfma_f32_16x16x32_bf16 v[236:239], v[76:79], v[180:183], v[236:239]
    ds_read_b64_tr_b16 v[70:71], v51 offset:28672
    v_xor_b32 v51, 65536, v51
    s_waitcnt lgkmcnt(8)
    v_mfma_f32_16x16x32_bf16 v[208:211], v[80:83], v[176:179], v[208:211]
    ds_read_b64_tr_b16 v[72:73], v52 offset:24576
    v_mfma_f32_16x16x32_bf16 v[240:243], v[80:83], v[180:183], v[240:243]
    ds_read_b64_tr_b16 v[74:75], v52 offset:28672
    v_xor_b32 v52, 65536, v52
    buffer_load_dwordx4 v[164:167], v3, s[4:7], s31 offen offset:0 sc1
    v_mfma_f32_16x16x32_bf16 v[212:215], v[84:87], v[176:179], v[212:215]
    ds_read_b64_tr_b16 v[76:77], v53 offset:24576
    v_mfma_f32_16x16x32_bf16 v[244:247], v[84:87], v[180:183], v[244:247]
    ds_read_b64_tr_b16 v[78:79], v53 offset:28672
    v_xor_b32 v53, 65536, v53
    s_waitcnt lgkmcnt(8)
    v_mfma_f32_16x16x32_bf16 v[216:219], v[88:91], v[176:179], v[216:219]
    ds_read_b64_tr_b16 v[80:81], v54 offset:24576
    v_mfma_f32_16x16x32_bf16 v[248:251], v[88:91], v[180:183], v[248:251]
    ds_read_b64_tr_b16 v[82:83], v54 offset:28672
    v_xor_b32 v54, 65536, v54
    v_mfma_f32_16x16x32_bf16 v[220:223], v[92:95], v[176:179], v[220:223]
    ds_read_b64_tr_b16 v[84:85], v55 offset:24576
    v_mfma_f32_16x16x32_bf16 v[252:255], v[92:95], v[180:183], v[252:255]
    ds_read_b64_tr_b16 v[86:87], v55 offset:28672
    v_xor_b32 v55, 65536, v55
    s_waitcnt lgkmcnt(8)
    s_waitcnt vmcnt(22)
    v_mfma_f32_16x16x32_bf16 v[192:195], v[64:67], v[184:187], v[192:195]
    ds_read_b64_tr_b16 v[88:89], v56 offset:24576
    v_mfma_f32_16x16x32_bf16 v[224:227], v[64:67], v[188:191], v[224:227]
    ds_read_b64_tr_b16 v[90:91], v56 offset:28672
    v_xor_b32 v56, 65536, v56
    buffer_load_dwordx4 v[168:171], v2, s[4:7], s31 offen offset:1024 sc1
    v_mfma_f32_16x16x32_bf16 v[196:199], v[68:71], v[184:187], v[196:199]
    ds_read_b64_tr_b16 v[92:93], v57 offset:24576
    v_mfma_f32_16x16x32_bf16 v[228:231], v[68:71], v[188:191], v[228:231]
    ds_read_b64_tr_b16 v[94:95], v57 offset:28672
    v_xor_b32 v57, 65536, v57
    s_waitcnt lgkmcnt(8)
    v_mfma_f32_16x16x32_bf16 v[200:203], v[72:75], v[184:187], v[200:203]
    v_mfma_f32_16x16x32_bf16 v[232:235], v[72:75], v[188:191], v[232:235]
    buffer_load_dwordx4 v[172:175], v3, s[4:7], s31 offen offset:1024 sc1
    v_mfma_f32_16x16x32_bf16 v[204:207], v[76:79], v[184:187], v[204:207]
    v_mfma_f32_16x16x32_bf16 v[236:239], v[76:79], v[188:191], v[236:239]
    s_cmp_lt_u32 s60, 15
    s_cbranch_scc1 L_recurrent_scan__compressed_kv_cla__moe_arch_mod__prompt_kernel_rare_168
L_recurrent_scan__compressed_kv_cla__moe_arch_mod__prompt_kernel_back_169:
    s_waitcnt lgkmcnt(0)
    s_waitcnt vmcnt(20)
    s_barrier
    v_mfma_f32_16x16x32_bf16 v[208:211], v[80:83], v[184:187], v[208:211]
    ds_read_b64_tr_b16 v[64:65], v50 offset:0
    ds_read_b64_tr_b16 v[66:67], v50 offset:4096
    v_mfma_f32_16x16x32_bf16 v[240:243], v[80:83], v[188:191], v[240:243]
    ds_read_b64_tr_b16 v[68:69], v51 offset:0
    ds_read_b64_tr_b16 v[70:71], v51 offset:4096
    s_add_u32 m0, s34, 16384
    v_mfma_f32_16x16x32_bf16 v[212:215], v[84:87], v[184:187], v[212:215]
    ds_read_b64_tr_b16 v[72:73], v52 offset:0
    ds_read_b64_tr_b16 v[74:75], v52 offset:4096
    buffer_load_dwordx4 v6, s[8:11], s32 offen offset:0 lds
    v_mfma_f32_16x16x32_bf16 v[244:247], v[84:87], v[188:191], v[244:247]
    ds_read_b64_tr_b16 v[76:77], v53 offset:0
    ds_read_b64_tr_b16 v[78:79], v53 offset:4096
    v_mfma_f32_16x16x32_bf16 v[216:219], v[88:91], v[184:187], v[216:219]
    ds_read_b64_tr_b16 v[80:81], v54 offset:0
    ds_read_b64_tr_b16 v[82:83], v54 offset:4096
    buffer_load_dwordx4 v7, s[8:11], s32 offen offset:1024 lds
    v_mfma_f32_16x16x32_bf16 v[248:251], v[88:91], v[188:191], v[248:251]
    v_mfma_f32_16x16x32_bf16 v[220:223], v[92:95], v[184:187], v[220:223]
    ds_read_b64_tr_b16 v[84:85], v55 offset:0
    ds_read_b64_tr_b16 v[86:87], v55 offset:4096
    buffer_load_dwordx4 v8, s[8:11], s32 offen offset:2048 lds
    v_mfma_f32_16x16x32_bf16 v[252:255], v[92:95], v[188:191], v[252:255]
    buffer_load_dwordx4 v9, s[8:11], s32 offen offset:3072 lds
    s_add_u32 s32, s32, 393216
    s_and_b32 s32, s32, 0x3fffff
    s_add_u32 s35, s35, 1
    s_cmp_lt_u32 s35, 3
    s_cbranch_scc1 L_p4_loop
    s_sub_u32 s36, s56, s38
    s_sub_u32 s37, s57, s38
    s_min_u32 s36, s36, s37
    s_cmp_lt_u32 s36, 16
    s_cbranch_scc1 L_recurrent_scan__compressed_kv_cla__moe_arch_mod__prompt_kernel_rare_177
L_recurrent_scan__compressed_kv_cla__moe_arch_mod__prompt_kernel_back_178:
    s_xor_b32 s37, s40, 512
    v_mov_b32 v5, s37
    s_waitcnt vmcnt(16)
    ds_read_b64 v[40:41], v17 offset:0
    ds_read_b64 v[42:43], v17 offset:32
    ds_read_b64 v[44:45], v17 offset:64
    ds_read_b64 v[46:47], v17 offset:96
    s_waitcnt lgkmcnt(12)
    v_mfma_f32_16x16x32_bf16 v[192:195], v[64:67], v[128:131], v[192:195]
    ds_read_b64_tr_b16 v[88:89], v56 offset:0
    v_mfma_f32_16x16x32_bf16 v[224:227], v[64:67], v[132:135], v[224:227]
    ds_read_b64_tr_b16 v[90:91], v56 offset:4096
    buffer_load_dwordx4 v[176:179], v2, s[4:7], s31 offen offset:2048 sc1
    v_mfma_f32_16x16x32_bf16 v[196:199], v[68:71], v[128:131], v[196:199]
    ds_read_b64_tr_b16 v[92:93], v57 offset:0
    v_mfma_f32_16x16x32_bf16 v[228:231], v[68:71], v[132:135], v[228:231]
    ds_read_b64_tr_b16 v[94:95], v57 offset:4096
    s_waitcnt lgkmcnt(12)
    v_mfma_f32_16x16x32_bf16 v[200:203], v[72:75], v[128:131], v[200:203]
    ds_read_b64_tr_b16 v[64:65], v50 offset:8192
    buffer_load_dwordx4 v[180:183], v3, s[4:7], s31 offen offset:2048 sc1
    v_mfma_f32_16x16x32_bf16 v[232:235], v[72:75], v[132:135], v[232:235]
    ds_read_b64_tr_b16 v[66:67], v50 offset:12288
    v_mfma_f32_16x16x32_bf16 v[204:207], v[76:79], v[128:131], v[204:207]
    ds_read_b64_tr_b16 v[68:69], v51 offset:8192
    v_mfma_f32_16x16x32_bf16 v[236:239], v[76:79], v[132:135], v[236:239]
    ds_read_b64_tr_b16 v[70:71], v51 offset:12288
    buffer_load_dwordx4 v[184:187], v2, s[4:7], s31 offen offset:3072 sc1
    s_waitcnt lgkmcnt(12)
    s_waitcnt lgkmcnt(8)
    v_mfma_f32_16x16x32_bf16 v[208:211], v[80:83], v[128:131], v[208:211]
    ds_read_b64_tr_b16 v[72:73], v52 offset:8192
    v_lshlrev_b32 v96, 16, v40
    v_and_b32 v97, 0xffff0000, v40
    v_sub_f32 v112, v96, v48
    v_sub_f32 v113, v97, v48
    v_mfma_f32_16x16x32_bf16 v[240:243], v[80:83], v[132:135], v[240:243]
    ds_read_b64_tr_b16 v[74:75], v52 offset:12288
    v_cvt_pk_bf16_f32 v10, v112, v113
    v_lshlrev_b32 v112, 16, v10
    v_and_b32 v113, 0xffff0000, v10
    v_mul_f32 v112, v112, v49
    v_mfma_f32_16x16x32_bf16 v[212:215], v[84:87], v[128:131], v[212:215]
    ds_read_b64_tr_b16 v[76:77], v53 offset:8192
    buffer_load_dwordx4 v[188:191], v3, s[4:7], s31 offen offset:3072 sc1
    v_mul_f32 v113, v113, v49
    v_cvt_pk_bf16_f32 v10, v112, v113
    v_mfma_f32_16x16x32_bf16 v[244:247], v[84:87], v[132:135], v[244:247]
    ds_read_b64_tr_b16 v[78:79], v53 offset:12288
    v_lshlrev_b32 v112, 16, v10
    v_and_b32 v113, 0xffff0000, v10
    v_mul_f32 v11, 0xbfb8aa3b, v112
    v_mul_f32 v12, 0xbfb8aa3b, v113
    s_barrier
    s_waitcnt lgkmcnt(8)
    v_mfma_f32_16x16x32_bf16 v[216:219], v[88:91], v[128:131], v[216:219]
    ds_read_b64_tr_b16 v[80:81], v50 offset:16384
    v_exp_f32 v11, v11
    v_exp_f32 v12, v12
    v_mfma_f32_16x16x32_bf16 v[248:251], v[88:91], v[132:135], v[248:251]
    ds_read_b64_tr_b16 v[82:83], v50 offset:20480
    v_add_f32 v11, 1.0, v11
    v_add_f32 v12, 1.0, v12
    v_rcp_f32 v11, v11
    v_rcp_f32 v12, v12
    v_mfma_f32_16x16x32_bf16 v[220:223], v[92:95], v[128:131], v[220:223]
    ds_read_b64_tr_b16 v[84:85], v51 offset:16384
    v_mul_f32 v112, v112, v11
    v_mul_f32 v113, v113, v12
    v_mfma_f32_16x16x32_bf16 v[252:255], v[92:95], v[132:135], v[252:255]
    ds_read_b64_tr_b16 v[86:87], v51 offset:20480
    v_cvt_pk_bf16_f32 v10, v112, v113
    v_lshlrev_b32 v112, 16, v10
    v_and_b32 v113, 0xffff0000, v10
    v_lshlrev_b32 v98, 16, v41
    s_waitcnt lgkmcnt(8)
    v_mfma_f32_16x16x32_bf16 v[192:195], v[64:67], v[136:139], v[192:195]
    ds_read_b64_tr_b16 v[88:89], v52 offset:16384
    v_and_b32 v99, 0xffff0000, v41
    v_sub_f32 v114, v98, v48
    v_sub_f32 v115, v99, v48
    v_cvt_pk_bf16_f32 v10, v114, v115
    v_mfma_f32_16x16x32_bf16 v[224:227], v[64:67], v[140:143], v[224:227]
    ds_read_b64_tr_b16 v[90:91], v52 offset:20480
    v_lshlrev_b32 v114, 16, v10
    v_and_b32 v115, 0xffff0000, v10
    v_mfma_f32_16x16x32_bf16 v[196:199], v[68:71], v[136:139], v[196:199]
    ds_read_b64_tr_b16 v[92:93], v53 offset:16384
    v_mul_f32 v114, v114, v49
    v_mul_f32 v115, v115, v49
    v_cvt_pk_bf16_f32 v10, v114, v115
    v_lshlrev_b32 v114, 16, v10
    v_mfma_f32_16x16x32_bf16 v[228:231], v[68:71], v[140:143], v[228:231]
    ds_read_b64_tr_b16 v[94:95], v53 offset:20480
    v_and_b32 v115, 0xffff0000, v10
    v_mul_f32 v11, 0xbfb8aa3b, v114
    s_waitcnt lgkmcnt(8)
    v_mfma_f32_16x16x32_bf16 v[200:203], v[72:75], v[136:139], v[200:203]
    ds_read_b64_tr_b16 v[64:65], v50 offset:24576
    v_mul_f32 v12, 0xbfb8aa3b, v115
    v_exp_f32 v11, v11
    v_exp_f32 v12, v12
    v_add_f32 v11, 1.0, v11
    v_mfma_f32_16x16x32_bf16 v[232:235], v[72:75], v[140:143], v[232:235]
    ds_read_b64_tr_b16 v[66:67], v50 offset:28672
    v_xor_b32 v50, 65536, v50
    v_add_f32 v12, 1.0, v12
    v_rcp_f32 v11, v11
    v_mfma_f32_16x16x32_bf16 v[204:207], v[76:79], v[136:139], v[204:207]
    ds_read_b64_tr_b16 v[68:69], v51 offset:24576
    v_rcp_f32 v12, v12
    v_mul_f32 v114, v114, v11
    v_mul_f32 v115, v115, v12
    v_cvt_pk_bf16_f32 v10, v114, v115
    v_mfma_f32_16x16x32_bf16 v[236:239], v[76:79], v[140:143], v[236:239]
    ds_read_b64_tr_b16 v[70:71], v51 offset:28672
    v_xor_b32 v51, 65536, v51
    v_lshlrev_b32 v114, 16, v10
    v_and_b32 v115, 0xffff0000, v10
    s_waitcnt lgkmcnt(8)
    s_waitcnt vmcnt(18)
    v_mfma_f32_16x16x32_bf16 v[192:195], v[80:83], v[144:147], v[192:195]
    ds_read_b64_tr_b16 v[72:73], v52 offset:24576
    v_lshlrev_b32 v100, 16, v42
    v_and_b32 v101, 0xffff0000, v42
    v_sub_f32 v116, v100, v48
    v_sub_f32 v117, v101, v48
    v_mfma_f32_16x16x32_bf16 v[224:227], v[80:83], v[148:151], v[224:227]
    ds_read_b64_tr_b16 v[74:75], v52 offset:28672
    v_xor_b32 v52, 65536, v52
    v_cvt_pk_bf16_f32 v10, v116, v117
    v_lshlrev_b32 v116, 16, v10
    v_and_b32 v117, 0xffff0000, v10
    v_mul_f32 v116, v116, v49
    v_mfma_f32_16x16x32_bf16 v[196:199], v[84:87], v[144:147], v[196:199]
    ds_read_b64_tr_b16 v[76:77], v53 offset:24576
    v_mul_f32 v117, v117, v49
    v_cvt_pk_bf16_f32 v10, v116, v117
    v_mfma_f32_16x16x32_bf16 v[228:231], v[84:87], v[148:151], v[228:231]
    ds_read_b64_tr_b16 v[78:79], v53 offset:28672
    v_xor_b32 v53, 65536, v53
    v_lshlrev_b32 v116, 16, v10
    v_and_b32 v117, 0xffff0000, v10
    v_mul_f32 v11, 0xbfb8aa3b, v116
    v_mul_f32 v12, 0xbfb8aa3b, v117
    s_waitcnt vmcnt(12)
    s_barrier
    s_waitcnt lgkmcnt(8)
    v_mfma_f32_16x16x32_bf16 v[200:203], v[88:91], v[144:147], v[200:203]
    ds_read_b64_tr_b16 v[80:81], v50 offset:0
    v_exp_f32 v11, v11
    v_exp_f32 v12, v12
    v_mfma_f32_16x16x32_bf16 v[232:235], v[88:91], v[148:151], v[232:235]
    ds_read_b64_tr_b16 v[82:83], v50 offset:4096
    v_add_f32 v11, 1.0, v11
    v_add_f32 v12, 1.0, v12
    v_rcp_f32 v11, v11
    v_rcp_f32 v12, v12
    v_mfma_f32_16x16x32_bf16 v[204:207], v[92:95], v[144:147], v[204:207]
    ds_read_b64_tr_b16 v[84:85], v51 offset:0
    v_mul_f32 v116, v116, v11
    v_mul_f32 v117, v117, v12
    v_mfma_f32_16x16x32_bf16 v[236:239], v[92:95], v[148:151], v[236:239]
    ds_read_b64_tr_b16 v[86:87], v51 offset:4096
    v_cvt_pk_bf16_f32 v10, v116, v117
    v_lshlrev_b32 v116, 16, v10
    v_and_b32 v117, 0xffff0000, v10
    v_lshlrev_b32 v102, 16, v43
    s_waitcnt lgkmcnt(8)
    v_mfma_f32_16x16x32_bf16 v[192:195], v[64:67], v[152:155], v[192:195]
    ds_read_b64_tr_b16 v[88:89], v52 offset:0
    v_and_b32 v103, 0xffff0000, v43
    v_sub_f32 v118, v102, v48
    v_sub_f32 v119, v103, v48
    v_cvt_pk_bf16_f32 v10, v118, v119
    v_mfma_f32_16x16x32_bf16 v[224:227], v[64:67], v[156:159], v[224:227]
    ds_read_b64_tr_b16 v[90:91], v52 offset:4096
    v_lshlrev_b32 v118, 16, v10
    v_and_b32 v119, 0xffff0000, v10
    v_mfma_f32_16x16x32_bf16 v[196:199], v[68:71], v[152:155], v[196:199]
    ds_read_b64_tr_b16 v[92:93], v53 offset:0
    v_mul_f32 v118, v118, v49
    v_mul_f32 v119, v119, v49
    v_cvt_pk_bf16_f32 v10, v118, v119
    v_lshlrev_b32 v118, 16, v10
    v_mfma_f32_16x16x32_bf16 v[228:231], v[68:71], v[156:159], v[228:231]
    ds_read_b64_tr_b16 v[94:95], v53 offset:4096
    v_and_b32 v119, 0xffff0000, v10
    v_mul_f32 v11, 0xbfb8aa3b, v118
    s_waitcnt lgkmcnt(8)
    v_mfma_f32_16x16x32_bf16 v[200:203], v[72:75], v[152:155], v[200:203]
    ds_read_b64_tr_b16 v[64:65], v50 offset:8192
    v_mul_f32 v12, 0xbfb8aa3b, v119
    v_exp_f32 v11, v11
    v_exp_f32 v12, v12
    v_add_f32 v11, 1.0, v11
    v_mfma_f32_16x16x32_bf16 v[232:235], v[72:75], v[156:159], v[232:235]
    ds_read_b64_tr_b16 v[66:67], v50 offset:12288
    v_add_f32 v12, 1.0, v12
    v_rcp_f32 v11, v11
    v_mfma_f32_16x16x32_bf16 v[204:207], v[76:79], v[152:155], v[204:207]
    ds_read_b64_tr_b16 v[68:69], v51 offset:8192
    v_rcp_f32 v12, v12
    v_mul_f32 v118, v118, v11
    v_mul_f32 v119, v119, v12
    v_cvt_pk_bf16_f32 v10, v118, v119
    v_mfma_f32_16x16x32_bf16 v[236:239], v[76:79], v[156:159], v[236:239]
    ds_read_b64_tr_b16 v[70:71], v51 offset:12288
    v_lshlrev_b32 v118, 16, v10
    v_and_b32 v119, 0xffff0000, v10
    s_waitcnt lgkmcnt(8)
    s_waitcnt vmcnt(10)
    v_mfma_f32_16x16x32_bf16 v[192:195], v[80:83], v[160:163], v[192:195]
    ds_read_b64_tr_b16 v[72:73], v52 offset:8192
    v_lshlrev_b32 v104, 16, v44
    v_and_b32 v105, 0xffff0000, v44
    v_sub_f32 v120, v104, v48
    v_sub_f32 v121, v105, v48
    v_mfma_f32_16x16x32_bf16 v[224:227], v[80:83], v[164:167], v[224:227]
    ds_read_b64_tr_b16 v[74:75], v52 offset:12288
    v_cvt_pk_bf16_f32 v10, v120, v121
    v_lshlrev_b32 v120, 16, v10
    v_and_b32 v121, 0xffff0000, v10
    v_mul_f32 v120, v120, v49
    v_mfma_f32_16x16x32_bf16 v[196:199], v[84:87], v[160:163], v[196:199]
    ds_read_b64_tr_b16 v[76:77], v53 offset:8192
    v_mul_f32 v121, v121, v49
    v_cvt_pk_bf16_f32 v10, v120, v121
    v_mfma_f32_16x16x32_bf16 v[228:231], v[84:87], v[164:167], v[228:231]
    ds_read_b64_tr_b16 v[78:79], v53 offset:12288
    v_lshlrev_b32 v120, 16, v10
    v_and_b32 v121, 0xffff0000, v10
    v_mul_f32 v11, 0xbfb8aa3b, v120
    v_mul_f32 v12, 0xbfb8aa3b, v121
    s_waitcnt vmcnt(4)
    s_barrier
    s_waitcnt lgkmcnt(8)
    v_mfma_f32_16x16x32_bf16 v[200:203], v[88:91], v[160:163], v[200:203]
    ds_read_b64_tr_b16 v[80:81], v50 offset:16384
    v_exp_f32 v11, v11
    v_exp_f32 v12, v12
    v_mfma_f32_16x16x32_bf16 v[232:235], v[88:91], v[164:167], v[232:235]
    ds_read_b64_tr_b16 v[82:83], v50 offset:20480
    v_add_f32 v11, 1.0, v11
    v_add_f32 v12, 1.0, v12
    v_rcp_f32 v11, v11
    v_rcp_f32 v12, v12
    v_mfma_f32_16x16x32_bf16 v[204:207], v[92:95], v[160:163], v[204:207]
    ds_read_b64_tr_b16 v[84:85], v51 offset:16384
    v_mul_f32 v120, v120, v11
    v_mul_f32 v121, v121, v12
    v_mfma_f32_16x16x32_bf16 v[236:239], v[92:95], v[164:167], v[236:239]
    ds_read_b64_tr_b16 v[86:87], v51 offset:20480
    v_cvt_pk_bf16_f32 v10, v120, v121
    v_lshlrev_b32 v120, 16, v10
    v_and_b32 v121, 0xffff0000, v10
    v_lshlrev_b32 v106, 16, v45
    s_waitcnt lgkmcnt(8)
    v_mfma_f32_16x16x32_bf16 v[192:195], v[64:67], v[168:171], v[192:195]
    ds_read_b64_tr_b16 v[88:89], v52 offset:16384
    v_and_b32 v107, 0xffff0000, v45
    v_sub_f32 v122, v106, v48
    v_sub_f32 v123, v107, v48
    v_cvt_pk_bf16_f32 v10, v122, v123
    v_mfma_f32_16x16x32_bf16 v[224:227], v[64:67], v[172:175], v[224:227]
    ds_read_b64_tr_b16 v[90:91], v52 offset:20480
    v_lshlrev_b32 v122, 16, v10
    v_and_b32 v123, 0xffff0000, v10
    v_mfma_f32_16x16x32_bf16 v[196:199], v[68:71], v[168:171], v[196:199]
    ds_read_b64_tr_b16 v[92:93], v53 offset:16384
    v_mul_f32 v122, v122, v49
    v_mul_f32 v123, v123, v49
    v_cvt_pk_bf16_f32 v10, v122, v123
    v_lshlrev_b32 v122, 16, v10
    v_mfma_f32_16x16x32_bf16 v[228:231], v[68:71], v[172:175], v[228:231]
    ds_read_b64_tr_b16 v[94:95], v53 offset:20480
    v_and_b32 v123, 0xffff0000, v10
    v_mul_f32 v11, 0xbfb8aa3b, v122
    s_waitcnt lgkmcnt(8)
    v_mfma_f32_16x16x32_bf16 v[200:203], v[72:75], v[168:171], v[200:203]
    ds_read_b64_tr_b16 v[64:65], v50 offset:24576
    v_mul_f32 v12, 0xbfb8aa3b, v123
    v_exp_f32 v11, v11
    v_exp_f32 v12, v12
    v_add_f32 v11, 1.0, v11
    v_mfma_f32_16x16x32_bf16 v[232:235], v[72:75], v[172:175], v[232:235]
    ds_read_b64_tr_b16 v[66:67], v50 offset:28672
    v_add_f32 v12, 1.0, v12
    v_rcp_f32 v11, v11
    v_mfma_f32_16x16x32_bf16 v[204:207], v[76:79], v[168:171], v[204:207]
    ds_read_b64_tr_b16 v[68:69], v51 offset:24576
    v_rcp_f32 v12, v12
    v_mul_f32 v122, v122, v11
    v_mul_f32 v123, v123, v12
    v_cvt_pk_bf16_f32 v10, v122, v123
    v_mfma_f32_16x16x32_bf16 v[236:239], v[76:79], v[172:175], v[236:239]
    ds_read_b64_tr_b16 v[70:71], v51 offset:28672
    v_lshlrev_b32 v122, 16, v10
    v_and_b32 v123, 0xffff0000, v10
    s_waitcnt lgkmcnt(8)
    s_waitcnt vmcnt(2)
    v_mfma_f32_16x16x32_bf16 v[192:195], v[80:83], v[176:179], v[192:195]
    ds_read_b64_tr_b16 v[72:73], v52 offset:24576
    v_lshlrev_b32 v108, 16, v46
    v_and_b32 v109, 0xffff0000, v46
    v_sub_f32 v124, v108, v48
    v_sub_f32 v125, v109, v48
    v_mfma_f32_16x16x32_bf16 v[224:227], v[80:83], v[180:183], v[224:227]
    ds_read_b64_tr_b16 v[74:75], v52 offset:28672
    v_cvt_pk_bf16_f32 v10, v124, v125
    v_lshlrev_b32 v124, 16, v10
    v_and_b32 v125, 0xffff0000, v10
    v_mul_f32 v124, v124, v49
    v_mfma_f32_16x16x32_bf16 v[196:199], v[84:87], v[176:179], v[196:199]
    ds_read_b64_tr_b16 v[76:77], v53 offset:24576
    v_mul_f32 v125, v125, v49
    v_cvt_pk_bf16_f32 v10, v124, v125
    v_mfma_f32_16x16x32_bf16 v[228:231], v[84:87], v[180:183], v[228:231]
    ds_read_b64_tr_b16 v[78:79], v53 offset:28672
    v_lshlrev_b32 v124, 16, v10
    v_and_b32 v125, 0xffff0000, v10
    v_mul_f32 v11, 0xbfb8aa3b, v124
    v_mul_f32 v12, 0xbfb8aa3b, v125
    s_waitcnt lgkmcnt(8)
    v_mfma_f32_16x16x32_bf16 v[200:203], v[88:91], v[176:179], v[200:203]
    ds_read_b64_tr_b16 v[80:81], v54 offset:8192
    v_exp_f32 v11, v11
    v_exp_f32 v12, v12
    v_mfma_f32_16x16x32_bf16 v[232:235], v[88:91], v[180:183], v[232:235]
    ds_read_b64_tr_b16 v[82:83], v54 offset:12288
    v_add_f32 v11, 1.0, v11
    v_add_f32 v12, 1.0, v12
    v_rcp_f32 v11, v11
    v_rcp_f32 v12, v12
    v_mfma_f32_16x16x32_bf16 v[204:207], v[92:95], v[176:179], v[204:207]
    ds_read_b64_tr_b16 v[84:85], v55 offset:8192
    v_mul_f32 v124, v124, v11
    v_mul_f32 v125, v125, v12
    v_mfma_f32_16x16x32_bf16 v[236:239], v[92:95], v[180:183], v[236:239]
    ds_read_b64_tr_b16 v[86:87], v55 offset:12288
    v_cvt_pk_bf16_f32 v10, v124, v125
    v_lshlrev_b32 v124, 16, v10
    v_and_b32 v125, 0xffff0000, v10
    v_lshlrev_b32 v110, 16, v47
    s_waitcnt lgkmcnt(8)
    s_waitcnt vmcnt(0)
    v_mfma_f32_16x16x32_bf16 v[192:195], v[64:67], v[184:187], v[192:195]
    ds_read_b64_tr_b16 v[88:89], v56 offset:8192
    v_and_b32 v111, 0xffff0000, v47
    v_sub_f32 v126, v110, v48
    v_sub_f32 v127, v111, v48
    v_cvt_pk_bf16_f32 v10, v126, v127
    v_mfma_f32_16x16x32_bf16 v[224:227], v[64:67], v[188:191], v[224:227]
    ds_read_b64_tr_b16 v[90:91], v56 offset:12288
    v_lshlrev_b32 v126, 16, v10
    v_and_b32 v127, 0xffff0000, v10
    v_mfma_f32_16x16x32_bf16 v[196:199], v[68:71], v[184:187], v[196:199]
    ds_read_b64_tr_b16 v[92:93], v57 offset:8192
    v_mul_f32 v126, v126, v49
    v_mul_f32 v127, v127, v49
    v_cvt_pk_bf16_f32 v10, v126, v127
    v_lshlrev_b32 v126, 16, v10
    v_mfma_f32_16x16x32_bf16 v[228:231], v[68:71], v[188:191], v[228:231]
    ds_read_b64_tr_b16 v[94:95], v57 offset:12288
    v_and_b32 v127, 0xffff0000, v10
    v_mul_f32 v11, 0xbfb8aa3b, v126
    s_waitcnt lgkmcnt(8)
    v_mfma_f32_16x16x32_bf16 v[200:203], v[72:75], v[184:187], v[200:203]
    ds_read_b64_tr_b16 v[64:65], v54 offset:16384
    v_mul_f32 v12, 0xbfb8aa3b, v127
    v_exp_f32 v11, v11
    v_exp_f32 v12, v12
    v_add_f32 v11, 1.0, v11
    v_mfma_f32_16x16x32_bf16 v[232:235], v[72:75], v[188:191], v[232:235]
    ds_read_b64_tr_b16 v[66:67], v54 offset:20480
    v_add_f32 v12, 1.0, v12
    v_rcp_f32 v11, v11
    v_mfma_f32_16x16x32_bf16 v[204:207], v[76:79], v[184:187], v[204:207]
    ds_read_b64_tr_b16 v[68:69], v55 offset:16384
    v_rcp_f32 v12, v12
    v_mul_f32 v126, v126, v11
    v_mul_f32 v127, v127, v12
    v_cvt_pk_bf16_f32 v10, v126, v127
    v_mfma_f32_16x16x32_bf16 v[236:239], v[76:79], v[188:191], v[236:239]
    ds_read_b64_tr_b16 v[70:71], v55 offset:20480
    v_lshlrev_b32 v126, 16, v10
    v_and_b32 v127, 0xffff0000, v10
    s_waitcnt lgkmcnt(8)
    v_mfma_f32_16x16x32_bf16 v[208:211], v[80:83], v[136:139], v[208:211]
    ds_read_b64_tr_b16 v[72:73], v56 offset:16384
    v_mfma_f32_16x16x32_bf16 v[240:243], v[80:83], v[140:143], v[240:243]
    ds_read_b64_tr_b16 v[74:75], v56 offset:20480
    v_mfma_f32_16x16x32_bf16 v[212:215], v[84:87], v[136:139], v[212:215]
    ds_read_b64_tr_b16 v[76:77], v57 offset:16384
    ds_write_b128 v20, v[224:227] offset:0
    v_mfma_f32_16x16x32_bf16 v[244:247], v[84:87], v[140:143], v[244:247]
    ds_read_b64_tr_b16 v[78:79], v57 offset:20480
    ds_write_b128 v20, v[228:231] offset:1024
    s_waitcnt lgkmcnt(10)
    v_mfma_f32_16x16x32_bf16 v[216:219], v[88:91], v[136:139], v[216:219]
    ds_read_b64_tr_b16 v[80:81], v54 offset:24576
    ds_write_b128 v20, v[232:235] offset:2048
    v_mfma_f32_16x16x32_bf16 v[248:251], v[88:91], v[140:143], v[248:251]
    ds_read_b64_tr_b16 v[82:83], v54 offset:28672
    v_xor_b32 v54, 65536, v54
    ds_write_b128 v20, v[236:239] offset:3072
    v_mfma_f32_16x16x32_bf16 v[220:223], v[92:95], v[136:139], v[220:223]
    ds_read_b64_tr_b16 v[84:85], v55 offset:24576
    v_mfma_f32_16x16x32_bf16 v[252:255], v[92:95], v[140:143], v[252:255]
    ds_read_b64_tr_b16 v[86:87], v55 offset:28672
    v_xor_b32 v55, 65536, v55
    s_waitcnt lgkmcnt(12)
    v_mfma_f32_16x16x32_bf16 v[208:211], v[64:67], v[144:147], v[208:211]
    ds_read_b64_tr_b16 v[88:89], v56 offset:24576
    v_mfma_f32_16x16x32_bf16 v[240:243], v[64:67], v[148:151], v[240:243]
    ds_read_b64_tr_b16 v[90:91], v56 offset:28672
    v_xor_b32 v56, 65536, v56
    v_mfma_f32_16x16x32_bf16 v[212:215], v[68:71], v[144:147], v[212:215]
    ds_read_b64_tr_b16 v[92:93], v57 offset:24576
    s_waitcnt lgkmcnt(5)
    s_barrier
    v_mfma_f32_16x16x32_bf16 v[244:247], v[68:71], v[148:151], v[244:247]
    ds_read_b64_tr_b16 v[94:95], v57 offset:28672
    v_xor_b32 v57, 65536, v57
    ds_read_b128 v[224:227], v21 offset:0
    ds_read_b128 v[228:231], v21 offset:1024
    v_mfma_f32_16x16x32_bf16 v[216:219], v[72:75], v[144:147], v[216:219]
    ds_read_b64_tr_b16 v[64:65], v54 offset:0
    ds_read_b128 v[232:235], v21 offset:2048
    ds_read_b128 v[236:239], v21 offset:3072
    v_mfma_f32_16x16x32_bf16 v[248:251], v[72:75], v[148:151], v[248:251]
    ds_read_b64_tr_b16 v[66:67], v54 offset:4096
    v_mfma_f32_16x16x32_bf16 v[220:223], v[76:79], v[144:147], v[220:223]
    ds_read_b64_tr_b16 v[68:69], v55 offset:0
    v_mfma_f32_16x16x32_bf16 v[252:255], v[76:79], v[148:151], v[252:255]
    ds_read_b64_tr_b16 v[70:71], v55 offset:4096
    s_waitcnt lgkmcnt(12)
    v_mfma_f32_16x16x32_bf16 v[208:211], v[80:83], v[152:155], v[208:211]
    ds_read_b64_tr_b16 v[72:73], v56 offset:0
    s_waitcnt lgkmcnt(8)
    v_add_f32 v192, v192, v224
    v_add_f32 v193, v193, v225
    v_mfma_f32_16x16x32_bf16 v[240:243], v[80:83], v[156:159], v[240:243]
    ds_read_b64_tr_b16 v[74:75], v56 offset:4096
    v_add_f32 v194, v194, v226
    v_add_f32 v195, v195, v227
    buffer_store_dwordx4 v[192:195], v22, s[24:27], s41 offen offset:0 sc1
    v_mfma_f32_16x16x32_bf16 v[212:215], v[84:87], v[152:155], v[212:215]
    ds_read_b64_tr_b16 v[76:77], v57 offset:0
    s_waitcnt lgkmcnt(9)
    v_add_f32 v196, v196, v228
    v_add_f32 v197, v197, v229
    v_mfma_f32_16x16x32_bf16 v[244:247], v[84:87], v[156:159], v[244:247]
    ds_read_b64_tr_b16 v[78:79], v57 offset:4096
    v_add_f32 v198, v198, v230
    v_add_f32 v199, v199, v231
    buffer_store_dwordx4 v[196:199], v22, s[24:27], s41 offen offset:1024 sc1
    v_mfma_f32_16x16x32_bf16 v[216:219], v[88:91], v[152:155], v[216:219]
    ds_read_b64_tr_b16 v[80:81], v54 offset:8192
    s_waitcnt lgkmcnt(9)
    v_add_f32 v200, v200, v232
    v_add_f32 v201, v201, v233
    v_mfma_f32_16x16x32_bf16 v[248:251], v[88:91], v[156:159], v[248:251]
    ds_read_b64_tr_b16 v[82:83], v54 offset:12288
    v_add_f32 v202, v202, v234
    v_add_f32 v203, v203, v235
    buffer_store_dwordx4 v[200:203], v22, s[24:27], s41 offen offset:2048 sc1
    v_mfma_f32_16x16x32_bf16 v[220:223], v[92:95], v[152:155], v[220:223]
    ds_read_b64_tr_b16 v[84:85], v55 offset:8192
    s_waitcnt lgkmcnt(10)
    v_add_f32 v204, v204, v236
    v_add_f32 v205, v205, v237
    v_mfma_f32_16x16x32_bf16 v[252:255], v[92:95], v[156:159], v[252:255]
    ds_read_b64_tr_b16 v[86:87], v55 offset:12288
    v_add_f32 v206, v206, v238
    v_add_f32 v207, v207, v239
    buffer_store_dwordx4 v[204:207], v22, s[24:27], s41 offen offset:3072 sc1
    s_waitcnt lgkmcnt(8)
    v_mfma_f32_16x16x32_bf16 v[208:211], v[64:67], v[160:163], v[208:211]
    ds_read_b64_tr_b16 v[88:89], v56 offset:8192
    v_mfma_f32_16x16x32_bf16 v[240:243], v[64:67], v[164:167], v[240:243]
    ds_read_b64_tr_b16 v[90:91], v56 offset:12288
    v_mfma_f32_16x16x32_bf16 v[212:215], v[68:71], v[160:163], v[212:215]
    ds_read_b64_tr_b16 v[92:93], v57 offset:8192
    v_mfma_f32_16x16x32_bf16 v[244:247], v[68:71], v[164:167], v[244:247]
    ds_read_b64_tr_b16 v[94:95], v57 offset:12288
    s_waitcnt lgkmcnt(8)
    v_mfma_f32_16x16x32_bf16 v[216:219], v[72:75], v[160:163], v[216:219]
    ds_read_b64_tr_b16 v[64:65], v54 offset:16384
    v_mfma_f32_16x16x32_bf16 v[248:251], v[72:75], v[164:167], v[248:251]
    ds_read_b64_tr_b16 v[66:67], v54 offset:20480
    v_mfma_f32_16x16x32_bf16 v[220:223], v[76:79], v[160:163], v[220:223]
    ds_read_b64_tr_b16 v[68:69], v55 offset:16384
    v_mfma_f32_16x16x32_bf16 v[252:255], v[76:79], v[164:167], v[252:255]
    ds_read_b64_tr_b16 v[70:71], v55 offset:20480
    s_waitcnt lgkmcnt(8)
    v_mfma_f32_16x16x32_bf16 v[208:211], v[80:83], v[168:171], v[208:211]
    ds_read_b64_tr_b16 v[72:73], v56 offset:16384
    v_mfma_f32_16x16x32_bf16 v[240:243], v[80:83], v[172:175], v[240:243]
    ds_read_b64_tr_b16 v[74:75], v56 offset:20480
    v_mfma_f32_16x16x32_bf16 v[212:215], v[84:87], v[168:171], v[212:215]
    ds_read_b64_tr_b16 v[76:77], v57 offset:16384
    v_mfma_f32_16x16x32_bf16 v[244:247], v[84:87], v[172:175], v[244:247]
    ds_read_b64_tr_b16 v[78:79], v57 offset:20480
    s_waitcnt lgkmcnt(8)
    v_mfma_f32_16x16x32_bf16 v[216:219], v[88:91], v[168:171], v[216:219]
    ds_read_b64_tr_b16 v[80:81], v54 offset:24576
    v_mfma_f32_16x16x32_bf16 v[248:251], v[88:91], v[172:175], v[248:251]
    ds_read_b64_tr_b16 v[82:83], v54 offset:28672
    v_mfma_f32_16x16x32_bf16 v[220:223], v[92:95], v[168:171], v[220:223]
    ds_read_b64_tr_b16 v[84:85], v55 offset:24576
    v_mfma_f32_16x16x32_bf16 v[252:255], v[92:95], v[172:175], v[252:255]
    ds_read_b64_tr_b16 v[86:87], v55 offset:28672
    s_waitcnt lgkmcnt(8)
    v_mfma_f32_16x16x32_bf16 v[208:211], v[64:67], v[176:179], v[208:211]
    ds_read_b64_tr_b16 v[88:89], v56 offset:24576
    v_mfma_f32_16x16x32_bf16 v[240:243], v[64:67], v[180:183], v[240:243]
    ds_read_b64_tr_b16 v[90:91], v56 offset:28672
    v_mfma_f32_16x16x32_bf16 v[212:215], v[68:71], v[176:179], v[212:215]
    ds_read_b64_tr_b16 v[92:93], v57 offset:24576
    v_mfma_f32_16x16x32_bf16 v[244:247], v[68:71], v[180:183], v[244:247]
    ds_read_b64_tr_b16 v[94:95], v57 offset:28672
    s_waitcnt lgkmcnt(8)
    v_mfma_f32_16x16x32_bf16 v[216:219], v[72:75], v[176:179], v[216:219]
    v_mfma_f32_16x16x32_bf16 v[248:251], v[72:75], v[180:183], v[248:251]
    v_mfma_f32_16x16x32_bf16 v[220:223], v[76:79], v[176:179], v[220:223]
    v_mfma_f32_16x16x32_bf16 v[252:255], v[76:79], v[180:183], v[252:255]
    s_waitcnt lgkmcnt(4)
    v_mfma_f32_16x16x32_bf16 v[208:211], v[80:83], v[184:187], v[208:211]
    v_mfma_f32_16x16x32_bf16 v[240:243], v[80:83], v[188:191], v[240:243]
    v_mfma_f32_16x16x32_bf16 v[212:215], v[84:87], v[184:187], v[212:215]
    s_lshr_b32 s36, s28, 2
    s_lshl_b32 s36, s36, 15
    s_and_b32 s37, s28, 3
    v_mfma_f32_16x16x32_bf16 v[244:247], v[84:87], v[188:191], v[244:247]
    s_lshl_b32 s37, s37, 12
    s_add_u32 s36, s36, s37
    s_add_u32 s36, s36, 65536
    s_waitcnt lgkmcnt(0)
    v_mfma_f32_16x16x32_bf16 v[216:219], v[88:91], v[184:187], v[216:219]
    v_add_u32 v20, s36, v22
    v_xor_b32 v21, 32768, v20
    v_mfma_f32_16x16x32_bf16 v[248:251], v[88:91], v[188:191], v[248:251]
    v_mfma_f32_16x16x32_bf16 v[220:223], v[92:95], v[184:187], v[220:223]
    v_mfma_f32_16x16x32_bf16 v[252:255], v[92:95], v[188:191], v[252:255]
    s_waitcnt vmcnt(0)
    v_mov_b32 v4, s40
    v_mov_b32 v13, 1
    s_mov_b64 exec, 1
    global_atomic_add v4, v13, s[90:91]
    s_mov_b64 exec, -1
    s_nop 3
    s_nop 4
    ds_write_b128 v20, v[240:243] offset:0
    ds_write_b128 v20, v[244:247] offset:1024
    ds_write_b128 v20, v[248:251] offset:2048
    ds_write_b128 v20, v[252:255] offset:3072
    s_sub_u32 s36, s56, s38
    s_sub_u32 s37, s57, s38
    s_min_u32 s36, s36, s37
    s_cmp_lt_u32 s36, 16
    s_cbranch_scc1 L_recurrent_scan__compressed_kv_cla__moe_arch_mod__prompt_kernel_rare_179
L_recurrent_scan__compressed_kv_cla__moe_arch_mod__prompt_kernel_back_180:
    s_cmp_eq_u32 s28, 3
    s_cbranch_scc1 L_recurrent_scan__compressed_kv_cla__moe_arch_mod__prompt_kernel_rare_183
L_recurrent_scan__compressed_kv_cla__moe_arch_mod__prompt_kernel_back_184:
    s_waitcnt lgkmcnt(0)
    s_barrier
    buffer_load_dwordx4 v[64:67], v22, s[24:27], s39 offen offset:0 sc1
    buffer_load_dwordx4 v[68:71], v22, s[24:27], s39 offen offset:1024 sc1
    buffer_load_dwordx4 v[72:75], v22, s[24:27], s39 offen offset:2048 sc1
    buffer_load_dwordx4 v[76:79], v22, s[24:27], s39 offen offset:3072 sc1
    ds_read_b128 v[128:131], v21 offset:0
    ds_read_b128 v[132:135], v21 offset:1024
    ds_read_b128 v[136:139], v21 offset:2048
    ds_read_b128 v[140:143], v21 offset:3072
    s_waitcnt lgkmcnt(3)
    v_pk_add_f32 v[128:129], v[128:129], v[208:209]
    v_pk_add_f32 v[130:131], v[130:131], v[210:211]
    s_waitcnt lgkmcnt(2)
    v_pk_add_f32 v[132:133], v[132:133], v[212:213]
    v_pk_add_f32 v[134:135], v[134:135], v[214:215]
    s_waitcnt lgkmcnt(1)
    v_pk_add_f32 v[136:137], v[136:137], v[216:217]
    v_pk_add_f32 v[138:139], v[138:139], v[218:219]
    s_waitcnt lgkmcnt(0)
    v_pk_add_f32 v[140:141], v[140:141], v[220:221]
    v_pk_add_f32 v[142:143], v[142:143], v[222:223]
    s_waitcnt vmcnt(3)
    v_pk_add_f32 v[128:129], v[128:129], v[64:65]
    v_cvt_pk_bf16_f32 v23, v128, v129
    v_lshlrev_b32 v128, 16, v23
    v_and_b32 v129, 0xffff0000, v23
    v_pk_mul_f32 v[128:129], v[128:129], v[112:113]
    v_cvt_pk_bf16_f32 v23, v128, v129
    v_lshlrev_b32 v128, 16, v23
    v_and_b32 v129, 0xffff0000, v23
    v_pk_add_f32 v[128:129], v[128:129], v[96:97]
    v_cvt_pk_bf16_f32 v80, v128, v129
    v_pk_add_f32 v[130:131], v[130:131], v[66:67]
    v_cvt_pk_bf16_f32 v23, v130, v131
    v_lshlrev_b32 v130, 16, v23
    v_and_b32 v131, 0xffff0000, v23
    v_pk_mul_f32 v[130:131], v[130:131], v[114:115]
    v_cvt_pk_bf16_f32 v23, v130, v131
    v_lshlrev_b32 v130, 16, v23
    v_and_b32 v131, 0xffff0000, v23
    v_pk_add_f32 v[130:131], v[130:131], v[98:99]
    v_cvt_pk_bf16_f32 v81, v130, v131
    ds_write_b64 v17, v[80:81] offset:0
    s_waitcnt vmcnt(2)
    v_pk_add_f32 v[132:133], v[132:133], v[68:69]
    v_cvt_pk_bf16_f32 v23, v132, v133
    v_lshlrev_b32 v132, 16, v23
    v_and_b32 v133, 0xffff0000, v23
    v_pk_mul_f32 v[132:133], v[132:133], v[116:117]
    v_cvt_pk_bf16_f32 v23, v132, v133
    v_lshlrev_b32 v132, 16, v23
    v_and_b32 v133, 0xffff0000, v23
    v_pk_add_f32 v[132:133], v[132:133], v[100:101]
    v_cvt_pk_bf16_f32 v82, v132, v133
    v_pk_add_f32 v[134:135], v[134:135], v[70:71]
    v_cvt_pk_bf16_f32 v23, v134, v135
    v_lshlrev_b32 v134, 16, v23
    v_and_b32 v135, 0xffff0000, v23
    v_pk_mul_f32 v[134:135], v[134:135], v[118:119]
    v_cvt_pk_bf16_f32 v23, v134, v135
    v_lshlrev_b32 v134, 16, v23
    v_and_b32 v135, 0xffff0000, v23
    v_pk_add_f32 v[134:135], v[134:135], v[102:103]
    v_cvt_pk_bf16_f32 v83, v134, v135
    ds_write_b64 v17, v[82:83] offset:32
    s_waitcnt vmcnt(1)
    v_pk_add_f32 v[136:137], v[136:137], v[72:73]
    v_cvt_pk_bf16_f32 v23, v136, v137
    v_lshlrev_b32 v136, 16, v23
    v_and_b32 v137, 0xffff0000, v23
    v_pk_mul_f32 v[136:137], v[136:137], v[120:121]
    v_cvt_pk_bf16_f32 v23, v136, v137
    v_lshlrev_b32 v136, 16, v23
    v_and_b32 v137, 0xffff0000, v23
    v_pk_add_f32 v[136:137], v[136:137], v[104:105]
    v_cvt_pk_bf16_f32 v84, v136, v137
    v_pk_add_f32 v[138:139], v[138:139], v[74:75]
    v_cvt_pk_bf16_f32 v23, v138, v139
    v_lshlrev_b32 v138, 16, v23
    v_and_b32 v139, 0xffff0000, v23
    v_pk_mul_f32 v[138:139], v[138:139], v[122:123]
    v_cvt_pk_bf16_f32 v23, v138, v139
    v_lshlrev_b32 v138, 16, v23
    v_and_b32 v139, 0xffff0000, v23
    v_pk_add_f32 v[138:139], v[138:139], v[106:107]
    v_cvt_pk_bf16_f32 v85, v138, v139
    ds_write_b64 v17, v[84:85] offset:64
    s_waitcnt vmcnt(0)
    v_pk_add_f32 v[140:141], v[140:141], v[76:77]
    v_cvt_pk_bf16_f32 v23, v140, v141
    v_lshlrev_b32 v140, 16, v23
    v_and_b32 v141, 0xffff0000, v23
    v_pk_mul_f32 v[140:141], v[140:141], v[124:125]
    v_cvt_pk_bf16_f32 v23, v140, v141
    v_lshlrev_b32 v140, 16, v23
    v_and_b32 v141, 0xffff0000, v23
    v_pk_add_f32 v[140:141], v[140:141], v[108:109]
    v_cvt_pk_bf16_f32 v86, v140, v141
    v_pk_add_f32 v[142:143], v[142:143], v[78:79]
    v_cvt_pk_bf16_f32 v23, v142, v143
    v_lshlrev_b32 v142, 16, v23
    v_and_b32 v143, 0xffff0000, v23
    v_pk_mul_f32 v[142:143], v[142:143], v[126:127]
    v_cvt_pk_bf16_f32 v23, v142, v143
    v_lshlrev_b32 v142, 16, v23
    v_and_b32 v143, 0xffff0000, v23
    v_pk_add_f32 v[142:143], v[142:143], v[110:111]
    v_cvt_pk_bf16_f32 v87, v142, v143
    ds_write_b64 v17, v[86:87] offset:96
    v_add_u32 v22, s42, v22
    s_mov_b32 s36, 16384
    s_waitcnt lgkmcnt(0)
    ds_read_b128 v[64:67], v22
    ds_read_b128 v[68:71], v22 offset:1024
    s_waitcnt lgkmcnt(1)
    buffer_store_dwordx4 v[64:67], v15, s[20:23], 0 offen sc1
    s_waitcnt lgkmcnt(0)
    buffer_store_dwordx4 v[68:71], v15, s[20:23], s36 offen sc1
    s_endpgm
L_recurrent_scan__compressed_kv_cla__moe_arch_mod__prompt_kernel_rare_143:
    v_mov_b32 v26, s40
    v_mov_b32 v28, 1
    v_writelane_b32 v26, s41, 1
    s_mov_b64 exec, 3
    global_atomic_add v26, v28, s[90:91]
    s_mov_b64 exec, -1
    s_branch L_recurrent_scan__compressed_kv_cla__moe_arch_mod__prompt_kernel_back_144
L_recurrent_scan__compressed_kv_cla__moe_arch_mod__prompt_kernel_rt1_rare_3:
    s_mov_b32 s61, 0x40000
L_recurrent_scan__compressed_kv_cla__moe_arch_mod__prompt_kernel_rt1_spin_1:
    s_sub_u32 s61, s61, 1
    s_cbranch_scc1 L_recurrent_scan__compressed_kv_cla__moe_arch_mod__prompt_kernel_rt1_spinx_2
    s_sleep 1
    global_load_dword v61, v60, s[90:91] sc1
    s_waitcnt vmcnt(0)
    v_readfirstlane_b32 s36, v61
    s_nop 0
    s_cmp_lt_u32 s36, 16
    s_cbranch_scc1 L_recurrent_scan__compressed_kv_cla__moe_arch_mod__prompt_kernel_rt1_spin_1
L_recurrent_scan__compressed_kv_cla__moe_arch_mod__prompt_kernel_rt1_spinx_2:
    s_branch L_recurrent_scan__compressed_kv_cla__moe_arch_mod__prompt_kernel_rt1_back_4
L_recurrent_scan__compressed_kv_cla__moe_arch_mod__prompt_kernel_rare_153:
    s_cmp_eq_u32 s35, 1
    s_cbranch_scc0 L_recurrent_scan__compressed_kv_cla__moe_arch_mod__prompt_kernel_swn_152
    s_cmp_eq_u32 s28, 0
    s_cbranch_scc0 L_recurrent_scan__compressed_kv_cla__moe_arch_mod__prompt_kernel_g_146
    s_and_b32 s36, s2, 15
    s_add_u32 s36, s36, 96
    s_lshl_b32 s36, s36, 7
    v_mov_b32 v26, s36
    v_mov_b32 v27, 1
    s_mov_b64 exec, 1
    global_atomic_add v26, v27, s[90:91]
    s_mov_b64 exec, -1
    s_nop 3
L_recurrent_scan__compressed_kv_cla__moe_arch_mod__prompt_kernel_g_146:
    s_branch L_recurrent_scan__compressed_kv_cla__moe_arch_mod__prompt_kernel_swend_151
L_recurrent_scan__compressed_kv_cla__moe_arch_mod__prompt_kernel_swn_152:
    s_sub_u32 s36, s56, s38
    s_sub_u32 s37, s57, s38
    s_min_u32 s36, s36, s37
    s_cmp_lt_u32 s36, 16
    s_cbranch_scc0 L_recurrent_scan__compressed_kv_cla__moe_arch_mod__prompt_kernel_nrt_147
    s_add_u32 s36, s30, 96
    s_lshl_b32 s36, s36, 7
    v_mov_b32 v60, s36
    global_load_dword v61, v60, s[90:91] sc1
L_recurrent_scan__compressed_kv_cla__moe_arch_mod__prompt_kernel_nrt_147:
    s_mov_b32 m0, s42
    s_mov_b32 s36, 15360
    buffer_load_dwordx4 v15, s[16:19], 0 offen lds
    buffer_load_dwordx4 v15, s[16:19], s36 offen offset:1024 lds
    s_mov_b32 s36, 4194304
    buffer_load_dwordx2 v[48:49], v16, s[24:27], s36 offen sc1
L_recurrent_scan__compressed_kv_cla__moe_arch_mod__prompt_kernel_swend_151:
    s_branch L_recurrent_scan__compressed_kv_cla__moe_arch_mod__prompt_kernel_back_154
L_recurrent_scan__compressed_kv_cla__moe_arch_mod__prompt_kernel_rare_156:
    s_cmp_eq_u32 s28, 0
    s_cbranch_scc0 L_recurrent_scan__compressed_kv_cla__moe_arch_mod__prompt_kernel_g_150
    s_mov_b32 s43, s38
    s_getpc_b64 s[36:37]
L_recurrent_scan__compressed_kv_cla__moe_arch_mod__prompt_kernel_pc_149:
    s_sub_u32 s36, s36, L_recurrent_scan__compressed_kv_cla__moe_arch_mod__prompt_kernel_pc_149-L_pc
    s_subb_u32 s37, s37, 0
    s_lshr_b32 s38, s2, 3
    s_lshl_b32 s38, s38, 7
    v_lshl_add_u32 v4, v1, 12, s38
    v_min_u32 v4, L_end-L_pc-4, v4
    v_mov_b32 v5, s37
    v_add_co_u32 v4, vcc, s36, v4
    s_mov_b64 exec, 0xffff
    s_nop 0
    v_addc_co_u32 v5, vcc, 0, v5, vcc
    global_load_dword v63, v[4:5], off
    s_mov_b64 exec, -1
    s_nop 1
    s_mov_b32 s38, s43
L_recurrent_scan__compressed_kv_cla__moe_arch_mod__prompt_kernel_g_150:
    s_sub_u32 s36, s56, s38
    s_sub_u32 s37, s57, s38
    s_min_u32 s36, s36, s37
    s_cmp_lt_u32 s36, 16
    s_cbranch_scc0 L_recurrent_scan__compressed_kv_cla__moe_arch_mod__prompt_kernel_nrt_148
    s_waitcnt vmcnt(16)
    v_readfirstlane_b32 s36, v61
    s_nop 0
    s_cmp_lt_u32 s36, 16
    s_cbranch_scc1 L_recurrent_scan__compressed_kv_cla__moe_arch_mod__prompt_kernel_rt1_rare_3
L_recurrent_scan__compressed_kv_cla__moe_arch_mod__prompt_kernel_rt1_back_4:
    s_lshl_b32 s37, s30, 8
    s_add_u32 s36, s37, 59768832
    s_add_u32 s37, s36, 4096
    v_and_b32 v60, 15, v1
    v_lshlrev_b32 v60, 13, v60
    v_lshl_add_u32 v60, v19, 4, v60
    buffer_load_dwordx4 v[96:99], v60, s[24:27], s36 offen offset:0 sc1
    buffer_load_dwordx4 v[100:103], v60, s[24:27], s36 offen offset:64 sc1
    buffer_load_dwordx4 v[104:107], v60, s[24:27], s36 offen offset:128 sc1
    buffer_load_dwordx4 v[108:111], v60, s[24:27], s36 offen offset:192 sc1
    buffer_load_dwordx4 v[112:115], v60, s[24:27], s37 offen offset:0 sc1
    buffer_load_dwordx4 v[116:119], v60, s[24:27], s37 offen offset:64 sc1
    buffer_load_dwordx4 v[120:123], v60, s[24:27], s37 offen offset:128 sc1
    buffer_load_dwordx4 v[124:127], v60, s[24:27], s37 offen offset:192 sc1
L_recurrent_scan__compressed_kv_cla__moe_arch_mod__prompt_kernel_nrt_148:
L_recurrent_scan__compressed_kv_cla__moe_arch_mod__prompt_kernel_swend_155:
    s_branch L_recurrent_scan__compressed_kv_cla__moe_arch_mod__prompt_kernel_back_157
L_recurrent_scan__compressed_kv_cla__moe_arch_mod__prompt_kernel_rare_158:
    global_load_dword v59, v58, s[90:91] sc1
    s_branch L_recurrent_scan__compressed_kv_cla__moe_arch_mod__prompt_kernel_back_159
L_recurrent_scan__compressed_kv_cla__moe_arch_mod__prompt_kernel_rare_168:
    s_cmp_eq_u32 s35, 0
    s_cbranch_scc0 L_recurrent_scan__compressed_kv_cla__moe_arch_mod__prompt_kernel_swn_167
    s_mov_b32 s61, 0x40000
    s_waitcnt vmcnt(8)
    s_branch L_recurrent_scan__compressed_kv_cla__moe_arch_mod__prompt_kernel_cchk_162
L_recurrent_scan__compressed_kv_cla__moe_arch_mod__prompt_kernel_cspin_160:
    s_sub_u32 s61, s61, 1
    s_cbranch_scc1 L_recurrent_scan__compressed_kv_cla__moe_arch_mod__prompt_kernel_cspinx_161
    global_load_dword v59, v58, s[90:91] sc1
    s_waitcnt vmcnt(0)
L_recurrent_scan__compressed_kv_cla__moe_arch_mod__prompt_kernel_cchk_162:
    v_cmp_le_u32 vcc, 4, v59
    s_nop 0
    s_and_b32 s60, vcc_lo, 15
    s_and_b32 s36, s60, 7
    s_cmp_eq_u32 s36, 7
    s_cbranch_scc1 L_recurrent_scan__compressed_kv_cla__moe_arch_mod__prompt_kernel_cspinx_161
    s_sleep 6
    s_branch L_recurrent_scan__compressed_kv_cla__moe_arch_mod__prompt_kernel_cspin_160
L_recurrent_scan__compressed_kv_cla__moe_arch_mod__prompt_kernel_cspinx_161:
    s_branch L_recurrent_scan__compressed_kv_cla__moe_arch_mod__prompt_kernel_swend_166
L_recurrent_scan__compressed_kv_cla__moe_arch_mod__prompt_kernel_swn_167:
    s_mov_b32 s61, 0x40000
    s_waitcnt vmcnt(8)
    s_branch L_recurrent_scan__compressed_kv_cla__moe_arch_mod__prompt_kernel_cchk_165
L_recurrent_scan__compressed_kv_cla__moe_arch_mod__prompt_kernel_cspin_163:
    s_sub_u32 s61, s61, 1
    s_cbranch_scc1 L_recurrent_scan__compressed_kv_cla__moe_arch_mod__prompt_kernel_cspinx_164
    global_load_dword v59, v58, s[90:91] sc1
    s_waitcnt vmcnt(0)
L_recurrent_scan__compressed_kv_cla__moe_arch_mod__prompt_kernel_cchk_165:
    v_cmp_le_u32 vcc, 4, v59
    s_nop 0
    s_and_b32 s60, vcc_lo, 15
    s_and_b32 s36, s60, 15
    s_cmp_eq_u32 s36, 15
    s_cbranch_scc1 L_recurrent_scan__compressed_kv_cla__moe_arch_mod__prompt_kernel_cspinx_164
    s_sleep 6
    s_branch L_recurrent_scan__compressed_kv_cla__moe_arch_mod__prompt_kernel_cspin_163
L_recurrent_scan__compressed_kv_cla__moe_arch_mod__prompt_kernel_cspinx_164:
L_recurrent_scan__compressed_kv_cla__moe_arch_mod__prompt_kernel_swend_166:
    s_branch L_recurrent_scan__compressed_kv_cla__moe_arch_mod__prompt_kernel_back_169
L_recurrent_scan__compressed_kv_cla__moe_arch_mod__prompt_kernel_f2m_170:
    v_lshrrev_b32 v28, 4, v1
    v_bfe_u32 v26, v1, 2, 2
    v_lshl_add_u32 v26, v28, 3, v26
    v_lshlrev_b32 v26, 7, v26
    v_and_b32 v27, 3, v1
    v_lshl_add_u32 v26, v27, 3, v26
    v_bfe_u32 v27, v1, 3, 2
    s_lshl_b32 s36, s28, 12
    s_add_u32 s36, s36, 131072
    v_add_u32 v26, s36, v26
    v_xor_b32 v28, 0, v27
    v_lshl_add_u32 v28, v28, 5, v26
    ds_read_b64_tr_b16 v[112:113], v28 offset:0
    ds_read_b64_tr_b16 v[114:115], v28 offset:512
    v_xor_b32 v28, 1, v27
    v_lshl_add_u32 v28, v28, 5, v26
    ds_read_b64_tr_b16 v[116:117], v28 offset:0
    ds_read_b64_tr_b16 v[118:119], v28 offset:512
    v_xor_b32 v28, 2, v27
    v_lshl_add_u32 v28, v28, 5, v26
    ds_read_b64_tr_b16 v[120:121], v28 offset:0
    ds_read_b64_tr_b16 v[122:123], v28 offset:512
    v_xor_b32 v28, 3, v27
    v_lshl_add_u32 v28, v28, 5, v26
    ds_read_b64_tr_b16 v[124:125], v28 offset:0
    ds_read_b64_tr_b16 v[126:127], v28 offset:512
    v_add_f32_dpp v96, v96, v96 row_ror:4 row_mask:0xf bank_mask:0xf
    v_add_f32_dpp v97, v97, v97 row_ror:4 row_mask:0xf bank_mask:0xf
    v_add_f32_dpp v98, v98, v98 row_ror:4 row_mask:0xf bank_mask:0xf
    v_add_f32_dpp v99, v99, v99 row_ror:4 row_mask:0xf bank_mask:0xf
    v_add_f32_dpp v100, v100, v100 row_ror:4 row_mask:0xf bank_mask:0xf
    v_add_f32_dpp v101, v101, v101 row_ror:4 row_mask:0xf bank_mask:0xf
    v_add_f32_dpp v102, v102, v102 row_ror:4 row_mask:0xf bank_mask:0xf
    v_add_f32_dpp v103, v103, v103 row_ror:4 row_mask:0xf bank_mask:0xf
    v_add_f32_dpp v96, v96, v96 row_ror:8 row_mask:0xf bank_mask:0xf
    v_add_f32_dpp v97, v97, v97 row_ror:8 row_mask:0xf bank_mask:0xf
    v_add_f32_dpp v98, v98, v98 row_ror:8 row_mask:0xf bank_mask:0xf
    v_add_f32_dpp v99, v99, v99 row_ror:8 row_mask:0xf bank_mask:0xf
    v_add_f32_dpp v100, v100, v100 row_ror:8 row_mask:0xf bank_mask:0xf
    v_add_f32_dpp v101, v101, v101 row_ror:8 row_mask:0xf bank_mask:0xf
    v_add_f32_dpp v102, v102, v102 row_ror:8 row_mask:0xf bank_mask:0xf
    v_add_f32_dpp v103, v103, v103 row_ror:8 row_mask:0xf bank_mask:0xf
    v_cvt_pk_bf16_f32 v29, v96, v97
    v_lshlrev_b32 v96, 16, v29
    v_and_b32 v97, 0xffff0000, v29
    v_cvt_pk_bf16_f32 v29, v98, v99
    v_lshlrev_b32 v98, 16, v29
    v_and_b32 v99, 0xffff0000, v29
    v_cvt_pk_bf16_f32 v29, v100, v101
    v_lshlrev_b32 v100, 16, v29
    v_and_b32 v101, 0xffff0000, v29
    v_cvt_pk_bf16_f32 v29, v102, v103
    v_lshlrev_b32 v102, 16, v29
    v_and_b32 v103, 0xffff0000, v29
    v_mul_f32 v104, 0xbfb8aa3b, v96
    v_mul_f32 v105, 0xbfb8aa3b, v97
    v_mul_f32 v106, 0xbfb8aa3b, v98
    v_mul_f32 v107, 0xbfb8aa3b, v99
    v_mul_f32 v108, 0xbfb8aa3b, v100
    v_mul_f32 v109, 0xbfb8aa3b, v101
    v_mul_f32 v110, 0xbfb8aa3b, v102
    v_mul_f32 v111, 0xbfb8aa3b, v103
    v_exp_f32 v104, v104
    v_exp_f32 v105, v105
    v_exp_f32 v106, v106
    v_exp_f32 v107, v107
    v_exp_f32 v108, v108
    v_exp_f32 v109, v109
    v_exp_f32 v110, v110
    v_exp_f32 v111, v111
    v_add_f32 v104, 1.0, v104
    v_add_f32 v105, 1.0, v105
    v_add_f32 v106, 1.0, v106
    v_add_f32 v107, 1.0, v107
    v_add_f32 v108, 1.0, v108
    v_add_f32 v109, 1.0, v109
    v_add_f32 v110, 1.0, v110
    v_add_f32 v111, 1.0, v111
    v_rcp_f32 v104, v104
    v_rcp_f32 v105, v105
    v_rcp_f32 v106, v106
    v_rcp_f32 v107, v107
    v_rcp_f32 v108, v108
    v_rcp_f32 v109, v109
    v_rcp_f32 v110, v110
    v_rcp_f32 v111, v111
    v_mul_f32 v104, v96, v104
    v_mul_f32 v105, v97, v105
    v_mul_f32 v106, v98, v106
    v_mul_f32 v107, v99, v107
    v_mul_f32 v108, v100, v108
    v_mul_f32 v109, v101, v109
    v_mul_f32 v110, v102, v110
    v_mul_f32 v111, v103, v111
    v_cvt_pk_bf16_f32 v29, v104, v105
    v_lshlrev_b32 v104, 16, v29
    v_and_b32 v105, 0xffff0000, v29
    v_cvt_pk_bf16_f32 v29, v106, v107
    v_lshlrev_b32 v106, 16, v29
    v_and_b32 v107, 0xffff0000, v29
    v_cvt_pk_bf16_f32 v29, v108, v109
    v_lshlrev_b32 v108, 16, v29
    v_and_b32 v109, 0xffff0000, v29
    v_cvt_pk_bf16_f32 v29, v110, v111
    v_lshlrev_b32 v110, 16, v29
    v_and_b32 v111, 0xffff0000, v29
    v_mul_f32_dpp v96, v96, v104 quad_perm:[2,3,0,1] row_mask:0xf bank_mask:0xf
    v_mul_f32_dpp v97, v97, v105 quad_perm:[2,3,0,1] row_mask:0xf bank_mask:0xf
    v_mul_f32_dpp v98, v98, v106 quad_perm:[2,3,0,1] row_mask:0xf bank_mask:0xf
    v_mul_f32_dpp v99, v99, v107 quad_perm:[2,3,0,1] row_mask:0xf bank_mask:0xf
    v_mul_f32_dpp v100, v100, v108 quad_perm:[2,3,0,1] row_mask:0xf bank_mask:0xf
    v_mul_f32_dpp v101, v101, v109 quad_perm:[2,3,0,1] row_mask:0xf bank_mask:0xf
    v_mul_f32_dpp v102, v102, v110 quad_perm:[2,3,0,1] row_mask:0xf bank_mask:0xf
    v_mul_f32_dpp v103, v103, v111 quad_perm:[2,3,0,1] row_mask:0xf bank_mask:0xf
    v_cvt_pk_bf16_f32 v36, v96, v97
    v_cvt_pk_bf16_f32 v37, v98, v99
    v_cvt_pk_bf16_f32 v38, v100, v101
    v_cvt_pk_bf16_f32 v39, v102, v103
    s_waitcnt lgkmcnt(0)
    v_lshl_add_u32 v28, v1, 4, s36
    v_mfma_f32_16x16x32_bf16 v[96:99], v[112:115], v[36:39], 0
    v_mfma_f32_16x16x32_bf16 v[100:103], v[116:119], v[36:39], 0
    v_mfma_f32_16x16x32_bf16 v[104:107], v[120:123], v[36:39], 0
    v_mfma_f32_16x16x32_bf16 v[108:111], v[124:127], v[36:39], 0
    s_nop 7
    ds_write_b128 v28, v[96:99] offset:0
    ds_write_b128 v28, v[100:103] offset:1024
    ds_write_b128 v28, v[104:107] offset:2048
    ds_write_b128 v28, v[108:111] offset:3072
    s_cmp_lt_u32 s28, 4
    s_cbranch_scc1 L_recurrent_scan__compressed_kv_cla__moe_arch_mod__prompt_kernel_f2b_172
    s_branch L_recurrent_scan__compressed_kv_cla__moe_arch_mod__prompt_kernel_f2a_171
L_recurrent_scan__compressed_kv_cla__moe_arch_mod__prompt_kernel_rare_177:
    v_mov_b64 v[24:25], 0
    v_mov_b64 v[26:27], 0
    v_mov_b64 v[28:29], 0
    v_mov_b64 v[30:31], 0
    v_mov_b64 v[32:33], 0
    v_mov_b64 v[34:35], 0
    v_mov_b64 v[36:37], 0
    v_mov_b64 v[38:39], 0
    s_waitcnt vmcnt(16)
    s_sub_u32 s36, s56, s38
    s_cmp_lt_u32 s36, 16
    s_cbranch_scc0 L_recurrent_scan__compressed_kv_cla__moe_arch_mod__prompt_kernel_rt2_noy_1
    s_and_b32 s36, s58, 0xffff0000
    s_cmp_lt_i32 s36, 0
    s_cselect_b32 s37, 0x80000000, -1
    s_xor_b32 s36, s36, s37
    s_and_b32 s36, s36, 0xffff0000
    v_mov_b32 v62, s36
    v_mul_f32 v62, 0xbfb8aa3b, v62
    v_exp_f32 v62, v62
    s_nop 0
    v_add_f32 v62, 1.0, v62
    v_rcp_f32 v62, v62
    s_nop 0
    v_cvt_pk_bf16_f32 v62, v62, v62
    v_lshlrev_b32 v62, 16, v62
    v_add_f32_dpp v96, v96, v96 quad_perm:[1,0,3,2] row_mask:0xf bank_mask:0xf
    v_add_f32_dpp v97, v97, v97 quad_perm:[1,0,3,2] row_mask:0xf bank_mask:0xf
    v_add_f32_dpp v98, v98, v98 quad_perm:[1,0,3,2] row_mask:0xf bank_mask:0xf
    v_add_f32_dpp v99, v99, v99 quad_perm:[1,0,3,2] row_mask:0xf bank_mask:0xf
    v_add_f32_dpp v100, v100, v100 quad_perm:[1,0,3,2] row_mask:0xf bank_mask:0xf
    v_add_f32_dpp v101, v101, v101 quad_perm:[1,0,3,2] row_mask:0xf bank_mask:0xf
    v_add_f32_dpp v102, v102, v102 quad_perm:[1,0,3,2] row_mask:0xf bank_mask:0xf
    v_add_f32_dpp v103, v103, v103 quad_perm:[1,0,3,2] row_mask:0xf bank_mask:0xf
    v_add_f32_dpp v104, v104, v104 quad_perm:[1,0,3,2] row_mask:0xf bank_mask:0xf
    v_add_f32_dpp v105, v105, v105 quad_perm:[1,0,3,2] row_mask:0xf bank_mask:0xf
    v_add_f32_dpp v106, v106, v106 quad_perm:[1,0,3,2] row_mask:0xf bank_mask:0xf
    v_add_f32_dpp v107, v107, v107 quad_perm:[1,0,3,2] row_mask:0xf bank_mask:0xf
    v_add_f32_dpp v108, v108, v108 quad_perm:[1,0,3,2] row_mask:0xf bank_mask:0xf
    v_add_f32_dpp v109, v109, v109 quad_perm:[1,0,3,2] row_mask:0xf bank_mask:0xf
    v_add_f32_dpp v110, v110, v110 quad_perm:[1,0,3,2] row_mask:0xf bank_mask:0xf
    v_add_f32_dpp v111, v111, v111 quad_perm:[1,0,3,2] row_mask:0xf bank_mask:0xf
    v_add_f32_dpp v96, v96, v96 quad_perm:[2,3,0,1] row_mask:0xf bank_mask:0xf
    v_add_f32_dpp v97, v97, v97 quad_perm:[2,3,0,1] row_mask:0xf bank_mask:0xf
    v_add_f32_dpp v98, v98, v98 quad_perm:[2,3,0,1] row_mask:0xf bank_mask:0xf
    v_add_f32_dpp v99, v99, v99 quad_perm:[2,3,0,1] row_mask:0xf bank_mask:0xf
    v_add_f32_dpp v100, v100, v100 quad_perm:[2,3,0,1] row_mask:0xf bank_mask:0xf
    v_add_f32_dpp v101, v101, v101 quad_perm:[2,3,0,1] row_mask:0xf bank_mask:0xf
    v_add_f32_dpp v102, v102, v102 quad_perm:[2,3,0,1] row_mask:0xf bank_mask:0xf
    v_add_f32_dpp v103, v103, v103 quad_perm:[2,3,0,1] row_mask:0xf bank_mask:0xf
    v_add_f32_dpp v104, v104, v104 quad_perm:[2,3,0,1] row_mask:0xf bank_mask:0xf
    v_add_f32_dpp v105, v105, v105 quad_perm:[2,3,0,1] row_mask:0xf bank_mask:0xf
    v_add_f32_dpp v106, v106, v106 quad_perm:[2,3,0,1] row_mask:0xf bank_mask:0xf
    v_add_f32_dpp v107, v107, v107 quad_perm:[2,3,0,1] row_mask:0xf bank_mask:0xf
    v_add_f32_dpp v108, v108, v108 quad_perm:[2,3,0,1] row_mask:0xf bank_mask:0xf
    v_add_f32_dpp v109, v109, v109 quad_perm:[2,3,0,1] row_mask:0xf bank_mask:0xf
    v_add_f32_dpp v110, v110, v110 quad_perm:[2,3,0,1] row_mask:0xf bank_mask:0xf
    v_add_f32_dpp v111, v111, v111 quad_perm:[2,3,0,1] row_mask:0xf bank_mask:0xf
    v_add_f32_dpp v96, v96, v96 row_half_mirror row_mask:0xf bank_mask:0xf
    v_add_f32_dpp v97, v97, v97 row_half_mirror row_mask:0xf bank_mask:0xf
    v_add_f32_dpp v98, v98, v98 row_half_mirror row_mask:0xf bank_mask:0xf
    v_add_f32_dpp v99, v99, v99 row_half_mirror row_mask:0xf bank_mask:0xf
    v_add_f32_dpp v100, v100, v100 row_half_mirror row_mask:0xf bank_mask:0xf
    v_add_f32_dpp v101, v101, v101 row_half_mirror row_mask:0xf bank_mask:0xf
    v_add_f32_dpp v102, v102, v102 row_half_mirror row_mask:0xf bank_mask:0xf
    v_add_f32_dpp v103, v103, v103 row_half_mirror row_mask:0xf bank_mask:0xf
    v_add_f32_dpp v104, v104, v104 row_half_mirror row_mask:0xf bank_mask:0xf
    v_add_f32_dpp v105, v105, v105 row_half_mirror row_mask:0xf bank_mask:0xf
    v_add_f32_dpp v106, v106, v106 row_half_mirror row_mask:0xf bank_mask:0xf
    v_add_f32_dpp v107, v107, v107 row_half_mirror row_mask:0xf bank_mask:0xf
    v_add_f32_dpp v108, v108, v108 row_half_mirror row_mask:0xf bank_mask:0xf
    v_add_f32_dpp v109, v109, v109 row_half_mirror row_mask:0xf bank_mask:0xf
    v_add_f32_dpp v110, v110, v110 row_half_mirror row_mask:0xf bank_mask:0xf
    v_add_f32_dpp v111, v111, v111 row_half_mirror row_mask:0xf bank_mask:0xf
    v_add_f32_dpp v96, v96, v96 row_mirror row_mask:0xf bank_mask:0xf
    v_add_f32_dpp v97, v97, v97 row_mirror row_mask:0xf bank_mask:0xf
    v_add_f32_dpp v98, v98, v98 row_mirror row_mask:0xf bank_mask:0xf
    v_add_f32_dpp v99, v99, v99 row_mirror row_mask:0xf bank_mask:0xf
    v_add_f32_dpp v100, v100, v100 row_mirror row_mask:0xf bank_mask:0xf
    v_add_f32_dpp v101, v101, v101 row_mirror row_mask:0xf bank_mask:0xf
    v_add_f32_dpp v102, v102, v102 row_mirror row_mask:0xf bank_mask:0xf
    v_add_f32_dpp v103, v103, v103 row_mirror row_mask:0xf bank_mask:0xf
    v_add_f32_dpp v104, v104, v104 row_mirror row_mask:0xf bank_mask:0xf
    v_add_f32_dpp v105, v105, v105 row_mirror row_mask:0xf bank_mask:0xf
    v_add_f32_dpp v106, v106, v106 row_mirror row_mask:0xf bank_mask:0xf
    v_add_f32_dpp v107, v107, v107 row_mirror row_mask:0xf bank_mask:0xf
    v_add_f32_dpp v108, v108, v108 row_mirror row_mask:0xf bank_mask:0xf
    v_add_f32_dpp v109, v109, v109 row_mirror row_mask:0xf bank_mask:0xf
    v_add_f32_dpp v110, v110, v110 row_mirror row_mask:0xf bank_mask:0xf
    v_add_f32_dpp v111, v111, v111 row_mirror row_mask:0xf bank_mask:0xf
    v_cmp_eq_u32 vcc, s56, v14
    v_cvt_pk_bf16_f32 v63, v96, v97
    v_lshlrev_b32 v96, 16, v63
    v_and_b32 v97, 0xffff0000, v63
    v_mul_f32 v96, v62, v96
    v_mul_f32 v97, v62, v97
    v_cvt_pk_bf16_f32 v63, v96, v97
    v_lshlrev_b32 v96, 16, v63
    v_and_b32 v97, 0xffff0000, v63
    v_cndmask_b32 v24, v24, v96, vcc
    v_cndmask_b32 v25, v25, v97, vcc
    v_cvt_pk_bf16_f32 v63, v98, v99
    v_lshlrev_b32 v98, 16, v63
    v_and_b32 v99, 0xffff0000, v63
    v_mul_f32 v98, v62, v98
    v_mul_f32 v99, v62, v99
    v_cvt_pk_bf16_f32 v63, v98, v99
    v_lshlrev_b32 v98, 16, v63
    v_and_b32 v99, 0xffff0000, v63
    v_cndmask_b32 v26, v26, v98, vcc
    v_cndmask_b32 v27, v27, v99, vcc
    v_cvt_pk_bf16_f32 v63, v100, v101
    v_lshlrev_b32 v100, 16, v63
    v_and_b32 v101, 0xffff0000, v63
    v_mul_f32 v100, v62, v100
    v_mul_f32 v101, v62, v101
    v_cvt_pk_bf16_f32 v63, v100, v101
    v_lshlrev_b32 v100, 16, v63
    v_and_b32 v101, 0xffff0000, v63
    v_cndmask_b32 v28, v28, v100, vcc
    v_cndmask_b32 v29, v29, v101, vcc
    v_cvt_pk_bf16_f32 v63, v102, v103
    v_lshlrev_b32 v102, 16, v63
    v_and_b32 v103, 0xffff0000, v63
    v_mul_f32 v102, v62, v102
    v_mul_f32 v103, v62, v103
    v_cvt_pk_bf16_f32 v63, v102, v103
    v_lshlrev_b32 v102, 16, v63
    v_and_b32 v103, 0xffff0000, v63
    v_cndmask_b32 v30, v30, v102, vcc
    v_cndmask_b32 v31, v31, v103, vcc
    v_cvt_pk_bf16_f32 v63, v104, v105
    v_lshlrev_b32 v104, 16, v63
    v_and_b32 v105, 0xffff0000, v63
    v_mul_f32 v104, v62, v104
    v_mul_f32 v105, v62, v105
    v_cvt_pk_bf16_f32 v63, v104, v105
    v_lshlrev_b32 v104, 16, v63
    v_and_b32 v105, 0xffff0000, v63
    v_cndmask_b32 v32, v32, v104, vcc
    v_cndmask_b32 v33, v33, v105, vcc
    v_cvt_pk_bf16_f32 v63, v106, v107
    v_lshlrev_b32 v106, 16, v63
    v_and_b32 v107, 0xffff0000, v63
    v_mul_f32 v106, v62, v106
    v_mul_f32 v107, v62, v107
    v_cvt_pk_bf16_f32 v63, v106, v107
    v_lshlrev_b32 v106, 16, v63
    v_and_b32 v107, 0xffff0000, v63
    v_cndmask_b32 v34, v34, v106, vcc
    v_cndmask_b32 v35, v35, v107, vcc
    v_cvt_pk_bf16_f32 v63, v108, v109
    v_lshlrev_b32 v108, 16, v63
    v_and_b32 v109, 0xffff0000, v63
    v_mul_f32 v108, v62, v108
    v_mul_f32 v109, v62, v109
    v_cvt_pk_bf16_f32 v63, v108, v109
    v_lshlrev_b32 v108, 16, v63
    v_and_b32 v109, 0xffff0000, v63
    v_cndmask_b32 v36, v36, v108, vcc
    v_cndmask_b32 v37, v37, v109, vcc
    v_cvt_pk_bf16_f32 v63, v110, v111
    v_lshlrev_b32 v110, 16, v63
    v_and_b32 v111, 0xffff0000, v63
    v_mul_f32 v110, v62, v110
    v_mul_f32 v111, v62, v111
    v_cvt_pk_bf16_f32 v63, v110, v111
    v_lshlrev_b32 v110, 16, v63
    v_and_b32 v111, 0xffff0000, v63
    v_cndmask_b32 v38, v38, v110, vcc
    v_cndmask_b32 v39, v39, v111, vcc
L_recurrent_scan__compressed_kv_cla__moe_arch_mod__prompt_kernel_rt2_noy_1:
    s_sub_u32 s36, s57, s38
    s_cmp_lt_u32 s36, 16
    s_cbranch_scc0 L_recurrent_scan__compressed_kv_cla__moe_arch_mod__prompt_kernel_rt2_noy_2
    s_and_b32 s36, s59, 0xffff0000
    s_cmp_lt_i32 s36, 0
    s_cselect_b32 s37, 0x80000000, -1
    s_xor_b32 s36, s36, s37
    s_and_b32 s36, s36, 0xffff0000
    v_mov_b32 v62, s36
    v_mul_f32 v62, 0xbfb8aa3b, v62
    v_exp_f32 v62, v62
    s_nop 0
    v_add_f32 v62, 1.0, v62
    v_rcp_f32 v62, v62
    s_nop 0
    v_cvt_pk_bf16_f32 v62, v62, v62
    v_lshlrev_b32 v62, 16, v62
    v_add_f32_dpp v112, v112, v112 quad_perm:[1,0,3,2] row_mask:0xf bank_mask:0xf
    v_add_f32_dpp v113, v113, v113 quad_perm:[1,0,3,2] row_mask:0xf bank_mask:0xf
    v_add_f32_dpp v114, v114, v114 quad_perm:[1,0,3,2] row_mask:0xf bank_mask:0xf
    v_add_f32_dpp v115, v115, v115 quad_perm:[1,0,3,2] row_mask:0xf bank_mask:0xf
    v_add_f32_dpp v116, v116, v116 quad_perm:[1,0,3,2] row_mask:0xf bank_mask:0xf
    v_add_f32_dpp v117, v117, v117 quad_perm:[1,0,3,2] row_mask:0xf bank_mask:0xf
    v_add_f32_dpp v118, v118, v118 quad_perm:[1,0,3,2] row_mask:0xf bank_mask:0xf
    v_add_f32_dpp v119, v119, v119 quad_perm:[1,0,3,2] row_mask:0xf bank_mask:0xf
    v_add_f32_dpp v120, v120, v120 quad_perm:[1,0,3,2] row_mask:0xf bank_mask:0xf
    v_add_f32_dpp v121, v121, v121 quad_perm:[1,0,3,2] row_mask:0xf bank_mask:0xf
    v_add_f32_dpp v122, v122, v122 quad_perm:[1,0,3,2] row_mask:0xf bank_mask:0xf
    v_add_f32_dpp v123, v123, v123 quad_perm:[1,0,3,2] row_mask:0xf bank_mask:0xf
    v_add_f32_dpp v124, v124, v124 quad_perm:[1,0,3,2] row_mask:0xf bank_mask:0xf
    v_add_f32_dpp v125, v125, v125 quad_perm:[1,0,3,2] row_mask:0xf bank_mask:0xf
    v_add_f32_dpp v126, v126, v126 quad_perm:[1,0,3,2] row_mask:0xf bank_mask:0xf
    v_add_f32_dpp v127, v127, v127 quad_perm:[1,0,3,2] row_mask:0xf bank_mask:0xf
    v_add_f32_dpp v112, v112, v112 quad_perm:[2,3,0,1] row_mask:0xf bank_mask:0xf
    v_add_f32_dpp v113, v113, v113 quad_perm:[2,3,0,1] row_mask:0xf bank_mask:0xf
    v_add_f32_dpp v114, v114, v114 quad_perm:[2,3,0,1] row_mask:0xf bank_mask:0xf
    v_add_f32_dpp v115, v115, v115 quad_perm:[2,3,0,1] row_mask:0xf bank_mask:0xf
    v_add_f32_dpp v116, v116, v116 quad_perm:[2,3,0,1] row_mask:0xf bank_mask:0xf
    v_add_f32_dpp v117, v117, v117 quad_perm:[2,3,0,1] row_mask:0xf bank_mask:0xf
    v_add_f32_dpp v118, v118, v118 quad_perm:[2,3,0,1] row_mask:0xf bank_mask:0xf
    v_add_f32_dpp v119, v119, v119 quad_perm:[2,3,0,1] row_mask:0xf bank_mask:0xf
    v_add_f32_dpp v120, v120, v120 quad_perm:[2,3,0,1] row_mask:0xf bank_mask:0xf
    v_add_f32_dpp v121, v121, v121 quad_perm:[2,3,0,1] row_mask:0xf bank_mask:0xf
    v_add_f32_dpp v122, v122, v122 quad_perm:[2,3,0,1] row_mask:0xf bank_mask:0xf
    v_add_f32_dpp v123, v123, v123 quad_perm:[2,3,0,1] row_mask:0xf bank_mask:0xf
    v_add_f32_dpp v124, v124, v124 quad_perm:[2,3,0,1] row_mask:0xf bank_mask:0xf
    v_add_f32_dpp v125, v125, v125 quad_perm:[2,3,0,1] row_mask:0xf bank_mask:0xf
    v_add_f32_dpp v126, v126, v126 quad_perm:[2,3,0,1] row_mask:0xf bank_mask:0xf
    v_add_f32_dpp v127, v127, v127 quad_perm:[2,3,0,1] row_mask:0xf bank_mask:0xf
    v_add_f32_dpp v112, v112, v112 row_half_mirror row_mask:0xf bank_mask:0xf
    v_add_f32_dpp v113, v113, v113 row_half_mirror row_mask:0xf bank_mask:0xf
    v_add_f32_dpp v114, v114, v114 row_half_mirror row_mask:0xf bank_mask:0xf
    v_add_f32_dpp v115, v115, v115 row_half_mirror row_mask:0xf bank_mask:0xf
    v_add_f32_dpp v116, v116, v116 row_half_mirror row_mask:0xf bank_mask:0xf
    v_add_f32_dpp v117, v117, v117 row_half_mirror row_mask:0xf bank_mask:0xf
    v_add_f32_dpp v118, v118, v118 row_half_mirror row_mask:0xf bank_mask:0xf
    v_add_f32_dpp v119, v119, v119 row_half_mirror row_mask:0xf bank_mask:0xf
    v_add_f32_dpp v120, v120, v120 row_half_mirror row_mask:0xf bank_mask:0xf
    v_add_f32_dpp v121, v121, v121 row_half_mirror row_mask:0xf bank_mask:0xf
    v_add_f32_dpp v122, v122, v122 row_half_mirror row_mask:0xf bank_mask:0xf
    v_add_f32_dpp v123, v123, v123 row_half_mirror row_mask:0xf bank_mask:0xf
    v_add_f32_dpp v124, v124, v124 row_half_mirror row_mask:0xf bank_mask:0xf
    v_add_f32_dpp v125, v125, v125 row_half_mirror row_mask:0xf bank_mask:0xf
    v_add_f32_dpp v126, v126, v126 row_half_mirror row_mask:0xf bank_mask:0xf
    v_add_f32_dpp v127, v127, v127 row_half_mirror row_mask:0xf bank_mask:0xf
    v_add_f32_dpp v112, v112, v112 row_mirror row_mask:0xf bank_mask:0xf
    v_add_f32_dpp v113, v113, v113 row_mirror row_mask:0xf bank_mask:0xf
    v_add_f32_dpp v114, v114, v114 row_mirror row_mask:0xf bank_mask:0xf
    v_add_f32_dpp v115, v115, v115 row_mirror row_mask:0xf bank_mask:0xf
    v_add_f32_dpp v116, v116, v116 row_mirror row_mask:0xf bank_mask:0xf
    v_add_f32_dpp v117, v117, v117 row_mirror row_mask:0xf bank_mask:0xf
    v_add_f32_dpp v118, v118, v118 row_mirror row_mask:0xf bank_mask:0xf
    v_add_f32_dpp v119, v119, v119 row_mirror row_mask:0xf bank_mask:0xf
    v_add_f32_dpp v120, v120, v120 row_mirror row_mask:0xf bank_mask:0xf
    v_add_f32_dpp v121, v121, v121 row_mirror row_mask:0xf bank_mask:0xf
    v_add_f32_dpp v122, v122, v122 row_mirror row_mask:0xf bank_mask:0xf
    v_add_f32_dpp v123, v123, v123 row_mirror row_mask:0xf bank_mask:0xf
    v_add_f32_dpp v124, v124, v124 row_mirror row_mask:0xf bank_mask:0xf
    v_add_f32_dpp v125, v125, v125 row_mirror row_mask:0xf bank_mask:0xf
    v_add_f32_dpp v126, v126, v126 row_mirror row_mask:0xf bank_mask:0xf
    v_add_f32_dpp v127, v127, v127 row_mirror row_mask:0xf bank_mask:0xf
    v_cmp_eq_u32 vcc, s57, v14
    v_cvt_pk_bf16_f32 v63, v112, v113
    v_lshlrev_b32 v112, 16, v63
    v_and_b32 v113, 0xffff0000, v63
    v_mul_f32 v112, v62, v112
    v_mul_f32 v113, v62, v113
    v_cvt_pk_bf16_f32 v63, v112, v113
    v_lshlrev_b32 v112, 16, v63
    v_and_b32 v113, 0xffff0000, v63
    v_cndmask_b32 v24, v24, v112, vcc
    v_cndmask_b32 v25, v25, v113, vcc
    v_cvt_pk_bf16_f32 v63, v114, v115
    v_lshlrev_b32 v114, 16, v63
    v_and_b32 v115, 0xffff0000, v63
    v_mul_f32 v114, v62, v114
    v_mul_f32 v115, v62, v115
    v_cvt_pk_bf16_f32 v63, v114, v115
    v_lshlrev_b32 v114, 16, v63
    v_and_b32 v115, 0xffff0000, v63
    v_cndmask_b32 v26, v26, v114, vcc
    v_cndmask_b32 v27, v27, v115, vcc
    v_cvt_pk_bf16_f32 v63, v116, v117
    v_lshlrev_b32 v116, 16, v63
    v_and_b32 v117, 0xffff0000, v63
    v_mul_f32 v116, v62, v116
    v_mul_f32 v117, v62, v117
    v_cvt_pk_bf16_f32 v63, v116, v117
    v_lshlrev_b32 v116, 16, v63
    v_and_b32 v117, 0xffff0000, v63
    v_cndmask_b32 v28, v28, v116, vcc
    v_cndmask_b32 v29, v29, v117, vcc
    v_cvt_pk_bf16_f32 v63, v118, v119
    v_lshlrev_b32 v118, 16, v63
    v_and_b32 v119, 0xffff0000, v63
    v_mul_f32 v118, v62, v118
    v_mul_f32 v119, v62, v119
    v_cvt_pk_bf16_f32 v63, v118, v119
    v_lshlrev_b32 v118, 16, v63
    v_and_b32 v119, 0xffff0000, v63
    v_cndmask_b32 v30, v30, v118, vcc
    v_cndmask_b32 v31, v31, v119, vcc
    v_cvt_pk_bf16_f32 v63, v120, v121
    v_lshlrev_b32 v120, 16, v63
    v_and_b32 v121, 0xffff0000, v63
    v_mul_f32 v120, v62, v120
    v_mul_f32 v121, v62, v121
    v_cvt_pk_bf16_f32 v63, v120, v121
    v_lshlrev_b32 v120, 16, v63
    v_and_b32 v121, 0xffff0000, v63
    v_cndmask_b32 v32, v32, v120, vcc
    v_cndmask_b32 v33, v33, v121, vcc
    v_cvt_pk_bf16_f32 v63, v122, v123
    v_lshlrev_b32 v122, 16, v63
    v_and_b32 v123, 0xffff0000, v63
    v_mul_f32 v122, v62, v122
    v_mul_f32 v123, v62, v123
    v_cvt_pk_bf16_f32 v63, v122, v123
    v_lshlrev_b32 v122, 16, v63
    v_and_b32 v123, 0xffff0000, v63
    v_cndmask_b32 v34, v34, v122, vcc
    v_cndmask_b32 v35, v35, v123, vcc
    v_cvt_pk_bf16_f32 v63, v124, v125
    v_lshlrev_b32 v124, 16, v63
    v_and_b32 v125, 0xffff0000, v63
    v_mul_f32 v124, v62, v124
    v_mul_f32 v125, v62, v125
    v_cvt_pk_bf16_f32 v63, v124, v125
    v_lshlrev_b32 v124, 16, v63
    v_and_b32 v125, 0xffff0000, v63
    v_cndmask_b32 v36, v36, v124, vcc
    v_cndmask_b32 v37, v37, v125, vcc
    v_cvt_pk_bf16_f32 v63, v126, v127
    v_lshlrev_b32 v126, 16, v63
    v_and_b32 v127, 0xffff0000, v63
    v_mul_f32 v126, v62, v126
    v_mul_f32 v127, v62, v127
    v_cvt_pk_bf16_f32 v63, v126, v127
    v_lshlrev_b32 v126, 16, v63
    v_and_b32 v127, 0xffff0000, v63
    v_cndmask_b32 v38, v38, v126, vcc
    v_cndmask_b32 v39, v39, v127, vcc
L_recurrent_scan__compressed_kv_cla__moe_arch_mod__prompt_kernel_rt2_noy_2:
    s_branch L_recurrent_scan__compressed_kv_cla__moe_arch_mod__prompt_kernel_back_178
L_recurrent_scan__compressed_kv_cla__moe_arch_mod__prompt_kernel_rare_179:
    v_lshlrev_b32 v96, 16, v40
    v_and_b32 v97, 0xffff0000, v40
    v_sub_f32 v112, v96, v48
    v_sub_f32 v113, v97, v48
    v_cvt_pk_bf16_f32 v10, v112, v113
    v_lshlrev_b32 v112, 16, v10
    v_and_b32 v113, 0xffff0000, v10
    v_mul_f32 v112, v112, v49
    v_mul_f32 v113, v113, v49
    v_cvt_pk_bf16_f32 v10, v112, v113
    v_lshlrev_b32 v112, 16, v10
    v_and_b32 v113, 0xffff0000, v10
    v_add_f32 v112, v112, v24
    v_add_f32 v113, v113, v25
    v_cvt_pk_bf16_f32 v10, v112, v113
    v_lshlrev_b32 v112, 16, v10
    v_and_b32 v113, 0xffff0000, v10
    v_mul_f32 v11, 0xbfb8aa3b, v112
    v_mul_f32 v12, 0xbfb8aa3b, v113
    v_exp_f32 v11, v11
    v_exp_f32 v12, v12
    s_nop 0
    v_add_f32 v11, 1.0, v11
    v_add_f32 v12, 1.0, v12
    v_rcp_f32 v11, v11
    v_rcp_f32 v12, v12
    s_nop 0
    v_mul_f32 v112, v112, v11
    v_mul_f32 v113, v113, v12
    v_cvt_pk_bf16_f32 v10, v112, v113
    v_lshlrev_b32 v112, 16, v10
    v_and_b32 v113, 0xffff0000, v10
    v_lshlrev_b32 v98, 16, v41
    v_and_b32 v99, 0xffff0000, v41
    v_sub_f32 v114, v98, v48
    v_sub_f32 v115, v99, v48
    v_cvt_pk_bf16_f32 v10, v114, v115
    v_lshlrev_b32 v114, 16, v10
    v_and_b32 v115, 0xffff0000, v10
    v_mul_f32 v114, v114, v49
    v_mul_f32 v115, v115, v49
    v_cvt_pk_bf16_f32 v10, v114, v115
    v_lshlrev_b32 v114, 16, v10
    v_and_b32 v115, 0xffff0000, v10
    v_add_f32 v114, v114, v26
    v_add_f32 v115, v115, v27
    v_cvt_pk_bf16_f32 v10, v114, v115
    v_lshlrev_b32 v114, 16, v10
    v_and_b32 v115, 0xffff0000, v10
    v_mul_f32 v11, 0xbfb8aa3b, v114
    v_mul_f32 v12, 0xbfb8aa3b, v115
    v_exp_f32 v11, v11
    v_exp_f32 v12, v12
    s_nop 0
    v_add_f32 v11, 1.0, v11
    v_add_f32 v12, 1.0, v12
    v_rcp_f32 v11, v11
    v_rcp_f32 v12, v12
    s_nop 0
    v_mul_f32 v114, v114, v11
    v_mul_f32 v115, v115, v12
    v_cvt_pk_bf16_f32 v10, v114, v115
    v_lshlrev_b32 v114, 16, v10
    v_and_b32 v115, 0xffff0000, v10
    v_lshlrev_b32 v100, 16, v42
    v_and_b32 v101, 0xffff0000, v42
    v_sub_f32 v116, v100, v48
    v_sub_f32 v117, v101, v48
    v_cvt_pk_bf16_f32 v10, v116, v117
    v_lshlrev_b32 v116, 16, v10
    v_and_b32 v117, 0xffff0000, v10
    v_mul_f32 v116, v116, v49
    v_mul_f32 v117, v117, v49
    v_cvt_pk_bf16_f32 v10, v116, v117
    v_lshlrev_b32 v116, 16, v10
    v_and_b32 v117, 0xffff0000, v10
    v_add_f32 v116, v116, v28
    v_add_f32 v117, v117, v29
    v_cvt_pk_bf16_f32 v10, v116, v117
    v_lshlrev_b32 v116, 16, v10
    v_and_b32 v117, 0xffff0000, v10
    v_mul_f32 v11, 0xbfb8aa3b, v116
    v_mul_f32 v12, 0xbfb8aa3b, v117
    v_exp_f32 v11, v11
    v_exp_f32 v12, v12
    s_nop 0
    v_add_f32 v11, 1.0, v11
    v_add_f32 v12, 1.0, v12
    v_rcp_f32 v11, v11
    v_rcp_f32 v12, v12
    s_nop 0
    v_mul_f32 v116, v116, v11
    v_mul_f32 v117, v117, v12
    v_cvt_pk_bf16_f32 v10, v116, v117
    v_lshlrev_b32 v116, 16, v10
    v_and_b32 v117, 0xffff0000, v10
    v_lshlrev_b32 v102, 16, v43
    v_and_b32 v103, 0xffff0000, v43
    v_sub_f32 v118, v102, v48
    v_sub_f32 v119, v103, v48
    v_cvt_pk_bf16_f32 v10, v118, v119
    v_lshlrev_b32 v118, 16, v10
    v_and_b32 v119, 0xffff0000, v10
    v_mul_f32 v118, v118, v49
    v_mul_f32 v119, v119, v49
    v_cvt_pk_bf16_f32 v10, v118, v119
    v_lshlrev_b32 v118, 16, v10
    v_and_b32 v119, 0xffff0000, v10
    v_add_f32 v118, v118, v30
    v_add_f32 v119, v119, v31
    v_cvt_pk_bf16_f32 v10, v118, v119
    v_lshlrev_b32 v118, 16, v10
    v_and_b32 v119, 0xffff0000, v10
    v_mul_f32 v11, 0xbfb8aa3b, v118
    v_mul_f32 v12, 0xbfb8aa3b, v119
    v_exp_f32 v11, v11
    v_exp_f32 v12, v12
    s_nop 0
    v_add_f32 v11, 1.0, v11
    v_add_f32 v12, 1.0, v12
    v_rcp_f32 v11, v11
    v_rcp_f32 v12, v12
    s_nop 0
    v_mul_f32 v118, v118, v11
    v_mul_f32 v119, v119, v12
    v_cvt_pk_bf16_f32 v10, v118, v119
    v_lshlrev_b32 v118, 16, v10
    v_and_b32 v119, 0xffff0000, v10
    v_lshlrev_b32 v104, 16, v44
    v_and_b32 v105, 0xffff0000, v44
    v_sub_f32 v120, v104, v48
    v_sub_f32 v121, v105, v48
    v_cvt_pk_bf16_f32 v10, v120, v121
    v_lshlrev_b32 v120, 16, v10
    v_and_b32 v121, 0xffff0000, v10
    v_mul_f32 v120, v120, v49
    v_mul_f32 v121, v121, v49
    v_cvt_pk_bf16_f32 v10, v120, v121
    v_lshlrev_b32 v120, 16, v10
    v_and_b32 v121, 0xffff0000, v10
    v_add_f32 v120, v120, v32
    v_add_f32 v121, v121, v33
    v_cvt_pk_bf16_f32 v10, v120, v121
    v_lshlrev_b32 v120, 16, v10
    v_and_b32 v121, 0xffff0000, v10
    v_mul_f32 v11, 0xbfb8aa3b, v120
    v_mul_f32 v12, 0xbfb8aa3b, v121
    v_exp_f32 v11, v11
    v_exp_f32 v12, v12
    s_nop 0
    v_add_f32 v11, 1.0, v11
    v_add_f32 v12, 1.0, v12
    v_rcp_f32 v11, v11
    v_rcp_f32 v12, v12
    s_nop 0
    v_mul_f32 v120, v120, v11
    v_mul_f32 v121, v121, v12
    v_cvt_pk_bf16_f32 v10, v120, v121
    v_lshlrev_b32 v120, 16, v10
    v_and_b32 v121, 0xffff0000, v10
    v_lshlrev_b32 v106, 16, v45
    v_and_b32 v107, 0xffff0000, v45
    v_sub_f32 v122, v106, v48
    v_sub_f32 v123, v107, v48
    v_cvt_pk_bf16_f32 v10, v122, v123
    v_lshlrev_b32 v122, 16, v10
    v_and_b32 v123, 0xffff0000, v10
    v_mul_f32 v122, v122, v49
    v_mul_f32 v123, v123, v49
    v_cvt_pk_bf16_f32 v10, v122, v123
    v_lshlrev_b32 v122, 16, v10
    v_and_b32 v123, 0xffff0000, v10
    v_add_f32 v122, v122, v34
    v_add_f32 v123, v123, v35
    v_cvt_pk_bf16_f32 v10, v122, v123
    v_lshlrev_b32 v122, 16, v10
    v_and_b32 v123, 0xffff0000, v10
    v_mul_f32 v11, 0xbfb8aa3b, v122
    v_mul_f32 v12, 0xbfb8aa3b, v123
    v_exp_f32 v11, v11
    v_exp_f32 v12, v12
    s_nop 0
    v_add_f32 v11, 1.0, v11
    v_add_f32 v12, 1.0, v12
    v_rcp_f32 v11, v11
    v_rcp_f32 v12, v12
    s_nop 0
    v_mul_f32 v122, v122, v11
    v_mul_f32 v123, v123, v12
    v_cvt_pk_bf16_f32 v10, v122, v123
    v_lshlrev_b32 v122, 16, v10
    v_and_b32 v123, 0xffff0000, v10
    v_lshlrev_b32 v108, 16, v46
    v_and_b32 v109, 0xffff0000, v46
    v_sub_f32 v124, v108, v48
    v_sub_f32 v125, v109, v48
    v_cvt_pk_bf16_f32 v10, v124, v125
    v_lshlrev_b32 v124, 16, v10
    v_and_b32 v125, 0xffff0000, v10
    v_mul_f32 v124, v124, v49
    v_mul_f32 v125, v125, v49
    v_cvt_pk_bf16_f32 v10, v124, v125
    v_lshlrev_b32 v124, 16, v10
    v_and_b32 v125, 0xffff0000, v10
    v_add_f32 v124, v124, v36
    v_add_f32 v125, v125, v37
    v_cvt_pk_bf16_f32 v10, v124, v125
    v_lshlrev_b32 v124, 16, v10
    v_and_b32 v125, 0xffff0000, v10
    v_mul_f32 v11, 0xbfb8aa3b, v124
    v_mul_f32 v12, 0xbfb8aa3b, v125
    v_exp_f32 v11, v11
    v_exp_f32 v12, v12
    s_nop 0
    v_add_f32 v11, 1.0, v11
    v_add_f32 v12, 1.0, v12
    v_rcp_f32 v11, v11
    v_rcp_f32 v12, v12
    s_nop 0
    v_mul_f32 v124, v124, v11
    v_mul_f32 v125, v125, v12
    v_cvt_pk_bf16_f32 v10, v124, v125
    v_lshlrev_b32 v124, 16, v10
    v_and_b32 v125, 0xffff0000, v10
    v_lshlrev_b32 v110, 16, v47
    v_and_b32 v111, 0xffff0000, v47
    v_sub_f32 v126, v110, v48
    v_sub_f32 v127, v111, v48
    v_cvt_pk_bf16_f32 v10, v126, v127
    v_lshlrev_b32 v126, 16, v10
    v_and_b32 v127, 0xffff0000, v10
    v_mul_f32 v126, v126, v49
    v_mul_f32 v127, v127, v49
    v_cvt_pk_bf16_f32 v10, v126, v127
    v_lshlrev_b32 v126, 16, v10
    v_and_b32 v127, 0xffff0000, v10
    v_add_f32 v126, v126, v38
    v_add_f32 v127, v127, v39
    v_cvt_pk_bf16_f32 v10, v126, v127
    v_lshlrev_b32 v126, 16, v10
    v_and_b32 v127, 0xffff0000, v10
    v_mul_f32 v11, 0xbfb8aa3b, v126
    v_mul_f32 v12, 0xbfb8aa3b, v127
    v_exp_f32 v11, v11
    v_exp_f32 v12, v12
    s_nop 0
    v_add_f32 v11, 1.0, v11
    v_add_f32 v12, 1.0, v12
    v_rcp_f32 v11, v11
    v_rcp_f32 v12, v12
    s_nop 0
    v_mul_f32 v126, v126, v11
    v_mul_f32 v127, v127, v12
    v_cvt_pk_bf16_f32 v10, v126, v127
    v_lshlrev_b32 v126, 16, v10
    v_and_b32 v127, 0xffff0000, v10
    s_branch L_recurrent_scan__compressed_kv_cla__moe_arch_mod__prompt_kernel_back_180
L_recurrent_scan__compressed_kv_cla__moe_arch_mod__prompt_kernel_rare_183:
    s_mov_b32 s61, 0x40000
L_recurrent_scan__compressed_kv_cla__moe_arch_mod__prompt_kernel_spin_181:
    s_sub_u32 s61, s61, 1
    s_cbranch_scc1 L_recurrent_scan__compressed_kv_cla__moe_arch_mod__prompt_kernel_spinx_182
    s_sleep 1
    global_load_dword v23, v5, s[90:91] sc1
    s_waitcnt vmcnt(0)
    v_readfirstlane_b32 s36, v23
    s_nop 0
    s_cmp_lt_u32 s36, 8
    s_cbranch_scc1 L_recurrent_scan__compressed_kv_cla__moe_arch_mod__prompt_kernel_spin_181
L_recurrent_scan__compressed_kv_cla__moe_arch_mod__prompt_kernel_spinx_182:
    s_branch L_recurrent_scan__compressed_kv_cla__moe_arch_mod__prompt_kernel_back_184
L_end:
    s_endpgm
.section .rodata,"a"
.p2align 6
.amdhsa_kernel recurrent_scan__compressed_kv_cla__moe_arch_mod__prompt_kernel
  .amdhsa_next_free_vgpr 256
  .amdhsa_next_free_sgpr 102
  .amdhsa_accum_offset 256
  .amdhsa_group_segment_fixed_size 0
  .amdhsa_kernarg_size 112
  .amdhsa_user_sgpr_count 2
  .amdhsa_user_sgpr_kernarg_segment_ptr 1
  .amdhsa_system_sgpr_workgroup_id_x 1
.end_amdhsa_kernel
```

```asm
; @launch kernel=recurrent_scan__compressed_kv_cla__moe_arch_mod__prompt_kernel grid=(256,1,1) block=(512,1,1) lds=163840
.amdgcn_target "amdgcn-amd-amdhsa--gfx950"
.text
.globl recurrent_scan__compressed_kv_cla__moe_arch_mod__prompt_kernel
.p2align 8
.type recurrent_scan__compressed_kv_cla__moe_arch_mod__prompt_kernel,@function
recurrent_scan__compressed_kv_cla__moe_arch_mod__prompt_kernel:
    s_cmp_ge_u32 s2, 256
    s_cbranch_scc1 L_end
    s_load_dwordx4 s[44:47], s[0:1], 0
    s_load_dwordx2 s[52:53], s[0:1], 56
    s_load_dwordx4 s[48:51], s[0:1], 24
    s_getpc_b64 s[36:37]
L_pc:
    s_lshr_b32 s38, s2, 3
    s_lshl_b32 s38, s38, 7
    v_lshl_add_u32 v16, v0, 12, s38
    v_cmp_gt_u32 vcc, L_end-L_pc-4, v16
    v_mov_b32 v17, s37
    s_and_b64 exec, exec, vcc
    s_cbranch_execz L_nocpf
    v_add_co_u32 v16, vcc, s36, v16
    s_nop 1
    v_addc_co_u32 v17, vcc, 0, v17, vcc
    global_load_dword v119, v[16:17], off
L_nocpf:
    s_mov_b64 exec, -1
    v_lshrrev_b32 v16, 6, v0
    v_and_b32 v1, 63, v0
    v_readfirstlane_b32 s28, v16
    v_lshlrev_b32 v116, 4, v1
    s_lshl_b32 s42, s2, 3
    s_cmp_lt_u32 s28, 4
    s_cbranch_scc1 L_nox
    s_add_u32 s43, s42, s28
    s_sub_u32 s42, s43, 4
    v_lshl_add_u32 v18, s42, 11, v116
    v_add_u32 v19, 8192, v18
    s_waitcnt lgkmcnt(0)
    global_load_dwordx4 v[20:23], v18, s[44:45]
    global_load_dwordx4 v[24:27], v18, s[44:45] offset:1024
    global_load_dwordx4 v[28:31], v19, s[44:45]
    global_load_dwordx4 v[32:35], v19, s[44:45] offset:1024
    global_load_dwordx4 v[36:39], v116, s[52:53]
    global_load_dwordx4 v[40:43], v116, s[52:53] offset:1024
    s_barrier
L_nox:
    s_load_dwordx4 s[88:91], s[0:1], 96
    s_load_dwordx4 s[92:95], s[0:1], 64
    s_load_dwordx2 s[96:97], s[0:1], 16
    s_and_b32 s29, s2, 7
    s_lshl_b32 s29, s29, 2
    s_lshr_b32 s29, 0x75643120, s29
    s_and_b32 s29, s29, 7
    s_lshl_b32 s29, s29, 2
    s_bfe_u32 s36, s2, 0x20003
    s_add_u32 s29, s29, s36
    s_lshr_b32 s30, s2, 5
    v_lshrrev_b32 v16, 3, v1
    s_lshl_b32 s36, s30, 8
    s_lshl_b32 s37, s28, 5
    s_add_u32 s36, s36, s37
    v_add_u32 v16, s36, v16
    v_lshlrev_b32 v16, 10, v16
    v_lshrrev_b32 v18, 4, v1
    v_and_b32 v19, 7, v1
    v_xor_b32 v19, v19, v18
    v_lshl_add_u32 v2, v19, 4, v16
    v_xor_b32 v19, 4, v19
    v_lshl_add_u32 v3, v19, 4, v16
    v_add_u32 v3, 7168, v3
    v_add_u32 v4, 14336, v2
    v_add_u32 v5, 14336, v3
    s_and_b32 s36, s28, 3
    s_lshl_b32 s37, s36, 4
    v_add_u32 v16, s37, v18
    v_lshlrev_b32 v16, 13, v16
    s_lshl_b32 s37, s29, 8
    v_add_u32 v16, s37, v16
    v_and_b32 v19, 15, v1
    v_lshlrev_b32 v18, 1, v18
    v_xor_b32 v19, v19, v18
    v_lshl_add_u32 v6, v19, 4, v16
    v_add_u32 v7, 31744, v6
    v_xor_b32 v19, 8, v19
    v_lshl_add_u32 v8, v19, 4, v16
    v_add_u32 v8, 63488, v8
    v_add_u32 v9, 31744, v8
    s_lshl_b32 s33, s28, 12
    s_add_u32 s34, s33, 65536
    s_mov_b32 s31, 0
    s_mov_b32 s32, 0
    s_mov_b32 s40, 128
    s_mov_b32 s41, 524288
    s_waitcnt lgkmcnt(0)
    s_mov_b32 s4, s46
    s_and_b32 s5, s47, 0xffff
    s_mov_b32 s6, 2097152
    s_mov_b32 s7, 0x20000
    s_mov_b32 s8, s48
    s_and_b32 s9, s49, 0xffff
    s_mov_b32 s10, 4194304
    s_mov_b32 s11, 0x20000
    s_mov_b32 s20, s50
    s_and_b32 s21, s51, 0xffff
    s_mov_b32 s22, 4194304
    s_mov_b32 s23, 0x20000
    s_cmp_lt_u32 s28, 4
    s_cbranch_scc0 L_pro_s
    s_barrier
    s_cmp_eq_u32 s2, 0
    s_cbranch_scc1 L_recurrent_scan__compressed_kv_cla__moe_arch_mod__prompt_kernel_rare_1
L_recurrent_scan__compressed_kv_cla__moe_arch_mod__prompt_kernel_back_2:
    s_add_u32 m0, s33, 0
    s_add_u32 s36, s31, 131072
    buffer_load_dwordx4 v2, s[4:7], s31 offen offset:0 lds
    buffer_load_dwordx4 v3, s[4:7], s31 offen offset:1024 lds
    buffer_load_dwordx4 v4, s[4:7], s31 offen offset:2048 lds
    buffer_load_dwordx4 v5, s[4:7], s31 offen offset:3072 lds
    s_add_u32 m0, s34, 0
    s_nop 0
    buffer_load_dwordx4 v6, s[8:11], s32 offen offset:0 nt lds
    buffer_load_dwordx4 v7, s[8:11], s32 offen offset:1024 nt lds
    buffer_load_dwordx4 v8, s[8:11], s32 offen offset:2048 nt lds
    buffer_load_dwordx4 v9, s[8:11], s32 offen offset:3072 nt lds
    s_add_u32 m0, s33, 16384
    s_nop 0
    buffer_load_dwordx4 v2, s[4:7], s36 offen offset:0 lds
    buffer_load_dwordx4 v3, s[4:7], s36 offen offset:1024 lds
    buffer_load_dwordx4 v4, s[4:7], s36 offen offset:2048 lds
    buffer_load_dwordx4 v5, s[4:7], s36 offen offset:3072 lds
    s_add_u32 m0, s34, 16384
    s_nop 0
    buffer_load_dwordx4 v6, s[20:23], s32 offen offset:0 nt lds
    buffer_load_dwordx4 v7, s[20:23], s32 offen offset:1024 nt lds
    buffer_load_dwordx4 v8, s[20:23], s32 offen offset:2048 nt lds
    buffer_load_dwordx4 v9, s[20:23], s32 offen offset:3072 nt lds
    s_add_u32 s31, s31, s40
    s_add_u32 s32, s32, s41
L_pro_s:
    s_add_u32 s54, s90, 0
    s_addc_u32 s55, s91, 0
    s_add_u32 s12, s54, 8388608
    s_addc_u32 s13, s55, 0
    s_and_b32 s13, s13, 0xffff
    s_mov_b32 s14, 134217856
    s_mov_b32 s15, 0x20000
    s_mov_b32 s24, s54
    s_and_b32 s25, s55, 0xffff
    s_mov_b32 s26, 184549504
    s_mov_b32 s27, 0x20000
    s_add_u32 s90, s54, 61865984
    s_addc_u32 s91, s55, 0
    v_and_b32 v16, 15, v1
    v_lshrrev_b32 v17, 4, v1
    s_bfe_u32 s36, s28, 0x10001
    s_lshl_b32 s36, s36, 14
    v_lshl_add_u32 v18, v16, 7, s36
    v_lshrrev_b32 v19, 1, v16
    v_xor_b32 v19, v19, v17
    v_lshl_add_u32 v10, v19, 4, v18
    v_xor_b32 v19, 4, v19
    v_lshl_add_u32 v11, v19, 4, v18
    v_lshrrev_b32 v16, 2, v16
    v_lshl_add_u32 v18, v17, 3, v16
    v_lshlrev_b32 v18, 8, v18
    s_lshr_b32 s36, s28, 2
    s_lshl_b32 s36, s36, 14
    s_add_u32 s36, s36, 65536
    v_add_u32 v18, s36, v18
    v_and_b32 v19, 3, v1
    v_lshl_add_u32 v18, v19, 3, v18
    v_and_b32 v17, 1, v17
    v_lshl_add_u32 v16, v17, 2, v16
    s_and_b32 s36, s28, 1
    s_lshl_b32 s36, s36, 2
    s_add_u32 s37, s36, 0
    v_xor_b32 v19, s37, v16
    v_lshl_add_u32 v12, v19, 5, v18
    s_add_u32 s37, s36, 1
    v_xor_b32 v19, s37, v16
    v_lshl_add_u32 v13, v19, 5, v18
    s_add_u32 s37, s36, 2
    v_xor_b32 v19, s37, v16
    v_lshl_add_u32 v14, v19, 5, v18
    s_add_u32 s37, s36, 3
    v_xor_b32 v19, s37, v16
    v_lshl_add_u32 v15, v19, 5, v18
    v_mov_b64 v[128:129], 0
    v_mov_b64 v[130:131], 0
    v_mov_b64 v[132:133], 0
    v_mov_b64 v[134:135], 0
    v_mov_b64 v[136:137], 0
    v_mov_b64 v[138:139], 0
    v_mov_b64 v[140:141], 0
    v_mov_b64 v[142:143], 0
    v_mov_b64 v[144:145], 0
    v_mov_b64 v[146:147], 0
    v_mov_b64 v[148:149], 0
    v_mov_b64 v[150:151], 0
    v_mov_b64 v[152:153], 0
    v_mov_b64 v[154:155], 0
    v_mov_b64 v[156:157], 0
    v_mov_b64 v[158:159], 0
    v_mov_b64 v[160:161], 0
    v_mov_b64 v[162:163], 0
    v_mov_b64 v[164:165], 0
    v_mov_b64 v[166:167], 0
    v_mov_b64 v[168:169], 0
    v_mov_b64 v[170:171], 0
    v_mov_b64 v[172:173], 0
    v_mov_b64 v[174:175], 0
    v_mov_b64 v[176:177], 0
    v_mov_b64 v[178:179], 0
    v_mov_b64 v[180:181], 0
    v_mov_b64 v[182:183], 0
    v_mov_b64 v[184:185], 0
    v_mov_b64 v[186:187], 0
    v_mov_b64 v[188:189], 0
    v_mov_b64 v[190:191], 0
    v_mov_b64 v[192:193], 0
    v_mov_b64 v[194:195], 0
    v_mov_b64 v[196:197], 0
    v_mov_b64 v[198:199], 0
    v_mov_b64 v[200:201], 0
    v_mov_b64 v[202:203], 0
    v_mov_b64 v[204:205], 0
    v_mov_b64 v[206:207], 0
    v_mov_b64 v[208:209], 0
    v_mov_b64 v[210:211], 0
    v_mov_b64 v[212:213], 0
    v_mov_b64 v[214:215], 0
    v_mov_b64 v[216:217], 0
    v_mov_b64 v[218:219], 0
    v_mov_b64 v[220:221], 0
    v_mov_b64 v[222:223], 0
    v_mov_b64 v[224:225], 0
    v_mov_b64 v[226:227], 0
    v_mov_b64 v[228:229], 0
    v_mov_b64 v[230:231], 0
    v_mov_b64 v[232:233], 0
    v_mov_b64 v[234:235], 0
    v_mov_b64 v[236:237], 0
    v_mov_b64 v[238:239], 0
    v_mov_b64 v[240:241], 0
    v_mov_b64 v[242:243], 0
    v_mov_b64 v[244:245], 0
    v_mov_b64 v[246:247], 0
    v_mov_b64 v[248:249], 0
    v_mov_b64 v[250:251], 0
    v_mov_b64 v[252:253], 0
    v_mov_b64 v[254:255], 0
    v_mov_b32 v118, 0
    v_mov_b32 v117, 0
    s_lshl_b32 s36, s30, 7
    s_lshl_b32 s37, s28, 4
    s_add_u32 s36, s36, s37
    v_bfe_u32 v17, v1, 1, 4
    v_add_u32 v17, s36, v17
    v_lshlrev_b32 v17, 13, v17
    v_and_b32 v19, 1, v1
    v_lshl_add_u32 v17, v19, 7, v17
    s_lshl_b32 s36, s29, 8
    v_add_u32 v17, s36, v17
    s_mov_b32 s45, 32768
    s_cmp_lt_u32 s28, 4
    s_cbranch_scc0 L_pro_b
    s_add_u32 m0, s33, 32768
    s_add_u32 s36, s31, 131072
    buffer_load_dwordx4 v2, s[4:7], s31 offen offset:0 lds
    buffer_load_dwordx4 v3, s[4:7], s31 offen offset:1024 lds
    buffer_load_dwordx4 v4, s[4:7], s31 offen offset:2048 lds
    buffer_load_dwordx4 v5, s[4:7], s31 offen offset:3072 lds
    s_add_u32 m0, s34, 32768
    s_nop 0
    buffer_load_dwordx4 v6, s[8:11], s32 offen offset:0 nt lds
    buffer_load_dwordx4 v7, s[8:11], s32 offen offset:1024 nt lds
    buffer_load_dwordx4 v8, s[8:11], s32 offen offset:2048 nt lds
    buffer_load_dwordx4 v9, s[8:11], s32 offen offset:3072 nt lds
    s_add_u32 m0, s33, 49152
    s_nop 0
    buffer_load_dwordx4 v2, s[4:7], s36 offen offset:0 lds
    buffer_load_dwordx4 v3, s[4:7], s36 offen offset:1024 lds
    buffer_load_dwordx4 v4, s[4:7], s36 offen offset:2048 lds
    buffer_load_dwordx4 v5, s[4:7], s36 offen offset:3072 lds
    s_add_u32 m0, s34, 49152
    s_nop 0
    buffer_load_dwordx4 v6, s[20:23], s32 offen offset:0 nt lds
    buffer_load_dwordx4 v7, s[20:23], s32 offen offset:1024 nt lds
    buffer_load_dwordx4 v8, s[20:23], s32 offen offset:2048 nt lds
    buffer_load_dwordx4 v9, s[20:23], s32 offen offset:3072 nt lds
    s_add_u32 s31, s31, s40
    s_add_u32 s32, s32, s41
    s_waitcnt vmcnt(16)
    s_branch L_pro_j
L_pro_b:
    s_mov_b64 s[8:9], s[20:21]
    s_mov_b32 s31, 256
    s_mov_b32 s32, 1048576
    s_and_b32 s60, s28, 3
    s_waitcnt vmcnt(0)
    s_mov_b32 s3, 0
L_ln:
    v_lshlrev_b32 v44, 16, v36
    v_and_b32 v45, 0xffff0000, v36
    v_lshlrev_b32 v46, 16, v37
    v_and_b32 v47, 0xffff0000, v37
    v_lshlrev_b32 v48, 16, v38
    v_and_b32 v49, 0xffff0000, v38
    v_lshlrev_b32 v50, 16, v39
    v_and_b32 v51, 0xffff0000, v39
    v_lshlrev_b32 v52, 16, v40
    v_and_b32 v53, 0xffff0000, v40
    v_lshlrev_b32 v54, 16, v41
    v_and_b32 v55, 0xffff0000, v41
    v_lshlrev_b32 v56, 16, v42
    v_and_b32 v57, 0xffff0000, v42
    v_lshlrev_b32 v58, 16, v43
    v_and_b32 v59, 0xffff0000, v43
    v_lshlrev_b32 v60, 16, v20
    v_lshlrev_b32 v76, 16, v28
    v_and_b32 v61, 0xffff0000, v20
    v_and_b32 v77, 0xffff0000, v28
    v_lshlrev_b32 v62, 16, v21
    v_lshlrev_b32 v78, 16, v29
    v_and_b32 v63, 0xffff0000, v21
    v_and_b32 v79, 0xffff0000, v29
    v_lshlrev_b32 v64, 16, v22
    v_lshlrev_b32 v80, 16, v30
    v_and_b32 v65, 0xffff0000, v22
    v_and_b32 v81, 0xffff0000, v30
    v_lshlrev_b32 v66, 16, v23
    v_lshlrev_b32 v82, 16, v31
    v_and_b32 v67, 0xffff0000, v23
    v_and_b32 v83, 0xffff0000, v31
    v_lshlrev_b32 v68, 16, v24
    v_lshlrev_b32 v84, 16, v32
    v_and_b32 v69, 0xffff0000, v24
    v_and_b32 v85, 0xffff0000, v32
    v_lshlrev_b32 v70, 16, v25
    v_lshlrev_b32 v86, 16, v33
    v_and_b32 v71, 0xffff0000, v25
    v_and_b32 v87, 0xffff0000, v33
    v_lshlrev_b32 v72, 16, v26
    v_lshlrev_b32 v88, 16, v34
    v_and_b32 v73, 0xffff0000, v26
    v_and_b32 v89, 0xffff0000, v34
    v_lshlrev_b32 v74, 16, v27
    v_lshlrev_b32 v90, 16, v35
    v_and_b32 v75, 0xffff0000, v27
    v_and_b32 v91, 0xffff0000, v35
    v_pk_add_f32 v[92:93], v[60:61], v[62:63]
    v_pk_add_f32 v[100:101], v[76:77], v[78:79]
    v_pk_add_f32 v[92:93], v[92:93], v[64:65]
    v_pk_add_f32 v[100:101], v[100:101], v[80:81]
    v_pk_add_f32 v[92:93], v[92:93], v[66:67]
    v_pk_add_f32 v[100:101], v[100:101], v[82:83]
    v_pk_add_f32 v[92:93], v[92:93], v[68:69]
    v_pk_add_f32 v[100:101], v[100:101], v[84:85]
    v_pk_add_f32 v[92:93], v[92:93], v[70:71]
    v_pk_add_f32 v[100:101], v[100:101], v[86:87]
    v_pk_add_f32 v[92:93], v[92:93], v[72:73]
    v_pk_add_f32 v[100:101], v[100:101], v[88:89]
    v_pk_add_f32 v[92:93], v[92:93], v[74:75]
    v_pk_add_f32 v[100:101], v[100:101], v[90:91]
    v_add_f32 v92, v92, v93
    v_add_f32 v100, v100, v101
    s_nop 0
    v_add_f32_dpp v92, v92, v92 quad_perm:[1,0,3,2] row_mask:0xf bank_mask:0xf
    v_add_f32_dpp v100, v100, v100 quad_perm:[1,0,3,2] row_mask:0xf bank_mask:0xf
    s_nop 0
    v_add_f32_dpp v92, v92, v92 quad_perm:[2,3,0,1] row_mask:0xf bank_mask:0xf
    v_add_f32_dpp v100, v100, v100 quad_perm:[2,3,0,1] row_mask:0xf bank_mask:0xf
    s_nop 0
    v_add_f32_dpp v92, v92, v92 row_half_mirror row_mask:0xf bank_mask:0xf
    v_add_f32_dpp v100, v100, v100 row_half_mirror row_mask:0xf bank_mask:0xf
    s_nop 0
    v_add_f32_dpp v92, v92, v92 row_mirror row_mask:0xf bank_mask:0xf
    v_add_f32_dpp v100, v100, v100 row_mirror row_mask:0xf bank_mask:0xf
    v_readlane_b32 s36, v92, 0
    v_readlane_b32 s56, v100, 0
    v_readlane_b32 s37, v92, 16
    v_readlane_b32 s57, v100, 16
    v_readlane_b32 s38, v92, 32
    v_readlane_b32 s58, v100, 32
    v_readlane_b32 s39, v92, 48
    v_readlane_b32 s59, v100, 48
    v_mov_b32 v96, s36
    v_mov_b32 v104, s56
    v_add_f32 v96, s37, v96
    v_add_f32 v104, s57, v104
    v_add_f32 v96, s38, v96
    v_add_f32 v104, s58, v104
    v_add_f32 v96, s39, v96
    v_add_f32 v104, s59, v104
    v_mul_f32 v96, 0xba800000, v96
    v_mul_f32 v104, 0xba800000, v104
    v_mov_b32 v97, v96
    v_mov_b32 v105, v104
    v_pk_add_f32 v[94:95], v[60:61], v[96:97]
    v_pk_add_f32 v[102:103], v[76:77], v[104:105]
    v_pk_mul_f32 v[92:93], v[94:95], v[94:95]
    v_pk_mul_f32 v[100:101], v[102:103], v[102:103]
    v_pk_add_f32 v[94:95], v[62:63], v[96:97]
    v_pk_add_f32 v[102:103], v[78:79], v[104:105]
    v_pk_fma_f32 v[92:93], v[94:95], v[94:95], v[92:93]
    v_pk_fma_f32 v[100:101], v[102:103], v[102:103], v[100:101]
    v_pk_add_f32 v[94:95], v[64:65], v[96:97]
    v_pk_add_f32 v[102:103], v[80:81], v[104:105]
    v_pk_fma_f32 v[92:93], v[94:95], v[94:95], v[92:93]
    v_pk_fma_f32 v[100:101], v[102:103], v[102:103], v[100:101]
    v_pk_add_f32 v[94:95], v[66:67], v[96:97]
    v_pk_add_f32 v[102:103], v[82:83], v[104:105]
    v_pk_fma_f32 v[92:93], v[94:95], v[94:95], v[92:93]
    v_pk_fma_f32 v[100:101], v[102:103], v[102:103], v[100:101]
    v_pk_add_f32 v[94:95], v[68:69], v[96:97]
    v_pk_add_f32 v[102:103], v[84:85], v[104:105]
    v_pk_fma_f32 v[92:93], v[94:95], v[94:95], v[92:93]
    v_pk_fma_f32 v[100:101], v[102:103], v[102:103], v[100:101]
    v_pk_add_f32 v[94:95], v[70:71], v[96:97]
    v_pk_add_f32 v[102:103], v[86:87], v[104:105]
    v_pk_fma_f32 v[92:93], v[94:95], v[94:95], v[92:93]
    v_pk_fma_f32 v[100:101], v[102:103], v[102:103], v[100:101]
    v_pk_add_f32 v[94:95], v[72:73], v[96:97]
    v_pk_add_f32 v[102:103], v[88:89], v[104:105]
    v_pk_fma_f32 v[92:93], v[94:95], v[94:95], v[92:93]
    v_pk_fma_f32 v[100:101], v[102:103], v[102:103], v[100:101]
    v_pk_add_f32 v[94:95], v[74:75], v[96:97]
    v_pk_add_f32 v[102:103], v[90:91], v[104:105]
    v_pk_fma_f32 v[92:93], v[94:95], v[94:95], v[92:93]
    v_pk_fma_f32 v[100:101], v[102:103], v[102:103], v[100:101]
    v_add_f32 v92, v92, v93
    v_add_f32 v100, v100, v101
    s_nop 0
    v_add_f32_dpp v92, v92, v92 quad_perm:[1,0,3,2] row_mask:0xf bank_mask:0xf
    v_add_f32_dpp v100, v100, v100 quad_perm:[1,0,3,2] row_mask:0xf bank_mask:0xf
    s_nop 0
    v_add_f32_dpp v92, v92, v92 quad_perm:[2,3,0,1] row_mask:0xf bank_mask:0xf
    v_add_f32_dpp v100, v100, v100 quad_perm:[2,3,0,1] row_mask:0xf bank_mask:0xf
    s_nop 0
    v_add_f32_dpp v92, v92, v92 row_half_mirror row_mask:0xf bank_mask:0xf
    v_add_f32_dpp v100, v100, v100 row_half_mirror row_mask:0xf bank_mask:0xf
    s_nop 0
    v_add_f32_dpp v92, v92, v92 row_mirror row_mask:0xf bank_mask:0xf
    v_add_f32_dpp v100, v100, v100 row_mirror row_mask:0xf bank_mask:0xf
    v_readlane_b32 s36, v92, 0
    v_readlane_b32 s56, v100, 0
    v_readlane_b32 s37, v92, 16
    v_readlane_b32 s57, v100, 16
    v_readlane_b32 s38, v92, 32
    v_readlane_b32 s58, v100, 32
    v_readlane_b32 s39, v92, 48
    v_readlane_b32 s59, v100, 48
    v_mov_b32 v94, s36
    v_mov_b32 v102, s56
    v_add_f32 v94, s37, v94
    v_add_f32 v102, s57, v102
    v_add_f32 v94, s38, v94
    v_add_f32 v102, s58, v102
    v_add_f32 v94, s39, v94
    v_add_f32 v102, s59, v102
    v_mul_f32 v94, 0x3a800000, v94
    v_mul_f32 v102, 0x3a800000, v102
    v_cvt_pk_bf16_f32 v95, v96, v94
    v_cvt_pk_bf16_f32 v103, v104, v102
    v_lshlrev_b32 v96, 16, v95
    v_lshlrev_b32 v104, 16, v103
    v_and_b32 v94, 0xffff0000, v95
    v_and_b32 v102, 0xffff0000, v103
    v_add_f32 v94, 0x3727c5ac, v94
    v_add_f32 v102, 0x3727c5ac, v102
    v_cvt_pk_bf16_f32 v94, v94, v94
    v_cvt_pk_bf16_f32 v102, v102, v102
    v_lshlrev_b32 v94, 16, v94
    v_lshlrev_b32 v102, 16, v102
    v_sqrt_f32 v94, v94
    v_sqrt_f32 v102, v102
    v_mov_b32 v97, v96
    v_mov_b32 v105, v104
    v_cvt_pk_bf16_f32 v94, v94, v94
    v_cvt_pk_bf16_f32 v102, v102, v102
    v_lshlrev_b32 v94, 16, v94
    v_lshlrev_b32 v102, 16, v102
    v_rcp_f32 v99, v94
    v_rcp_f32 v107, v102
    v_fma_f32 v95, -v94, v99, 1.0
    v_fma_f32 v103, -v102, v107, 1.0
    v_fma_f32 v99, v95, v99, v99
    v_fma_f32 v107, v103, v107, v107
    v_mov_b32 v98, v99
    v_mov_b32 v106, v107
    v_pk_add_f32 v[60:61], v[60:61], v[96:97]
    v_pk_add_f32 v[76:77], v[76:77], v[104:105]
    v_cvt_pk_bf16_f32 v94, v60, v61
    v_cvt_pk_bf16_f32 v102, v76, v77
    v_lshlrev_b32 v60, 16, v94
    v_lshlrev_b32 v76, 16, v102
    v_and_b32 v61, 0xffff0000, v94
    v_and_b32 v77, 0xffff0000, v102
    v_pk_mul_f32 v[60:61], v[60:61], v[98:99]
    v_pk_mul_f32 v[76:77], v[76:77], v[106:107]
    v_cvt_pk_bf16_f32 v108, v60, v61
    v_cvt_pk_bf16_f32 v120, v76, v77
    v_lshlrev_b32 v60, 16, v108
    v_lshlrev_b32 v76, 16, v120
    v_and_b32 v61, 0xffff0000, v108
    v_and_b32 v77, 0xffff0000, v120
    v_pk_mul_f32 v[92:93], v[60:61], v[44:45]
    v_pk_mul_f32 v[100:101], v[76:77], v[44:45]
    v_pk_add_f32 v[62:63], v[62:63], v[96:97]
    v_pk_add_f32 v[78:79], v[78:79], v[104:105]
    v_cvt_pk_bf16_f32 v94, v62, v63
    v_cvt_pk_bf16_f32 v102, v78, v79
    v_lshlrev_b32 v62, 16, v94
    v_lshlrev_b32 v78, 16, v102
    v_and_b32 v63, 0xffff0000, v94
    v_and_b32 v79, 0xffff0000, v102
    v_pk_mul_f32 v[62:63], v[62:63], v[98:99]
    v_pk_mul_f32 v[78:79], v[78:79], v[106:107]
    v_cvt_pk_bf16_f32 v109, v62, v63
    v_cvt_pk_bf16_f32 v121, v78, v79
    v_lshlrev_b32 v62, 16, v109
    v_lshlrev_b32 v78, 16, v121
    v_and_b32 v63, 0xffff0000, v109
    v_and_b32 v79, 0xffff0000, v121
    v_pk_fma_f32 v[92:93], v[62:63], v[46:47], v[92:93]
    v_pk_fma_f32 v[100:101], v[78:79], v[46:47], v[100:101]
    v_pk_add_f32 v[64:65], v[64:65], v[96:97]
    v_pk_add_f32 v[80:81], v[80:81], v[104:105]
    v_cvt_pk_bf16_f32 v94, v64, v65
    v_cvt_pk_bf16_f32 v102, v80, v81
    v_lshlrev_b32 v64, 16, v94
    v_lshlrev_b32 v80, 16, v102
    v_and_b32 v65, 0xffff0000, v94
    v_and_b32 v81, 0xffff0000, v102
    v_pk_mul_f32 v[64:65], v[64:65], v[98:99]
    v_pk_mul_f32 v[80:81], v[80:81], v[106:107]
    v_cvt_pk_bf16_f32 v110, v64, v65
    v_cvt_pk_bf16_f32 v122, v80, v81
    v_lshlrev_b32 v64, 16, v110
    v_lshlrev_b32 v80, 16, v122
    v_and_b32 v65, 0xffff0000, v110
    v_and_b32 v81, 0xffff0000, v122
    v_pk_fma_f32 v[92:93], v[64:65], v[48:49], v[92:93]
    v_pk_fma_f32 v[100:101], v[80:81], v[48:49], v[100:101]
    v_pk_add_f32 v[66:67], v[66:67], v[96:97]
    v_pk_add_f32 v[82:83], v[82:83], v[104:105]
    v_cvt_pk_bf16_f32 v94, v66, v67
    v_cvt_pk_bf16_f32 v102, v82, v83
    v_lshlrev_b32 v66, 16, v94
    v_lshlrev_b32 v82, 16, v102
    v_and_b32 v67, 0xffff0000, v94
    v_and_b32 v83, 0xffff0000, v102
    v_pk_mul_f32 v[66:67], v[66:67], v[98:99]
    v_pk_mul_f32 v[82:83], v[82:83], v[106:107]
    v_cvt_pk_bf16_f32 v111, v66, v67
    v_cvt_pk_bf16_f32 v123, v82, v83
    v_lshlrev_b32 v66, 16, v111
    v_lshlrev_b32 v82, 16, v123
    v_and_b32 v67, 0xffff0000, v111
    v_and_b32 v83, 0xffff0000, v123
    v_pk_fma_f32 v[92:93], v[66:67], v[50:51], v[92:93]
    v_pk_fma_f32 v[100:101], v[82:83], v[50:51], v[100:101]
    v_pk_add_f32 v[68:69], v[68:69], v[96:97]
    v_pk_add_f32 v[84:85], v[84:85], v[104:105]
    v_cvt_pk_bf16_f32 v94, v68, v69
    v_cvt_pk_bf16_f32 v102, v84, v85
    v_lshlrev_b32 v68, 16, v94
    v_lshlrev_b32 v84, 16, v102
    v_and_b32 v69, 0xffff0000, v94
    v_and_b32 v85, 0xffff0000, v102
    v_pk_mul_f32 v[68:69], v[68:69], v[98:99]
    v_pk_mul_f32 v[84:85], v[84:85], v[106:107]
    v_cvt_pk_bf16_f32 v112, v68, v69
    v_cvt_pk_bf16_f32 v124, v84, v85
    v_lshlrev_b32 v68, 16, v112
    v_lshlrev_b32 v84, 16, v124
    v_and_b32 v69, 0xffff0000, v112
    v_and_b32 v85, 0xffff0000, v124
    v_pk_fma_f32 v[92:93], v[68:69], v[52:53], v[92:93]
    v_pk_fma_f32 v[100:101], v[84:85], v[52:53], v[100:101]
    v_pk_add_f32 v[70:71], v[70:71], v[96:97]
    v_pk_add_f32 v[86:87], v[86:87], v[104:105]
    v_cvt_pk_bf16_f32 v94, v70, v71
    v_cvt_pk_bf16_f32 v102, v86, v87
    v_lshlrev_b32 v70, 16, v94
    v_lshlrev_b32 v86, 16, v102
    v_and_b32 v71, 0xffff0000, v94
    v_and_b32 v87, 0xffff0000, v102
    v_pk_mul_f32 v[70:71], v[70:71], v[98:99]
    v_pk_mul_f32 v[86:87], v[86:87], v[106:107]
    v_cvt_pk_bf16_f32 v113, v70, v71
    v_cvt_pk_bf16_f32 v125, v86, v87
    v_lshlrev_b32 v70, 16, v113
    v_lshlrev_b32 v86, 16, v125
    v_and_b32 v71, 0xffff0000, v113
    v_and_b32 v87, 0xffff0000, v125
    v_pk_fma_f32 v[92:93], v[70:71], v[54:55], v[92:93]
    v_pk_fma_f32 v[100:101], v[86:87], v[54:55], v[100:101]
    v_pk_add_f32 v[72:73], v[72:73], v[96:97]
    v_pk_add_f32 v[88:89], v[88:89], v[104:105]
    v_cvt_pk_bf16_f32 v94, v72, v73
    v_cvt_pk_bf16_f32 v102, v88, v89
    v_lshlrev_b32 v72, 16, v94
    v_lshlrev_b32 v88, 16, v102
    v_and_b32 v73, 0xffff0000, v94
    v_and_b32 v89, 0xffff0000, v102
    v_pk_mul_f32 v[72:73], v[72:73], v[98:99]
    v_pk_mul_f32 v[88:89], v[88:89], v[106:107]
    v_cvt_pk_bf16_f32 v114, v72, v73
    v_cvt_pk_bf16_f32 v126, v88, v89
    v_lshlrev_b32 v72, 16, v114
    v_lshlrev_b32 v88, 16, v126
    v_and_b32 v73, 0xffff0000, v114
    v_and_b32 v89, 0xffff0000, v126
    v_pk_fma_f32 v[92:93], v[72:73], v[56:57], v[92:93]
    v_pk_fma_f32 v[100:101], v[88:89], v[56:57], v[100:101]
    v_pk_add_f32 v[74:75], v[74:75], v[96:97]
    v_pk_add_f32 v[90:91], v[90:91], v[104:105]
    v_cvt_pk_bf16_f32 v94, v74, v75
    v_cvt_pk_bf16_f32 v102, v90, v91
    v_lshlrev_b32 v74, 16, v94
    v_lshlrev_b32 v90, 16, v102
    v_and_b32 v75, 0xffff0000, v94
    v_and_b32 v91, 0xffff0000, v102
    v_pk_mul_f32 v[74:75], v[74:75], v[98:99]
    v_pk_mul_f32 v[90:91], v[90:91], v[106:107]
    v_cvt_pk_bf16_f32 v115, v74, v75
    v_cvt_pk_bf16_f32 v127, v90, v91
    v_lshlrev_b32 v74, 16, v115
    v_lshlrev_b32 v90, 16, v127
    v_and_b32 v75, 0xffff0000, v115
    v_and_b32 v91, 0xffff0000, v127
    v_pk_fma_f32 v[92:93], v[74:75], v[58:59], v[92:93]
    v_pk_fma_f32 v[100:101], v[90:91], v[58:59], v[100:101]
    v_add_f32 v92, v92, v93
    v_add_f32 v100, v100, v101
    v_xor_b32 v98, 0x80000000, v96
    v_xor_b32 v106, 0x80000000, v104
    s_mul_i32 s36, s60, 2064
    s_mul_i32 s56, s28, 2064
    s_add_u32 s36, s36, 131072
    s_add_u32 s56, s56, 131072
    v_lshl_add_u32 v95, v1, 4, s36
    v_lshl_add_u32 v103, v1, 4, s56
    ds_write_b128 v95, v[108:111]
    ds_write_b128 v103, v[120:123]
    ds_write_b128 v95, v[112:115] offset:1024
    ds_write_b128 v103, v[124:127] offset:1024
    s_nop 0
    v_add_f32_dpp v92, v92, v92 quad_perm:[1,0,3,2] row_mask:0xf bank_mask:0xf
    v_add_f32_dpp v100, v100, v100 quad_perm:[1,0,3,2] row_mask:0xf bank_mask:0xf
    s_nop 0
    v_add_f32_dpp v92, v92, v92 quad_perm:[2,3,0,1] row_mask:0xf bank_mask:0xf
    v_add_f32_dpp v100, v100, v100 quad_perm:[2,3,0,1] row_mask:0xf bank_mask:0xf
    s_nop 0
    v_add_f32_dpp v92, v92, v92 row_half_mirror row_mask:0xf bank_mask:0xf
    v_add_f32_dpp v100, v100, v100 row_half_mirror row_mask:0xf bank_mask:0xf
    s_nop 0
    v_add_f32_dpp v92, v92, v92 row_mirror row_mask:0xf bank_mask:0xf
    v_add_f32_dpp v100, v100, v100 row_mirror row_mask:0xf bank_mask:0xf
    v_readlane_b32 s36, v92, 0
    v_readlane_b32 s56, v100, 0
    v_readlane_b32 s37, v92, 16
    v_readlane_b32 s57, v100, 16
    v_readlane_b32 s38, v92, 32
    v_readlane_b32 s58, v100, 32
    v_readlane_b32 s39, v92, 48
    v_readlane_b32 s59, v100, 48
    v_mov_b32 v93, s36
    v_mov_b32 v101, s56
    v_add_f32 v93, s37, v93
    v_add_f32 v101, s57, v101
    v_add_f32 v93, s38, v93
    v_add_f32 v101, s58, v101
    v_add_f32 v93, s39, v93
    v_add_f32 v101, s59, v101
    v_cvt_pk_bf16_f32 v93, v93, v93
    v_cvt_pk_bf16_f32 v101, v101, v101
    v_lshlrev_b32 v93, 16, v93
    v_lshlrev_b32 v101, 16, v101
    v_ashrrev_i32 v95, 31, v93
    v_ashrrev_i32 v103, 31, v101
    v_or_b32 v95, 0x80000000, v95
    v_or_b32 v103, 0x80000000, v103
    v_xor_b32 v95, v93, v95
    v_xor_b32 v103, v101, v103
    v_and_b32 v95, 0xffff0000, v95
    v_and_b32 v103, 0xffff0000, v103
    s_sub_u32 s36, 0xffff, s42
    s_sub_u32 s56, 0xffff, s43
    v_or_b32 v95, s36, v95
    v_or_b32 v103, s56, v103
    s_lshl_b32 s37, s60, 3
    s_lshl_b32 s57, s28, 3
    s_add_u32 s37, s37, 147712
    s_add_u32 s57, s57, 147712
    v_mov_b32 v94, s37
    v_mov_b32 v102, s57
    ds_write_b64 v94, v[98:99]
    ds_write_b64 v102, v[106:107]
    ds_write_b32 v94, v95 offset:64
    ds_write_b32 v102, v103 offset:64
    s_waitcnt vmcnt(0) lgkmcnt(0)
    s_cmp_eq_u32 s3, 0
    s_mov_b32 s3, 0
    s_cbranch_scc0 L_ln
L_pro_j:
    s_barrier
    ds_read_b128 v[20:23], v10 offset:0
    ds_read_b64_tr_b16 v[52:53], v12 offset:0
    ds_read_b64_tr_b16 v[54:55], v12 offset:1024
    ds_read_b64_tr_b16 v[56:57], v13 offset:0
    ds_read_b64_tr_b16 v[58:59], v13 offset:1024
    ds_read_b64_tr_b16 v[60:61], v14 offset:0
    ds_read_b64_tr_b16 v[62:63], v14 offset:1024
    ds_read_b64_tr_b16 v[64:65], v15 offset:0
    ds_read_b64_tr_b16 v[66:67], v15 offset:1024
    ds_read_b128 v[24:27], v10 offset:2048
    ds_read_b128 v[28:31], v10 offset:4096
    ds_read_b128 v[32:35], v10 offset:6144
    ds_read_b128 v[36:39], v10 offset:8192
    ds_read_b128 v[40:43], v10 offset:10240
    ds_read_b128 v[44:47], v10 offset:12288
    ds_read_b128 v[48:51], v10 offset:14336
    s_add_u32 s36, s2, s28
    s_cmp_eq_u32 s36, 0
    s_cbranch_scc1 L_recurrent_scan__compressed_kv_cla__moe_arch_mod__prompt_kernel_rare_3
L_recurrent_scan__compressed_kv_cla__moe_arch_mod__prompt_kernel_back_4:
    s_mov_b32 s35, 0
    s_cmp_eq_u32 s28, 0
    s_cselect_b32 s43, 9, 0
    s_cselect_b32 s44, 2, 1
    s_cmp_lt_u32 s28, 4
    s_cbranch_scc0 L_kv_vloop
    .p2align 6
L_kv_kloop:
    s_waitcnt lgkmcnt(0)
    v_mfma_f32_16x16x32_bf16 v[128:131], v[52:55], v[20:23], v[128:131]
    ds_read_b128 v[68:71], v11 offset:0
    v_mfma_f32_16x16x32_bf16 v[132:135], v[56:59], v[20:23], v[132:135]
    ds_read_b64_tr_b16 v[100:101], v12 offset:8192
    v_mfma_f32_16x16x32_bf16 v[136:139], v[60:63], v[20:23], v[136:139]
    ds_read_b64_tr_b16 v[102:103], v12 offset:9216
    v_mfma_f32_16x16x32_bf16 v[140:143], v[64:67], v[20:23], v[140:143]
    ds_read_b64_tr_b16 v[104:105], v13 offset:8192
    v_mfma_f32_16x16x32_bf16 v[144:147], v[52:55], v[24:27], v[144:147]
    ds_read_b64_tr_b16 v[106:107], v13 offset:9216
    v_mfma_f32_16x16x32_bf16 v[148:151], v[56:59], v[24:27], v[148:151]
    ds_read_b64_tr_b16 v[108:109], v14 offset:8192
    v_mfma_f32_16x16x32_bf16 v[152:155], v[60:63], v[24:27], v[152:155]
    ds_read_b64_tr_b16 v[110:111], v14 offset:9216
    v_mfma_f32_16x16x32_bf16 v[156:159], v[64:67], v[24:27], v[156:159]
    ds_read_b64_tr_b16 v[112:113], v15 offset:8192
    v_mfma_f32_16x16x32_bf16 v[160:163], v[52:55], v[28:31], v[160:163]
    ds_read_b64_tr_b16 v[114:115], v15 offset:9216
    v_mfma_f32_16x16x32_bf16 v[164:167], v[56:59], v[28:31], v[164:167]
    ds_read_b128 v[72:75], v11 offset:2048
    v_mfma_f32_16x16x32_bf16 v[168:171], v[60:63], v[28:31], v[168:171]
    ds_read_b128 v[76:79], v11 offset:4096
    v_mfma_f32_16x16x32_bf16 v[172:175], v[64:67], v[28:31], v[172:175]
    ds_read_b128 v[80:83], v11 offset:6144
    v_mfma_f32_16x16x32_bf16 v[176:179], v[52:55], v[32:35], v[176:179]
    ds_read_b128 v[84:87], v11 offset:8192
    v_mfma_f32_16x16x32_bf16 v[180:183], v[56:59], v[32:35], v[180:183]
    ds_read_b128 v[88:91], v11 offset:10240
    v_mfma_f32_16x16x32_bf16 v[184:187], v[60:63], v[32:35], v[184:187]
    ds_read_b128 v[92:95], v11 offset:12288
    v_mfma_f32_16x16x32_bf16 v[188:191], v[64:67], v[32:35], v[188:191]
    ds_read_b128 v[96:99], v11 offset:14336
    v_mfma_f32_16x16x32_bf16 v[192:195], v[52:55], v[36:39], v[192:195]
    v_mfma_f32_16x16x32_bf16 v[196:199], v[56:59], v[36:39], v[196:199]
    v_mfma_f32_16x16x32_bf16 v[200:203], v[60:63], v[36:39], v[200:203]
    v_mfma_f32_16x16x32_bf16 v[204:207], v[64:67], v[36:39], v[204:207]
    v_mfma_f32_16x16x32_bf16 v[208:211], v[52:55], v[40:43], v[208:211]
    v_mfma_f32_16x16x32_bf16 v[212:215], v[56:59], v[40:43], v[212:215]
    v_mfma_f32_16x16x32_bf16 v[216:219], v[60:63], v[40:43], v[216:219]
    v_mfma_f32_16x16x32_bf16 v[220:223], v[64:67], v[40:43], v[220:223]
    v_mfma_f32_16x16x32_bf16 v[224:227], v[52:55], v[44:47], v[224:227]
    v_mfma_f32_16x16x32_bf16 v[228:231], v[56:59], v[44:47], v[228:231]
    v_mfma_f32_16x16x32_bf16 v[232:235], v[60:63], v[44:47], v[232:235]
    v_mfma_f32_16x16x32_bf16 v[236:239], v[64:67], v[44:47], v[236:239]
    v_mfma_f32_16x16x32_bf16 v[240:243], v[52:55], v[48:51], v[240:243]
    v_mfma_f32_16x16x32_bf16 v[244:247], v[56:59], v[48:51], v[244:247]
    v_mfma_f32_16x16x32_bf16 v[248:251], v[60:63], v[48:51], v[248:251]
    v_mfma_f32_16x16x32_bf16 v[252:255], v[64:67], v[48:51], v[252:255]
    s_cmp_eq_u32 s35, 3
    s_cbranch_scc1 L_recurrent_scan__compressed_kv_cla__moe_arch_mod__prompt_kernel_rare_5
L_recurrent_scan__compressed_kv_cla__moe_arch_mod__prompt_kernel_back_6:
    s_cmp_lt_u32 s35, s44
    s_cbranch_scc1 L_recurrent_scan__compressed_kv_cla__moe_arch_mod__prompt_kernel_w0_7
    s_waitcnt vmcnt(1)
L_recurrent_scan__compressed_kv_cla__moe_arch_mod__prompt_kernel_w0b_8:
    s_waitcnt lgkmcnt(0)
    s_barrier
    v_mfma_f32_16x16x32_bf16 v[128:131], v[100:103], v[68:71], v[128:131]
    ds_read_b128 v[20:23], v10 offset:32768
    s_add_u32 m0, s33, 0
    v_mfma_f32_16x16x32_bf16 v[132:135], v[104:107], v[68:71], v[132:135]
    ds_read_b64_tr_b16 v[52:53], v12 offset:32768
    buffer_load_dwordx4 v2, s[4:7], s31 offen offset:0 lds
    v_mfma_f32_16x16x32_bf16 v[136:139], v[108:111], v[68:71], v[136:139]
    ds_read_b64_tr_b16 v[54:55], v12 offset:33792
    v_mfma_f32_16x16x32_bf16 v[140:143], v[112:115], v[68:71], v[140:143]
    ds_read_b64_tr_b16 v[56:57], v13 offset:32768
    v_mfma_f32_16x16x32_bf16 v[144:147], v[100:103], v[72:75], v[144:147]
    ds_read_b64_tr_b16 v[58:59], v13 offset:33792
    buffer_load_dwordx4 v3, s[4:7], s31 offen offset:1024 lds
    v_mfma_f32_16x16x32_bf16 v[148:151], v[104:107], v[72:75], v[148:151]
    ds_read_b64_tr_b16 v[60:61], v14 offset:32768
    v_mfma_f32_16x16x32_bf16 v[152:155], v[108:111], v[72:75], v[152:155]
    ds_read_b64_tr_b16 v[62:63], v14 offset:33792
    v_mfma_f32_16x16x32_bf16 v[156:159], v[112:115], v[72:75], v[156:159]
    ds_read_b64_tr_b16 v[64:65], v15 offset:32768
    buffer_load_dwordx4 v4, s[4:7], s31 offen offset:2048 lds
    v_mfma_f32_16x16x32_bf16 v[160:163], v[100:103], v[76:79], v[160:163]
    ds_read_b64_tr_b16 v[66:67], v15 offset:33792
    v_mfma_f32_16x16x32_bf16 v[164:167], v[104:107], v[76:79], v[164:167]
    ds_read_b128 v[24:27], v10 offset:34816
    v_mfma_f32_16x16x32_bf16 v[168:171], v[108:111], v[76:79], v[168:171]
    ds_read_b128 v[28:31], v10 offset:36864
    buffer_load_dwordx4 v5, s[4:7], s31 offen offset:3072 lds
    v_mfma_f32_16x16x32_bf16 v[172:175], v[112:115], v[76:79], v[172:175]
    ds_read_b128 v[32:35], v10 offset:38912
    v_mfma_f32_16x16x32_bf16 v[176:179], v[100:103], v[80:83], v[176:179]
    ds_read_b128 v[36:39], v10 offset:40960
    s_add_u32 m0, s34, 0
    v_mfma_f32_16x16x32_bf16 v[180:183], v[104:107], v[80:83], v[180:183]
    ds_read_b128 v[40:43], v10 offset:43008
    buffer_load_dwordx4 v6, s[8:11], s32 offen offset:0 nt lds
    v_mfma_f32_16x16x32_bf16 v[184:187], v[108:111], v[80:83], v[184:187]
    ds_read_b128 v[44:47], v10 offset:45056
    v_mfma_f32_16x16x32_bf16 v[188:191], v[112:115], v[80:83], v[188:191]
    ds_read_b128 v[48:51], v10 offset:47104
    v_mfma_f32_16x16x32_bf16 v[192:195], v[100:103], v[84:87], v[192:195]
    buffer_load_dwordx4 v7, s[8:11], s32 offen offset:1024 nt lds
    v_mfma_f32_16x16x32_bf16 v[196:199], v[104:107], v[84:87], v[196:199]
    v_mfma_f32_16x16x32_bf16 v[200:203], v[108:111], v[84:87], v[200:203]
    v_mfma_f32_16x16x32_bf16 v[204:207], v[112:115], v[84:87], v[204:207]
    buffer_load_dwordx4 v8, s[8:11], s32 offen offset:2048 nt lds
    v_mfma_f32_16x16x32_bf16 v[208:211], v[100:103], v[88:91], v[208:211]
    v_mfma_f32_16x16x32_bf16 v[212:215], v[104:107], v[88:91], v[212:215]
    v_mfma_f32_16x16x32_bf16 v[216:219], v[108:111], v[88:91], v[216:219]
    buffer_load_dwordx4 v9, s[8:11], s32 offen offset:3072 nt lds
    v_mfma_f32_16x16x32_bf16 v[220:223], v[112:115], v[88:91], v[220:223]
    v_mfma_f32_16x16x32_bf16 v[224:227], v[100:103], v[92:95], v[224:227]
    v_mfma_f32_16x16x32_bf16 v[228:231], v[104:107], v[92:95], v[228:231]
    v_mfma_f32_16x16x32_bf16 v[232:235], v[108:111], v[92:95], v[232:235]
    v_mfma_f32_16x16x32_bf16 v[236:239], v[112:115], v[92:95], v[236:239]
    v_mfma_f32_16x16x32_bf16 v[240:243], v[100:103], v[96:99], v[240:243]
    v_mfma_f32_16x16x32_bf16 v[244:247], v[104:107], v[96:99], v[244:247]
    v_mfma_f32_16x16x32_bf16 v[248:251], v[108:111], v[96:99], v[248:251]
    v_mfma_f32_16x16x32_bf16 v[252:255], v[112:115], v[96:99], v[252:255]
    s_bitcmp1_b32 3, s35
    s_cselect_b32 exec_lo, 255, 1
    s_mov_b32 exec_hi, 0
    global_load_dword v0, v17, s[96:97]
    s_mov_b64 exec, -1
    s_cselect_b32 s36, s45, 0
    v_add_u32 v17, s36, v17
    v_min_u32 v17, 8388480, v17
    s_nop 1
    s_add_u32 s31, s31, s40
    s_add_u32 s32, s32, s41
    s_waitcnt lgkmcnt(0)
    v_mfma_f32_16x16x32_bf16 v[128:131], v[52:55], v[20:23], v[128:131]
    ds_read_b128 v[68:71], v11 offset:32768
    v_mfma_f32_16x16x32_bf16 v[132:135], v[56:59], v[20:23], v[132:135]
    ds_read_b64_tr_b16 v[100:101], v12 offset:40960
    v_mfma_f32_16x16x32_bf16 v[136:139], v[60:63], v[20:23], v[136:139]
    ds_read_b64_tr_b16 v[102:103], v12 offset:41984
    v_mfma_f32_16x16x32_bf16 v[140:143], v[64:67], v[20:23], v[140:143]
    ds_read_b64_tr_b16 v[104:105], v13 offset:40960
    v_mfma_f32_16x16x32_bf16 v[144:147], v[52:55], v[24:27], v[144:147]
    ds_read_b64_tr_b16 v[106:107], v13 offset:41984
    v_mfma_f32_16x16x32_bf16 v[148:151], v[56:59], v[24:27], v[148:151]
    ds_read_b64_tr_b16 v[108:109], v14 offset:40960
    v_mfma_f32_16x16x32_bf16 v[152:155], v[60:63], v[24:27], v[152:155]
    ds_read_b64_tr_b16 v[110:111], v14 offset:41984
    v_mfma_f32_16x16x32_bf16 v[156:159], v[64:67], v[24:27], v[156:159]
    ds_read_b64_tr_b16 v[112:113], v15 offset:40960
    v_mfma_f32_16x16x32_bf16 v[160:163], v[52:55], v[28:31], v[160:163]
    ds_read_b64_tr_b16 v[114:115], v15 offset:41984
    v_mfma_f32_16x16x32_bf16 v[164:167], v[56:59], v[28:31], v[164:167]
    ds_read_b128 v[72:75], v11 offset:34816
    v_mfma_f32_16x16x32_bf16 v[168:171], v[60:63], v[28:31], v[168:171]
    ds_read_b128 v[76:79], v11 offset:36864
    v_mfma_f32_16x16x32_bf16 v[172:175], v[64:67], v[28:31], v[172:175]
    ds_read_b128 v[80:83], v11 offset:38912
    v_mfma_f32_16x16x32_bf16 v[176:179], v[52:55], v[32:35], v[176:179]
    ds_read_b128 v[84:87], v11 offset:40960
    v_mfma_f32_16x16x32_bf16 v[180:183], v[56:59], v[32:35], v[180:183]
    ds_read_b128 v[88:91], v11 offset:43008
    v_mfma_f32_16x16x32_bf16 v[184:187], v[60:63], v[32:35], v[184:187]
    ds_read_b128 v[92:95], v11 offset:45056
    v_mfma_f32_16x16x32_bf16 v[188:191], v[64:67], v[32:35], v[188:191]
    ds_read_b128 v[96:99], v11 offset:47104
    v_mfma_f32_16x16x32_bf16 v[192:195], v[52:55], v[36:39], v[192:195]
    v_mfma_f32_16x16x32_bf16 v[196:199], v[56:59], v[36:39], v[196:199]
    v_mfma_f32_16x16x32_bf16 v[200:203], v[60:63], v[36:39], v[200:203]
    v_mfma_f32_16x16x32_bf16 v[204:207], v[64:67], v[36:39], v[204:207]
    v_mfma_f32_16x16x32_bf16 v[208:211], v[52:55], v[40:43], v[208:211]
    s_bitcmp1_b32 s43, s35
    s_cbranch_scc1 L_recurrent_scan__compressed_kv_cla__moe_arch_mod__prompt_kernel_rare_13
L_recurrent_scan__compressed_kv_cla__moe_arch_mod__prompt_kernel_back_14:
    v_mfma_f32_16x16x32_bf16 v[212:215], v[56:59], v[40:43], v[212:215]
    v_mfma_f32_16x16x32_bf16 v[216:219], v[60:63], v[40:43], v[216:219]
    v_mfma_f32_16x16x32_bf16 v[220:223], v[64:67], v[40:43], v[220:223]
    v_mfma_f32_16x16x32_bf16 v[224:227], v[52:55], v[44:47], v[224:227]
    v_mfma_f32_16x16x32_bf16 v[228:231], v[56:59], v[44:47], v[228:231]
    v_mfma_f32_16x16x32_bf16 v[232:235], v[60:63], v[44:47], v[232:235]
    v_mfma_f32_16x16x32_bf16 v[236:239], v[64:67], v[44:47], v[236:239]
    v_mfma_f32_16x16x32_bf16 v[240:243], v[52:55], v[48:51], v[240:243]
    v_mfma_f32_16x16x32_bf16 v[244:247], v[56:59], v[48:51], v[244:247]
    v_mfma_f32_16x16x32_bf16 v[248:251], v[60:63], v[48:51], v[248:251]
    v_mfma_f32_16x16x32_bf16 v[252:255], v[64:67], v[48:51], v[252:255]
    s_bitcmp1_b32 s43, s35
    s_cbranch_scc1 L_recurrent_scan__compressed_kv_cla__moe_arch_mod__prompt_kernel_w0_15
    s_waitcnt vmcnt(1)
L_recurrent_scan__compressed_kv_cla__moe_arch_mod__prompt_kernel_w0b_16:
    s_waitcnt lgkmcnt(0)
    s_cmp_eq_u32 s35, 3
    s_barrier
    s_cbranch_scc1 L_p1_fin0
    v_mfma_f32_16x16x32_bf16 v[128:131], v[100:103], v[68:71], v[128:131]
    ds_read_b128 v[20:23], v10 offset:0
    s_add_u32 m0, s33, 32768
    v_mfma_f32_16x16x32_bf16 v[132:135], v[104:107], v[68:71], v[132:135]
    ds_read_b64_tr_b16 v[52:53], v12 offset:0
    buffer_load_dwordx4 v2, s[4:7], s31 offen offset:0 lds
    v_mfma_f32_16x16x32_bf16 v[136:139], v[108:111], v[68:71], v[136:139]
    ds_read_b64_tr_b16 v[54:55], v12 offset:1024
    v_mfma_f32_16x16x32_bf16 v[140:143], v[112:115], v[68:71], v[140:143]
    ds_read_b64_tr_b16 v[56:57], v13 offset:0
    v_mfma_f32_16x16x32_bf16 v[144:147], v[100:103], v[72:75], v[144:147]
    ds_read_b64_tr_b16 v[58:59], v13 offset:1024
    buffer_load_dwordx4 v3, s[4:7], s31 offen offset:1024 lds
    v_mfma_f32_16x16x32_bf16 v[148:151], v[104:107], v[72:75], v[148:151]
    ds_read_b64_tr_b16 v[60:61], v14 offset:0
    v_mfma_f32_16x16x32_bf16 v[152:155], v[108:111], v[72:75], v[152:155]
    ds_read_b64_tr_b16 v[62:63], v14 offset:1024
    v_mfma_f32_16x16x32_bf16 v[156:159], v[112:115], v[72:75], v[156:159]
    ds_read_b64_tr_b16 v[64:65], v15 offset:0
    buffer_load_dwordx4 v4, s[4:7], s31 offen offset:2048 lds
    v_mfma_f32_16x16x32_bf16 v[160:163], v[100:103], v[76:79], v[160:163]
    ds_read_b64_tr_b16 v[66:67], v15 offset:1024
    v_mfma_f32_16x16x32_bf16 v[164:167], v[104:107], v[76:79], v[164:167]
    ds_read_b128 v[24:27], v10 offset:2048
    v_mfma_f32_16x16x32_bf16 v[168:171], v[108:111], v[76:79], v[168:171]
    ds_read_b128 v[28:31], v10 offset:4096
    buffer_load_dwordx4 v5, s[4:7], s31 offen offset:3072 lds
    v_mfma_f32_16x16x32_bf16 v[172:175], v[112:115], v[76:79], v[172:175]
    ds_read_b128 v[32:35], v10 offset:6144
    v_mfma_f32_16x16x32_bf16 v[176:179], v[100:103], v[80:83], v[176:179]
    ds_read_b128 v[36:39], v10 offset:8192
    s_add_u32 m0, s34, 32768
    v_mfma_f32_16x16x32_bf16 v[180:183], v[104:107], v[80:83], v[180:183]
    ds_read_b128 v[40:43], v10 offset:10240
    buffer_load_dwordx4 v6, s[8:11], s32 offen offset:0 nt lds
    v_mfma_f32_16x16x32_bf16 v[184:187], v[108:111], v[80:83], v[184:187]
    ds_read_b128 v[44:47], v10 offset:12288
    v_mfma_f32_16x16x32_bf16 v[188:191], v[112:115], v[80:83], v[188:191]
    ds_read_b128 v[48:51], v10 offset:14336
    v_mfma_f32_16x16x32_bf16 v[192:195], v[100:103], v[84:87], v[192:195]
    buffer_load_dwordx4 v7, s[8:11], s32 offen offset:1024 nt lds
    v_mfma_f32_16x16x32_bf16 v[196:199], v[104:107], v[84:87], v[196:199]
    v_mfma_f32_16x16x32_bf16 v[200:203], v[108:111], v[84:87], v[200:203]
    v_mfma_f32_16x16x32_bf16 v[204:207], v[112:115], v[84:87], v[204:207]
    buffer_load_dwordx4 v8, s[8:11], s32 offen offset:2048 nt lds
    v_mfma_f32_16x16x32_bf16 v[208:211], v[100:103], v[88:91], v[208:211]
    v_mfma_f32_16x16x32_bf16 v[212:215], v[104:107], v[88:91], v[212:215]
    v_mfma_f32_16x16x32_bf16 v[216:219], v[108:111], v[88:91], v[216:219]
    buffer_load_dwordx4 v9, s[8:11], s32 offen offset:3072 nt lds
    v_mfma_f32_16x16x32_bf16 v[220:223], v[112:115], v[88:91], v[220:223]
    v_mfma_f32_16x16x32_bf16 v[224:227], v[100:103], v[92:95], v[224:227]
    v_mfma_f32_16x16x32_bf16 v[228:231], v[104:107], v[92:95], v[228:231]
    v_mfma_f32_16x16x32_bf16 v[232:235], v[108:111], v[92:95], v[232:235]
    v_mfma_f32_16x16x32_bf16 v[236:239], v[112:115], v[92:95], v[236:239]
    v_mfma_f32_16x16x32_bf16 v[240:243], v[100:103], v[96:99], v[240:243]
    v_mfma_f32_16x16x32_bf16 v[244:247], v[104:107], v[96:99], v[244:247]
    v_mfma_f32_16x16x32_bf16 v[248:251], v[108:111], v[96:99], v[248:251]
    s_add_u32 s36, s35, s28
    s_cmp_eq_u32 s36, 0
    s_cbranch_scc1 L_recurrent_scan__compressed_kv_cla__moe_arch_mod__prompt_kernel_rare_25
L_recurrent_scan__compressed_kv_cla__moe_arch_mod__prompt_kernel_back_26:
    v_mfma_f32_16x16x32_bf16 v[252:255], v[112:115], v[96:99], v[252:255]
    s_bitcmp1_b32 3, s35
    s_cselect_b32 exec_lo, 255, 1
    s_mov_b32 exec_hi, 0
    global_load_dword v0, v17, s[96:97]
    s_mov_b64 exec, -1
    s_cselect_b32 s36, s45, 0
    v_add_u32 v17, s36, v17
    v_min_u32 v17, 8388480, v17
    s_nop 1
    s_add_u32 s31, s31, s40
    s_add_u32 s32, s32, s41
    s_add_u32 s35, s35, 1
    s_branch L_kv_kloop
L_p1_fin0:
    v_mfma_f32_16x16x32_bf16 v[128:131], v[100:103], v[68:71], v[128:131]
    s_and_b32 s36, s28, 3
    s_sub_u32 s37, 15, s30
    s_cmp_lt_u32 s28, 4
    s_cselect_b32 s37, s37, s30
    s_lshl_b32 s37, s37, 2
    s_add_u32 s37, s37, s36
    s_lshl_b32 s37, s37, 16
    v_lshl_add_u32 v6, v1, 4, s37
    v_add_u32 v7, 32768, v6
    s_mov_b32 s32, 0
    s_mov_b32 s8, s54
    s_and_b32 s9, s55, 0xffff
    s_mov_b32 s10, 104857728
    s_mov_b32 s11, 0x20000
    v_mfma_f32_16x16x32_bf16 v[132:135], v[104:107], v[68:71], v[132:135]
    buffer_load_dwordx4 v[24:27], v6, s[8:11], s32 offen offset:0 sc1
    v_mfma_f32_16x16x32_bf16 v[136:139], v[108:111], v[68:71], v[136:139]
    v_lshrrev_b32 v18, 4, v1
    v_mfma_f32_16x16x32_bf16 v[140:143], v[112:115], v[68:71], v[140:143]
    v_bfe_u32 v20, v1, 2, 2
    v_mfma_f32_16x16x32_bf16 v[144:147], v[100:103], v[72:75], v[144:147]
    v_lshl_add_u32 v19, v18, 3, v20
    v_mfma_f32_16x16x32_bf16 v[148:151], v[104:107], v[72:75], v[148:151]
    buffer_load_dwordx4 v[28:31], v7, s[8:11], s32 offen offset:0 sc1
    v_lshlrev_b32 v19, 8, v19
    v_mfma_f32_16x16x32_bf16 v[152:155], v[108:111], v[72:75], v[152:155]
    v_and_b32 v21, 3, v1
    v_mfma_f32_16x16x32_bf16 v[156:159], v[112:115], v[72:75], v[156:159]
    v_lshl_add_u32 v19, v21, 3, v19
    v_mfma_f32_16x16x32_bf16 v[160:163], v[100:103], v[76:79], v[160:163]
    v_and_b32 v21, 1, v18
    v_mfma_f32_16x16x32_bf16 v[164:167], v[104:107], v[76:79], v[164:167]
    buffer_load_dwordx4 v[32:35], v6, s[8:11], s32 offen offset:1024 sc1
    v_lshl_add_u32 v20, v21, 2, v20
    v_mfma_f32_16x16x32_bf16 v[168:171], v[108:111], v[76:79], v[168:171]
    v_xor_b32 v21, 0, v20
    v_mfma_f32_16x16x32_bf16 v[172:175], v[112:115], v[76:79], v[172:175]
    v_lshl_add_u32 v10, v21, 5, v19
    v_mfma_f32_16x16x32_bf16 v[176:179], v[100:103], v[80:83], v[176:179]
    v_xor_b32 v21, 1, v20
    v_mfma_f32_16x16x32_bf16 v[180:183], v[104:107], v[80:83], v[180:183]
    buffer_load_dwordx4 v[36:39], v7, s[8:11], s32 offen offset:1024 sc1
    v_lshl_add_u32 v11, v21, 5, v19
    v_mfma_f32_16x16x32_bf16 v[184:187], v[108:111], v[80:83], v[184:187]
    v_xor_b32 v21, 2, v20
    v_mfma_f32_16x16x32_bf16 v[188:191], v[112:115], v[80:83], v[188:191]
    v_lshl_add_u32 v12, v21, 5, v19
    v_mfma_f32_16x16x32_bf16 v[192:195], v[100:103], v[84:87], v[192:195]
    v_xor_b32 v21, 3, v20
    v_mfma_f32_16x16x32_bf16 v[196:199], v[104:107], v[84:87], v[196:199]
    buffer_load_dwordx4 v[40:43], v6, s[8:11], s32 offen offset:2048 sc1
    v_lshl_add_u32 v13, v21, 5, v19
    v_mfma_f32_16x16x32_bf16 v[200:203], v[108:111], v[84:87], v[200:203]
    v_xor_b32 v21, 4, v20
    v_mfma_f32_16x16x32_bf16 v[204:207], v[112:115], v[84:87], v[204:207]
    v_lshl_add_u32 v14, v21, 5, v19
    v_mfma_f32_16x16x32_bf16 v[208:211], v[100:103], v[88:91], v[208:211]
    v_xor_b32 v21, 5, v20
    v_mfma_f32_16x16x32_bf16 v[212:215], v[104:107], v[88:91], v[212:215]
    buffer_load_dwordx4 v[44:47], v7, s[8:11], s32 offen offset:2048 sc1
    v_lshl_add_u32 v15, v21, 5, v19
    v_mfma_f32_16x16x32_bf16 v[216:219], v[108:111], v[88:91], v[216:219]
    v_xor_b32 v21, 6, v20
    v_mfma_f32_16x16x32_bf16 v[220:223], v[112:115], v[88:91], v[220:223]
    v_lshl_add_u32 v16, v21, 5, v19
    v_mfma_f32_16x16x32_bf16 v[224:227], v[100:103], v[92:95], v[224:227]
    v_xor_b32 v21, 7, v20
    v_mfma_f32_16x16x32_bf16 v[228:231], v[104:107], v[92:95], v[228:231]
    buffer_load_dwordx4 v[48:51], v6, s[8:11], s32 offen offset:3072 sc1
    v_lshl_add_u32 v17, v21, 5, v19
    v_mfma_f32_16x16x32_bf16 v[232:235], v[108:111], v[92:95], v[232:235]
    s_lshl_b32 s45, s29, 20
    v_mfma_f32_16x16x32_bf16 v[236:239], v[112:115], v[92:95], v[236:239]
    v_mfma_f32_16x16x32_bf16 v[240:243], v[100:103], v[96:99], v[240:243]
    v_mfma_f32_16x16x32_bf16 v[244:247], v[104:107], v[96:99], v[244:247]
    buffer_load_dwordx4 v[52:55], v7, s[8:11], s32 offen offset:3072 sc1
    v_mfma_f32_16x16x32_bf16 v[248:251], v[108:111], v[96:99], v[248:251]
    v_mfma_f32_16x16x32_bf16 v[252:255], v[112:115], v[96:99], v[252:255]
    s_branch L_p1_done
    .p2align 6
L_kv_vloop:
    s_waitcnt lgkmcnt(0)
    v_mfma_f32_16x16x32_bf16 v[128:131], v[20:23], v[52:55], v[128:131]
    ds_read_b128 v[68:71], v11 offset:0
    v_mfma_f32_16x16x32_bf16 v[160:163], v[20:23], v[56:59], v[160:163]
    ds_read_b64_tr_b16 v[100:101], v12 offset:8192
    v_mfma_f32_16x16x32_bf16 v[192:195], v[20:23], v[60:63], v[192:195]
    ds_read_b64_tr_b16 v[102:103], v12 offset:9216
    v_mfma_f32_16x16x32_bf16 v[224:227], v[20:23], v[64:67], v[224:227]
    ds_read_b64_tr_b16 v[104:105], v13 offset:8192
    v_mfma_f32_16x16x32_bf16 v[132:135], v[24:27], v[52:55], v[132:135]
    ds_read_b64_tr_b16 v[106:107], v13 offset:9216
    v_mfma_f32_16x16x32_bf16 v[164:167], v[24:27], v[56:59], v[164:167]
    ds_read_b64_tr_b16 v[108:109], v14 offset:8192
    v_mfma_f32_16x16x32_bf16 v[196:199], v[24:27], v[60:63], v[196:199]
    ds_read_b64_tr_b16 v[110:111], v14 offset:9216
    v_mfma_f32_16x16x32_bf16 v[228:231], v[24:27], v[64:67], v[228:231]
    ds_read_b64_tr_b16 v[112:113], v15 offset:8192
    v_mfma_f32_16x16x32_bf16 v[136:139], v[28:31], v[52:55], v[136:139]
    ds_read_b64_tr_b16 v[114:115], v15 offset:9216
    v_mfma_f32_16x16x32_bf16 v[168:171], v[28:31], v[56:59], v[168:171]
    ds_read_b128 v[72:75], v11 offset:2048
    v_mfma_f32_16x16x32_bf16 v[200:203], v[28:31], v[60:63], v[200:203]
    ds_read_b128 v[76:79], v11 offset:4096
    v_mfma_f32_16x16x32_bf16 v[232:235], v[28:31], v[64:67], v[232:235]
    ds_read_b128 v[80:83], v11 offset:6144
    v_mfma_f32_16x16x32_bf16 v[140:143], v[32:35], v[52:55], v[140:143]
    ds_read_b128 v[84:87], v11 offset:8192
    v_mfma_f32_16x16x32_bf16 v[172:175], v[32:35], v[56:59], v[172:175]
    ds_read_b128 v[88:91], v11 offset:10240
    v_mfma_f32_16x16x32_bf16 v[204:207], v[32:35], v[60:63], v[204:207]
    ds_read_b128 v[92:95], v11 offset:12288
    v_mfma_f32_16x16x32_bf16 v[236:239], v[32:35], v[64:67], v[236:239]
    ds_read_b128 v[96:99], v11 offset:14336
    v_mfma_f32_16x16x32_bf16 v[144:147], v[36:39], v[52:55], v[144:147]
    v_mfma_f32_16x16x32_bf16 v[176:179], v[36:39], v[56:59], v[176:179]
    v_mfma_f32_16x16x32_bf16 v[208:211], v[36:39], v[60:63], v[208:211]
    v_mfma_f32_16x16x32_bf16 v[240:243], v[36:39], v[64:67], v[240:243]
    v_mfma_f32_16x16x32_bf16 v[148:151], v[40:43], v[52:55], v[148:151]
    v_mfma_f32_16x16x32_bf16 v[180:183], v[40:43], v[56:59], v[180:183]
    v_mfma_f32_16x16x32_bf16 v[212:215], v[40:43], v[60:63], v[212:215]
    v_mfma_f32_16x16x32_bf16 v[244:247], v[40:43], v[64:67], v[244:247]
    v_mfma_f32_16x16x32_bf16 v[152:155], v[44:47], v[52:55], v[152:155]
    v_mfma_f32_16x16x32_bf16 v[184:187], v[44:47], v[56:59], v[184:187]
    v_mfma_f32_16x16x32_bf16 v[216:219], v[44:47], v[60:63], v[216:219]
    v_mfma_f32_16x16x32_bf16 v[248:251], v[44:47], v[64:67], v[248:251]
    v_mfma_f32_16x16x32_bf16 v[156:159], v[48:51], v[52:55], v[156:159]
    v_mfma_f32_16x16x32_bf16 v[188:191], v[48:51], v[56:59], v[188:191]
    v_mfma_f32_16x16x32_bf16 v[220:223], v[48:51], v[60:63], v[220:223]
    v_mfma_f32_16x16x32_bf16 v[252:255], v[48:51], v[64:67], v[252:255]
    s_cmp_lt_u32 s35, s44
    s_cbranch_scc1 L_recurrent_scan__compressed_kv_cla__moe_arch_mod__prompt_kernel_w0_27
    s_waitcnt vmcnt(1)
L_recurrent_scan__compressed_kv_cla__moe_arch_mod__prompt_kernel_w0b_28:
    s_waitcnt lgkmcnt(0)
    s_barrier
    s_add_u32 m0, s33, 0
    s_nop 0
    buffer_load_dwordx4 v2, s[4:7], s31 offen offset:0 lds
    buffer_load_dwordx4 v3, s[4:7], s31 offen offset:1024 lds
    buffer_load_dwordx4 v4, s[4:7], s31 offen offset:2048 lds
    buffer_load_dwordx4 v5, s[4:7], s31 offen offset:3072 lds
    s_add_u32 m0, s34, 0
    s_nop 0
    buffer_load_dwordx4 v6, s[8:11], s32 offen offset:0 nt lds
    buffer_load_dwordx4 v7, s[8:11], s32 offen offset:1024 nt lds
    buffer_load_dwordx4 v8, s[8:11], s32 offen offset:2048 nt lds
    buffer_load_dwordx4 v9, s[8:11], s32 offen offset:3072 nt lds
    s_add_u32 s31, s31, s40
    s_add_u32 s32, s32, s41
    s_cmp_eq_u32 s35, 0
    s_cbranch_scc1 L_recurrent_scan__compressed_kv_cla__moe_arch_mod__prompt_kernel_rare_32
L_recurrent_scan__compressed_kv_cla__moe_arch_mod__prompt_kernel_back_33:
    v_mfma_f32_16x16x32_bf16 v[128:131], v[68:71], v[100:103], v[128:131]
    ds_read_b128 v[20:23], v10 offset:32768
    v_mfma_f32_16x16x32_bf16 v[160:163], v[68:71], v[104:107], v[160:163]
    ds_read_b64_tr_b16 v[52:53], v12 offset:32768
    v_mfma_f32_16x16x32_bf16 v[192:195], v[68:71], v[108:111], v[192:195]
    ds_read_b64_tr_b16 v[54:55], v12 offset:33792
    v_mfma_f32_16x16x32_bf16 v[224:227], v[68:71], v[112:115], v[224:227]
    ds_read_b64_tr_b16 v[56:57], v13 offset:32768
    v_mfma_f32_16x16x32_bf16 v[132:135], v[72:75], v[100:103], v[132:135]
    ds_read_b64_tr_b16 v[58:59], v13 offset:33792
    v_mfma_f32_16x16x32_bf16 v[164:167], v[72:75], v[104:107], v[164:167]
    ds_read_b64_tr_b16 v[60:61], v14 offset:32768
    v_mfma_f32_16x16x32_bf16 v[196:199], v[72:75], v[108:111], v[196:199]
    ds_read_b64_tr_b16 v[62:63], v14 offset:33792
    v_mfma_f32_16x16x32_bf16 v[228:231], v[72:75], v[112:115], v[228:231]
    ds_read_b64_tr_b16 v[64:65], v15 offset:32768
    v_mfma_f32_16x16x32_bf16 v[136:139], v[76:79], v[100:103], v[136:139]
    ds_read_b64_tr_b16 v[66:67], v15 offset:33792
    v_mfma_f32_16x16x32_bf16 v[168:171], v[76:79], v[104:107], v[168:171]
    ds_read_b128 v[24:27], v10 offset:34816
    v_mfma_f32_16x16x32_bf16 v[200:203], v[76:79], v[108:111], v[200:203]
    ds_read_b128 v[28:31], v10 offset:36864
    v_mfma_f32_16x16x32_bf16 v[232:235], v[76:79], v[112:115], v[232:235]
    ds_read_b128 v[32:35], v10 offset:38912
    v_mfma_f32_16x16x32_bf16 v[140:143], v[80:83], v[100:103], v[140:143]
    ds_read_b128 v[36:39], v10 offset:40960
    v_mfma_f32_16x16x32_bf16 v[172:175], v[80:83], v[104:107], v[172:175]
    ds_read_b128 v[40:43], v10 offset:43008
    v_mfma_f32_16x16x32_bf16 v[204:207], v[80:83], v[108:111], v[204:207]
    ds_read_b128 v[44:47], v10 offset:45056
    v_mfma_f32_16x16x32_bf16 v[236:239], v[80:83], v[112:115], v[236:239]
    ds_read_b128 v[48:51], v10 offset:47104
    v_mfma_f32_16x16x32_bf16 v[144:147], v[84:87], v[100:103], v[144:147]
    v_mfma_f32_16x16x32_bf16 v[176:179], v[84:87], v[104:107], v[176:179]
    v_mfma_f32_16x16x32_bf16 v[208:211], v[84:87], v[108:111], v[208:211]
    v_mfma_f32_16x16x32_bf16 v[240:243], v[84:87], v[112:115], v[240:243]
    v_mfma_f32_16x16x32_bf16 v[148:151], v[88:91], v[100:103], v[148:151]
    v_mfma_f32_16x16x32_bf16 v[180:183], v[88:91], v[104:107], v[180:183]
    v_mfma_f32_16x16x32_bf16 v[212:215], v[88:91], v[108:111], v[212:215]
    v_mfma_f32_16x16x32_bf16 v[244:247], v[88:91], v[112:115], v[244:247]
    v_mfma_f32_16x16x32_bf16 v[152:155], v[92:95], v[100:103], v[152:155]
    v_mfma_f32_16x16x32_bf16 v[184:187], v[92:95], v[104:107], v[184:187]
    v_mfma_f32_16x16x32_bf16 v[216:219], v[92:95], v[108:111], v[216:219]
    v_mfma_f32_16x16x32_bf16 v[248:251], v[92:95], v[112:115], v[248:251]
    v_mfma_f32_16x16x32_bf16 v[156:159], v[96:99], v[100:103], v[156:159]
    v_mfma_f32_16x16x32_bf16 v[188:191], v[96:99], v[104:107], v[188:191]
    v_mfma_f32_16x16x32_bf16 v[220:223], v[96:99], v[108:111], v[220:223]
    v_mfma_f32_16x16x32_bf16 v[252:255], v[96:99], v[112:115], v[252:255]
    s_bitcmp1_b32 3, s35
    s_cselect_b32 exec_lo, 255, 1
    s_mov_b32 exec_hi, 0
    global_load_dword v0, v17, s[96:97]
    s_mov_b64 exec, -1
    s_cselect_b32 s36, s45, 0
    v_add_u32 v17, s36, v17
    v_min_u32 v17, 8388480, v17
    s_nop 1
    s_waitcnt lgkmcnt(0)
    v_mfma_f32_16x16x32_bf16 v[128:131], v[20:23], v[52:55], v[128:131]
    ds_read_b128 v[68:71], v11 offset:32768
    v_mfma_f32_16x16x32_bf16 v[160:163], v[20:23], v[56:59], v[160:163]
    ds_read_b64_tr_b16 v[100:101], v12 offset:40960
    v_mfma_f32_16x16x32_bf16 v[192:195], v[20:23], v[60:63], v[192:195]
    ds_read_b64_tr_b16 v[102:103], v12 offset:41984
    v_mfma_f32_16x16x32_bf16 v[224:227], v[20:23], v[64:67], v[224:227]
    ds_read_b64_tr_b16 v[104:105], v13 offset:40960
    v_mfma_f32_16x16x32_bf16 v[132:135], v[24:27], v[52:55], v[132:135]
    ds_read_b64_tr_b16 v[106:107], v13 offset:41984
    v_mfma_f32_16x16x32_bf16 v[164:167], v[24:27], v[56:59], v[164:167]
    ds_read_b64_tr_b16 v[108:109], v14 offset:40960
    v_mfma_f32_16x16x32_bf16 v[196:199], v[24:27], v[60:63], v[196:199]
    ds_read_b64_tr_b16 v[110:111], v14 offset:41984
    v_mfma_f32_16x16x32_bf16 v[228:231], v[24:27], v[64:67], v[228:231]
    ds_read_b64_tr_b16 v[112:113], v15 offset:40960
    v_mfma_f32_16x16x32_bf16 v[136:139], v[28:31], v[52:55], v[136:139]
    ds_read_b64_tr_b16 v[114:115], v15 offset:41984
    v_mfma_f32_16x16x32_bf16 v[168:171], v[28:31], v[56:59], v[168:171]
    ds_read_b128 v[72:75], v11 offset:34816
    v_mfma_f32_16x16x32_bf16 v[200:203], v[28:31], v[60:63], v[200:203]
    ds_read_b128 v[76:79], v11 offset:36864
    v_mfma_f32_16x16x32_bf16 v[232:235], v[28:31], v[64:67], v[232:235]
    ds_read_b128 v[80:83], v11 offset:38912
    v_mfma_f32_16x16x32_bf16 v[140:143], v[32:35], v[52:55], v[140:143]
    ds_read_b128 v[84:87], v11 offset:40960
    v_mfma_f32_16x16x32_bf16 v[172:175], v[32:35], v[56:59], v[172:175]
    ds_read_b128 v[88:91], v11 offset:43008
    v_mfma_f32_16x16x32_bf16 v[204:207], v[32:35], v[60:63], v[204:207]
    ds_read_b128 v[92:95], v11 offset:45056
    v_mfma_f32_16x16x32_bf16 v[236:239], v[32:35], v[64:67], v[236:239]
    ds_read_b128 v[96:99], v11 offset:47104
    v_mfma_f32_16x16x32_bf16 v[144:147], v[36:39], v[52:55], v[144:147]
    v_mfma_f32_16x16x32_bf16 v[176:179], v[36:39], v[56:59], v[176:179]
    v_mfma_f32_16x16x32_bf16 v[208:211], v[36:39], v[60:63], v[208:211]
    v_mfma_f32_16x16x32_bf16 v[240:243], v[36:39], v[64:67], v[240:243]
    v_mfma_f32_16x16x32_bf16 v[148:151], v[40:43], v[52:55], v[148:151]
    v_mfma_f32_16x16x32_bf16 v[180:183], v[40:43], v[56:59], v[180:183]
    v_mfma_f32_16x16x32_bf16 v[212:215], v[40:43], v[60:63], v[212:215]
    v_mfma_f32_16x16x32_bf16 v[244:247], v[40:43], v[64:67], v[244:247]
    v_mfma_f32_16x16x32_bf16 v[152:155], v[44:47], v[52:55], v[152:155]
    v_mfma_f32_16x16x32_bf16 v[184:187], v[44:47], v[56:59], v[184:187]
    v_mfma_f32_16x16x32_bf16 v[216:219], v[44:47], v[60:63], v[216:219]
    v_mfma_f32_16x16x32_bf16 v[248:251], v[44:47], v[64:67], v[248:251]
    v_mfma_f32_16x16x32_bf16 v[156:159], v[48:51], v[52:55], v[156:159]
    v_mfma_f32_16x16x32_bf16 v[188:191], v[48:51], v[56:59], v[188:191]
    v_mfma_f32_16x16x32_bf16 v[220:223], v[48:51], v[60:63], v[220:223]
    v_mfma_f32_16x16x32_bf16 v[252:255], v[48:51], v[64:67], v[252:255]
    s_waitcnt vmcnt(1) lgkmcnt(0)
    s_cmp_eq_u32 s35, 3
    s_barrier
    s_cbranch_scc1 L_p1_fin1
    s_add_u32 m0, s33, 32768
    s_nop 0
    buffer_load_dwordx4 v2, s[4:7], s31 offen offset:0 lds
    buffer_load_dwordx4 v3, s[4:7], s31 offen offset:1024 lds
    buffer_load_dwordx4 v4, s[4:7], s31 offen offset:2048 lds
    buffer_load_dwordx4 v5, s[4:7], s31 offen offset:3072 lds
    s_add_u32 m0, s34, 32768
    s_nop 0
    buffer_load_dwordx4 v6, s[8:11], s32 offen offset:0 nt lds
    buffer_load_dwordx4 v7, s[8:11], s32 offen offset:1024 nt lds
    buffer_load_dwordx4 v8, s[8:11], s32 offen offset:2048 nt lds
    buffer_load_dwordx4 v9, s[8:11], s32 offen offset:3072 nt lds
    s_add_u32 s31, s31, s40
    s_add_u32 s32, s32, s41
    s_cmp_eq_u32 s35, 2
    s_cbranch_scc1 L_recurrent_scan__compressed_kv_cla__moe_arch_mod__prompt_kernel_rare_36
L_recurrent_scan__compressed_kv_cla__moe_arch_mod__prompt_kernel_back_37:
    v_mfma_f32_16x16x32_bf16 v[128:131], v[68:71], v[100:103], v[128:131]
    ds_read_b128 v[20:23], v10 offset:0
    v_mfma_f32_16x16x32_bf16 v[160:163], v[68:71], v[104:107], v[160:163]
    ds_read_b64_tr_b16 v[52:53], v12 offset:0
    v_mfma_f32_16x16x32_bf16 v[192:195], v[68:71], v[108:111], v[192:195]
    ds_read_b64_tr_b16 v[54:55], v12 offset:1024
    v_mfma_f32_16x16x32_bf16 v[224:227], v[68:71], v[112:115], v[224:227]
    ds_read_b64_tr_b16 v[56:57], v13 offset:0
    v_mfma_f32_16x16x32_bf16 v[132:135], v[72:75], v[100:103], v[132:135]
    ds_read_b64_tr_b16 v[58:59], v13 offset:1024
    v_mfma_f32_16x16x32_bf16 v[164:167], v[72:75], v[104:107], v[164:167]
    ds_read_b64_tr_b16 v[60:61], v14 offset:0
    v_mfma_f32_16x16x32_bf16 v[196:199], v[72:75], v[108:111], v[196:199]
    ds_read_b64_tr_b16 v[62:63], v14 offset:1024
    v_mfma_f32_16x16x32_bf16 v[228:231], v[72:75], v[112:115], v[228:231]
    ds_read_b64_tr_b16 v[64:65], v15 offset:0
    v_mfma_f32_16x16x32_bf16 v[136:139], v[76:79], v[100:103], v[136:139]
    ds_read_b64_tr_b16 v[66:67], v15 offset:1024
    v_mfma_f32_16x16x32_bf16 v[168:171], v[76:79], v[104:107], v[168:171]
    ds_read_b128 v[24:27], v10 offset:2048
    v_mfma_f32_16x16x32_bf16 v[200:203], v[76:79], v[108:111], v[200:203]
    ds_read_b128 v[28:31], v10 offset:4096
    v_mfma_f32_16x16x32_bf16 v[232:235], v[76:79], v[112:115], v[232:235]
    ds_read_b128 v[32:35], v10 offset:6144
    v_mfma_f32_16x16x32_bf16 v[140:143], v[80:83], v[100:103], v[140:143]
    ds_read_b128 v[36:39], v10 offset:8192
    v_mfma_f32_16x16x32_bf16 v[172:175], v[80:83], v[104:107], v[172:175]
    ds_read_b128 v[40:43], v10 offset:10240
    v_mfma_f32_16x16x32_bf16 v[204:207], v[80:83], v[108:111], v[204:207]
    ds_read_b128 v[44:47], v10 offset:12288
    v_mfma_f32_16x16x32_bf16 v[236:239], v[80:83], v[112:115], v[236:239]
    ds_read_b128 v[48:51], v10 offset:14336
    v_mfma_f32_16x16x32_bf16 v[144:147], v[84:87], v[100:103], v[144:147]
    v_mfma_f32_16x16x32_bf16 v[176:179], v[84:87], v[104:107], v[176:179]
    v_mfma_f32_16x16x32_bf16 v[208:211], v[84:87], v[108:111], v[208:211]
    v_mfma_f32_16x16x32_bf16 v[240:243], v[84:87], v[112:115], v[240:243]
    v_mfma_f32_16x16x32_bf16 v[148:151], v[88:91], v[100:103], v[148:151]
    v_mfma_f32_16x16x32_bf16 v[180:183], v[88:91], v[104:107], v[180:183]
    v_mfma_f32_16x16x32_bf16 v[212:215], v[88:91], v[108:111], v[212:215]
    v_mfma_f32_16x16x32_bf16 v[244:247], v[88:91], v[112:115], v[244:247]
    v_mfma_f32_16x16x32_bf16 v[152:155], v[92:95], v[100:103], v[152:155]
    v_mfma_f32_16x16x32_bf16 v[184:187], v[92:95], v[104:107], v[184:187]
    v_mfma_f32_16x16x32_bf16 v[216:219], v[92:95], v[108:111], v[216:219]
    v_mfma_f32_16x16x32_bf16 v[248:251], v[92:95], v[112:115], v[248:251]
    v_mfma_f32_16x16x32_bf16 v[156:159], v[96:99], v[100:103], v[156:159]
    v_mfma_f32_16x16x32_bf16 v[188:191], v[96:99], v[104:107], v[188:191]
    v_mfma_f32_16x16x32_bf16 v[220:223], v[96:99], v[108:111], v[220:223]
    v_mfma_f32_16x16x32_bf16 v[252:255], v[96:99], v[112:115], v[252:255]
    s_bitcmp1_b32 3, s35
    s_cselect_b32 exec_lo, 255, 1
    s_mov_b32 exec_hi, 0
    global_load_dword v0, v17, s[96:97]
    s_mov_b64 exec, -1
    s_cselect_b32 s36, s45, 0
    v_add_u32 v17, s36, v17
    v_min_u32 v17, 8388480, v17
    s_nop 1
    s_add_u32 s35, s35, 1
    s_branch L_kv_vloop
L_p1_fin1:
    s_and_b32 s36, s28, 3
    s_sub_u32 s37, 15, s30
    s_cmp_lt_u32 s28, 4
    s_cselect_b32 s37, s37, s30
    s_lshl_b32 s37, s37, 2
    s_add_u32 s37, s37, s36
    s_lshl_b32 s37, s37, 16
    v_lshl_add_u32 v6, v1, 4, s37
    v_add_u32 v7, 32768, v6
    s_mov_b32 s32, 0
    s_mov_b32 s8, s54
    s_and_b32 s9, s55, 0xffff
    s_mov_b32 s10, 104857728
    s_mov_b32 s11, 0x20000
    v_mfma_f32_16x16x32_bf16 v[128:131], v[68:71], v[100:103], v[128:131]
    v_mfma_f32_16x16x32_bf16 v[160:163], v[68:71], v[104:107], v[160:163]
    buffer_load_dwordx4 v[24:27], v6, s[8:11], s32 offen offset:0 sc1
    v_mfma_f32_16x16x32_bf16 v[192:195], v[68:71], v[108:111], v[192:195]
    v_lshrrev_b32 v18, 4, v1
    v_mfma_f32_16x16x32_bf16 v[224:227], v[68:71], v[112:115], v[224:227]
    v_bfe_u32 v20, v1, 2, 2
    v_mfma_f32_16x16x32_bf16 v[132:135], v[72:75], v[100:103], v[132:135]
    v_lshl_add_u32 v19, v18, 3, v20
    v_mfma_f32_16x16x32_bf16 v[164:167], v[72:75], v[104:107], v[164:167]
    buffer_load_dwordx4 v[28:31], v7, s[8:11], s32 offen offset:0 sc1
    v_lshlrev_b32 v19, 8, v19
    v_mfma_f32_16x16x32_bf16 v[196:199], v[72:75], v[108:111], v[196:199]
    v_and_b32 v21, 3, v1
    v_mfma_f32_16x16x32_bf16 v[228:231], v[72:75], v[112:115], v[228:231]
    v_lshl_add_u32 v19, v21, 3, v19
    v_mfma_f32_16x16x32_bf16 v[136:139], v[76:79], v[100:103], v[136:139]
    v_and_b32 v21, 1, v18
    v_mfma_f32_16x16x32_bf16 v[168:171], v[76:79], v[104:107], v[168:171]
    buffer_load_dwordx4 v[32:35], v6, s[8:11], s32 offen offset:1024 sc1
    v_lshl_add_u32 v20, v21, 2, v20
    v_mfma_f32_16x16x32_bf16 v[200:203], v[76:79], v[108:111], v[200:203]
    v_xor_b32 v21, 0, v20
    v_mfma_f32_16x16x32_bf16 v[232:235], v[76:79], v[112:115], v[232:235]
    v_lshl_add_u32 v10, v21, 5, v19
    v_mfma_f32_16x16x32_bf16 v[140:143], v[80:83], v[100:103], v[140:143]
    v_xor_b32 v21, 1, v20
    v_mfma_f32_16x16x32_bf16 v[172:175], v[80:83], v[104:107], v[172:175]
    buffer_load_dwordx4 v[36:39], v7, s[8:11], s32 offen offset:1024 sc1
    v_lshl_add_u32 v11, v21, 5, v19
    v_mfma_f32_16x16x32_bf16 v[204:207], v[80:83], v[108:111], v[204:207]
    v_xor_b32 v21, 2, v20
    v_mfma_f32_16x16x32_bf16 v[236:239], v[80:83], v[112:115], v[236:239]
    v_lshl_add_u32 v12, v21, 5, v19
    v_mfma_f32_16x16x32_bf16 v[144:147], v[84:87], v[100:103], v[144:147]
    v_xor_b32 v21, 3, v20
    v_mfma_f32_16x16x32_bf16 v[176:179], v[84:87], v[104:107], v[176:179]
    buffer_load_dwordx4 v[40:43], v6, s[8:11], s32 offen offset:2048 sc1
    v_lshl_add_u32 v13, v21, 5, v19
    v_mfma_f32_16x16x32_bf16 v[208:211], v[84:87], v[108:111], v[208:211]
    v_xor_b32 v21, 4, v20
    v_mfma_f32_16x16x32_bf16 v[240:243], v[84:87], v[112:115], v[240:243]
    v_lshl_add_u32 v14, v21, 5, v19
    v_mfma_f32_16x16x32_bf16 v[148:151], v[88:91], v[100:103], v[148:151]
    v_xor_b32 v21, 5, v20
    v_mfma_f32_16x16x32_bf16 v[180:183], v[88:91], v[104:107], v[180:183]
    buffer_load_dwordx4 v[44:47], v7, s[8:11], s32 offen offset:2048 sc1
    v_lshl_add_u32 v15, v21, 5, v19
    v_mfma_f32_16x16x32_bf16 v[212:215], v[88:91], v[108:111], v[212:215]
    v_xor_b32 v21, 6, v20
    v_mfma_f32_16x16x32_bf16 v[244:247], v[88:91], v[112:115], v[244:247]
    v_lshl_add_u32 v16, v21, 5, v19
    v_mfma_f32_16x16x32_bf16 v[152:155], v[92:95], v[100:103], v[152:155]
    v_xor_b32 v21, 7, v20
    v_mfma_f32_16x16x32_bf16 v[184:187], v[92:95], v[104:107], v[184:187]
    buffer_load_dwordx4 v[48:51], v6, s[8:11], s32 offen offset:3072 sc1
    v_lshl_add_u32 v17, v21, 5, v19
    v_mfma_f32_16x16x32_bf16 v[216:219], v[92:95], v[108:111], v[216:219]
    s_lshl_b32 s45, s29, 20
    v_mfma_f32_16x16x32_bf16 v[248:251], v[92:95], v[112:115], v[248:251]
    v_mfma_f32_16x16x32_bf16 v[156:159], v[96:99], v[100:103], v[156:159]
    v_mfma_f32_16x16x32_bf16 v[188:191], v[96:99], v[104:107], v[188:191]
    buffer_load_dwordx4 v[52:55], v7, s[8:11], s32 offen offset:3072 sc1
    v_mfma_f32_16x16x32_bf16 v[220:223], v[96:99], v[108:111], v[220:223]
    v_mfma_f32_16x16x32_bf16 v[252:255], v[96:99], v[112:115], v[252:255]
L_p1_done:
    s_waitcnt vmcnt(8)
    ds_read_b64_tr_b16 v[64:65], v10 offset:0
    ds_read_b64_tr_b16 v[66:67], v10 offset:1024
    ds_read_b64_tr_b16 v[68:69], v11 offset:0
    ds_read_b64_tr_b16 v[70:71], v11 offset:1024
    ds_read_b64_tr_b16 v[72:73], v12 offset:0
    ds_read_b64_tr_b16 v[74:75], v12 offset:1024
    ds_read_b64_tr_b16 v[76:77], v13 offset:0
    ds_read_b64_tr_b16 v[78:79], v13 offset:1024
    ds_read_b64_tr_b16 v[80:81], v14 offset:0
    ds_read_b64_tr_b16 v[82:83], v14 offset:1024
    ds_read_b64_tr_b16 v[84:85], v15 offset:0
    ds_read_b64_tr_b16 v[86:87], v15 offset:1024
    s_add_u32 m0, s33, 32768
    s_add_u32 s32, s32, 4096
    v_cvt_pk_bf16_f32 v128, v128, v129
    v_cvt_pk_bf16_f32 v129, v130, v131
    v_cvt_pk_bf16_f32 v130, v132, v133
    v_cvt_pk_bf16_f32 v131, v134, v135
    v_cvt_pk_bf16_f32 v132, v136, v137
    v_cvt_pk_bf16_f32 v133, v138, v139
    buffer_load_dwordx4 v2, s[4:7], s31 offen offset:0 lds
    v_cvt_pk_bf16_f32 v134, v140, v141
    v_cvt_pk_bf16_f32 v135, v142, v143
    v_cvt_pk_bf16_f32 v136, v144, v145
    v_cvt_pk_bf16_f32 v137, v146, v147
    v_cvt_pk_bf16_f32 v138, v148, v149
    v_cvt_pk_bf16_f32 v139, v150, v151
    buffer_load_dwordx4 v3, s[4:7], s31 offen offset:1024 lds
    v_cvt_pk_bf16_f32 v140, v152, v153
    v_cvt_pk_bf16_f32 v141, v154, v155
    v_cvt_pk_bf16_f32 v142, v156, v157
    v_cvt_pk_bf16_f32 v143, v158, v159
    v_cvt_pk_bf16_f32 v144, v160, v161
    v_cvt_pk_bf16_f32 v145, v162, v163
    buffer_load_dwordx4 v4, s[4:7], s31 offen offset:2048 lds
    v_cvt_pk_bf16_f32 v146, v164, v165
    v_cvt_pk_bf16_f32 v147, v166, v167
    v_cvt_pk_bf16_f32 v148, v168, v169
    v_cvt_pk_bf16_f32 v149, v170, v171
    v_cvt_pk_bf16_f32 v150, v172, v173
    v_cvt_pk_bf16_f32 v151, v174, v175
    buffer_load_dwordx4 v5, s[4:7], s31 offen offset:3072 lds
    v_cvt_pk_bf16_f32 v152, v176, v177
    v_cvt_pk_bf16_f32 v153, v178, v179
    v_cvt_pk_bf16_f32 v154, v180, v181
    v_cvt_pk_bf16_f32 v155, v182, v183
    v_cvt_pk_bf16_f32 v156, v184, v185
    v_cvt_pk_bf16_f32 v157, v186, v187
    s_mov_b32 s31, 3145728
    s_add_u32 s34, s33, 98304
    v_cvt_pk_bf16_f32 v158, v188, v189
    v_cvt_pk_bf16_f32 v159, v190, v191
    v_cvt_pk_bf16_f32 v160, v192, v193
    v_cvt_pk_bf16_f32 v161, v194, v195
    v_cvt_pk_bf16_f32 v162, v196, v197
    v_cvt_pk_bf16_f32 v163, v198, v199
    buffer_load_dwordx4 v[96:99], v6, s[8:11], s32 offen offset:0 sc1
    v_cvt_pk_bf16_f32 v164, v200, v201
    v_cvt_pk_bf16_f32 v165, v202, v203
    v_cvt_pk_bf16_f32 v166, v204, v205
    v_cvt_pk_bf16_f32 v167, v206, v207
    v_cvt_pk_bf16_f32 v168, v208, v209
    v_cvt_pk_bf16_f32 v169, v210, v211
    buffer_load_dwordx4 v[100:103], v7, s[8:11], s32 offen offset:0 sc1
    v_cvt_pk_bf16_f32 v170, v212, v213
    v_cvt_pk_bf16_f32 v171, v214, v215
    v_cvt_pk_bf16_f32 v172, v216, v217
    v_cvt_pk_bf16_f32 v173, v218, v219
    v_cvt_pk_bf16_f32 v174, v220, v221
    v_cvt_pk_bf16_f32 v175, v222, v223
    buffer_load_dwordx4 v[104:107], v6, s[8:11], s32 offen offset:1024 sc1
    v_cvt_pk_bf16_f32 v176, v224, v225
    v_cvt_pk_bf16_f32 v177, v226, v227
    v_cvt_pk_bf16_f32 v178, v228, v229
    v_cvt_pk_bf16_f32 v179, v230, v231
    v_cvt_pk_bf16_f32 v180, v232, v233
    v_cvt_pk_bf16_f32 v181, v234, v235
    buffer_load_dwordx4 v[108:111], v7, s[8:11], s32 offen offset:1024 sc1
    v_cvt_pk_bf16_f32 v182, v236, v237
    v_cvt_pk_bf16_f32 v183, v238, v239
    v_cvt_pk_bf16_f32 v184, v240, v241
    v_cvt_pk_bf16_f32 v185, v242, v243
    v_cvt_pk_bf16_f32 v186, v244, v245
    v_cvt_pk_bf16_f32 v187, v246, v247
    buffer_load_dwordx4 v[112:115], v6, s[8:11], s32 offen offset:2048 sc1
    v_cvt_pk_bf16_f32 v188, v248, v249
    v_cvt_pk_bf16_f32 v189, v250, v251
    v_cvt_pk_bf16_f32 v190, v252, v253
    v_cvt_pk_bf16_f32 v191, v254, v255
    s_lshl_b32 s38, s29, 20
    s_lshl_b32 s37, s30, 17
    s_add_u32 s38, s38, s37
    s_bfe_u32 s37, s28, 0x10001
    s_lshl_b32 s37, s37, 16
    s_add_u32 s38, s38, s37
    s_lshr_b32 s36, s28, 2
    s_lshl_b32 s37, s36, 15
    s_add_u32 s38, s38, s37
    s_and_b32 s37, s28, 1
    s_add_u32 s36, s36, 11
    s_lshl_b32 s37, s37, s36
    s_add_u32 s38, s38, s37
    s_cmp_lt_u32 s28, 4
    s_cselect_b32 s36, 4, 32
    s_cselect_b32 s37, 16, 64
    s_cselect_b32 s39, 32, 4
    s_lshl_b32 s36, s36, 8
    s_lshl_b32 s37, s37, 8
    s_lshl_b32 s39, s39, 8
    s_mov_b64 s[16:17], s[12:13]
    s_mov_b64 s[18:19], s[14:15]
    s_cmp_eq_u32 s30, 0
    s_cselect_b32 s52, 2, 4
    v_lshlrev_b32 v58, 4, v1
    v_add_u32 v59, s36, v58
    v_add_u32 v60, s37, v58
    v_add_u32 v61, s36, v60
    v_mov_b64 v[192:193], 0
    v_mov_b64 v[194:195], 0
    v_mov_b64 v[196:197], 0
    v_mov_b64 v[198:199], 0
    v_mov_b64 v[200:201], 0
    v_mov_b64 v[202:203], 0
    v_mov_b64 v[204:205], 0
    v_mov_b64 v[206:207], 0
    v_mov_b64 v[208:209], 0
    v_mov_b64 v[210:211], 0
    v_mov_b64 v[212:213], 0
    v_mov_b64 v[214:215], 0
    v_mov_b64 v[216:217], 0
    v_mov_b64 v[218:219], 0
    v_mov_b64 v[220:221], 0
    v_mov_b64 v[222:223], 0
    v_mov_b64 v[224:225], 0
    v_mov_b64 v[226:227], 0
    v_mov_b64 v[228:229], 0
    v_mov_b64 v[230:231], 0
    v_mov_b64 v[232:233], 0
    v_mov_b64 v[234:235], 0
    v_mov_b64 v[236:237], 0
    v_mov_b64 v[238:239], 0
    v_mov_b64 v[240:241], 0
    v_mov_b64 v[242:243], 0
    v_mov_b64 v[244:245], 0
    v_mov_b64 v[246:247], 0
    v_mov_b64 v[248:249], 0
    v_mov_b64 v[250:251], 0
    v_mov_b64 v[252:253], 0
    v_mov_b64 v[254:255], 0
    buffer_load_dwordx4 v[116:119], v7, s[8:11], s32 offen offset:2048 sc1
    s_mov_b32 s35, 0
    s_mov_b32 s41, 0x1ffff
    s_waitcnt vmcnt(10)
    s_cmp_eq_u32 s30, 0
    s_cbranch_scc1 L_recurrent_scan__compressed_kv_cla__moe_arch_mod__prompt_kernel_rare_55
L_recurrent_scan__compressed_kv_cla__moe_arch_mod__prompt_kernel_back_56:
    .p2align 6
L_p2_loop:
    s_cmp_eq_u32 s35, 3
    s_cbranch_scc1 L_recurrent_scan__compressed_kv_cla__moe_arch_mod__prompt_kernel_rare_47
L_recurrent_scan__compressed_kv_cla__moe_arch_mod__prompt_kernel_back_48:
    s_waitcnt lgkmcnt(8)
    s_waitcnt vmcnt(22)
    v_mfma_f32_16x16x32_bf16 v[192:195], v[64:67], v[24:27], v[192:195]
    ds_read_b64_tr_b16 v[88:89], v16 offset:0
    v_mfma_f32_16x16x32_bf16 v[224:227], v[64:67], v[28:31], v[224:227]
    ds_read_b64_tr_b16 v[90:91], v16 offset:1024
    v_mfma_f32_16x16x32_bf16 v[196:199], v[68:71], v[24:27], v[196:199]
    ds_read_b64_tr_b16 v[92:93], v17 offset:0
    buffer_load_dwordx4 v[120:123], v6, s[8:11], s32 offen offset:3072 sc1
    v_mfma_f32_16x16x32_bf16 v[228:231], v[68:71], v[28:31], v[228:231]
    ds_read_b64_tr_b16 v[94:95], v17 offset:1024
    s_waitcnt lgkmcnt(8)
    v_mfma_f32_16x16x32_bf16 v[200:203], v[72:75], v[24:27], v[200:203]
    ds_read_b64_tr_b16 v[64:65], v10 offset:8192
    v_mfma_f32_16x16x32_bf16 v[232:235], v[72:75], v[28:31], v[232:235]
    ds_read_b64_tr_b16 v[66:67], v10 offset:9216
    v_mfma_f32_16x16x32_bf16 v[204:207], v[76:79], v[24:27], v[204:207]
    ds_read_b64_tr_b16 v[68:69], v11 offset:8192
    buffer_load_dwordx4 v[124:127], v7, s[8:11], s32 offen offset:3072 sc1
    v_mfma_f32_16x16x32_bf16 v[236:239], v[76:79], v[28:31], v[236:239]
    ds_read_b64_tr_b16 v[70:71], v11 offset:9216
    s_add_u32 s32, s32, 4096
    s_cmp_lt_u32 s35, s52
    s_cselect_b32 s18, s18, 0
    s_waitcnt lgkmcnt(8)
    v_mfma_f32_16x16x32_bf16 v[208:211], v[80:83], v[24:27], v[208:211]
    ds_read_b64_tr_b16 v[72:73], v12 offset:8192
    s_cmp_lt_u32 s35, 3
    s_cselect_b32 s10, s10, 0
    v_mfma_f32_16x16x32_bf16 v[240:243], v[80:83], v[28:31], v[240:243]
    ds_read_b64_tr_b16 v[74:75], v12 offset:9216
    v_mfma_f32_16x16x32_bf16 v[212:215], v[84:87], v[24:27], v[212:215]
    ds_read_b64_tr_b16 v[76:77], v13 offset:8192
    buffer_store_dwordx4 v[128:131], v58, s[16:19], s38 offen sc1
    v_mfma_f32_16x16x32_bf16 v[244:247], v[84:87], v[28:31], v[244:247]
    ds_read_b64_tr_b16 v[78:79], v13 offset:9216
    s_mov_b32 m0, s34
    s_waitcnt lgkmcnt(8)
    v_mfma_f32_16x16x32_bf16 v[216:219], v[88:91], v[24:27], v[216:219]
    ds_read_b64_tr_b16 v[80:81], v14 offset:8192
    v_mov_b64 v[128:129], v[144:145]
    buffer_load_dwordx4 v2, s[4:7], s31 offen offset:0 sc1 lds
    v_mfma_f32_16x16x32_bf16 v[248:251], v[88:91], v[28:31], v[248:251]
    ds_read_b64_tr_b16 v[82:83], v14 offset:9216
    v_mfma_f32_16x16x32_bf16 v[220:223], v[92:95], v[24:27], v[220:223]
    ds_read_b64_tr_b16 v[84:85], v15 offset:8192
    v_mov_b64 v[130:131], v[146:147]
    v_mfma_f32_16x16x32_bf16 v[252:255], v[92:95], v[28:31], v[252:255]
    ds_read_b64_tr_b16 v[86:87], v15 offset:9216
    s_waitcnt lgkmcnt(8)
    s_waitcnt vmcnt(22)
    v_mfma_f32_16x16x32_bf16 v[192:195], v[64:67], v[32:35], v[192:195]
    ds_read_b64_tr_b16 v[88:89], v16 offset:8192
    v_mov_b64 v[144:145], v[160:161]
    v_mfma_f32_16x16x32_bf16 v[224:227], v[64:67], v[36:39], v[224:227]
    ds_read_b64_tr_b16 v[90:91], v16 offset:9216
    v_mfma_f32_16x16x32_bf16 v[196:199], v[68:71], v[32:35], v[196:199]
    ds_read_b64_tr_b16 v[92:93], v17 offset:8192
    buffer_load_dwordx4 v[24:27], v6, s[8:11], s32 offen offset:0 sc1
    v_mov_b64 v[146:147], v[162:163]
    v_mfma_f32_16x16x32_bf16 v[228:231], v[68:71], v[36:39], v[228:231]
    ds_read_b64_tr_b16 v[94:95], v17 offset:9216
    s_waitcnt lgkmcnt(8)
    v_mfma_f32_16x16x32_bf16 v[200:203], v[72:75], v[32:35], v[200:203]
    ds_read_b64_tr_b16 v[64:65], v10 offset:16384
    v_mov_b64 v[160:161], v[176:177]
    v_mfma_f32_16x16x32_bf16 v[232:235], v[72:75], v[36:39], v[232:235]
    ds_read_b64_tr_b16 v[66:67], v10 offset:17408
    v_mfma_f32_16x16x32_bf16 v[204:207], v[76:79], v[32:35], v[204:207]
    ds_read_b64_tr_b16 v[68:69], v11 offset:16384
    buffer_load_dwordx4 v[28:31], v7, s[8:11], s32 offen offset:0 sc1
    v_mov_b64 v[162:163], v[178:179]
    v_mfma_f32_16x16x32_bf16 v[236:239], v[76:79], v[36:39], v[236:239]
    ds_read_b64_tr_b16 v[70:71], v11 offset:17408
    s_waitcnt lgkmcnt(8)
    v_mfma_f32_16x16x32_bf16 v[208:211], v[80:83], v[32:35], v[208:211]
    ds_read_b64_tr_b16 v[72:73], v12 offset:16384
    v_mfma_f32_16x16x32_bf16 v[240:243], v[80:83], v[36:39], v[240:243]
    ds_read_b64_tr_b16 v[74:75], v12 offset:17408
    v_mfma_f32_16x16x32_bf16 v[212:215], v[84:87], v[32:35], v[212:215]
    ds_read_b64_tr_b16 v[76:77], v13 offset:16384
    v_mfma_f32_16x16x32_bf16 v[244:247], v[84:87], v[36:39], v[244:247]
    ds_read_b64_tr_b16 v[78:79], v13 offset:17408
    s_waitcnt lgkmcnt(8)
    v_mfma_f32_16x16x32_bf16 v[216:219], v[88:91], v[32:35], v[216:219]
    ds_read_b64_tr_b16 v[80:81], v14 offset:16384
    buffer_load_dwordx4 v3, s[4:7], s31 offen offset:1024 sc1 lds
    v_mfma_f32_16x16x32_bf16 v[248:251], v[88:91], v[36:39], v[248:251]
    ds_read_b64_tr_b16 v[82:83], v14 offset:17408
    v_mfma_f32_16x16x32_bf16 v[220:223], v[92:95], v[32:35], v[220:223]
    ds_read_b64_tr_b16 v[84:85], v15 offset:16384
    buffer_store_dwordx4 v[132:135], v59, s[16:19], s38 offen sc1
    v_mfma_f32_16x16x32_bf16 v[252:255], v[92:95], v[36:39], v[252:255]
    ds_read_b64_tr_b16 v[86:87], v15 offset:17408
    s_waitcnt lgkmcnt(8)
    s_waitcnt vmcnt(23)
    v_mfma_f32_16x16x32_bf16 v[192:195], v[64:67], v[40:43], v[192:195]
    ds_read_b64_tr_b16 v[88:89], v16 offset:16384
    v_mov_b64 v[132:133], v[148:149]
    v_mfma_f32_16x16x32_bf16 v[224:227], v[64:67], v[44:47], v[224:227]
    ds_read_b64_tr_b16 v[90:91], v16 offset:17408
    v_mfma_f32_16x16x32_bf16 v[196:199], v[68:71], v[40:43], v[196:199]
    ds_read_b64_tr_b16 v[92:93], v17 offset:16384
    buffer_load_dwordx4 v[32:35], v6, s[8:11], s32 offen offset:1024 sc1
    v_mov_b64 v[134:135], v[150:151]
    v_mfma_f32_16x16x32_bf16 v[228:231], v[68:71], v[44:47], v[228:231]
    ds_read_b64_tr_b16 v[94:95], v17 offset:17408
    s_waitcnt lgkmcnt(8)
    v_mfma_f32_16x16x32_bf16 v[200:203], v[72:75], v[40:43], v[200:203]
    ds_read_b64_tr_b16 v[64:65], v10 offset:24576
    v_mov_b64 v[148:149], v[164:165]
    v_mfma_f32_16x16x32_bf16 v[232:235], v[72:75], v[44:47], v[232:235]
    ds_read_b64_tr_b16 v[66:67], v10 offset:25600
    v_mfma_f32_16x16x32_bf16 v[204:207], v[76:79], v[40:43], v[204:207]
    ds_read_b64_tr_b16 v[68:69], v11 offset:24576
    buffer_load_dwordx4 v[36:39], v7, s[8:11], s32 offen offset:1024 sc1
    v_mov_b64 v[150:151], v[166:167]
    v_mfma_f32_16x16x32_bf16 v[236:239], v[76:79], v[44:47], v[236:239]
    ds_read_b64_tr_b16 v[70:71], v11 offset:25600
    s_waitcnt lgkmcnt(8)
    v_mfma_f32_16x16x32_bf16 v[208:211], v[80:83], v[40:43], v[208:211]
    ds_read_b64_tr_b16 v[72:73], v12 offset:24576
    v_mov_b64 v[164:165], v[180:181]
    v_mfma_f32_16x16x32_bf16 v[240:243], v[80:83], v[44:47], v[240:243]
    ds_read_b64_tr_b16 v[74:75], v12 offset:25600
    v_mfma_f32_16x16x32_bf16 v[212:215], v[84:87], v[40:43], v[212:215]
    ds_read_b64_tr_b16 v[76:77], v13 offset:24576
    v_mov_b64 v[166:167], v[182:183]
    v_mfma_f32_16x16x32_bf16 v[244:247], v[84:87], v[44:47], v[244:247]
    ds_read_b64_tr_b16 v[78:79], v13 offset:25600
    s_waitcnt lgkmcnt(8)
    v_mfma_f32_16x16x32_bf16 v[216:219], v[88:91], v[40:43], v[216:219]
    ds_read_b64_tr_b16 v[80:81], v14 offset:24576
    buffer_load_dwordx4 v4, s[4:7], s31 offen offset:2048 sc1 lds
    v_mfma_f32_16x16x32_bf16 v[248:251], v[88:91], v[44:47], v[248:251]
    ds_read_b64_tr_b16 v[82:83], v14 offset:25600
    v_mfma_f32_16x16x32_bf16 v[220:223], v[92:95], v[40:43], v[220:223]
    ds_read_b64_tr_b16 v[84:85], v15 offset:24576
    v_mfma_f32_16x16x32_bf16 v[252:255], v[92:95], v[44:47], v[252:255]
    ds_read_b64_tr_b16 v[86:87], v15 offset:25600
    s_waitcnt lgkmcnt(8)
    s_waitcnt vmcnt(23)
    v_mfma_f32_16x16x32_bf16 v[192:195], v[64:67], v[48:51], v[192:195]
    ds_read_b64_tr_b16 v[88:89], v16 offset:24576
    v_mfma_f32_16x16x32_bf16 v[224:227], v[64:67], v[52:55], v[224:227]
    ds_read_b64_tr_b16 v[90:91], v16 offset:25600
    v_mfma_f32_16x16x32_bf16 v[196:199], v[68:71], v[48:51], v[196:199]
    ds_read_b64_tr_b16 v[92:93], v17 offset:24576
    buffer_load_dwordx4 v[40:43], v6, s[8:11], s32 offen offset:2048 sc1
    v_mfma_f32_16x16x32_bf16 v[228:231], v[68:71], v[52:55], v[228:231]
    ds_read_b64_tr_b16 v[94:95], v17 offset:25600
    s_waitcnt lgkmcnt(8)
    v_mfma_f32_16x16x32_bf16 v[200:203], v[72:75], v[48:51], v[200:203]
    v_mfma_f32_16x16x32_bf16 v[232:235], v[72:75], v[52:55], v[232:235]
    v_mfma_f32_16x16x32_bf16 v[204:207], v[76:79], v[48:51], v[204:207]
    buffer_load_dwordx4 v[44:47], v7, s[8:11], s32 offen offset:2048 sc1
    v_mfma_f32_16x16x32_bf16 v[236:239], v[76:79], v[52:55], v[236:239]
    s_cmp_eq_u32 s35, 3
    s_cbranch_scc1 L_recurrent_scan__compressed_kv_cla__moe_arch_mod__prompt_kernel_rare_45
L_recurrent_scan__compressed_kv_cla__moe_arch_mod__prompt_kernel_back_46:
    s_waitcnt lgkmcnt(0)
    s_waitcnt vmcnt(19)
    s_cmp_eq_u32 s35, s52
    s_cbranch_scc1 L_recurrent_scan__compressed_kv_cla__moe_arch_mod__prompt_kernel_rare_53
L_recurrent_scan__compressed_kv_cla__moe_arch_mod__prompt_kernel_back_54:
    s_barrier
    v_mfma_f32_16x16x32_bf16 v[208:211], v[80:83], v[48:51], v[208:211]
    ds_read_b64_tr_b16 v[64:65], v10 offset:32768
    ds_read_b64_tr_b16 v[66:67], v10 offset:33792
    v_mfma_f32_16x16x32_bf16 v[240:243], v[80:83], v[52:55], v[240:243]
    ds_read_b64_tr_b16 v[68:69], v11 offset:32768
    ds_read_b64_tr_b16 v[70:71], v11 offset:33792
    v_mfma_f32_16x16x32_bf16 v[212:215], v[84:87], v[48:51], v[212:215]
    ds_read_b64_tr_b16 v[72:73], v12 offset:32768
    ds_read_b64_tr_b16 v[74:75], v12 offset:33792
    v_mfma_f32_16x16x32_bf16 v[244:247], v[84:87], v[52:55], v[244:247]
    ds_read_b64_tr_b16 v[76:77], v13 offset:32768
    ds_read_b64_tr_b16 v[78:79], v13 offset:33792
    v_mfma_f32_16x16x32_bf16 v[216:219], v[88:91], v[48:51], v[216:219]
    ds_read_b64_tr_b16 v[80:81], v14 offset:32768
    ds_read_b64_tr_b16 v[82:83], v14 offset:33792
    buffer_load_dwordx4 v5, s[4:7], s31 offen offset:3072 sc1 lds
    v_mfma_f32_16x16x32_bf16 v[248:251], v[88:91], v[52:55], v[248:251]
    s_add_u32 s31, s31, s40
    s_add_u32 s34, s34, 32768
    s_and_b32 s34, s34, s41
    v_mfma_f32_16x16x32_bf16 v[220:223], v[92:95], v[48:51], v[220:223]
    ds_read_b64_tr_b16 v[84:85], v15 offset:32768
    ds_read_b64_tr_b16 v[86:87], v15 offset:33792
    v_mfma_f32_16x16x32_bf16 v[252:255], v[92:95], v[52:55], v[252:255]
    s_cmp_ge_u32 s35, 2
    s_cbranch_scc1 L_recurrent_scan__compressed_kv_cla__moe_arch_mod__prompt_kernel_rare_51
L_recurrent_scan__compressed_kv_cla__moe_arch_mod__prompt_kernel_back_52:
    s_waitcnt lgkmcnt(8)
    s_waitcnt vmcnt(18)
    v_mfma_f32_16x16x32_bf16 v[192:195], v[64:67], v[96:99], v[192:195]
    ds_read_b64_tr_b16 v[88:89], v16 offset:32768
    v_mfma_f32_16x16x32_bf16 v[224:227], v[64:67], v[100:103], v[224:227]
    ds_read_b64_tr_b16 v[90:91], v16 offset:33792
    v_mfma_f32_16x16x32_bf16 v[196:199], v[68:71], v[96:99], v[196:199]
    ds_read_b64_tr_b16 v[92:93], v17 offset:32768
    buffer_load_dwordx4 v[48:51], v6, s[8:11], s32 offen offset:3072 sc1
    v_mfma_f32_16x16x32_bf16 v[228:231], v[68:71], v[100:103], v[228:231]
    ds_read_b64_tr_b16 v[94:95], v17 offset:33792
    s_waitcnt lgkmcnt(8)
    v_mfma_f32_16x16x32_bf16 v[200:203], v[72:75], v[96:99], v[200:203]
    ds_read_b64_tr_b16 v[64:65], v10 offset:40960
    v_mfma_f32_16x16x32_bf16 v[232:235], v[72:75], v[100:103], v[232:235]
    ds_read_b64_tr_b16 v[66:67], v10 offset:41984
    v_mfma_f32_16x16x32_bf16 v[204:207], v[76:79], v[96:99], v[204:207]
    ds_read_b64_tr_b16 v[68:69], v11 offset:40960
    buffer_load_dwordx4 v[52:55], v7, s[8:11], s32 offen offset:3072 sc1
    v_mfma_f32_16x16x32_bf16 v[236:239], v[76:79], v[100:103], v[236:239]
    ds_read_b64_tr_b16 v[70:71], v11 offset:41984
    s_add_u32 s32, s32, 4096
    s_waitcnt lgkmcnt(8)
    v_mfma_f32_16x16x32_bf16 v[208:211], v[80:83], v[96:99], v[208:211]
    ds_read_b64_tr_b16 v[72:73], v12 offset:40960
    v_mfma_f32_16x16x32_bf16 v[240:243], v[80:83], v[100:103], v[240:243]
    ds_read_b64_tr_b16 v[74:75], v12 offset:41984
    v_mfma_f32_16x16x32_bf16 v[212:215], v[84:87], v[96:99], v[212:215]
    ds_read_b64_tr_b16 v[76:77], v13 offset:40960
    buffer_store_dwordx4 v[136:139], v60, s[16:19], s38 offen sc1
    v_mfma_f32_16x16x32_bf16 v[244:247], v[84:87], v[100:103], v[244:247]
    ds_read_b64_tr_b16 v[78:79], v13 offset:41984
    s_mov_b32 m0, s34
    s_waitcnt lgkmcnt(8)
    v_mfma_f32_16x16x32_bf16 v[216:219], v[88:91], v[96:99], v[216:219]
    ds_read_b64_tr_b16 v[80:81], v14 offset:40960
    v_mov_b64 v[136:137], v[152:153]
    buffer_load_dwordx4 v2, s[4:7], s31 offen offset:0 sc1 lds
    v_mfma_f32_16x16x32_bf16 v[248:251], v[88:91], v[100:103], v[248:251]
    ds_read_b64_tr_b16 v[82:83], v14 offset:41984
    v_mfma_f32_16x16x32_bf16 v[220:223], v[92:95], v[96:99], v[220:223]
    ds_read_b64_tr_b16 v[84:85], v15 offset:40960
    v_mov_b64 v[138:139], v[154:155]
    v_mfma_f32_16x16x32_bf16 v[252:255], v[92:95], v[100:103], v[252:255]
    ds_read_b64_tr_b16 v[86:87], v15 offset:41984
    s_waitcnt lgkmcnt(8)
    s_waitcnt vmcnt(20)
    v_mfma_f32_16x16x32_bf16 v[192:195], v[64:67], v[104:107], v[192:195]
    ds_read_b64_tr_b16 v[88:89], v16 offset:40960
    v_mov_b64 v[152:153], v[168:169]
    v_mfma_f32_16x16x32_bf16 v[224:227], v[64:67], v[108:111], v[224:227]
    ds_read_b64_tr_b16 v[90:91], v16 offset:41984
    v_mfma_f32_16x16x32_bf16 v[196:199], v[68:71], v[104:107], v[196:199]
    ds_read_b64_tr_b16 v[92:93], v17 offset:40960
    buffer_load_dwordx4 v[96:99], v6, s[8:11], s32 offen offset:0 sc1
    v_mov_b64 v[154:155], v[170:171]
    v_mfma_f32_16x16x32_bf16 v[228:231], v[68:71], v[108:111], v[228:231]
    ds_read_b64_tr_b16 v[94:95], v17 offset:41984
    s_waitcnt lgkmcnt(8)
    v_mfma_f32_16x16x32_bf16 v[200:203], v[72:75], v[104:107], v[200:203]
    ds_read_b64_tr_b16 v[64:65], v10 offset:49152
    v_mov_b64 v[168:169], v[184:185]
    v_mfma_f32_16x16x32_bf16 v[232:235], v[72:75], v[108:111], v[232:235]
    ds_read_b64_tr_b16 v[66:67], v10 offset:50176
    v_mfma_f32_16x16x32_bf16 v[204:207], v[76:79], v[104:107], v[204:207]
    ds_read_b64_tr_b16 v[68:69], v11 offset:49152
    buffer_load_dwordx4 v[100:103], v7, s[8:11], s32 offen offset:0 sc1
    v_mov_b64 v[170:171], v[186:187]
    v_mfma_f32_16x16x32_bf16 v[236:239], v[76:79], v[108:111], v[236:239]
    ds_read_b64_tr_b16 v[70:71], v11 offset:50176
    s_waitcnt lgkmcnt(8)
    v_mfma_f32_16x16x32_bf16 v[208:211], v[80:83], v[104:107], v[208:211]
    ds_read_b64_tr_b16 v[72:73], v12 offset:49152
    v_mfma_f32_16x16x32_bf16 v[240:243], v[80:83], v[108:111], v[240:243]
    ds_read_b64_tr_b16 v[74:75], v12 offset:50176
    v_mfma_f32_16x16x32_bf16 v[212:215], v[84:87], v[104:107], v[212:215]
    ds_read_b64_tr_b16 v[76:77], v13 offset:49152
    v_mfma_f32_16x16x32_bf16 v[244:247], v[84:87], v[108:111], v[244:247]
    ds_read_b64_tr_b16 v[78:79], v13 offset:50176
    s_waitcnt lgkmcnt(8)
    v_mfma_f32_16x16x32_bf16 v[216:219], v[88:91], v[104:107], v[216:219]
    ds_read_b64_tr_b16 v[80:81], v14 offset:49152
    buffer_load_dwordx4 v3, s[4:7], s31 offen offset:1024 sc1 lds
    v_mfma_f32_16x16x32_bf16 v[248:251], v[88:91], v[108:111], v[248:251]
    ds_read_b64_tr_b16 v[82:83], v14 offset:50176
    v_mfma_f32_16x16x32_bf16 v[220:223], v[92:95], v[104:107], v[220:223]
    ds_read_b64_tr_b16 v[84:85], v15 offset:49152
    buffer_store_dwordx4 v[140:143], v61, s[16:19], s38 offen sc1
    v_mfma_f32_16x16x32_bf16 v[252:255], v[92:95], v[108:111], v[252:255]
    ds_read_b64_tr_b16 v[86:87], v15 offset:50176
    s_add_u32 s38, s38, s39
    s_waitcnt lgkmcnt(8)
    s_waitcnt vmcnt(22)
    v_mfma_f32_16x16x32_bf16 v[192:195], v[64:67], v[112:115], v[192:195]
    ds_read_b64_tr_b16 v[88:89], v16 offset:49152
    v_mov_b64 v[140:141], v[156:157]
    v_mfma_f32_16x16x32_bf16 v[224:227], v[64:67], v[116:119], v[224:227]
    ds_read_b64_tr_b16 v[90:91], v16 offset:50176
    v_mfma_f32_16x16x32_bf16 v[196:199], v[68:71], v[112:115], v[196:199]
    ds_read_b64_tr_b16 v[92:93], v17 offset:49152
    buffer_load_dwordx4 v[104:107], v6, s[8:11], s32 offen offset:1024 sc1
    v_mov_b64 v[142:143], v[158:159]
    v_mfma_f32_16x16x32_bf16 v[228:231], v[68:71], v[116:119], v[228:231]
    ds_read_b64_tr_b16 v[94:95], v17 offset:50176
    s_waitcnt lgkmcnt(8)
    v_mfma_f32_16x16x32_bf16 v[200:203], v[72:75], v[112:115], v[200:203]
    ds_read_b64_tr_b16 v[64:65], v10 offset:57344
    v_mov_b64 v[156:157], v[172:173]
    v_mfma_f32_16x16x32_bf16 v[232:235], v[72:75], v[116:119], v[232:235]
    ds_read_b64_tr_b16 v[66:67], v10 offset:58368
    v_xor_b32 v10, 65536, v10
    v_mfma_f32_16x16x32_bf16 v[204:207], v[76:79], v[112:115], v[204:207]
    ds_read_b64_tr_b16 v[68:69], v11 offset:57344
    buffer_load_dwordx4 v[108:111], v7, s[8:11], s32 offen offset:1024 sc1
    v_mov_b64 v[158:159], v[174:175]
    v_mfma_f32_16x16x32_bf16 v[236:239], v[76:79], v[116:119], v[236:239]
    ds_read_b64_tr_b16 v[70:71], v11 offset:58368
    v_xor_b32 v11, 65536, v11
    s_waitcnt lgkmcnt(8)
    v_mfma_f32_16x16x32_bf16 v[208:211], v[80:83], v[112:115], v[208:211]
    ds_read_b64_tr_b16 v[72:73], v12 offset:57344
    v_mov_b64 v[172:173], v[188:189]
    v_mfma_f32_16x16x32_bf16 v[240:243], v[80:83], v[116:119], v[240:243]
    ds_read_b64_tr_b16 v[74:75], v12 offset:58368
    v_xor_b32 v12, 65536, v12
    v_mfma_f32_16x16x32_bf16 v[212:215], v[84:87], v[112:115], v[212:215]
    ds_read_b64_tr_b16 v[76:77], v13 offset:57344
    v_mov_b64 v[174:175], v[190:191]
    v_mfma_f32_16x16x32_bf16 v[244:247], v[84:87], v[116:119], v[244:247]
    ds_read_b64_tr_b16 v[78:79], v13 offset:58368
    v_xor_b32 v13, 65536, v13
    s_waitcnt lgkmcnt(8)
    v_mfma_f32_16x16x32_bf16 v[216:219], v[88:91], v[112:115], v[216:219]
    ds_read_b64_tr_b16 v[80:81], v14 offset:57344
    buffer_load_dwordx4 v4, s[4:7], s31 offen offset:2048 sc1 lds
    v_mfma_f32_16x16x32_bf16 v[248:251], v[88:91], v[116:119], v[248:251]
    ds_read_b64_tr_b16 v[82:83], v14 offset:58368
    v_xor_b32 v14, 65536, v14
    v_mfma_f32_16x16x32_bf16 v[220:223], v[92:95], v[112:115], v[220:223]
    ds_read_b64_tr_b16 v[84:85], v15 offset:57344
    v_mfma_f32_16x16x32_bf16 v[252:255], v[92:95], v[116:119], v[252:255]
    ds_read_b64_tr_b16 v[86:87], v15 offset:58368
    v_xor_b32 v15, 65536, v15
    s_waitcnt lgkmcnt(8)
    s_waitcnt vmcnt(23)
    v_mfma_f32_16x16x32_bf16 v[192:195], v[64:67], v[120:123], v[192:195]
    ds_read_b64_tr_b16 v[88:89], v16 offset:57344
    v_mfma_f32_16x16x32_bf16 v[224:227], v[64:67], v[124:127], v[224:227]
    ds_read_b64_tr_b16 v[90:91], v16 offset:58368
    v_xor_b32 v16, 65536, v16
    v_mfma_f32_16x16x32_bf16 v[196:199], v[68:71], v[120:123], v[196:199]
    ds_read_b64_tr_b16 v[92:93], v17 offset:57344
    buffer_load_dwordx4 v[112:115], v6, s[8:11], s32 offen offset:2048 sc1
    v_mfma_f32_16x16x32_bf16 v[228:231], v[68:71], v[124:127], v[228:231]
    ds_read_b64_tr_b16 v[94:95], v17 offset:58368
    v_xor_b32 v17, 65536, v17
    s_waitcnt lgkmcnt(8)
    v_mfma_f32_16x16x32_bf16 v[200:203], v[72:75], v[120:123], v[200:203]
    v_mfma_f32_16x16x32_bf16 v[232:235], v[72:75], v[124:127], v[232:235]
    v_mfma_f32_16x16x32_bf16 v[204:207], v[76:79], v[120:123], v[204:207]
    buffer_load_dwordx4 v[116:119], v7, s[8:11], s32 offen offset:2048 sc1
    v_mfma_f32_16x16x32_bf16 v[236:239], v[76:79], v[124:127], v[236:239]
    s_waitcnt lgkmcnt(0)
    s_barrier
    v_mfma_f32_16x16x32_bf16 v[208:211], v[80:83], v[120:123], v[208:211]
    ds_read_b64_tr_b16 v[64:65], v10 offset:0
    ds_read_b64_tr_b16 v[66:67], v10 offset:1024
    v_mfma_f32_16x16x32_bf16 v[240:243], v[80:83], v[124:127], v[240:243]
    ds_read_b64_tr_b16 v[68:69], v11 offset:0
    ds_read_b64_tr_b16 v[70:71], v11 offset:1024
    v_mfma_f32_16x16x32_bf16 v[212:215], v[84:87], v[120:123], v[212:215]
    ds_read_b64_tr_b16 v[72:73], v12 offset:0
    ds_read_b64_tr_b16 v[74:75], v12 offset:1024
    v_mfma_f32_16x16x32_bf16 v[244:247], v[84:87], v[124:127], v[244:247]
    ds_read_b64_tr_b16 v[76:77], v13 offset:0
    ds_read_b64_tr_b16 v[78:79], v13 offset:1024
    v_mfma_f32_16x16x32_bf16 v[216:219], v[88:91], v[120:123], v[216:219]
    ds_read_b64_tr_b16 v[80:81], v14 offset:0
    ds_read_b64_tr_b16 v[82:83], v14 offset:1024
    buffer_load_dwordx4 v5, s[4:7], s31 offen offset:3072 sc1 lds
    v_mfma_f32_16x16x32_bf16 v[248:251], v[88:91], v[124:127], v[248:251]
    s_add_u32 s31, s31, s40
    s_add_u32 s34, s34, 32768
    s_and_b32 s34, s34, s41
    v_mfma_f32_16x16x32_bf16 v[220:223], v[92:95], v[120:123], v[220:223]
    ds_read_b64_tr_b16 v[84:85], v15 offset:0
    ds_read_b64_tr_b16 v[86:87], v15 offset:1024
    v_mfma_f32_16x16x32_bf16 v[252:255], v[92:95], v[124:127], v[252:255]
    s_add_u32 s35, s35, 1
    s_cmp_lt_u32 s35, 4
    s_cbranch_scc1 L_p2_loop
    s_add_u32 m0, s33, 65536
    s_nop 0
    buffer_load_dwordx4 v2, s[4:7], s31 offen offset:0 sc1 lds
    buffer_load_dwordx4 v2, s[4:7], s31 offen offset:1024 sc1 lds
    buffer_load_dwordx4 v2, s[4:7], s31 offen offset:2048 sc1 lds
    buffer_load_dwordx4 v2, s[4:7], s31 offen offset:3072 sc1 lds
    s_load_dwordx2 s[32:33], s[0:1], 40
    s_load_dwordx2 s[34:35], s[0:1], 80
    s_load_dwordx2 s[96:97], s[0:1], 0
    s_load_dwordx2 s[98:99], s[0:1], 88
    s_cmp_lt_u32 s28, 4
    s_cbranch_scc0 L_grp1
    v_mov_b32 v20, 1040356334
    v_mov_b32 v21, v20
    s_and_b32 s37, s28, 3
    s_lshl_b32 s37, s37, 13
    v_lshlrev_b32 v7, 4, v1
    v_add_u32 v4, s37, v7
    v_add_u32 v19, 131072, v4
    v_add_u32 v6, 4096, v4
    s_add_u32 s43, s37, 32768
    s_add_u32 s44, s37, 98304
    s_waitcnt vmcnt(4) lgkmcnt(0)
    v_pk_mul_f32 v[192:193], v[192:193], v[20:21]
    v_pk_mul_f32 v[194:195], v[194:195], v[20:21]
    v_pk_mul_f32 v[196:197], v[196:197], v[20:21]
    v_pk_mul_f32 v[198:199], v[198:199], v[20:21]
    v_cvt_pk_bf16_f32 v128, v192, v193
    v_cvt_pk_bf16_f32 v129, v194, v195
    v_cvt_pk_bf16_f32 v130, v196, v197
    v_cvt_pk_bf16_f32 v131, v198, v199
    ds_write_b128 v19, v[128:131] offset:0
    v_pk_mul_f32 v[200:201], v[200:201], v[20:21]
    v_pk_mul_f32 v[202:203], v[202:203], v[20:21]
    v_pk_mul_f32 v[204:205], v[204:205], v[20:21]
    v_pk_mul_f32 v[206:207], v[206:207], v[20:21]
    v_cvt_pk_bf16_f32 v132, v200, v201
    v_cvt_pk_bf16_f32 v133, v202, v203
    v_cvt_pk_bf16_f32 v134, v204, v205
    v_cvt_pk_bf16_f32 v135, v206, v207
    ds_write_b128 v19, v[132:135] offset:1024
    v_pk_mul_f32 v[208:209], v[208:209], v[20:21]
    v_pk_mul_f32 v[210:211], v[210:211], v[20:21]
    v_pk_mul_f32 v[212:213], v[212:213], v[20:21]
    v_pk_mul_f32 v[214:215], v[214:215], v[20:21]
    v_cvt_pk_bf16_f32 v136, v208, v209
    v_cvt_pk_bf16_f32 v137, v210, v211
    v_cvt_pk_bf16_f32 v138, v212, v213
    v_cvt_pk_bf16_f32 v139, v214, v215
    ds_write_b128 v19, v[136:139] offset:2048
    v_pk_mul_f32 v[216:217], v[216:217], v[20:21]
    v_pk_mul_f32 v[218:219], v[218:219], v[20:21]
    v_pk_mul_f32 v[220:221], v[220:221], v[20:21]
    v_pk_mul_f32 v[222:223], v[222:223], v[20:21]
    v_cvt_pk_bf16_f32 v140, v216, v217
    v_cvt_pk_bf16_f32 v141, v218, v219
    v_cvt_pk_bf16_f32 v142, v220, v221
    v_cvt_pk_bf16_f32 v143, v222, v223
    ds_write_b128 v19, v[140:143] offset:3072
    v_pk_mul_f32 v[224:225], v[224:225], v[20:21]
    v_pk_mul_f32 v[226:227], v[226:227], v[20:21]
    v_pk_mul_f32 v[228:229], v[228:229], v[20:21]
    v_pk_mul_f32 v[230:231], v[230:231], v[20:21]
    v_cvt_pk_bf16_f32 v144, v224, v225
    v_cvt_pk_bf16_f32 v145, v226, v227
    v_cvt_pk_bf16_f32 v146, v228, v229
    v_cvt_pk_bf16_f32 v147, v230, v231
    ds_write_b128 v19, v[144:147] offset:4096
    v_pk_mul_f32 v[232:233], v[232:233], v[20:21]
    v_pk_mul_f32 v[234:235], v[234:235], v[20:21]
    v_pk_mul_f32 v[236:237], v[236:237], v[20:21]
    v_pk_mul_f32 v[238:239], v[238:239], v[20:21]
    v_cvt_pk_bf16_f32 v148, v232, v233
    v_cvt_pk_bf16_f32 v149, v234, v235
    v_cvt_pk_bf16_f32 v150, v236, v237
    v_cvt_pk_bf16_f32 v151, v238, v239
    ds_write_b128 v19, v[148:151] offset:5120
    v_pk_mul_f32 v[240:241], v[240:241], v[20:21]
    v_pk_mul_f32 v[242:243], v[242:243], v[20:21]
    v_pk_mul_f32 v[244:245], v[244:245], v[20:21]
    v_pk_mul_f32 v[246:247], v[246:247], v[20:21]
    v_cvt_pk_bf16_f32 v152, v240, v241
    v_cvt_pk_bf16_f32 v153, v242, v243
    v_cvt_pk_bf16_f32 v154, v244, v245
    v_cvt_pk_bf16_f32 v155, v246, v247
    ds_write_b128 v19, v[152:155] offset:6144
    v_pk_mul_f32 v[248:249], v[248:249], v[20:21]
    v_pk_mul_f32 v[250:251], v[250:251], v[20:21]
    v_pk_mul_f32 v[252:253], v[252:253], v[20:21]
    v_pk_mul_f32 v[254:255], v[254:255], v[20:21]
    v_cvt_pk_bf16_f32 v156, v248, v249
    v_cvt_pk_bf16_f32 v157, v250, v251
    v_cvt_pk_bf16_f32 v158, v252, v253
    v_cvt_pk_bf16_f32 v159, v254, v255
    ds_write_b128 v19, v[156:159] offset:7168
    v_mov_b32 v2, v7
    v_and_b32 v21, 15, v1
    v_lshrrev_b32 v22, 4, v1
    v_lshlrev_b32 v22, 2, v22
    v_sub_u32 v18, v21, v22
    s_mov_b32 s40, 0
    s_mov_b32 s41, 16384
    s_mov_b32 s49, 0xffff
    s_lshl_b32 s51, s30, 1
    s_add_u32 s51, s51, 1
    s_and_b32 s50, s28, 3
    s_lshl_b32 s50, s50, 5
    v_mov_b32 v36, 0x3f803f80
    v_mov_b32 v37, 0x3f803f80
    v_mov_b32 v38, 0x3f803f80
    v_mov_b32 v39, 0x3f803f80
    s_lshl_b32 s31, 1, s51
    s_or_b32 s31, s31, 0x8000
    s_add_u32 s36, s51, 1
    s_lshl_b32 s36, -1, s36
    s_or_b32 s48, s36, 0xaaaaaaab
    s_and_b32 s48, s48, 0x7fff
    s_or_b32 s39, s36, 0x55555555
    s_and_b32 s39, s39, 0xffff
    s_add_u32 s46, s45, 65536
    s_add_u32 s47, s45, 98304
    s_mov_b64 s[52:53], 0
    s_waitcnt lgkmcnt(0)
    s_barrier
    s_add_u32 s16, s54, 41943040
    s_addc_u32 s17, s55, 0
    s_and_b32 s17, s17, 0xffff
    s_mov_b32 s18, 117440640
    s_mov_b32 s19, 0x20000
    s_mov_b32 s4, s92
    s_and_b32 s5, s93, 0xffff
    s_mov_b32 s6, 7340032
    s_mov_b32 s7, 0x20000
    s_mov_b32 s8, s94
    s_and_b32 s9, s95, 0xffff
    s_mov_b32 s10, 7340032
    s_mov_b32 s11, 0x20000
    s_and_b32 s60, s29, 3
    s_add_u32 s60, s60, 4
    s_sub_u32 s3, s2, 32
    s_cmp_eq_u32 s28, 0
    s_cselect_b32 s36, 0xad, 0x2d
    s_cselect_b32 s42, 14, 12
    s_cmp_lt_u32 s3, 224
    s_cselect_b32 s36, s36, 0
    s_lshl_b32 s36, s36, s60
    s_or_b32 s42, s42, s36
    ds_read_b128 v[64:67], v2 offset:0
    ds_read_b128 v[68:71], v2 offset:1024
    ds_read_b128 v[72:75], v2 offset:2048
    ds_read_b128 v[76:79], v2 offset:3072
    ds_read_b128 v[80:83], v2 offset:4096
    ds_read_b128 v[84:87], v2 offset:5120
    ds_read_b128 v[88:91], v2 offset:6144
    ds_read_b128 v[92:95], v2 offset:7168
    s_waitcnt lgkmcnt(7)
    v_mfma_f32_16x16x32_bf16 v[96:99], v[64:67], v[128:131], 0
    v_mov_b64 v[192:193], 0
    v_mov_b64 v[194:195], 0
    v_mfma_f32_16x16x32_bf16 v[104:107], v[64:67], v[144:147], 0
    ds_read_b128 v[64:67], v2 offset:8192
    v_mov_b64 v[196:197], 0
    v_mov_b64 v[198:199], 0
    s_waitcnt lgkmcnt(7)
    v_mfma_f32_16x16x32_bf16 v[96:99], v[68:71], v[132:135], v[96:99]
    v_mov_b64 v[200:201], 0
    v_mov_b64 v[202:203], 0
    v_mfma_f32_16x16x32_bf16 v[104:107], v[68:71], v[148:151], v[104:107]
    ds_read_b128 v[68:71], v2 offset:9216
    v_mov_b64 v[204:205], 0
    v_mov_b64 v[206:207], 0
    s_waitcnt lgkmcnt(7)
    v_mfma_f32_16x16x32_bf16 v[96:99], v[72:75], v[136:139], v[96:99]
    v_mov_b64 v[208:209], 0
    v_mfma_f32_16x16x32_bf16 v[104:107], v[72:75], v[152:155], v[104:107]
    ds_read_b128 v[72:75], v2 offset:10240
    v_mov_b64 v[210:211], 0
    v_mov_b64 v[212:213], 0
    s_waitcnt lgkmcnt(7)
    v_mfma_f32_16x16x32_bf16 v[96:99], v[76:79], v[140:143], v[96:99]
    v_mov_b64 v[214:215], 0
    v_mov_b64 v[216:217], 0
    v_mfma_f32_16x16x32_bf16 v[104:107], v[76:79], v[156:159], v[104:107]
    ds_read_b128 v[76:79], v2 offset:11264
    v_mov_b64 v[218:219], 0
    v_mov_b64 v[220:221], 0
    s_waitcnt lgkmcnt(7)
    v_mfma_f32_16x16x32_bf16 v[100:103], v[80:83], v[128:131], 0
    v_mov_b64 v[222:223], 0
    v_mov_b64 v[224:225], 0
    v_mfma_f32_16x16x32_bf16 v[108:111], v[80:83], v[144:147], 0
    ds_read_b128 v[80:83], v2 offset:12288
    v_mov_b64 v[226:227], 0
    s_waitcnt lgkmcnt(7)
    v_mfma_f32_16x16x32_bf16 v[100:103], v[84:87], v[132:135], v[100:103]
    v_mov_b64 v[228:229], 0
    v_mov_b64 v[230:231], 0
    v_mfma_f32_16x16x32_bf16 v[108:111], v[84:87], v[148:151], v[108:111]
    ds_read_b128 v[84:87], v2 offset:13312
    v_mov_b64 v[232:233], 0
    v_mov_b64 v[234:235], 0
    s_waitcnt lgkmcnt(7)
    v_mfma_f32_16x16x32_bf16 v[100:103], v[88:91], v[136:139], v[100:103]
    v_mov_b64 v[236:237], 0
    v_mov_b64 v[238:239], 0
    v_mfma_f32_16x16x32_bf16 v[108:111], v[88:91], v[152:155], v[108:111]
    ds_read_b128 v[88:91], v2 offset:14336
    v_mov_b64 v[240:241], 0
    v_mov_b64 v[242:243], 0
    s_waitcnt lgkmcnt(7)
    v_mfma_f32_16x16x32_bf16 v[100:103], v[92:95], v[140:143], v[100:103]
    v_mov_b64 v[244:245], 0
    v_mfma_f32_16x16x32_bf16 v[108:111], v[92:95], v[156:159], v[108:111]
    ds_read_b128 v[92:95], v2 offset:15360
    v_mov_b64 v[246:247], 0
    v_mov_b64 v[248:249], 0
    s_waitcnt lgkmcnt(7)
    v_mfma_f32_16x16x32_bf16 v[112:115], v[64:67], v[128:131], 0
    v_mov_b64 v[250:251], 0
    v_mov_b64 v[252:253], 0
    v_mfma_f32_16x16x32_bf16 v[120:123], v[64:67], v[144:147], 0
    v_mov_b64 v[254:255], 0
    v_mov_b64 v[28:29], 0
    s_waitcnt lgkmcnt(6)
    v_mfma_f32_16x16x32_bf16 v[112:115], v[68:71], v[132:135], v[112:115]
    v_mov_b64 v[30:31], 0
    v_mov_b64 v[32:33], 0
    v_mfma_f32_16x16x32_bf16 v[120:123], v[68:71], v[148:151], v[120:123]
    v_mov_b64 v[34:35], 0
    s_waitcnt lgkmcnt(5)
    v_mfma_f32_16x16x32_bf16 v[112:115], v[72:75], v[136:139], v[112:115]
    v_mfma_f32_16x16x32_bf16 v[120:123], v[72:75], v[152:155], v[120:123]
    v_max3_f32 v22, v96, v97, v98
    v_max3_f32 v23, v104, v105, v106
    s_waitcnt lgkmcnt(4)
    v_mfma_f32_16x16x32_bf16 v[112:115], v[76:79], v[140:143], v[112:115]
    v_max3_f32 v22, v22, v99, v100
    v_max3_f32 v23, v23, v107, v108
    v_mfma_f32_16x16x32_bf16 v[120:123], v[76:79], v[156:159], v[120:123]
    v_max3_f32 v22, v22, v101, v102
    v_max3_f32 v23, v23, v109, v110
    s_waitcnt lgkmcnt(3)
    v_mfma_f32_16x16x32_bf16 v[116:119], v[80:83], v[128:131], 0
    v_max_f32 v22, v22, v103
    v_max_f32 v23, v23, v111
    v_mfma_f32_16x16x32_bf16 v[124:127], v[80:83], v[144:147], 0
    v_mov_b32 v24, v22
    v_mov_b32 v25, v23
    s_waitcnt lgkmcnt(2)
    v_mfma_f32_16x16x32_bf16 v[116:119], v[84:87], v[132:135], v[116:119]
    v_permlane16_swap_b32 v22, v24
    v_permlane16_swap_b32 v23, v25
    v_mfma_f32_16x16x32_bf16 v[124:127], v[84:87], v[148:151], v[124:127]
    v_max_f32 v22, v22, v24
    v_max_f32 v23, v23, v25
    s_waitcnt lgkmcnt(1)
    v_mfma_f32_16x16x32_bf16 v[116:119], v[88:91], v[136:139], v[116:119]
    v_mov_b32 v24, v22
    v_mov_b32 v25, v23
    v_mfma_f32_16x16x32_bf16 v[124:127], v[88:91], v[152:155], v[124:127]
    v_permlane32_swap_b32 v22, v24
    v_permlane32_swap_b32 v23, v25
    s_waitcnt lgkmcnt(0)
    v_mfma_f32_16x16x32_bf16 v[116:119], v[92:95], v[140:143], v[116:119]
    v_max_f32 v22, v22, v24
    v_max_f32 v23, v23, v25
    v_mfma_f32_16x16x32_bf16 v[124:127], v[92:95], v[156:159], v[124:127]
    v_sub_f32 v40, 0, v22
    v_sub_f32 v41, 0, v22
    v_sub_f32 v42, 0, v22
    v_sub_f32 v43, 0, v22
    v_sub_f32 v44, 0, v23
    v_sub_f32 v45, 0, v23
    v_sub_f32 v46, 0, v23
    v_sub_f32 v47, 0, v23
    v_add_u32 v3, 65536, v2
    v_add_u32 v2, s41, v2
    v_and_b32 v2, s49, v2
    s_waitcnt vmcnt(0)
    s_barrier
    s_cmp_eq_u32 s28, 0
    s_cbranch_scc1 L_recurrent_scan__compressed_kv_cla__moe_arch_mod__prompt_kernel_rare_57
L_recurrent_scan__compressed_kv_cla__moe_arch_mod__prompt_kernel_back_58:
    ds_read_b128 v[64:67], v2 offset:0
    ds_read_b128 v[68:71], v2 offset:1024
    ds_read_b128 v[72:75], v2 offset:2048
    ds_read_b128 v[76:79], v2 offset:3072
    ds_read_b128 v[80:83], v2 offset:4096
    ds_read_b128 v[84:87], v2 offset:5120
    ds_read_b128 v[88:91], v2 offset:6144
    ds_write_b32 v19, v40
    ds_write_b32 v19, v44 offset:4
    v_pk_add_f32 v[96:97], v[96:97], v[40:41]
    v_pk_add_f32 v[98:99], v[98:99], v[40:41]
    v_pk_add_f32 v[100:101], v[100:101], v[40:41]
    v_pk_add_f32 v[102:103], v[102:103], v[40:41]
    v_pk_add_f32 v[104:105], v[104:105], v[44:45]
    v_pk_add_f32 v[106:107], v[106:107], v[44:45]
    v_pk_add_f32 v[108:109], v[108:109], v[44:45]
    v_pk_add_f32 v[110:111], v[110:111], v[44:45]
    v_pk_add_f32 v[112:113], v[112:113], v[40:41]
    v_pk_add_f32 v[114:115], v[114:115], v[40:41]
    v_pk_add_f32 v[116:117], v[116:117], v[40:41]
    v_pk_add_f32 v[118:119], v[118:119], v[40:41]
    v_pk_add_f32 v[120:121], v[120:121], v[44:45]
    v_pk_add_f32 v[122:123], v[122:123], v[44:45]
    v_pk_add_f32 v[124:125], v[124:125], v[44:45]
    v_pk_add_f32 v[126:127], v[126:127], v[44:45]
    v_exp_f32 v96, v96
    v_exp_f32 v97, v97
    v_exp_f32 v98, v98
    v_exp_f32 v99, v99
    v_exp_f32 v104, v104
    v_exp_f32 v105, v105
    v_exp_f32 v106, v106
    v_exp_f32 v107, v107
    v_exp_f32 v100, v100
    v_exp_f32 v101, v101
    v_exp_f32 v102, v102
    v_exp_f32 v103, v103
    v_exp_f32 v108, v108
    v_exp_f32 v109, v109
    v_exp_f32 v110, v110
    v_exp_f32 v111, v111
    v_cvt_pk_bf16_f32 v48, v96, v97
    v_cvt_pk_bf16_f32 v49, v98, v99
    v_cvt_pk_bf16_f32 v52, v104, v105
    v_cvt_pk_bf16_f32 v53, v106, v107
    v_cvt_pk_bf16_f32 v50, v100, v101
    v_cvt_pk_bf16_f32 v51, v102, v103
    v_cvt_pk_bf16_f32 v54, v108, v109
    v_cvt_pk_bf16_f32 v55, v110, v111
    .p2align 6
L_body0:
    s_waitcnt lgkmcnt(5)
    v_mfma_f32_16x16x32_bf16 v[96:99], v[64:67], v[128:131], v[40:43]
    v_exp_f32 v112, v112
    v_mfma_f32_16x16x32_bf16 v[104:107], v[64:67], v[144:147], v[44:47]
    ds_read_b128 v[92:95], v2 offset:7168
    s_bitcmp1_b32 s48, s40
    s_cbranch_scc0 L_recurrent_scan__compressed_kv_cla__moe_arch_mod__prompt_kernel_nodma_81
    s_add_u32 m0, s43, 0
    s_nop 0
    buffer_load_dwordx4 v4, s[12:15], s46 offen offset:0 sc1 lds
    buffer_load_dwordx4 v4, s[12:15], s46 offen offset:1024 sc1 lds
L_recurrent_scan__compressed_kv_cla__moe_arch_mod__prompt_kernel_nodma_81:
    v_mfma_f32_16x16x32_bf16 v[96:99], v[68:71], v[132:135], v[96:99]
    v_exp_f32 v113, v113
    v_mfma_f32_16x16x32_bf16 v[104:107], v[68:71], v[148:151], v[104:107]
    ds_read_b128 v[64:67], v3 offset:0
    s_waitcnt lgkmcnt(5)
    v_mfma_f32_16x16x32_bf16 v[96:99], v[72:75], v[136:139], v[96:99]
    v_exp_f32 v114, v114
    v_mfma_f32_16x16x32_bf16 v[104:107], v[72:75], v[152:155], v[104:107]
    ds_read_b128 v[68:71], v3 offset:1024
    v_cvt_pk_bf16_f32 v56, v112, v113
    s_bitcmp1_b32 s48, s40
    s_cbranch_scc0 L_recurrent_scan__compressed_kv_cla__moe_arch_mod__prompt_kernel_nodma_82
    s_add_u32 m0, s43, 0
    s_nop 0
    buffer_load_dwordx4 v4, s[12:15], s46 offen offset:2048 sc1 lds
    buffer_load_dwordx4 v4, s[12:15], s46 offen offset:3072 sc1 lds
L_recurrent_scan__compressed_kv_cla__moe_arch_mod__prompt_kernel_nodma_82:
    v_mfma_f32_16x16x32_bf16 v[96:99], v[76:79], v[140:143], v[96:99]
    v_exp_f32 v115, v115
    v_mfma_f32_16x16x32_bf16 v[104:107], v[76:79], v[156:159], v[104:107]
    ds_read_b128 v[72:75], v3 offset:2048
    s_waitcnt lgkmcnt(5)
    v_mfma_f32_16x16x32_bf16 v[100:103], v[80:83], v[128:131], v[40:43]
    v_exp_f32 v120, v120
    v_mfma_f32_16x16x32_bf16 v[108:111], v[80:83], v[144:147], v[44:47]
    ds_read_b128 v[76:79], v3 offset:3072
    v_cvt_pk_bf16_f32 v57, v114, v115
    v_mfma_f32_16x16x32_bf16 v[100:103], v[84:87], v[132:135], v[100:103]
    v_exp_f32 v121, v121
    v_mfma_f32_16x16x32_bf16 v[108:111], v[84:87], v[148:151], v[108:111]
    ds_read_b128 v[80:83], v3 offset:4096
    s_bitcmp1_b32 s48, s40
    s_cbranch_scc0 L_recurrent_scan__compressed_kv_cla__moe_arch_mod__prompt_kernel_nodma_83
    s_add_u32 m0, s43, 4096
    s_nop 0
    buffer_load_dwordx4 v6, s[12:15], s46 offen offset:0 sc1 lds
    buffer_load_dwordx4 v6, s[12:15], s46 offen offset:1024 sc1 lds
L_recurrent_scan__compressed_kv_cla__moe_arch_mod__prompt_kernel_nodma_83:
    s_waitcnt lgkmcnt(5)
    v_mfma_f32_16x16x32_bf16 v[100:103], v[88:91], v[136:139], v[100:103]
    v_exp_f32 v122, v122
    v_mfma_f32_16x16x32_bf16 v[108:111], v[88:91], v[152:155], v[108:111]
    ds_read_b128 v[84:87], v3 offset:5120
    v_cvt_pk_bf16_f32 v60, v120, v121
    v_mfma_f32_16x16x32_bf16 v[100:103], v[92:95], v[140:143], v[100:103]
    v_exp_f32 v123, v123
    v_mfma_f32_16x16x32_bf16 v[108:111], v[92:95], v[156:159], v[108:111]
    ds_read_b128 v[88:91], v3 offset:6144
    s_bitcmp1_b32 s48, s40
    s_cbranch_scc0 L_recurrent_scan__compressed_kv_cla__moe_arch_mod__prompt_kernel_nodma_84
    s_add_u32 m0, s43, 4096
    s_nop 0
    buffer_load_dwordx4 v6, s[12:15], s46 offen offset:2048 sc1 lds
    buffer_load_dwordx4 v6, s[12:15], s46 offen offset:3072 sc1 lds
    s_add_u32 s46, s46, 65536
    s_xor_b32 s43, s43, 32768
L_recurrent_scan__compressed_kv_cla__moe_arch_mod__prompt_kernel_nodma_84:
    s_waitcnt lgkmcnt(5)
    v_mfma_f32_16x16x32_bf16 v[192:195], v[64:67], v[48:51], v[192:195]
    v_exp_f32 v116, v116
    v_mfma_f32_16x16x32_bf16 v[224:227], v[64:67], v[52:55], v[224:227]
    ds_read_b128 v[92:95], v3 offset:7168
    v_cvt_pk_bf16_f32 v61, v122, v123
    v_mfma_f32_16x16x32_bf16 v[196:199], v[68:71], v[48:51], v[196:199]
    v_exp_f32 v117, v117
    v_mfma_f32_16x16x32_bf16 v[228:231], v[68:71], v[52:55], v[228:231]
    ds_read_b128 v[64:67], v2 offset:8192
    s_waitcnt lgkmcnt(5)
    v_mfma_f32_16x16x32_bf16 v[200:203], v[72:75], v[48:51], v[200:203]
    v_exp_f32 v118, v118
    v_mfma_f32_16x16x32_bf16 v[232:235], v[72:75], v[52:55], v[232:235]
    v_mfma_f32_16x16x32_bf16 v[28:31], v[36:39], v[48:51], v[28:31]
    ds_read_b128 v[68:71], v2 offset:9216
    v_cvt_pk_bf16_f32 v58, v116, v117
    s_bitcmp1_b32 s39, s40
    s_cbranch_scc0 L_recurrent_scan__compressed_kv_cla__moe_arch_mod__prompt_kernel_nodma_85
    s_add_u32 m0, s44, 0
    s_nop 0
    buffer_load_dwordx4 v4, s[12:15], s47 offen offset:0 sc1 lds
    buffer_load_dwordx4 v4, s[12:15], s47 offen offset:1024 sc1 lds
L_recurrent_scan__compressed_kv_cla__moe_arch_mod__prompt_kernel_nodma_85:
    v_mfma_f32_16x16x32_bf16 v[204:207], v[76:79], v[48:51], v[204:207]
    v_exp_f32 v119, v119
    v_mfma_f32_16x16x32_bf16 v[236:239], v[76:79], v[52:55], v[236:239]
    ds_read_b128 v[72:75], v2 offset:10240
    s_waitcnt lgkmcnt(5)
    v_mfma_f32_16x16x32_bf16 v[208:211], v[80:83], v[48:51], v[208:211]
    v_exp_f32 v124, v124
    v_mfma_f32_16x16x32_bf16 v[240:243], v[80:83], v[52:55], v[240:243]
    ds_read_b128 v[76:79], v2 offset:11264
    v_cvt_pk_bf16_f32 v59, v118, v119
    s_bitcmp1_b32 s39, s40
    s_cbranch_scc0 L_recurrent_scan__compressed_kv_cla__moe_arch_mod__prompt_kernel_nodma_86
    s_add_u32 m0, s44, 0
    s_nop 0
    buffer_load_dwordx4 v4, s[12:15], s47 offen offset:2048 sc1 lds
    buffer_load_dwordx4 v4, s[12:15], s47 offen offset:3072 sc1 lds
L_recurrent_scan__compressed_kv_cla__moe_arch_mod__prompt_kernel_nodma_86:
    v_mfma_f32_16x16x32_bf16 v[212:215], v[84:87], v[48:51], v[212:215]
    v_exp_f32 v125, v125
    v_mfma_f32_16x16x32_bf16 v[244:247], v[84:87], v[52:55], v[244:247]
    ds_read_b128 v[80:83], v2 offset:12288
    s_waitcnt lgkmcnt(5)
    v_mfma_f32_16x16x32_bf16 v[216:219], v[88:91], v[48:51], v[216:219]
    v_exp_f32 v126, v126
    v_mfma_f32_16x16x32_bf16 v[248:251], v[88:91], v[52:55], v[248:251]
    v_mfma_f32_16x16x32_bf16 v[32:35], v[36:39], v[52:55], v[32:35]
    ds_read_b128 v[84:87], v2 offset:13312
    v_cvt_pk_bf16_f32 v62, v124, v125
    v_mfma_f32_16x16x32_bf16 v[220:223], v[92:95], v[48:51], v[220:223]
    v_exp_f32 v127, v127
    v_mfma_f32_16x16x32_bf16 v[252:255], v[92:95], v[52:55], v[252:255]
    ds_read_b128 v[88:91], v2 offset:14336
    v_cvt_pk_bf16_f32 v63, v126, v127
    s_bitcmp1_b32 s39, s40
    s_cbranch_scc0 L_recurrent_scan__compressed_kv_cla__moe_arch_mod__prompt_kernel_nodma_87
    s_add_u32 m0, s44, 4096
    s_nop 0
    buffer_load_dwordx4 v6, s[12:15], s47 offen offset:0 sc1 lds
    buffer_load_dwordx4 v6, s[12:15], s47 offen offset:1024 sc1 lds
L_recurrent_scan__compressed_kv_cla__moe_arch_mod__prompt_kernel_nodma_87:
    s_bitcmp1_b32 s31, s40
    s_cbranch_scc1 L_recurrent_scan__compressed_kv_cla__moe_arch_mod__prompt_kernel_rare_63
L_recurrent_scan__compressed_kv_cla__moe_arch_mod__prompt_kernel_back_64:
    s_waitcnt lgkmcnt(5)
    v_mfma_f32_16x16x32_bf16 v[112:115], v[64:67], v[128:131], v[40:43]
    v_exp_f32 v96, v96
    v_mfma_f32_16x16x32_bf16 v[120:123], v[64:67], v[144:147], v[44:47]
    ds_read_b128 v[92:95], v2 offset:15360
    v_mfma_f32_16x16x32_bf16 v[112:115], v[68:71], v[132:135], v[112:115]
    v_exp_f32 v97, v97
    v_mfma_f32_16x16x32_bf16 v[120:123], v[68:71], v[148:151], v[120:123]
    ds_read_b128 v[64:67], v3 offset:8192
    s_bitcmp1_b32 s39, s40
    s_cbranch_scc0 L_recurrent_scan__compressed_kv_cla__moe_arch_mod__prompt_kernel_nodma_88
    s_add_u32 m0, s44, 4096
    s_nop 0
    buffer_load_dwordx4 v6, s[12:15], s47 offen offset:2048 sc1 lds
    buffer_load_dwordx4 v6, s[12:15], s47 offen offset:3072 sc1 lds
    s_add_u32 s47, s47, 65536
    s_xor_b32 s44, s44, 32768
L_recurrent_scan__compressed_kv_cla__moe_arch_mod__prompt_kernel_nodma_88:
    s_waitcnt lgkmcnt(5)
    v_mfma_f32_16x16x32_bf16 v[112:115], v[72:75], v[136:139], v[112:115]
    v_exp_f32 v98, v98
    v_mfma_f32_16x16x32_bf16 v[120:123], v[72:75], v[152:155], v[120:123]
    ds_read_b128 v[68:71], v3 offset:9216
    v_cvt_pk_bf16_f32 v48, v96, v97
    v_mfma_f32_16x16x32_bf16 v[112:115], v[76:79], v[140:143], v[112:115]
    v_exp_f32 v99, v99
    v_mfma_f32_16x16x32_bf16 v[120:123], v[76:79], v[156:159], v[120:123]
    ds_read_b128 v[72:75], v3 offset:10240
    s_waitcnt lgkmcnt(5)
    v_mfma_f32_16x16x32_bf16 v[116:119], v[80:83], v[128:131], v[40:43]
    v_exp_f32 v104, v104
    v_mfma_f32_16x16x32_bf16 v[124:127], v[80:83], v[144:147], v[44:47]
    ds_read_b128 v[76:79], v3 offset:11264
    v_cvt_pk_bf16_f32 v49, v98, v99
    v_mfma_f32_16x16x32_bf16 v[116:119], v[84:87], v[132:135], v[116:119]
    v_exp_f32 v105, v105
    v_mfma_f32_16x16x32_bf16 v[124:127], v[84:87], v[148:151], v[124:127]
    ds_read_b128 v[80:83], v3 offset:12288
    s_waitcnt lgkmcnt(5)
    v_mfma_f32_16x16x32_bf16 v[116:119], v[88:91], v[136:139], v[116:119]
    v_exp_f32 v106, v106
    v_mfma_f32_16x16x32_bf16 v[124:127], v[88:91], v[152:155], v[124:127]
    ds_read_b128 v[84:87], v3 offset:13312
    v_cvt_pk_bf16_f32 v52, v104, v105
    v_mfma_f32_16x16x32_bf16 v[116:119], v[92:95], v[140:143], v[116:119]
    v_exp_f32 v107, v107
    v_mfma_f32_16x16x32_bf16 v[124:127], v[92:95], v[156:159], v[124:127]
    ds_read_b128 v[88:91], v3 offset:14336
    s_waitcnt lgkmcnt(5)
    v_mfma_f32_16x16x32_bf16 v[192:195], v[64:67], v[56:59], v[192:195]
    v_exp_f32 v100, v100
    v_mfma_f32_16x16x32_bf16 v[224:227], v[64:67], v[60:63], v[224:227]
    ds_read_b128 v[92:95], v3 offset:15360
    v_cvt_pk_bf16_f32 v53, v106, v107
    v_mfma_f32_16x16x32_bf16 v[196:199], v[68:71], v[56:59], v[196:199]
    v_exp_f32 v101, v101
    v_mfma_f32_16x16x32_bf16 v[228:231], v[68:71], v[60:63], v[228:231]
    v_add_u32 v3, 65536, v2
    v_add_u32 v2, s41, v2
    s_waitcnt lgkmcnt(4)
    v_mfma_f32_16x16x32_bf16 v[200:203], v[72:75], v[56:59], v[200:203]
    v_exp_f32 v102, v102
    s_add_u32 s40, s40, 1
    v_and_b32 v2, s49, v2
    v_mfma_f32_16x16x32_bf16 v[232:235], v[72:75], v[60:63], v[232:235]
    v_mfma_f32_16x16x32_bf16 v[28:31], v[36:39], v[56:59], v[28:31]
    v_cvt_pk_bf16_f32 v50, v100, v101
    s_waitcnt vmcnt(8) lgkmcnt(0)
    s_cmp_le_u32 s40, s51
    s_cbranch_scc1 L_recurrent_scan__compressed_kv_cla__moe_arch_mod__prompt_kernel_rlx_65
    s_waitcnt vmcnt(0)
L_recurrent_scan__compressed_kv_cla__moe_arch_mod__prompt_kernel_rlx_65:
    s_bitcmp1_b32 s42, s40
    s_cbranch_scc1 L_recurrent_scan__compressed_kv_cla__moe_arch_mod__prompt_kernel_rare_79
L_recurrent_scan__compressed_kv_cla__moe_arch_mod__prompt_kernel_back_80:
    s_barrier
    v_mfma_f32_16x16x32_bf16 v[204:207], v[76:79], v[56:59], v[204:207]
    v_exp_f32 v103, v103
    v_mfma_f32_16x16x32_bf16 v[236:239], v[76:79], v[60:63], v[236:239]
    ds_read_b128 v[68:71], v2 offset:1024
    ds_read_b128 v[64:67], v2 offset:0
    v_mfma_f32_16x16x32_bf16 v[208:211], v[80:83], v[56:59], v[208:211]
    v_exp_f32 v108, v108
    v_mfma_f32_16x16x32_bf16 v[240:243], v[80:83], v[60:63], v[240:243]
    ds_read_b128 v[76:79], v2 offset:3072
    ds_read_b128 v[72:75], v2 offset:2048
    v_cvt_pk_bf16_f32 v51, v102, v103
    v_mfma_f32_16x16x32_bf16 v[212:215], v[84:87], v[56:59], v[212:215]
    v_exp_f32 v109, v109
    v_mfma_f32_16x16x32_bf16 v[244:247], v[84:87], v[60:63], v[244:247]
    ds_read_b128 v[80:83], v2 offset:4096
    v_mfma_f32_16x16x32_bf16 v[216:219], v[88:91], v[56:59], v[216:219]
    v_exp_f32 v110, v110
    v_mfma_f32_16x16x32_bf16 v[248:251], v[88:91], v[60:63], v[248:251]
    v_mfma_f32_16x16x32_bf16 v[32:35], v[36:39], v[60:63], v[32:35]
    ds_read_b128 v[84:87], v2 offset:5120
    v_cvt_pk_bf16_f32 v54, v108, v109
    v_mfma_f32_16x16x32_bf16 v[220:223], v[92:95], v[56:59], v[220:223]
    v_exp_f32 v111, v111
    v_mfma_f32_16x16x32_bf16 v[252:255], v[92:95], v[60:63], v[252:255]
    ds_read_b128 v[88:91], v2 offset:6144
    v_cvt_pk_bf16_f32 v55, v110, v111
    s_cmp_lg_u32 s40, 16
    s_cbranch_scc1 L_body0
    s_lshr_b32 s36, s2, 5
    s_add_u32 s36, s36, 48
    s_lshl_b32 s36, s36, 7
    v_mov_b32 v12, s36
    global_load_dword v11, v12, s[90:91] sc1
    s_sub_u32 s36, 32, s50
    s_cmp_lt_i32 s36, 0
    s_cbranch_scc0 L_recurrent_scan__compressed_kv_cla__moe_arch_mod__prompt_kernel_rare_89
L_recurrent_scan__compressed_kv_cla__moe_arch_mod__prompt_kernel_back_90:
    s_lshl_b32 s37, s28, 13
    v_add_u32 v5, s37, v7
    s_waitcnt lgkmcnt(5)
    v_mfma_f32_16x16x32_bf16 v[192:195], v[64:67], v[48:51], v[192:195]
    v_exp_f32 v112, v112
    v_mfma_f32_16x16x32_bf16 v[224:227], v[64:67], v[52:55], v[224:227]
    ds_read_b128 v[92:95], v3 offset:7168
    v_exp_f32 v113, v113
    v_mfma_f32_16x16x32_bf16 v[196:199], v[68:71], v[48:51], v[196:199]
    v_cvt_pk_bf16_f32 v56, v112, v113
    v_exp_f32 v114, v114
    v_mfma_f32_16x16x32_bf16 v[228:231], v[68:71], v[52:55], v[228:231]
    ds_read_b128 v[64:67], v3 offset:8192
    v_exp_f32 v115, v115
    s_waitcnt lgkmcnt(5)
    v_mfma_f32_16x16x32_bf16 v[200:203], v[72:75], v[48:51], v[200:203]
    v_cvt_pk_bf16_f32 v57, v114, v115
    v_exp_f32 v120, v120
    v_mfma_f32_16x16x32_bf16 v[232:235], v[72:75], v[52:55], v[232:235]
    v_mfma_f32_16x16x32_bf16 v[28:31], v[36:39], v[48:51], v[28:31]
    ds_read_b128 v[68:71], v3 offset:9216
    v_exp_f32 v121, v121
    v_mfma_f32_16x16x32_bf16 v[204:207], v[76:79], v[48:51], v[204:207]
    v_cvt_pk_bf16_f32 v60, v120, v121
    v_exp_f32 v122, v122
    v_mfma_f32_16x16x32_bf16 v[236:239], v[76:79], v[52:55], v[236:239]
    ds_read_b128 v[72:75], v3 offset:10240
    v_exp_f32 v123, v123
    s_waitcnt lgkmcnt(6)
    v_mfma_f32_16x16x32_bf16 v[208:211], v[80:83], v[48:51], v[208:211]
    v_cvt_pk_bf16_f32 v61, v122, v123
    v_exp_f32 v116, v116
    v_mfma_f32_16x16x32_bf16 v[240:243], v[80:83], v[52:55], v[240:243]
    ds_read_b128 v[76:79], v3 offset:11264
    v_exp_f32 v117, v117
    s_waitcnt lgkmcnt(6)
    v_mfma_f32_16x16x32_bf16 v[212:215], v[84:87], v[48:51], v[212:215]
    v_cvt_pk_bf16_f32 v58, v116, v117
    v_exp_f32 v118, v118
    v_mfma_f32_16x16x32_bf16 v[244:247], v[84:87], v[52:55], v[244:247]
    ds_read_b128 v[80:83], v3 offset:12288
    v_exp_f32 v119, v119
    s_waitcnt lgkmcnt(6)
    v_mfma_f32_16x16x32_bf16 v[216:219], v[88:91], v[48:51], v[216:219]
    v_cvt_pk_bf16_f32 v59, v118, v119
    v_exp_f32 v124, v124
    v_mfma_f32_16x16x32_bf16 v[248:251], v[88:91], v[52:55], v[248:251]
    v_mfma_f32_16x16x32_bf16 v[32:35], v[36:39], v[52:55], v[32:35]
    ds_read_b128 v[84:87], v3 offset:13312
    v_exp_f32 v125, v125
    s_waitcnt lgkmcnt(6)
    v_mfma_f32_16x16x32_bf16 v[220:223], v[92:95], v[48:51], v[220:223]
    v_cvt_pk_bf16_f32 v62, v124, v125
    v_exp_f32 v126, v126
    v_mfma_f32_16x16x32_bf16 v[252:255], v[92:95], v[52:55], v[252:255]
    ds_read_b128 v[88:91], v3 offset:14336
    v_exp_f32 v127, v127
    s_nop 0
    v_cvt_pk_bf16_f32 v63, v126, v127
    s_nop 1
    s_waitcnt lgkmcnt(6)
    v_mfma_f32_16x16x32_bf16 v[192:195], v[64:67], v[56:59], v[192:195]
    s_mov_b32 s4, s34
    s_and_b32 s5, s35, 0xffff
    s_mov_b32 s6, 7340032
    s_mov_b32 s7, 0x20000
    s_mov_b32 s8, s32
    v_mfma_f32_16x16x32_bf16 v[224:227], v[64:67], v[60:63], v[224:227]
    ds_read_b128 v[92:95], v3 offset:15360
    s_and_b32 s9, s33, 0xffff
    s_mov_b32 s10, 8388608
    s_mov_b32 s11, 0x20000
    s_lshr_b32 s38, s2, 4
    s_waitcnt lgkmcnt(6)
    v_mfma_f32_16x16x32_bf16 v[196:199], v[68:71], v[56:59], v[196:199]
    s_mul_i32 s38, s38, 224
    s_and_b32 s39, s2, 15
    s_lshl_b32 s39, s39, 7
    v_lshrrev_b32 v25, 3, v1
    s_lshl_b32 s36, s28, 5
    v_mfma_f32_16x16x32_bf16 v[228:231], v[68:71], v[60:63], v[228:231]
    s_add_u32 s36, s36, s38
    v_add_u32 v25, s36, v25
    v_mul_u32_u24 v25, 2048, v25
    v_add_u32 v25, s39, v25
    s_waitcnt lgkmcnt(5)
    v_mfma_f32_16x16x32_bf16 v[200:203], v[72:75], v[56:59], v[200:203]
    v_bfe_u32 v26, v1, 4, 1
    v_lshlrev_b32 v26, 1, v26
    v_and_b32 v27, 7, v1
    v_xor_b32 v26, v26, v27
    v_mfma_f32_16x16x32_bf16 v[232:235], v[72:75], v[60:63], v[232:235]
    v_mfma_f32_16x16x32_bf16 v[28:31], v[36:39], v[56:59], v[28:31]
    v_lshl_add_u32 v24, v26, 4, v25
    v_xor_b32 v26, 4, v26
    v_lshl_add_u32 v25, v26, 4, v25
    v_add_u32 v25, 15360, v25
    v_add_u32 v26, 30720, v24
    s_waitcnt lgkmcnt(4)
    v_mfma_f32_16x16x32_bf16 v[204:207], v[76:79], v[56:59], v[204:207]
    v_add_u32 v27, 30720, v25
    s_lshl_b32 s36, s28, 12
    s_add_u32 s36, s36, 131072
    s_cmp_lt_u32 s28, 7
    s_cselect_b32 m0, s36, 0x30000
    s_cselect_b32 s6, 7340032, 0
    v_mfma_f32_16x16x32_bf16 v[236:239], v[76:79], v[60:63], v[236:239]
    buffer_load_dwordx4 v24, s[4:7], 0 offen offset:0 lds
    buffer_load_dwordx4 v25, s[4:7], 0 offen offset:1024 lds
    buffer_load_dwordx4 v26, s[4:7], 0 offen offset:2048 lds
    buffer_load_dwordx4 v27, s[4:7], 0 offen offset:3072 lds
    s_waitcnt lgkmcnt(3)
    v_mfma_f32_16x16x32_bf16 v[208:211], v[80:83], v[56:59], v[208:211]
    v_mfma_f32_16x16x32_bf16 v[240:243], v[80:83], v[60:63], v[240:243]
    ds_write_b128 v5, v[224:227] offset:0
    s_waitcnt lgkmcnt(3)
    v_mfma_f32_16x16x32_bf16 v[212:215], v[84:87], v[56:59], v[212:215]
    v_mfma_f32_16x16x32_bf16 v[244:247], v[84:87], v[60:63], v[244:247]
    ds_write_b128 v5, v[228:231] offset:1024
    s_waitcnt lgkmcnt(3)
    v_mfma_f32_16x16x32_bf16 v[216:219], v[88:91], v[56:59], v[216:219]
    v_mfma_f32_16x16x32_bf16 v[248:251], v[88:91], v[60:63], v[248:251]
    v_mfma_f32_16x16x32_bf16 v[32:35], v[36:39], v[60:63], v[32:35]
    ds_write_b128 v5, v[232:235] offset:2048
    s_waitcnt lgkmcnt(3)
    v_mfma_f32_16x16x32_bf16 v[220:223], v[92:95], v[56:59], v[220:223]
    v_mfma_f32_16x16x32_bf16 v[252:255], v[92:95], v[60:63], v[252:255]
    ds_write_b128 v5, v[236:239] offset:3072
    ds_write_b128 v5, v[240:243] offset:4096
    ds_write_b128 v5, v[244:247] offset:5120
    v_xor_b32 v106, 32768, v5
    s_lshl_b32 s37, s28, 8
    s_add_u32 s37, s37, 159744
    v_lshl_add_u32 v107, v1, 2, s37
    v_xor_b32 v108, 1024, v107
    ds_write_b128 v5, v[248:251] offset:6144
    ds_write_b128 v5, v[252:255] offset:7168
    ds_write_b32 v107, v32
    s_mov_b32 s36, 0x5d800000
    v_cmp_nge_f32 vcc, s36, v28
    s_nop 0
    s_or_b64 s[52:53], s[52:53], vcc
    v_cmp_nge_f32 vcc, s36, v32
    s_nop 0
    s_or_b64 s[52:53], s[52:53], vcc
    s_or_b32 s36, s52, s53
    v_mov_b32 v110, s36
    s_lshl_b32 s37, s28, 2
    s_add_u32 s37, s37, 161792
    v_mov_b32 v111, s37
    ds_write_b32 v111, v110
    v_mov_b32 v112, 161856
    v_mov_b32 v114, s56
    v_mov_b32 v115, s57
    v_mov_b32 v116, s58
    v_mov_b32 v117, s59
    ds_write_b128 v112, v[114:117]
    v_and_b32 v111, 7, v1
    v_lshlrev_b32 v111, 2, v111
    v_add_u32 v111, 161792, v111
    v_mov_b32 v113, v7
    s_sub_u32 s36, 15, s30
    s_lshl_b32 s38, s36, 3
    s_and_b32 s37, s28, 3
    s_lshl_b32 s37, s37, 1
    s_add_u32 s38, s38, s37
    s_lshl_b32 s38, s38, 17
    s_lshl_b32 s37, s29, 12
    s_add_u32 s38, s38, s37
    s_waitcnt vmcnt(4)
    v_readfirstlane_b32 s36, v11
    s_nop 0
    s_cmp_lt_u32 s36, 28
    s_cbranch_scc1 L_recurrent_scan__compressed_kv_cla__moe_arch_mod__prompt_kernel_rare_93
L_recurrent_scan__compressed_kv_cla__moe_arch_mod__prompt_kernel_back_94:
    s_lshr_b32 s36, s2, 4
    s_mul_i32 s36, s36, 7
    s_min_u32 s37, s28, 6
    s_add_u32 s36, s36, s37
    s_lshl_b32 s36, s36, 11
    s_add_u32 s36, s36, 58720256
    v_and_b32 v11, 15, v1
    v_lshlrev_b32 v11, 4, v11
    v_lshrrev_b32 v12, 4, v1
    v_lshl_add_u32 v11, v12, 9, v11
    buffer_load_dwordx4 v[96:99], v11, s[24:27], s36 offen offset:0 sc1
    buffer_load_dwordx4 v[100:103], v11, s[24:27], s36 offen offset:256 sc1
    s_waitcnt lgkmcnt(0)
    s_barrier
    ds_read_b32 v110, v111
    ds_read_b32 v109, v108
    ds_read_b128 v[64:67], v106 offset:0
    ds_read_b128 v[68:71], v106 offset:1024
    ds_read_b128 v[72:75], v106 offset:2048
    ds_read_b128 v[76:79], v106 offset:3072
    ds_read_b128 v[80:83], v106 offset:4096
    ds_read_b128 v[84:87], v106 offset:5120
    ds_read_b128 v[88:91], v106 offset:6144
    ds_read_b128 v[92:95], v106 offset:7168
    s_waitcnt lgkmcnt(8)
    v_add_f32 v109, v109, v28
    v_cmp_ne_u32 s[52:53], 0, v110
    v_rcp_f32 v109, v109
    s_nop 0
    v_mov_b32 v108, v109
    s_waitcnt lgkmcnt(6)
    v_pk_add_f32 v[192:193], v[192:193], v[64:65]
    v_pk_add_f32 v[194:195], v[194:195], v[66:67]
    v_pk_add_f32 v[196:197], v[196:197], v[68:69]
    v_pk_add_f32 v[198:199], v[198:199], v[70:71]
    v_pk_mul_f32 v[192:193], v[192:193], v[108:109]
    v_pk_mul_f32 v[194:195], v[194:195], v[108:109]
    v_pk_mul_f32 v[196:197], v[196:197], v[108:109]
    v_pk_mul_f32 v[198:199], v[198:199], v[108:109]
    v_cvt_pk_bf16_f32 v48, v192, v193
    v_cvt_pk_bf16_f32 v49, v194, v195
    v_cvt_pk_bf16_f32 v50, v196, v197
    v_cvt_pk_bf16_f32 v51, v198, v199
    buffer_store_dwordx4 v[48:51], v113, s[16:19], s38 offen offset:0 sc1
    s_waitcnt lgkmcnt(4)
    v_pk_add_f32 v[200:201], v[200:201], v[72:73]
    v_pk_add_f32 v[202:203], v[202:203], v[74:75]
    v_pk_add_f32 v[204:205], v[204:205], v[76:77]
    v_pk_add_f32 v[206:207], v[206:207], v[78:79]
    v_pk_mul_f32 v[200:201], v[200:201], v[108:109]
    v_pk_mul_f32 v[202:203], v[202:203], v[108:109]
    v_pk_mul_f32 v[204:205], v[204:205], v[108:109]
    v_pk_mul_f32 v[206:207], v[206:207], v[108:109]
    v_cvt_pk_bf16_f32 v52, v200, v201
    v_cvt_pk_bf16_f32 v53, v202, v203
    v_cvt_pk_bf16_f32 v54, v204, v205
    v_cvt_pk_bf16_f32 v55, v206, v207
    buffer_store_dwordx4 v[52:55], v113, s[16:19], s38 offen offset:1024 sc1
    s_waitcnt lgkmcnt(2)
    v_pk_add_f32 v[208:209], v[208:209], v[80:81]
    v_pk_add_f32 v[210:211], v[210:211], v[82:83]
    v_pk_add_f32 v[212:213], v[212:213], v[84:85]
    v_pk_add_f32 v[214:215], v[214:215], v[86:87]
    v_pk_mul_f32 v[208:209], v[208:209], v[108:109]
    v_pk_mul_f32 v[210:211], v[210:211], v[108:109]
    v_pk_mul_f32 v[212:213], v[212:213], v[108:109]
    v_pk_mul_f32 v[214:215], v[214:215], v[108:109]
    v_cvt_pk_bf16_f32 v56, v208, v209
    v_cvt_pk_bf16_f32 v57, v210, v211
    v_cvt_pk_bf16_f32 v58, v212, v213
    v_cvt_pk_bf16_f32 v59, v214, v215
    buffer_store_dwordx4 v[56:59], v113, s[16:19], s38 offen offset:2048 sc1
    s_waitcnt lgkmcnt(0)
    v_pk_add_f32 v[216:217], v[216:217], v[88:89]
    v_pk_add_f32 v[218:219], v[218:219], v[90:91]
    v_pk_add_f32 v[220:221], v[220:221], v[92:93]
    v_pk_add_f32 v[222:223], v[222:223], v[94:95]
    v_pk_mul_f32 v[216:217], v[216:217], v[108:109]
    v_pk_mul_f32 v[218:219], v[218:219], v[108:109]
    v_pk_mul_f32 v[220:221], v[220:221], v[108:109]
    v_pk_mul_f32 v[222:223], v[222:223], v[108:109]
    v_cvt_pk_bf16_f32 v60, v216, v217
    v_cvt_pk_bf16_f32 v61, v218, v219
    v_cvt_pk_bf16_f32 v62, v220, v221
    v_cvt_pk_bf16_f32 v63, v222, v223
    buffer_store_dwordx4 v[60:63], v113, s[16:19], s38 offen offset:3072 sc1
    s_cmp_eq_u64 s[52:53], 0
    s_cbranch_scc1 L_p3_done
    s_waitcnt vmcnt(0)
    v_mov_b32 v112, v96
    v_mov_b32 v113, v97
    v_mov_b32 v114, v98
    v_mov_b32 v115, v99
    v_mov_b32 v116, v100
    v_mov_b32 v117, v101
    v_mov_b32 v118, v102
    v_mov_b32 v119, v103
    v_mov_b32 v192, 0
    v_mov_b32 v193, 0
    v_mov_b32 v194, 0
    v_mov_b32 v195, 0
    v_mov_b32 v196, 0
    v_mov_b32 v197, 0
    v_mov_b32 v198, 0
    v_mov_b32 v199, 0
    v_mov_b32 v200, 0
    v_mov_b32 v201, 0
    v_mov_b32 v202, 0
    v_mov_b32 v203, 0
    v_mov_b32 v204, 0
    v_mov_b32 v205, 0
    v_mov_b32 v206, 0
    v_mov_b32 v207, 0
    v_mov_b32 v208, 0
    v_mov_b32 v209, 0
    v_mov_b32 v210, 0
    v_mov_b32 v211, 0
    v_mov_b32 v212, 0
    v_mov_b32 v213, 0
    v_mov_b32 v214, 0
    v_mov_b32 v215, 0
    v_mov_b32 v216, 0
    v_mov_b32 v217, 0
    v_mov_b32 v218, 0
    v_mov_b32 v219, 0
    v_mov_b32 v220, 0
    v_mov_b32 v221, 0
    v_mov_b32 v222, 0
    v_mov_b32 v223, 0
    v_mov_b32 v224, 0
    v_mov_b32 v225, 0
    v_mov_b32 v226, 0
    v_mov_b32 v227, 0
    v_mov_b32 v228, 0
    v_mov_b32 v229, 0
    v_mov_b32 v230, 0
    v_mov_b32 v231, 0
    v_mov_b32 v232, 0
    v_mov_b32 v233, 0
    v_mov_b32 v234, 0
    v_mov_b32 v235, 0
    v_mov_b32 v236, 0
    v_mov_b32 v237, 0
    v_mov_b32 v238, 0
    v_mov_b32 v239, 0
    v_mov_b32 v240, 0
    v_mov_b32 v241, 0
    v_mov_b32 v242, 0
    v_mov_b32 v243, 0
    v_mov_b32 v244, 0
    v_mov_b32 v245, 0
    v_mov_b32 v246, 0
    v_mov_b32 v247, 0
    v_mov_b32 v248, 0
    v_mov_b32 v249, 0
    v_mov_b32 v250, 0
    v_mov_b32 v251, 0
    v_mov_b32 v252, 0
    v_mov_b32 v253, 0
    v_mov_b32 v254, 0
    v_mov_b32 v255, 0
    v_mov_b32 v28, 0
    v_mov_b32 v40, 4048155338
    v_mov_b32 v32, 0
    v_mov_b32 v41, 4048155338
    s_lshl_b32 s43, s28, 12
    v_add_u32 v4, s43, v7
    s_mov_b32 s46, s45
    s_sub_u32 s40, 16, s30
    s_sub_u32 s39, 15, s30
    s_lshl_b32 s37, s39, 7
    s_and_b32 s36, s28, 3
    s_lshl_b32 s36, s36, 5
    s_add_u32 s36, s36, s37
    s_sub_u32 s50, 0, s36
L_recurrent_scan__compressed_kv_cla__moe_arch_mod__prompt_kernel_stile_95:
    s_waitcnt vmcnt(0) lgkmcnt(0)
    s_barrier
    s_mov_b32 m0, s43
    s_add_u32 s47, s46, 32768
    buffer_load_dwordx4 v4, s[12:15], s46 offen offset:0 sc1 lds
    buffer_load_dwordx4 v4, s[12:15], s46 offen offset:1024 sc1 lds
    buffer_load_dwordx4 v4, s[12:15], s46 offen offset:2048 sc1 lds
    buffer_load_dwordx4 v4, s[12:15], s46 offen offset:3072 sc1 lds
    s_add_u32 m0, s43, 32768
    s_add_u32 s46, s46, 65536
    buffer_load_dwordx4 v4, s[12:15], s47 offen offset:0 sc1 lds
    buffer_load_dwordx4 v4, s[12:15], s47 offen offset:1024 sc1 lds
    buffer_load_dwordx4 v4, s[12:15], s47 offen offset:2048 sc1 lds
    buffer_load_dwordx4 v4, s[12:15], s47 offen offset:3072 sc1 lds
    v_mov_b32 v2, v7
    s_mov_b32 s41, 4
    s_waitcnt vmcnt(0)
    s_barrier
L_recurrent_scan__compressed_kv_cla__moe_arch_mod__prompt_kernel_sunit_96:
    s_cmp_gt_i32 s50, 0
    s_cbranch_scc1 L_recurrent_scan__compressed_kv_cla__moe_arch_mod__prompt_kernel_snext_97
    ds_read_b128 v[64:67], v2 offset:0
    ds_read_b128 v[68:71], v2 offset:1024
    ds_read_b128 v[72:75], v2 offset:2048
    ds_read_b128 v[76:79], v2 offset:3072
    ds_read_b128 v[80:83], v2 offset:4096
    ds_read_b128 v[84:87], v2 offset:5120
    ds_read_b128 v[88:91], v2 offset:6144
    ds_read_b128 v[92:95], v2 offset:7168
    s_waitcnt lgkmcnt(0)
    v_mfma_f32_16x16x32_bf16 v[96:99], v[64:67], v[128:131], 0
    v_mfma_f32_16x16x32_bf16 v[104:107], v[64:67], v[144:147], 0
    v_mfma_f32_16x16x32_bf16 v[96:99], v[68:71], v[132:135], v[96:99]
    v_mfma_f32_16x16x32_bf16 v[104:107], v[68:71], v[148:151], v[104:107]
    v_mfma_f32_16x16x32_bf16 v[96:99], v[72:75], v[136:139], v[96:99]
    v_mfma_f32_16x16x32_bf16 v[104:107], v[72:75], v[152:155], v[104:107]
    v_mfma_f32_16x16x32_bf16 v[96:99], v[76:79], v[140:143], v[96:99]
    v_mfma_f32_16x16x32_bf16 v[104:107], v[76:79], v[156:159], v[104:107]
    v_mfma_f32_16x16x32_bf16 v[100:103], v[80:83], v[128:131], 0
    v_mfma_f32_16x16x32_bf16 v[108:111], v[80:83], v[144:147], 0
    v_mfma_f32_16x16x32_bf16 v[100:103], v[84:87], v[132:135], v[100:103]
    v_mfma_f32_16x16x32_bf16 v[108:111], v[84:87], v[148:151], v[108:111]
    v_mfma_f32_16x16x32_bf16 v[100:103], v[88:91], v[136:139], v[100:103]
    v_mfma_f32_16x16x32_bf16 v[108:111], v[88:91], v[152:155], v[108:111]
    v_mfma_f32_16x16x32_bf16 v[100:103], v[92:95], v[140:143], v[100:103]
    v_mfma_f32_16x16x32_bf16 v[108:111], v[92:95], v[156:159], v[108:111]
    ds_read_b128 v[64:67], v2 offset:32768
    ds_read_b128 v[68:71], v2 offset:33792
    ds_read_b128 v[72:75], v2 offset:34816
    ds_read_b128 v[76:79], v2 offset:35840
    ds_read_b128 v[80:83], v2 offset:36864
    ds_read_b128 v[84:87], v2 offset:37888
    ds_read_b128 v[88:91], v2 offset:38912
    ds_read_b128 v[92:95], v2 offset:39936
    s_nop 1
    s_cmp_lt_i32 s50, 0
    s_cbranch_scc0 L_recurrent_scan__compressed_kv_cla__moe_arch_mod__prompt_kernel_rare_98
L_recurrent_scan__compressed_kv_cla__moe_arch_mod__prompt_kernel_back_99:
    v_max3_f32 v22, v96, v97, v98
    v_max3_f32 v22, v22, v99, v100
    v_max3_f32 v22, v22, v101, v102
    v_max3_f32 v22, v22, v103, v40
    v_mov_b32 v24, v22
    s_nop 1
    v_permlane16_swap_b32 v22, v24
    s_nop 1
    v_max_f32 v22, v22, v24
    v_mov_b32 v24, v22
    s_nop 1
    v_permlane32_swap_b32 v22, v24
    s_nop 1
    v_max_f32 v22, v22, v24
    v_sub_f32 v25, v40, v22
    v_exp_f32 v25, v25
    v_mov_b32 v40, v22
    v_mul_f32 v28, v28, v25
    v_mul_f32 v192, v192, v25
    v_mul_f32 v193, v193, v25
    v_mul_f32 v194, v194, v25
    v_mul_f32 v195, v195, v25
    v_mul_f32 v196, v196, v25
    v_mul_f32 v197, v197, v25
    v_mul_f32 v198, v198, v25
    v_mul_f32 v199, v199, v25
    v_mul_f32 v200, v200, v25
    v_mul_f32 v201, v201, v25
    v_mul_f32 v202, v202, v25
    v_mul_f32 v203, v203, v25
    v_mul_f32 v204, v204, v25
    v_mul_f32 v205, v205, v25
    v_mul_f32 v206, v206, v25
    v_mul_f32 v207, v207, v25
    v_mul_f32 v208, v208, v25
    v_mul_f32 v209, v209, v25
    v_mul_f32 v210, v210, v25
    v_mul_f32 v211, v211, v25
    v_mul_f32 v212, v212, v25
    v_mul_f32 v213, v213, v25
    v_mul_f32 v214, v214, v25
    v_mul_f32 v215, v215, v25
    v_mul_f32 v216, v216, v25
    v_mul_f32 v217, v217, v25
    v_mul_f32 v218, v218, v25
    v_mul_f32 v219, v219, v25
    v_mul_f32 v220, v220, v25
    v_mul_f32 v221, v221, v25
    v_mul_f32 v222, v222, v25
    v_mul_f32 v223, v223, v25
    v_sub_f32 v96, v96, v22
    v_sub_f32 v97, v97, v22
    v_sub_f32 v98, v98, v22
    v_sub_f32 v99, v99, v22
    v_sub_f32 v100, v100, v22
    v_sub_f32 v101, v101, v22
    v_sub_f32 v102, v102, v22
    v_sub_f32 v103, v103, v22
    v_max3_f32 v23, v104, v105, v106
    v_max3_f32 v23, v23, v107, v108
    v_max3_f32 v23, v23, v109, v110
    v_max3_f32 v23, v23, v111, v41
    v_mov_b32 v24, v23
    s_nop 1
    v_permlane16_swap_b32 v23, v24
    s_nop 1
    v_max_f32 v23, v23, v24
    v_mov_b32 v24, v23
    s_nop 1
    v_permlane32_swap_b32 v23, v24
    s_nop 1
    v_max_f32 v23, v23, v24
    v_sub_f32 v25, v41, v23
    v_exp_f32 v25, v25
    v_mov_b32 v41, v23
    v_mul_f32 v32, v32, v25
    v_mul_f32 v224, v224, v25
    v_mul_f32 v225, v225, v25
    v_mul_f32 v226, v226, v25
    v_mul_f32 v227, v227, v25
    v_mul_f32 v228, v228, v25
    v_mul_f32 v229, v229, v25
    v_mul_f32 v230, v230, v25
    v_mul_f32 v231, v231, v25
    v_mul_f32 v232, v232, v25
    v_mul_f32 v233, v233, v25
    v_mul_f32 v234, v234, v25
    v_mul_f32 v235, v235, v25
    v_mul_f32 v236, v236, v25
    v_mul_f32 v237, v237, v25
    v_mul_f32 v238, v238, v25
    v_mul_f32 v239, v239, v25
    v_mul_f32 v240, v240, v25
    v_mul_f32 v241, v241, v25
    v_mul_f32 v242, v242, v25
    v_mul_f32 v243, v243, v25
    v_mul_f32 v244, v244, v25
    v_mul_f32 v245, v245, v25
    v_mul_f32 v246, v246, v25
    v_mul_f32 v247, v247, v25
    v_mul_f32 v248, v248, v25
    v_mul_f32 v249, v249, v25
    v_mul_f32 v250, v250, v25
    v_mul_f32 v251, v251, v25
    v_mul_f32 v252, v252, v25
    v_mul_f32 v253, v253, v25
    v_mul_f32 v254, v254, v25
    v_mul_f32 v255, v255, v25
    v_sub_f32 v104, v104, v23
    v_sub_f32 v105, v105, v23
    v_sub_f32 v106, v106, v23
    v_sub_f32 v107, v107, v23
    v_sub_f32 v108, v108, v23
    v_sub_f32 v109, v109, v23
    v_sub_f32 v110, v110, v23
    v_sub_f32 v111, v111, v23
    v_exp_f32 v96, v96
    v_exp_f32 v97, v97
    v_exp_f32 v98, v98
    v_exp_f32 v99, v99
    v_exp_f32 v104, v104
    v_exp_f32 v105, v105
    v_exp_f32 v106, v106
    v_exp_f32 v107, v107
    v_exp_f32 v100, v100
    v_exp_f32 v101, v101
    v_exp_f32 v102, v102
    v_exp_f32 v103, v103
    v_exp_f32 v108, v108
    v_exp_f32 v109, v109
    v_exp_f32 v110, v110
    v_exp_f32 v111, v111
    v_add_f32 v28, v28, v96
    v_add_f32 v28, v28, v97
    v_cvt_pk_bf16_f32 v48, v96, v97
    v_add_f32 v28, v28, v98
    v_add_f32 v28, v28, v99
    v_cvt_pk_bf16_f32 v49, v98, v99
    v_add_f32 v32, v32, v104
    v_add_f32 v32, v32, v105
    v_cvt_pk_bf16_f32 v52, v104, v105
    v_add_f32 v32, v32, v106
    v_add_f32 v32, v32, v107
    v_cvt_pk_bf16_f32 v53, v106, v107
    v_add_f32 v28, v28, v100
    v_add_f32 v28, v28, v101
    v_cvt_pk_bf16_f32 v50, v100, v101
    v_add_f32 v28, v28, v102
    v_add_f32 v28, v28, v103
    v_cvt_pk_bf16_f32 v51, v102, v103
    v_add_f32 v32, v32, v108
    v_add_f32 v32, v32, v109
    v_cvt_pk_bf16_f32 v54, v108, v109
    v_add_f32 v32, v32, v110
    v_add_f32 v32, v32, v111
    v_cvt_pk_bf16_f32 v55, v110, v111
    s_waitcnt lgkmcnt(0)
    s_nop 0
    v_mfma_f32_16x16x32_bf16 v[192:195], v[64:67], v[48:51], v[192:195]
    v_mfma_f32_16x16x32_bf16 v[224:227], v[64:67], v[52:55], v[224:227]
    v_mfma_f32_16x16x32_bf16 v[196:199], v[68:71], v[48:51], v[196:199]
    v_mfma_f32_16x16x32_bf16 v[228:231], v[68:71], v[52:55], v[228:231]
    v_mfma_f32_16x16x32_bf16 v[200:203], v[72:75], v[48:51], v[200:203]
    v_mfma_f32_16x16x32_bf16 v[232:235], v[72:75], v[52:55], v[232:235]
    v_mfma_f32_16x16x32_bf16 v[204:207], v[76:79], v[48:51], v[204:207]
    v_mfma_f32_16x16x32_bf16 v[236:239], v[76:79], v[52:55], v[236:239]
    v_mfma_f32_16x16x32_bf16 v[208:211], v[80:83], v[48:51], v[208:211]
    v_mfma_f32_16x16x32_bf16 v[240:243], v[80:83], v[52:55], v[240:243]
    v_mfma_f32_16x16x32_bf16 v[212:215], v[84:87], v[48:51], v[212:215]
    v_mfma_f32_16x16x32_bf16 v[244:247], v[84:87], v[52:55], v[244:247]
    v_mfma_f32_16x16x32_bf16 v[216:219], v[88:91], v[48:51], v[216:219]
    v_mfma_f32_16x16x32_bf16 v[248:251], v[88:91], v[52:55], v[248:251]
    v_mfma_f32_16x16x32_bf16 v[220:223], v[92:95], v[48:51], v[220:223]
    v_mfma_f32_16x16x32_bf16 v[252:255], v[92:95], v[52:55], v[252:255]
L_recurrent_scan__compressed_kv_cla__moe_arch_mod__prompt_kernel_snext_97:
    v_add_u32 v2, 8192, v2
    s_add_u32 s50, s50, 32
    s_sub_u32 s41, s41, 1
    s_cmp_lg_u32 s41, 0
    s_cbranch_scc1 L_recurrent_scan__compressed_kv_cla__moe_arch_mod__prompt_kernel_sunit_96
    s_sub_u32 s40, s40, 1
    s_cmp_lg_u32 s40, 0
    s_cbranch_scc1 L_recurrent_scan__compressed_kv_cla__moe_arch_mod__prompt_kernel_stile_95
    v_mov_b32 v20, v28
    s_nop 1
    v_permlane16_swap_b32 v28, v20
    s_nop 1
    v_add_f32 v28, v28, v20
    v_mov_b32 v20, v28
    s_nop 1
    v_permlane32_swap_b32 v28, v20
    s_nop 1
    v_add_f32 v28, v28, v20
    v_mov_b32 v20, v32
    s_nop 1
    v_permlane16_swap_b32 v32, v20
    s_nop 1
    v_add_f32 v32, v32, v20
    v_mov_b32 v20, v32
    s_nop 1
    v_permlane32_swap_b32 v32, v20
    s_nop 1
    v_add_f32 v32, v32, v20
    s_mov_b32 s36, 0x5d800000
    v_cmp_nge_f32 vcc, s36, v28
    s_nop 0
    s_or_b64 s[52:53], s[52:53], vcc
    v_cmp_nge_f32 vcc, s36, v32
    s_nop 0
    s_or_b64 s[52:53], s[52:53], vcc
    v_rcp_f32 v20, v28
    v_rcp_f32 v22, v32
    s_lshl_b32 s38, s39, 3
    s_and_b32 s37, s28, 3
    s_lshl_b32 s37, s37, 1
    s_add_u32 s38, s38, s37
    s_lshl_b32 s38, s38, 17
    s_lshl_b32 s37, s29, 12
    s_add_u32 s38, s38, s37
    v_mov_b32 v21, v20
    v_mov_b32 v23, v22
    v_mov_b32 v24, v7
    v_pk_mul_f32 v[192:193], v[192:193], v[20:21]
    v_pk_mul_f32 v[194:195], v[194:195], v[20:21]
    v_pk_mul_f32 v[196:197], v[196:197], v[20:21]
    v_pk_mul_f32 v[198:199], v[198:199], v[20:21]
    v_cvt_pk_bf16_f32 v192, v192, v193
    v_cvt_pk_bf16_f32 v193, v194, v195
    v_cvt_pk_bf16_f32 v194, v196, v197
    v_cvt_pk_bf16_f32 v195, v198, v199
    buffer_store_dwordx4 v[192:195], v24, s[16:19], s38 offen offset:0 sc1
    v_pk_mul_f32 v[200:201], v[200:201], v[20:21]
    v_pk_mul_f32 v[202:203], v[202:203], v[20:21]
    v_pk_mul_f32 v[204:205], v[204:205], v[20:21]
    v_pk_mul_f32 v[206:207], v[206:207], v[20:21]
    v_cvt_pk_bf16_f32 v200, v200, v201
    v_cvt_pk_bf16_f32 v201, v202, v203
    v_cvt_pk_bf16_f32 v202, v204, v205
    v_cvt_pk_bf16_f32 v203, v206, v207
    buffer_store_dwordx4 v[200:203], v24, s[16:19], s38 offen offset:1024 sc1
    v_pk_mul_f32 v[208:209], v[208:209], v[20:21]
    v_pk_mul_f32 v[210:211], v[210:211], v[20:21]
    v_pk_mul_f32 v[212:213], v[212:213], v[20:21]
    v_pk_mul_f32 v[214:215], v[214:215], v[20:21]
    v_cvt_pk_bf16_f32 v208, v208, v209
    v_cvt_pk_bf16_f32 v209, v210, v211
    v_cvt_pk_bf16_f32 v210, v212, v213
    v_cvt_pk_bf16_f32 v211, v214, v215
    buffer_store_dwordx4 v[208:211], v24, s[16:19], s38 offen offset:2048 sc1
    v_pk_mul_f32 v[216:217], v[216:217], v[20:21]
    v_pk_mul_f32 v[218:219], v[218:219], v[20:21]
    v_pk_mul_f32 v[220:221], v[220:221], v[20:21]
    v_pk_mul_f32 v[222:223], v[222:223], v[20:21]
    v_cvt_pk_bf16_f32 v216, v216, v217
    v_cvt_pk_bf16_f32 v217, v218, v219
    v_cvt_pk_bf16_f32 v218, v220, v221
    v_cvt_pk_bf16_f32 v219, v222, v223
    buffer_store_dwordx4 v[216:219], v24, s[16:19], s38 offen offset:3072 sc1
    s_add_u32 s38, s38, 131072
    v_pk_mul_f32 v[224:225], v[224:225], v[22:23]
    v_pk_mul_f32 v[226:227], v[226:227], v[22:23]
    v_pk_mul_f32 v[228:229], v[228:229], v[22:23]
    v_pk_mul_f32 v[230:231], v[230:231], v[22:23]
    v_cvt_pk_bf16_f32 v224, v224, v225
    v_cvt_pk_bf16_f32 v225, v226, v227
    v_cvt_pk_bf16_f32 v226, v228, v229
    v_cvt_pk_bf16_f32 v227, v230, v231
    buffer_store_dwordx4 v[224:227], v24, s[16:19], s38 offen offset:0 sc1
    v_pk_mul_f32 v[232:233], v[232:233], v[22:23]
    v_pk_mul_f32 v[234:235], v[234:235], v[22:23]
    v_pk_mul_f32 v[236:237], v[236:237], v[22:23]
    v_pk_mul_f32 v[238:239], v[238:239], v[22:23]
    v_cvt_pk_bf16_f32 v232, v232, v233
    v_cvt_pk_bf16_f32 v233, v234, v235
    v_cvt_pk_bf16_f32 v234, v236, v237
    v_cvt_pk_bf16_f32 v235, v238, v239
    buffer_store_dwordx4 v[232:235], v24, s[16:19], s38 offen offset:1024 sc1
    v_pk_mul_f32 v[240:241], v[240:241], v[22:23]
    v_pk_mul_f32 v[242:243], v[242:243], v[22:23]
    v_pk_mul_f32 v[244:245], v[244:245], v[22:23]
    v_pk_mul_f32 v[246:247], v[246:247], v[22:23]
    v_cvt_pk_bf16_f32 v240, v240, v241
    v_cvt_pk_bf16_f32 v241, v242, v243
    v_cvt_pk_bf16_f32 v242, v244, v245
    v_cvt_pk_bf16_f32 v243, v246, v247
    buffer_store_dwordx4 v[240:243], v24, s[16:19], s38 offen offset:2048 sc1
    v_pk_mul_f32 v[248:249], v[248:249], v[22:23]
    v_pk_mul_f32 v[250:251], v[250:251], v[22:23]
    v_pk_mul_f32 v[252:253], v[252:253], v[22:23]
    v_pk_mul_f32 v[254:255], v[254:255], v[22:23]
    v_cvt_pk_bf16_f32 v248, v248, v249
    v_cvt_pk_bf16_f32 v249, v250, v251
    v_cvt_pk_bf16_f32 v250, v252, v253
    v_cvt_pk_bf16_f32 v251, v254, v255
    buffer_store_dwordx4 v[248:251], v24, s[16:19], s38 offen offset:3072 sc1
    v_mov_b32 v96, v112
    v_mov_b32 v97, v113
    v_mov_b32 v98, v114
    v_mov_b32 v99, v115
    v_mov_b32 v100, v116
    v_mov_b32 v101, v117
    v_mov_b32 v102, v118
    v_mov_b32 v103, v119
    s_branch L_p3_done
L_recurrent_scan__compressed_kv_cla__moe_arch_mod__prompt_kernel_rare_1:
    s_mul_i32 s36, s28, 12288
    s_add_u32 s36, s36, 61865984
    v_lshl_add_u32 v16, v1, 4, s36
    v_mov_b32 v108, 0
    v_mov_b32 v109, 0
    v_mov_b32 v110, 0
    v_mov_b32 v111, 0
    global_store_dwordx4 v16, v[108:111], s[90:91] sc1
    v_add_u32 v16, 1024, v16
    global_store_dwordx4 v16, v[108:111], s[90:91] sc1
    v_add_u32 v16, 1024, v16
    global_store_dwordx4 v16, v[108:111], s[90:91] sc1
    v_add_u32 v16, 1024, v16
    global_store_dwordx4 v16, v[108:111], s[90:91] sc1
    v_add_u32 v16, 1024, v16
    global_store_dwordx4 v16, v[108:111], s[90:91] sc1
    v_add_u32 v16, 1024, v16
    global_store_dwordx4 v16, v[108:111], s[90:91] sc1
    v_add_u32 v16, 1024, v16
    global_store_dwordx4 v16, v[108:111], s[90:91] sc1
    v_add_u32 v16, 1024, v16
    global_store_dwordx4 v16, v[108:111], s[90:91] sc1
    v_add_u32 v16, 1024, v16
    global_store_dwordx4 v16, v[108:111], s[90:91] sc1
    v_add_u32 v16, 1024, v16
    global_store_dwordx4 v16, v[108:111], s[90:91] sc1
    v_add_u32 v16, 1024, v16
    global_store_dwordx4 v16, v[108:111], s[90:91] sc1
    v_add_u32 v16, 1024, v16
    global_store_dwordx4 v16, v[108:111], s[90:91] sc1
    v_add_u32 v16, 1024, v16
    s_branch L_recurrent_scan__compressed_kv_cla__moe_arch_mod__prompt_kernel_back_2
L_recurrent_scan__compressed_kv_cla__moe_arch_mod__prompt_kernel_rare_3:
    v_mov_b32 v19, 1
    s_mov_b64 exec, 1
    global_store_dword v118, v19, s[88:89] sc1
    s_mov_b64 exec, -1
    s_branch L_recurrent_scan__compressed_kv_cla__moe_arch_mod__prompt_kernel_back_4
L_recurrent_scan__compressed_kv_cla__moe_arch_mod__prompt_kernel_rare_5:
    v_lshrrev_b32 v3, 4, v1
    s_lshl_b32 s37, s28, 4
    v_add_u32 v19, s37, v3
    v_lshlrev_b32 v19, 13, v19
    s_lshl_b32 s37, s29, 8
    v_add_u32 v19, s37, v19
    v_and_b32 v16, 15, v1
    v_lshlrev_b32 v3, 1, v3
    v_xor_b32 v16, v16, v3
    v_lshl_add_u32 v2, v16, 4, v19
    v_add_u32 v3, 31744, v2
    v_xor_b32 v16, 8, v16
    v_lshl_add_u32 v4, v16, 4, v19
    v_add_u32 v4, 63488, v4
    v_add_u32 v5, 31744, v4
    s_mov_b32 s4, s96
    s_and_b32 s5, s97, 0xffff
    s_mov_b32 s6, 8388608
    s_mov_b32 s7, 0x20000
    s_mov_b32 s31, 0
    s_mov_b32 s40, 1048576
    s_mov_b64 s[8:9], s[4:5]
    s_mov_b32 s10, s6
    s_mov_b32 s32, 2097152
    v_mov_b32 v6, v2
    v_mov_b32 v7, v3
    v_mov_b32 v8, v4
    v_mov_b32 v9, v5
    s_branch L_recurrent_scan__compressed_kv_cla__moe_arch_mod__prompt_kernel_back_6
L_recurrent_scan__compressed_kv_cla__moe_arch_mod__prompt_kernel_w0_7:
    s_cmp_eq_u32 s35, 0
    s_cbranch_scc0 L_recurrent_scan__compressed_kv_cla__moe_arch_mod__prompt_kernel_swn_10
    v_and_b32 v16, 7, v1
    v_lshrrev_b32 v18, 3, v1
    v_mul_u32_u24 v19, 2064, v16
    v_lshl_add_u32 v19, v18, 4, v19
    s_lshl_b32 s36, s28, 8
    s_add_u32 s36, s36, 131072
    v_add_u32 v19, s36, v19
    ds_read_b128 v[120:123], v19
    ds_read_b128 v[124:127], v19 offset:128
    v_lshlrev_b32 v16, 4, v16
    v_lshl_add_u32 v16, v18, 8, v16
    s_lshr_b32 s36, s2, 1
    s_lshl_b32 s36, s36, 15
    s_and_b32 s37, s2, 1
    s_lshl_b32 s37, s37, 7
    s_add_u32 s36, s36, s37
    s_lshl_b32 s37, s28, 12
    s_add_u32 s36, s36, s37
    s_waitcnt lgkmcnt(0)
    buffer_store_dwordx4 v[120:123], v16, s[24:27], s36 offen sc1
    buffer_store_dwordx4 v[124:127], v16, s[24:27], s36 offen offset:2048 sc1
    s_waitcnt vmcnt(2)
    s_branch L_recurrent_scan__compressed_kv_cla__moe_arch_mod__prompt_kernel_swend_9
L_recurrent_scan__compressed_kv_cla__moe_arch_mod__prompt_kernel_swn_10:
    s_waitcnt vmcnt(2)
L_recurrent_scan__compressed_kv_cla__moe_arch_mod__prompt_kernel_swend_9:
    s_branch L_recurrent_scan__compressed_kv_cla__moe_arch_mod__prompt_kernel_w0b_8
L_recurrent_scan__compressed_kv_cla__moe_arch_mod__prompt_kernel_rare_13:
    s_cmp_eq_u32 s35, 0
    s_cbranch_scc0 L_recurrent_scan__compressed_kv_cla__moe_arch_mod__prompt_kernel_swn_12
    global_load_dword v116, v118, s[88:89] sc1
    s_branch L_recurrent_scan__compressed_kv_cla__moe_arch_mod__prompt_kernel_swend_11
L_recurrent_scan__compressed_kv_cla__moe_arch_mod__prompt_kernel_swn_12:
    v_and_b32 v117, 15, v1
    v_add_u32 v117, 112, v117
    v_lshlrev_b32 v117, 7, v117
    global_load_dword v116, v117, s[90:91] sc1
L_recurrent_scan__compressed_kv_cla__moe_arch_mod__prompt_kernel_swend_11:
    s_branch L_recurrent_scan__compressed_kv_cla__moe_arch_mod__prompt_kernel_back_14
L_recurrent_scan__compressed_kv_cla__moe_arch_mod__prompt_kernel_rare_19:
    s_mov_b32 s61, 0x40000
L_recurrent_scan__compressed_kv_cla__moe_arch_mod__prompt_kernel_spin_17:
    s_sub_u32 s61, s61, 1
    s_cbranch_scc1 L_recurrent_scan__compressed_kv_cla__moe_arch_mod__prompt_kernel_spinx_18
    s_sleep 8
    global_load_dword v116, v118, s[88:89] sc1
    s_waitcnt vmcnt(0)
    v_readfirstlane_b32 s36, v116
    s_nop 0
    s_cmp_lt_u32 s36, 1
    s_cbranch_scc1 L_recurrent_scan__compressed_kv_cla__moe_arch_mod__prompt_kernel_spin_17
L_recurrent_scan__compressed_kv_cla__moe_arch_mod__prompt_kernel_spinx_18:
    s_branch L_recurrent_scan__compressed_kv_cla__moe_arch_mod__prompt_kernel_back_20
L_recurrent_scan__compressed_kv_cla__moe_arch_mod__prompt_kernel_w0_15:
    s_waitcnt vmcnt(0)
    s_cmp_eq_u32 s35, 0
    s_cbranch_scc0 L_recurrent_scan__compressed_kv_cla__moe_arch_mod__prompt_kernel_swn_24
    v_readfirstlane_b32 s36, v116
    s_nop 0
    s_cmp_lt_u32 s36, 1
    s_cbranch_scc1 L_recurrent_scan__compressed_kv_cla__moe_arch_mod__prompt_kernel_rare_19
L_recurrent_scan__compressed_kv_cla__moe_arch_mod__prompt_kernel_back_20:
    s_branch L_recurrent_scan__compressed_kv_cla__moe_arch_mod__prompt_kernel_swend_23
L_recurrent_scan__compressed_kv_cla__moe_arch_mod__prompt_kernel_swn_24:
    s_mov_b32 s61, 0x40000
L_recurrent_scan__compressed_kv_cla__moe_arch_mod__prompt_kernel_lspin_21:
    v_cmp_gt_u32 vcc, 16, v116
    s_nop 0
    s_cmp_eq_u64 vcc, 0
    s_cbranch_scc1 L_recurrent_scan__compressed_kv_cla__moe_arch_mod__prompt_kernel_lspinx_22
    s_sub_u32 s61, s61, 1
    s_cbranch_scc1 L_recurrent_scan__compressed_kv_cla__moe_arch_mod__prompt_kernel_lspinx_22
    s_sleep 8
    global_load_dword v116, v117, s[90:91] sc1
    s_waitcnt vmcnt(0)
    s_branch L_recurrent_scan__compressed_kv_cla__moe_arch_mod__prompt_kernel_lspin_21
L_recurrent_scan__compressed_kv_cla__moe_arch_mod__prompt_kernel_lspinx_22:
L_recurrent_scan__compressed_kv_cla__moe_arch_mod__prompt_kernel_swend_23:
    s_branch L_recurrent_scan__compressed_kv_cla__moe_arch_mod__prompt_kernel_w0b_16
L_recurrent_scan__compressed_kv_cla__moe_arch_mod__prompt_kernel_rare_25:
    s_lshr_b32 s36, s2, 4
    s_add_u32 s36, s36, 112
    s_lshl_b32 s36, s36, 7
    v_mov_b32 v16, s36
    v_mov_b32 v19, 1
    s_mov_b64 exec, 1
    global_atomic_add v16, v19, s[90:91]
    s_mov_b64 exec, -1
    s_nop 3
    s_branch L_recurrent_scan__compressed_kv_cla__moe_arch_mod__prompt_kernel_back_26
L_recurrent_scan__compressed_kv_cla__moe_arch_mod__prompt_kernel_w0_27:
    s_cmp_eq_u32 s35, 0
    s_cbranch_scc0 L_recurrent_scan__compressed_kv_cla__moe_arch_mod__prompt_kernel_swn_30
    s_waitcnt vmcnt(2)
    s_branch L_recurrent_scan__compressed_kv_cla__moe_arch_mod__prompt_kernel_swend_29
L_recurrent_scan__compressed_kv_cla__moe_arch_mod__prompt_kernel_swn_30:
    s_waitcnt vmcnt(2)
L_recurrent_scan__compressed_kv_cla__moe_arch_mod__prompt_kernel_swend_29:
    s_branch L_recurrent_scan__compressed_kv_cla__moe_arch_mod__prompt_kernel_w0b_28
L_recurrent_scan__compressed_kv_cla__moe_arch_mod__prompt_kernel_rare_32:
    v_and_b32 v16, 7, v1
    v_lshrrev_b32 v18, 3, v1
    v_mul_u32_u24 v19, 2064, v16
    v_lshl_add_u32 v19, v18, 4, v19
    s_lshl_b32 s36, s28, 8
    s_add_u32 s36, s36, 131072
    v_add_u32 v19, s36, v19
    ds_read_b128 v[120:123], v19
    ds_read_b128 v[124:127], v19 offset:128
    v_lshlrev_b32 v16, 4, v16
    v_lshl_add_u32 v16, v18, 8, v16
    s_lshr_b32 s36, s2, 1
    s_lshl_b32 s36, s36, 15
    s_and_b32 s37, s2, 1
    s_lshl_b32 s37, s37, 7
    s_add_u32 s36, s36, s37
    s_lshl_b32 s37, s28, 12
    s_add_u32 s36, s36, s37
    s_waitcnt lgkmcnt(0)
    buffer_store_dwordx4 v[120:123], v16, s[24:27], s36 offen sc1
    buffer_store_dwordx4 v[124:127], v16, s[24:27], s36 offen offset:2048 sc1
    s_cmp_eq_u32 s28, 7
    s_cbranch_scc0 L_recurrent_scan__compressed_kv_cla__moe_arch_mod__prompt_kernel_l7_31
    v_and_b32 v120, 7, v1
    v_lshlrev_b32 v120, 3, v120
    v_add_u32 v121, 147712, v120
    ds_read_b64 v[122:123], v121
    ds_read_b32 v124, v121 offset:64
    s_lshl_b32 s36, s2, 6
    s_add_u32 s36, s36, 4194304
    s_lshl_b32 s37, s2, 3
    s_add_u32 s37, s37, 4276224
    s_waitcnt lgkmcnt(0)
    v_mov_b32 v126, v124
    s_nop 1
    v_max_u32_dpp v126, v126, v126 quad_perm:[1,0,3,2] row_mask:0xf bank_mask:0xf
    s_nop 1
    v_max_u32_dpp v126, v126, v126 quad_perm:[2,3,0,1] row_mask:0xf bank_mask:0xf
    s_nop 1
    v_max_u32_dpp v126, v126, v126 row_half_mirror row_mask:0xf bank_mask:0xf
    v_cmp_eq_u32 vcc, v126, v124
    s_nop 1
    v_cndmask_b32 v127, v124, v118, vcc
    s_nop 1
    v_max_u32_dpp v127, v127, v127 quad_perm:[1,0,3,2] row_mask:0xf bank_mask:0xf
    s_nop 1
    v_max_u32_dpp v127, v127, v127 quad_perm:[2,3,0,1] row_mask:0xf bank_mask:0xf
    s_nop 1
    v_max_u32_dpp v127, v127, v127 row_half_mirror row_mask:0xf bank_mask:0xf
    s_mov_b64 exec, 0xff
    buffer_store_dwordx2 v[122:123], v120, s[24:27], s36 offen sc1
    s_mov_b64 exec, 1
    buffer_store_dwordx2 v[126:127], v120, s[24:27], s37 offen sc1
    s_mov_b64 exec, -1
    s_nop 3
L_recurrent_scan__compressed_kv_cla__moe_arch_mod__prompt_kernel_l7_31:
    s_branch L_recurrent_scan__compressed_kv_cla__moe_arch_mod__prompt_kernel_back_33
L_recurrent_scan__compressed_kv_cla__moe_arch_mod__prompt_kernel_rare_36:
    v_lshrrev_b32 v3, 4, v1
    s_lshl_b32 s37, s28, 4
    v_add_u32 v19, s37, v3
    v_lshlrev_b32 v19, 13, v19
    s_lshl_b32 s37, s29, 8
    v_add_u32 v19, s37, v19
    v_and_b32 v16, 15, v1
    v_lshlrev_b32 v3, 1, v3
    v_xor_b32 v16, v16, v3
    v_lshl_add_u32 v2, v16, 4, v19
    v_add_u32 v3, 31744, v2
    v_xor_b32 v16, 8, v16
    v_lshl_add_u32 v4, v16, 4, v19
    v_add_u32 v4, 63488, v4
    v_add_u32 v5, 31744, v4
    s_mov_b32 s4, s96
    s_and_b32 s5, s97, 0xffff
    s_mov_b32 s6, 8388608
    s_mov_b32 s7, 0x20000
    s_mov_b32 s31, 0
    s_mov_b32 s40, 1048576
    s_mov_b64 s[8:9], s[4:5]
    s_mov_b32 s10, s6
    s_mov_b32 s32, 2097152
    v_mov_b32 v6, v2
    v_mov_b32 v7, v3
    v_mov_b32 v8, v4
    v_mov_b32 v9, v5
    s_branch L_recurrent_scan__compressed_kv_cla__moe_arch_mod__prompt_kernel_back_37
L_recurrent_scan__compressed_kv_cla__moe_arch_mod__prompt_kernel_rare_42:
    s_mov_b32 s61, 0x40000
L_recurrent_scan__compressed_kv_cla__moe_arch_mod__prompt_kernel_spin_40:
    s_sub_u32 s61, s61, 1
    s_cbranch_scc1 L_recurrent_scan__compressed_kv_cla__moe_arch_mod__prompt_kernel_spinx_41
    s_sleep 8
    global_load_dword v56, v57, s[90:91] sc1
    s_waitcnt vmcnt(0)
    v_readfirstlane_b32 s36, v56
    s_nop 0
    s_cmp_lt_u32 s36, 1
    s_cbranch_scc1 L_recurrent_scan__compressed_kv_cla__moe_arch_mod__prompt_kernel_spin_40
L_recurrent_scan__compressed_kv_cla__moe_arch_mod__prompt_kernel_spinx_41:
    s_branch L_recurrent_scan__compressed_kv_cla__moe_arch_mod__prompt_kernel_back_43
L_recurrent_scan__compressed_kv_cla__moe_arch_mod__prompt_kernel_rare_45:
    s_cmp_eq_u32 s28, 0
    s_cbranch_scc0 L_recurrent_scan__compressed_kv_cla__moe_arch_mod__prompt_kernel_g_44
    s_waitcnt vmcnt(13)
    v_readfirstlane_b32 s36, v56
    s_nop 0
    s_cmp_lt_u32 s36, 1
    s_cbranch_scc1 L_recurrent_scan__compressed_kv_cla__moe_arch_mod__prompt_kernel_rare_42
L_recurrent_scan__compressed_kv_cla__moe_arch_mod__prompt_kernel_back_43:
L_recurrent_scan__compressed_kv_cla__moe_arch_mod__prompt_kernel_g_44:
    s_branch L_recurrent_scan__compressed_kv_cla__moe_arch_mod__prompt_kernel_back_46
L_recurrent_scan__compressed_kv_cla__moe_arch_mod__prompt_kernel_rare_47:
    s_cmp_eq_u32 s28, 0
    s_cbranch_scc0 L_recurrent_scan__compressed_kv_cla__moe_arch_mod__prompt_kernel_g_39
    s_add_u32 s36, s29, 64
    s_lshl_b32 s36, s36, 7
    v_mov_b32 v57, s36
    global_load_dword v56, v57, s[90:91] sc1
L_recurrent_scan__compressed_kv_cla__moe_arch_mod__prompt_kernel_g_39:
    s_branch L_recurrent_scan__compressed_kv_cla__moe_arch_mod__prompt_kernel_back_48
L_recurrent_scan__compressed_kv_cla__moe_arch_mod__prompt_kernel_rare_51:
    s_cmp_eq_u32 s35, 2
    s_cbranch_scc0 L_recurrent_scan__compressed_kv_cla__moe_arch_mod__prompt_kernel_swn_50
    s_mov_b32 s6, 0
    s_mov_b32 s34, 0x30000
    s_mov_b32 s41, 0x37fff
    s_lshl_b32 s36, s30, 3
    s_add_u32 s36, s28, s36
    s_cmp_eq_u32 s36, 4
    s_cbranch_scc0 L_recurrent_scan__compressed_kv_cla__moe_arch_mod__prompt_kernel_g_38
    s_add_u32 s36, s29, 64
    s_lshl_b32 s36, s36, 7
    v_mov_b32 v62, s36
    v_mov_b32 v63, 1
    s_mov_b64 exec, 1
    global_atomic_add v62, v63, s[90:91]
    s_mov_b64 exec, -1
    s_nop 3
L_recurrent_scan__compressed_kv_cla__moe_arch_mod__prompt_kernel_g_38:
    s_branch L_recurrent_scan__compressed_kv_cla__moe_arch_mod__prompt_kernel_swend_49
L_recurrent_scan__compressed_kv_cla__moe_arch_mod__prompt_kernel_swn_50:
    s_mov_b64 s[4:5], s[12:13]
    s_mov_b32 s6, s14
    s_mov_b32 s31, s45
    s_mov_b32 s40, 32768
    s_mov_b32 s34, s33
    v_add_u32 v2, s33, v58
    v_mov_b32 v3, v2
    v_mov_b32 v4, v2
    v_mov_b32 v5, v2
L_recurrent_scan__compressed_kv_cla__moe_arch_mod__prompt_kernel_swend_49:
    s_branch L_recurrent_scan__compressed_kv_cla__moe_arch_mod__prompt_kernel_back_52
L_recurrent_scan__compressed_kv_cla__moe_arch_mod__prompt_kernel_rare_53:
    s_branch L_recurrent_scan__compressed_kv_cla__moe_arch_mod__prompt_kernel_back_54
L_recurrent_scan__compressed_kv_cla__moe_arch_mod__prompt_kernel_rare_55:
    s_lshl_b32 s36, s39, 1
    s_add_u32 s36, s36, s38
    s_add_u32 s37, s36, s39
    buffer_store_dwordx4 v[160:163], v58, s[16:19], s36 offen sc1
    buffer_store_dwordx4 v[164:167], v59, s[16:19], s36 offen sc1
    buffer_store_dwordx4 v[168:171], v60, s[16:19], s36 offen sc1
    buffer_store_dwordx4 v[172:175], v61, s[16:19], s36 offen sc1
    buffer_store_dwordx4 v[176:179], v58, s[16:19], s37 offen sc1
    buffer_store_dwordx4 v[180:183], v59, s[16:19], s37 offen sc1
    buffer_store_dwordx4 v[184:187], v60, s[16:19], s37 offen sc1
    buffer_store_dwordx4 v[188:191], v61, s[16:19], s37 offen sc1
    s_branch L_recurrent_scan__compressed_kv_cla__moe_arch_mod__prompt_kernel_back_56
L_recurrent_scan__compressed_kv_cla__moe_arch_mod__prompt_kernel_rare_57:
    s_lshl_b32 s36, s29, 7
    v_mov_b32 v13, s36
    global_load_dword v14, v13, s[90:91] sc1
    s_branch L_recurrent_scan__compressed_kv_cla__moe_arch_mod__prompt_kernel_back_58
L_recurrent_scan__compressed_kv_cla__moe_arch_mod__prompt_kernel_rare_63:
    s_mov_b32 s41, 32768
    s_cmp_eq_u32 s40, 15
    s_cbranch_scc0 L_recurrent_scan__compressed_kv_cla__moe_arch_mod__prompt_kernel_r_59
    s_mov_b32 s41, 65536
    s_mov_b32 s49, 0x1ffff
    s_sub_u32 s36, 0, s50
    s_cmp_lt_i32 s36, 0
    s_cbranch_scc1 L_recurrent_scan__compressed_kv_cla__moe_arch_mod__prompt_kernel_nm_62
    v_mov_b32 v20, 4048155338
    v_subrev_u32 v21, s36, v18
    v_cmp_gt_i32 s[20:21], 0, v21
    v_cmp_gt_i32 s[22:23], 1, v21
    v_cmp_gt_i32 s[62:63], 2, v21
    v_cmp_gt_i32 vcc, 3, v21
    v_cndmask_b32 v96, v96, v20, s[20:21]
    v_cndmask_b32 v97, v97, v20, s[22:23]
    v_cndmask_b32 v98, v98, v20, s[62:63]
    v_cndmask_b32 v99, v99, v20, vcc
    v_cmp_gt_i32 s[20:21], 16, v21
    v_cmp_gt_i32 s[22:23], 17, v21
    v_cmp_gt_i32 s[62:63], 18, v21
    v_cmp_gt_i32 vcc, 19, v21
    v_cndmask_b32 v100, v100, v20, s[20:21]
    v_cndmask_b32 v101, v101, v20, s[22:23]
    v_cndmask_b32 v102, v102, v20, s[62:63]
    v_cndmask_b32 v103, v103, v20, vcc
    v_cmp_gt_i32 s[20:21], -16, v21
    v_cmp_gt_i32 s[22:23], -15, v21
    v_cmp_gt_i32 s[62:63], -14, v21
    v_cmp_gt_i32 vcc, -13, v21
    v_cndmask_b32 v104, v104, v20, s[20:21]
    v_cndmask_b32 v105, v105, v20, s[22:23]
    v_cndmask_b32 v106, v106, v20, s[62:63]
    v_cndmask_b32 v107, v107, v20, vcc
    v_cmp_gt_i32 s[20:21], 0, v21
    v_cmp_gt_i32 s[22:23], 1, v21
    v_cmp_gt_i32 s[62:63], 2, v21
    v_cmp_gt_i32 vcc, 3, v21
    v_cndmask_b32 v108, v108, v20, s[20:21]
    v_cndmask_b32 v109, v109, v20, s[22:23]
    v_cndmask_b32 v110, v110, v20, s[62:63]
    v_cndmask_b32 v111, v111, v20, vcc
L_recurrent_scan__compressed_kv_cla__moe_arch_mod__prompt_kernel_nm_62:
L_recurrent_scan__compressed_kv_cla__moe_arch_mod__prompt_kernel_r_59:
    s_branch L_recurrent_scan__compressed_kv_cla__moe_arch_mod__prompt_kernel_back_64
L_recurrent_scan__compressed_kv_cla__moe_arch_mod__prompt_kernel_rare_73:
    s_mov_b32 s61, 0x40000
L_recurrent_scan__compressed_kv_cla__moe_arch_mod__prompt_kernel_spin_71:
    s_sub_u32 s61, s61, 1
    s_cbranch_scc1 L_recurrent_scan__compressed_kv_cla__moe_arch_mod__prompt_kernel_spinx_72
    s_sleep 8
    global_load_dword v14, v13, s[90:91] sc1
    s_waitcnt vmcnt(0)
    v_readfirstlane_b32 s36, v14
    s_nop 0
    s_cmp_lt_u32 s36, 7
    s_cbranch_scc1 L_recurrent_scan__compressed_kv_cla__moe_arch_mod__prompt_kernel_spin_71
L_recurrent_scan__compressed_kv_cla__moe_arch_mod__prompt_kernel_spinx_72:
    s_branch L_recurrent_scan__compressed_kv_cla__moe_arch_mod__prompt_kernel_back_74
L_recurrent_scan__compressed_kv_cla__moe_arch_mod__prompt_kernel_rare_79:
    s_cmp_eq_u32 s40, 1
    s_cbranch_scc0 L_recurrent_scan__compressed_kv_cla__moe_arch_mod__prompt_kernel_swn_76
    v_readfirstlane_b32 s36, v14
    s_nop 0
    s_cmp_lt_u32 s36, 7
    s_cbranch_scc1 L_recurrent_scan__compressed_kv_cla__moe_arch_mod__prompt_kernel_rare_73
L_recurrent_scan__compressed_kv_cla__moe_arch_mod__prompt_kernel_back_74:
    s_branch L_recurrent_scan__compressed_kv_cla__moe_arch_mod__prompt_kernel_swend_75
L_recurrent_scan__compressed_kv_cla__moe_arch_mod__prompt_kernel_swn_76:
    s_cmp_eq_u32 s40, 2
    s_cbranch_scc0 L_recurrent_scan__compressed_kv_cla__moe_arch_mod__prompt_kernel_swn_77
    s_mov_b32 s36, 4276224
    buffer_load_dwordx4 v[160:163], v7, s[24:27], s36 offen offset:0 sc1
    buffer_load_dwordx4 v[164:167], v7, s[24:27], s36 offen offset:1024 sc1
    s_branch L_recurrent_scan__compressed_kv_cla__moe_arch_mod__prompt_kernel_swend_75
L_recurrent_scan__compressed_kv_cla__moe_arch_mod__prompt_kernel_swn_77:
    s_cmp_eq_u32 s40, 3
    s_cbranch_scc0 L_recurrent_scan__compressed_kv_cla__moe_arch_mod__prompt_kernel_swn_78
    v_max_u32 v24, v160, v161
    v_min_u32 v25, v160, v161
    v_med3_u32 v25, v24, v25, v162
    v_max_u32 v24, v24, v162
    v_med3_u32 v25, v24, v25, v163
    v_max_u32 v24, v24, v163
    v_med3_u32 v25, v24, v25, v164
    v_max_u32 v24, v24, v164
    v_med3_u32 v25, v24, v25, v165
    v_max_u32 v24, v24, v165
    v_med3_u32 v25, v24, v25, v166
    v_max_u32 v24, v24, v166
    v_med3_u32 v25, v24, v25, v167
    v_max_u32 v24, v24, v167
    v_mov_b32 v26, v24
    s_nop 1
    v_max_u32_dpp v26, v26, v26 quad_perm:[1,0,3,2] row_mask:0xf bank_mask:0xf
    s_nop 1
    v_max_u32_dpp v26, v26, v26 quad_perm:[2,3,0,1] row_mask:0xf bank_mask:0xf
    s_nop 1
    v_max_u32_dpp v26, v26, v26 row_half_mirror row_mask:0xf bank_mask:0xf
    s_nop 1
    v_max_u32_dpp v26, v26, v26 row_mirror row_mask:0xf bank_mask:0xf
    s_nop 0
    v_readlane_b32 s20, v26, 0
    v_readlane_b32 s21, v26, 16
    v_readlane_b32 s22, v26, 32
    v_readlane_b32 s23, v26, 48
    s_max_u32 s20, s20, s21
    s_max_u32 s22, s22, s23
    s_max_u32 s20, s20, s22
    s_mov_b32 s58, s20
    v_cmp_eq_u32 vcc, s58, v24
    s_nop 1
    v_cndmask_b32 v26, v24, v25, vcc
    s_nop 1
    v_max_u32_dpp v26, v26, v26 quad_perm:[1,0,3,2] row_mask:0xf bank_mask:0xf
    s_nop 1
    v_max_u32_dpp v26, v26, v26 quad_perm:[2,3,0,1] row_mask:0xf bank_mask:0xf
    s_nop 1
    v_max_u32_dpp v26, v26, v26 row_half_mirror row_mask:0xf bank_mask:0xf
    s_nop 1
    v_max_u32_dpp v26, v26, v26 row_mirror row_mask:0xf bank_mask:0xf
    s_nop 0
    v_readlane_b32 s20, v26, 0
    v_readlane_b32 s21, v26, 16
    v_readlane_b32 s22, v26, 32
    v_readlane_b32 s23, v26, 48
    s_max_u32 s20, s20, s21
    s_max_u32 s22, s22, s23
    s_max_u32 s20, s20, s22
    s_mov_b32 s59, s20
    s_and_b32 s36, s58, 0xffff
    s_sub_u32 s56, 0xffff, s36
    s_and_b32 s36, s59, 0xffff
    s_sub_u32 s57, 0xffff, s36
    v_and_b32 v24, 1, v1
    v_mov_b32 v25, s56
    v_mov_b32 v26, s57
    v_cmp_eq_u32 vcc, 1, v24
    s_nop 1
    v_cndmask_b32 v25, v25, v26, vcc
    v_lshrrev_b32 v26, 4, v25
    v_lshlrev_b32 v26, 15, v26
    v_and_b32 v25, 15, v25
    v_lshl_add_u32 v26, v25, 4, v26
    v_lshrrev_b32 v27, 4, v1
    v_lshl_add_u32 v26, v27, 8, v26
    s_and_b32 s36, s3, 3
    s_lshl_b32 s36, s36, 13
    s_add_u32 s37, s36, 4096
    s_mov_b32 exec_lo, 0x00030003
    s_mov_b32 exec_hi, 0x00030003
    buffer_load_dwordx4 v[160:163], v26, s[24:27], s36 offen offset:0 sc1
    buffer_load_dwordx4 v[164:167], v26, s[24:27], s36 offen offset:1024 sc1
    buffer_load_dwordx4 v[168:171], v26, s[24:27], s36 offen offset:2048 sc1
    buffer_load_dwordx4 v[172:175], v26, s[24:27], s36 offen offset:3072 sc1
    buffer_load_dwordx4 v[176:179], v26, s[24:27], s37 offen offset:0 sc1
    buffer_load_dwordx4 v[180:183], v26, s[24:27], s37 offen offset:1024 sc1
    buffer_load_dwordx4 v[184:187], v26, s[24:27], s37 offen offset:2048 sc1
    buffer_load_dwordx4 v[188:191], v26, s[24:27], s37 offen offset:3072 sc1
    s_mov_b64 exec, -1
    s_branch L_recurrent_scan__compressed_kv_cla__moe_arch_mod__prompt_kernel_swend_75
L_recurrent_scan__compressed_kv_cla__moe_arch_mod__prompt_kernel_swn_78:
    s_sub_u32 s38, s40, s60
    s_cmp_eq_u32 s38, 0
    s_cbranch_scc0 L_recurrent_scan__compressed_kv_cla__moe_arch_mod__prompt_kernel_swn_67
    s_and_b32 s20, s3, 3
    s_lshl_b32 s20, s20, 8
    s_lshl_b32 s21, s28, 5
    s_add_u32 s20, s20, s21
    s_lshr_b32 s21, s3, 2
    s_lshl_b32 s21, s21, 7
    v_lshrrev_b32 v25, 3, v1
    s_lshl_b32 s36, s28, 5
    s_add_u32 s36, s36, s20
    v_add_u32 v25, s36, v25
    v_mul_u32_u24 v25, 7168, v25
    v_add_u32 v25, s21, v25
    v_bfe_u32 v26, v1, 4, 1
    v_lshlrev_b32 v26, 1, v26
    v_and_b32 v27, 7, v1
    v_xor_b32 v26, v26, v27
    v_lshl_add_u32 v24, v26, 4, v25
    v_xor_b32 v26, 4, v26
    v_lshl_add_u32 v25, v26, 4, v25
    v_add_u32 v25, 56320, v25
    v_add_u32 v26, 112640, v24
    v_add_u32 v27, 112640, v25
    s_lshl_b32 s36, s28, 13
    s_add_u32 m0, s36, 131072
    s_mov_b32 s37, 229376
    buffer_load_dwordx4 v24, s[4:7], 0 offen offset:0 nt lds
    buffer_load_dwordx4 v25, s[4:7], 0 offen offset:1024 nt lds
    buffer_load_dwordx4 v26, s[4:7], 0 offen offset:2048 nt lds
    buffer_load_dwordx4 v27, s[4:7], 0 offen offset:3072 nt lds
    s_add_u32 m0, s36, 135168
    s_nop 0
    buffer_load_dwordx4 v24, s[4:7], s37 offen offset:0 nt lds
    buffer_load_dwordx4 v25, s[4:7], s37 offen offset:1024 nt lds
    buffer_load_dwordx4 v26, s[4:7], s37 offen offset:2048 nt lds
    buffer_load_dwordx4 v27, s[4:7], s37 offen offset:3072 nt lds
    s_branch L_recurrent_scan__compressed_kv_cla__moe_arch_mod__prompt_kernel_swend_66
L_recurrent_scan__compressed_kv_cla__moe_arch_mod__prompt_kernel_swn_67:
    s_cmp_eq_u32 s38, 2
    s_cbranch_scc0 L_recurrent_scan__compressed_kv_cla__moe_arch_mod__prompt_kernel_swn_68
    v_lshrrev_b32 v8, 4, v1
    v_bfe_u32 v5, v1, 2, 2
    v_lshl_add_u32 v5, v8, 3, v5
    v_lshlrev_b32 v5, 7, v5
    v_and_b32 v9, 3, v1
    v_lshl_add_u32 v5, v9, 3, v5
    v_bfe_u32 v9, v1, 3, 2
    v_xor_b32 v9, s28, v9
    v_lshl_add_u32 v5, v9, 5, v5
    v_add_u32 v5, 131072, v5
    ds_read_b64_tr_b16 v[14:15], v5 offset:0
    ds_read_b64_tr_b16 v[16:17], v5 offset:512
    ds_read_b64_tr_b16 v[20:21], v5 offset:4096
    ds_read_b64_tr_b16 v[22:23], v5 offset:4608
    ds_read_b64_tr_b16 v[24:25], v5 offset:8192
    ds_read_b64_tr_b16 v[26:27], v5 offset:8704
    s_and_b32 s36, s3, 3
    s_lshl_b32 s36, s36, 6
    s_lshr_b32 s37, s3, 2
    s_lshl_b32 s37, s37, 12
    s_add_u32 s36, s36, s37
    s_lshl_b32 s37, s28, 10
    s_add_u32 s36, s36, s37
    s_add_u32 s36, s36, 58720256
    v_and_b32 v9, 1, v1
    v_lshlrev_b32 v9, 4, v9
    v_lshl_add_u32 v9, v8, 8, v9
    s_waitcnt lgkmcnt(4)
    v_mfma_f32_16x16x32_bf16 v[10:13], v[14:17], v[160:163], 0
    ds_read_b64_tr_b16 v[14:15], v5 offset:12288
    ds_read_b64_tr_b16 v[16:17], v5 offset:12800
    s_waitcnt lgkmcnt(4)
    v_mfma_f32_16x16x32_bf16 v[10:13], v[20:23], v[164:167], v[10:13]
    ds_read_b64_tr_b16 v[20:21], v5 offset:16384
    ds_read_b64_tr_b16 v[22:23], v5 offset:16896
    s_waitcnt lgkmcnt(4)
    v_mfma_f32_16x16x32_bf16 v[10:13], v[24:27], v[168:171], v[10:13]
    ds_read_b64_tr_b16 v[24:25], v5 offset:20480
    ds_read_b64_tr_b16 v[26:27], v5 offset:20992
    s_waitcnt lgkmcnt(4)
    v_mfma_f32_16x16x32_bf16 v[10:13], v[14:17], v[172:175], v[10:13]
    ds_read_b64_tr_b16 v[14:15], v5 offset:24576
    ds_read_b64_tr_b16 v[16:17], v5 offset:25088
    s_waitcnt lgkmcnt(4)
    v_mfma_f32_16x16x32_bf16 v[10:13], v[20:23], v[176:179], v[10:13]
    ds_read_b64_tr_b16 v[20:21], v5 offset:28672
    ds_read_b64_tr_b16 v[22:23], v5 offset:29184
    s_waitcnt lgkmcnt(4)
    v_mfma_f32_16x16x32_bf16 v[10:13], v[24:27], v[180:183], v[10:13]
    s_waitcnt lgkmcnt(2)
    v_mfma_f32_16x16x32_bf16 v[10:13], v[14:17], v[184:187], v[10:13]
    s_waitcnt lgkmcnt(0)
    v_mfma_f32_16x16x32_bf16 v[10:13], v[20:23], v[188:191], v[10:13]
    s_nop 5
    s_mov_b32 exec_lo, 0x00030003
    s_mov_b32 exec_hi, 0x00030003
    buffer_store_dwordx4 v[10:13], v9, s[24:27], s36 offen sc1
    s_mov_b64 exec, -1
    s_nop 1
    s_branch L_recurrent_scan__compressed_kv_cla__moe_arch_mod__prompt_kernel_swend_66
L_recurrent_scan__compressed_kv_cla__moe_arch_mod__prompt_kernel_swn_68:
    s_cmp_eq_u32 s38, 3
    s_cbranch_scc0 L_recurrent_scan__compressed_kv_cla__moe_arch_mod__prompt_kernel_swn_69
    s_and_b32 s20, s3, 3
    s_lshl_b32 s20, s20, 8
    s_lshl_b32 s21, s28, 5
    s_add_u32 s20, s20, s21
    s_lshr_b32 s21, s3, 2
    s_lshl_b32 s21, s21, 7
    v_lshrrev_b32 v25, 3, v1
    s_lshl_b32 s36, s28, 5
    s_add_u32 s36, s36, s20
    v_add_u32 v25, s36, v25
    v_mul_u32_u24 v25, 7168, v25
    v_add_u32 v25, s21, v25
    v_bfe_u32 v26, v1, 4, 1
    v_lshlrev_b32 v26, 1, v26
    v_and_b32 v27, 7, v1
    v_xor_b32 v26, v26, v27
    v_lshl_add_u32 v24, v26, 4, v25
    v_xor_b32 v26, 4, v26
    v_lshl_add_u32 v25, v26, 4, v25
    v_add_u32 v25, 56320, v25
    v_add_u32 v26, 112640, v24
    v_add_u32 v27, 112640, v25
    s_lshl_b32 s36, s28, 13
    s_add_u32 m0, s36, 131072
    s_mov_b32 s37, 229376
    buffer_load_dwordx4 v24, s[8:11], 0 offen offset:0 nt lds
    buffer_load_dwordx4 v25, s[8:11], 0 offen offset:1024 nt lds
    buffer_load_dwordx4 v26, s[8:11], 0 offen offset:2048 nt lds
    buffer_load_dwordx4 v27, s[8:11], 0 offen offset:3072 nt lds
    s_add_u32 m0, s36, 135168
    s_nop 0
    buffer_load_dwordx4 v24, s[8:11], s37 offen offset:0 nt lds
    buffer_load_dwordx4 v25, s[8:11], s37 offen offset:1024 nt lds
    buffer_load_dwordx4 v26, s[8:11], s37 offen offset:2048 nt lds
    buffer_load_dwordx4 v27, s[8:11], s37 offen offset:3072 nt lds
    s_branch L_recurrent_scan__compressed_kv_cla__moe_arch_mod__prompt_kernel_swend_66
L_recurrent_scan__compressed_kv_cla__moe_arch_mod__prompt_kernel_swn_69:
    s_cmp_eq_u32 s38, 5
    s_cbranch_scc0 L_recurrent_scan__compressed_kv_cla__moe_arch_mod__prompt_kernel_swn_70
    v_lshrrev_b32 v8, 4, v1
    v_bfe_u32 v5, v1, 2, 2
    v_lshl_add_u32 v5, v8, 3, v5
    v_lshlrev_b32 v5, 7, v5
    v_and_b32 v9, 3, v1
    v_lshl_add_u32 v5, v9, 3, v5
    v_bfe_u32 v9, v1, 3, 2
    v_xor_b32 v9, s28, v9
    v_lshl_add_u32 v5, v9, 5, v5
    v_add_u32 v5, 131072, v5
    ds_read_b64_tr_b16 v[14:15], v5 offset:0
    ds_read_b64_tr_b16 v[16:17], v5 offset:512
    ds_read_b64_tr_b16 v[20:21], v5 offset:4096
    ds_read_b64_tr_b16 v[22:23], v5 offset:4608
    ds_read_b64_tr_b16 v[24:25], v5 offset:8192
    ds_read_b64_tr_b16 v[26:27], v5 offset:8704
    s_and_b32 s36, s3, 3
    s_lshl_b32 s36, s36, 6
    s_lshr_b32 s37, s3, 2
    s_lshl_b32 s37, s37, 12
    s_add_u32 s36, s36, s37
    s_lshl_b32 s37, s28, 10
    s_add_u32 s36, s36, s37
    s_add_u32 s36, s36, 58720288
    v_and_b32 v9, 1, v1
    v_lshlrev_b32 v9, 4, v9
    v_lshl_add_u32 v9, v8, 8, v9
    s_waitcnt lgkmcnt(4)
    v_mfma_f32_16x16x32_bf16 v[10:13], v[14:17], v[160:163], 0
    ds_read_b64_tr_b16 v[14:15], v5 offset:12288
    ds_read_b64_tr_b16 v[16:17], v5 offset:12800
    s_waitcnt lgkmcnt(4)
    v_mfma_f32_16x16x32_bf16 v[10:13], v[20:23], v[164:167], v[10:13]
    ds_read_b64_tr_b16 v[20:21], v5 offset:16384
    ds_read_b64_tr_b16 v[22:23], v5 offset:16896
    s_waitcnt lgkmcnt(4)
    v_mfma_f32_16x16x32_bf16 v[10:13], v[24:27], v[168:171], v[10:13]
    ds_read_b64_tr_b16 v[24:25], v5 offset:20480
    ds_read_b64_tr_b16 v[26:27], v5 offset:20992
    s_waitcnt lgkmcnt(4)
    v_mfma_f32_16x16x32_bf16 v[10:13], v[14:17], v[172:175], v[10:13]
    ds_read_b64_tr_b16 v[14:15], v5 offset:24576
    ds_read_b64_tr_b16 v[16:17], v5 offset:25088
    s_waitcnt lgkmcnt(4)
    v_mfma_f32_16x16x32_bf16 v[10:13], v[20:23], v[176:179], v[10:13]
    ds_read_b64_tr_b16 v[20:21], v5 offset:28672
    ds_read_b64_tr_b16 v[22:23], v5 offset:29184
    s_waitcnt lgkmcnt(4)
    v_mfma_f32_16x16x32_bf16 v[10:13], v[24:27], v[180:183], v[10:13]
    s_waitcnt lgkmcnt(2)
    v_mfma_f32_16x16x32_bf16 v[10:13], v[14:17], v[184:187], v[10:13]
    s_waitcnt lgkmcnt(0)
    v_mfma_f32_16x16x32_bf16 v[10:13], v[20:23], v[188:191], v[10:13]
    s_nop 5
    s_mov_b32 exec_lo, 0x00030003
    s_mov_b32 exec_hi, 0x00030003
    buffer_store_dwordx4 v[10:13], v9, s[24:27], s36 offen sc1
    s_mov_b64 exec, -1
    s_nop 1
    s_branch L_recurrent_scan__compressed_kv_cla__moe_arch_mod__prompt_kernel_swend_66
L_recurrent_scan__compressed_kv_cla__moe_arch_mod__prompt_kernel_swn_70:
    s_mul_i32 s36, s3, 2341
    s_lshr_b32 s36, s36, 16
    s_add_u32 s36, s36, 48
    s_lshl_b32 s36, s36, 7
    v_mov_b32 v20, s36
    v_mov_b32 v21, 1
    s_mov_b64 exec, 1
    global_atomic_add v20, v21, s[90:91]
    s_mov_b64 exec, -1
    s_nop 3
L_recurrent_scan__compressed_kv_cla__moe_arch_mod__prompt_kernel_swend_66:
L_recurrent_scan__compressed_kv_cla__moe_arch_mod__prompt_kernel_swend_75:
    s_branch L_recurrent_scan__compressed_kv_cla__moe_arch_mod__prompt_kernel_back_80
L_recurrent_scan__compressed_kv_cla__moe_arch_mod__prompt_kernel_rare_89:
    v_mov_b32 v20, 4048155338
    v_subrev_u32 v21, s36, v18
    v_cmp_gt_i32 s[20:21], 0, v21
    v_cmp_gt_i32 s[22:23], 1, v21
    v_cmp_gt_i32 s[62:63], 2, v21
    v_cmp_gt_i32 vcc, 3, v21
    v_cndmask_b32 v112, v112, v20, s[20:21]
    v_cndmask_b32 v113, v113, v20, s[22:23]
    v_cndmask_b32 v114, v114, v20, s[62:63]
    v_cndmask_b32 v115, v115, v20, vcc
    v_cmp_gt_i32 s[20:21], 16, v21
    v_cmp_gt_i32 s[22:23], 17, v21
    v_cmp_gt_i32 s[62:63], 18, v21
    v_cmp_gt_i32 vcc, 19, v21
    v_cndmask_b32 v116, v116, v20, s[20:21]
    v_cndmask_b32 v117, v117, v20, s[22:23]
    v_cndmask_b32 v118, v118, v20, s[62:63]
    v_cndmask_b32 v119, v119, v20, vcc
    v_cmp_gt_i32 s[20:21], -16, v21
    v_cmp_gt_i32 s[22:23], -15, v21
    v_cmp_gt_i32 s[62:63], -14, v21
    v_cmp_gt_i32 vcc, -13, v21
    v_cndmask_b32 v120, v120, v20, s[20:21]
    v_cndmask_b32 v121, v121, v20, s[22:23]
    v_cndmask_b32 v122, v122, v20, s[62:63]
    v_cndmask_b32 v123, v123, v20, vcc
    v_cmp_gt_i32 s[20:21], 0, v21
    v_cmp_gt_i32 s[22:23], 1, v21
    v_cmp_gt_i32 s[62:63], 2, v21
    v_cmp_gt_i32 vcc, 3, v21
    v_cndmask_b32 v124, v124, v20, s[20:21]
    v_cndmask_b32 v125, v125, v20, s[22:23]
    v_cndmask_b32 v126, v126, v20, s[62:63]
    v_cndmask_b32 v127, v127, v20, vcc
    s_branch L_recurrent_scan__compressed_kv_cla__moe_arch_mod__prompt_kernel_back_90
L_recurrent_scan__compressed_kv_cla__moe_arch_mod__prompt_kernel_rare_93:
    s_mov_b32 s61, 0x40000
L_recurrent_scan__compressed_kv_cla__moe_arch_mod__prompt_kernel_spin_91:
    s_sub_u32 s61, s61, 1
    s_cbranch_scc1 L_recurrent_scan__compressed_kv_cla__moe_arch_mod__prompt_kernel_spinx_92
    s_sleep 8
    global_load_dword v11, v12, s[90:91] sc1
    s_waitcnt vmcnt(0)
    v_readfirstlane_b32 s36, v11
    s_nop 0
    s_cmp_lt_u32 s36, 28
    s_cbranch_scc1 L_recurrent_scan__compressed_kv_cla__moe_arch_mod__prompt_kernel_spin_91
L_recurrent_scan__compressed_kv_cla__moe_arch_mod__prompt_kernel_spinx_92:
    s_branch L_recurrent_scan__compressed_kv_cla__moe_arch_mod__prompt_kernel_back_94
L_recurrent_scan__compressed_kv_cla__moe_arch_mod__prompt_kernel_rare_98:
    v_mov_b32 v20, 4048155338
    v_subrev_u32 v21, s50, v18
    v_cmp_gt_i32 s[20:21], 0, v21
    v_cmp_gt_i32 s[22:23], 1, v21
    v_cmp_gt_i32 s[62:63], 2, v21
    v_cmp_gt_i32 vcc, 3, v21
    v_cndmask_b32 v96, v96, v20, s[20:21]
    v_cndmask_b32 v97, v97, v20, s[22:23]
    v_cndmask_b32 v98, v98, v20, s[62:63]
    v_cndmask_b32 v99, v99, v20, vcc
    v_cmp_gt_i32 s[20:21], 16, v21
    v_cmp_gt_i32 s[22:23], 17, v21
    v_cmp_gt_i32 s[62:63], 18, v21
    v_cmp_gt_i32 vcc, 19, v21
    v_cndmask_b32 v100, v100, v20, s[20:21]
    v_cndmask_b32 v101, v101, v20, s[22:23]
    v_cndmask_b32 v102, v102, v20, s[62:63]
    v_cndmask_b32 v103, v103, v20, vcc
    v_cmp_gt_i32 s[20:21], -16, v21
    v_cmp_gt_i32 s[22:23], -15, v21
    v_cmp_gt_i32 s[62:63], -14, v21
    v_cmp_gt_i32 vcc, -13, v21
    v_cndmask_b32 v104, v104, v20, s[20:21]
    v_cndmask_b32 v105, v105, v20, s[22:23]
    v_cndmask_b32 v106, v106, v20, s[62:63]
    v_cndmask_b32 v107, v107, v20, vcc
    v_cmp_gt_i32 s[20:21], 0, v21
    v_cmp_gt_i32 s[22:23], 1, v21
    v_cmp_gt_i32 s[62:63], 2, v21
    v_cmp_gt_i32 vcc, 3, v21
    v_cndmask_b32 v108, v108, v20, s[20:21]
    v_cndmask_b32 v109, v109, v20, s[22:23]
    v_cndmask_b32 v110, v110, v20, s[62:63]
    v_cndmask_b32 v111, v111, v20, vcc
    s_branch L_recurrent_scan__compressed_kv_cla__moe_arch_mod__prompt_kernel_back_99
L_grp1:
    v_mov_b32 v20, 1040356334
    v_mov_b32 v21, v20
    s_and_b32 s37, s28, 3
    s_lshl_b32 s37, s37, 13
    v_lshlrev_b32 v7, 4, v1
    v_add_u32 v4, s37, v7
    v_add_u32 v19, 131072, v4
    v_add_u32 v6, 4096, v4
    s_add_u32 s43, s37, 32768
    s_add_u32 s44, s37, 98304
    s_waitcnt vmcnt(4) lgkmcnt(0)
    v_pk_mul_f32 v[192:193], v[192:193], v[20:21]
    v_pk_mul_f32 v[194:195], v[194:195], v[20:21]
    v_pk_mul_f32 v[196:197], v[196:197], v[20:21]
    v_pk_mul_f32 v[198:199], v[198:199], v[20:21]
    v_cvt_pk_bf16_f32 v128, v192, v193
    v_cvt_pk_bf16_f32 v129, v194, v195
    v_cvt_pk_bf16_f32 v130, v196, v197
    v_cvt_pk_bf16_f32 v131, v198, v199
    v_pk_mul_f32 v[200:201], v[200:201], v[20:21]
    v_pk_mul_f32 v[202:203], v[202:203], v[20:21]
    v_pk_mul_f32 v[204:205], v[204:205], v[20:21]
    v_pk_mul_f32 v[206:207], v[206:207], v[20:21]
    v_cvt_pk_bf16_f32 v132, v200, v201
    v_cvt_pk_bf16_f32 v133, v202, v203
    v_cvt_pk_bf16_f32 v134, v204, v205
    v_cvt_pk_bf16_f32 v135, v206, v207
    v_pk_mul_f32 v[208:209], v[208:209], v[20:21]
    v_pk_mul_f32 v[210:211], v[210:211], v[20:21]
    v_pk_mul_f32 v[212:213], v[212:213], v[20:21]
    v_pk_mul_f32 v[214:215], v[214:215], v[20:21]
    v_cvt_pk_bf16_f32 v136, v208, v209
    v_cvt_pk_bf16_f32 v137, v210, v211
    v_cvt_pk_bf16_f32 v138, v212, v213
    v_cvt_pk_bf16_f32 v139, v214, v215
    v_pk_mul_f32 v[216:217], v[216:217], v[20:21]
    v_pk_mul_f32 v[218:219], v[218:219], v[20:21]
    v_pk_mul_f32 v[220:221], v[220:221], v[20:21]
    v_pk_mul_f32 v[222:223], v[222:223], v[20:21]
    v_cvt_pk_bf16_f32 v140, v216, v217
    v_cvt_pk_bf16_f32 v141, v218, v219
    v_cvt_pk_bf16_f32 v142, v220, v221
    v_cvt_pk_bf16_f32 v143, v222, v223
    v_pk_mul_f32 v[224:225], v[224:225], v[20:21]
    v_pk_mul_f32 v[226:227], v[226:227], v[20:21]
    v_pk_mul_f32 v[228:229], v[228:229], v[20:21]
    v_pk_mul_f32 v[230:231], v[230:231], v[20:21]
    v_cvt_pk_bf16_f32 v144, v224, v225
    v_cvt_pk_bf16_f32 v145, v226, v227
    v_cvt_pk_bf16_f32 v146, v228, v229
    v_cvt_pk_bf16_f32 v147, v230, v231
    v_pk_mul_f32 v[232:233], v[232:233], v[20:21]
    v_pk_mul_f32 v[234:235], v[234:235], v[20:21]
    v_pk_mul_f32 v[236:237], v[236:237], v[20:21]
    v_pk_mul_f32 v[238:239], v[238:239], v[20:21]
    v_cvt_pk_bf16_f32 v148, v232, v233
    v_cvt_pk_bf16_f32 v149, v234, v235
    v_cvt_pk_bf16_f32 v150, v236, v237
    v_cvt_pk_bf16_f32 v151, v238, v239
    v_pk_mul_f32 v[240:241], v[240:241], v[20:21]
    v_pk_mul_f32 v[242:243], v[242:243], v[20:21]
    v_pk_mul_f32 v[244:245], v[244:245], v[20:21]
    v_pk_mul_f32 v[246:247], v[246:247], v[20:21]
    v_cvt_pk_bf16_f32 v152, v240, v241
    v_cvt_pk_bf16_f32 v153, v242, v243
    v_cvt_pk_bf16_f32 v154, v244, v245
    v_cvt_pk_bf16_f32 v155, v246, v247
    v_pk_mul_f32 v[248:249], v[248:249], v[20:21]
    v_pk_mul_f32 v[250:251], v[250:251], v[20:21]
    v_pk_mul_f32 v[252:253], v[252:253], v[20:21]
    v_pk_mul_f32 v[254:255], v[254:255], v[20:21]
    v_cvt_pk_bf16_f32 v156, v248, v249
    v_cvt_pk_bf16_f32 v157, v250, v251
    v_cvt_pk_bf16_f32 v158, v252, v253
    v_cvt_pk_bf16_f32 v159, v254, v255
    v_mov_b32 v2, v7
    v_and_b32 v21, 15, v1
    v_lshrrev_b32 v22, 4, v1
    v_lshlrev_b32 v22, 2, v22
    v_sub_u32 v18, v21, v22
    s_mov_b32 s40, 0
    s_mov_b32 s41, 16384
    s_mov_b32 s49, 0xffff
    s_lshl_b32 s51, s30, 1
    s_add_u32 s51, s51, 1
    s_and_b32 s50, s28, 3
    s_lshl_b32 s50, s50, 5
    v_mov_b32 v36, 0x3f803f80
    v_mov_b32 v37, 0x3f803f80
    v_mov_b32 v38, 0x3f803f80
    v_mov_b32 v39, 0x3f803f80
    s_lshl_b32 s42, 7, s51
    s_lshr_b32 s42, s42, 2
    s_or_b32 s42, s42, 0x8001
    s_mov_b64 s[52:53], 0
    s_waitcnt lgkmcnt(0)
    s_barrier
    ds_read_b128 v[160:163], v19 offset:0
    ds_read_b128 v[164:167], v19 offset:1024
    ds_read_b128 v[168:171], v19 offset:2048
    ds_read_b128 v[172:175], v19 offset:3072
    ds_read_b128 v[176:179], v19 offset:4096
    ds_read_b128 v[180:183], v19 offset:5120
    ds_read_b128 v[184:187], v19 offset:6144
    ds_read_b128 v[188:191], v19 offset:7168
    s_add_u32 s16, s54, 41943040
    s_addc_u32 s17, s55, 0
    s_and_b32 s17, s17, 0xffff
    s_mov_b32 s18, 117440640
    s_mov_b32 s19, 0x20000
    s_cmp_eq_u32 s28, 4
    s_cbranch_scc1 L_recurrent_scan__compressed_kv_cla__moe_arch_mod__prompt_kernel_rare_100
L_recurrent_scan__compressed_kv_cla__moe_arch_mod__prompt_kernel_back_101:
    s_sub_u32 s36, s2, 160
    s_lshl_b32 s36, s36, 1
    s_and_b32 s37, s28, 1
    s_add_u32 s36, s36, s37
    s_min_u32 s36, s36, 1024
    s_mul_i32 s36, s36, 43776
    s_cmp_lt_u32 s28, 6
    s_cselect_b64 s[4:5], s[32:33], s[34:35]
    s_cselect_b32 s37, 32, 28
    s_lshl_b32 s37, s37, 18
    s_min_u32 s36, s36, s37
    s_sub_u32 s6, s37, s36
    s_min_u32 s6, s6, 43776
    s_add_u32 s4, s4, s36
    s_addc_u32 s5, s5, 0
    s_and_b32 s5, s5, 0xffff
    s_mov_b32 s7, 0x20000
    v_cmp_gt_u32 vcc, 32, v1
    v_lshlrev_b32 v13, 7, v1
    v_mov_b32 v12, 0x100000
    v_cndmask_b32 v13, v12, v13, vcc
    s_mov_b32 s48, 0
    s_cmp_eq_u32 s28, 5
    s_cselect_b32 s36, 0x1000, 0
    s_or_b32 s42, s42, s36
    ds_read_b128 v[64:67], v2 offset:0
    ds_read_b128 v[68:71], v2 offset:1024
    ds_read_b128 v[72:75], v2 offset:2048
    ds_read_b128 v[76:79], v2 offset:3072
    ds_read_b128 v[80:83], v2 offset:4096
    ds_read_b128 v[84:87], v2 offset:5120
    ds_read_b128 v[88:91], v2 offset:6144
    ds_read_b128 v[92:95], v2 offset:7168
    s_waitcnt lgkmcnt(7)
    v_mfma_f32_16x16x32_bf16 v[96:99], v[64:67], v[128:131], 0
    v_mov_b64 v[192:193], 0
    v_mov_b64 v[194:195], 0
    v_mfma_f32_16x16x32_bf16 v[104:107], v[64:67], v[144:147], 0
    ds_read_b128 v[64:67], v2 offset:8192
    v_mov_b64 v[196:197], 0
    v_mov_b64 v[198:199], 0
    s_waitcnt lgkmcnt(7)
    v_mfma_f32_16x16x32_bf16 v[96:99], v[68:71], v[132:135], v[96:99]
    v_mov_b64 v[200:201], 0
    v_mov_b64 v[202:203], 0
    v_mfma_f32_16x16x32_bf16 v[104:107], v[68:71], v[148:151], v[104:107]
    ds_read_b128 v[68:71], v2 offset:9216
    v_mov_b64 v[204:205], 0
    v_mov_b64 v[206:207], 0
    s_waitcnt lgkmcnt(7)
    v_mfma_f32_16x16x32_bf16 v[96:99], v[72:75], v[136:139], v[96:99]
    v_mov_b64 v[208:209], 0
    v_mfma_f32_16x16x32_bf16 v[104:107], v[72:75], v[152:155], v[104:107]
    ds_read_b128 v[72:75], v2 offset:10240
    v_mov_b64 v[210:211], 0
    v_mov_b64 v[212:213], 0
    s_waitcnt lgkmcnt(7)
    v_mfma_f32_16x16x32_bf16 v[96:99], v[76:79], v[140:143], v[96:99]
    v_mov_b64 v[214:215], 0
    v_mov_b64 v[216:217], 0
    v_mfma_f32_16x16x32_bf16 v[104:107], v[76:79], v[156:159], v[104:107]
    ds_read_b128 v[76:79], v2 offset:11264
    v_mov_b64 v[218:219], 0
    v_mov_b64 v[220:221], 0
    s_waitcnt lgkmcnt(7)
    v_mfma_f32_16x16x32_bf16 v[100:103], v[80:83], v[128:131], 0
    v_mov_b64 v[222:223], 0
    v_mov_b64 v[224:225], 0
    v_mfma_f32_16x16x32_bf16 v[108:111], v[80:83], v[144:147], 0
    ds_read_b128 v[80:83], v2 offset:12288
    v_mov_b64 v[226:227], 0
    s_waitcnt lgkmcnt(7)
    v_mfma_f32_16x16x32_bf16 v[100:103], v[84:87], v[132:135], v[100:103]
    v_mov_b64 v[228:229], 0
    v_mov_b64 v[230:231], 0
    v_mfma_f32_16x16x32_bf16 v[108:111], v[84:87], v[148:151], v[108:111]
    ds_read_b128 v[84:87], v2 offset:13312
    v_mov_b64 v[232:233], 0
    v_mov_b64 v[234:235], 0
    s_waitcnt lgkmcnt(7)
    v_mfma_f32_16x16x32_bf16 v[100:103], v[88:91], v[136:139], v[100:103]
    v_mov_b64 v[236:237], 0
    v_mov_b64 v[238:239], 0
    v_mfma_f32_16x16x32_bf16 v[108:111], v[88:91], v[152:155], v[108:111]
    ds_read_b128 v[88:91], v2 offset:14336
    v_mov_b64 v[240:241], 0
    v_mov_b64 v[242:243], 0
    s_waitcnt lgkmcnt(7)
    v_mfma_f32_16x16x32_bf16 v[100:103], v[92:95], v[140:143], v[100:103]
    v_mov_b64 v[244:245], 0
    v_mfma_f32_16x16x32_bf16 v[108:111], v[92:95], v[156:159], v[108:111]
    ds_read_b128 v[92:95], v2 offset:15360
    v_mov_b64 v[246:247], 0
    v_mov_b64 v[248:249], 0
    s_waitcnt lgkmcnt(7)
    v_mfma_f32_16x16x32_bf16 v[112:115], v[64:67], v[128:131], 0
    v_mov_b64 v[250:251], 0
    v_mov_b64 v[252:253], 0
    v_mfma_f32_16x16x32_bf16 v[120:123], v[64:67], v[144:147], 0
    v_mov_b64 v[254:255], 0
    v_mov_b64 v[28:29], 0
    s_waitcnt lgkmcnt(6)
    v_mfma_f32_16x16x32_bf16 v[112:115], v[68:71], v[132:135], v[112:115]
    v_mov_b64 v[30:31], 0
    v_mov_b64 v[32:33], 0
    v_mfma_f32_16x16x32_bf16 v[120:123], v[68:71], v[148:151], v[120:123]
    v_mov_b64 v[34:35], 0
    s_waitcnt lgkmcnt(5)
    v_mfma_f32_16x16x32_bf16 v[112:115], v[72:75], v[136:139], v[112:115]
    s_add_u32 s36, s30, s50
    s_cmp_eq_u32 s36, 0
    s_cbranch_scc1 L_recurrent_scan__compressed_kv_cla__moe_arch_mod__prompt_kernel_rare_103
L_recurrent_scan__compressed_kv_cla__moe_arch_mod__prompt_kernel_back_104:
    v_mfma_f32_16x16x32_bf16 v[120:123], v[72:75], v[152:155], v[120:123]
    v_max3_f32 v22, v96, v97, v98
    v_max3_f32 v23, v104, v105, v106
    s_waitcnt lgkmcnt(4)
    v_mfma_f32_16x16x32_bf16 v[112:115], v[76:79], v[140:143], v[112:115]
    v_max3_f32 v22, v22, v99, v100
    v_max3_f32 v23, v23, v107, v108
    v_mfma_f32_16x16x32_bf16 v[120:123], v[76:79], v[156:159], v[120:123]
    v_max3_f32 v22, v22, v101, v102
    v_max3_f32 v23, v23, v109, v110
    s_waitcnt lgkmcnt(3)
    v_mfma_f32_16x16x32_bf16 v[116:119], v[80:83], v[128:131], 0
    v_max_f32 v22, v22, v103
    v_max_f32 v23, v23, v111
    v_mfma_f32_16x16x32_bf16 v[124:127], v[80:83], v[144:147], 0
    v_mov_b32 v24, v22
    v_mov_b32 v25, v23
    s_waitcnt lgkmcnt(2)
    v_mfma_f32_16x16x32_bf16 v[116:119], v[84:87], v[132:135], v[116:119]
    v_permlane16_swap_b32 v22, v24
    v_permlane16_swap_b32 v23, v25
    v_mfma_f32_16x16x32_bf16 v[124:127], v[84:87], v[148:151], v[124:127]
    v_max_f32 v22, v22, v24
    v_max_f32 v23, v23, v25
    s_waitcnt lgkmcnt(1)
    v_mfma_f32_16x16x32_bf16 v[116:119], v[88:91], v[136:139], v[116:119]
    v_mov_b32 v24, v22
    v_mov_b32 v25, v23
    v_mfma_f32_16x16x32_bf16 v[124:127], v[88:91], v[152:155], v[124:127]
    v_permlane32_swap_b32 v22, v24
    v_permlane32_swap_b32 v23, v25
    s_waitcnt lgkmcnt(0)
    v_mfma_f32_16x16x32_bf16 v[116:119], v[92:95], v[140:143], v[116:119]
    v_max_f32 v22, v22, v24
    v_max_f32 v23, v23, v25
    v_mfma_f32_16x16x32_bf16 v[124:127], v[92:95], v[156:159], v[124:127]
    v_sub_f32 v40, 0, v22
    v_sub_f32 v41, 0, v22
    v_sub_f32 v42, 0, v22
    v_sub_f32 v43, 0, v22
    v_sub_f32 v44, 0, v23
    v_sub_f32 v45, 0, v23
    v_sub_f32 v46, 0, v23
    v_sub_f32 v47, 0, v23
    v_add_u32 v3, 65536, v2
    v_add_u32 v2, s41, v2
    v_and_b32 v2, s49, v2
    s_waitcnt vmcnt(1)
    s_cmp_eq_u32 s28, 4
    s_cbranch_scc1 L_recurrent_scan__compressed_kv_cla__moe_arch_mod__prompt_kernel_pw_105
    s_waitcnt vmcnt(0)
L_recurrent_scan__compressed_kv_cla__moe_arch_mod__prompt_kernel_pw_105:
    s_barrier
    ds_read_b128 v[64:67], v2 offset:0
    ds_read_b128 v[68:71], v2 offset:1024
    ds_read_b128 v[72:75], v2 offset:2048
    ds_read_b128 v[76:79], v2 offset:3072
    ds_read_b128 v[80:83], v2 offset:4096
    ds_read_b128 v[84:87], v2 offset:5120
    ds_read_b128 v[88:91], v2 offset:6144
    v_pk_add_f32 v[96:97], v[96:97], v[40:41]
    v_pk_add_f32 v[98:99], v[98:99], v[40:41]
    v_pk_add_f32 v[100:101], v[100:101], v[40:41]
    v_pk_add_f32 v[102:103], v[102:103], v[40:41]
    v_pk_add_f32 v[104:105], v[104:105], v[44:45]
    v_pk_add_f32 v[106:107], v[106:107], v[44:45]
    v_pk_add_f32 v[108:109], v[108:109], v[44:45]
    v_pk_add_f32 v[110:111], v[110:111], v[44:45]
    v_pk_add_f32 v[112:113], v[112:113], v[40:41]
    v_pk_add_f32 v[114:115], v[114:115], v[40:41]
    v_pk_add_f32 v[116:117], v[116:117], v[40:41]
    v_pk_add_f32 v[118:119], v[118:119], v[40:41]
    v_pk_add_f32 v[120:121], v[120:121], v[44:45]
    v_pk_add_f32 v[122:123], v[122:123], v[44:45]
    v_pk_add_f32 v[124:125], v[124:125], v[44:45]
    v_pk_add_f32 v[126:127], v[126:127], v[44:45]
    v_exp_f32 v96, v96
    v_exp_f32 v97, v97
    v_exp_f32 v98, v98
    v_exp_f32 v99, v99
    v_exp_f32 v104, v104
    v_exp_f32 v105, v105
    v_exp_f32 v106, v106
    v_exp_f32 v107, v107
    v_exp_f32 v100, v100
    v_exp_f32 v101, v101
    v_exp_f32 v102, v102
    v_exp_f32 v103, v103
    v_exp_f32 v108, v108
    v_exp_f32 v109, v109
    v_exp_f32 v110, v110
    v_exp_f32 v111, v111
    v_cvt_pk_bf16_f32 v48, v96, v97
    v_cvt_pk_bf16_f32 v49, v98, v99
    v_cvt_pk_bf16_f32 v52, v104, v105
    v_cvt_pk_bf16_f32 v53, v106, v107
    v_cvt_pk_bf16_f32 v50, v100, v101
    v_cvt_pk_bf16_f32 v51, v102, v103
    v_cvt_pk_bf16_f32 v54, v108, v109
    v_cvt_pk_bf16_f32 v55, v110, v111
    .p2align 6
L_body1:
    s_bitcmp1_b32 s42, s40
    s_cbranch_scc1 L_recurrent_scan__compressed_kv_cla__moe_arch_mod__prompt_kernel_rare_110
L_recurrent_scan__compressed_kv_cla__moe_arch_mod__prompt_kernel_back_111:
    s_waitcnt lgkmcnt(5)
    v_mfma_f32_16x16x32_bf16 v[96:99], v[64:67], v[128:131], v[40:43]
    v_exp_f32 v112, v112
    v_mfma_f32_16x16x32_bf16 v[104:107], v[64:67], v[144:147], v[44:47]
    ds_read_b128 v[92:95], v2 offset:7168
    v_mfma_f32_16x16x32_bf16 v[96:99], v[68:71], v[132:135], v[96:99]
    v_exp_f32 v113, v113
    v_mfma_f32_16x16x32_bf16 v[104:107], v[68:71], v[148:151], v[104:107]
    ds_read_b128 v[64:67], v3 offset:0
    s_waitcnt lgkmcnt(5)
    v_mfma_f32_16x16x32_bf16 v[96:99], v[72:75], v[136:139], v[96:99]
    v_exp_f32 v114, v114
    v_mfma_f32_16x16x32_bf16 v[104:107], v[72:75], v[152:155], v[104:107]
    ds_read_b128 v[68:71], v3 offset:1024
    v_cvt_pk_bf16_f32 v56, v112, v113
    v_mfma_f32_16x16x32_bf16 v[96:99], v[76:79], v[140:143], v[96:99]
    v_exp_f32 v115, v115
    v_mfma_f32_16x16x32_bf16 v[104:107], v[76:79], v[156:159], v[104:107]
    ds_read_b128 v[72:75], v3 offset:2048
    s_waitcnt lgkmcnt(5)
    v_mfma_f32_16x16x32_bf16 v[100:103], v[80:83], v[128:131], v[40:43]
    v_exp_f32 v120, v120
    v_mfma_f32_16x16x32_bf16 v[108:111], v[80:83], v[144:147], v[44:47]
    ds_read_b128 v[76:79], v3 offset:3072
    v_cvt_pk_bf16_f32 v57, v114, v115
    v_mfma_f32_16x16x32_bf16 v[100:103], v[84:87], v[132:135], v[100:103]
    v_exp_f32 v121, v121
    v_mfma_f32_16x16x32_bf16 v[108:111], v[84:87], v[148:151], v[108:111]
    ds_read_b128 v[80:83], v3 offset:4096
    s_waitcnt lgkmcnt(5)
    v_mfma_f32_16x16x32_bf16 v[100:103], v[88:91], v[136:139], v[100:103]
    v_exp_f32 v122, v122
    v_mfma_f32_16x16x32_bf16 v[108:111], v[88:91], v[152:155], v[108:111]
    ds_read_b128 v[84:87], v3 offset:5120
    v_cvt_pk_bf16_f32 v60, v120, v121
    v_mfma_f32_16x16x32_bf16 v[100:103], v[92:95], v[140:143], v[100:103]
    v_exp_f32 v123, v123
    v_mfma_f32_16x16x32_bf16 v[108:111], v[92:95], v[156:159], v[108:111]
    ds_read_b128 v[88:91], v3 offset:6144
    s_waitcnt lgkmcnt(5)
    v_mfma_f32_16x16x32_bf16 v[192:195], v[64:67], v[48:51], v[192:195]
    v_exp_f32 v116, v116
    v_mfma_f32_16x16x32_bf16 v[224:227], v[64:67], v[52:55], v[224:227]
    ds_read_b128 v[92:95], v3 offset:7168
    v_cvt_pk_bf16_f32 v61, v122, v123
    v_mfma_f32_16x16x32_bf16 v[196:199], v[68:71], v[48:51], v[196:199]
    v_exp_f32 v117, v117
    v_mfma_f32_16x16x32_bf16 v[228:231], v[68:71], v[52:55], v[228:231]
    ds_read_b128 v[64:67], v2 offset:8192
    s_waitcnt lgkmcnt(5)
    v_mfma_f32_16x16x32_bf16 v[200:203], v[72:75], v[48:51], v[200:203]
    v_exp_f32 v118, v118
    v_mfma_f32_16x16x32_bf16 v[232:235], v[72:75], v[52:55], v[232:235]
    v_mfma_f32_16x16x32_bf16 v[28:31], v[36:39], v[48:51], v[28:31]
    ds_read_b128 v[68:71], v2 offset:9216
    v_cvt_pk_bf16_f32 v58, v116, v117
    v_mfma_f32_16x16x32_bf16 v[204:207], v[76:79], v[48:51], v[204:207]
    v_exp_f32 v119, v119
    v_mfma_f32_16x16x32_bf16 v[236:239], v[76:79], v[52:55], v[236:239]
    ds_read_b128 v[72:75], v2 offset:10240
    s_waitcnt lgkmcnt(5)
    v_mfma_f32_16x16x32_bf16 v[208:211], v[80:83], v[48:51], v[208:211]
    v_exp_f32 v124, v124
    buffer_load_dword v0, v13, s[4:7], s48 offen
    s_add_u32 s48, s48, 4096
    v_mfma_f32_16x16x32_bf16 v[240:243], v[80:83], v[52:55], v[240:243]
    ds_read_b128 v[76:79], v2 offset:11264
    v_cvt_pk_bf16_f32 v59, v118, v119
    v_mfma_f32_16x16x32_bf16 v[212:215], v[84:87], v[48:51], v[212:215]
    v_exp_f32 v125, v125
    v_mfma_f32_16x16x32_bf16 v[244:247], v[84:87], v[52:55], v[244:247]
    ds_read_b128 v[80:83], v2 offset:12288
    s_waitcnt lgkmcnt(5)
    v_mfma_f32_16x16x32_bf16 v[216:219], v[88:91], v[48:51], v[216:219]
    v_exp_f32 v126, v126
    v_mfma_f32_16x16x32_bf16 v[248:251], v[88:91], v[52:55], v[248:251]
    v_mfma_f32_16x16x32_bf16 v[32:35], v[36:39], v[52:55], v[32:35]
    ds_read_b128 v[84:87], v2 offset:13312
    v_cvt_pk_bf16_f32 v62, v124, v125
    v_mfma_f32_16x16x32_bf16 v[220:223], v[92:95], v[48:51], v[220:223]
    v_exp_f32 v127, v127
    v_mfma_f32_16x16x32_bf16 v[252:255], v[92:95], v[52:55], v[252:255]
    ds_read_b128 v[88:91], v2 offset:14336
    v_cvt_pk_bf16_f32 v63, v126, v127
    s_bitcmp1_b32 s42, s40
    s_cbranch_scc1 L_recurrent_scan__compressed_kv_cla__moe_arch_mod__prompt_kernel_rare_113
L_recurrent_scan__compressed_kv_cla__moe_arch_mod__prompt_kernel_back_114:
    s_waitcnt lgkmcnt(5)
    v_mfma_f32_16x16x32_bf16 v[112:115], v[64:67], v[128:131], v[40:43]
    v_exp_f32 v96, v96
    v_mfma_f32_16x16x32_bf16 v[120:123], v[64:67], v[144:147], v[44:47]
    ds_read_b128 v[92:95], v2 offset:15360
    v_mfma_f32_16x16x32_bf16 v[112:115], v[68:71], v[132:135], v[112:115]
    v_exp_f32 v97, v97
    v_mfma_f32_16x16x32_bf16 v[120:123], v[68:71], v[148:151], v[120:123]
    ds_read_b128 v[64:67], v3 offset:8192
    s_waitcnt lgkmcnt(5)
    v_mfma_f32_16x16x32_bf16 v[112:115], v[72:75], v[136:139], v[112:115]
    v_exp_f32 v98, v98
    v_mfma_f32_16x16x32_bf16 v[120:123], v[72:75], v[152:155], v[120:123]
    ds_read_b128 v[68:71], v3 offset:9216
    v_cvt_pk_bf16_f32 v48, v96, v97
    v_mfma_f32_16x16x32_bf16 v[112:115], v[76:79], v[140:143], v[112:115]
    v_exp_f32 v99, v99
    v_mfma_f32_16x16x32_bf16 v[120:123], v[76:79], v[156:159], v[120:123]
    ds_read_b128 v[72:75], v3 offset:10240
    s_waitcnt lgkmcnt(5)
    v_mfma_f32_16x16x32_bf16 v[116:119], v[80:83], v[128:131], v[40:43]
    v_exp_f32 v104, v104
    v_mfma_f32_16x16x32_bf16 v[124:127], v[80:83], v[144:147], v[44:47]
    ds_read_b128 v[76:79], v3 offset:11264
    v_cvt_pk_bf16_f32 v49, v98, v99
    v_mfma_f32_16x16x32_bf16 v[116:119], v[84:87], v[132:135], v[116:119]
    v_exp_f32 v105, v105
    v_mfma_f32_16x16x32_bf16 v[124:127], v[84:87], v[148:151], v[124:127]
    ds_read_b128 v[80:83], v3 offset:12288
    s_waitcnt lgkmcnt(5)
    v_mfma_f32_16x16x32_bf16 v[116:119], v[88:91], v[136:139], v[116:119]
    v_exp_f32 v106, v106
    v_mfma_f32_16x16x32_bf16 v[124:127], v[88:91], v[152:155], v[124:127]
    ds_read_b128 v[84:87], v3 offset:13312
    v_cvt_pk_bf16_f32 v52, v104, v105
    v_mfma_f32_16x16x32_bf16 v[116:119], v[92:95], v[140:143], v[116:119]
    v_exp_f32 v107, v107
    v_mfma_f32_16x16x32_bf16 v[124:127], v[92:95], v[156:159], v[124:127]
    ds_read_b128 v[88:91], v3 offset:14336
    s_waitcnt lgkmcnt(5)
    v_mfma_f32_16x16x32_bf16 v[192:195], v[64:67], v[56:59], v[192:195]
    v_exp_f32 v100, v100
    v_mfma_f32_16x16x32_bf16 v[224:227], v[64:67], v[60:63], v[224:227]
    ds_read_b128 v[92:95], v3 offset:15360
    v_cvt_pk_bf16_f32 v53, v106, v107
    v_mfma_f32_16x16x32_bf16 v[196:199], v[68:71], v[56:59], v[196:199]
    v_exp_f32 v101, v101
    v_mfma_f32_16x16x32_bf16 v[228:231], v[68:71], v[60:63], v[228:231]
    v_add_u32 v3, 65536, v2
    v_add_u32 v2, s41, v2
    s_waitcnt lgkmcnt(4)
    v_mfma_f32_16x16x32_bf16 v[200:203], v[72:75], v[56:59], v[200:203]
    v_exp_f32 v102, v102
    v_and_b32 v2, s49, v2
    v_mfma_f32_16x16x32_bf16 v[232:235], v[72:75], v[60:63], v[232:235]
    v_mfma_f32_16x16x32_bf16 v[28:31], v[36:39], v[56:59], v[28:31]
    v_cvt_pk_bf16_f32 v50, v100, v101
    s_waitcnt lgkmcnt(0)
    s_barrier
    v_mfma_f32_16x16x32_bf16 v[204:207], v[76:79], v[56:59], v[204:207]
    v_exp_f32 v103, v103
    v_mfma_f32_16x16x32_bf16 v[236:239], v[76:79], v[60:63], v[236:239]
    ds_read_b128 v[68:71], v2 offset:1024
    ds_read_b128 v[64:67], v2 offset:0
    v_mfma_f32_16x16x32_bf16 v[208:211], v[80:83], v[56:59], v[208:211]
    v_exp_f32 v108, v108
    v_mfma_f32_16x16x32_bf16 v[240:243], v[80:83], v[60:63], v[240:243]
    ds_read_b128 v[76:79], v2 offset:3072
    ds_read_b128 v[72:75], v2 offset:2048
    v_cvt_pk_bf16_f32 v51, v102, v103
    v_mfma_f32_16x16x32_bf16 v[212:215], v[84:87], v[56:59], v[212:215]
    v_exp_f32 v109, v109
    v_mfma_f32_16x16x32_bf16 v[244:247], v[84:87], v[60:63], v[244:247]
    ds_read_b128 v[80:83], v2 offset:4096
    v_mfma_f32_16x16x32_bf16 v[216:219], v[88:91], v[56:59], v[216:219]
    v_exp_f32 v110, v110
    v_mfma_f32_16x16x32_bf16 v[248:251], v[88:91], v[60:63], v[248:251]
    v_mfma_f32_16x16x32_bf16 v[32:35], v[36:39], v[60:63], v[32:35]
    ds_read_b128 v[84:87], v2 offset:5120
    v_cvt_pk_bf16_f32 v54, v108, v109
    v_mfma_f32_16x16x32_bf16 v[220:223], v[92:95], v[56:59], v[220:223]
    v_exp_f32 v111, v111
    v_mfma_f32_16x16x32_bf16 v[252:255], v[92:95], v[60:63], v[252:255]
    ds_read_b128 v[88:91], v2 offset:6144
    v_cvt_pk_bf16_f32 v55, v110, v111
    s_bitcmp1_b32 s42, s40
    s_cbranch_scc1 L_recurrent_scan__compressed_kv_cla__moe_arch_mod__prompt_kernel_rare_123
L_recurrent_scan__compressed_kv_cla__moe_arch_mod__prompt_kernel_back_124:
    s_add_u32 s40, s40, 1
    s_cmp_lg_u32 s40, 16
    s_cbranch_scc1 L_body1
    s_lshr_b32 s36, s2, 5
    s_add_u32 s36, s36, 48
    s_lshl_b32 s36, s36, 7
    v_mov_b32 v12, s36
    global_load_dword v11, v12, s[90:91] sc1
    s_sub_u32 s36, 96, s50
    s_cmp_lt_i32 s36, 0
    s_cbranch_scc0 L_recurrent_scan__compressed_kv_cla__moe_arch_mod__prompt_kernel_rare_116
L_recurrent_scan__compressed_kv_cla__moe_arch_mod__prompt_kernel_back_117:
    s_lshl_b32 s37, s28, 13
    v_add_u32 v5, s37, v7
    s_waitcnt lgkmcnt(5)
    v_mfma_f32_16x16x32_bf16 v[192:195], v[64:67], v[48:51], v[192:195]
    v_exp_f32 v112, v112
    v_mfma_f32_16x16x32_bf16 v[224:227], v[64:67], v[52:55], v[224:227]
    ds_read_b128 v[92:95], v3 offset:7168
    v_exp_f32 v113, v113
    v_mfma_f32_16x16x32_bf16 v[196:199], v[68:71], v[48:51], v[196:199]
    v_cvt_pk_bf16_f32 v56, v112, v113
    v_exp_f32 v114, v114
    v_mfma_f32_16x16x32_bf16 v[228:231], v[68:71], v[52:55], v[228:231]
    ds_read_b128 v[64:67], v3 offset:8192
    v_exp_f32 v115, v115
    s_waitcnt lgkmcnt(5)
    v_mfma_f32_16x16x32_bf16 v[200:203], v[72:75], v[48:51], v[200:203]
    v_cvt_pk_bf16_f32 v57, v114, v115
    v_exp_f32 v120, v120
    v_mfma_f32_16x16x32_bf16 v[232:235], v[72:75], v[52:55], v[232:235]
    v_mfma_f32_16x16x32_bf16 v[28:31], v[36:39], v[48:51], v[28:31]
    ds_read_b128 v[68:71], v3 offset:9216
    v_exp_f32 v121, v121
    v_mfma_f32_16x16x32_bf16 v[204:207], v[76:79], v[48:51], v[204:207]
    v_cvt_pk_bf16_f32 v60, v120, v121
    v_exp_f32 v122, v122
    v_mfma_f32_16x16x32_bf16 v[236:239], v[76:79], v[52:55], v[236:239]
    ds_read_b128 v[72:75], v3 offset:10240
    v_exp_f32 v123, v123
    s_waitcnt lgkmcnt(6)
    v_mfma_f32_16x16x32_bf16 v[208:211], v[80:83], v[48:51], v[208:211]
    v_cvt_pk_bf16_f32 v61, v122, v123
    v_exp_f32 v116, v116
    v_mfma_f32_16x16x32_bf16 v[240:243], v[80:83], v[52:55], v[240:243]
    ds_read_b128 v[76:79], v3 offset:11264
    v_exp_f32 v117, v117
    s_waitcnt lgkmcnt(6)
    v_mfma_f32_16x16x32_bf16 v[212:215], v[84:87], v[48:51], v[212:215]
    v_cvt_pk_bf16_f32 v58, v116, v117
    v_exp_f32 v118, v118
    v_mfma_f32_16x16x32_bf16 v[244:247], v[84:87], v[52:55], v[244:247]
    ds_read_b128 v[80:83], v3 offset:12288
    v_exp_f32 v119, v119
    s_waitcnt lgkmcnt(6)
    v_mfma_f32_16x16x32_bf16 v[216:219], v[88:91], v[48:51], v[216:219]
    v_cvt_pk_bf16_f32 v59, v118, v119
    v_exp_f32 v124, v124
    v_mfma_f32_16x16x32_bf16 v[248:251], v[88:91], v[52:55], v[248:251]
    v_mfma_f32_16x16x32_bf16 v[32:35], v[36:39], v[52:55], v[32:35]
    ds_read_b128 v[84:87], v3 offset:13312
    v_exp_f32 v125, v125
    s_waitcnt lgkmcnt(6)
    v_mfma_f32_16x16x32_bf16 v[220:223], v[92:95], v[48:51], v[220:223]
    v_cvt_pk_bf16_f32 v62, v124, v125
    v_exp_f32 v126, v126
    v_mfma_f32_16x16x32_bf16 v[252:255], v[92:95], v[52:55], v[252:255]
    ds_read_b128 v[88:91], v3 offset:14336
    v_exp_f32 v127, v127
    s_nop 0
    v_cvt_pk_bf16_f32 v63, v126, v127
    s_nop 1
    s_waitcnt lgkmcnt(6)
    v_mfma_f32_16x16x32_bf16 v[192:195], v[64:67], v[56:59], v[192:195]
    s_mov_b32 s4, s34
    s_and_b32 s5, s35, 0xffff
    s_mov_b32 s6, 7340032
    s_mov_b32 s7, 0x20000
    s_mov_b32 s8, s32
    v_mfma_f32_16x16x32_bf16 v[224:227], v[64:67], v[60:63], v[224:227]
    ds_read_b128 v[92:95], v3 offset:15360
    s_and_b32 s9, s33, 0xffff
    s_mov_b32 s10, 8388608
    s_mov_b32 s11, 0x20000
    s_lshr_b32 s38, s2, 4
    s_waitcnt lgkmcnt(6)
    v_mfma_f32_16x16x32_bf16 v[196:199], v[68:71], v[56:59], v[196:199]
    s_mul_i32 s38, s38, 224
    s_and_b32 s39, s2, 15
    s_lshl_b32 s39, s39, 7
    v_lshrrev_b32 v25, 3, v1
    s_lshl_b32 s36, s28, 5
    v_mfma_f32_16x16x32_bf16 v[228:231], v[68:71], v[60:63], v[228:231]
    s_add_u32 s36, s36, s38
    v_add_u32 v25, s36, v25
    v_mul_u32_u24 v25, 2048, v25
    v_add_u32 v25, s39, v25
    s_waitcnt lgkmcnt(5)
    v_mfma_f32_16x16x32_bf16 v[200:203], v[72:75], v[56:59], v[200:203]
    v_bfe_u32 v26, v1, 4, 1
    v_lshlrev_b32 v26, 1, v26
    v_and_b32 v27, 7, v1
    v_xor_b32 v26, v26, v27
    v_mfma_f32_16x16x32_bf16 v[232:235], v[72:75], v[60:63], v[232:235]
    v_mfma_f32_16x16x32_bf16 v[28:31], v[36:39], v[56:59], v[28:31]
    v_lshl_add_u32 v24, v26, 4, v25
    v_xor_b32 v26, 4, v26
    v_lshl_add_u32 v25, v26, 4, v25
    v_add_u32 v25, 15360, v25
    v_add_u32 v26, 30720, v24
    s_waitcnt lgkmcnt(4)
    v_mfma_f32_16x16x32_bf16 v[204:207], v[76:79], v[56:59], v[204:207]
    v_add_u32 v27, 30720, v25
    s_lshl_b32 s36, s28, 12
    s_add_u32 s36, s36, 131072
    s_cmp_lt_u32 s28, 7
    s_cselect_b32 m0, s36, 0x30000
    s_cselect_b32 s6, 7340032, 0
    v_mfma_f32_16x16x32_bf16 v[236:239], v[76:79], v[60:63], v[236:239]
    buffer_load_dwordx4 v24, s[4:7], 0 offen offset:0 lds
    buffer_load_dwordx4 v25, s[4:7], 0 offen offset:1024 lds
    buffer_load_dwordx4 v26, s[4:7], 0 offen offset:2048 lds
    buffer_load_dwordx4 v27, s[4:7], 0 offen offset:3072 lds
    s_waitcnt lgkmcnt(3)
    v_mfma_f32_16x16x32_bf16 v[208:211], v[80:83], v[56:59], v[208:211]
    v_mfma_f32_16x16x32_bf16 v[240:243], v[80:83], v[60:63], v[240:243]
    ds_write_b128 v5, v[192:195] offset:0
    s_waitcnt lgkmcnt(3)
    v_mfma_f32_16x16x32_bf16 v[212:215], v[84:87], v[56:59], v[212:215]
    v_mfma_f32_16x16x32_bf16 v[244:247], v[84:87], v[60:63], v[244:247]
    ds_write_b128 v5, v[196:199] offset:1024
    s_waitcnt lgkmcnt(3)
    v_mfma_f32_16x16x32_bf16 v[216:219], v[88:91], v[56:59], v[216:219]
    v_mfma_f32_16x16x32_bf16 v[248:251], v[88:91], v[60:63], v[248:251]
    v_mfma_f32_16x16x32_bf16 v[32:35], v[36:39], v[60:63], v[32:35]
    ds_write_b128 v5, v[200:203] offset:2048
    s_waitcnt lgkmcnt(3)
    v_mfma_f32_16x16x32_bf16 v[220:223], v[92:95], v[56:59], v[220:223]
    v_mfma_f32_16x16x32_bf16 v[252:255], v[92:95], v[60:63], v[252:255]
    ds_write_b128 v5, v[204:207] offset:3072
    ds_write_b128 v5, v[208:211] offset:4096
    ds_write_b128 v5, v[212:215] offset:5120
    v_xor_b32 v106, 32768, v5
    s_lshl_b32 s37, s28, 8
    s_add_u32 s37, s37, 159744
    v_lshl_add_u32 v107, v1, 2, s37
    v_xor_b32 v108, 1024, v107
    ds_write_b128 v5, v[216:219] offset:6144
    ds_write_b128 v5, v[220:223] offset:7168
    ds_write_b32 v107, v28
    s_mov_b32 s36, 0x5d800000
    v_cmp_nge_f32 vcc, s36, v28
    s_nop 0
    s_or_b64 s[52:53], s[52:53], vcc
    v_cmp_nge_f32 vcc, s36, v32
    s_nop 0
    s_or_b64 s[52:53], s[52:53], vcc
    s_or_b32 s36, s52, s53
    v_mov_b32 v110, s36
    s_lshl_b32 s37, s28, 2
    s_add_u32 s37, s37, 161792
    v_mov_b32 v111, s37
    ds_write_b32 v111, v110
    v_mov_b32 v112, 161856
    v_and_b32 v111, 7, v1
    v_lshlrev_b32 v111, 2, v111
    v_add_u32 v111, 161792, v111
    v_mov_b32 v113, v7
    s_sub_u32 s36, 15, s30
    s_lshl_b32 s38, s36, 3
    s_and_b32 s37, s28, 3
    s_lshl_b32 s37, s37, 1
    s_add_u32 s38, s38, s37
    s_add_u32 s38, s38, 1
    s_lshl_b32 s38, s38, 17
    s_lshl_b32 s37, s29, 12
    s_add_u32 s38, s38, s37
    s_waitcnt vmcnt(4)
    v_readfirstlane_b32 s36, v11
    s_nop 0
    s_cmp_lt_u32 s36, 28
    s_cbranch_scc1 L_recurrent_scan__compressed_kv_cla__moe_arch_mod__prompt_kernel_rare_127
L_recurrent_scan__compressed_kv_cla__moe_arch_mod__prompt_kernel_back_128:
    s_lshr_b32 s36, s2, 4
    s_mul_i32 s36, s36, 7
    s_min_u32 s37, s28, 6
    s_add_u32 s36, s36, s37
    s_lshl_b32 s36, s36, 11
    s_add_u32 s36, s36, 58720256
    v_and_b32 v11, 15, v1
    v_lshlrev_b32 v11, 4, v11
    v_lshrrev_b32 v12, 4, v1
    v_lshl_add_u32 v11, v12, 9, v11
    buffer_load_dwordx4 v[96:99], v11, s[24:27], s36 offen offset:0 sc1
    buffer_load_dwordx4 v[100:103], v11, s[24:27], s36 offen offset:256 sc1
    s_waitcnt lgkmcnt(0)
    s_barrier
    ds_read_b128 v[114:117], v112
    ds_read_b32 v110, v111
    ds_read_b32 v109, v108
    ds_read_b128 v[64:67], v106 offset:0
    ds_read_b128 v[68:71], v106 offset:1024
    ds_read_b128 v[72:75], v106 offset:2048
    ds_read_b128 v[76:79], v106 offset:3072
    ds_read_b128 v[80:83], v106 offset:4096
    ds_read_b128 v[84:87], v106 offset:5120
    ds_read_b128 v[88:91], v106 offset:6144
    ds_read_b128 v[92:95], v106 offset:7168
    s_waitcnt lgkmcnt(8)
    v_add_f32 v109, v109, v32
    v_cmp_ne_u32 s[52:53], 0, v110
    v_readfirstlane_b32 s56, v114
    v_readfirstlane_b32 s57, v115
    v_readfirstlane_b32 s58, v116
    v_readfirstlane_b32 s59, v117
    v_rcp_f32 v109, v109
    s_nop 0
    v_mov_b32 v108, v109
    s_waitcnt lgkmcnt(6)
    v_pk_add_f32 v[224:225], v[224:225], v[64:65]
    v_pk_add_f32 v[226:227], v[226:227], v[66:67]
    v_pk_add_f32 v[228:229], v[228:229], v[68:69]
    v_pk_add_f32 v[230:231], v[230:231], v[70:71]
    v_pk_mul_f32 v[224:225], v[224:225], v[108:109]
    v_pk_mul_f32 v[226:227], v[226:227], v[108:109]
    v_pk_mul_f32 v[228:229], v[228:229], v[108:109]
    v_pk_mul_f32 v[230:231], v[230:231], v[108:109]
    v_cvt_pk_bf16_f32 v48, v224, v225
    v_cvt_pk_bf16_f32 v49, v226, v227
    v_cvt_pk_bf16_f32 v50, v228, v229
    v_cvt_pk_bf16_f32 v51, v230, v231
    buffer_store_dwordx4 v[48:51], v113, s[16:19], s38 offen offset:0 sc1
    s_waitcnt lgkmcnt(4)
    v_pk_add_f32 v[232:233], v[232:233], v[72:73]
    v_pk_add_f32 v[234:235], v[234:235], v[74:75]
    v_pk_add_f32 v[236:237], v[236:237], v[76:77]
    v_pk_add_f32 v[238:239], v[238:239], v[78:79]
    v_pk_mul_f32 v[232:233], v[232:233], v[108:109]
    v_pk_mul_f32 v[234:235], v[234:235], v[108:109]
    v_pk_mul_f32 v[236:237], v[236:237], v[108:109]
    v_pk_mul_f32 v[238:239], v[238:239], v[108:109]
    v_cvt_pk_bf16_f32 v52, v232, v233
    v_cvt_pk_bf16_f32 v53, v234, v235
    v_cvt_pk_bf16_f32 v54, v236, v237
    v_cvt_pk_bf16_f32 v55, v238, v239
    buffer_store_dwordx4 v[52:55], v113, s[16:19], s38 offen offset:1024 sc1
    s_waitcnt lgkmcnt(2)
    v_pk_add_f32 v[240:241], v[240:241], v[80:81]
    v_pk_add_f32 v[242:243], v[242:243], v[82:83]
    v_pk_add_f32 v[244:245], v[244:245], v[84:85]
    v_pk_add_f32 v[246:247], v[246:247], v[86:87]
    v_pk_mul_f32 v[240:241], v[240:241], v[108:109]
    v_pk_mul_f32 v[242:243], v[242:243], v[108:109]
    v_pk_mul_f32 v[244:245], v[244:245], v[108:109]
    v_pk_mul_f32 v[246:247], v[246:247], v[108:109]
    v_cvt_pk_bf16_f32 v56, v240, v241
    v_cvt_pk_bf16_f32 v57, v242, v243
    v_cvt_pk_bf16_f32 v58, v244, v245
    v_cvt_pk_bf16_f32 v59, v246, v247
    buffer_store_dwordx4 v[56:59], v113, s[16:19], s38 offen offset:2048 sc1
    s_waitcnt lgkmcnt(0)
    v_pk_add_f32 v[248:249], v[248:249], v[88:89]
    v_pk_add_f32 v[250:251], v[250:251], v[90:91]
    v_pk_add_f32 v[252:253], v[252:253], v[92:93]
    v_pk_add_f32 v[254:255], v[254:255], v[94:95]
    v_pk_mul_f32 v[248:249], v[248:249], v[108:109]
    v_pk_mul_f32 v[250:251], v[250:251], v[108:109]
    v_pk_mul_f32 v[252:253], v[252:253], v[108:109]
    v_pk_mul_f32 v[254:255], v[254:255], v[108:109]
    v_cvt_pk_bf16_f32 v60, v248, v249
    v_cvt_pk_bf16_f32 v61, v250, v251
    v_cvt_pk_bf16_f32 v62, v252, v253
    v_cvt_pk_bf16_f32 v63, v254, v255
    buffer_store_dwordx4 v[60:63], v113, s[16:19], s38 offen offset:3072 sc1
    s_cmp_eq_u64 s[52:53], 0
    s_cbranch_scc1 L_p3_done
    s_waitcnt vmcnt(0)
    v_mov_b32 v112, v96
    v_mov_b32 v113, v97
    v_mov_b32 v114, v98
    v_mov_b32 v115, v99
    v_mov_b32 v116, v100
    v_mov_b32 v117, v101
    v_mov_b32 v118, v102
    v_mov_b32 v119, v103
    v_swap_b32 v128, v160
    v_swap_b32 v129, v161
    v_swap_b32 v130, v162
    v_swap_b32 v131, v163
    v_swap_b32 v132, v164
    v_swap_b32 v133, v165
    v_swap_b32 v134, v166
    v_swap_b32 v135, v167
    v_swap_b32 v136, v168
    v_swap_b32 v137, v169
    v_swap_b32 v138, v170
    v_swap_b32 v139, v171
    v_swap_b32 v140, v172
    v_swap_b32 v141, v173
    v_swap_b32 v142, v174
    v_swap_b32 v143, v175
    v_swap_b32 v144, v176
    v_swap_b32 v145, v177
    v_swap_b32 v146, v178
    v_swap_b32 v147, v179
    v_swap_b32 v148, v180
    v_swap_b32 v149, v181
    v_swap_b32 v150, v182
    v_swap_b32 v151, v183
    v_swap_b32 v152, v184
    v_swap_b32 v153, v185
    v_swap_b32 v154, v186
    v_swap_b32 v155, v187
    v_swap_b32 v156, v188
    v_swap_b32 v157, v189
    v_swap_b32 v158, v190
    v_swap_b32 v159, v191
    v_mov_b32 v192, 0
    v_mov_b32 v193, 0
    v_mov_b32 v194, 0
    v_mov_b32 v195, 0
    v_mov_b32 v196, 0
    v_mov_b32 v197, 0
    v_mov_b32 v198, 0
    v_mov_b32 v199, 0
    v_mov_b32 v200, 0
    v_mov_b32 v201, 0
    v_mov_b32 v202, 0
    v_mov_b32 v203, 0
    v_mov_b32 v204, 0
    v_mov_b32 v205, 0
    v_mov_b32 v206, 0
    v_mov_b32 v207, 0
    v_mov_b32 v208, 0
    v_mov_b32 v209, 0
    v_mov_b32 v210, 0
    v_mov_b32 v211, 0
    v_mov_b32 v212, 0
    v_mov_b32 v213, 0
    v_mov_b32 v214, 0
    v_mov_b32 v215, 0
    v_mov_b32 v216, 0
    v_mov_b32 v217, 0
    v_mov_b32 v218, 0
    v_mov_b32 v219, 0
    v_mov_b32 v220, 0
    v_mov_b32 v221, 0
    v_mov_b32 v222, 0
    v_mov_b32 v223, 0
    v_mov_b32 v224, 0
    v_mov_b32 v225, 0
    v_mov_b32 v226, 0
    v_mov_b32 v227, 0
    v_mov_b32 v228, 0
    v_mov_b32 v229, 0
    v_mov_b32 v230, 0
    v_mov_b32 v231, 0
    v_mov_b32 v232, 0
    v_mov_b32 v233, 0
    v_mov_b32 v234, 0
    v_mov_b32 v235, 0
    v_mov_b32 v236, 0
    v_mov_b32 v237, 0
    v_mov_b32 v238, 0
    v_mov_b32 v239, 0
    v_mov_b32 v240, 0
    v_mov_b32 v241, 0
    v_mov_b32 v242, 0
    v_mov_b32 v243, 0
    v_mov_b32 v244, 0
    v_mov_b32 v245, 0
    v_mov_b32 v246, 0
    v_mov_b32 v247, 0
    v_mov_b32 v248, 0
    v_mov_b32 v249, 0
    v_mov_b32 v250, 0
    v_mov_b32 v251, 0
    v_mov_b32 v252, 0
    v_mov_b32 v253, 0
    v_mov_b32 v254, 0
    v_mov_b32 v255, 0
    v_mov_b32 v28, 0
    v_mov_b32 v40, 4048155338
    v_mov_b32 v32, 0
    v_mov_b32 v41, 4048155338
    s_lshl_b32 s43, s28, 12
    v_add_u32 v4, s43, v7
    s_mov_b32 s46, s45
    s_sub_u32 s40, 16, s30
    s_mov_b32 s39, s30
    s_lshl_b32 s37, s39, 7
    s_and_b32 s36, s28, 3
    s_lshl_b32 s36, s36, 5
    s_add_u32 s36, s36, s37
    s_sub_u32 s50, 0, s36
L_recurrent_scan__compressed_kv_cla__moe_arch_mod__prompt_kernel_stile_129:
    s_waitcnt vmcnt(0) lgkmcnt(0)
    s_barrier
    s_mov_b32 m0, s43
    s_add_u32 s47, s46, 32768
    buffer_load_dwordx4 v4, s[12:15], s46 offen offset:0 sc1 lds
    buffer_load_dwordx4 v4, s[12:15], s46 offen offset:1024 sc1 lds
    buffer_load_dwordx4 v4, s[12:15], s46 offen offset:2048 sc1 lds
    buffer_load_dwordx4 v4, s[12:15], s46 offen offset:3072 sc1 lds
    s_add_u32 m0, s43, 32768
    s_add_u32 s46, s46, 65536
    buffer_load_dwordx4 v4, s[12:15], s47 offen offset:0 sc1 lds
    buffer_load_dwordx4 v4, s[12:15], s47 offen offset:1024 sc1 lds
    buffer_load_dwordx4 v4, s[12:15], s47 offen offset:2048 sc1 lds
    buffer_load_dwordx4 v4, s[12:15], s47 offen offset:3072 sc1 lds
    v_mov_b32 v2, v7
    s_mov_b32 s41, 4
    s_waitcnt vmcnt(0)
    s_barrier
L_recurrent_scan__compressed_kv_cla__moe_arch_mod__prompt_kernel_sunit_130:
    s_cmp_gt_i32 s50, 0
    s_cbranch_scc1 L_recurrent_scan__compressed_kv_cla__moe_arch_mod__prompt_kernel_snext_131
    ds_read_b128 v[64:67], v2 offset:0
    ds_read_b128 v[68:71], v2 offset:1024
    ds_read_b128 v[72:75], v2 offset:2048
    ds_read_b128 v[76:79], v2 offset:3072
    ds_read_b128 v[80:83], v2 offset:4096
    ds_read_b128 v[84:87], v2 offset:5120
    ds_read_b128 v[88:91], v2 offset:6144
    ds_read_b128 v[92:95], v2 offset:7168
    s_waitcnt lgkmcnt(0)
    v_mfma_f32_16x16x32_bf16 v[96:99], v[64:67], v[128:131], 0
    v_mfma_f32_16x16x32_bf16 v[104:107], v[64:67], v[144:147], 0
    v_mfma_f32_16x16x32_bf16 v[96:99], v[68:71], v[132:135], v[96:99]
    v_mfma_f32_16x16x32_bf16 v[104:107], v[68:71], v[148:151], v[104:107]
    v_mfma_f32_16x16x32_bf16 v[96:99], v[72:75], v[136:139], v[96:99]
    v_mfma_f32_16x16x32_bf16 v[104:107], v[72:75], v[152:155], v[104:107]
    v_mfma_f32_16x16x32_bf16 v[96:99], v[76:79], v[140:143], v[96:99]
    v_mfma_f32_16x16x32_bf16 v[104:107], v[76:79], v[156:159], v[104:107]
    v_mfma_f32_16x16x32_bf16 v[100:103], v[80:83], v[128:131], 0
    v_mfma_f32_16x16x32_bf16 v[108:111], v[80:83], v[144:147], 0
    v_mfma_f32_16x16x32_bf16 v[100:103], v[84:87], v[132:135], v[100:103]
    v_mfma_f32_16x16x32_bf16 v[108:111], v[84:87], v[148:151], v[108:111]
    v_mfma_f32_16x16x32_bf16 v[100:103], v[88:91], v[136:139], v[100:103]
    v_mfma_f32_16x16x32_bf16 v[108:111], v[88:91], v[152:155], v[108:111]
    v_mfma_f32_16x16x32_bf16 v[100:103], v[92:95], v[140:143], v[100:103]
    v_mfma_f32_16x16x32_bf16 v[108:111], v[92:95], v[156:159], v[108:111]
    ds_read_b128 v[64:67], v2 offset:32768
    ds_read_b128 v[68:71], v2 offset:33792
    ds_read_b128 v[72:75], v2 offset:34816
    ds_read_b128 v[76:79], v2 offset:35840
    ds_read_b128 v[80:83], v2 offset:36864
    ds_read_b128 v[84:87], v2 offset:37888
    ds_read_b128 v[88:91], v2 offset:38912
    ds_read_b128 v[92:95], v2 offset:39936
    s_nop 1
    s_cmp_lt_i32 s50, 0
    s_cbranch_scc0 L_recurrent_scan__compressed_kv_cla__moe_arch_mod__prompt_kernel_rare_132
L_recurrent_scan__compressed_kv_cla__moe_arch_mod__prompt_kernel_back_133:
    v_max3_f32 v22, v96, v97, v98
    v_max3_f32 v22, v22, v99, v100
    v_max3_f32 v22, v22, v101, v102
    v_max3_f32 v22, v22, v103, v40
    v_mov_b32 v24, v22
    s_nop 1
    v_permlane16_swap_b32 v22, v24
    s_nop 1
    v_max_f32 v22, v22, v24
    v_mov_b32 v24, v22
    s_nop 1
    v_permlane32_swap_b32 v22, v24
    s_nop 1
    v_max_f32 v22, v22, v24
    v_sub_f32 v25, v40, v22
    v_exp_f32 v25, v25
    v_mov_b32 v40, v22
    v_mul_f32 v28, v28, v25
    v_mul_f32 v192, v192, v25
    v_mul_f32 v193, v193, v25
    v_mul_f32 v194, v194, v25
    v_mul_f32 v195, v195, v25
    v_mul_f32 v196, v196, v25
    v_mul_f32 v197, v197, v25
    v_mul_f32 v198, v198, v25
    v_mul_f32 v199, v199, v25
    v_mul_f32 v200, v200, v25
    v_mul_f32 v201, v201, v25
    v_mul_f32 v202, v202, v25
    v_mul_f32 v203, v203, v25
    v_mul_f32 v204, v204, v25
    v_mul_f32 v205, v205, v25
    v_mul_f32 v206, v206, v25
    v_mul_f32 v207, v207, v25
    v_mul_f32 v208, v208, v25
    v_mul_f32 v209, v209, v25
    v_mul_f32 v210, v210, v25
    v_mul_f32 v211, v211, v25
    v_mul_f32 v212, v212, v25
    v_mul_f32 v213, v213, v25
    v_mul_f32 v214, v214, v25
    v_mul_f32 v215, v215, v25
    v_mul_f32 v216, v216, v25
    v_mul_f32 v217, v217, v25
    v_mul_f32 v218, v218, v25
    v_mul_f32 v219, v219, v25
    v_mul_f32 v220, v220, v25
    v_mul_f32 v221, v221, v25
    v_mul_f32 v222, v222, v25
    v_mul_f32 v223, v223, v25
    v_sub_f32 v96, v96, v22
    v_sub_f32 v97, v97, v22
    v_sub_f32 v98, v98, v22
    v_sub_f32 v99, v99, v22
    v_sub_f32 v100, v100, v22
    v_sub_f32 v101, v101, v22
    v_sub_f32 v102, v102, v22
    v_sub_f32 v103, v103, v22
    v_max3_f32 v23, v104, v105, v106
    v_max3_f32 v23, v23, v107, v108
    v_max3_f32 v23, v23, v109, v110
    v_max3_f32 v23, v23, v111, v41
    v_mov_b32 v24, v23
    s_nop 1
    v_permlane16_swap_b32 v23, v24
    s_nop 1
    v_max_f32 v23, v23, v24
    v_mov_b32 v24, v23
    s_nop 1
    v_permlane32_swap_b32 v23, v24
    s_nop 1
    v_max_f32 v23, v23, v24
    v_sub_f32 v25, v41, v23
    v_exp_f32 v25, v25
    v_mov_b32 v41, v23
    v_mul_f32 v32, v32, v25
    v_mul_f32 v224, v224, v25
    v_mul_f32 v225, v225, v25
    v_mul_f32 v226, v226, v25
    v_mul_f32 v227, v227, v25
    v_mul_f32 v228, v228, v25
    v_mul_f32 v229, v229, v25
    v_mul_f32 v230, v230, v25
    v_mul_f32 v231, v231, v25
    v_mul_f32 v232, v232, v25
    v_mul_f32 v233, v233, v25
    v_mul_f32 v234, v234, v25
    v_mul_f32 v235, v235, v25
    v_mul_f32 v236, v236, v25
    v_mul_f32 v237, v237, v25
    v_mul_f32 v238, v238, v25
    v_mul_f32 v239, v239, v25
    v_mul_f32 v240, v240, v25
    v_mul_f32 v241, v241, v25
    v_mul_f32 v242, v242, v25
    v_mul_f32 v243, v243, v25
    v_mul_f32 v244, v244, v25
    v_mul_f32 v245, v245, v25
    v_mul_f32 v246, v246, v25
    v_mul_f32 v247, v247, v25
    v_mul_f32 v248, v248, v25
    v_mul_f32 v249, v249, v25
    v_mul_f32 v250, v250, v25
    v_mul_f32 v251, v251, v25
    v_mul_f32 v252, v252, v25
    v_mul_f32 v253, v253, v25
    v_mul_f32 v254, v254, v25
    v_mul_f32 v255, v255, v25
    v_sub_f32 v104, v104, v23
    v_sub_f32 v105, v105, v23
    v_sub_f32 v106, v106, v23
    v_sub_f32 v107, v107, v23
    v_sub_f32 v108, v108, v23
    v_sub_f32 v109, v109, v23
    v_sub_f32 v110, v110, v23
    v_sub_f32 v111, v111, v23
    v_exp_f32 v96, v96
    v_exp_f32 v97, v97
    v_exp_f32 v98, v98
    v_exp_f32 v99, v99
    v_exp_f32 v104, v104
    v_exp_f32 v105, v105
    v_exp_f32 v106, v106
    v_exp_f32 v107, v107
    v_exp_f32 v100, v100
    v_exp_f32 v101, v101
    v_exp_f32 v102, v102
    v_exp_f32 v103, v103
    v_exp_f32 v108, v108
    v_exp_f32 v109, v109
    v_exp_f32 v110, v110
    v_exp_f32 v111, v111
    v_add_f32 v28, v28, v96
    v_add_f32 v28, v28, v97
    v_cvt_pk_bf16_f32 v48, v96, v97
    v_add_f32 v28, v28, v98
    v_add_f32 v28, v28, v99
    v_cvt_pk_bf16_f32 v49, v98, v99
    v_add_f32 v32, v32, v104
    v_add_f32 v32, v32, v105
    v_cvt_pk_bf16_f32 v52, v104, v105
    v_add_f32 v32, v32, v106
    v_add_f32 v32, v32, v107
    v_cvt_pk_bf16_f32 v53, v106, v107
    v_add_f32 v28, v28, v100
    v_add_f32 v28, v28, v101
    v_cvt_pk_bf16_f32 v50, v100, v101
    v_add_f32 v28, v28, v102
    v_add_f32 v28, v28, v103
    v_cvt_pk_bf16_f32 v51, v102, v103
    v_add_f32 v32, v32, v108
    v_add_f32 v32, v32, v109
    v_cvt_pk_bf16_f32 v54, v108, v109
    v_add_f32 v32, v32, v110
    v_add_f32 v32, v32, v111
    v_cvt_pk_bf16_f32 v55, v110, v111
    s_waitcnt lgkmcnt(0)
    s_nop 0
    v_mfma_f32_16x16x32_bf16 v[192:195], v[64:67], v[48:51], v[192:195]
    v_mfma_f32_16x16x32_bf16 v[224:227], v[64:67], v[52:55], v[224:227]
    v_mfma_f32_16x16x32_bf16 v[196:199], v[68:71], v[48:51], v[196:199]
    v_mfma_f32_16x16x32_bf16 v[228:231], v[68:71], v[52:55], v[228:231]
    v_mfma_f32_16x16x32_bf16 v[200:203], v[72:75], v[48:51], v[200:203]
    v_mfma_f32_16x16x32_bf16 v[232:235], v[72:75], v[52:55], v[232:235]
    v_mfma_f32_16x16x32_bf16 v[204:207], v[76:79], v[48:51], v[204:207]
    v_mfma_f32_16x16x32_bf16 v[236:239], v[76:79], v[52:55], v[236:239]
    v_mfma_f32_16x16x32_bf16 v[208:211], v[80:83], v[48:51], v[208:211]
    v_mfma_f32_16x16x32_bf16 v[240:243], v[80:83], v[52:55], v[240:243]
    v_mfma_f32_16x16x32_bf16 v[212:215], v[84:87], v[48:51], v[212:215]
    v_mfma_f32_16x16x32_bf16 v[244:247], v[84:87], v[52:55], v[244:247]
    v_mfma_f32_16x16x32_bf16 v[216:219], v[88:91], v[48:51], v[216:219]
    v_mfma_f32_16x16x32_bf16 v[248:251], v[88:91], v[52:55], v[248:251]
    v_mfma_f32_16x16x32_bf16 v[220:223], v[92:95], v[48:51], v[220:223]
    v_mfma_f32_16x16x32_bf16 v[252:255], v[92:95], v[52:55], v[252:255]
L_recurrent_scan__compressed_kv_cla__moe_arch_mod__prompt_kernel_snext_131:
    v_add_u32 v2, 8192, v2
    s_add_u32 s50, s50, 32
    s_sub_u32 s41, s41, 1
    s_cmp_lg_u32 s41, 0
    s_cbranch_scc1 L_recurrent_scan__compressed_kv_cla__moe_arch_mod__prompt_kernel_sunit_130
    s_sub_u32 s40, s40, 1
    s_cmp_lg_u32 s40, 0
    s_cbranch_scc1 L_recurrent_scan__compressed_kv_cla__moe_arch_mod__prompt_kernel_stile_129
    v_mov_b32 v20, v28
    s_nop 1
    v_permlane16_swap_b32 v28, v20
    s_nop 1
    v_add_f32 v28, v28, v20
    v_mov_b32 v20, v28
    s_nop 1
    v_permlane32_swap_b32 v28, v20
    s_nop 1
    v_add_f32 v28, v28, v20
    v_mov_b32 v20, v32
    s_nop 1
    v_permlane16_swap_b32 v32, v20
    s_nop 1
    v_add_f32 v32, v32, v20
    v_mov_b32 v20, v32
    s_nop 1
    v_permlane32_swap_b32 v32, v20
    s_nop 1
    v_add_f32 v32, v32, v20
    s_mov_b32 s36, 0x5d800000
    v_cmp_nge_f32 vcc, s36, v28
    s_nop 0
    s_or_b64 s[52:53], s[52:53], vcc
    v_cmp_nge_f32 vcc, s36, v32
    s_nop 0
    s_or_b64 s[52:53], s[52:53], vcc
    v_rcp_f32 v20, v28
    v_rcp_f32 v22, v32
    s_lshl_b32 s38, s39, 3
    s_and_b32 s37, s28, 3
    s_lshl_b32 s37, s37, 1
    s_add_u32 s38, s38, s37
    s_lshl_b32 s38, s38, 17
    s_lshl_b32 s37, s29, 12
    s_add_u32 s38, s38, s37
    v_mov_b32 v21, v20
    v_mov_b32 v23, v22
    v_mov_b32 v24, v7
    v_pk_mul_f32 v[192:193], v[192:193], v[20:21]
    v_pk_mul_f32 v[194:195], v[194:195], v[20:21]
    v_pk_mul_f32 v[196:197], v[196:197], v[20:21]
    v_pk_mul_f32 v[198:199], v[198:199], v[20:21]
    v_cvt_pk_bf16_f32 v192, v192, v193
    v_cvt_pk_bf16_f32 v193, v194, v195
    v_cvt_pk_bf16_f32 v194, v196, v197
    v_cvt_pk_bf16_f32 v195, v198, v199
    buffer_store_dwordx4 v[192:195], v24, s[16:19], s38 offen offset:0 sc1
    v_pk_mul_f32 v[200:201], v[200:201], v[20:21]
    v_pk_mul_f32 v[202:203], v[202:203], v[20:21]
    v_pk_mul_f32 v[204:205], v[204:205], v[20:21]
    v_pk_mul_f32 v[206:207], v[206:207], v[20:21]
    v_cvt_pk_bf16_f32 v200, v200, v201
    v_cvt_pk_bf16_f32 v201, v202, v203
    v_cvt_pk_bf16_f32 v202, v204, v205
    v_cvt_pk_bf16_f32 v203, v206, v207
    buffer_store_dwordx4 v[200:203], v24, s[16:19], s38 offen offset:1024 sc1
    v_pk_mul_f32 v[208:209], v[208:209], v[20:21]
    v_pk_mul_f32 v[210:211], v[210:211], v[20:21]
    v_pk_mul_f32 v[212:213], v[212:213], v[20:21]
    v_pk_mul_f32 v[214:215], v[214:215], v[20:21]
    v_cvt_pk_bf16_f32 v208, v208, v209
    v_cvt_pk_bf16_f32 v209, v210, v211
    v_cvt_pk_bf16_f32 v210, v212, v213
    v_cvt_pk_bf16_f32 v211, v214, v215
    buffer_store_dwordx4 v[208:211], v24, s[16:19], s38 offen offset:2048 sc1
    v_pk_mul_f32 v[216:217], v[216:217], v[20:21]
    v_pk_mul_f32 v[218:219], v[218:219], v[20:21]
    v_pk_mul_f32 v[220:221], v[220:221], v[20:21]
    v_pk_mul_f32 v[222:223], v[222:223], v[20:21]
    v_cvt_pk_bf16_f32 v216, v216, v217
    v_cvt_pk_bf16_f32 v217, v218, v219
    v_cvt_pk_bf16_f32 v218, v220, v221
    v_cvt_pk_bf16_f32 v219, v222, v223
    buffer_store_dwordx4 v[216:219], v24, s[16:19], s38 offen offset:3072 sc1
    s_add_u32 s38, s38, 131072
    v_pk_mul_f32 v[224:225], v[224:225], v[22:23]
    v_pk_mul_f32 v[226:227], v[226:227], v[22:23]
    v_pk_mul_f32 v[228:229], v[228:229], v[22:23]
    v_pk_mul_f32 v[230:231], v[230:231], v[22:23]
    v_cvt_pk_bf16_f32 v224, v224, v225
    v_cvt_pk_bf16_f32 v225, v226, v227
    v_cvt_pk_bf16_f32 v226, v228, v229
    v_cvt_pk_bf16_f32 v227, v230, v231
    buffer_store_dwordx4 v[224:227], v24, s[16:19], s38 offen offset:0 sc1
    v_pk_mul_f32 v[232:233], v[232:233], v[22:23]
    v_pk_mul_f32 v[234:235], v[234:235], v[22:23]
    v_pk_mul_f32 v[236:237], v[236:237], v[22:23]
    v_pk_mul_f32 v[238:239], v[238:239], v[22:23]
    v_cvt_pk_bf16_f32 v232, v232, v233
    v_cvt_pk_bf16_f32 v233, v234, v235
    v_cvt_pk_bf16_f32 v234, v236, v237
    v_cvt_pk_bf16_f32 v235, v238, v239
    buffer_store_dwordx4 v[232:235], v24, s[16:19], s38 offen offset:1024 sc1
    v_pk_mul_f32 v[240:241], v[240:241], v[22:23]
    v_pk_mul_f32 v[242:243], v[242:243], v[22:23]
    v_pk_mul_f32 v[244:245], v[244:245], v[22:23]
    v_pk_mul_f32 v[246:247], v[246:247], v[22:23]
    v_cvt_pk_bf16_f32 v240, v240, v241
    v_cvt_pk_bf16_f32 v241, v242, v243
    v_cvt_pk_bf16_f32 v242, v244, v245
    v_cvt_pk_bf16_f32 v243, v246, v247
    buffer_store_dwordx4 v[240:243], v24, s[16:19], s38 offen offset:2048 sc1
    v_pk_mul_f32 v[248:249], v[248:249], v[22:23]
    v_pk_mul_f32 v[250:251], v[250:251], v[22:23]
    v_pk_mul_f32 v[252:253], v[252:253], v[22:23]
    v_pk_mul_f32 v[254:255], v[254:255], v[22:23]
    v_cvt_pk_bf16_f32 v248, v248, v249
    v_cvt_pk_bf16_f32 v249, v250, v251
    v_cvt_pk_bf16_f32 v250, v252, v253
    v_cvt_pk_bf16_f32 v251, v254, v255
    buffer_store_dwordx4 v[248:251], v24, s[16:19], s38 offen offset:3072 sc1
    v_mov_b32 v96, v112
    v_mov_b32 v97, v113
    v_mov_b32 v98, v114
    v_mov_b32 v99, v115
    v_mov_b32 v100, v116
    v_mov_b32 v101, v117
    v_mov_b32 v102, v118
    v_mov_b32 v103, v119
    s_branch L_p3_done
L_recurrent_scan__compressed_kv_cla__moe_arch_mod__prompt_kernel_rare_100:
    s_lshl_b32 s36, s29, 7
    s_cmp_eq_u32 s30, 0
    s_cselect_b32 s37, 4, 0
    s_add_u32 s36, s36, s37
    v_mov_b32 v20, s36
    v_mov_b32 v21, 1
    s_mov_b64 exec, 1
    global_atomic_add v20, v21, s[90:91]
    s_mov_b64 exec, -1
    s_nop 3
    s_branch L_recurrent_scan__compressed_kv_cla__moe_arch_mod__prompt_kernel_back_101
L_recurrent_scan__compressed_kv_cla__moe_arch_mod__prompt_kernel_rare_103:
    s_cmp_lt_i32 s36, 0
    s_cbranch_scc1 L_recurrent_scan__compressed_kv_cla__moe_arch_mod__prompt_kernel_nm_102
    v_mov_b32 v20, 4048155338
    v_subrev_u32 v21, s36, v18
    v_cmp_gt_i32 s[20:21], 0, v21
    v_cmp_gt_i32 s[22:23], 1, v21
    v_cmp_gt_i32 s[62:63], 2, v21
    v_cmp_gt_i32 vcc, 3, v21
    v_cndmask_b32 v96, v96, v20, s[20:21]
    v_cndmask_b32 v97, v97, v20, s[22:23]
    v_cndmask_b32 v98, v98, v20, s[62:63]
    v_cndmask_b32 v99, v99, v20, vcc
    v_cmp_gt_i32 s[20:21], 16, v21
    v_cmp_gt_i32 s[22:23], 17, v21
    v_cmp_gt_i32 s[62:63], 18, v21
    v_cmp_gt_i32 vcc, 19, v21
    v_cndmask_b32 v100, v100, v20, s[20:21]
    v_cndmask_b32 v101, v101, v20, s[22:23]
    v_cndmask_b32 v102, v102, v20, s[62:63]
    v_cndmask_b32 v103, v103, v20, vcc
    v_cmp_gt_i32 s[20:21], -16, v21
    v_cmp_gt_i32 s[22:23], -15, v21
    v_cmp_gt_i32 s[62:63], -14, v21
    v_cmp_gt_i32 vcc, -13, v21
    v_cndmask_b32 v104, v104, v20, s[20:21]
    v_cndmask_b32 v105, v105, v20, s[22:23]
    v_cndmask_b32 v106, v106, v20, s[62:63]
    v_cndmask_b32 v107, v107, v20, vcc
    v_cmp_gt_i32 s[20:21], 0, v21
    v_cmp_gt_i32 s[22:23], 1, v21
    v_cmp_gt_i32 s[62:63], 2, v21
    v_cmp_gt_i32 vcc, 3, v21
    v_cndmask_b32 v108, v108, v20, s[20:21]
    v_cndmask_b32 v109, v109, v20, s[22:23]
    v_cndmask_b32 v110, v110, v20, s[62:63]
    v_cndmask_b32 v111, v111, v20, vcc
L_recurrent_scan__compressed_kv_cla__moe_arch_mod__prompt_kernel_nm_102:
    s_branch L_recurrent_scan__compressed_kv_cla__moe_arch_mod__prompt_kernel_back_104
L_recurrent_scan__compressed_kv_cla__moe_arch_mod__prompt_kernel_rare_110:
    s_add_u32 s36, s40, 1
    s_sub_u32 s36, s36, s51
    s_cmp_lt_u32 s36, 2
    s_cbranch_scc0 L_recurrent_scan__compressed_kv_cla__moe_arch_mod__prompt_kernel_r_106
    s_lshl_b32 s36, s36, 6
    s_add_u32 s36, s36, 32
    s_sub_u32 s36, s36, s50
    s_cmp_lt_i32 s36, 0
    s_cbranch_scc1 L_recurrent_scan__compressed_kv_cla__moe_arch_mod__prompt_kernel_nm_109
    v_mov_b32 v20, 4048155338
    v_subrev_u32 v21, s36, v18
    v_cmp_gt_i32 s[20:21], 0, v21
    v_cmp_gt_i32 s[22:23], 1, v21
    v_cmp_gt_i32 s[62:63], 2, v21
    v_cmp_gt_i32 vcc, 3, v21
    v_cndmask_b32 v112, v112, v20, s[20:21]
    v_cndmask_b32 v113, v113, v20, s[22:23]
    v_cndmask_b32 v114, v114, v20, s[62:63]
    v_cndmask_b32 v115, v115, v20, vcc
    v_cmp_gt_i32 s[20:21], 16, v21
    v_cmp_gt_i32 s[22:23], 17, v21
    v_cmp_gt_i32 s[62:63], 18, v21
    v_cmp_gt_i32 vcc, 19, v21
    v_cndmask_b32 v116, v116, v20, s[20:21]
    v_cndmask_b32 v117, v117, v20, s[22:23]
    v_cndmask_b32 v118, v118, v20, s[62:63]
    v_cndmask_b32 v119, v119, v20, vcc
    v_cmp_gt_i32 s[20:21], -16, v21
    v_cmp_gt_i32 s[22:23], -15, v21
    v_cmp_gt_i32 s[62:63], -14, v21
    v_cmp_gt_i32 vcc, -13, v21
    v_cndmask_b32 v120, v120, v20, s[20:21]
    v_cndmask_b32 v121, v121, v20, s[22:23]
    v_cndmask_b32 v122, v122, v20, s[62:63]
    v_cndmask_b32 v123, v123, v20, vcc
    v_cmp_gt_i32 s[20:21], 0, v21
    v_cmp_gt_i32 s[22:23], 1, v21
    v_cmp_gt_i32 s[62:63], 2, v21
    v_cmp_gt_i32 vcc, 3, v21
    v_cndmask_b32 v124, v124, v20, s[20:21]
    v_cndmask_b32 v125, v125, v20, s[22:23]
    v_cndmask_b32 v126, v126, v20, s[62:63]
    v_cndmask_b32 v127, v127, v20, vcc
L_recurrent_scan__compressed_kv_cla__moe_arch_mod__prompt_kernel_nm_109:
L_recurrent_scan__compressed_kv_cla__moe_arch_mod__prompt_kernel_r_106:
    s_branch L_recurrent_scan__compressed_kv_cla__moe_arch_mod__prompt_kernel_back_111
L_recurrent_scan__compressed_kv_cla__moe_arch_mod__prompt_kernel_rare_113:
    s_add_u32 s36, s40, 2
    s_sub_u32 s36, s36, s51
    s_cmp_eq_u32 s36, 1
    s_cselect_b32 s41, 0x8000, s41
    s_cmp_eq_u32 s40, 15
    s_cbranch_scc0 L_recurrent_scan__compressed_kv_cla__moe_arch_mod__prompt_kernel_r_107
    s_mov_b32 s41, 65536
    s_mov_b32 s49, 0x1ffff
    s_mov_b32 s36, 1
L_recurrent_scan__compressed_kv_cla__moe_arch_mod__prompt_kernel_r_107:
    s_cmp_lt_u32 s36, 2
    s_cbranch_scc0 L_recurrent_scan__compressed_kv_cla__moe_arch_mod__prompt_kernel_r_108
    s_lshl_b32 s36, s36, 6
    s_sub_u32 s36, s36, s50
    s_cmp_lt_i32 s36, 0
    s_cbranch_scc1 L_recurrent_scan__compressed_kv_cla__moe_arch_mod__prompt_kernel_nm_112
    v_mov_b32 v20, 4048155338
    v_subrev_u32 v21, s36, v18
    v_cmp_gt_i32 s[20:21], 0, v21
    v_cmp_gt_i32 s[22:23], 1, v21
    v_cmp_gt_i32 s[62:63], 2, v21
    v_cmp_gt_i32 vcc, 3, v21
    v_cndmask_b32 v96, v96, v20, s[20:21]
    v_cndmask_b32 v97, v97, v20, s[22:23]
    v_cndmask_b32 v98, v98, v20, s[62:63]
    v_cndmask_b32 v99, v99, v20, vcc
    v_cmp_gt_i32 s[20:21], 16, v21
    v_cmp_gt_i32 s[22:23], 17, v21
    v_cmp_gt_i32 s[62:63], 18, v21
    v_cmp_gt_i32 vcc, 19, v21
    v_cndmask_b32 v100, v100, v20, s[20:21]
    v_cndmask_b32 v101, v101, v20, s[22:23]
    v_cndmask_b32 v102, v102, v20, s[62:63]
    v_cndmask_b32 v103, v103, v20, vcc
    v_cmp_gt_i32 s[20:21], -16, v21
    v_cmp_gt_i32 s[22:23], -15, v21
    v_cmp_gt_i32 s[62:63], -14, v21
    v_cmp_gt_i32 vcc, -13, v21
    v_cndmask_b32 v104, v104, v20, s[20:21]
    v_cndmask_b32 v105, v105, v20, s[22:23]
    v_cndmask_b32 v106, v106, v20, s[62:63]
    v_cndmask_b32 v107, v107, v20, vcc
    v_cmp_gt_i32 s[20:21], 0, v21
    v_cmp_gt_i32 s[22:23], 1, v21
    v_cmp_gt_i32 s[62:63], 2, v21
    v_cmp_gt_i32 vcc, 3, v21
    v_cndmask_b32 v108, v108, v20, s[20:21]
    v_cndmask_b32 v109, v109, v20, s[22:23]
    v_cndmask_b32 v110, v110, v20, s[62:63]
    v_cndmask_b32 v111, v111, v20, vcc
L_recurrent_scan__compressed_kv_cla__moe_arch_mod__prompt_kernel_nm_112:
L_recurrent_scan__compressed_kv_cla__moe_arch_mod__prompt_kernel_r_108:
    s_branch L_recurrent_scan__compressed_kv_cla__moe_arch_mod__prompt_kernel_back_114
L_recurrent_scan__compressed_kv_cla__moe_arch_mod__prompt_kernel_rare_116:
    v_mov_b32 v20, 4048155338
    v_subrev_u32 v21, s36, v18
    v_cmp_gt_i32 s[20:21], 0, v21
    v_cmp_gt_i32 s[22:23], 1, v21
    v_cmp_gt_i32 s[62:63], 2, v21
    v_cmp_gt_i32 vcc, 3, v21
    v_cndmask_b32 v112, v112, v20, s[20:21]
    v_cndmask_b32 v113, v113, v20, s[22:23]
    v_cndmask_b32 v114, v114, v20, s[62:63]
    v_cndmask_b32 v115, v115, v20, vcc
    v_cmp_gt_i32 s[20:21], 16, v21
    v_cmp_gt_i32 s[22:23], 17, v21
    v_cmp_gt_i32 s[62:63], 18, v21
    v_cmp_gt_i32 vcc, 19, v21
    v_cndmask_b32 v116, v116, v20, s[20:21]
    v_cndmask_b32 v117, v117, v20, s[22:23]
    v_cndmask_b32 v118, v118, v20, s[62:63]
    v_cndmask_b32 v119, v119, v20, vcc
    v_cmp_gt_i32 s[20:21], -16, v21
    v_cmp_gt_i32 s[22:23], -15, v21
    v_cmp_gt_i32 s[62:63], -14, v21
    v_cmp_gt_i32 vcc, -13, v21
    v_cndmask_b32 v120, v120, v20, s[20:21]
    v_cndmask_b32 v121, v121, v20, s[22:23]
    v_cndmask_b32 v122, v122, v20, s[62:63]
    v_cndmask_b32 v123, v123, v20, vcc
    v_cmp_gt_i32 s[20:21], 0, v21
    v_cmp_gt_i32 s[22:23], 1, v21
    v_cmp_gt_i32 s[62:63], 2, v21
    v_cmp_gt_i32 vcc, 3, v21
    v_cndmask_b32 v124, v124, v20, s[20:21]
    v_cndmask_b32 v125, v125, v20, s[22:23]
    v_cndmask_b32 v126, v126, v20, s[62:63]
    v_cndmask_b32 v127, v127, v20, vcc
    s_branch L_recurrent_scan__compressed_kv_cla__moe_arch_mod__prompt_kernel_back_117
L_recurrent_scan__compressed_kv_cla__moe_arch_mod__prompt_kernel_rare_123:
    s_cmp_eq_u32 s40, 0
    s_cbranch_scc0 L_recurrent_scan__compressed_kv_cla__moe_arch_mod__prompt_kernel_nm_118
    ds_read_b64 v[14:15], v19
    s_waitcnt lgkmcnt(0)
L_recurrent_scan__compressed_kv_cla__moe_arch_mod__prompt_kernel_nm_118:
    s_cmp_eq_u32 s40, 12
    s_cbranch_scc0 L_recurrent_scan__compressed_kv_cla__moe_arch_mod__prompt_kernel_bh_121
    s_getpc_b64 s[36:37]
L_recurrent_scan__compressed_kv_cla__moe_arch_mod__prompt_kernel_pc_122:
    s_sub_u32 s36, s36, L_recurrent_scan__compressed_kv_cla__moe_arch_mod__prompt_kernel_pc_122-L_pc
    s_subb_u32 s37, s37, 0
    s_lshr_b32 s38, s2, 3
    s_lshl_b32 s38, s38, 7
    v_lshl_add_u32 v26, v1, 12, s38
    v_min_u32 v26, L_end-L_pc-4, v26
    v_mov_b32 v27, s37
    v_add_co_u32 v26, vcc, s36, v26
    s_mov_b64 exec, 0xffff
    s_nop 0
    v_addc_co_u32 v27, vcc, 0, v27, vcc
    global_load_dword v0, v[26:27], off
    s_mov_b64 exec, -1
    s_nop 1
L_recurrent_scan__compressed_kv_cla__moe_arch_mod__prompt_kernel_bh_121:
    s_add_u32 s36, s40, 1
    s_cmp_eq_u32 s36, s51
    s_cbranch_scc0 L_recurrent_scan__compressed_kv_cla__moe_arch_mod__prompt_kernel_ns_119
    v_swap_b32 v128, v160
    v_swap_b32 v129, v161
    v_swap_b32 v130, v162
    v_swap_b32 v131, v163
    v_swap_b32 v132, v164
    v_swap_b32 v133, v165
    v_swap_b32 v134, v166
    v_swap_b32 v135, v167
    v_swap_b32 v136, v168
    v_swap_b32 v137, v169
    v_swap_b32 v138, v170
    v_swap_b32 v139, v171
    v_swap_b32 v140, v172
    v_swap_b32 v141, v173
    v_swap_b32 v142, v174
    v_swap_b32 v143, v175
    v_swap_b32 v144, v176
    v_swap_b32 v145, v177
    v_swap_b32 v146, v178
    v_swap_b32 v147, v179
    v_swap_b32 v148, v180
    v_swap_b32 v149, v181
    v_swap_b32 v150, v182
    v_swap_b32 v151, v183
    v_swap_b32 v152, v184
    v_swap_b32 v153, v185
    v_swap_b32 v154, v186
    v_swap_b32 v155, v187
    v_swap_b32 v156, v188
    v_swap_b32 v157, v189
    v_swap_b32 v158, v190
    v_swap_b32 v159, v191
    v_mov_b32 v40, v14
    v_mov_b32 v41, v14
    v_mov_b32 v42, v14
    v_mov_b32 v43, v14
    v_mov_b32 v44, v15
    v_mov_b32 v45, v15
    v_mov_b32 v46, v15
    v_mov_b32 v47, v15
    s_nop 1
L_recurrent_scan__compressed_kv_cla__moe_arch_mod__prompt_kernel_ns_119:
    s_cmp_eq_u32 s40, s51
    s_cbranch_scc0 L_recurrent_scan__compressed_kv_cla__moe_arch_mod__prompt_kernel_ne_120
    s_nop 4
    s_mov_b32 s36, 0x5d800000
    v_cmp_nge_f32 vcc, s36, v28
    s_nop 0
    s_or_b64 s[52:53], s[52:53], vcc
    v_cmp_nge_f32 vcc, s36, v32
    s_nop 0
    s_or_b64 s[52:53], s[52:53], vcc
    v_rcp_f32 v20, v28
    v_rcp_f32 v22, v32
    s_lshl_b32 s38, s30, 3
    s_and_b32 s37, s28, 3
    s_lshl_b32 s37, s37, 1
    s_add_u32 s38, s38, s37
    s_lshl_b32 s38, s38, 17
    s_lshl_b32 s37, s29, 12
    s_add_u32 s38, s38, s37
    v_mov_b32 v21, v20
    v_mov_b32 v23, v22
    v_mov_b32 v24, v7
    v_pk_mul_f32 v[192:193], v[192:193], v[20:21]
    v_pk_mul_f32 v[194:195], v[194:195], v[20:21]
    v_pk_mul_f32 v[196:197], v[196:197], v[20:21]
    v_pk_mul_f32 v[198:199], v[198:199], v[20:21]
    v_cvt_pk_bf16_f32 v192, v192, v193
    v_cvt_pk_bf16_f32 v193, v194, v195
    v_cvt_pk_bf16_f32 v194, v196, v197
    v_cvt_pk_bf16_f32 v195, v198, v199
    buffer_store_dwordx4 v[192:195], v24, s[16:19], s38 offen offset:0 sc1
    v_pk_mul_f32 v[200:201], v[200:201], v[20:21]
    v_pk_mul_f32 v[202:203], v[202:203], v[20:21]
    v_pk_mul_f32 v[204:205], v[204:205], v[20:21]
    v_pk_mul_f32 v[206:207], v[206:207], v[20:21]
    v_cvt_pk_bf16_f32 v200, v200, v201
    v_cvt_pk_bf16_f32 v201, v202, v203
    v_cvt_pk_bf16_f32 v202, v204, v205
    v_cvt_pk_bf16_f32 v203, v206, v207
    buffer_store_dwordx4 v[200:203], v24, s[16:19], s38 offen offset:1024 sc1
    v_pk_mul_f32 v[208:209], v[208:209], v[20:21]
    v_pk_mul_f32 v[210:211], v[210:211], v[20:21]
    v_pk_mul_f32 v[212:213], v[212:213], v[20:21]
    v_pk_mul_f32 v[214:215], v[214:215], v[20:21]
    v_cvt_pk_bf16_f32 v208, v208, v209
    v_cvt_pk_bf16_f32 v209, v210, v211
    v_cvt_pk_bf16_f32 v210, v212, v213
    v_cvt_pk_bf16_f32 v211, v214, v215
    buffer_store_dwordx4 v[208:211], v24, s[16:19], s38 offen offset:2048 sc1
    v_pk_mul_f32 v[216:217], v[216:217], v[20:21]
    v_pk_mul_f32 v[218:219], v[218:219], v[20:21]
    v_pk_mul_f32 v[220:221], v[220:221], v[20:21]
    v_pk_mul_f32 v[222:223], v[222:223], v[20:21]
    v_cvt_pk_bf16_f32 v216, v216, v217
    v_cvt_pk_bf16_f32 v217, v218, v219
    v_cvt_pk_bf16_f32 v218, v220, v221
    v_cvt_pk_bf16_f32 v219, v222, v223
    buffer_store_dwordx4 v[216:219], v24, s[16:19], s38 offen offset:3072 sc1
    s_add_u32 s38, s38, 131072
    v_pk_mul_f32 v[224:225], v[224:225], v[22:23]
    v_pk_mul_f32 v[226:227], v[226:227], v[22:23]
    v_pk_mul_f32 v[228:229], v[228:229], v[22:23]
    v_pk_mul_f32 v[230:231], v[230:231], v[22:23]
    v_cvt_pk_bf16_f32 v224, v224, v225
    v_cvt_pk_bf16_f32 v225, v226, v227
    v_cvt_pk_bf16_f32 v226, v228, v229
    v_cvt_pk_bf16_f32 v227, v230, v231
    buffer_store_dwordx4 v[224:227], v24, s[16:19], s38 offen offset:0 sc1
    v_pk_mul_f32 v[232:233], v[232:233], v[22:23]
    v_pk_mul_f32 v[234:235], v[234:235], v[22:23]
    v_pk_mul_f32 v[236:237], v[236:237], v[22:23]
    v_pk_mul_f32 v[238:239], v[238:239], v[22:23]
    v_cvt_pk_bf16_f32 v232, v232, v233
    v_cvt_pk_bf16_f32 v233, v234, v235
    v_cvt_pk_bf16_f32 v234, v236, v237
    v_cvt_pk_bf16_f32 v235, v238, v239
    buffer_store_dwordx4 v[232:235], v24, s[16:19], s38 offen offset:1024 sc1
    v_pk_mul_f32 v[240:241], v[240:241], v[22:23]
    v_pk_mul_f32 v[242:243], v[242:243], v[22:23]
    v_pk_mul_f32 v[244:245], v[244:245], v[22:23]
    v_pk_mul_f32 v[246:247], v[246:247], v[22:23]
    v_cvt_pk_bf16_f32 v240, v240, v241
    v_cvt_pk_bf16_f32 v241, v242, v243
    v_cvt_pk_bf16_f32 v242, v244, v245
    v_cvt_pk_bf16_f32 v243, v246, v247
    buffer_store_dwordx4 v[240:243], v24, s[16:19], s38 offen offset:2048 sc1
    v_pk_mul_f32 v[248:249], v[248:249], v[22:23]
    v_pk_mul_f32 v[250:251], v[250:251], v[22:23]
    v_pk_mul_f32 v[252:253], v[252:253], v[22:23]
    v_pk_mul_f32 v[254:255], v[254:255], v[22:23]
    v_cvt_pk_bf16_f32 v248, v248, v249
    v_cvt_pk_bf16_f32 v249, v250, v251
    v_cvt_pk_bf16_f32 v250, v252, v253
    v_cvt_pk_bf16_f32 v251, v254, v255
    buffer_store_dwordx4 v[248:251], v24, s[16:19], s38 offen offset:3072 sc1
    v_mov_b64 v[28:29], 0
    v_mov_b64 v[30:31], 0
    v_mov_b64 v[32:33], 0
    v_mov_b64 v[34:35], 0
    v_mov_b64 v[192:193], 0
    v_mov_b64 v[194:195], 0
    v_mov_b64 v[196:197], 0
    v_mov_b64 v[198:199], 0
    v_mov_b64 v[200:201], 0
    v_mov_b64 v[202:203], 0
    v_mov_b64 v[204:205], 0
    v_mov_b64 v[206:207], 0
    v_mov_b64 v[208:209], 0
    v_mov_b64 v[210:211], 0
    v_mov_b64 v[212:213], 0
    v_mov_b64 v[214:215], 0
    v_mov_b64 v[216:217], 0
    v_mov_b64 v[218:219], 0
    v_mov_b64 v[220:221], 0
    v_mov_b64 v[222:223], 0
    v_mov_b64 v[224:225], 0
    v_mov_b64 v[226:227], 0
    v_mov_b64 v[228:229], 0
    v_mov_b64 v[230:231], 0
    v_mov_b64 v[232:233], 0
    v_mov_b64 v[234:235], 0
    v_mov_b64 v[236:237], 0
    v_mov_b64 v[238:239], 0
    v_mov_b64 v[240:241], 0
    v_mov_b64 v[242:243], 0
    v_mov_b64 v[244:245], 0
    v_mov_b64 v[246:247], 0
    v_mov_b64 v[248:249], 0
    v_mov_b64 v[250:251], 0
    v_mov_b64 v[252:253], 0
    v_mov_b64 v[254:255], 0
L_recurrent_scan__compressed_kv_cla__moe_arch_mod__prompt_kernel_ne_120:
    s_branch L_recurrent_scan__compressed_kv_cla__moe_arch_mod__prompt_kernel_back_124
L_recurrent_scan__compressed_kv_cla__moe_arch_mod__prompt_kernel_rare_127:
    s_mov_b32 s61, 0x40000
L_recurrent_scan__compressed_kv_cla__moe_arch_mod__prompt_kernel_spin_125:
    s_sub_u32 s61, s61, 1
    s_cbranch_scc1 L_recurrent_scan__compressed_kv_cla__moe_arch_mod__prompt_kernel_spinx_126
    s_sleep 8
    global_load_dword v11, v12, s[90:91] sc1
    s_waitcnt vmcnt(0)
    v_readfirstlane_b32 s36, v11
    s_nop 0
    s_cmp_lt_u32 s36, 28
    s_cbranch_scc1 L_recurrent_scan__compressed_kv_cla__moe_arch_mod__prompt_kernel_spin_125
L_recurrent_scan__compressed_kv_cla__moe_arch_mod__prompt_kernel_spinx_126:
    s_branch L_recurrent_scan__compressed_kv_cla__moe_arch_mod__prompt_kernel_back_128
L_recurrent_scan__compressed_kv_cla__moe_arch_mod__prompt_kernel_rare_132:
    v_mov_b32 v20, 4048155338
    v_subrev_u32 v21, s50, v18
    v_cmp_gt_i32 s[20:21], 0, v21
    v_cmp_gt_i32 s[22:23], 1, v21
    v_cmp_gt_i32 s[62:63], 2, v21
    v_cmp_gt_i32 vcc, 3, v21
    v_cndmask_b32 v96, v96, v20, s[20:21]
    v_cndmask_b32 v97, v97, v20, s[22:23]
    v_cndmask_b32 v98, v98, v20, s[62:63]
    v_cndmask_b32 v99, v99, v20, vcc
    v_cmp_gt_i32 s[20:21], 16, v21
    v_cmp_gt_i32 s[22:23], 17, v21
    v_cmp_gt_i32 s[62:63], 18, v21
    v_cmp_gt_i32 vcc, 19, v21
    v_cndmask_b32 v100, v100, v20, s[20:21]
    v_cndmask_b32 v101, v101, v20, s[22:23]
    v_cndmask_b32 v102, v102, v20, s[62:63]
    v_cndmask_b32 v103, v103, v20, vcc
    v_cmp_gt_i32 s[20:21], -16, v21
    v_cmp_gt_i32 s[22:23], -15, v21
    v_cmp_gt_i32 s[62:63], -14, v21
    v_cmp_gt_i32 vcc, -13, v21
    v_cndmask_b32 v104, v104, v20, s[20:21]
    v_cndmask_b32 v105, v105, v20, s[22:23]
    v_cndmask_b32 v106, v106, v20, s[62:63]
    v_cndmask_b32 v107, v107, v20, vcc
    v_cmp_gt_i32 s[20:21], 0, v21
    v_cmp_gt_i32 s[22:23], 1, v21
    v_cmp_gt_i32 s[62:63], 2, v21
    v_cmp_gt_i32 vcc, 3, v21
    v_cndmask_b32 v108, v108, v20, s[20:21]
    v_cndmask_b32 v109, v109, v20, s[22:23]
    v_cndmask_b32 v110, v110, v20, s[62:63]
    v_cndmask_b32 v111, v111, v20, vcc
    s_branch L_recurrent_scan__compressed_kv_cla__moe_arch_mod__prompt_kernel_back_133
L_p3_done:
    s_and_b32 s36, s29, 28
    s_sub_u32 s40, 47, s30
    s_lshl_b32 s40, s40, 7
    s_add_u32 s40, s40, s36
    s_add_u32 s41, s30, 32
    s_lshl_b32 s41, s41, 7
    s_add_u32 s41, s41, s36
    s_lshr_b32 s63, s29, 4
    s_lshl_b32 s36, s30, 2
    s_lshr_b32 s30, 0x76534210, s36
    s_and_b32 s30, s30, 7
    s_and_b32 s36, s30, 4
    s_add_u32 s43, s30, s36
    s_lshl_b32 s36, s63, 2
    s_add_u32 s30, s43, s36
    s_and_b32 s29, s29, 15
    s_and_b32 s36, s28, 3
    s_lshl_b32 s37, s29, 2
    s_add_u32 s36, s36, s37
    s_lshl_b32 s36, s36, 18
    s_lshr_b32 s37, s28, 2
    s_lshl_b32 s37, s37, 12
    s_add_u32 s36, s36, s37
    s_lshl_b32 s37, s63, 16
    s_add_u32 s36, s36, s37
    s_lshr_b32 s37, s28, 2
    s_lshl_b32 s37, s37, 17
    s_add_u32 s36, s36, s37
    v_lshl_add_u32 v2, v1, 4, s36
    v_xor_b32 v3, 131072, v2
    v_lshrrev_b32 v19, 4, v1
    s_lshr_b32 s36, s28, 2
    s_lshl_b32 s36, s36, 7
    s_and_b32 s37, s28, 3
    s_lshl_b32 s37, s37, 4
    s_add_u32 s36, s36, s37
    s_lshl_b32 s33, s36, 8
    s_lshl_b32 s37, s63, 11
    s_add_u32 s36, s36, s37
    v_add_u32 v18, s36, v19
    v_lshlrev_b32 v18, 11, v18
    s_lshl_b32 s36, s43, 7
    v_add_u32 v18, s36, v18
    v_lshlrev_b32 v20, 1, v19
    v_and_b32 v21, 7, v1
    v_xor_b32 v20, v20, v21
    v_lshl_add_u32 v18, v20, 4, v18
    v_and_b32 v21, 8, v1
    v_lshl_add_u32 v6, v21, 6, v18
    v_xor_b32 v21, 8, v21
    v_lshl_add_u32 v7, v21, 6, v18
    v_add_u32 v7, 7168, v7
    v_add_u32 v8, 14336, v6
    v_add_u32 v9, 14336, v7
    s_add_u32 s36, s2, 1
    s_mov_b32 s62, 0
    s_lshl_b32 s31, s62, 14
    s_lshl_b32 s32, s62, 20
    s_add_u32 s4, s54, 41943040
    s_addc_u32 s5, s55, 0
    s_and_b32 s5, s5, 0xffff
    s_mov_b32 s6, 117440640
    s_mov_b32 s7, 0x20000
    s_mov_b32 s16, s96
    s_and_b32 s17, s97, 0xffff
    s_mov_b32 s18, 4194304
    s_mov_b32 s19, 0x20000
    s_mov_b32 s20, s98
    s_and_b32 s21, s99, 0xffff
    s_mov_b32 s22, 4194304
    s_mov_b32 s23, 0x20000
    s_lshl_b32 s36, s29, 7
    s_and_b32 s37, s28, 3
    s_lshl_b32 s37, s37, 5
    s_add_u32 s36, s36, s37
    s_lshr_b32 s37, s28, 2
    s_lshl_b32 s37, s37, 4
    s_add_u32 s38, s36, s37
    v_and_b32 v17, 15, v1
    v_add_u32 v14, s38, v17
    v_lshlrev_b32 v16, 3, v14
    v_lshrrev_b32 v15, 3, v1
    v_add_u32 v15, s38, v15
    v_lshlrev_b32 v15, 11, v15
    v_and_b32 v4, 7, v1
    v_lshl_add_u32 v15, v4, 4, v15
    s_lshl_b32 s36, s30, 7
    v_add_u32 v15, s36, v15
    s_lshl_b32 s36, s28, 12
    s_add_u32 s42, s36, 131072
    v_lshl_add_u32 v17, v17, 7, s42
    v_lshl_add_u32 v17, v19, 3, v17
    v_bfe_u32 v20, v1, 2, 2
    v_lshl_add_u32 v18, v19, 2, v20
    v_and_b32 v20, 7, v18
    s_lshl_b32 s36, s63, 2
    s_xor_b32 s36, s36, 4
    v_xor_b32 v20, s36, v20
    v_lshlrev_b32 v18, 8, v18
    s_lshr_b32 s36, s28, 2
    s_lshl_b32 s36, s36, 15
    s_add_u32 s36, s36, 65536
    v_add_u32 v18, s36, v18
    v_and_b32 v21, 3, v1
    v_lshl_add_u32 v18, v21, 3, v18
    v_xor_b32 v21, 0, v20
    v_lshl_add_u32 v50, v21, 5, v18
    v_xor_b32 v21, 1, v20
    v_lshl_add_u32 v51, v21, 5, v18
    v_xor_b32 v21, 2, v20
    v_lshl_add_u32 v52, v21, 5, v18
    v_xor_b32 v21, 3, v20
    v_lshl_add_u32 v53, v21, 5, v18
    v_xor_b32 v21, 4, v20
    v_lshl_add_u32 v54, v21, 5, v18
    v_xor_b32 v21, 5, v20
    v_lshl_add_u32 v55, v21, 5, v18
    v_xor_b32 v21, 6, v20
    v_lshl_add_u32 v56, v21, 5, v18
    v_xor_b32 v21, 7, v20
    v_lshl_add_u32 v57, v21, 5, v18
    v_mov_b64 v[192:193], 0
    v_mov_b64 v[194:195], 0
    v_mov_b64 v[196:197], 0
    v_mov_b64 v[198:199], 0
    v_mov_b64 v[200:201], 0
    v_mov_b64 v[202:203], 0
    v_mov_b64 v[204:205], 0
    v_mov_b64 v[206:207], 0
    v_mov_b64 v[208:209], 0
    v_mov_b64 v[210:211], 0
    v_mov_b64 v[212:213], 0
    v_mov_b64 v[214:215], 0
    v_mov_b64 v[216:217], 0
    v_mov_b64 v[218:219], 0
    v_mov_b64 v[220:221], 0
    v_mov_b64 v[222:223], 0
    v_mov_b64 v[224:225], 0
    v_mov_b64 v[226:227], 0
    v_mov_b64 v[228:229], 0
    v_mov_b64 v[230:231], 0
    v_mov_b64 v[232:233], 0
    v_mov_b64 v[234:235], 0
    v_mov_b64 v[236:237], 0
    v_mov_b64 v[238:239], 0
    v_mov_b64 v[240:241], 0
    v_mov_b64 v[242:243], 0
    v_mov_b64 v[244:245], 0
    v_mov_b64 v[246:247], 0
    v_mov_b64 v[248:249], 0
    v_mov_b64 v[250:251], 0
    v_mov_b64 v[252:253], 0
    v_mov_b64 v[254:255], 0
    s_waitcnt vmcnt(0)
    s_barrier
    s_cmp_eq_u32 s28, 0
    s_cbranch_scc1 L_recurrent_scan__compressed_kv_cla__moe_arch_mod__prompt_kernel_rare_134
L_recurrent_scan__compressed_kv_cla__moe_arch_mod__prompt_kernel_back_135:
    s_bitcmp1_b32 0x70, s28
    s_cbranch_scc1 L_recurrent_scan__compressed_kv_cla__moe_arch_mod__prompt_kernel_f2m_161
L_recurrent_scan__compressed_kv_cla__moe_arch_mod__prompt_kernel_f2a_162:
    s_mov_b32 s34, s33
    s_add_u32 m0, s34, 65536
    s_nop 0
    buffer_load_dwordx4 v6, s[8:11], s32 offen offset:0 lds
    buffer_load_dwordx4 v7, s[8:11], s32 offen offset:1024 lds
    buffer_load_dwordx4 v8, s[8:11], s32 offen offset:2048 lds
    buffer_load_dwordx4 v9, s[8:11], s32 offen offset:3072 lds
    s_add_u32 s32, s32, 131072
    s_add_u32 m0, s34, 81920
    s_nop 0
    buffer_load_dwordx4 v6, s[8:11], s32 offen offset:0 lds
    buffer_load_dwordx4 v7, s[8:11], s32 offen offset:1024 lds
    buffer_load_dwordx4 v8, s[8:11], s32 offen offset:2048 lds
    buffer_load_dwordx4 v9, s[8:11], s32 offen offset:3072 lds
    s_add_u32 s32, s32, 393216
    s_and_b32 s32, s32, 0x3fffff
    s_add_u32 m0, s34, 0
    s_nop 0
    buffer_load_dwordx4 v6, s[8:11], s32 offen offset:0 lds
    buffer_load_dwordx4 v7, s[8:11], s32 offen offset:1024 lds
    buffer_load_dwordx4 v8, s[8:11], s32 offen offset:2048 lds
    buffer_load_dwordx4 v9, s[8:11], s32 offen offset:3072 lds
    s_add_u32 s32, s32, 131072
    s_cmp_lt_u32 s28, 4
    s_cbranch_scc1 L_recurrent_scan__compressed_kv_cla__moe_arch_mod__prompt_kernel_f2m_161
L_recurrent_scan__compressed_kv_cla__moe_arch_mod__prompt_kernel_f2b_163:
    s_mov_b32 s60, 15
    s_cmp_eq_u32 s28, 3
    s_cbranch_scc0 L_recurrent_scan__compressed_kv_cla__moe_arch_mod__prompt_kernel_w7j_164
    v_add_u32 v58, s62, v1
    v_and_b32 v58, 3, v58
    s_add_u32 s36, s29, 32
    s_lshl_b32 s36, s36, 7
    s_lshl_b32 s37, s63, 4
    s_add_u32 s36, s36, s37
    v_lshl_add_u32 v58, v58, 2, s36
    s_mov_b32 s61, 0x40000
L_recurrent_scan__compressed_kv_cla__moe_arch_mod__prompt_kernel_cspin_165:
    s_sub_u32 s61, s61, 1
    s_cbranch_scc1 L_recurrent_scan__compressed_kv_cla__moe_arch_mod__prompt_kernel_cspinx_166
    global_load_dword v59, v58, s[90:91] sc1
    s_waitcnt vmcnt(0)
L_recurrent_scan__compressed_kv_cla__moe_arch_mod__prompt_kernel_cchk_167:
    v_cmp_le_u32 vcc, 4, v59
    s_nop 0
    s_and_b32 s60, vcc_lo, 15
    s_and_b32 s36, s60, 3
    s_cmp_eq_u32 s36, 3
    s_cbranch_scc1 L_recurrent_scan__compressed_kv_cla__moe_arch_mod__prompt_kernel_cspinx_166
    s_sleep 6
    s_branch L_recurrent_scan__compressed_kv_cla__moe_arch_mod__prompt_kernel_cspin_165
L_recurrent_scan__compressed_kv_cla__moe_arch_mod__prompt_kernel_cspinx_166:
L_recurrent_scan__compressed_kv_cla__moe_arch_mod__prompt_kernel_w7j_164:
    s_waitcnt vmcnt(8)
    s_waitcnt lgkmcnt(0)
    s_barrier
    buffer_load_dwordx4 v[128:131], v2, s[4:7], s31 offen offset:0 sc1
    buffer_load_dwordx4 v[132:135], v3, s[4:7], s31 offen offset:0 sc1
    buffer_load_dwordx4 v[136:139], v2, s[4:7], s31 offen offset:1024 sc1
    buffer_load_dwordx4 v[140:143], v3, s[4:7], s31 offen offset:1024 sc1
    buffer_load_dwordx4 v[144:147], v2, s[4:7], s31 offen offset:2048 sc1
    buffer_load_dwordx4 v[148:151], v3, s[4:7], s31 offen offset:2048 sc1
    buffer_load_dwordx4 v[152:155], v2, s[4:7], s31 offen offset:3072 sc1
    buffer_load_dwordx4 v[156:159], v3, s[4:7], s31 offen offset:3072 sc1
    s_add_u32 s31, s31, 8192
    s_and_b32 s31, s31, 0xffff
    s_cmp_lt_u32 s28, 4
    s_cbranch_scc0 L_recurrent_scan__compressed_kv_cla__moe_arch_mod__prompt_kernel_g_136
    s_lshl_b32 s36, s28, 10
    s_add_u32 s36, s36, 131072
    v_lshl_add_u32 v28, v1, 4, s36
    ds_read_b128 v[96:99], v28 offset:0
    ds_read_b128 v[100:103], v28 offset:4096
    ds_read_b128 v[104:107], v28 offset:8192
    ds_read_b128 v[108:111], v28 offset:12288
    ds_read_b128 v[112:115], v28 offset:16384
    ds_read_b128 v[116:119], v28 offset:20480
    ds_read_b128 v[120:123], v28 offset:24576
    s_lshr_b32 s36, s2, 4
    s_lshl_b32 s36, s36, 13
    s_and_b32 s37, s2, 15
    s_lshl_b32 s37, s37, 8
    s_add_u32 s36, s36, s37
    s_lshl_b32 s37, s28, 6
    s_add_u32 s36, s36, s37
    s_add_u32 s36, s36, 59768832
    v_and_b32 v28, 1, v1
    v_lshlrev_b32 v28, 12, v28
    v_lshl_add_u32 v28, v19, 4, v28
    s_waitcnt lgkmcnt(0)
    v_add_f32 v96, v96, v100
    v_add_f32 v97, v97, v101
    v_add_f32 v98, v98, v102
    v_add_f32 v99, v99, v103
    v_add_f32 v96, v96, v104
    v_add_f32 v97, v97, v105
    v_add_f32 v98, v98, v106
    v_add_f32 v99, v99, v107
    v_add_f32 v96, v96, v108
    v_add_f32 v97, v97, v109
    v_add_f32 v98, v98, v110
    v_add_f32 v99, v99, v111
    v_add_f32 v96, v96, v112
    v_add_f32 v97, v97, v113
    v_add_f32 v98, v98, v114
    v_add_f32 v99, v99, v115
    v_add_f32 v96, v96, v116
    v_add_f32 v97, v97, v117
    v_add_f32 v98, v98, v118
    v_add_f32 v99, v99, v119
    v_add_f32 v96, v96, v120
    v_add_f32 v97, v97, v121
    v_add_f32 v98, v98, v122
    v_add_f32 v99, v99, v123
    s_mov_b32 exec_lo, 0x00030003
    s_mov_b32 exec_hi, 0x00030003
    buffer_store_dwordx4 v[96:99], v28, s[24:27], s36 offen sc1
    s_mov_b64 exec, -1
    s_nop 3
L_recurrent_scan__compressed_kv_cla__moe_arch_mod__prompt_kernel_g_136:
    v_lshlrev_b32 v22, 4, v1
    v_mov_b32 v18, v22
    v_add_u32 v20, s42, v22
    v_xor_b32 v21, 16384, v20
    s_lshl_b32 s36, s2, 15
    s_lshl_b32 s37, s28, 12
    s_add_u32 s36, s36, s37
    s_add_u32 s36, s36, 67108864
    s_mov_b32 s41, s36
    s_xor_b32 s39, s36, 131072
    s_add_u32 s40, s2, 128
    s_lshl_b32 s40, s40, 7
    ds_read_b64_tr_b16 v[64:65], v50 offset:0
    ds_read_b64_tr_b16 v[66:67], v50 offset:4096
    ds_read_b64_tr_b16 v[68:69], v51 offset:0
    ds_read_b64_tr_b16 v[70:71], v51 offset:4096
    ds_read_b64_tr_b16 v[72:73], v52 offset:0
    ds_read_b64_tr_b16 v[74:75], v52 offset:4096
    ds_read_b64_tr_b16 v[76:77], v53 offset:0
    ds_read_b64_tr_b16 v[78:79], v53 offset:4096
    ds_read_b64_tr_b16 v[80:81], v54 offset:0
    ds_read_b64_tr_b16 v[82:83], v54 offset:4096
    ds_read_b64_tr_b16 v[84:85], v55 offset:0
    ds_read_b64_tr_b16 v[86:87], v55 offset:4096
    s_mov_b32 s35, 0
    s_waitcnt vmcnt(0)
    buffer_load_dwordx4 v[160:163], v2, s[4:7], s31 offen offset:0 sc1
    buffer_load_dwordx4 v[164:167], v3, s[4:7], s31 offen offset:0 sc1
    buffer_load_dwordx4 v[168:171], v2, s[4:7], s31 offen offset:1024 sc1
    buffer_load_dwordx4 v[172:175], v3, s[4:7], s31 offen offset:1024 sc1
    .p2align 6
L_p4_loop:
    s_cmp_lg_u32 s35, 0
    s_cbranch_scc1 L_recurrent_scan__compressed_kv_cla__moe_arch_mod__prompt_kernel_rare_144
L_recurrent_scan__compressed_kv_cla__moe_arch_mod__prompt_kernel_back_145:
    s_waitcnt lgkmcnt(8)
    v_mfma_f32_16x16x32_bf16 v[192:195], v[64:67], v[128:131], v[192:195]
    ds_read_b64_tr_b16 v[88:89], v56 offset:0
    buffer_load_dwordx4 v[176:179], v2, s[4:7], s31 offen offset:2048 sc1
    v_mfma_f32_16x16x32_bf16 v[224:227], v[64:67], v[132:135], v[224:227]
    ds_read_b64_tr_b16 v[90:91], v56 offset:4096
    v_mfma_f32_16x16x32_bf16 v[196:199], v[68:71], v[128:131], v[196:199]
    ds_read_b64_tr_b16 v[92:93], v57 offset:0
    v_mfma_f32_16x16x32_bf16 v[228:231], v[68:71], v[132:135], v[228:231]
    ds_read_b64_tr_b16 v[94:95], v57 offset:4096
    s_add_u32 m0, s34, 16384
    s_waitcnt lgkmcnt(8)
    v_mfma_f32_16x16x32_bf16 v[200:203], v[72:75], v[128:131], v[200:203]
    ds_read_b64_tr_b16 v[64:65], v50 offset:8192
    buffer_load_dwordx4 v6, s[8:11], s32 offen offset:0 lds
    v_mfma_f32_16x16x32_bf16 v[232:235], v[72:75], v[132:135], v[232:235]
    ds_read_b64_tr_b16 v[66:67], v50 offset:12288
    v_mfma_f32_16x16x32_bf16 v[204:207], v[76:79], v[128:131], v[204:207]
    ds_read_b64_tr_b16 v[68:69], v51 offset:8192
    v_mfma_f32_16x16x32_bf16 v[236:239], v[76:79], v[132:135], v[236:239]
    ds_read_b64_tr_b16 v[70:71], v51 offset:12288
    s_waitcnt lgkmcnt(8)
    v_mfma_f32_16x16x32_bf16 v[208:211], v[80:83], v[128:131], v[208:211]
    ds_read_b64_tr_b16 v[72:73], v52 offset:8192
    buffer_load_dwordx4 v[180:183], v3, s[4:7], s31 offen offset:2048 sc1
    v_mfma_f32_16x16x32_bf16 v[240:243], v[80:83], v[132:135], v[240:243]
    ds_read_b64_tr_b16 v[74:75], v52 offset:12288
    v_mfma_f32_16x16x32_bf16 v[212:215], v[84:87], v[128:131], v[212:215]
    ds_read_b64_tr_b16 v[76:77], v53 offset:8192
    v_mfma_f32_16x16x32_bf16 v[244:247], v[84:87], v[132:135], v[244:247]
    ds_read_b64_tr_b16 v[78:79], v53 offset:12288
    s_waitcnt lgkmcnt(8)
    v_mfma_f32_16x16x32_bf16 v[216:219], v[88:91], v[128:131], v[216:219]
    ds_read_b64_tr_b16 v[80:81], v54 offset:8192
    buffer_load_dwordx4 v7, s[8:11], s32 offen offset:1024 lds
    v_mfma_f32_16x16x32_bf16 v[248:251], v[88:91], v[132:135], v[248:251]
    ds_read_b64_tr_b16 v[82:83], v54 offset:12288
    v_mfma_f32_16x16x32_bf16 v[220:223], v[92:95], v[128:131], v[220:223]
    ds_read_b64_tr_b16 v[84:85], v55 offset:8192
    v_mfma_f32_16x16x32_bf16 v[252:255], v[92:95], v[132:135], v[252:255]
    ds_read_b64_tr_b16 v[86:87], v55 offset:12288
    s_waitcnt lgkmcnt(8)
    v_mfma_f32_16x16x32_bf16 v[192:195], v[64:67], v[136:139], v[192:195]
    ds_read_b64_tr_b16 v[88:89], v56 offset:8192
    buffer_load_dwordx4 v[184:187], v2, s[4:7], s31 offen offset:3072 sc1
    v_mfma_f32_16x16x32_bf16 v[224:227], v[64:67], v[140:143], v[224:227]
    ds_read_b64_tr_b16 v[90:91], v56 offset:12288
    v_mfma_f32_16x16x32_bf16 v[196:199], v[68:71], v[136:139], v[196:199]
    ds_read_b64_tr_b16 v[92:93], v57 offset:8192
    v_mfma_f32_16x16x32_bf16 v[228:231], v[68:71], v[140:143], v[228:231]
    ds_read_b64_tr_b16 v[94:95], v57 offset:12288
    buffer_load_dwordx4 v8, s[8:11], s32 offen offset:2048 lds
    s_waitcnt lgkmcnt(8)
    v_mfma_f32_16x16x32_bf16 v[200:203], v[72:75], v[136:139], v[200:203]
    v_mfma_f32_16x16x32_bf16 v[232:235], v[72:75], v[140:143], v[232:235]
    v_mfma_f32_16x16x32_bf16 v[204:207], v[76:79], v[136:139], v[204:207]
    buffer_load_dwordx4 v[188:191], v3, s[4:7], s31 offen offset:3072 sc1
    s_add_u32 s31, s31, 8192
    s_and_b32 s31, s31, 0xffff
    v_mfma_f32_16x16x32_bf16 v[236:239], v[76:79], v[140:143], v[236:239]
    s_waitcnt lgkmcnt(0)
    s_waitcnt vmcnt(15)
    s_barrier
    v_mfma_f32_16x16x32_bf16 v[208:211], v[80:83], v[136:139], v[208:211]
    ds_read_b64_tr_b16 v[64:65], v50 offset:16384
    ds_read_b64_tr_b16 v[66:67], v50 offset:20480
    v_mfma_f32_16x16x32_bf16 v[240:243], v[80:83], v[140:143], v[240:243]
    ds_read_b64_tr_b16 v[68:69], v51 offset:16384
    ds_read_b64_tr_b16 v[70:71], v51 offset:20480
    v_mfma_f32_16x16x32_bf16 v[212:215], v[84:87], v[136:139], v[212:215]
    ds_read_b64_tr_b16 v[72:73], v52 offset:16384
    ds_read_b64_tr_b16 v[74:75], v52 offset:20480
    v_mfma_f32_16x16x32_bf16 v[244:247], v[84:87], v[140:143], v[244:247]
    ds_read_b64_tr_b16 v[76:77], v53 offset:16384
    ds_read_b64_tr_b16 v[78:79], v53 offset:20480
    v_mfma_f32_16x16x32_bf16 v[216:219], v[88:91], v[136:139], v[216:219]
    ds_read_b64_tr_b16 v[80:81], v54 offset:16384
    ds_read_b64_tr_b16 v[82:83], v54 offset:20480
    buffer_load_dwordx4 v9, s[8:11], s32 offen offset:3072 lds
    v_mfma_f32_16x16x32_bf16 v[248:251], v[88:91], v[140:143], v[248:251]
    s_add_u32 s32, s32, 393216
    s_and_b32 s32, s32, 0x3fffff
    v_mfma_f32_16x16x32_bf16 v[220:223], v[92:95], v[136:139], v[220:223]
    ds_read_b64_tr_b16 v[84:85], v55 offset:16384
    ds_read_b64_tr_b16 v[86:87], v55 offset:20480
    v_mfma_f32_16x16x32_bf16 v[252:255], v[92:95], v[140:143], v[252:255]
    s_waitcnt lgkmcnt(8)
    v_mfma_f32_16x16x32_bf16 v[192:195], v[64:67], v[144:147], v[192:195]
    ds_read_b64_tr_b16 v[88:89], v56 offset:16384
    buffer_load_dwordx4 v[128:131], v2, s[4:7], s31 offen offset:0 sc1
    v_mfma_f32_16x16x32_bf16 v[224:227], v[64:67], v[148:151], v[224:227]
    ds_read_b64_tr_b16 v[90:91], v56 offset:20480
    v_mfma_f32_16x16x32_bf16 v[196:199], v[68:71], v[144:147], v[196:199]
    ds_read_b64_tr_b16 v[92:93], v57 offset:16384
    v_mfma_f32_16x16x32_bf16 v[228:231], v[68:71], v[148:151], v[228:231]
    ds_read_b64_tr_b16 v[94:95], v57 offset:20480
    s_add_u32 m0, s34, 65536
    s_waitcnt lgkmcnt(8)
    v_mfma_f32_16x16x32_bf16 v[200:203], v[72:75], v[144:147], v[200:203]
    ds_read_b64_tr_b16 v[64:65], v50 offset:24576
    buffer_load_dwordx4 v6, s[8:11], s32 offen offset:0 lds
    v_mfma_f32_16x16x32_bf16 v[232:235], v[72:75], v[148:151], v[232:235]
    ds_read_b64_tr_b16 v[66:67], v50 offset:28672
    v_xor_b32 v50, 65536, v50
    v_mfma_f32_16x16x32_bf16 v[204:207], v[76:79], v[144:147], v[204:207]
    ds_read_b64_tr_b16 v[68:69], v51 offset:24576
    v_mfma_f32_16x16x32_bf16 v[236:239], v[76:79], v[148:151], v[236:239]
    ds_read_b64_tr_b16 v[70:71], v51 offset:28672
    v_xor_b32 v51, 65536, v51
    s_waitcnt lgkmcnt(8)
    v_mfma_f32_16x16x32_bf16 v[208:211], v[80:83], v[144:147], v[208:211]
    ds_read_b64_tr_b16 v[72:73], v52 offset:24576
    buffer_load_dwordx4 v[132:135], v3, s[4:7], s31 offen offset:0 sc1
    v_mfma_f32_16x16x32_bf16 v[240:243], v[80:83], v[148:151], v[240:243]
    ds_read_b64_tr_b16 v[74:75], v52 offset:28672
    v_xor_b32 v52, 65536, v52
    v_mfma_f32_16x16x32_bf16 v[212:215], v[84:87], v[144:147], v[212:215]
    ds_read_b64_tr_b16 v[76:77], v53 offset:24576
    v_mfma_f32_16x16x32_bf16 v[244:247], v[84:87], v[148:151], v[244:247]
    ds_read_b64_tr_b16 v[78:79], v53 offset:28672
    v_xor_b32 v53, 65536, v53
    s_waitcnt lgkmcnt(8)
    v_mfma_f32_16x16x32_bf16 v[216:219], v[88:91], v[144:147], v[216:219]
    ds_read_b64_tr_b16 v[80:81], v54 offset:24576
    buffer_load_dwordx4 v7, s[8:11], s32 offen offset:1024 lds
    v_mfma_f32_16x16x32_bf16 v[248:251], v[88:91], v[148:151], v[248:251]
    ds_read_b64_tr_b16 v[82:83], v54 offset:28672
    v_xor_b32 v54, 65536, v54
    v_mfma_f32_16x16x32_bf16 v[220:223], v[92:95], v[144:147], v[220:223]
    ds_read_b64_tr_b16 v[84:85], v55 offset:24576
    v_mfma_f32_16x16x32_bf16 v[252:255], v[92:95], v[148:151], v[252:255]
    ds_read_b64_tr_b16 v[86:87], v55 offset:28672
    v_xor_b32 v55, 65536, v55
    s_waitcnt lgkmcnt(8)
    v_mfma_f32_16x16x32_bf16 v[192:195], v[64:67], v[152:155], v[192:195]
    ds_read_b64_tr_b16 v[88:89], v56 offset:24576
    buffer_load_dwordx4 v[136:139], v2, s[4:7], s31 offen offset:1024 sc1
    v_mfma_f32_16x16x32_bf16 v[224:227], v[64:67], v[156:159], v[224:227]
    ds_read_b64_tr_b16 v[90:91], v56 offset:28672
    v_xor_b32 v56, 65536, v56
    v_mfma_f32_16x16x32_bf16 v[196:199], v[68:71], v[152:155], v[196:199]
    ds_read_b64_tr_b16 v[92:93], v57 offset:24576
    v_mfma_f32_16x16x32_bf16 v[228:231], v[68:71], v[156:159], v[228:231]
    ds_read_b64_tr_b16 v[94:95], v57 offset:28672
    v_xor_b32 v57, 65536, v57
    buffer_load_dwordx4 v8, s[8:11], s32 offen offset:2048 lds
    s_waitcnt lgkmcnt(8)
    v_mfma_f32_16x16x32_bf16 v[200:203], v[72:75], v[152:155], v[200:203]
    v_mfma_f32_16x16x32_bf16 v[232:235], v[72:75], v[156:159], v[232:235]
    v_mfma_f32_16x16x32_bf16 v[204:207], v[76:79], v[152:155], v[204:207]
    buffer_load_dwordx4 v[140:143], v3, s[4:7], s31 offen offset:1024 sc1
    v_mfma_f32_16x16x32_bf16 v[236:239], v[76:79], v[156:159], v[236:239]
    s_waitcnt lgkmcnt(0)
    s_waitcnt vmcnt(15)
    s_barrier
    v_mfma_f32_16x16x32_bf16 v[208:211], v[80:83], v[152:155], v[208:211]
    ds_read_b64_tr_b16 v[64:65], v50 offset:0
    ds_read_b64_tr_b16 v[66:67], v50 offset:4096
    v_mfma_f32_16x16x32_bf16 v[240:243], v[80:83], v[156:159], v[240:243]
    ds_read_b64_tr_b16 v[68:69], v51 offset:0
    ds_read_b64_tr_b16 v[70:71], v51 offset:4096
    v_mfma_f32_16x16x32_bf16 v[212:215], v[84:87], v[152:155], v[212:215]
    ds_read_b64_tr_b16 v[72:73], v52 offset:0
    ds_read_b64_tr_b16 v[74:75], v52 offset:4096
    v_mfma_f32_16x16x32_bf16 v[244:247], v[84:87], v[156:159], v[244:247]
    ds_read_b64_tr_b16 v[76:77], v53 offset:0
    ds_read_b64_tr_b16 v[78:79], v53 offset:4096
    v_mfma_f32_16x16x32_bf16 v[216:219], v[88:91], v[152:155], v[216:219]
    ds_read_b64_tr_b16 v[80:81], v54 offset:0
    ds_read_b64_tr_b16 v[82:83], v54 offset:4096
    buffer_load_dwordx4 v9, s[8:11], s32 offen offset:3072 lds
    v_mfma_f32_16x16x32_bf16 v[248:251], v[88:91], v[156:159], v[248:251]
    s_add_u32 s32, s32, 131072
    v_mfma_f32_16x16x32_bf16 v[220:223], v[92:95], v[152:155], v[220:223]
    ds_read_b64_tr_b16 v[84:85], v55 offset:0
    ds_read_b64_tr_b16 v[86:87], v55 offset:4096
    v_mfma_f32_16x16x32_bf16 v[252:255], v[92:95], v[156:159], v[252:255]
    s_cmp_eq_u32 s35, 2
    s_cbranch_scc1 L_recurrent_scan__compressed_kv_cla__moe_arch_mod__prompt_kernel_rare_147
L_recurrent_scan__compressed_kv_cla__moe_arch_mod__prompt_kernel_back_148:
    s_waitcnt lgkmcnt(8)
    s_waitcnt vmcnt(18)
    v_mfma_f32_16x16x32_bf16 v[192:195], v[64:67], v[160:163], v[192:195]
    ds_read_b64_tr_b16 v[88:89], v56 offset:0
    buffer_load_dwordx4 v[144:147], v2, s[4:7], s31 offen offset:2048 sc1
    v_mfma_f32_16x16x32_bf16 v[224:227], v[64:67], v[164:167], v[224:227]
    ds_read_b64_tr_b16 v[90:91], v56 offset:4096
    v_mfma_f32_16x16x32_bf16 v[196:199], v[68:71], v[160:163], v[196:199]
    ds_read_b64_tr_b16 v[92:93], v57 offset:0
    v_mfma_f32_16x16x32_bf16 v[228:231], v[68:71], v[164:167], v[228:231]
    ds_read_b64_tr_b16 v[94:95], v57 offset:4096
    s_add_u32 m0, s34, 81920
    s_waitcnt lgkmcnt(8)
    v_mfma_f32_16x16x32_bf16 v[200:203], v[72:75], v[160:163], v[200:203]
    ds_read_b64_tr_b16 v[64:65], v50 offset:8192
    buffer_load_dwordx4 v6, s[8:11], s32 offen offset:0 lds
    v_mfma_f32_16x16x32_bf16 v[232:235], v[72:75], v[164:167], v[232:235]
    ds_read_b64_tr_b16 v[66:67], v50 offset:12288
    v_mfma_f32_16x16x32_bf16 v[204:207], v[76:79], v[160:163], v[204:207]
    ds_read_b64_tr_b16 v[68:69], v51 offset:8192
    v_mfma_f32_16x16x32_bf16 v[236:239], v[76:79], v[164:167], v[236:239]
    ds_read_b64_tr_b16 v[70:71], v51 offset:12288
    s_waitcnt lgkmcnt(8)
    v_mfma_f32_16x16x32_bf16 v[208:211], v[80:83], v[160:163], v[208:211]
    ds_read_b64_tr_b16 v[72:73], v52 offset:8192
    buffer_load_dwordx4 v[148:151], v3, s[4:7], s31 offen offset:2048 sc1
    v_mfma_f32_16x16x32_bf16 v[240:243], v[80:83], v[164:167], v[240:243]
    ds_read_b64_tr_b16 v[74:75], v52 offset:12288
    v_mfma_f32_16x16x32_bf16 v[212:215], v[84:87], v[160:163], v[212:215]
    ds_read_b64_tr_b16 v[76:77], v53 offset:8192
    v_mfma_f32_16x16x32_bf16 v[244:247], v[84:87], v[164:167], v[244:247]
    ds_read_b64_tr_b16 v[78:79], v53 offset:12288
    s_waitcnt lgkmcnt(8)
    v_mfma_f32_16x16x32_bf16 v[216:219], v[88:91], v[160:163], v[216:219]
    ds_read_b64_tr_b16 v[80:81], v54 offset:8192
    buffer_load_dwordx4 v7, s[8:11], s32 offen offset:1024 lds
    v_mfma_f32_16x16x32_bf16 v[248:251], v[88:91], v[164:167], v[248:251]
    ds_read_b64_tr_b16 v[82:83], v54 offset:12288
    v_mfma_f32_16x16x32_bf16 v[220:223], v[92:95], v[160:163], v[220:223]
    ds_read_b64_tr_b16 v[84:85], v55 offset:8192
    v_mfma_f32_16x16x32_bf16 v[252:255], v[92:95], v[164:167], v[252:255]
    ds_read_b64_tr_b16 v[86:87], v55 offset:12288
    s_waitcnt lgkmcnt(8)
    s_waitcnt vmcnt(20)
    v_mfma_f32_16x16x32_bf16 v[192:195], v[64:67], v[168:171], v[192:195]
    ds_read_b64_tr_b16 v[88:89], v56 offset:8192
    buffer_load_dwordx4 v[152:155], v2, s[4:7], s31 offen offset:3072 sc1
    v_mfma_f32_16x16x32_bf16 v[224:227], v[64:67], v[172:175], v[224:227]
    ds_read_b64_tr_b16 v[90:91], v56 offset:12288
    v_mfma_f32_16x16x32_bf16 v[196:199], v[68:71], v[168:171], v[196:199]
    ds_read_b64_tr_b16 v[92:93], v57 offset:8192
    v_mfma_f32_16x16x32_bf16 v[228:231], v[68:71], v[172:175], v[228:231]
    ds_read_b64_tr_b16 v[94:95], v57 offset:12288
    buffer_load_dwordx4 v8, s[8:11], s32 offen offset:2048 lds
    s_waitcnt lgkmcnt(8)
    v_mfma_f32_16x16x32_bf16 v[200:203], v[72:75], v[168:171], v[200:203]
    v_mfma_f32_16x16x32_bf16 v[232:235], v[72:75], v[172:175], v[232:235]
    v_mfma_f32_16x16x32_bf16 v[204:207], v[76:79], v[168:171], v[204:207]
    buffer_load_dwordx4 v[156:159], v3, s[4:7], s31 offen offset:3072 sc1
    s_add_u32 s31, s31, 8192
    s_and_b32 s31, s31, 0xffff
    v_mfma_f32_16x16x32_bf16 v[236:239], v[76:79], v[172:175], v[236:239]
    s_cmp_lt_u32 s60, 15
    s_cbranch_scc1 L_recurrent_scan__compressed_kv_cla__moe_arch_mod__prompt_kernel_rare_149
L_recurrent_scan__compressed_kv_cla__moe_arch_mod__prompt_kernel_back_150:
    s_waitcnt lgkmcnt(0)
    s_waitcnt vmcnt(15)
    s_barrier
    v_mfma_f32_16x16x32_bf16 v[208:211], v[80:83], v[168:171], v[208:211]
    ds_read_b64_tr_b16 v[64:65], v50 offset:16384
    ds_read_b64_tr_b16 v[66:67], v50 offset:20480
    v_mfma_f32_16x16x32_bf16 v[240:243], v[80:83], v[172:175], v[240:243]
    ds_read_b64_tr_b16 v[68:69], v51 offset:16384
    ds_read_b64_tr_b16 v[70:71], v51 offset:20480
    v_mfma_f32_16x16x32_bf16 v[212:215], v[84:87], v[168:171], v[212:215]
    ds_read_b64_tr_b16 v[72:73], v52 offset:16384
    ds_read_b64_tr_b16 v[74:75], v52 offset:20480
    v_mfma_f32_16x16x32_bf16 v[244:247], v[84:87], v[172:175], v[244:247]
    ds_read_b64_tr_b16 v[76:77], v53 offset:16384
    ds_read_b64_tr_b16 v[78:79], v53 offset:20480
    v_mfma_f32_16x16x32_bf16 v[216:219], v[88:91], v[168:171], v[216:219]
    ds_read_b64_tr_b16 v[80:81], v54 offset:16384
    ds_read_b64_tr_b16 v[82:83], v54 offset:20480
    buffer_load_dwordx4 v9, s[8:11], s32 offen offset:3072 lds
    v_mfma_f32_16x16x32_bf16 v[248:251], v[88:91], v[172:175], v[248:251]
    s_add_u32 s32, s32, 393216
    s_and_b32 s32, s32, 0x3fffff
    v_mfma_f32_16x16x32_bf16 v[220:223], v[92:95], v[168:171], v[220:223]
    ds_read_b64_tr_b16 v[84:85], v55 offset:16384
    ds_read_b64_tr_b16 v[86:87], v55 offset:20480
    v_mfma_f32_16x16x32_bf16 v[252:255], v[92:95], v[172:175], v[252:255]
    s_waitcnt lgkmcnt(8)
    v_mfma_f32_16x16x32_bf16 v[192:195], v[64:67], v[176:179], v[192:195]
    ds_read_b64_tr_b16 v[88:89], v56 offset:16384
    buffer_load_dwordx4 v[160:163], v2, s[4:7], s31 offen offset:0 sc1
    v_mfma_f32_16x16x32_bf16 v[224:227], v[64:67], v[180:183], v[224:227]
    ds_read_b64_tr_b16 v[90:91], v56 offset:20480
    v_mfma_f32_16x16x32_bf16 v[196:199], v[68:71], v[176:179], v[196:199]
    ds_read_b64_tr_b16 v[92:93], v57 offset:16384
    v_mfma_f32_16x16x32_bf16 v[228:231], v[68:71], v[180:183], v[228:231]
    ds_read_b64_tr_b16 v[94:95], v57 offset:20480
    s_add_u32 m0, s34, 0
    s_waitcnt lgkmcnt(8)
    v_mfma_f32_16x16x32_bf16 v[200:203], v[72:75], v[176:179], v[200:203]
    ds_read_b64_tr_b16 v[64:65], v50 offset:24576
    buffer_load_dwordx4 v6, s[8:11], s32 offen offset:0 lds
    v_mfma_f32_16x16x32_bf16 v[232:235], v[72:75], v[180:183], v[232:235]
    ds_read_b64_tr_b16 v[66:67], v50 offset:28672
    v_xor_b32 v50, 65536, v50
    v_mfma_f32_16x16x32_bf16 v[204:207], v[76:79], v[176:179], v[204:207]
    ds_read_b64_tr_b16 v[68:69], v51 offset:24576
    v_mfma_f32_16x16x32_bf16 v[236:239], v[76:79], v[180:183], v[236:239]
    ds_read_b64_tr_b16 v[70:71], v51 offset:28672
    v_xor_b32 v51, 65536, v51
    s_waitcnt lgkmcnt(8)
    v_mfma_f32_16x16x32_bf16 v[208:211], v[80:83], v[176:179], v[208:211]
    ds_read_b64_tr_b16 v[72:73], v52 offset:24576
    buffer_load_dwordx4 v[164:167], v3, s[4:7], s31 offen offset:0 sc1
    v_mfma_f32_16x16x32_bf16 v[240:243], v[80:83], v[180:183], v[240:243]
    ds_read_b64_tr_b16 v[74:75], v52 offset:28672
    v_xor_b32 v52, 65536, v52
    v_mfma_f32_16x16x32_bf16 v[212:215], v[84:87], v[176:179], v[212:215]
    ds_read_b64_tr_b16 v[76:77], v53 offset:24576
    v_mfma_f32_16x16x32_bf16 v[244:247], v[84:87], v[180:183], v[244:247]
    ds_read_b64_tr_b16 v[78:79], v53 offset:28672
    v_xor_b32 v53, 65536, v53
    s_waitcnt lgkmcnt(8)
    v_mfma_f32_16x16x32_bf16 v[216:219], v[88:91], v[176:179], v[216:219]
    ds_read_b64_tr_b16 v[80:81], v54 offset:24576
    buffer_load_dwordx4 v7, s[8:11], s32 offen offset:1024 lds
    v_mfma_f32_16x16x32_bf16 v[248:251], v[88:91], v[180:183], v[248:251]
    ds_read_b64_tr_b16 v[82:83], v54 offset:28672
    v_xor_b32 v54, 65536, v54
    v_mfma_f32_16x16x32_bf16 v[220:223], v[92:95], v[176:179], v[220:223]
    ds_read_b64_tr_b16 v[84:85], v55 offset:24576
    v_mfma_f32_16x16x32_bf16 v[252:255], v[92:95], v[180:183], v[252:255]
    ds_read_b64_tr_b16 v[86:87], v55 offset:28672
    v_xor_b32 v55, 65536, v55
    s_waitcnt lgkmcnt(8)
    v_mfma_f32_16x16x32_bf16 v[192:195], v[64:67], v[184:187], v[192:195]
    ds_read_b64_tr_b16 v[88:89], v56 offset:24576
    buffer_load_dwordx4 v[168:171], v2, s[4:7], s31 offen offset:1024 sc1
    v_mfma_f32_16x16x32_bf16 v[224:227], v[64:67], v[188:191], v[224:227]
    ds_read_b64_tr_b16 v[90:91], v56 offset:28672
    v_xor_b32 v56, 65536, v56
    v_mfma_f32_16x16x32_bf16 v[196:199], v[68:71], v[184:187], v[196:199]
    ds_read_b64_tr_b16 v[92:93], v57 offset:24576
    v_mfma_f32_16x16x32_bf16 v[228:231], v[68:71], v[188:191], v[228:231]
    ds_read_b64_tr_b16 v[94:95], v57 offset:28672
    v_xor_b32 v57, 65536, v57
    buffer_load_dwordx4 v8, s[8:11], s32 offen offset:2048 lds
    s_waitcnt lgkmcnt(8)
    v_mfma_f32_16x16x32_bf16 v[200:203], v[72:75], v[184:187], v[200:203]
    v_mfma_f32_16x16x32_bf16 v[232:235], v[72:75], v[188:191], v[232:235]
    v_mfma_f32_16x16x32_bf16 v[204:207], v[76:79], v[184:187], v[204:207]
    buffer_load_dwordx4 v[172:175], v3, s[4:7], s31 offen offset:1024 sc1
    v_mfma_f32_16x16x32_bf16 v[236:239], v[76:79], v[188:191], v[236:239]
    s_cmp_lt_u32 s60, 15
    s_cbranch_scc1 L_recurrent_scan__compressed_kv_cla__moe_arch_mod__prompt_kernel_rare_159
L_recurrent_scan__compressed_kv_cla__moe_arch_mod__prompt_kernel_back_160:
    s_waitcnt lgkmcnt(0)
    s_waitcnt vmcnt(15)
    s_barrier
    v_mfma_f32_16x16x32_bf16 v[208:211], v[80:83], v[184:187], v[208:211]
    ds_read_b64_tr_b16 v[64:65], v50 offset:0
    ds_read_b64_tr_b16 v[66:67], v50 offset:4096
    v_mfma_f32_16x16x32_bf16 v[240:243], v[80:83], v[188:191], v[240:243]
    ds_read_b64_tr_b16 v[68:69], v51 offset:0
    ds_read_b64_tr_b16 v[70:71], v51 offset:4096
    v_mfma_f32_16x16x32_bf16 v[212:215], v[84:87], v[184:187], v[212:215]
    ds_read_b64_tr_b16 v[72:73], v52 offset:0
    ds_read_b64_tr_b16 v[74:75], v52 offset:4096
    v_mfma_f32_16x16x32_bf16 v[244:247], v[84:87], v[188:191], v[244:247]
    ds_read_b64_tr_b16 v[76:77], v53 offset:0
    ds_read_b64_tr_b16 v[78:79], v53 offset:4096
    v_mfma_f32_16x16x32_bf16 v[216:219], v[88:91], v[184:187], v[216:219]
    ds_read_b64_tr_b16 v[80:81], v54 offset:0
    ds_read_b64_tr_b16 v[82:83], v54 offset:4096
    buffer_load_dwordx4 v9, s[8:11], s32 offen offset:3072 lds
    v_mfma_f32_16x16x32_bf16 v[248:251], v[88:91], v[188:191], v[248:251]
    s_add_u32 s32, s32, 131072
    v_mfma_f32_16x16x32_bf16 v[220:223], v[92:95], v[184:187], v[220:223]
    ds_read_b64_tr_b16 v[84:85], v55 offset:0
    ds_read_b64_tr_b16 v[86:87], v55 offset:4096
    v_mfma_f32_16x16x32_bf16 v[252:255], v[92:95], v[188:191], v[252:255]
    s_add_u32 s35, s35, 1
    s_cmp_lt_u32 s35, 3
    s_cbranch_scc1 L_p4_loop
    s_sub_u32 s36, s56, s38
    s_sub_u32 s37, s57, s38
    s_min_u32 s36, s36, s37
    s_cmp_lt_u32 s36, 16
    s_cbranch_scc1 L_recurrent_scan__compressed_kv_cla__moe_arch_mod__prompt_kernel_rare_168
L_recurrent_scan__compressed_kv_cla__moe_arch_mod__prompt_kernel_back_169:
    s_xor_b32 s37, s40, 512
    v_mov_b32 v5, s37
    s_waitcnt vmcnt(16)
    ds_read_b64 v[40:41], v17 offset:0
    ds_read_b64 v[42:43], v17 offset:32
    ds_read_b64 v[44:45], v17 offset:64
    ds_read_b64 v[46:47], v17 offset:96
    s_waitcnt lgkmcnt(12)
    v_mfma_f32_16x16x32_bf16 v[192:195], v[64:67], v[128:131], v[192:195]
    ds_read_b64_tr_b16 v[88:89], v56 offset:0
    s_add_u32 m0, s34, 16384
    v_mfma_f32_16x16x32_bf16 v[224:227], v[64:67], v[132:135], v[224:227]
    ds_read_b64_tr_b16 v[90:91], v56 offset:4096
    v_mfma_f32_16x16x32_bf16 v[196:199], v[68:71], v[128:131], v[196:199]
    ds_read_b64_tr_b16 v[92:93], v57 offset:0
    v_mfma_f32_16x16x32_bf16 v[228:231], v[68:71], v[132:135], v[228:231]
    ds_read_b64_tr_b16 v[94:95], v57 offset:4096
    buffer_load_dwordx4 v6, s[8:11], s32 offen offset:0 lds
    s_waitcnt lgkmcnt(12)
    v_mfma_f32_16x16x32_bf16 v[200:203], v[72:75], v[128:131], v[200:203]
    ds_read_b64_tr_b16 v[64:65], v50 offset:8192
    v_mfma_f32_16x16x32_bf16 v[232:235], v[72:75], v[132:135], v[232:235]
    ds_read_b64_tr_b16 v[66:67], v50 offset:12288
    v_mfma_f32_16x16x32_bf16 v[204:207], v[76:79], v[128:131], v[204:207]
    ds_read_b64_tr_b16 v[68:69], v51 offset:8192
    buffer_load_dwordx4 v7, s[8:11], s32 offen offset:1024 lds
    v_mfma_f32_16x16x32_bf16 v[236:239], v[76:79], v[132:135], v[236:239]
    ds_read_b64_tr_b16 v[70:71], v51 offset:12288
    s_waitcnt lgkmcnt(12)
    s_waitcnt lgkmcnt(8)
    v_mfma_f32_16x16x32_bf16 v[208:211], v[80:83], v[128:131], v[208:211]
    ds_read_b64_tr_b16 v[72:73], v52 offset:8192
    v_lshlrev_b32 v96, 16, v40
    v_and_b32 v97, 0xffff0000, v40
    v_mfma_f32_16x16x32_bf16 v[240:243], v[80:83], v[132:135], v[240:243]
    ds_read_b64_tr_b16 v[74:75], v52 offset:12288
    buffer_load_dwordx4 v8, s[8:11], s32 offen offset:2048 lds
    v_sub_f32 v112, v96, v48
    v_sub_f32 v113, v97, v48
    v_mfma_f32_16x16x32_bf16 v[212:215], v[84:87], v[128:131], v[212:215]
    ds_read_b64_tr_b16 v[76:77], v53 offset:8192
    v_cvt_pk_bf16_f32 v10, v112, v113
    v_lshlrev_b32 v112, 16, v10
    v_mfma_f32_16x16x32_bf16 v[244:247], v[84:87], v[132:135], v[244:247]
    ds_read_b64_tr_b16 v[78:79], v53 offset:12288
    v_and_b32 v113, 0xffff0000, v10
    v_mul_f32 v112, v112, v49
    s_waitcnt vmcnt(11)
    s_barrier
    s_waitcnt lgkmcnt(8)
    v_mfma_f32_16x16x32_bf16 v[216:219], v[88:91], v[128:131], v[216:219]
    ds_read_b64_tr_b16 v[80:81], v50 offset:16384
    buffer_load_dwordx4 v9, s[8:11], s32 offen offset:3072 lds
    v_mul_f32 v113, v113, v49
    v_cvt_pk_bf16_f32 v10, v112, v113
    v_mfma_f32_16x16x32_bf16 v[248:251], v[88:91], v[132:135], v[248:251]
    ds_read_b64_tr_b16 v[82:83], v50 offset:20480
    v_lshlrev_b32 v112, 16, v10
    v_and_b32 v113, 0xffff0000, v10
    v_mfma_f32_16x16x32_bf16 v[220:223], v[92:95], v[128:131], v[220:223]
    ds_read_b64_tr_b16 v[84:85], v51 offset:16384
    v_mul_f32 v11, 0xbfb8aa3b, v112
    v_mul_f32 v12, 0xbfb8aa3b, v113
    v_mfma_f32_16x16x32_bf16 v[252:255], v[92:95], v[132:135], v[252:255]
    ds_read_b64_tr_b16 v[86:87], v51 offset:20480
    buffer_load_dwordx4 v[176:179], v2, s[4:7], s31 offen offset:2048 sc1
    s_waitcnt lgkmcnt(8)
    v_mfma_f32_16x16x32_bf16 v[192:195], v[64:67], v[136:139], v[192:195]
    ds_read_b64_tr_b16 v[88:89], v52 offset:16384
    v_exp_f32 v11, v11
    v_exp_f32 v12, v12
    v_mfma_f32_16x16x32_bf16 v[224:227], v[64:67], v[140:143], v[224:227]
    ds_read_b64_tr_b16 v[90:91], v52 offset:20480
    v_add_f32 v11, 1.0, v11
    v_add_f32 v12, 1.0, v12
    v_mfma_f32_16x16x32_bf16 v[196:199], v[68:71], v[136:139], v[196:199]
    ds_read_b64_tr_b16 v[92:93], v53 offset:16384
    buffer_load_dwordx4 v[180:183], v3, s[4:7], s31 offen offset:2048 sc1
    v_rcp_f32 v11, v11
    v_rcp_f32 v12, v12
    v_mfma_f32_16x16x32_bf16 v[228:231], v[68:71], v[140:143], v[228:231]
    ds_read_b64_tr_b16 v[94:95], v53 offset:20480
    v_mul_f32 v112, v112, v11
    v_mul_f32 v113, v113, v12
    s_waitcnt lgkmcnt(8)
    v_mfma_f32_16x16x32_bf16 v[200:203], v[72:75], v[136:139], v[200:203]
    ds_read_b64_tr_b16 v[64:65], v50 offset:24576
    v_cvt_pk_bf16_f32 v10, v112, v113
    v_lshlrev_b32 v112, 16, v10
    v_mfma_f32_16x16x32_bf16 v[232:235], v[72:75], v[140:143], v[232:235]
    ds_read_b64_tr_b16 v[66:67], v50 offset:28672
    v_xor_b32 v50, 65536, v50
    buffer_load_dwordx4 v[184:187], v2, s[4:7], s31 offen offset:3072 sc1
    v_and_b32 v113, 0xffff0000, v10
    v_lshlrev_b32 v98, 16, v41
    v_mfma_f32_16x16x32_bf16 v[204:207], v[76:79], v[136:139], v[204:207]
    ds_read_b64_tr_b16 v[68:69], v51 offset:24576
    v_mfma_f32_16x16x32_bf16 v[236:239], v[76:79], v[140:143], v[236:239]
    ds_read_b64_tr_b16 v[70:71], v51 offset:28672
    v_xor_b32 v51, 65536, v51
    v_and_b32 v99, 0xffff0000, v41
    v_sub_f32 v114, v98, v48
    s_waitcnt lgkmcnt(8)
    v_mfma_f32_16x16x32_bf16 v[192:195], v[80:83], v[144:147], v[192:195]
    ds_read_b64_tr_b16 v[72:73], v52 offset:24576
    buffer_load_dwordx4 v[188:191], v3, s[4:7], s31 offen offset:3072 sc1
    v_sub_f32 v115, v99, v48
    v_cvt_pk_bf16_f32 v10, v114, v115
    v_mfma_f32_16x16x32_bf16 v[224:227], v[80:83], v[148:151], v[224:227]
    ds_read_b64_tr_b16 v[74:75], v52 offset:28672
    v_xor_b32 v52, 65536, v52
    v_lshlrev_b32 v114, 16, v10
    v_and_b32 v115, 0xffff0000, v10
    v_mfma_f32_16x16x32_bf16 v[196:199], v[84:87], v[144:147], v[196:199]
    ds_read_b64_tr_b16 v[76:77], v53 offset:24576
    v_mul_f32 v114, v114, v49
    v_mul_f32 v115, v115, v49
    v_mfma_f32_16x16x32_bf16 v[228:231], v[84:87], v[148:151], v[228:231]
    ds_read_b64_tr_b16 v[78:79], v53 offset:28672
    v_xor_b32 v53, 65536, v53
    v_cvt_pk_bf16_f32 v10, v114, v115
    v_lshlrev_b32 v114, 16, v10
    s_waitcnt vmcnt(8)
    s_barrier
    s_waitcnt lgkmcnt(8)
    v_mfma_f32_16x16x32_bf16 v[200:203], v[88:91], v[144:147], v[200:203]
    ds_read_b64_tr_b16 v[80:81], v50 offset:0
    v_and_b32 v115, 0xffff0000, v10
    v_mul_f32 v11, 0xbfb8aa3b, v114
    v_mfma_f32_16x16x32_bf16 v[232:235], v[88:91], v[148:151], v[232:235]
    ds_read_b64_tr_b16 v[82:83], v50 offset:4096
    v_mfma_f32_16x16x32_bf16 v[204:207], v[92:95], v[144:147], v[204:207]
    ds_read_b64_tr_b16 v[84:85], v51 offset:0
    v_mul_f32 v12, 0xbfb8aa3b, v115
    v_exp_f32 v11, v11
    v_mfma_f32_16x16x32_bf16 v[236:239], v[92:95], v[148:151], v[236:239]
    ds_read_b64_tr_b16 v[86:87], v51 offset:4096
    v_exp_f32 v12, v12
    v_add_f32 v11, 1.0, v11
    s_waitcnt lgkmcnt(8)
    v_mfma_f32_16x16x32_bf16 v[192:195], v[64:67], v[152:155], v[192:195]
    ds_read_b64_tr_b16 v[88:89], v52 offset:0
    v_add_f32 v12, 1.0, v12
    v_rcp_f32 v11, v11
    v_mfma_f32_16x16x32_bf16 v[224:227], v[64:67], v[156:159], v[224:227]
    ds_read_b64_tr_b16 v[90:91], v52 offset:4096
    v_rcp_f32 v12, v12
    v_mul_f32 v114, v114, v11
    v_mfma_f32_16x16x32_bf16 v[196:199], v[68:71], v[152:155], v[196:199]
    ds_read_b64_tr_b16 v[92:93], v53 offset:0
    v_mul_f32 v115, v115, v12
    v_cvt_pk_bf16_f32 v10, v114, v115
    v_mfma_f32_16x16x32_bf16 v[228:231], v[68:71], v[156:159], v[228:231]
    ds_read_b64_tr_b16 v[94:95], v53 offset:4096
    v_lshlrev_b32 v114, 16, v10
    v_and_b32 v115, 0xffff0000, v10
    s_waitcnt lgkmcnt(8)
    v_mfma_f32_16x16x32_bf16 v[200:203], v[72:75], v[152:155], v[200:203]
    ds_read_b64_tr_b16 v[64:65], v50 offset:8192
    v_mfma_f32_16x16x32_bf16 v[232:235], v[72:75], v[156:159], v[232:235]
    ds_read_b64_tr_b16 v[66:67], v50 offset:12288
    v_lshlrev_b32 v100, 16, v42
    v_and_b32 v101, 0xffff0000, v42
    v_mfma_f32_16x16x32_bf16 v[204:207], v[76:79], v[152:155], v[204:207]
    ds_read_b64_tr_b16 v[68:69], v51 offset:8192
    v_sub_f32 v116, v100, v48
    v_sub_f32 v117, v101, v48
    v_mfma_f32_16x16x32_bf16 v[236:239], v[76:79], v[156:159], v[236:239]
    ds_read_b64_tr_b16 v[70:71], v51 offset:12288
    v_cvt_pk_bf16_f32 v10, v116, v117
    v_lshlrev_b32 v116, 16, v10
    s_waitcnt lgkmcnt(8)
    v_mfma_f32_16x16x32_bf16 v[192:195], v[80:83], v[160:163], v[192:195]
    ds_read_b64_tr_b16 v[72:73], v52 offset:8192
    v_and_b32 v117, 0xffff0000, v10
    v_mul_f32 v116, v116, v49
    v_mfma_f32_16x16x32_bf16 v[224:227], v[80:83], v[164:167], v[224:227]
    ds_read_b64_tr_b16 v[74:75], v52 offset:12288
    v_mul_f32 v117, v117, v49
    v_cvt_pk_bf16_f32 v10, v116, v117
    v_mfma_f32_16x16x32_bf16 v[196:199], v[84:87], v[160:163], v[196:199]
    ds_read_b64_tr_b16 v[76:77], v53 offset:8192
    v_lshlrev_b32 v116, 16, v10
    v_and_b32 v117, 0xffff0000, v10
    v_mfma_f32_16x16x32_bf16 v[228:231], v[84:87], v[164:167], v[228:231]
    ds_read_b64_tr_b16 v[78:79], v53 offset:12288
    v_mul_f32 v11, 0xbfb8aa3b, v116
    v_mul_f32 v12, 0xbfb8aa3b, v117
    s_waitcnt vmcnt(4)
    s_barrier
    s_waitcnt lgkmcnt(8)
    v_mfma_f32_16x16x32_bf16 v[200:203], v[88:91], v[160:163], v[200:203]
    ds_read_b64_tr_b16 v[80:81], v50 offset:16384
    v_mfma_f32_16x16x32_bf16 v[232:235], v[88:91], v[164:167], v[232:235]
    ds_read_b64_tr_b16 v[82:83], v50 offset:20480
    v_exp_f32 v11, v11
    v_exp_f32 v12, v12
    v_mfma_f32_16x16x32_bf16 v[204:207], v[92:95], v[160:163], v[204:207]
    ds_read_b64_tr_b16 v[84:85], v51 offset:16384
    v_add_f32 v11, 1.0, v11
    v_add_f32 v12, 1.0, v12
    v_mfma_f32_16x16x32_bf16 v[236:239], v[92:95], v[164:167], v[236:239]
    ds_read_b64_tr_b16 v[86:87], v51 offset:20480
    v_rcp_f32 v11, v11
    v_rcp_f32 v12, v12
    s_waitcnt lgkmcnt(8)
    v_mfma_f32_16x16x32_bf16 v[192:195], v[64:67], v[168:171], v[192:195]
    ds_read_b64_tr_b16 v[88:89], v52 offset:16384
    v_mul_f32 v116, v116, v11
    v_mul_f32 v117, v117, v12
    v_mfma_f32_16x16x32_bf16 v[224:227], v[64:67], v[172:175], v[224:227]
    ds_read_b64_tr_b16 v[90:91], v52 offset:20480
    v_cvt_pk_bf16_f32 v10, v116, v117
    v_lshlrev_b32 v116, 16, v10
    v_mfma_f32_16x16x32_bf16 v[196:199], v[68:71], v[168:171], v[196:199]
    ds_read_b64_tr_b16 v[92:93], v53 offset:16384
    v_and_b32 v117, 0xffff0000, v10
    v_lshlrev_b32 v102, 16, v43
    v_mfma_f32_16x16x32_bf16 v[228:231], v[68:71], v[172:175], v[228:231]
    ds_read_b64_tr_b16 v[94:95], v53 offset:20480
    s_waitcnt lgkmcnt(8)
    v_mfma_f32_16x16x32_bf16 v[200:203], v[72:75], v[168:171], v[200:203]
    ds_read_b64_tr_b16 v[64:65], v50 offset:24576
    v_and_b32 v103, 0xffff0000, v43
    v_sub_f32 v118, v102, v48
    v_mfma_f32_16x16x32_bf16 v[232:235], v[72:75], v[172:175], v[232:235]
    ds_read_b64_tr_b16 v[66:67], v50 offset:28672
    v_sub_f32 v119, v103, v48
    v_cvt_pk_bf16_f32 v10, v118, v119
    v_mfma_f32_16x16x32_bf16 v[204:207], v[76:79], v[168:171], v[204:207]
    ds_read_b64_tr_b16 v[68:69], v51 offset:24576
    v_lshlrev_b32 v118, 16, v10
    v_and_b32 v119, 0xffff0000, v10
    v_mfma_f32_16x16x32_bf16 v[236:239], v[76:79], v[172:175], v[236:239]
    ds_read_b64_tr_b16 v[70:71], v51 offset:28672
    v_mul_f32 v118, v118, v49
    v_mul_f32 v119, v119, v49
    s_waitcnt lgkmcnt(8)
    s_waitcnt vmcnt(2)
    v_mfma_f32_16x16x32_bf16 v[192:195], v[80:83], v[176:179], v[192:195]
    ds_read_b64_tr_b16 v[72:73], v52 offset:24576
    v_cvt_pk_bf16_f32 v10, v118, v119
    v_lshlrev_b32 v118, 16, v10
    v_mfma_f32_16x16x32_bf16 v[224:227], v[80:83], v[180:183], v[224:227]
    ds_read_b64_tr_b16 v[74:75], v52 offset:28672
    v_and_b32 v119, 0xffff0000, v10
    v_mul_f32 v11, 0xbfb8aa3b, v118
    v_mfma_f32_16x16x32_bf16 v[196:199], v[84:87], v[176:179], v[196:199]
    ds_read_b64_tr_b16 v[76:77], v53 offset:24576
    v_mfma_f32_16x16x32_bf16 v[228:231], v[84:87], v[180:183], v[228:231]
    ds_read_b64_tr_b16 v[78:79], v53 offset:28672
    v_mul_f32 v12, 0xbfb8aa3b, v119
    v_exp_f32 v11, v11
    s_waitcnt lgkmcnt(8)
    v_mfma_f32_16x16x32_bf16 v[200:203], v[88:91], v[176:179], v[200:203]
    ds_read_b64_tr_b16 v[80:81], v54 offset:8192
    v_exp_f32 v12, v12
    v_add_f32 v11, 1.0, v11
    v_mfma_f32_16x16x32_bf16 v[232:235], v[88:91], v[180:183], v[232:235]
    ds_read_b64_tr_b16 v[82:83], v54 offset:12288
    v_add_f32 v12, 1.0, v12
    v_rcp_f32 v11, v11
    v_mfma_f32_16x16x32_bf16 v[204:207], v[92:95], v[176:179], v[204:207]
    ds_read_b64_tr_b16 v[84:85], v55 offset:8192
    v_rcp_f32 v12, v12
    v_mul_f32 v118, v118, v11
    v_mfma_f32_16x16x32_bf16 v[236:239], v[92:95], v[180:183], v[236:239]
    ds_read_b64_tr_b16 v[86:87], v55 offset:12288
    v_mul_f32 v119, v119, v12
    v_cvt_pk_bf16_f32 v10, v118, v119
    s_waitcnt lgkmcnt(8)
    s_waitcnt vmcnt(0)
    v_mfma_f32_16x16x32_bf16 v[192:195], v[64:67], v[184:187], v[192:195]
    ds_read_b64_tr_b16 v[88:89], v56 offset:8192
    v_lshlrev_b32 v118, 16, v10
    v_and_b32 v119, 0xffff0000, v10
    v_mfma_f32_16x16x32_bf16 v[224:227], v[64:67], v[188:191], v[224:227]
    ds_read_b64_tr_b16 v[90:91], v56 offset:12288
    v_mfma_f32_16x16x32_bf16 v[196:199], v[68:71], v[184:187], v[196:199]
    ds_read_b64_tr_b16 v[92:93], v57 offset:8192
    v_lshlrev_b32 v104, 16, v44
    v_and_b32 v105, 0xffff0000, v44
    v_mfma_f32_16x16x32_bf16 v[228:231], v[68:71], v[188:191], v[228:231]
    ds_read_b64_tr_b16 v[94:95], v57 offset:12288
    v_sub_f32 v120, v104, v48
    v_sub_f32 v121, v105, v48
    s_waitcnt lgkmcnt(8)
    v_mfma_f32_16x16x32_bf16 v[200:203], v[72:75], v[184:187], v[200:203]
    ds_read_b64_tr_b16 v[64:65], v54 offset:16384
    v_cvt_pk_bf16_f32 v10, v120, v121
    v_lshlrev_b32 v120, 16, v10
    v_mfma_f32_16x16x32_bf16 v[232:235], v[72:75], v[188:191], v[232:235]
    ds_read_b64_tr_b16 v[66:67], v54 offset:20480
    v_and_b32 v121, 0xffff0000, v10
    v_mul_f32 v120, v120, v49
    v_mfma_f32_16x16x32_bf16 v[204:207], v[76:79], v[184:187], v[204:207]
    ds_read_b64_tr_b16 v[68:69], v55 offset:16384
    v_mul_f32 v121, v121, v49
    v_cvt_pk_bf16_f32 v10, v120, v121
    v_mfma_f32_16x16x32_bf16 v[236:239], v[76:79], v[188:191], v[236:239]
    ds_read_b64_tr_b16 v[70:71], v55 offset:20480
    v_lshlrev_b32 v120, 16, v10
    v_and_b32 v121, 0xffff0000, v10
    s_waitcnt lgkmcnt(8)
    v_mfma_f32_16x16x32_bf16 v[208:211], v[80:83], v[136:139], v[208:211]
    ds_read_b64_tr_b16 v[72:73], v56 offset:16384
    v_mul_f32 v11, 0xbfb8aa3b, v120
    v_mul_f32 v12, 0xbfb8aa3b, v121
    v_mfma_f32_16x16x32_bf16 v[240:243], v[80:83], v[140:143], v[240:243]
    ds_read_b64_tr_b16 v[74:75], v56 offset:20480
    v_mfma_f32_16x16x32_bf16 v[212:215], v[84:87], v[136:139], v[212:215]
    ds_read_b64_tr_b16 v[76:77], v57 offset:16384
    v_exp_f32 v11, v11
    v_exp_f32 v12, v12
    ds_write_b128 v20, v[224:227] offset:0
    v_mfma_f32_16x16x32_bf16 v[244:247], v[84:87], v[140:143], v[244:247]
    ds_read_b64_tr_b16 v[78:79], v57 offset:20480
    v_add_f32 v11, 1.0, v11
    v_add_f32 v12, 1.0, v12
    ds_write_b128 v20, v[228:231] offset:1024
    s_waitcnt lgkmcnt(10)
    v_mfma_f32_16x16x32_bf16 v[216:219], v[88:91], v[136:139], v[216:219]
    ds_read_b64_tr_b16 v[80:81], v54 offset:24576
    v_rcp_f32 v11, v11
    v_rcp_f32 v12, v12
    ds_write_b128 v20, v[232:235] offset:2048
    v_mfma_f32_16x16x32_bf16 v[248:251], v[88:91], v[140:143], v[248:251]
    ds_read_b64_tr_b16 v[82:83], v54 offset:28672
    v_xor_b32 v54, 65536, v54
    v_mul_f32 v120, v120, v11
    v_mul_f32 v121, v121, v12
    ds_write_b128 v20, v[236:239] offset:3072
    v_mfma_f32_16x16x32_bf16 v[220:223], v[92:95], v[136:139], v[220:223]
    ds_read_b64_tr_b16 v[84:85], v55 offset:24576
    v_cvt_pk_bf16_f32 v10, v120, v121
    v_lshlrev_b32 v120, 16, v10
    v_mfma_f32_16x16x32_bf16 v[252:255], v[92:95], v[140:143], v[252:255]
    ds_read_b64_tr_b16 v[86:87], v55 offset:28672
    v_xor_b32 v55, 65536, v55
    v_and_b32 v121, 0xffff0000, v10
    v_lshlrev_b32 v106, 16, v45
    s_waitcnt lgkmcnt(12)
    v_mfma_f32_16x16x32_bf16 v[208:211], v[64:67], v[144:147], v[208:211]
    ds_read_b64_tr_b16 v[88:89], v56 offset:24576
    v_mfma_f32_16x16x32_bf16 v[240:243], v[64:67], v[148:151], v[240:243]
    ds_read_b64_tr_b16 v[90:91], v56 offset:28672
    v_xor_b32 v56, 65536, v56
    v_and_b32 v107, 0xffff0000, v45
    v_sub_f32 v122, v106, v48
    v_mfma_f32_16x16x32_bf16 v[212:215], v[68:71], v[144:147], v[212:215]
    ds_read_b64_tr_b16 v[92:93], v57 offset:24576
    v_sub_f32 v123, v107, v48
    v_cvt_pk_bf16_f32 v10, v122, v123
    s_waitcnt lgkmcnt(5)
    s_barrier
    v_mfma_f32_16x16x32_bf16 v[244:247], v[68:71], v[148:151], v[244:247]
    ds_read_b64_tr_b16 v[94:95], v57 offset:28672
    v_xor_b32 v57, 65536, v57
    v_lshlrev_b32 v122, 16, v10
    v_and_b32 v123, 0xffff0000, v10
    ds_read_b128 v[224:227], v21 offset:0
    ds_read_b128 v[228:231], v21 offset:1024
    v_mfma_f32_16x16x32_bf16 v[216:219], v[72:75], v[144:147], v[216:219]
    ds_read_b64_tr_b16 v[64:65], v54 offset:0
    v_mul_f32 v122, v122, v49
    v_mul_f32 v123, v123, v49
    ds_read_b128 v[232:235], v21 offset:2048
    ds_read_b128 v[236:239], v21 offset:3072
    v_mfma_f32_16x16x32_bf16 v[248:251], v[72:75], v[148:151], v[248:251]
    ds_read_b64_tr_b16 v[66:67], v54 offset:4096
    v_cvt_pk_bf16_f32 v10, v122, v123
    v_lshlrev_b32 v122, 16, v10
    v_mfma_f32_16x16x32_bf16 v[220:223], v[76:79], v[144:147], v[220:223]
    ds_read_b64_tr_b16 v[68:69], v55 offset:0
    v_and_b32 v123, 0xffff0000, v10
    v_mul_f32 v11, 0xbfb8aa3b, v122
    v_mfma_f32_16x16x32_bf16 v[252:255], v[76:79], v[148:151], v[252:255]
    ds_read_b64_tr_b16 v[70:71], v55 offset:4096
    s_waitcnt lgkmcnt(12)
    v_mfma_f32_16x16x32_bf16 v[208:211], v[80:83], v[152:155], v[208:211]
    ds_read_b64_tr_b16 v[72:73], v56 offset:0
    v_mul_f32 v12, 0xbfb8aa3b, v123
    v_exp_f32 v11, v11
    s_waitcnt lgkmcnt(8)
    v_add_f32 v192, v192, v224
    v_add_f32 v193, v193, v225
    v_mfma_f32_16x16x32_bf16 v[240:243], v[80:83], v[156:159], v[240:243]
    ds_read_b64_tr_b16 v[74:75], v56 offset:4096
    v_exp_f32 v12, v12
    v_add_f32 v11, 1.0, v11
    v_add_f32 v194, v194, v226
    v_add_f32 v195, v195, v227
    buffer_store_dwordx4 v[192:195], v18, s[24:27], s41 offen offset:0 sc1
    v_mfma_f32_16x16x32_bf16 v[212:215], v[84:87], v[152:155], v[212:215]
    ds_read_b64_tr_b16 v[76:77], v57 offset:0
    v_add_f32 v12, 1.0, v12
    v_rcp_f32 v11, v11
    s_waitcnt lgkmcnt(9)
    v_add_f32 v196, v196, v228
    v_add_f32 v197, v197, v229
    v_mfma_f32_16x16x32_bf16 v[244:247], v[84:87], v[156:159], v[244:247]
    ds_read_b64_tr_b16 v[78:79], v57 offset:4096
    v_rcp_f32 v12, v12
    v_mul_f32 v122, v122, v11
    v_add_f32 v198, v198, v230
    v_add_f32 v199, v199, v231
    buffer_store_dwordx4 v[196:199], v18, s[24:27], s41 offen offset:1024 sc1
    v_mfma_f32_16x16x32_bf16 v[216:219], v[88:91], v[152:155], v[216:219]
    ds_read_b64_tr_b16 v[80:81], v54 offset:8192
    v_mul_f32 v123, v123, v12
    v_cvt_pk_bf16_f32 v10, v122, v123
    s_waitcnt lgkmcnt(9)
    v_add_f32 v200, v200, v232
    v_add_f32 v201, v201, v233
    v_mfma_f32_16x16x32_bf16 v[248:251], v[88:91], v[156:159], v[248:251]
    ds_read_b64_tr_b16 v[82:83], v54 offset:12288
    v_lshlrev_b32 v122, 16, v10
    v_and_b32 v123, 0xffff0000, v10
    v_add_f32 v202, v202, v234
    v_add_f32 v203, v203, v235
    buffer_store_dwordx4 v[200:203], v18, s[24:27], s41 offen offset:2048 sc1
    v_mfma_f32_16x16x32_bf16 v[220:223], v[92:95], v[152:155], v[220:223]
    ds_read_b64_tr_b16 v[84:85], v55 offset:8192
    s_waitcnt lgkmcnt(10)
    v_add_f32 v204, v204, v236
    v_add_f32 v205, v205, v237
    v_mfma_f32_16x16x32_bf16 v[252:255], v[92:95], v[156:159], v[252:255]
    ds_read_b64_tr_b16 v[86:87], v55 offset:12288
    v_lshlrev_b32 v108, 16, v46
    v_and_b32 v109, 0xffff0000, v46
    v_add_f32 v206, v206, v238
    v_add_f32 v207, v207, v239
    buffer_store_dwordx4 v[204:207], v18, s[24:27], s41 offen offset:3072 sc1
    s_waitcnt lgkmcnt(8)
    v_mfma_f32_16x16x32_bf16 v[208:211], v[64:67], v[160:163], v[208:211]
    ds_read_b64_tr_b16 v[88:89], v56 offset:8192
    v_sub_f32 v124, v108, v48
    v_sub_f32 v125, v109, v48
    v_mfma_f32_16x16x32_bf16 v[240:243], v[64:67], v[164:167], v[240:243]
    ds_read_b64_tr_b16 v[90:91], v56 offset:12288
    v_cvt_pk_bf16_f32 v10, v124, v125
    v_lshlrev_b32 v124, 16, v10
    v_mfma_f32_16x16x32_bf16 v[212:215], v[68:71], v[160:163], v[212:215]
    ds_read_b64_tr_b16 v[92:93], v57 offset:8192
    v_and_b32 v125, 0xffff0000, v10
    v_mul_f32 v124, v124, v49
    v_mfma_f32_16x16x32_bf16 v[244:247], v[68:71], v[164:167], v[244:247]
    ds_read_b64_tr_b16 v[94:95], v57 offset:12288
    v_mul_f32 v125, v125, v49
    v_cvt_pk_bf16_f32 v10, v124, v125
    s_waitcnt lgkmcnt(8)
    v_mfma_f32_16x16x32_bf16 v[216:219], v[72:75], v[160:163], v[216:219]
    ds_read_b64_tr_b16 v[64:65], v54 offset:16384
    v_lshlrev_b32 v124, 16, v10
    v_and_b32 v125, 0xffff0000, v10
    v_mfma_f32_16x16x32_bf16 v[248:251], v[72:75], v[164:167], v[248:251]
    ds_read_b64_tr_b16 v[66:67], v54 offset:20480
    v_mul_f32 v11, 0xbfb8aa3b, v124
    v_mul_f32 v12, 0xbfb8aa3b, v125
    v_mfma_f32_16x16x32_bf16 v[220:223], v[76:79], v[160:163], v[220:223]
    ds_read_b64_tr_b16 v[68:69], v55 offset:16384
    v_mfma_f32_16x16x32_bf16 v[252:255], v[76:79], v[164:167], v[252:255]
    ds_read_b64_tr_b16 v[70:71], v55 offset:20480
    v_exp_f32 v11, v11
    v_exp_f32 v12, v12
    s_waitcnt lgkmcnt(8)
    v_mfma_f32_16x16x32_bf16 v[208:211], v[80:83], v[168:171], v[208:211]
    ds_read_b64_tr_b16 v[72:73], v56 offset:16384
    v_add_f32 v11, 1.0, v11
    v_add_f32 v12, 1.0, v12
    v_mfma_f32_16x16x32_bf16 v[240:243], v[80:83], v[172:175], v[240:243]
    ds_read_b64_tr_b16 v[74:75], v56 offset:20480
    v_rcp_f32 v11, v11
    v_rcp_f32 v12, v12
    v_mfma_f32_16x16x32_bf16 v[212:215], v[84:87], v[168:171], v[212:215]
    ds_read_b64_tr_b16 v[76:77], v57 offset:16384
    v_mul_f32 v124, v124, v11
    v_mul_f32 v125, v125, v12
    v_mfma_f32_16x16x32_bf16 v[244:247], v[84:87], v[172:175], v[244:247]
    ds_read_b64_tr_b16 v[78:79], v57 offset:20480
    v_cvt_pk_bf16_f32 v10, v124, v125
    v_lshlrev_b32 v124, 16, v10
    s_waitcnt lgkmcnt(8)
    v_mfma_f32_16x16x32_bf16 v[216:219], v[88:91], v[168:171], v[216:219]
    ds_read_b64_tr_b16 v[80:81], v54 offset:24576
    v_and_b32 v125, 0xffff0000, v10
    v_lshlrev_b32 v110, 16, v47
    v_mfma_f32_16x16x32_bf16 v[248:251], v[88:91], v[172:175], v[248:251]
    ds_read_b64_tr_b16 v[82:83], v54 offset:28672
    v_mfma_f32_16x16x32_bf16 v[220:223], v[92:95], v[168:171], v[220:223]
    ds_read_b64_tr_b16 v[84:85], v55 offset:24576
    v_and_b32 v111, 0xffff0000, v47
    v_sub_f32 v126, v110, v48
    v_mfma_f32_16x16x32_bf16 v[252:255], v[92:95], v[172:175], v[252:255]
    ds_read_b64_tr_b16 v[86:87], v55 offset:28672
    v_sub_f32 v127, v111, v48
    v_cvt_pk_bf16_f32 v10, v126, v127
    s_waitcnt lgkmcnt(8)
    v_mfma_f32_16x16x32_bf16 v[208:211], v[64:67], v[176:179], v[208:211]
    ds_read_b64_tr_b16 v[88:89], v56 offset:24576
    v_lshlrev_b32 v126, 16, v10
    v_and_b32 v127, 0xffff0000, v10
    v_mfma_f32_16x16x32_bf16 v[240:243], v[64:67], v[180:183], v[240:243]
    ds_read_b64_tr_b16 v[90:91], v56 offset:28672
    v_mul_f32 v126, v126, v49
    v_mul_f32 v127, v127, v49
    v_mfma_f32_16x16x32_bf16 v[212:215], v[68:71], v[176:179], v[212:215]
    ds_read_b64_tr_b16 v[92:93], v57 offset:24576
    v_cvt_pk_bf16_f32 v10, v126, v127
    v_lshlrev_b32 v126, 16, v10
    v_mfma_f32_16x16x32_bf16 v[244:247], v[68:71], v[180:183], v[244:247]
    ds_read_b64_tr_b16 v[94:95], v57 offset:28672
    v_and_b32 v127, 0xffff0000, v10
    v_mul_f32 v11, 0xbfb8aa3b, v126
    s_waitcnt lgkmcnt(8)
    v_mfma_f32_16x16x32_bf16 v[216:219], v[72:75], v[176:179], v[216:219]
    v_mfma_f32_16x16x32_bf16 v[248:251], v[72:75], v[180:183], v[248:251]
    v_mul_f32 v12, 0xbfb8aa3b, v127
    v_exp_f32 v11, v11
    v_mfma_f32_16x16x32_bf16 v[220:223], v[76:79], v[176:179], v[220:223]
    v_exp_f32 v12, v12
    v_add_f32 v11, 1.0, v11
    v_mfma_f32_16x16x32_bf16 v[252:255], v[76:79], v[180:183], v[252:255]
    v_add_f32 v12, 1.0, v12
    v_rcp_f32 v11, v11
    s_waitcnt lgkmcnt(4)
    v_mfma_f32_16x16x32_bf16 v[208:211], v[80:83], v[184:187], v[208:211]
    v_rcp_f32 v12, v12
    v_mul_f32 v126, v126, v11
    v_mfma_f32_16x16x32_bf16 v[240:243], v[80:83], v[188:191], v[240:243]
    v_mul_f32 v127, v127, v12
    v_cvt_pk_bf16_f32 v10, v126, v127
    v_mfma_f32_16x16x32_bf16 v[212:215], v[84:87], v[184:187], v[212:215]
    v_lshlrev_b32 v126, 16, v10
    v_and_b32 v127, 0xffff0000, v10
    s_lshr_b32 s36, s28, 2
    s_lshl_b32 s36, s36, 15
    s_and_b32 s37, s28, 3
    v_mfma_f32_16x16x32_bf16 v[244:247], v[84:87], v[188:191], v[244:247]
    s_lshl_b32 s37, s37, 12
    s_add_u32 s36, s36, s37
    s_add_u32 s36, s36, 65536
    s_waitcnt lgkmcnt(0)
    v_mfma_f32_16x16x32_bf16 v[216:219], v[88:91], v[184:187], v[216:219]
    v_add_u32 v20, s36, v22
    v_xor_b32 v21, 32768, v20
    v_mfma_f32_16x16x32_bf16 v[248:251], v[88:91], v[188:191], v[248:251]
    v_mfma_f32_16x16x32_bf16 v[220:223], v[92:95], v[184:187], v[220:223]
    v_mfma_f32_16x16x32_bf16 v[252:255], v[92:95], v[188:191], v[252:255]
    s_waitcnt vmcnt(0)
    v_mov_b32 v4, s40
    v_mov_b32 v13, 1
    s_mov_b64 exec, 1
    global_atomic_add v4, v13, s[90:91]
    s_mov_b64 exec, -1
    s_nop 3
    s_nop 4
    ds_write_b128 v20, v[240:243] offset:0
    ds_write_b128 v20, v[244:247] offset:1024
    ds_write_b128 v20, v[248:251] offset:2048
    ds_write_b128 v20, v[252:255] offset:3072
    s_sub_u32 s36, s56, s38
    s_sub_u32 s37, s57, s38
    s_min_u32 s36, s36, s37
    s_cmp_lt_u32 s36, 16
    s_cbranch_scc1 L_recurrent_scan__compressed_kv_cla__moe_arch_mod__prompt_kernel_rare_170
L_recurrent_scan__compressed_kv_cla__moe_arch_mod__prompt_kernel_back_171:
    s_cmp_eq_u32 s28, 3
    s_cbranch_scc1 L_recurrent_scan__compressed_kv_cla__moe_arch_mod__prompt_kernel_rare_174
L_recurrent_scan__compressed_kv_cla__moe_arch_mod__prompt_kernel_back_175:
    s_waitcnt lgkmcnt(0)
    s_barrier
    buffer_load_dwordx4 v[64:67], v18, s[24:27], s39 offen offset:0 sc1
    buffer_load_dwordx4 v[68:71], v18, s[24:27], s39 offen offset:1024 sc1
    buffer_load_dwordx4 v[72:75], v18, s[24:27], s39 offen offset:2048 sc1
    buffer_load_dwordx4 v[76:79], v18, s[24:27], s39 offen offset:3072 sc1
    ds_read_b128 v[128:131], v21 offset:0
    ds_read_b128 v[132:135], v21 offset:1024
    ds_read_b128 v[136:139], v21 offset:2048
    ds_read_b128 v[140:143], v21 offset:3072
    s_waitcnt lgkmcnt(3)
    v_pk_add_f32 v[128:129], v[128:129], v[208:209]
    v_pk_add_f32 v[130:131], v[130:131], v[210:211]
    s_waitcnt lgkmcnt(2)
    v_pk_add_f32 v[132:133], v[132:133], v[212:213]
    v_pk_add_f32 v[134:135], v[134:135], v[214:215]
    s_waitcnt lgkmcnt(1)
    v_pk_add_f32 v[136:137], v[136:137], v[216:217]
    v_pk_add_f32 v[138:139], v[138:139], v[218:219]
    s_waitcnt lgkmcnt(0)
    v_pk_add_f32 v[140:141], v[140:141], v[220:221]
    v_pk_add_f32 v[142:143], v[142:143], v[222:223]
    s_waitcnt vmcnt(3)
    v_pk_add_f32 v[128:129], v[128:129], v[64:65]
    v_cvt_pk_bf16_f32 v23, v128, v129
    v_lshlrev_b32 v128, 16, v23
    v_and_b32 v129, 0xffff0000, v23
    v_pk_mul_f32 v[128:129], v[128:129], v[112:113]
    v_cvt_pk_bf16_f32 v23, v128, v129
    v_lshlrev_b32 v128, 16, v23
    v_and_b32 v129, 0xffff0000, v23
    v_pk_add_f32 v[128:129], v[128:129], v[96:97]
    v_cvt_pk_bf16_f32 v80, v128, v129
    v_pk_add_f32 v[130:131], v[130:131], v[66:67]
    v_cvt_pk_bf16_f32 v23, v130, v131
    v_lshlrev_b32 v130, 16, v23
    v_and_b32 v131, 0xffff0000, v23
    v_pk_mul_f32 v[130:131], v[130:131], v[114:115]
    v_cvt_pk_bf16_f32 v23, v130, v131
    v_lshlrev_b32 v130, 16, v23
    v_and_b32 v131, 0xffff0000, v23
    v_pk_add_f32 v[130:131], v[130:131], v[98:99]
    v_cvt_pk_bf16_f32 v81, v130, v131
    ds_write_b64 v17, v[80:81] offset:0
    s_waitcnt vmcnt(2)
    v_pk_add_f32 v[132:133], v[132:133], v[68:69]
    v_cvt_pk_bf16_f32 v23, v132, v133
    v_lshlrev_b32 v132, 16, v23
    v_and_b32 v133, 0xffff0000, v23
    v_pk_mul_f32 v[132:133], v[132:133], v[116:117]
    v_cvt_pk_bf16_f32 v23, v132, v133
    v_lshlrev_b32 v132, 16, v23
    v_and_b32 v133, 0xffff0000, v23
    v_pk_add_f32 v[132:133], v[132:133], v[100:101]
    v_cvt_pk_bf16_f32 v82, v132, v133
    v_pk_add_f32 v[134:135], v[134:135], v[70:71]
    v_cvt_pk_bf16_f32 v23, v134, v135
    v_lshlrev_b32 v134, 16, v23
    v_and_b32 v135, 0xffff0000, v23
    v_pk_mul_f32 v[134:135], v[134:135], v[118:119]
    v_cvt_pk_bf16_f32 v23, v134, v135
    v_lshlrev_b32 v134, 16, v23
    v_and_b32 v135, 0xffff0000, v23
    v_pk_add_f32 v[134:135], v[134:135], v[102:103]
    v_cvt_pk_bf16_f32 v83, v134, v135
    ds_write_b64 v17, v[82:83] offset:32
    s_waitcnt vmcnt(1)
    v_pk_add_f32 v[136:137], v[136:137], v[72:73]
    v_cvt_pk_bf16_f32 v23, v136, v137
    v_lshlrev_b32 v136, 16, v23
    v_and_b32 v137, 0xffff0000, v23
    v_pk_mul_f32 v[136:137], v[136:137], v[120:121]
    v_cvt_pk_bf16_f32 v23, v136, v137
    v_lshlrev_b32 v136, 16, v23
    v_and_b32 v137, 0xffff0000, v23
    v_pk_add_f32 v[136:137], v[136:137], v[104:105]
    v_cvt_pk_bf16_f32 v84, v136, v137
    v_pk_add_f32 v[138:139], v[138:139], v[74:75]
    v_cvt_pk_bf16_f32 v23, v138, v139
    v_lshlrev_b32 v138, 16, v23
    v_and_b32 v139, 0xffff0000, v23
    v_pk_mul_f32 v[138:139], v[138:139], v[122:123]
    v_cvt_pk_bf16_f32 v23, v138, v139
    v_lshlrev_b32 v138, 16, v23
    v_and_b32 v139, 0xffff0000, v23
    v_pk_add_f32 v[138:139], v[138:139], v[106:107]
    v_cvt_pk_bf16_f32 v85, v138, v139
    ds_write_b64 v17, v[84:85] offset:64
    s_waitcnt vmcnt(0)
    v_pk_add_f32 v[140:141], v[140:141], v[76:77]
    v_cvt_pk_bf16_f32 v23, v140, v141
    v_lshlrev_b32 v140, 16, v23
    v_and_b32 v141, 0xffff0000, v23
    v_pk_mul_f32 v[140:141], v[140:141], v[124:125]
    v_cvt_pk_bf16_f32 v23, v140, v141
    v_lshlrev_b32 v140, 16, v23
    v_and_b32 v141, 0xffff0000, v23
    v_pk_add_f32 v[140:141], v[140:141], v[108:109]
    v_cvt_pk_bf16_f32 v86, v140, v141
    v_pk_add_f32 v[142:143], v[142:143], v[78:79]
    v_cvt_pk_bf16_f32 v23, v142, v143
    v_lshlrev_b32 v142, 16, v23
    v_and_b32 v143, 0xffff0000, v23
    v_pk_mul_f32 v[142:143], v[142:143], v[126:127]
    v_cvt_pk_bf16_f32 v23, v142, v143
    v_lshlrev_b32 v142, 16, v23
    v_and_b32 v143, 0xffff0000, v23
    v_pk_add_f32 v[142:143], v[142:143], v[110:111]
    v_cvt_pk_bf16_f32 v87, v142, v143
    ds_write_b64 v17, v[86:87] offset:96
    v_add_u32 v22, s42, v22
    s_mov_b32 s36, 16384
    s_waitcnt lgkmcnt(0)
    ds_read_b128 v[64:67], v22
    ds_read_b128 v[68:71], v22 offset:1024
    s_waitcnt lgkmcnt(1)
    buffer_store_dwordx4 v[64:67], v15, s[20:23], 0 offen sc1
    s_waitcnt lgkmcnt(0)
    buffer_store_dwordx4 v[68:71], v15, s[20:23], s36 offen sc1
    s_endpgm
L_recurrent_scan__compressed_kv_cla__moe_arch_mod__prompt_kernel_rare_134:
    v_mov_b32 v26, s40
    v_mov_b32 v28, 1
    v_writelane_b32 v26, s41, 1
    s_mov_b64 exec, 3
    global_atomic_add v26, v28, s[90:91]
    s_mov_b64 exec, -1
    s_branch L_recurrent_scan__compressed_kv_cla__moe_arch_mod__prompt_kernel_back_135
L_recurrent_scan__compressed_kv_cla__moe_arch_mod__prompt_kernel_rt1_rare_3:
    s_mov_b32 s61, 0x40000
L_recurrent_scan__compressed_kv_cla__moe_arch_mod__prompt_kernel_rt1_spin_1:
    s_sub_u32 s61, s61, 1
    s_cbranch_scc1 L_recurrent_scan__compressed_kv_cla__moe_arch_mod__prompt_kernel_rt1_spinx_2
    s_sleep 1
    global_load_dword v61, v60, s[90:91] sc1
    s_waitcnt vmcnt(0)
    v_readfirstlane_b32 s36, v61
    s_nop 0
    s_cmp_lt_u32 s36, 16
    s_cbranch_scc1 L_recurrent_scan__compressed_kv_cla__moe_arch_mod__prompt_kernel_rt1_spin_1
L_recurrent_scan__compressed_kv_cla__moe_arch_mod__prompt_kernel_rt1_spinx_2:
    s_branch L_recurrent_scan__compressed_kv_cla__moe_arch_mod__prompt_kernel_rt1_back_4
L_recurrent_scan__compressed_kv_cla__moe_arch_mod__prompt_kernel_rare_144:
    s_cmp_eq_u32 s35, 1
    s_cbranch_scc0 L_recurrent_scan__compressed_kv_cla__moe_arch_mod__prompt_kernel_swn_143
    s_cmp_eq_u32 s28, 0
    s_cbranch_scc0 L_recurrent_scan__compressed_kv_cla__moe_arch_mod__prompt_kernel_g_137
    s_and_b32 s36, s2, 15
    s_add_u32 s36, s36, 96
    s_lshl_b32 s36, s36, 7
    v_mov_b32 v26, s36
    v_mov_b32 v27, 1
    s_mov_b64 exec, 1
    global_atomic_add v26, v27, s[90:91]
    s_mov_b64 exec, -1
    s_nop 3
L_recurrent_scan__compressed_kv_cla__moe_arch_mod__prompt_kernel_g_137:
    s_branch L_recurrent_scan__compressed_kv_cla__moe_arch_mod__prompt_kernel_swend_142
L_recurrent_scan__compressed_kv_cla__moe_arch_mod__prompt_kernel_swn_143:
    s_sub_u32 s36, s56, s38
    s_sub_u32 s37, s57, s38
    s_min_u32 s36, s36, s37
    s_cmp_lt_u32 s36, 16
    s_cbranch_scc0 L_recurrent_scan__compressed_kv_cla__moe_arch_mod__prompt_kernel_nrt_138
    s_add_u32 s36, s30, 96
    s_lshl_b32 s36, s36, 7
    v_mov_b32 v60, s36
    global_load_dword v61, v60, s[90:91] sc1
L_recurrent_scan__compressed_kv_cla__moe_arch_mod__prompt_kernel_nrt_138:
    s_mov_b32 m0, s42
    s_mov_b32 s36, 15360
    buffer_load_dwordx4 v15, s[16:19], 0 offen lds
    buffer_load_dwordx4 v15, s[16:19], s36 offen offset:1024 lds
    s_mov_b32 s36, 4194304
    buffer_load_dwordx2 v[48:49], v16, s[24:27], s36 offen sc1
L_recurrent_scan__compressed_kv_cla__moe_arch_mod__prompt_kernel_swend_142:
    s_branch L_recurrent_scan__compressed_kv_cla__moe_arch_mod__prompt_kernel_back_145
L_recurrent_scan__compressed_kv_cla__moe_arch_mod__prompt_kernel_rare_147:
    s_cmp_eq_u32 s28, 0
    s_cbranch_scc0 L_recurrent_scan__compressed_kv_cla__moe_arch_mod__prompt_kernel_g_141
    s_mov_b32 s43, s38
    s_getpc_b64 s[36:37]
L_recurrent_scan__compressed_kv_cla__moe_arch_mod__prompt_kernel_pc_140:
    s_sub_u32 s36, s36, L_recurrent_scan__compressed_kv_cla__moe_arch_mod__prompt_kernel_pc_140-L_pc
    s_subb_u32 s37, s37, 0
    s_lshr_b32 s38, s2, 3
    s_lshl_b32 s38, s38, 7
    v_lshl_add_u32 v4, v1, 12, s38
    v_min_u32 v4, L_end-L_pc-4, v4
    v_mov_b32 v5, s37
    v_add_co_u32 v4, vcc, s36, v4
    s_mov_b64 exec, 0xffff
    s_nop 0
    v_addc_co_u32 v5, vcc, 0, v5, vcc
    global_load_dword v63, v[4:5], off
    s_mov_b64 exec, -1
    s_nop 1
    s_mov_b32 s38, s43
L_recurrent_scan__compressed_kv_cla__moe_arch_mod__prompt_kernel_g_141:
    s_sub_u32 s36, s56, s38
    s_sub_u32 s37, s57, s38
    s_min_u32 s36, s36, s37
    s_cmp_lt_u32 s36, 16
    s_cbranch_scc0 L_recurrent_scan__compressed_kv_cla__moe_arch_mod__prompt_kernel_nrt_139
    s_waitcnt vmcnt(16)
    v_readfirstlane_b32 s36, v61
    s_nop 0
    s_cmp_lt_u32 s36, 16
    s_cbranch_scc1 L_recurrent_scan__compressed_kv_cla__moe_arch_mod__prompt_kernel_rt1_rare_3
L_recurrent_scan__compressed_kv_cla__moe_arch_mod__prompt_kernel_rt1_back_4:
    s_lshl_b32 s37, s30, 8
    s_add_u32 s36, s37, 59768832
    s_add_u32 s37, s36, 4096
    v_and_b32 v60, 15, v1
    v_lshlrev_b32 v60, 13, v60
    v_lshl_add_u32 v60, v19, 4, v60
    buffer_load_dwordx4 v[96:99], v60, s[24:27], s36 offen offset:0 sc1
    buffer_load_dwordx4 v[100:103], v60, s[24:27], s36 offen offset:64 sc1
    buffer_load_dwordx4 v[104:107], v60, s[24:27], s36 offen offset:128 sc1
    buffer_load_dwordx4 v[108:111], v60, s[24:27], s36 offen offset:192 sc1
    buffer_load_dwordx4 v[112:115], v60, s[24:27], s37 offen offset:0 sc1
    buffer_load_dwordx4 v[116:119], v60, s[24:27], s37 offen offset:64 sc1
    buffer_load_dwordx4 v[120:123], v60, s[24:27], s37 offen offset:128 sc1
    buffer_load_dwordx4 v[124:127], v60, s[24:27], s37 offen offset:192 sc1
L_recurrent_scan__compressed_kv_cla__moe_arch_mod__prompt_kernel_nrt_139:
L_recurrent_scan__compressed_kv_cla__moe_arch_mod__prompt_kernel_swend_146:
    s_branch L_recurrent_scan__compressed_kv_cla__moe_arch_mod__prompt_kernel_back_148
L_recurrent_scan__compressed_kv_cla__moe_arch_mod__prompt_kernel_rare_149:
    global_load_dword v59, v58, s[90:91] sc1
    s_branch L_recurrent_scan__compressed_kv_cla__moe_arch_mod__prompt_kernel_back_150
L_recurrent_scan__compressed_kv_cla__moe_arch_mod__prompt_kernel_rare_159:
    s_cmp_eq_u32 s35, 0
    s_cbranch_scc0 L_recurrent_scan__compressed_kv_cla__moe_arch_mod__prompt_kernel_swn_158
    s_mov_b32 s61, 0x40000
    s_waitcnt vmcnt(7)
    s_branch L_recurrent_scan__compressed_kv_cla__moe_arch_mod__prompt_kernel_cchk_153
L_recurrent_scan__compressed_kv_cla__moe_arch_mod__prompt_kernel_cspin_151:
    s_sub_u32 s61, s61, 1
    s_cbranch_scc1 L_recurrent_scan__compressed_kv_cla__moe_arch_mod__prompt_kernel_cspinx_152
    global_load_dword v59, v58, s[90:91] sc1
    s_waitcnt vmcnt(0)
L_recurrent_scan__compressed_kv_cla__moe_arch_mod__prompt_kernel_cchk_153:
    v_cmp_le_u32 vcc, 4, v59
    s_nop 0
    s_and_b32 s60, vcc_lo, 15
    s_and_b32 s36, s60, 7
    s_cmp_eq_u32 s36, 7
    s_cbranch_scc1 L_recurrent_scan__compressed_kv_cla__moe_arch_mod__prompt_kernel_cspinx_152
    s_sleep 6
    s_branch L_recurrent_scan__compressed_kv_cla__moe_arch_mod__prompt_kernel_cspin_151
L_recurrent_scan__compressed_kv_cla__moe_arch_mod__prompt_kernel_cspinx_152:
    s_branch L_recurrent_scan__compressed_kv_cla__moe_arch_mod__prompt_kernel_swend_157
L_recurrent_scan__compressed_kv_cla__moe_arch_mod__prompt_kernel_swn_158:
    s_mov_b32 s61, 0x40000
    s_waitcnt vmcnt(7)
    s_branch L_recurrent_scan__compressed_kv_cla__moe_arch_mod__prompt_kernel_cchk_156
L_recurrent_scan__compressed_kv_cla__moe_arch_mod__prompt_kernel_cspin_154:
    s_sub_u32 s61, s61, 1
    s_cbranch_scc1 L_recurrent_scan__compressed_kv_cla__moe_arch_mod__prompt_kernel_cspinx_155
    global_load_dword v59, v58, s[90:91] sc1
    s_waitcnt vmcnt(0)
L_recurrent_scan__compressed_kv_cla__moe_arch_mod__prompt_kernel_cchk_156:
    v_cmp_le_u32 vcc, 4, v59
    s_nop 0
    s_and_b32 s60, vcc_lo, 15
    s_and_b32 s36, s60, 15
    s_cmp_eq_u32 s36, 15
    s_cbranch_scc1 L_recurrent_scan__compressed_kv_cla__moe_arch_mod__prompt_kernel_cspinx_155
    s_sleep 6
    s_branch L_recurrent_scan__compressed_kv_cla__moe_arch_mod__prompt_kernel_cspin_154
L_recurrent_scan__compressed_kv_cla__moe_arch_mod__prompt_kernel_cspinx_155:
L_recurrent_scan__compressed_kv_cla__moe_arch_mod__prompt_kernel_swend_157:
    s_branch L_recurrent_scan__compressed_kv_cla__moe_arch_mod__prompt_kernel_back_160
L_recurrent_scan__compressed_kv_cla__moe_arch_mod__prompt_kernel_f2m_161:
    v_lshrrev_b32 v28, 4, v1
    v_bfe_u32 v26, v1, 2, 2
    v_lshl_add_u32 v26, v28, 3, v26
    v_lshlrev_b32 v26, 7, v26
    v_and_b32 v27, 3, v1
    v_lshl_add_u32 v26, v27, 3, v26
    v_bfe_u32 v27, v1, 3, 2
    s_lshl_b32 s36, s28, 12
    s_add_u32 s36, s36, 131072
    v_add_u32 v26, s36, v26
    v_xor_b32 v28, 0, v27
    v_lshl_add_u32 v28, v28, 5, v26
    ds_read_b64_tr_b16 v[112:113], v28 offset:0
    ds_read_b64_tr_b16 v[114:115], v28 offset:512
    v_xor_b32 v28, 1, v27
    v_lshl_add_u32 v28, v28, 5, v26
    ds_read_b64_tr_b16 v[116:117], v28 offset:0
    ds_read_b64_tr_b16 v[118:119], v28 offset:512
    v_xor_b32 v28, 2, v27
    v_lshl_add_u32 v28, v28, 5, v26
    ds_read_b64_tr_b16 v[120:121], v28 offset:0
    ds_read_b64_tr_b16 v[122:123], v28 offset:512
    v_xor_b32 v28, 3, v27
    v_lshl_add_u32 v28, v28, 5, v26
    ds_read_b64_tr_b16 v[124:125], v28 offset:0
    ds_read_b64_tr_b16 v[126:127], v28 offset:512
    v_add_f32_dpp v96, v96, v96 row_ror:4 row_mask:0xf bank_mask:0xf
    v_add_f32_dpp v97, v97, v97 row_ror:4 row_mask:0xf bank_mask:0xf
    v_add_f32_dpp v98, v98, v98 row_ror:4 row_mask:0xf bank_mask:0xf
    v_add_f32_dpp v99, v99, v99 row_ror:4 row_mask:0xf bank_mask:0xf
    v_add_f32_dpp v100, v100, v100 row_ror:4 row_mask:0xf bank_mask:0xf
    v_add_f32_dpp v101, v101, v101 row_ror:4 row_mask:0xf bank_mask:0xf
    v_add_f32_dpp v102, v102, v102 row_ror:4 row_mask:0xf bank_mask:0xf
    v_add_f32_dpp v103, v103, v103 row_ror:4 row_mask:0xf bank_mask:0xf
    v_add_f32_dpp v96, v96, v96 row_ror:8 row_mask:0xf bank_mask:0xf
    v_add_f32_dpp v97, v97, v97 row_ror:8 row_mask:0xf bank_mask:0xf
    v_add_f32_dpp v98, v98, v98 row_ror:8 row_mask:0xf bank_mask:0xf
    v_add_f32_dpp v99, v99, v99 row_ror:8 row_mask:0xf bank_mask:0xf
    v_add_f32_dpp v100, v100, v100 row_ror:8 row_mask:0xf bank_mask:0xf
    v_add_f32_dpp v101, v101, v101 row_ror:8 row_mask:0xf bank_mask:0xf
    v_add_f32_dpp v102, v102, v102 row_ror:8 row_mask:0xf bank_mask:0xf
    v_add_f32_dpp v103, v103, v103 row_ror:8 row_mask:0xf bank_mask:0xf
    v_cvt_pk_bf16_f32 v29, v96, v97
    v_lshlrev_b32 v96, 16, v29
    v_and_b32 v97, 0xffff0000, v29
    v_cvt_pk_bf16_f32 v29, v98, v99
    v_lshlrev_b32 v98, 16, v29
    v_and_b32 v99, 0xffff0000, v29
    v_cvt_pk_bf16_f32 v29, v100, v101
    v_lshlrev_b32 v100, 16, v29
    v_and_b32 v101, 0xffff0000, v29
    v_cvt_pk_bf16_f32 v29, v102, v103
    v_lshlrev_b32 v102, 16, v29
    v_and_b32 v103, 0xffff0000, v29
    v_mul_f32 v104, 0xbfb8aa3b, v96
    v_mul_f32 v105, 0xbfb8aa3b, v97
    v_mul_f32 v106, 0xbfb8aa3b, v98
    v_mul_f32 v107, 0xbfb8aa3b, v99
    v_mul_f32 v108, 0xbfb8aa3b, v100
    v_mul_f32 v109, 0xbfb8aa3b, v101
    v_mul_f32 v110, 0xbfb8aa3b, v102
    v_mul_f32 v111, 0xbfb8aa3b, v103
    v_exp_f32 v104, v104
    v_exp_f32 v105, v105
    v_exp_f32 v106, v106
    v_exp_f32 v107, v107
    v_exp_f32 v108, v108
    v_exp_f32 v109, v109
    v_exp_f32 v110, v110
    v_exp_f32 v111, v111
    v_add_f32 v104, 1.0, v104
    v_add_f32 v105, 1.0, v105
    v_add_f32 v106, 1.0, v106
    v_add_f32 v107, 1.0, v107
    v_add_f32 v108, 1.0, v108
    v_add_f32 v109, 1.0, v109
    v_add_f32 v110, 1.0, v110
    v_add_f32 v111, 1.0, v111
    v_rcp_f32 v104, v104
    v_rcp_f32 v105, v105
    v_rcp_f32 v106, v106
    v_rcp_f32 v107, v107
    v_rcp_f32 v108, v108
    v_rcp_f32 v109, v109
    v_rcp_f32 v110, v110
    v_rcp_f32 v111, v111
    v_mul_f32 v104, v96, v104
    v_mul_f32 v105, v97, v105
    v_mul_f32 v106, v98, v106
    v_mul_f32 v107, v99, v107
    v_mul_f32 v108, v100, v108
    v_mul_f32 v109, v101, v109
    v_mul_f32 v110, v102, v110
    v_mul_f32 v111, v103, v111
    v_cvt_pk_bf16_f32 v29, v104, v105
    v_lshlrev_b32 v104, 16, v29
    v_and_b32 v105, 0xffff0000, v29
    v_cvt_pk_bf16_f32 v29, v106, v107
    v_lshlrev_b32 v106, 16, v29
    v_and_b32 v107, 0xffff0000, v29
    v_cvt_pk_bf16_f32 v29, v108, v109
    v_lshlrev_b32 v108, 16, v29
    v_and_b32 v109, 0xffff0000, v29
    v_cvt_pk_bf16_f32 v29, v110, v111
    v_lshlrev_b32 v110, 16, v29
    v_and_b32 v111, 0xffff0000, v29
    v_mul_f32_dpp v96, v96, v104 quad_perm:[2,3,0,1] row_mask:0xf bank_mask:0xf
    v_mul_f32_dpp v97, v97, v105 quad_perm:[2,3,0,1] row_mask:0xf bank_mask:0xf
    v_mul_f32_dpp v98, v98, v106 quad_perm:[2,3,0,1] row_mask:0xf bank_mask:0xf
    v_mul_f32_dpp v99, v99, v107 quad_perm:[2,3,0,1] row_mask:0xf bank_mask:0xf
    v_mul_f32_dpp v100, v100, v108 quad_perm:[2,3,0,1] row_mask:0xf bank_mask:0xf
    v_mul_f32_dpp v101, v101, v109 quad_perm:[2,3,0,1] row_mask:0xf bank_mask:0xf
    v_mul_f32_dpp v102, v102, v110 quad_perm:[2,3,0,1] row_mask:0xf bank_mask:0xf
    v_mul_f32_dpp v103, v103, v111 quad_perm:[2,3,0,1] row_mask:0xf bank_mask:0xf
    v_cvt_pk_bf16_f32 v36, v96, v97
    v_cvt_pk_bf16_f32 v37, v98, v99
    v_cvt_pk_bf16_f32 v38, v100, v101
    v_cvt_pk_bf16_f32 v39, v102, v103
    s_waitcnt lgkmcnt(0)
    v_lshl_add_u32 v28, v1, 4, s36
    v_mfma_f32_16x16x32_bf16 v[96:99], v[112:115], v[36:39], 0
    v_mfma_f32_16x16x32_bf16 v[100:103], v[116:119], v[36:39], 0
    v_mfma_f32_16x16x32_bf16 v[104:107], v[120:123], v[36:39], 0
    v_mfma_f32_16x16x32_bf16 v[108:111], v[124:127], v[36:39], 0
    s_nop 7
    ds_write_b128 v28, v[96:99] offset:0
    ds_write_b128 v28, v[100:103] offset:1024
    ds_write_b128 v28, v[104:107] offset:2048
    ds_write_b128 v28, v[108:111] offset:3072
    s_cmp_lt_u32 s28, 4
    s_cbranch_scc1 L_recurrent_scan__compressed_kv_cla__moe_arch_mod__prompt_kernel_f2b_163
    s_branch L_recurrent_scan__compressed_kv_cla__moe_arch_mod__prompt_kernel_f2a_162
L_recurrent_scan__compressed_kv_cla__moe_arch_mod__prompt_kernel_rare_168:
    v_mov_b64 v[24:25], 0
    v_mov_b64 v[26:27], 0
    v_mov_b64 v[28:29], 0
    v_mov_b64 v[30:31], 0
    v_mov_b64 v[32:33], 0
    v_mov_b64 v[34:35], 0
    v_mov_b64 v[36:37], 0
    v_mov_b64 v[38:39], 0
    s_waitcnt vmcnt(16)
    s_sub_u32 s36, s56, s38
    s_cmp_lt_u32 s36, 16
    s_cbranch_scc0 L_recurrent_scan__compressed_kv_cla__moe_arch_mod__prompt_kernel_rt2_noy_1
    s_and_b32 s36, s58, 0xffff0000
    s_cmp_lt_i32 s36, 0
    s_cselect_b32 s37, 0x80000000, -1
    s_xor_b32 s36, s36, s37
    s_and_b32 s36, s36, 0xffff0000
    v_mov_b32 v62, s36
    v_mul_f32 v62, 0xbfb8aa3b, v62
    v_exp_f32 v62, v62
    s_nop 0
    v_add_f32 v62, 1.0, v62
    v_rcp_f32 v62, v62
    s_nop 0
    v_cvt_pk_bf16_f32 v62, v62, v62
    v_lshlrev_b32 v62, 16, v62
    v_add_f32_dpp v96, v96, v96 quad_perm:[1,0,3,2] row_mask:0xf bank_mask:0xf
    v_add_f32_dpp v97, v97, v97 quad_perm:[1,0,3,2] row_mask:0xf bank_mask:0xf
    v_add_f32_dpp v98, v98, v98 quad_perm:[1,0,3,2] row_mask:0xf bank_mask:0xf
    v_add_f32_dpp v99, v99, v99 quad_perm:[1,0,3,2] row_mask:0xf bank_mask:0xf
    v_add_f32_dpp v100, v100, v100 quad_perm:[1,0,3,2] row_mask:0xf bank_mask:0xf
    v_add_f32_dpp v101, v101, v101 quad_perm:[1,0,3,2] row_mask:0xf bank_mask:0xf
    v_add_f32_dpp v102, v102, v102 quad_perm:[1,0,3,2] row_mask:0xf bank_mask:0xf
    v_add_f32_dpp v103, v103, v103 quad_perm:[1,0,3,2] row_mask:0xf bank_mask:0xf
    v_add_f32_dpp v104, v104, v104 quad_perm:[1,0,3,2] row_mask:0xf bank_mask:0xf
    v_add_f32_dpp v105, v105, v105 quad_perm:[1,0,3,2] row_mask:0xf bank_mask:0xf
    v_add_f32_dpp v106, v106, v106 quad_perm:[1,0,3,2] row_mask:0xf bank_mask:0xf
    v_add_f32_dpp v107, v107, v107 quad_perm:[1,0,3,2] row_mask:0xf bank_mask:0xf
    v_add_f32_dpp v108, v108, v108 quad_perm:[1,0,3,2] row_mask:0xf bank_mask:0xf
    v_add_f32_dpp v109, v109, v109 quad_perm:[1,0,3,2] row_mask:0xf bank_mask:0xf
    v_add_f32_dpp v110, v110, v110 quad_perm:[1,0,3,2] row_mask:0xf bank_mask:0xf
    v_add_f32_dpp v111, v111, v111 quad_perm:[1,0,3,2] row_mask:0xf bank_mask:0xf
    v_add_f32_dpp v96, v96, v96 quad_perm:[2,3,0,1] row_mask:0xf bank_mask:0xf
    v_add_f32_dpp v97, v97, v97 quad_perm:[2,3,0,1] row_mask:0xf bank_mask:0xf
    v_add_f32_dpp v98, v98, v98 quad_perm:[2,3,0,1] row_mask:0xf bank_mask:0xf
    v_add_f32_dpp v99, v99, v99 quad_perm:[2,3,0,1] row_mask:0xf bank_mask:0xf
    v_add_f32_dpp v100, v100, v100 quad_perm:[2,3,0,1] row_mask:0xf bank_mask:0xf
    v_add_f32_dpp v101, v101, v101 quad_perm:[2,3,0,1] row_mask:0xf bank_mask:0xf
    v_add_f32_dpp v102, v102, v102 quad_perm:[2,3,0,1] row_mask:0xf bank_mask:0xf
    v_add_f32_dpp v103, v103, v103 quad_perm:[2,3,0,1] row_mask:0xf bank_mask:0xf
    v_add_f32_dpp v104, v104, v104 quad_perm:[2,3,0,1] row_mask:0xf bank_mask:0xf
    v_add_f32_dpp v105, v105, v105 quad_perm:[2,3,0,1] row_mask:0xf bank_mask:0xf
    v_add_f32_dpp v106, v106, v106 quad_perm:[2,3,0,1] row_mask:0xf bank_mask:0xf
    v_add_f32_dpp v107, v107, v107 quad_perm:[2,3,0,1] row_mask:0xf bank_mask:0xf
    v_add_f32_dpp v108, v108, v108 quad_perm:[2,3,0,1] row_mask:0xf bank_mask:0xf
    v_add_f32_dpp v109, v109, v109 quad_perm:[2,3,0,1] row_mask:0xf bank_mask:0xf
    v_add_f32_dpp v110, v110, v110 quad_perm:[2,3,0,1] row_mask:0xf bank_mask:0xf
    v_add_f32_dpp v111, v111, v111 quad_perm:[2,3,0,1] row_mask:0xf bank_mask:0xf
    v_add_f32_dpp v96, v96, v96 row_half_mirror row_mask:0xf bank_mask:0xf
    v_add_f32_dpp v97, v97, v97 row_half_mirror row_mask:0xf bank_mask:0xf
    v_add_f32_dpp v98, v98, v98 row_half_mirror row_mask:0xf bank_mask:0xf
    v_add_f32_dpp v99, v99, v99 row_half_mirror row_mask:0xf bank_mask:0xf
    v_add_f32_dpp v100, v100, v100 row_half_mirror row_mask:0xf bank_mask:0xf
    v_add_f32_dpp v101, v101, v101 row_half_mirror row_mask:0xf bank_mask:0xf
    v_add_f32_dpp v102, v102, v102 row_half_mirror row_mask:0xf bank_mask:0xf
    v_add_f32_dpp v103, v103, v103 row_half_mirror row_mask:0xf bank_mask:0xf
    v_add_f32_dpp v104, v104, v104 row_half_mirror row_mask:0xf bank_mask:0xf
    v_add_f32_dpp v105, v105, v105 row_half_mirror row_mask:0xf bank_mask:0xf
    v_add_f32_dpp v106, v106, v106 row_half_mirror row_mask:0xf bank_mask:0xf
    v_add_f32_dpp v107, v107, v107 row_half_mirror row_mask:0xf bank_mask:0xf
    v_add_f32_dpp v108, v108, v108 row_half_mirror row_mask:0xf bank_mask:0xf
    v_add_f32_dpp v109, v109, v109 row_half_mirror row_mask:0xf bank_mask:0xf
    v_add_f32_dpp v110, v110, v110 row_half_mirror row_mask:0xf bank_mask:0xf
    v_add_f32_dpp v111, v111, v111 row_half_mirror row_mask:0xf bank_mask:0xf
    v_add_f32_dpp v96, v96, v96 row_mirror row_mask:0xf bank_mask:0xf
    v_add_f32_dpp v97, v97, v97 row_mirror row_mask:0xf bank_mask:0xf
    v_add_f32_dpp v98, v98, v98 row_mirror row_mask:0xf bank_mask:0xf
    v_add_f32_dpp v99, v99, v99 row_mirror row_mask:0xf bank_mask:0xf
    v_add_f32_dpp v100, v100, v100 row_mirror row_mask:0xf bank_mask:0xf
    v_add_f32_dpp v101, v101, v101 row_mirror row_mask:0xf bank_mask:0xf
    v_add_f32_dpp v102, v102, v102 row_mirror row_mask:0xf bank_mask:0xf
    v_add_f32_dpp v103, v103, v103 row_mirror row_mask:0xf bank_mask:0xf
    v_add_f32_dpp v104, v104, v104 row_mirror row_mask:0xf bank_mask:0xf
    v_add_f32_dpp v105, v105, v105 row_mirror row_mask:0xf bank_mask:0xf
    v_add_f32_dpp v106, v106, v106 row_mirror row_mask:0xf bank_mask:0xf
    v_add_f32_dpp v107, v107, v107 row_mirror row_mask:0xf bank_mask:0xf
    v_add_f32_dpp v108, v108, v108 row_mirror row_mask:0xf bank_mask:0xf
    v_add_f32_dpp v109, v109, v109 row_mirror row_mask:0xf bank_mask:0xf
    v_add_f32_dpp v110, v110, v110 row_mirror row_mask:0xf bank_mask:0xf
    v_add_f32_dpp v111, v111, v111 row_mirror row_mask:0xf bank_mask:0xf
    v_cmp_eq_u32 vcc, s56, v14
    v_cvt_pk_bf16_f32 v63, v96, v97
    v_lshlrev_b32 v96, 16, v63
    v_and_b32 v97, 0xffff0000, v63
    v_mul_f32 v96, v62, v96
    v_mul_f32 v97, v62, v97
    v_cvt_pk_bf16_f32 v63, v96, v97
    v_lshlrev_b32 v96, 16, v63
    v_and_b32 v97, 0xffff0000, v63
    v_cndmask_b32 v24, v24, v96, vcc
    v_cndmask_b32 v25, v25, v97, vcc
    v_cvt_pk_bf16_f32 v63, v98, v99
    v_lshlrev_b32 v98, 16, v63
    v_and_b32 v99, 0xffff0000, v63
    v_mul_f32 v98, v62, v98
    v_mul_f32 v99, v62, v99
    v_cvt_pk_bf16_f32 v63, v98, v99
    v_lshlrev_b32 v98, 16, v63
    v_and_b32 v99, 0xffff0000, v63
    v_cndmask_b32 v26, v26, v98, vcc
    v_cndmask_b32 v27, v27, v99, vcc
    v_cvt_pk_bf16_f32 v63, v100, v101
    v_lshlrev_b32 v100, 16, v63
    v_and_b32 v101, 0xffff0000, v63
    v_mul_f32 v100, v62, v100
    v_mul_f32 v101, v62, v101
    v_cvt_pk_bf16_f32 v63, v100, v101
    v_lshlrev_b32 v100, 16, v63
    v_and_b32 v101, 0xffff0000, v63
    v_cndmask_b32 v28, v28, v100, vcc
    v_cndmask_b32 v29, v29, v101, vcc
    v_cvt_pk_bf16_f32 v63, v102, v103
    v_lshlrev_b32 v102, 16, v63
    v_and_b32 v103, 0xffff0000, v63
    v_mul_f32 v102, v62, v102
    v_mul_f32 v103, v62, v103
    v_cvt_pk_bf16_f32 v63, v102, v103
    v_lshlrev_b32 v102, 16, v63
    v_and_b32 v103, 0xffff0000, v63
    v_cndmask_b32 v30, v30, v102, vcc
    v_cndmask_b32 v31, v31, v103, vcc
    v_cvt_pk_bf16_f32 v63, v104, v105
    v_lshlrev_b32 v104, 16, v63
    v_and_b32 v105, 0xffff0000, v63
    v_mul_f32 v104, v62, v104
    v_mul_f32 v105, v62, v105
    v_cvt_pk_bf16_f32 v63, v104, v105
    v_lshlrev_b32 v104, 16, v63
    v_and_b32 v105, 0xffff0000, v63
    v_cndmask_b32 v32, v32, v104, vcc
    v_cndmask_b32 v33, v33, v105, vcc
    v_cvt_pk_bf16_f32 v63, v106, v107
    v_lshlrev_b32 v106, 16, v63
    v_and_b32 v107, 0xffff0000, v63
    v_mul_f32 v106, v62, v106
    v_mul_f32 v107, v62, v107
    v_cvt_pk_bf16_f32 v63, v106, v107
    v_lshlrev_b32 v106, 16, v63
    v_and_b32 v107, 0xffff0000, v63
    v_cndmask_b32 v34, v34, v106, vcc
    v_cndmask_b32 v35, v35, v107, vcc
    v_cvt_pk_bf16_f32 v63, v108, v109
    v_lshlrev_b32 v108, 16, v63
    v_and_b32 v109, 0xffff0000, v63
    v_mul_f32 v108, v62, v108
    v_mul_f32 v109, v62, v109
    v_cvt_pk_bf16_f32 v63, v108, v109
    v_lshlrev_b32 v108, 16, v63
    v_and_b32 v109, 0xffff0000, v63
    v_cndmask_b32 v36, v36, v108, vcc
    v_cndmask_b32 v37, v37, v109, vcc
    v_cvt_pk_bf16_f32 v63, v110, v111
    v_lshlrev_b32 v110, 16, v63
    v_and_b32 v111, 0xffff0000, v63
    v_mul_f32 v110, v62, v110
    v_mul_f32 v111, v62, v111
    v_cvt_pk_bf16_f32 v63, v110, v111
    v_lshlrev_b32 v110, 16, v63
    v_and_b32 v111, 0xffff0000, v63
    v_cndmask_b32 v38, v38, v110, vcc
    v_cndmask_b32 v39, v39, v111, vcc
L_recurrent_scan__compressed_kv_cla__moe_arch_mod__prompt_kernel_rt2_noy_1:
    s_sub_u32 s36, s57, s38
    s_cmp_lt_u32 s36, 16
    s_cbranch_scc0 L_recurrent_scan__compressed_kv_cla__moe_arch_mod__prompt_kernel_rt2_noy_2
    s_and_b32 s36, s59, 0xffff0000
    s_cmp_lt_i32 s36, 0
    s_cselect_b32 s37, 0x80000000, -1
    s_xor_b32 s36, s36, s37
    s_and_b32 s36, s36, 0xffff0000
    v_mov_b32 v62, s36
    v_mul_f32 v62, 0xbfb8aa3b, v62
    v_exp_f32 v62, v62
    s_nop 0
    v_add_f32 v62, 1.0, v62
    v_rcp_f32 v62, v62
    s_nop 0
    v_cvt_pk_bf16_f32 v62, v62, v62
    v_lshlrev_b32 v62, 16, v62
    v_add_f32_dpp v112, v112, v112 quad_perm:[1,0,3,2] row_mask:0xf bank_mask:0xf
    v_add_f32_dpp v113, v113, v113 quad_perm:[1,0,3,2] row_mask:0xf bank_mask:0xf
    v_add_f32_dpp v114, v114, v114 quad_perm:[1,0,3,2] row_mask:0xf bank_mask:0xf
    v_add_f32_dpp v115, v115, v115 quad_perm:[1,0,3,2] row_mask:0xf bank_mask:0xf
    v_add_f32_dpp v116, v116, v116 quad_perm:[1,0,3,2] row_mask:0xf bank_mask:0xf
    v_add_f32_dpp v117, v117, v117 quad_perm:[1,0,3,2] row_mask:0xf bank_mask:0xf
    v_add_f32_dpp v118, v118, v118 quad_perm:[1,0,3,2] row_mask:0xf bank_mask:0xf
    v_add_f32_dpp v119, v119, v119 quad_perm:[1,0,3,2] row_mask:0xf bank_mask:0xf
    v_add_f32_dpp v120, v120, v120 quad_perm:[1,0,3,2] row_mask:0xf bank_mask:0xf
    v_add_f32_dpp v121, v121, v121 quad_perm:[1,0,3,2] row_mask:0xf bank_mask:0xf
    v_add_f32_dpp v122, v122, v122 quad_perm:[1,0,3,2] row_mask:0xf bank_mask:0xf
    v_add_f32_dpp v123, v123, v123 quad_perm:[1,0,3,2] row_mask:0xf bank_mask:0xf
    v_add_f32_dpp v124, v124, v124 quad_perm:[1,0,3,2] row_mask:0xf bank_mask:0xf
    v_add_f32_dpp v125, v125, v125 quad_perm:[1,0,3,2] row_mask:0xf bank_mask:0xf
    v_add_f32_dpp v126, v126, v126 quad_perm:[1,0,3,2] row_mask:0xf bank_mask:0xf
    v_add_f32_dpp v127, v127, v127 quad_perm:[1,0,3,2] row_mask:0xf bank_mask:0xf
    v_add_f32_dpp v112, v112, v112 quad_perm:[2,3,0,1] row_mask:0xf bank_mask:0xf
    v_add_f32_dpp v113, v113, v113 quad_perm:[2,3,0,1] row_mask:0xf bank_mask:0xf
    v_add_f32_dpp v114, v114, v114 quad_perm:[2,3,0,1] row_mask:0xf bank_mask:0xf
    v_add_f32_dpp v115, v115, v115 quad_perm:[2,3,0,1] row_mask:0xf bank_mask:0xf
    v_add_f32_dpp v116, v116, v116 quad_perm:[2,3,0,1] row_mask:0xf bank_mask:0xf
    v_add_f32_dpp v117, v117, v117 quad_perm:[2,3,0,1] row_mask:0xf bank_mask:0xf
    v_add_f32_dpp v118, v118, v118 quad_perm:[2,3,0,1] row_mask:0xf bank_mask:0xf
    v_add_f32_dpp v119, v119, v119 quad_perm:[2,3,0,1] row_mask:0xf bank_mask:0xf
    v_add_f32_dpp v120, v120, v120 quad_perm:[2,3,0,1] row_mask:0xf bank_mask:0xf
    v_add_f32_dpp v121, v121, v121 quad_perm:[2,3,0,1] row_mask:0xf bank_mask:0xf
    v_add_f32_dpp v122, v122, v122 quad_perm:[2,3,0,1] row_mask:0xf bank_mask:0xf
    v_add_f32_dpp v123, v123, v123 quad_perm:[2,3,0,1] row_mask:0xf bank_mask:0xf
    v_add_f32_dpp v124, v124, v124 quad_perm:[2,3,0,1] row_mask:0xf bank_mask:0xf
    v_add_f32_dpp v125, v125, v125 quad_perm:[2,3,0,1] row_mask:0xf bank_mask:0xf
    v_add_f32_dpp v126, v126, v126 quad_perm:[2,3,0,1] row_mask:0xf bank_mask:0xf
    v_add_f32_dpp v127, v127, v127 quad_perm:[2,3,0,1] row_mask:0xf bank_mask:0xf
    v_add_f32_dpp v112, v112, v112 row_half_mirror row_mask:0xf bank_mask:0xf
    v_add_f32_dpp v113, v113, v113 row_half_mirror row_mask:0xf bank_mask:0xf
    v_add_f32_dpp v114, v114, v114 row_half_mirror row_mask:0xf bank_mask:0xf
    v_add_f32_dpp v115, v115, v115 row_half_mirror row_mask:0xf bank_mask:0xf
    v_add_f32_dpp v116, v116, v116 row_half_mirror row_mask:0xf bank_mask:0xf
    v_add_f32_dpp v117, v117, v117 row_half_mirror row_mask:0xf bank_mask:0xf
    v_add_f32_dpp v118, v118, v118 row_half_mirror row_mask:0xf bank_mask:0xf
    v_add_f32_dpp v119, v119, v119 row_half_mirror row_mask:0xf bank_mask:0xf
    v_add_f32_dpp v120, v120, v120 row_half_mirror row_mask:0xf bank_mask:0xf
    v_add_f32_dpp v121, v121, v121 row_half_mirror row_mask:0xf bank_mask:0xf
    v_add_f32_dpp v122, v122, v122 row_half_mirror row_mask:0xf bank_mask:0xf
    v_add_f32_dpp v123, v123, v123 row_half_mirror row_mask:0xf bank_mask:0xf
    v_add_f32_dpp v124, v124, v124 row_half_mirror row_mask:0xf bank_mask:0xf
    v_add_f32_dpp v125, v125, v125 row_half_mirror row_mask:0xf bank_mask:0xf
    v_add_f32_dpp v126, v126, v126 row_half_mirror row_mask:0xf bank_mask:0xf
    v_add_f32_dpp v127, v127, v127 row_half_mirror row_mask:0xf bank_mask:0xf
    v_add_f32_dpp v112, v112, v112 row_mirror row_mask:0xf bank_mask:0xf
    v_add_f32_dpp v113, v113, v113 row_mirror row_mask:0xf bank_mask:0xf
    v_add_f32_dpp v114, v114, v114 row_mirror row_mask:0xf bank_mask:0xf
    v_add_f32_dpp v115, v115, v115 row_mirror row_mask:0xf bank_mask:0xf
    v_add_f32_dpp v116, v116, v116 row_mirror row_mask:0xf bank_mask:0xf
    v_add_f32_dpp v117, v117, v117 row_mirror row_mask:0xf bank_mask:0xf
    v_add_f32_dpp v118, v118, v118 row_mirror row_mask:0xf bank_mask:0xf
    v_add_f32_dpp v119, v119, v119 row_mirror row_mask:0xf bank_mask:0xf
    v_add_f32_dpp v120, v120, v120 row_mirror row_mask:0xf bank_mask:0xf
    v_add_f32_dpp v121, v121, v121 row_mirror row_mask:0xf bank_mask:0xf
    v_add_f32_dpp v122, v122, v122 row_mirror row_mask:0xf bank_mask:0xf
    v_add_f32_dpp v123, v123, v123 row_mirror row_mask:0xf bank_mask:0xf
    v_add_f32_dpp v124, v124, v124 row_mirror row_mask:0xf bank_mask:0xf
    v_add_f32_dpp v125, v125, v125 row_mirror row_mask:0xf bank_mask:0xf
    v_add_f32_dpp v126, v126, v126 row_mirror row_mask:0xf bank_mask:0xf
    v_add_f32_dpp v127, v127, v127 row_mirror row_mask:0xf bank_mask:0xf
    v_cmp_eq_u32 vcc, s57, v14
    v_cvt_pk_bf16_f32 v63, v112, v113
    v_lshlrev_b32 v112, 16, v63
    v_and_b32 v113, 0xffff0000, v63
    v_mul_f32 v112, v62, v112
    v_mul_f32 v113, v62, v113
    v_cvt_pk_bf16_f32 v63, v112, v113
    v_lshlrev_b32 v112, 16, v63
    v_and_b32 v113, 0xffff0000, v63
    v_cndmask_b32 v24, v24, v112, vcc
    v_cndmask_b32 v25, v25, v113, vcc
    v_cvt_pk_bf16_f32 v63, v114, v115
    v_lshlrev_b32 v114, 16, v63
    v_and_b32 v115, 0xffff0000, v63
    v_mul_f32 v114, v62, v114
    v_mul_f32 v115, v62, v115
    v_cvt_pk_bf16_f32 v63, v114, v115
    v_lshlrev_b32 v114, 16, v63
    v_and_b32 v115, 0xffff0000, v63
    v_cndmask_b32 v26, v26, v114, vcc
    v_cndmask_b32 v27, v27, v115, vcc
    v_cvt_pk_bf16_f32 v63, v116, v117
    v_lshlrev_b32 v116, 16, v63
    v_and_b32 v117, 0xffff0000, v63
    v_mul_f32 v116, v62, v116
    v_mul_f32 v117, v62, v117
    v_cvt_pk_bf16_f32 v63, v116, v117
    v_lshlrev_b32 v116, 16, v63
    v_and_b32 v117, 0xffff0000, v63
    v_cndmask_b32 v28, v28, v116, vcc
    v_cndmask_b32 v29, v29, v117, vcc
    v_cvt_pk_bf16_f32 v63, v118, v119
    v_lshlrev_b32 v118, 16, v63
    v_and_b32 v119, 0xffff0000, v63
    v_mul_f32 v118, v62, v118
    v_mul_f32 v119, v62, v119
    v_cvt_pk_bf16_f32 v63, v118, v119
    v_lshlrev_b32 v118, 16, v63
    v_and_b32 v119, 0xffff0000, v63
    v_cndmask_b32 v30, v30, v118, vcc
    v_cndmask_b32 v31, v31, v119, vcc
    v_cvt_pk_bf16_f32 v63, v120, v121
    v_lshlrev_b32 v120, 16, v63
    v_and_b32 v121, 0xffff0000, v63
    v_mul_f32 v120, v62, v120
    v_mul_f32 v121, v62, v121
    v_cvt_pk_bf16_f32 v63, v120, v121
    v_lshlrev_b32 v120, 16, v63
    v_and_b32 v121, 0xffff0000, v63
    v_cndmask_b32 v32, v32, v120, vcc
    v_cndmask_b32 v33, v33, v121, vcc
    v_cvt_pk_bf16_f32 v63, v122, v123
    v_lshlrev_b32 v122, 16, v63
    v_and_b32 v123, 0xffff0000, v63
    v_mul_f32 v122, v62, v122
    v_mul_f32 v123, v62, v123
    v_cvt_pk_bf16_f32 v63, v122, v123
    v_lshlrev_b32 v122, 16, v63
    v_and_b32 v123, 0xffff0000, v63
    v_cndmask_b32 v34, v34, v122, vcc
    v_cndmask_b32 v35, v35, v123, vcc
    v_cvt_pk_bf16_f32 v63, v124, v125
    v_lshlrev_b32 v124, 16, v63
    v_and_b32 v125, 0xffff0000, v63
    v_mul_f32 v124, v62, v124
    v_mul_f32 v125, v62, v125
    v_cvt_pk_bf16_f32 v63, v124, v125
    v_lshlrev_b32 v124, 16, v63
    v_and_b32 v125, 0xffff0000, v63
    v_cndmask_b32 v36, v36, v124, vcc
    v_cndmask_b32 v37, v37, v125, vcc
    v_cvt_pk_bf16_f32 v63, v126, v127
    v_lshlrev_b32 v126, 16, v63
    v_and_b32 v127, 0xffff0000, v63
    v_mul_f32 v126, v62, v126
    v_mul_f32 v127, v62, v127
    v_cvt_pk_bf16_f32 v63, v126, v127
    v_lshlrev_b32 v126, 16, v63
    v_and_b32 v127, 0xffff0000, v63
    v_cndmask_b32 v38, v38, v126, vcc
    v_cndmask_b32 v39, v39, v127, vcc
L_recurrent_scan__compressed_kv_cla__moe_arch_mod__prompt_kernel_rt2_noy_2:
    s_branch L_recurrent_scan__compressed_kv_cla__moe_arch_mod__prompt_kernel_back_169
L_recurrent_scan__compressed_kv_cla__moe_arch_mod__prompt_kernel_rare_170:
    v_lshlrev_b32 v96, 16, v40
    v_and_b32 v97, 0xffff0000, v40
    v_sub_f32 v112, v96, v48
    v_sub_f32 v113, v97, v48
    v_cvt_pk_bf16_f32 v10, v112, v113
    v_lshlrev_b32 v112, 16, v10
    v_and_b32 v113, 0xffff0000, v10
    v_mul_f32 v112, v112, v49
    v_mul_f32 v113, v113, v49
    v_cvt_pk_bf16_f32 v10, v112, v113
    v_lshlrev_b32 v112, 16, v10
    v_and_b32 v113, 0xffff0000, v10
    v_add_f32 v112, v112, v24
    v_add_f32 v113, v113, v25
    v_cvt_pk_bf16_f32 v10, v112, v113
    v_lshlrev_b32 v112, 16, v10
    v_and_b32 v113, 0xffff0000, v10
    v_mul_f32 v11, 0xbfb8aa3b, v112
    v_mul_f32 v12, 0xbfb8aa3b, v113
    v_exp_f32 v11, v11
    v_exp_f32 v12, v12
    s_nop 0
    v_add_f32 v11, 1.0, v11
    v_add_f32 v12, 1.0, v12
    v_rcp_f32 v11, v11
    v_rcp_f32 v12, v12
    s_nop 0
    v_mul_f32 v112, v112, v11
    v_mul_f32 v113, v113, v12
    v_cvt_pk_bf16_f32 v10, v112, v113
    v_lshlrev_b32 v112, 16, v10
    v_and_b32 v113, 0xffff0000, v10
    v_lshlrev_b32 v98, 16, v41
    v_and_b32 v99, 0xffff0000, v41
    v_sub_f32 v114, v98, v48
    v_sub_f32 v115, v99, v48
    v_cvt_pk_bf16_f32 v10, v114, v115
    v_lshlrev_b32 v114, 16, v10
    v_and_b32 v115, 0xffff0000, v10
    v_mul_f32 v114, v114, v49
    v_mul_f32 v115, v115, v49
    v_cvt_pk_bf16_f32 v10, v114, v115
    v_lshlrev_b32 v114, 16, v10
    v_and_b32 v115, 0xffff0000, v10
    v_add_f32 v114, v114, v26
    v_add_f32 v115, v115, v27
    v_cvt_pk_bf16_f32 v10, v114, v115
    v_lshlrev_b32 v114, 16, v10
    v_and_b32 v115, 0xffff0000, v10
    v_mul_f32 v11, 0xbfb8aa3b, v114
    v_mul_f32 v12, 0xbfb8aa3b, v115
    v_exp_f32 v11, v11
    v_exp_f32 v12, v12
    s_nop 0
    v_add_f32 v11, 1.0, v11
    v_add_f32 v12, 1.0, v12
    v_rcp_f32 v11, v11
    v_rcp_f32 v12, v12
    s_nop 0
    v_mul_f32 v114, v114, v11
    v_mul_f32 v115, v115, v12
    v_cvt_pk_bf16_f32 v10, v114, v115
    v_lshlrev_b32 v114, 16, v10
    v_and_b32 v115, 0xffff0000, v10
    v_lshlrev_b32 v100, 16, v42
    v_and_b32 v101, 0xffff0000, v42
    v_sub_f32 v116, v100, v48
    v_sub_f32 v117, v101, v48
    v_cvt_pk_bf16_f32 v10, v116, v117
    v_lshlrev_b32 v116, 16, v10
    v_and_b32 v117, 0xffff0000, v10
    v_mul_f32 v116, v116, v49
    v_mul_f32 v117, v117, v49
    v_cvt_pk_bf16_f32 v10, v116, v117
    v_lshlrev_b32 v116, 16, v10
    v_and_b32 v117, 0xffff0000, v10
    v_add_f32 v116, v116, v28
    v_add_f32 v117, v117, v29
    v_cvt_pk_bf16_f32 v10, v116, v117
    v_lshlrev_b32 v116, 16, v10
    v_and_b32 v117, 0xffff0000, v10
    v_mul_f32 v11, 0xbfb8aa3b, v116
    v_mul_f32 v12, 0xbfb8aa3b, v117
    v_exp_f32 v11, v11
    v_exp_f32 v12, v12
    s_nop 0
    v_add_f32 v11, 1.0, v11
    v_add_f32 v12, 1.0, v12
    v_rcp_f32 v11, v11
    v_rcp_f32 v12, v12
    s_nop 0
    v_mul_f32 v116, v116, v11
    v_mul_f32 v117, v117, v12
    v_cvt_pk_bf16_f32 v10, v116, v117
    v_lshlrev_b32 v116, 16, v10
    v_and_b32 v117, 0xffff0000, v10
    v_lshlrev_b32 v102, 16, v43
    v_and_b32 v103, 0xffff0000, v43
    v_sub_f32 v118, v102, v48
    v_sub_f32 v119, v103, v48
    v_cvt_pk_bf16_f32 v10, v118, v119
    v_lshlrev_b32 v118, 16, v10
    v_and_b32 v119, 0xffff0000, v10
    v_mul_f32 v118, v118, v49
    v_mul_f32 v119, v119, v49
    v_cvt_pk_bf16_f32 v10, v118, v119
    v_lshlrev_b32 v118, 16, v10
    v_and_b32 v119, 0xffff0000, v10
    v_add_f32 v118, v118, v30
    v_add_f32 v119, v119, v31
    v_cvt_pk_bf16_f32 v10, v118, v119
    v_lshlrev_b32 v118, 16, v10
    v_and_b32 v119, 0xffff0000, v10
    v_mul_f32 v11, 0xbfb8aa3b, v118
    v_mul_f32 v12, 0xbfb8aa3b, v119
    v_exp_f32 v11, v11
    v_exp_f32 v12, v12
    s_nop 0
    v_add_f32 v11, 1.0, v11
    v_add_f32 v12, 1.0, v12
    v_rcp_f32 v11, v11
    v_rcp_f32 v12, v12
    s_nop 0
    v_mul_f32 v118, v118, v11
    v_mul_f32 v119, v119, v12
    v_cvt_pk_bf16_f32 v10, v118, v119
    v_lshlrev_b32 v118, 16, v10
    v_and_b32 v119, 0xffff0000, v10
    v_lshlrev_b32 v104, 16, v44
    v_and_b32 v105, 0xffff0000, v44
    v_sub_f32 v120, v104, v48
    v_sub_f32 v121, v105, v48
    v_cvt_pk_bf16_f32 v10, v120, v121
    v_lshlrev_b32 v120, 16, v10
    v_and_b32 v121, 0xffff0000, v10
    v_mul_f32 v120, v120, v49
    v_mul_f32 v121, v121, v49
    v_cvt_pk_bf16_f32 v10, v120, v121
    v_lshlrev_b32 v120, 16, v10
    v_and_b32 v121, 0xffff0000, v10
    v_add_f32 v120, v120, v32
    v_add_f32 v121, v121, v33
    v_cvt_pk_bf16_f32 v10, v120, v121
    v_lshlrev_b32 v120, 16, v10
    v_and_b32 v121, 0xffff0000, v10
    v_mul_f32 v11, 0xbfb8aa3b, v120
    v_mul_f32 v12, 0xbfb8aa3b, v121
    v_exp_f32 v11, v11
    v_exp_f32 v12, v12
    s_nop 0
    v_add_f32 v11, 1.0, v11
    v_add_f32 v12, 1.0, v12
    v_rcp_f32 v11, v11
    v_rcp_f32 v12, v12
    s_nop 0
    v_mul_f32 v120, v120, v11
    v_mul_f32 v121, v121, v12
    v_cvt_pk_bf16_f32 v10, v120, v121
    v_lshlrev_b32 v120, 16, v10
    v_and_b32 v121, 0xffff0000, v10
    v_lshlrev_b32 v106, 16, v45
    v_and_b32 v107, 0xffff0000, v45
    v_sub_f32 v122, v106, v48
    v_sub_f32 v123, v107, v48
    v_cvt_pk_bf16_f32 v10, v122, v123
    v_lshlrev_b32 v122, 16, v10
    v_and_b32 v123, 0xffff0000, v10
    v_mul_f32 v122, v122, v49
    v_mul_f32 v123, v123, v49
    v_cvt_pk_bf16_f32 v10, v122, v123
    v_lshlrev_b32 v122, 16, v10
    v_and_b32 v123, 0xffff0000, v10
    v_add_f32 v122, v122, v34
    v_add_f32 v123, v123, v35
    v_cvt_pk_bf16_f32 v10, v122, v123
    v_lshlrev_b32 v122, 16, v10
    v_and_b32 v123, 0xffff0000, v10
    v_mul_f32 v11, 0xbfb8aa3b, v122
    v_mul_f32 v12, 0xbfb8aa3b, v123
    v_exp_f32 v11, v11
    v_exp_f32 v12, v12
    s_nop 0
    v_add_f32 v11, 1.0, v11
    v_add_f32 v12, 1.0, v12
    v_rcp_f32 v11, v11
    v_rcp_f32 v12, v12
    s_nop 0
    v_mul_f32 v122, v122, v11
    v_mul_f32 v123, v123, v12
    v_cvt_pk_bf16_f32 v10, v122, v123
    v_lshlrev_b32 v122, 16, v10
    v_and_b32 v123, 0xffff0000, v10
    v_lshlrev_b32 v108, 16, v46
    v_and_b32 v109, 0xffff0000, v46
    v_sub_f32 v124, v108, v48
    v_sub_f32 v125, v109, v48
    v_cvt_pk_bf16_f32 v10, v124, v125
    v_lshlrev_b32 v124, 16, v10
    v_and_b32 v125, 0xffff0000, v10
    v_mul_f32 v124, v124, v49
    v_mul_f32 v125, v125, v49
    v_cvt_pk_bf16_f32 v10, v124, v125
    v_lshlrev_b32 v124, 16, v10
    v_and_b32 v125, 0xffff0000, v10
    v_add_f32 v124, v124, v36
    v_add_f32 v125, v125, v37
    v_cvt_pk_bf16_f32 v10, v124, v125
    v_lshlrev_b32 v124, 16, v10
    v_and_b32 v125, 0xffff0000, v10
    v_mul_f32 v11, 0xbfb8aa3b, v124
    v_mul_f32 v12, 0xbfb8aa3b, v125
    v_exp_f32 v11, v11
    v_exp_f32 v12, v12
    s_nop 0
    v_add_f32 v11, 1.0, v11
    v_add_f32 v12, 1.0, v12
    v_rcp_f32 v11, v11
    v_rcp_f32 v12, v12
    s_nop 0
    v_mul_f32 v124, v124, v11
    v_mul_f32 v125, v125, v12
    v_cvt_pk_bf16_f32 v10, v124, v125
    v_lshlrev_b32 v124, 16, v10
    v_and_b32 v125, 0xffff0000, v10
    v_lshlrev_b32 v110, 16, v47
    v_and_b32 v111, 0xffff0000, v47
    v_sub_f32 v126, v110, v48
    v_sub_f32 v127, v111, v48
    v_cvt_pk_bf16_f32 v10, v126, v127
    v_lshlrev_b32 v126, 16, v10
    v_and_b32 v127, 0xffff0000, v10
    v_mul_f32 v126, v126, v49
    v_mul_f32 v127, v127, v49
    v_cvt_pk_bf16_f32 v10, v126, v127
    v_lshlrev_b32 v126, 16, v10
    v_and_b32 v127, 0xffff0000, v10
    v_add_f32 v126, v126, v38
    v_add_f32 v127, v127, v39
    v_cvt_pk_bf16_f32 v10, v126, v127
    v_lshlrev_b32 v126, 16, v10
    v_and_b32 v127, 0xffff0000, v10
    v_mul_f32 v11, 0xbfb8aa3b, v126
    v_mul_f32 v12, 0xbfb8aa3b, v127
    v_exp_f32 v11, v11
    v_exp_f32 v12, v12
    s_nop 0
    v_add_f32 v11, 1.0, v11
    v_add_f32 v12, 1.0, v12
    v_rcp_f32 v11, v11
    v_rcp_f32 v12, v12
    s_nop 0
    v_mul_f32 v126, v126, v11
    v_mul_f32 v127, v127, v12
    v_cvt_pk_bf16_f32 v10, v126, v127
    v_lshlrev_b32 v126, 16, v10
    v_and_b32 v127, 0xffff0000, v10
    s_branch L_recurrent_scan__compressed_kv_cla__moe_arch_mod__prompt_kernel_back_171
L_recurrent_scan__compressed_kv_cla__moe_arch_mod__prompt_kernel_rare_174:
    s_mov_b32 s61, 0x40000
L_recurrent_scan__compressed_kv_cla__moe_arch_mod__prompt_kernel_spin_172:
    s_sub_u32 s61, s61, 1
    s_cbranch_scc1 L_recurrent_scan__compressed_kv_cla__moe_arch_mod__prompt_kernel_spinx_173
    s_sleep 1
    global_load_dword v23, v5, s[90:91] sc1
    s_waitcnt vmcnt(0)
    v_readfirstlane_b32 s36, v23
    s_nop 0
    s_cmp_lt_u32 s36, 8
    s_cbranch_scc1 L_recurrent_scan__compressed_kv_cla__moe_arch_mod__prompt_kernel_spin_172
L_recurrent_scan__compressed_kv_cla__moe_arch_mod__prompt_kernel_spinx_173:
    s_branch L_recurrent_scan__compressed_kv_cla__moe_arch_mod__prompt_kernel_back_175
L_end:
    s_endpgm
.section .rodata,"a"
.p2align 6
.amdhsa_kernel recurrent_scan__compressed_kv_cla__moe_arch_mod__prompt_kernel
  .amdhsa_next_free_vgpr 256
  .amdhsa_next_free_sgpr 102
  .amdhsa_accum_offset 256
  .amdhsa_group_segment_fixed_size 0
  .amdhsa_kernarg_size 112
  .amdhsa_user_sgpr_count 2
  .amdhsa_user_sgpr_kernarg_segment_ptr 1
  .amdhsa_system_sgpr_workgroup_id_x 1
.end_amdhsa_kernel
```

```asm
; @launch kernel=recurrent_scan__compressed_kv_cla__moe_arch_mod__prompt_kernel grid=(256,1,1) block=(512,1,1) lds=163840
.amdgcn_target "amdgcn-amd-amdhsa--gfx950"
.text
.globl recurrent_scan__compressed_kv_cla__moe_arch_mod__prompt_kernel
.p2align 8
.type recurrent_scan__compressed_kv_cla__moe_arch_mod__prompt_kernel,@function
recurrent_scan__compressed_kv_cla__moe_arch_mod__prompt_kernel:
    s_cmp_ge_u32 s2, 256
    s_cbranch_scc1 L_end
    s_load_dwordx4 s[44:47], s[0:1], 0
    s_load_dwordx2 s[52:53], s[0:1], 56
    s_load_dwordx4 s[48:51], s[0:1], 24
    s_getpc_b64 s[36:37]
L_pc:
    s_lshr_b32 s38, s2, 3
    s_lshl_b32 s38, s38, 7
    v_lshl_add_u32 v16, v0, 12, s38
    v_cmp_gt_u32 vcc, L_end-L_pc-4, v16
    v_mov_b32 v17, s37
    s_and_b64 exec, exec, vcc
    s_cbranch_execz L_nocpf
    v_add_co_u32 v16, vcc, s36, v16
    s_nop 1
    v_addc_co_u32 v17, vcc, 0, v17, vcc
    global_load_dword v119, v[16:17], off
L_nocpf:
    s_mov_b64 exec, -1
    v_lshrrev_b32 v16, 6, v0
    v_and_b32 v1, 63, v0
    v_readfirstlane_b32 s28, v16
    v_lshlrev_b32 v116, 4, v1
    s_lshl_b32 s42, s2, 3
    s_cmp_lt_u32 s28, 4
    s_cbranch_scc1 L_nox
    s_add_u32 s43, s42, s28
    s_sub_u32 s42, s43, 4
    v_lshl_add_u32 v18, s42, 11, v116
    v_add_u32 v19, 8192, v18
    s_waitcnt lgkmcnt(0)
    global_load_dwordx4 v[20:23], v18, s[44:45] nt
    global_load_dwordx4 v[24:27], v18, s[44:45] offset:1024 nt
    global_load_dwordx4 v[28:31], v19, s[44:45] nt
    global_load_dwordx4 v[32:35], v19, s[44:45] offset:1024 nt
    global_load_dwordx4 v[36:39], v116, s[52:53]
    global_load_dwordx4 v[40:43], v116, s[52:53] offset:1024
    s_barrier
L_nox:
    s_load_dwordx4 s[88:91], s[0:1], 96
    s_load_dwordx4 s[92:95], s[0:1], 64
    s_load_dwordx2 s[96:97], s[0:1], 16
    s_and_b32 s29, s2, 7
    s_lshl_b32 s29, s29, 2
    s_lshr_b32 s29, 0x75643120, s29
    s_and_b32 s29, s29, 7
    s_lshl_b32 s29, s29, 2
    s_bfe_u32 s36, s2, 0x20003
    s_add_u32 s29, s29, s36
    s_lshr_b32 s30, s2, 5
    v_lshrrev_b32 v16, 3, v1
    s_lshl_b32 s36, s30, 8
    s_lshl_b32 s37, s28, 5
    s_add_u32 s36, s36, s37
    v_add_u32 v16, s36, v16
    v_lshlrev_b32 v16, 10, v16
    v_lshrrev_b32 v18, 4, v1
    v_and_b32 v19, 7, v1
    v_xor_b32 v19, v19, v18
    v_lshl_add_u32 v2, v19, 4, v16
    v_xor_b32 v19, 4, v19
    v_lshl_add_u32 v3, v19, 4, v16
    v_add_u32 v3, 7168, v3
    v_add_u32 v4, 14336, v2
    v_add_u32 v5, 14336, v3
    s_and_b32 s36, s28, 3
    s_lshl_b32 s37, s36, 4
    v_add_u32 v16, s37, v18
    v_lshlrev_b32 v16, 13, v16
    s_lshl_b32 s37, s29, 8
    v_add_u32 v16, s37, v16
    v_and_b32 v19, 15, v1
    v_lshlrev_b32 v18, 1, v18
    v_xor_b32 v19, v19, v18
    v_lshl_add_u32 v6, v19, 4, v16
    v_add_u32 v7, 31744, v6
    v_xor_b32 v19, 8, v19
    v_lshl_add_u32 v8, v19, 4, v16
    v_add_u32 v8, 63488, v8
    v_add_u32 v9, 31744, v8
    s_lshl_b32 s33, s28, 12
    s_add_u32 s34, s33, 65536
    s_mov_b32 s31, 0
    s_mov_b32 s32, 0
    s_mov_b32 s40, 128
    s_mov_b32 s41, 524288
    s_waitcnt lgkmcnt(0)
    s_mov_b32 s4, s46
    s_and_b32 s5, s47, 0xffff
    s_mov_b32 s6, 2097152
    s_mov_b32 s7, 0x20000
    s_mov_b32 s8, s48
    s_and_b32 s9, s49, 0xffff
    s_mov_b32 s10, 4194304
    s_mov_b32 s11, 0x20000
    s_mov_b32 s20, s50
    s_and_b32 s21, s51, 0xffff
    s_mov_b32 s22, 4194304
    s_mov_b32 s23, 0x20000
    s_cmp_lt_u32 s28, 4
    s_cbranch_scc0 L_pro_s
    s_barrier
    s_cmp_eq_u32 s2, 0
    s_cbranch_scc1 L_recurrent_scan__compressed_kv_cla__moe_arch_mod__prompt_kernel_rare_1
L_recurrent_scan__compressed_kv_cla__moe_arch_mod__prompt_kernel_back_2:
    s_add_u32 m0, s33, 0
    s_add_u32 s36, s31, 131072
    buffer_load_dwordx4 v2, s[4:7], s31 offen offset:0 lds
    buffer_load_dwordx4 v3, s[4:7], s31 offen offset:1024 lds
    buffer_load_dwordx4 v4, s[4:7], s31 offen offset:2048 lds
    buffer_load_dwordx4 v5, s[4:7], s31 offen offset:3072 lds
    s_add_u32 m0, s34, 0
    s_nop 0
    buffer_load_dwordx4 v6, s[8:11], s32 offen offset:0 nt lds
    buffer_load_dwordx4 v7, s[8:11], s32 offen offset:1024 nt lds
    buffer_load_dwordx4 v8, s[8:11], s32 offen offset:2048 nt lds
    buffer_load_dwordx4 v9, s[8:11], s32 offen offset:3072 nt lds
    s_add_u32 m0, s33, 16384
    s_nop 0
    buffer_load_dwordx4 v2, s[4:7], s36 offen offset:0 lds
    buffer_load_dwordx4 v3, s[4:7], s36 offen offset:1024 lds
    buffer_load_dwordx4 v4, s[4:7], s36 offen offset:2048 lds
    buffer_load_dwordx4 v5, s[4:7], s36 offen offset:3072 lds
    s_add_u32 m0, s34, 16384
    s_nop 0
    buffer_load_dwordx4 v6, s[20:23], s32 offen offset:0 nt lds
    buffer_load_dwordx4 v7, s[20:23], s32 offen offset:1024 nt lds
    buffer_load_dwordx4 v8, s[20:23], s32 offen offset:2048 nt lds
    buffer_load_dwordx4 v9, s[20:23], s32 offen offset:3072 nt lds
    s_add_u32 s31, s31, s40
    s_add_u32 s32, s32, s41
L_pro_s:
    s_add_u32 s54, s90, 0
    s_addc_u32 s55, s91, 0
    s_add_u32 s12, s54, 8388608
    s_addc_u32 s13, s55, 0
    s_and_b32 s13, s13, 0xffff
    s_mov_b32 s14, 134217856
    s_mov_b32 s15, 0x20000
    s_mov_b32 s24, s54
    s_and_b32 s25, s55, 0xffff
    s_mov_b32 s26, 184549504
    s_mov_b32 s27, 0x20000
    s_add_u32 s90, s54, 61865984
    s_addc_u32 s91, s55, 0
    v_and_b32 v16, 15, v1
    v_lshrrev_b32 v17, 4, v1
    s_bfe_u32 s36, s28, 0x10001
    s_lshl_b32 s36, s36, 14
    v_lshl_add_u32 v18, v16, 7, s36
    v_lshrrev_b32 v19, 1, v16
    v_xor_b32 v19, v19, v17
    v_lshl_add_u32 v10, v19, 4, v18
    v_xor_b32 v19, 4, v19
    v_lshl_add_u32 v11, v19, 4, v18
    v_lshrrev_b32 v16, 2, v16
    v_lshl_add_u32 v18, v17, 3, v16
    v_lshlrev_b32 v18, 8, v18
    s_lshr_b32 s36, s28, 2
    s_lshl_b32 s36, s36, 14
    s_add_u32 s36, s36, 65536
    v_add_u32 v18, s36, v18
    v_and_b32 v19, 3, v1
    v_lshl_add_u32 v18, v19, 3, v18
    v_and_b32 v17, 1, v17
    v_lshl_add_u32 v16, v17, 2, v16
    s_and_b32 s36, s28, 1
    s_lshl_b32 s36, s36, 2
    s_add_u32 s37, s36, 0
    v_xor_b32 v19, s37, v16
    v_lshl_add_u32 v12, v19, 5, v18
    s_add_u32 s37, s36, 1
    v_xor_b32 v19, s37, v16
    v_lshl_add_u32 v13, v19, 5, v18
    s_add_u32 s37, s36, 2
    v_xor_b32 v19, s37, v16
    v_lshl_add_u32 v14, v19, 5, v18
    s_add_u32 s37, s36, 3
    v_xor_b32 v19, s37, v16
    v_lshl_add_u32 v15, v19, 5, v18
    v_mov_b64 v[128:129], 0
    v_mov_b64 v[130:131], 0
    v_mov_b64 v[132:133], 0
    v_mov_b64 v[134:135], 0
    v_mov_b64 v[136:137], 0
    v_mov_b64 v[138:139], 0
    v_mov_b64 v[140:141], 0
    v_mov_b64 v[142:143], 0
    v_mov_b64 v[144:145], 0
    v_mov_b64 v[146:147], 0
    v_mov_b64 v[148:149], 0
    v_mov_b64 v[150:151], 0
    v_mov_b64 v[152:153], 0
    v_mov_b64 v[154:155], 0
    v_mov_b64 v[156:157], 0
    v_mov_b64 v[158:159], 0
    v_mov_b64 v[160:161], 0
    v_mov_b64 v[162:163], 0
    v_mov_b64 v[164:165], 0
    v_mov_b64 v[166:167], 0
    v_mov_b64 v[168:169], 0
    v_mov_b64 v[170:171], 0
    v_mov_b64 v[172:173], 0
    v_mov_b64 v[174:175], 0
    v_mov_b64 v[176:177], 0
    v_mov_b64 v[178:179], 0
    v_mov_b64 v[180:181], 0
    v_mov_b64 v[182:183], 0
    v_mov_b64 v[184:185], 0
    v_mov_b64 v[186:187], 0
    v_mov_b64 v[188:189], 0
    v_mov_b64 v[190:191], 0
    v_mov_b64 v[192:193], 0
    v_mov_b64 v[194:195], 0
    v_mov_b64 v[196:197], 0
    v_mov_b64 v[198:199], 0
    v_mov_b64 v[200:201], 0
    v_mov_b64 v[202:203], 0
    v_mov_b64 v[204:205], 0
    v_mov_b64 v[206:207], 0
    v_mov_b64 v[208:209], 0
    v_mov_b64 v[210:211], 0
    v_mov_b64 v[212:213], 0
    v_mov_b64 v[214:215], 0
    v_mov_b64 v[216:217], 0
    v_mov_b64 v[218:219], 0
    v_mov_b64 v[220:221], 0
    v_mov_b64 v[222:223], 0
    v_mov_b64 v[224:225], 0
    v_mov_b64 v[226:227], 0
    v_mov_b64 v[228:229], 0
    v_mov_b64 v[230:231], 0
    v_mov_b64 v[232:233], 0
    v_mov_b64 v[234:235], 0
    v_mov_b64 v[236:237], 0
    v_mov_b64 v[238:239], 0
    v_mov_b64 v[240:241], 0
    v_mov_b64 v[242:243], 0
    v_mov_b64 v[244:245], 0
    v_mov_b64 v[246:247], 0
    v_mov_b64 v[248:249], 0
    v_mov_b64 v[250:251], 0
    v_mov_b64 v[252:253], 0
    v_mov_b64 v[254:255], 0
    v_mov_b32 v118, 0
    v_mov_b32 v117, 0
    s_lshr_b32 s36, s2, 3
    s_lshl_b32 s36, s36, 5
    s_lshl_b32 s37, s28, 2
    s_add_u32 s36, s36, s37
    v_bfe_u32 v17, v1, 3, 2
    v_add_u32 v17, s36, v17
    v_lshlrev_b32 v17, 13, v17
    v_and_b32 v19, 7, v1
    v_lshl_add_u32 v17, v19, 7, v17
    s_and_b32 s36, s29, 28
    s_lshl_b32 s36, s36, 8
    v_add_u32 v17, s36, v17
    s_mov_b32 s45, 8192
    s_cmp_lt_u32 s28, 4
    s_cbranch_scc0 L_pro_b
    s_add_u32 m0, s33, 32768
    s_add_u32 s36, s31, 131072
    buffer_load_dwordx4 v2, s[4:7], s31 offen offset:0 lds
    buffer_load_dwordx4 v3, s[4:7], s31 offen offset:1024 lds
    buffer_load_dwordx4 v4, s[4:7], s31 offen offset:2048 lds
    buffer_load_dwordx4 v5, s[4:7], s31 offen offset:3072 lds
    s_add_u32 m0, s34, 32768
    s_nop 0
    buffer_load_dwordx4 v6, s[8:11], s32 offen offset:0 nt lds
    buffer_load_dwordx4 v7, s[8:11], s32 offen offset:1024 nt lds
    buffer_load_dwordx4 v8, s[8:11], s32 offen offset:2048 nt lds
    buffer_load_dwordx4 v9, s[8:11], s32 offen offset:3072 nt lds
    s_add_u32 m0, s33, 49152
    s_nop 0
    buffer_load_dwordx4 v2, s[4:7], s36 offen offset:0 lds
    buffer_load_dwordx4 v3, s[4:7], s36 offen offset:1024 lds
    buffer_load_dwordx4 v4, s[4:7], s36 offen offset:2048 lds
    buffer_load_dwordx4 v5, s[4:7], s36 offen offset:3072 lds
    s_add_u32 m0, s34, 49152
    s_nop 0
    buffer_load_dwordx4 v6, s[20:23], s32 offen offset:0 nt lds
    buffer_load_dwordx4 v7, s[20:23], s32 offen offset:1024 nt lds
    buffer_load_dwordx4 v8, s[20:23], s32 offen offset:2048 nt lds
    buffer_load_dwordx4 v9, s[20:23], s32 offen offset:3072 nt lds
    s_add_u32 s31, s31, s40
    s_add_u32 s32, s32, s41
    s_waitcnt vmcnt(16)
    s_branch L_pro_j
L_pro_b:
    s_mov_b64 s[8:9], s[20:21]
    s_mov_b32 s31, 256
    s_mov_b32 s32, 1048576
    s_and_b32 s60, s28, 3
    s_waitcnt vmcnt(0)
    s_mov_b32 s3, 0
L_ln:
    v_lshlrev_b32 v44, 16, v36
    v_and_b32 v45, 0xffff0000, v36
    v_lshlrev_b32 v46, 16, v37
    v_and_b32 v47, 0xffff0000, v37
    v_lshlrev_b32 v48, 16, v38
    v_and_b32 v49, 0xffff0000, v38
    v_lshlrev_b32 v50, 16, v39
    v_and_b32 v51, 0xffff0000, v39
    v_lshlrev_b32 v52, 16, v40
    v_and_b32 v53, 0xffff0000, v40
    v_lshlrev_b32 v54, 16, v41
    v_and_b32 v55, 0xffff0000, v41
    v_lshlrev_b32 v56, 16, v42
    v_and_b32 v57, 0xffff0000, v42
    v_lshlrev_b32 v58, 16, v43
    v_and_b32 v59, 0xffff0000, v43
    v_lshlrev_b32 v60, 16, v20
    v_lshlrev_b32 v76, 16, v28
    v_and_b32 v61, 0xffff0000, v20
    v_and_b32 v77, 0xffff0000, v28
    v_lshlrev_b32 v62, 16, v21
    v_lshlrev_b32 v78, 16, v29
    v_and_b32 v63, 0xffff0000, v21
    v_and_b32 v79, 0xffff0000, v29
    v_lshlrev_b32 v64, 16, v22
    v_lshlrev_b32 v80, 16, v30
    v_and_b32 v65, 0xffff0000, v22
    v_and_b32 v81, 0xffff0000, v30
    v_lshlrev_b32 v66, 16, v23
    v_lshlrev_b32 v82, 16, v31
    v_and_b32 v67, 0xffff0000, v23
    v_and_b32 v83, 0xffff0000, v31
    v_lshlrev_b32 v68, 16, v24
    v_lshlrev_b32 v84, 16, v32
    v_and_b32 v69, 0xffff0000, v24
    v_and_b32 v85, 0xffff0000, v32
    v_lshlrev_b32 v70, 16, v25
    v_lshlrev_b32 v86, 16, v33
    v_and_b32 v71, 0xffff0000, v25
    v_and_b32 v87, 0xffff0000, v33
    v_lshlrev_b32 v72, 16, v26
    v_lshlrev_b32 v88, 16, v34
    v_and_b32 v73, 0xffff0000, v26
    v_and_b32 v89, 0xffff0000, v34
    v_lshlrev_b32 v74, 16, v27
    v_lshlrev_b32 v90, 16, v35
    v_and_b32 v75, 0xffff0000, v27
    v_and_b32 v91, 0xffff0000, v35
    v_pk_add_f32 v[92:93], v[60:61], v[62:63]
    v_pk_add_f32 v[100:101], v[76:77], v[78:79]
    v_pk_add_f32 v[92:93], v[92:93], v[64:65]
    v_pk_add_f32 v[100:101], v[100:101], v[80:81]
    v_pk_add_f32 v[92:93], v[92:93], v[66:67]
    v_pk_add_f32 v[100:101], v[100:101], v[82:83]
    v_pk_add_f32 v[92:93], v[92:93], v[68:69]
    v_pk_add_f32 v[100:101], v[100:101], v[84:85]
    v_pk_add_f32 v[92:93], v[92:93], v[70:71]
    v_pk_add_f32 v[100:101], v[100:101], v[86:87]
    v_pk_add_f32 v[92:93], v[92:93], v[72:73]
    v_pk_add_f32 v[100:101], v[100:101], v[88:89]
    v_pk_add_f32 v[92:93], v[92:93], v[74:75]
    v_pk_add_f32 v[100:101], v[100:101], v[90:91]
    v_add_f32 v92, v92, v93
    v_add_f32 v100, v100, v101
    s_nop 0
    v_add_f32_dpp v92, v92, v92 quad_perm:[1,0,3,2] row_mask:0xf bank_mask:0xf
    v_add_f32_dpp v100, v100, v100 quad_perm:[1,0,3,2] row_mask:0xf bank_mask:0xf
    s_nop 0
    v_add_f32_dpp v92, v92, v92 quad_perm:[2,3,0,1] row_mask:0xf bank_mask:0xf
    v_add_f32_dpp v100, v100, v100 quad_perm:[2,3,0,1] row_mask:0xf bank_mask:0xf
    s_nop 0
    v_add_f32_dpp v92, v92, v92 row_half_mirror row_mask:0xf bank_mask:0xf
    v_add_f32_dpp v100, v100, v100 row_half_mirror row_mask:0xf bank_mask:0xf
    s_nop 0
    v_add_f32_dpp v92, v92, v92 row_mirror row_mask:0xf bank_mask:0xf
    v_add_f32_dpp v100, v100, v100 row_mirror row_mask:0xf bank_mask:0xf
    v_readlane_b32 s36, v92, 0
    v_readlane_b32 s56, v100, 0
    v_readlane_b32 s37, v92, 16
    v_readlane_b32 s57, v100, 16
    v_readlane_b32 s38, v92, 32
    v_readlane_b32 s58, v100, 32
    v_readlane_b32 s39, v92, 48
    v_readlane_b32 s59, v100, 48
    v_mov_b32 v96, s36
    v_mov_b32 v104, s56
    v_add_f32 v96, s37, v96
    v_add_f32 v104, s57, v104
    v_add_f32 v96, s38, v96
    v_add_f32 v104, s58, v104
    v_add_f32 v96, s39, v96
    v_add_f32 v104, s59, v104
    v_mul_f32 v96, 0xba800000, v96
    v_mul_f32 v104, 0xba800000, v104
    v_mov_b32 v97, v96
    v_mov_b32 v105, v104
    v_pk_add_f32 v[94:95], v[60:61], v[96:97]
    v_pk_add_f32 v[102:103], v[76:77], v[104:105]
    v_pk_mul_f32 v[92:93], v[94:95], v[94:95]
    v_pk_mul_f32 v[100:101], v[102:103], v[102:103]
    v_pk_add_f32 v[94:95], v[62:63], v[96:97]
    v_pk_add_f32 v[102:103], v[78:79], v[104:105]
    v_pk_fma_f32 v[92:93], v[94:95], v[94:95], v[92:93]
    v_pk_fma_f32 v[100:101], v[102:103], v[102:103], v[100:101]
    v_pk_add_f32 v[94:95], v[64:65], v[96:97]
    v_pk_add_f32 v[102:103], v[80:81], v[104:105]
    v_pk_fma_f32 v[92:93], v[94:95], v[94:95], v[92:93]
    v_pk_fma_f32 v[100:101], v[102:103], v[102:103], v[100:101]
    v_pk_add_f32 v[94:95], v[66:67], v[96:97]
    v_pk_add_f32 v[102:103], v[82:83], v[104:105]
    v_pk_fma_f32 v[92:93], v[94:95], v[94:95], v[92:93]
    v_pk_fma_f32 v[100:101], v[102:103], v[102:103], v[100:101]
    v_pk_add_f32 v[94:95], v[68:69], v[96:97]
    v_pk_add_f32 v[102:103], v[84:85], v[104:105]
    v_pk_fma_f32 v[92:93], v[94:95], v[94:95], v[92:93]
    v_pk_fma_f32 v[100:101], v[102:103], v[102:103], v[100:101]
    v_pk_add_f32 v[94:95], v[70:71], v[96:97]
    v_pk_add_f32 v[102:103], v[86:87], v[104:105]
    v_pk_fma_f32 v[92:93], v[94:95], v[94:95], v[92:93]
    v_pk_fma_f32 v[100:101], v[102:103], v[102:103], v[100:101]
    v_pk_add_f32 v[94:95], v[72:73], v[96:97]
    v_pk_add_f32 v[102:103], v[88:89], v[104:105]
    v_pk_fma_f32 v[92:93], v[94:95], v[94:95], v[92:93]
    v_pk_fma_f32 v[100:101], v[102:103], v[102:103], v[100:101]
    v_pk_add_f32 v[94:95], v[74:75], v[96:97]
    v_pk_add_f32 v[102:103], v[90:91], v[104:105]
    v_pk_fma_f32 v[92:93], v[94:95], v[94:95], v[92:93]
    v_pk_fma_f32 v[100:101], v[102:103], v[102:103], v[100:101]
    v_add_f32 v92, v92, v93
    v_add_f32 v100, v100, v101
    s_nop 0
    v_add_f32_dpp v92, v92, v92 quad_perm:[1,0,3,2] row_mask:0xf bank_mask:0xf
    v_add_f32_dpp v100, v100, v100 quad_perm:[1,0,3,2] row_mask:0xf bank_mask:0xf
    s_nop 0
    v_add_f32_dpp v92, v92, v92 quad_perm:[2,3,0,1] row_mask:0xf bank_mask:0xf
    v_add_f32_dpp v100, v100, v100 quad_perm:[2,3,0,1] row_mask:0xf bank_mask:0xf
    s_nop 0
    v_add_f32_dpp v92, v92, v92 row_half_mirror row_mask:0xf bank_mask:0xf
    v_add_f32_dpp v100, v100, v100 row_half_mirror row_mask:0xf bank_mask:0xf
    s_nop 0
    v_add_f32_dpp v92, v92, v92 row_mirror row_mask:0xf bank_mask:0xf
    v_add_f32_dpp v100, v100, v100 row_mirror row_mask:0xf bank_mask:0xf
    v_readlane_b32 s36, v92, 0
    v_readlane_b32 s56, v100, 0
    v_readlane_b32 s37, v92, 16
    v_readlane_b32 s57, v100, 16
    v_readlane_b32 s38, v92, 32
    v_readlane_b32 s58, v100, 32
    v_readlane_b32 s39, v92, 48
    v_readlane_b32 s59, v100, 48
    v_mov_b32 v94, s36
    v_mov_b32 v102, s56
    v_add_f32 v94, s37, v94
    v_add_f32 v102, s57, v102
    v_add_f32 v94, s38, v94
    v_add_f32 v102, s58, v102
    v_add_f32 v94, s39, v94
    v_add_f32 v102, s59, v102
    v_mul_f32 v94, 0x3a800000, v94
    v_mul_f32 v102, 0x3a800000, v102
    v_cvt_pk_bf16_f32 v95, v96, v94
    v_cvt_pk_bf16_f32 v103, v104, v102
    v_lshlrev_b32 v96, 16, v95
    v_lshlrev_b32 v104, 16, v103
    v_and_b32 v94, 0xffff0000, v95
    v_and_b32 v102, 0xffff0000, v103
    v_add_f32 v94, 0x3727c5ac, v94
    v_add_f32 v102, 0x3727c5ac, v102
    v_cvt_pk_bf16_f32 v94, v94, v94
    v_cvt_pk_bf16_f32 v102, v102, v102
    v_lshlrev_b32 v94, 16, v94
    v_lshlrev_b32 v102, 16, v102
    v_sqrt_f32 v94, v94
    v_sqrt_f32 v102, v102
    v_mov_b32 v97, v96
    v_mov_b32 v105, v104
    v_cvt_pk_bf16_f32 v94, v94, v94
    v_cvt_pk_bf16_f32 v102, v102, v102
    v_lshlrev_b32 v94, 16, v94
    v_lshlrev_b32 v102, 16, v102
    v_rcp_f32 v99, v94
    v_rcp_f32 v107, v102
    v_fma_f32 v95, -v94, v99, 1.0
    v_fma_f32 v103, -v102, v107, 1.0
    v_fma_f32 v99, v95, v99, v99
    v_fma_f32 v107, v103, v107, v107
    v_mov_b32 v98, v99
    v_mov_b32 v106, v107
    v_pk_add_f32 v[60:61], v[60:61], v[96:97]
    v_pk_add_f32 v[76:77], v[76:77], v[104:105]
    v_cvt_pk_bf16_f32 v94, v60, v61
    v_cvt_pk_bf16_f32 v102, v76, v77
    v_lshlrev_b32 v60, 16, v94
    v_lshlrev_b32 v76, 16, v102
    v_and_b32 v61, 0xffff0000, v94
    v_and_b32 v77, 0xffff0000, v102
    v_pk_mul_f32 v[60:61], v[60:61], v[98:99]
    v_pk_mul_f32 v[76:77], v[76:77], v[106:107]
    v_cvt_pk_bf16_f32 v108, v60, v61
    v_cvt_pk_bf16_f32 v120, v76, v77
    v_lshlrev_b32 v60, 16, v108
    v_lshlrev_b32 v76, 16, v120
    v_and_b32 v61, 0xffff0000, v108
    v_and_b32 v77, 0xffff0000, v120
    v_pk_mul_f32 v[92:93], v[60:61], v[44:45]
    v_pk_mul_f32 v[100:101], v[76:77], v[44:45]
    v_pk_add_f32 v[62:63], v[62:63], v[96:97]
    v_pk_add_f32 v[78:79], v[78:79], v[104:105]
    v_cvt_pk_bf16_f32 v94, v62, v63
    v_cvt_pk_bf16_f32 v102, v78, v79
    v_lshlrev_b32 v62, 16, v94
    v_lshlrev_b32 v78, 16, v102
    v_and_b32 v63, 0xffff0000, v94
    v_and_b32 v79, 0xffff0000, v102
    v_pk_mul_f32 v[62:63], v[62:63], v[98:99]
    v_pk_mul_f32 v[78:79], v[78:79], v[106:107]
    v_cvt_pk_bf16_f32 v109, v62, v63
    v_cvt_pk_bf16_f32 v121, v78, v79
    v_lshlrev_b32 v62, 16, v109
    v_lshlrev_b32 v78, 16, v121
    v_and_b32 v63, 0xffff0000, v109
    v_and_b32 v79, 0xffff0000, v121
    v_pk_fma_f32 v[92:93], v[62:63], v[46:47], v[92:93]
    v_pk_fma_f32 v[100:101], v[78:79], v[46:47], v[100:101]
    v_pk_add_f32 v[64:65], v[64:65], v[96:97]
    v_pk_add_f32 v[80:81], v[80:81], v[104:105]
    v_cvt_pk_bf16_f32 v94, v64, v65
    v_cvt_pk_bf16_f32 v102, v80, v81
    v_lshlrev_b32 v64, 16, v94
    v_lshlrev_b32 v80, 16, v102
    v_and_b32 v65, 0xffff0000, v94
    v_and_b32 v81, 0xffff0000, v102
    v_pk_mul_f32 v[64:65], v[64:65], v[98:99]
    v_pk_mul_f32 v[80:81], v[80:81], v[106:107]
    v_cvt_pk_bf16_f32 v110, v64, v65
    v_cvt_pk_bf16_f32 v122, v80, v81
    v_lshlrev_b32 v64, 16, v110
    v_lshlrev_b32 v80, 16, v122
    v_and_b32 v65, 0xffff0000, v110
    v_and_b32 v81, 0xffff0000, v122
    v_pk_fma_f32 v[92:93], v[64:65], v[48:49], v[92:93]
    v_pk_fma_f32 v[100:101], v[80:81], v[48:49], v[100:101]
    v_pk_add_f32 v[66:67], v[66:67], v[96:97]
    v_pk_add_f32 v[82:83], v[82:83], v[104:105]
    v_cvt_pk_bf16_f32 v94, v66, v67
    v_cvt_pk_bf16_f32 v102, v82, v83
    v_lshlrev_b32 v66, 16, v94
    v_lshlrev_b32 v82, 16, v102
    v_and_b32 v67, 0xffff0000, v94
    v_and_b32 v83, 0xffff0000, v102
    v_pk_mul_f32 v[66:67], v[66:67], v[98:99]
    v_pk_mul_f32 v[82:83], v[82:83], v[106:107]
    v_cvt_pk_bf16_f32 v111, v66, v67
    v_cvt_pk_bf16_f32 v123, v82, v83
    v_lshlrev_b32 v66, 16, v111
    v_lshlrev_b32 v82, 16, v123
    v_and_b32 v67, 0xffff0000, v111
    v_and_b32 v83, 0xffff0000, v123
    v_pk_fma_f32 v[92:93], v[66:67], v[50:51], v[92:93]
    v_pk_fma_f32 v[100:101], v[82:83], v[50:51], v[100:101]
    v_pk_add_f32 v[68:69], v[68:69], v[96:97]
    v_pk_add_f32 v[84:85], v[84:85], v[104:105]
    v_cvt_pk_bf16_f32 v94, v68, v69
    v_cvt_pk_bf16_f32 v102, v84, v85
    v_lshlrev_b32 v68, 16, v94
    v_lshlrev_b32 v84, 16, v102
    v_and_b32 v69, 0xffff0000, v94
    v_and_b32 v85, 0xffff0000, v102
    v_pk_mul_f32 v[68:69], v[68:69], v[98:99]
    v_pk_mul_f32 v[84:85], v[84:85], v[106:107]
    v_cvt_pk_bf16_f32 v112, v68, v69
    v_cvt_pk_bf16_f32 v124, v84, v85
    v_lshlrev_b32 v68, 16, v112
    v_lshlrev_b32 v84, 16, v124
    v_and_b32 v69, 0xffff0000, v112
    v_and_b32 v85, 0xffff0000, v124
    v_pk_fma_f32 v[92:93], v[68:69], v[52:53], v[92:93]
    v_pk_fma_f32 v[100:101], v[84:85], v[52:53], v[100:101]
    v_pk_add_f32 v[70:71], v[70:71], v[96:97]
    v_pk_add_f32 v[86:87], v[86:87], v[104:105]
    v_cvt_pk_bf16_f32 v94, v70, v71
    v_cvt_pk_bf16_f32 v102, v86, v87
    v_lshlrev_b32 v70, 16, v94
    v_lshlrev_b32 v86, 16, v102
    v_and_b32 v71, 0xffff0000, v94
    v_and_b32 v87, 0xffff0000, v102
    v_pk_mul_f32 v[70:71], v[70:71], v[98:99]
    v_pk_mul_f32 v[86:87], v[86:87], v[106:107]
    v_cvt_pk_bf16_f32 v113, v70, v71
    v_cvt_pk_bf16_f32 v125, v86, v87
    v_lshlrev_b32 v70, 16, v113
    v_lshlrev_b32 v86, 16, v125
    v_and_b32 v71, 0xffff0000, v113
    v_and_b32 v87, 0xffff0000, v125
    v_pk_fma_f32 v[92:93], v[70:71], v[54:55], v[92:93]
    v_pk_fma_f32 v[100:101], v[86:87], v[54:55], v[100:101]
    v_pk_add_f32 v[72:73], v[72:73], v[96:97]
    v_pk_add_f32 v[88:89], v[88:89], v[104:105]
    v_cvt_pk_bf16_f32 v94, v72, v73
    v_cvt_pk_bf16_f32 v102, v88, v89
    v_lshlrev_b32 v72, 16, v94
    v_lshlrev_b32 v88, 16, v102
    v_and_b32 v73, 0xffff0000, v94
    v_and_b32 v89, 0xffff0000, v102
    v_pk_mul_f32 v[72:73], v[72:73], v[98:99]
    v_pk_mul_f32 v[88:89], v[88:89], v[106:107]
    v_cvt_pk_bf16_f32 v114, v72, v73
    v_cvt_pk_bf16_f32 v126, v88, v89
    v_lshlrev_b32 v72, 16, v114
    v_lshlrev_b32 v88, 16, v126
    v_and_b32 v73, 0xffff0000, v114
    v_and_b32 v89, 0xffff0000, v126
    v_pk_fma_f32 v[92:93], v[72:73], v[56:57], v[92:93]
    v_pk_fma_f32 v[100:101], v[88:89], v[56:57], v[100:101]
    v_pk_add_f32 v[74:75], v[74:75], v[96:97]
    v_pk_add_f32 v[90:91], v[90:91], v[104:105]
    v_cvt_pk_bf16_f32 v94, v74, v75
    v_cvt_pk_bf16_f32 v102, v90, v91
    v_lshlrev_b32 v74, 16, v94
    v_lshlrev_b32 v90, 16, v102
    v_and_b32 v75, 0xffff0000, v94
    v_and_b32 v91, 0xffff0000, v102
    v_pk_mul_f32 v[74:75], v[74:75], v[98:99]
    v_pk_mul_f32 v[90:91], v[90:91], v[106:107]
    v_cvt_pk_bf16_f32 v115, v74, v75
    v_cvt_pk_bf16_f32 v127, v90, v91
    v_lshlrev_b32 v74, 16, v115
    v_lshlrev_b32 v90, 16, v127
    v_and_b32 v75, 0xffff0000, v115
    v_and_b32 v91, 0xffff0000, v127
    v_pk_fma_f32 v[92:93], v[74:75], v[58:59], v[92:93]
    v_pk_fma_f32 v[100:101], v[90:91], v[58:59], v[100:101]
    v_add_f32 v92, v92, v93
    v_add_f32 v100, v100, v101
    v_xor_b32 v98, 0x80000000, v96
    v_xor_b32 v106, 0x80000000, v104
    s_mul_i32 s36, s60, 2064
    s_mul_i32 s56, s28, 2064
    s_add_u32 s36, s36, 131072
    s_add_u32 s56, s56, 131072
    v_lshl_add_u32 v95, v1, 4, s36
    v_lshl_add_u32 v103, v1, 4, s56
    ds_write_b128 v95, v[108:111]
    ds_write_b128 v103, v[120:123]
    ds_write_b128 v95, v[112:115] offset:1024
    ds_write_b128 v103, v[124:127] offset:1024
    s_nop 0
    v_add_f32_dpp v92, v92, v92 quad_perm:[1,0,3,2] row_mask:0xf bank_mask:0xf
    v_add_f32_dpp v100, v100, v100 quad_perm:[1,0,3,2] row_mask:0xf bank_mask:0xf
    s_nop 0
    v_add_f32_dpp v92, v92, v92 quad_perm:[2,3,0,1] row_mask:0xf bank_mask:0xf
    v_add_f32_dpp v100, v100, v100 quad_perm:[2,3,0,1] row_mask:0xf bank_mask:0xf
    s_nop 0
    v_add_f32_dpp v92, v92, v92 row_half_mirror row_mask:0xf bank_mask:0xf
    v_add_f32_dpp v100, v100, v100 row_half_mirror row_mask:0xf bank_mask:0xf
    s_nop 0
    v_add_f32_dpp v92, v92, v92 row_mirror row_mask:0xf bank_mask:0xf
    v_add_f32_dpp v100, v100, v100 row_mirror row_mask:0xf bank_mask:0xf
    v_readlane_b32 s36, v92, 0
    v_readlane_b32 s56, v100, 0
    v_readlane_b32 s37, v92, 16
    v_readlane_b32 s57, v100, 16
    v_readlane_b32 s38, v92, 32
    v_readlane_b32 s58, v100, 32
    v_readlane_b32 s39, v92, 48
    v_readlane_b32 s59, v100, 48
    v_mov_b32 v93, s36
    v_mov_b32 v101, s56
    v_add_f32 v93, s37, v93
    v_add_f32 v101, s57, v101
    v_add_f32 v93, s38, v93
    v_add_f32 v101, s58, v101
    v_add_f32 v93, s39, v93
    v_add_f32 v101, s59, v101
    v_cvt_pk_bf16_f32 v93, v93, v93
    v_cvt_pk_bf16_f32 v101, v101, v101
    v_lshlrev_b32 v93, 16, v93
    v_lshlrev_b32 v101, 16, v101
    v_ashrrev_i32 v95, 31, v93
    v_ashrrev_i32 v103, 31, v101
    v_or_b32 v95, 0x80000000, v95
    v_or_b32 v103, 0x80000000, v103
    v_xor_b32 v95, v93, v95
    v_xor_b32 v103, v101, v103
    v_and_b32 v95, 0xffff0000, v95
    v_and_b32 v103, 0xffff0000, v103
    s_sub_u32 s36, 0xffff, s42
    s_sub_u32 s56, 0xffff, s43
    v_or_b32 v95, s36, v95
    v_or_b32 v103, s56, v103
    s_lshl_b32 s37, s60, 3
    s_lshl_b32 s57, s28, 3
    s_add_u32 s37, s37, 147712
    s_add_u32 s57, s57, 147712
    v_mov_b32 v94, s37
    v_mov_b32 v102, s57
    ds_write_b64 v94, v[98:99]
    ds_write_b64 v102, v[106:107]
    ds_write_b32 v94, v95 offset:64
    ds_write_b32 v102, v103 offset:64
    s_lshl_b32 s36, s2, 13
    s_lshl_b32 s37, s60, 11
    s_add_u32 s36, s36, s37
    v_lshl_add_u32 v16, v1, 7, s36
    s_cmp_lt_u32 s60, 2
    s_cselect_b64 s[38:39], s[48:49], s[50:51]
    s_lshr_b32 s36, s2, 3
    s_lshl_b32 s36, s36, 1
    s_and_b32 s37, s60, 1
    s_add_u32 s36, s36, s37
    s_lshl_b32 s36, s36, 16
    s_and_b32 s37, s29, 28
    s_lshl_b32 s37, s37, 8
    s_add_u32 s36, s36, s37
    s_sub_u32 s37, 256, s38
    s_and_b32 s37, s37, 0x300
    s_add_u32 s36, s36, s37
    v_lshrrev_b32 v18, 1, v1
    v_lshl_add_u32 v18, v18, 13, s36
    v_and_b32 v19, 1, v1
    v_lshl_add_u32 v18, v19, 7, v18
    s_mov_b64 exec, 0xffff
    global_load_dword v0, v16, s[46:47]
    global_load_dword v0, v18, s[38:39]
    s_mov_b64 exec, -1
    s_waitcnt lgkmcnt(0)
    s_cmp_eq_u32 s3, 0
    s_mov_b32 s3, 0
    s_cbranch_scc0 L_ln
L_pro_j:
    s_barrier
    ds_read_b128 v[20:23], v10 offset:0
    ds_read_b64_tr_b16 v[52:53], v12 offset:0
    ds_read_b64_tr_b16 v[54:55], v12 offset:1024
    ds_read_b64_tr_b16 v[56:57], v13 offset:0
    ds_read_b64_tr_b16 v[58:59], v13 offset:1024
    ds_read_b64_tr_b16 v[60:61], v14 offset:0
    ds_read_b64_tr_b16 v[62:63], v14 offset:1024
    ds_read_b64_tr_b16 v[64:65], v15 offset:0
    ds_read_b64_tr_b16 v[66:67], v15 offset:1024
    ds_read_b128 v[24:27], v10 offset:2048
    ds_read_b128 v[28:31], v10 offset:4096
    ds_read_b128 v[32:35], v10 offset:6144
    ds_read_b128 v[36:39], v10 offset:8192
    ds_read_b128 v[40:43], v10 offset:10240
    ds_read_b128 v[44:47], v10 offset:12288
    ds_read_b128 v[48:51], v10 offset:14336
    s_add_u32 s36, s2, s28
    s_cmp_eq_u32 s36, 0
    s_cbranch_scc1 L_recurrent_scan__compressed_kv_cla__moe_arch_mod__prompt_kernel_rare_3
L_recurrent_scan__compressed_kv_cla__moe_arch_mod__prompt_kernel_back_4:
    s_mov_b32 s35, 0
    s_cmp_eq_u32 s28, 0
    s_cselect_b32 s43, 9, 0
    s_cselect_b32 s44, 2, 1
    s_cmp_lt_u32 s28, 4
    s_cbranch_scc0 L_kv_vloop
    .p2align 6
L_kv_kloop:
    s_waitcnt lgkmcnt(0)
    v_mfma_f32_16x16x32_bf16 v[128:131], v[52:55], v[20:23], v[128:131]
    ds_read_b128 v[68:71], v11 offset:0
    v_mfma_f32_16x16x32_bf16 v[132:135], v[56:59], v[20:23], v[132:135]
    ds_read_b64_tr_b16 v[100:101], v12 offset:8192
    v_mfma_f32_16x16x32_bf16 v[136:139], v[60:63], v[20:23], v[136:139]
    ds_read_b64_tr_b16 v[102:103], v12 offset:9216
    v_mfma_f32_16x16x32_bf16 v[140:143], v[64:67], v[20:23], v[140:143]
    ds_read_b64_tr_b16 v[104:105], v13 offset:8192
    v_mfma_f32_16x16x32_bf16 v[144:147], v[52:55], v[24:27], v[144:147]
    ds_read_b64_tr_b16 v[106:107], v13 offset:9216
    v_mfma_f32_16x16x32_bf16 v[148:151], v[56:59], v[24:27], v[148:151]
    ds_read_b64_tr_b16 v[108:109], v14 offset:8192
    v_mfma_f32_16x16x32_bf16 v[152:155], v[60:63], v[24:27], v[152:155]
    ds_read_b64_tr_b16 v[110:111], v14 offset:9216
    v_mfma_f32_16x16x32_bf16 v[156:159], v[64:67], v[24:27], v[156:159]
    ds_read_b64_tr_b16 v[112:113], v15 offset:8192
    v_mfma_f32_16x16x32_bf16 v[160:163], v[52:55], v[28:31], v[160:163]
    ds_read_b64_tr_b16 v[114:115], v15 offset:9216
    v_mfma_f32_16x16x32_bf16 v[164:167], v[56:59], v[28:31], v[164:167]
    ds_read_b128 v[72:75], v11 offset:2048
    v_mfma_f32_16x16x32_bf16 v[168:171], v[60:63], v[28:31], v[168:171]
    ds_read_b128 v[76:79], v11 offset:4096
    v_mfma_f32_16x16x32_bf16 v[172:175], v[64:67], v[28:31], v[172:175]
    ds_read_b128 v[80:83], v11 offset:6144
    v_mfma_f32_16x16x32_bf16 v[176:179], v[52:55], v[32:35], v[176:179]
    ds_read_b128 v[84:87], v11 offset:8192
    v_mfma_f32_16x16x32_bf16 v[180:183], v[56:59], v[32:35], v[180:183]
    ds_read_b128 v[88:91], v11 offset:10240
    v_mfma_f32_16x16x32_bf16 v[184:187], v[60:63], v[32:35], v[184:187]
    ds_read_b128 v[92:95], v11 offset:12288
    v_mfma_f32_16x16x32_bf16 v[188:191], v[64:67], v[32:35], v[188:191]
    ds_read_b128 v[96:99], v11 offset:14336
    v_mfma_f32_16x16x32_bf16 v[192:195], v[52:55], v[36:39], v[192:195]
    v_mfma_f32_16x16x32_bf16 v[196:199], v[56:59], v[36:39], v[196:199]
    v_mfma_f32_16x16x32_bf16 v[200:203], v[60:63], v[36:39], v[200:203]
    v_mfma_f32_16x16x32_bf16 v[204:207], v[64:67], v[36:39], v[204:207]
    v_mfma_f32_16x16x32_bf16 v[208:211], v[52:55], v[40:43], v[208:211]
    v_mfma_f32_16x16x32_bf16 v[212:215], v[56:59], v[40:43], v[212:215]
    v_mfma_f32_16x16x32_bf16 v[216:219], v[60:63], v[40:43], v[216:219]
    v_mfma_f32_16x16x32_bf16 v[220:223], v[64:67], v[40:43], v[220:223]
    v_mfma_f32_16x16x32_bf16 v[224:227], v[52:55], v[44:47], v[224:227]
    v_mfma_f32_16x16x32_bf16 v[228:231], v[56:59], v[44:47], v[228:231]
    v_mfma_f32_16x16x32_bf16 v[232:235], v[60:63], v[44:47], v[232:235]
    v_mfma_f32_16x16x32_bf16 v[236:239], v[64:67], v[44:47], v[236:239]
    v_mfma_f32_16x16x32_bf16 v[240:243], v[52:55], v[48:51], v[240:243]
    v_mfma_f32_16x16x32_bf16 v[244:247], v[56:59], v[48:51], v[244:247]
    v_mfma_f32_16x16x32_bf16 v[248:251], v[60:63], v[48:51], v[248:251]
    v_mfma_f32_16x16x32_bf16 v[252:255], v[64:67], v[48:51], v[252:255]
    s_cmp_eq_u32 s35, 3
    s_cbranch_scc1 L_recurrent_scan__compressed_kv_cla__moe_arch_mod__prompt_kernel_rare_5
L_recurrent_scan__compressed_kv_cla__moe_arch_mod__prompt_kernel_back_6:
    s_cmp_lt_u32 s35, s44
    s_cbranch_scc1 L_recurrent_scan__compressed_kv_cla__moe_arch_mod__prompt_kernel_w0_7
    s_waitcnt vmcnt(1)
L_recurrent_scan__compressed_kv_cla__moe_arch_mod__prompt_kernel_w0b_8:
    s_waitcnt lgkmcnt(0)
    s_barrier
    v_mfma_f32_16x16x32_bf16 v[128:131], v[100:103], v[68:71], v[128:131]
    ds_read_b128 v[20:23], v10 offset:32768
    s_add_u32 m0, s33, 0
    v_mfma_f32_16x16x32_bf16 v[132:135], v[104:107], v[68:71], v[132:135]
    ds_read_b64_tr_b16 v[52:53], v12 offset:32768
    buffer_load_dwordx4 v2, s[4:7], s31 offen offset:0 lds
    v_mfma_f32_16x16x32_bf16 v[136:139], v[108:111], v[68:71], v[136:139]
    ds_read_b64_tr_b16 v[54:55], v12 offset:33792
    v_mfma_f32_16x16x32_bf16 v[140:143], v[112:115], v[68:71], v[140:143]
    ds_read_b64_tr_b16 v[56:57], v13 offset:32768
    v_mfma_f32_16x16x32_bf16 v[144:147], v[100:103], v[72:75], v[144:147]
    ds_read_b64_tr_b16 v[58:59], v13 offset:33792
    buffer_load_dwordx4 v3, s[4:7], s31 offen offset:1024 lds
    v_mfma_f32_16x16x32_bf16 v[148:151], v[104:107], v[72:75], v[148:151]
    ds_read_b64_tr_b16 v[60:61], v14 offset:32768
    v_mfma_f32_16x16x32_bf16 v[152:155], v[108:111], v[72:75], v[152:155]
    ds_read_b64_tr_b16 v[62:63], v14 offset:33792
    v_mfma_f32_16x16x32_bf16 v[156:159], v[112:115], v[72:75], v[156:159]
    ds_read_b64_tr_b16 v[64:65], v15 offset:32768
    buffer_load_dwordx4 v4, s[4:7], s31 offen offset:2048 lds
    v_mfma_f32_16x16x32_bf16 v[160:163], v[100:103], v[76:79], v[160:163]
    ds_read_b64_tr_b16 v[66:67], v15 offset:33792
    v_mfma_f32_16x16x32_bf16 v[164:167], v[104:107], v[76:79], v[164:167]
    ds_read_b128 v[24:27], v10 offset:34816
    v_mfma_f32_16x16x32_bf16 v[168:171], v[108:111], v[76:79], v[168:171]
    ds_read_b128 v[28:31], v10 offset:36864
    buffer_load_dwordx4 v5, s[4:7], s31 offen offset:3072 lds
    v_mfma_f32_16x16x32_bf16 v[172:175], v[112:115], v[76:79], v[172:175]
    ds_read_b128 v[32:35], v10 offset:38912
    v_mfma_f32_16x16x32_bf16 v[176:179], v[100:103], v[80:83], v[176:179]
    ds_read_b128 v[36:39], v10 offset:40960
    s_add_u32 m0, s34, 0
    v_mfma_f32_16x16x32_bf16 v[180:183], v[104:107], v[80:83], v[180:183]
    ds_read_b128 v[40:43], v10 offset:43008
    buffer_load_dwordx4 v6, s[8:11], s32 offen offset:0 nt lds
    v_mfma_f32_16x16x32_bf16 v[184:187], v[108:111], v[80:83], v[184:187]
    ds_read_b128 v[44:47], v10 offset:45056
    v_mfma_f32_16x16x32_bf16 v[188:191], v[112:115], v[80:83], v[188:191]
    ds_read_b128 v[48:51], v10 offset:47104
    v_mfma_f32_16x16x32_bf16 v[192:195], v[100:103], v[84:87], v[192:195]
    buffer_load_dwordx4 v7, s[8:11], s32 offen offset:1024 nt lds
    v_mfma_f32_16x16x32_bf16 v[196:199], v[104:107], v[84:87], v[196:199]
    v_mfma_f32_16x16x32_bf16 v[200:203], v[108:111], v[84:87], v[200:203]
    v_mfma_f32_16x16x32_bf16 v[204:207], v[112:115], v[84:87], v[204:207]
    buffer_load_dwordx4 v8, s[8:11], s32 offen offset:2048 nt lds
    v_mfma_f32_16x16x32_bf16 v[208:211], v[100:103], v[88:91], v[208:211]
    v_mfma_f32_16x16x32_bf16 v[212:215], v[104:107], v[88:91], v[212:215]
    v_mfma_f32_16x16x32_bf16 v[216:219], v[108:111], v[88:91], v[216:219]
    buffer_load_dwordx4 v9, s[8:11], s32 offen offset:3072 nt lds
    v_mfma_f32_16x16x32_bf16 v[220:223], v[112:115], v[88:91], v[220:223]
    v_mfma_f32_16x16x32_bf16 v[224:227], v[100:103], v[92:95], v[224:227]
    v_mfma_f32_16x16x32_bf16 v[228:231], v[104:107], v[92:95], v[228:231]
    v_mfma_f32_16x16x32_bf16 v[232:235], v[108:111], v[92:95], v[232:235]
    v_mfma_f32_16x16x32_bf16 v[236:239], v[112:115], v[92:95], v[236:239]
    v_mfma_f32_16x16x32_bf16 v[240:243], v[100:103], v[96:99], v[240:243]
    v_mfma_f32_16x16x32_bf16 v[244:247], v[104:107], v[96:99], v[244:247]
    v_mfma_f32_16x16x32_bf16 v[248:251], v[108:111], v[96:99], v[248:251]
    v_mfma_f32_16x16x32_bf16 v[252:255], v[112:115], v[96:99], v[252:255]
    s_bitcmp1_b32 6, s35
    s_cselect_b32 exec_lo, 255, 1
    s_mov_b32 exec_hi, 0
    global_load_dword v0, v17, s[96:97]
    s_mov_b64 exec, -1
    s_cselect_b32 s36, s45, 0
    v_add_u32 v17, s36, v17
    v_min_u32 v17, 8388480, v17
    s_nop 1
    s_add_u32 s31, s31, s40
    s_add_u32 s32, s32, s41
    s_waitcnt lgkmcnt(0)
    v_mfma_f32_16x16x32_bf16 v[128:131], v[52:55], v[20:23], v[128:131]
    ds_read_b128 v[68:71], v11 offset:32768
    v_mfma_f32_16x16x32_bf16 v[132:135], v[56:59], v[20:23], v[132:135]
    ds_read_b64_tr_b16 v[100:101], v12 offset:40960
    v_mfma_f32_16x16x32_bf16 v[136:139], v[60:63], v[20:23], v[136:139]
    ds_read_b64_tr_b16 v[102:103], v12 offset:41984
    v_mfma_f32_16x16x32_bf16 v[140:143], v[64:67], v[20:23], v[140:143]
    ds_read_b64_tr_b16 v[104:105], v13 offset:40960
    v_mfma_f32_16x16x32_bf16 v[144:147], v[52:55], v[24:27], v[144:147]
    ds_read_b64_tr_b16 v[106:107], v13 offset:41984
    v_mfma_f32_16x16x32_bf16 v[148:151], v[56:59], v[24:27], v[148:151]
    ds_read_b64_tr_b16 v[108:109], v14 offset:40960
    v_mfma_f32_16x16x32_bf16 v[152:155], v[60:63], v[24:27], v[152:155]
    ds_read_b64_tr_b16 v[110:111], v14 offset:41984
    v_mfma_f32_16x16x32_bf16 v[156:159], v[64:67], v[24:27], v[156:159]
    ds_read_b64_tr_b16 v[112:113], v15 offset:40960
    v_mfma_f32_16x16x32_bf16 v[160:163], v[52:55], v[28:31], v[160:163]
    ds_read_b64_tr_b16 v[114:115], v15 offset:41984
    v_mfma_f32_16x16x32_bf16 v[164:167], v[56:59], v[28:31], v[164:167]
    ds_read_b128 v[72:75], v11 offset:34816
    v_mfma_f32_16x16x32_bf16 v[168:171], v[60:63], v[28:31], v[168:171]
    ds_read_b128 v[76:79], v11 offset:36864
    v_mfma_f32_16x16x32_bf16 v[172:175], v[64:67], v[28:31], v[172:175]
    ds_read_b128 v[80:83], v11 offset:38912
    v_mfma_f32_16x16x32_bf16 v[176:179], v[52:55], v[32:35], v[176:179]
    ds_read_b128 v[84:87], v11 offset:40960
    v_mfma_f32_16x16x32_bf16 v[180:183], v[56:59], v[32:35], v[180:183]
    ds_read_b128 v[88:91], v11 offset:43008
    v_mfma_f32_16x16x32_bf16 v[184:187], v[60:63], v[32:35], v[184:187]
    ds_read_b128 v[92:95], v11 offset:45056
    v_mfma_f32_16x16x32_bf16 v[188:191], v[64:67], v[32:35], v[188:191]
    ds_read_b128 v[96:99], v11 offset:47104
    v_mfma_f32_16x16x32_bf16 v[192:195], v[52:55], v[36:39], v[192:195]
    v_mfma_f32_16x16x32_bf16 v[196:199], v[56:59], v[36:39], v[196:199]
    v_mfma_f32_16x16x32_bf16 v[200:203], v[60:63], v[36:39], v[200:203]
    v_mfma_f32_16x16x32_bf16 v[204:207], v[64:67], v[36:39], v[204:207]
    v_mfma_f32_16x16x32_bf16 v[208:211], v[52:55], v[40:43], v[208:211]
    s_bitcmp1_b32 s43, s35
    s_cbranch_scc1 L_recurrent_scan__compressed_kv_cla__moe_arch_mod__prompt_kernel_rare_13
L_recurrent_scan__compressed_kv_cla__moe_arch_mod__prompt_kernel_back_14:
    v_mfma_f32_16x16x32_bf16 v[212:215], v[56:59], v[40:43], v[212:215]
    v_mfma_f32_16x16x32_bf16 v[216:219], v[60:63], v[40:43], v[216:219]
    v_mfma_f32_16x16x32_bf16 v[220:223], v[64:67], v[40:43], v[220:223]
    v_mfma_f32_16x16x32_bf16 v[224:227], v[52:55], v[44:47], v[224:227]
    v_mfma_f32_16x16x32_bf16 v[228:231], v[56:59], v[44:47], v[228:231]
    v_mfma_f32_16x16x32_bf16 v[232:235], v[60:63], v[44:47], v[232:235]
    v_mfma_f32_16x16x32_bf16 v[236:239], v[64:67], v[44:47], v[236:239]
    v_mfma_f32_16x16x32_bf16 v[240:243], v[52:55], v[48:51], v[240:243]
    v_mfma_f32_16x16x32_bf16 v[244:247], v[56:59], v[48:51], v[244:247]
    v_mfma_f32_16x16x32_bf16 v[248:251], v[60:63], v[48:51], v[248:251]
    v_mfma_f32_16x16x32_bf16 v[252:255], v[64:67], v[48:51], v[252:255]
    s_bitcmp1_b32 s43, s35
    s_cbranch_scc1 L_recurrent_scan__compressed_kv_cla__moe_arch_mod__prompt_kernel_w0_15
    s_waitcnt vmcnt(1)
L_recurrent_scan__compressed_kv_cla__moe_arch_mod__prompt_kernel_w0b_16:
    s_waitcnt lgkmcnt(0)
    s_cmp_eq_u32 s35, 3
    s_barrier
    s_cbranch_scc1 L_p1_fin0
    v_mfma_f32_16x16x32_bf16 v[128:131], v[100:103], v[68:71], v[128:131]
    ds_read_b128 v[20:23], v10 offset:0
    s_add_u32 m0, s33, 32768
    v_mfma_f32_16x16x32_bf16 v[132:135], v[104:107], v[68:71], v[132:135]
    ds_read_b64_tr_b16 v[52:53], v12 offset:0
    buffer_load_dwordx4 v2, s[4:7], s31 offen offset:0 lds
    v_mfma_f32_16x16x32_bf16 v[136:139], v[108:111], v[68:71], v[136:139]
    ds_read_b64_tr_b16 v[54:55], v12 offset:1024
    v_mfma_f32_16x16x32_bf16 v[140:143], v[112:115], v[68:71], v[140:143]
    ds_read_b64_tr_b16 v[56:57], v13 offset:0
    v_mfma_f32_16x16x32_bf16 v[144:147], v[100:103], v[72:75], v[144:147]
    ds_read_b64_tr_b16 v[58:59], v13 offset:1024
    buffer_load_dwordx4 v3, s[4:7], s31 offen offset:1024 lds
    v_mfma_f32_16x16x32_bf16 v[148:151], v[104:107], v[72:75], v[148:151]
    ds_read_b64_tr_b16 v[60:61], v14 offset:0
    v_mfma_f32_16x16x32_bf16 v[152:155], v[108:111], v[72:75], v[152:155]
    ds_read_b64_tr_b16 v[62:63], v14 offset:1024
    v_mfma_f32_16x16x32_bf16 v[156:159], v[112:115], v[72:75], v[156:159]
    ds_read_b64_tr_b16 v[64:65], v15 offset:0
    buffer_load_dwordx4 v4, s[4:7], s31 offen offset:2048 lds
    v_mfma_f32_16x16x32_bf16 v[160:163], v[100:103], v[76:79], v[160:163]
    ds_read_b64_tr_b16 v[66:67], v15 offset:1024
    v_mfma_f32_16x16x32_bf16 v[164:167], v[104:107], v[76:79], v[164:167]
    ds_read_b128 v[24:27], v10 offset:2048
    v_mfma_f32_16x16x32_bf16 v[168:171], v[108:111], v[76:79], v[168:171]
    ds_read_b128 v[28:31], v10 offset:4096
    buffer_load_dwordx4 v5, s[4:7], s31 offen offset:3072 lds
    v_mfma_f32_16x16x32_bf16 v[172:175], v[112:115], v[76:79], v[172:175]
    ds_read_b128 v[32:35], v10 offset:6144
    v_mfma_f32_16x16x32_bf16 v[176:179], v[100:103], v[80:83], v[176:179]
    ds_read_b128 v[36:39], v10 offset:8192
    s_add_u32 m0, s34, 32768
    v_mfma_f32_16x16x32_bf16 v[180:183], v[104:107], v[80:83], v[180:183]
    ds_read_b128 v[40:43], v10 offset:10240
    buffer_load_dwordx4 v6, s[8:11], s32 offen offset:0 nt lds
    v_mfma_f32_16x16x32_bf16 v[184:187], v[108:111], v[80:83], v[184:187]
    ds_read_b128 v[44:47], v10 offset:12288
    v_mfma_f32_16x16x32_bf16 v[188:191], v[112:115], v[80:83], v[188:191]
    ds_read_b128 v[48:51], v10 offset:14336
    v_mfma_f32_16x16x32_bf16 v[192:195], v[100:103], v[84:87], v[192:195]
    buffer_load_dwordx4 v7, s[8:11], s32 offen offset:1024 nt lds
    v_mfma_f32_16x16x32_bf16 v[196:199], v[104:107], v[84:87], v[196:199]
    v_mfma_f32_16x16x32_bf16 v[200:203], v[108:111], v[84:87], v[200:203]
    v_mfma_f32_16x16x32_bf16 v[204:207], v[112:115], v[84:87], v[204:207]
    buffer_load_dwordx4 v8, s[8:11], s32 offen offset:2048 nt lds
    v_mfma_f32_16x16x32_bf16 v[208:211], v[100:103], v[88:91], v[208:211]
    v_mfma_f32_16x16x32_bf16 v[212:215], v[104:107], v[88:91], v[212:215]
    v_mfma_f32_16x16x32_bf16 v[216:219], v[108:111], v[88:91], v[216:219]
    buffer_load_dwordx4 v9, s[8:11], s32 offen offset:3072 nt lds
    v_mfma_f32_16x16x32_bf16 v[220:223], v[112:115], v[88:91], v[220:223]
    v_mfma_f32_16x16x32_bf16 v[224:227], v[100:103], v[92:95], v[224:227]
    v_mfma_f32_16x16x32_bf16 v[228:231], v[104:107], v[92:95], v[228:231]
    v_mfma_f32_16x16x32_bf16 v[232:235], v[108:111], v[92:95], v[232:235]
    v_mfma_f32_16x16x32_bf16 v[236:239], v[112:115], v[92:95], v[236:239]
    v_mfma_f32_16x16x32_bf16 v[240:243], v[100:103], v[96:99], v[240:243]
    v_mfma_f32_16x16x32_bf16 v[244:247], v[104:107], v[96:99], v[244:247]
    v_mfma_f32_16x16x32_bf16 v[248:251], v[108:111], v[96:99], v[248:251]
    s_add_u32 s36, s35, s28
    s_cmp_eq_u32 s36, 0
    s_cbranch_scc1 L_recurrent_scan__compressed_kv_cla__moe_arch_mod__prompt_kernel_rare_25
L_recurrent_scan__compressed_kv_cla__moe_arch_mod__prompt_kernel_back_26:
    v_mfma_f32_16x16x32_bf16 v[252:255], v[112:115], v[96:99], v[252:255]
    s_bitcmp1_b32 3, s35
    s_cselect_b32 exec_lo, 255, 1
    s_mov_b32 exec_hi, 0
    global_load_dword v0, v17, s[96:97]
    s_mov_b64 exec, -1
    s_cselect_b32 s36, s45, 0
    v_add_u32 v17, s36, v17
    v_min_u32 v17, 8388480, v17
    s_nop 1
    s_add_u32 s31, s31, s40
    s_add_u32 s32, s32, s41
    s_add_u32 s35, s35, 1
    s_branch L_kv_kloop
L_p1_fin0:
    v_mfma_f32_16x16x32_bf16 v[128:131], v[100:103], v[68:71], v[128:131]
    s_and_b32 s36, s28, 3
    s_sub_u32 s37, 15, s30
    s_cmp_lt_u32 s28, 4
    s_cselect_b32 s37, s37, s30
    s_lshl_b32 s37, s37, 2
    s_add_u32 s37, s37, s36
    s_lshl_b32 s37, s37, 16
    v_lshl_add_u32 v6, v1, 4, s37
    v_add_u32 v7, 32768, v6
    s_mov_b32 s32, 0
    s_mov_b32 s8, s54
    s_and_b32 s9, s55, 0xffff
    s_mov_b32 s10, 104857728
    s_mov_b32 s11, 0x20000
    v_mfma_f32_16x16x32_bf16 v[132:135], v[104:107], v[68:71], v[132:135]
    buffer_load_dwordx4 v[24:27], v6, s[8:11], s32 offen offset:0 sc1
    v_mfma_f32_16x16x32_bf16 v[136:139], v[108:111], v[68:71], v[136:139]
    v_lshrrev_b32 v18, 4, v1
    v_mfma_f32_16x16x32_bf16 v[140:143], v[112:115], v[68:71], v[140:143]
    v_bfe_u32 v20, v1, 2, 2
    v_mfma_f32_16x16x32_bf16 v[144:147], v[100:103], v[72:75], v[144:147]
    v_lshl_add_u32 v19, v18, 3, v20
    v_mfma_f32_16x16x32_bf16 v[148:151], v[104:107], v[72:75], v[148:151]
    buffer_load_dwordx4 v[28:31], v7, s[8:11], s32 offen offset:0 sc1
    v_lshlrev_b32 v19, 8, v19
    v_mfma_f32_16x16x32_bf16 v[152:155], v[108:111], v[72:75], v[152:155]
    v_and_b32 v21, 3, v1
    v_mfma_f32_16x16x32_bf16 v[156:159], v[112:115], v[72:75], v[156:159]
    v_lshl_add_u32 v19, v21, 3, v19
    v_mfma_f32_16x16x32_bf16 v[160:163], v[100:103], v[76:79], v[160:163]
    v_and_b32 v21, 1, v18
    v_mfma_f32_16x16x32_bf16 v[164:167], v[104:107], v[76:79], v[164:167]
    buffer_load_dwordx4 v[32:35], v6, s[8:11], s32 offen offset:1024 sc1
    v_lshl_add_u32 v20, v21, 2, v20
    v_mfma_f32_16x16x32_bf16 v[168:171], v[108:111], v[76:79], v[168:171]
    v_xor_b32 v21, 0, v20
    v_mfma_f32_16x16x32_bf16 v[172:175], v[112:115], v[76:79], v[172:175]
    v_lshl_add_u32 v10, v21, 5, v19
    v_mfma_f32_16x16x32_bf16 v[176:179], v[100:103], v[80:83], v[176:179]
    v_xor_b32 v21, 1, v20
    v_mfma_f32_16x16x32_bf16 v[180:183], v[104:107], v[80:83], v[180:183]
    buffer_load_dwordx4 v[36:39], v7, s[8:11], s32 offen offset:1024 sc1
    v_lshl_add_u32 v11, v21, 5, v19
    v_mfma_f32_16x16x32_bf16 v[184:187], v[108:111], v[80:83], v[184:187]
    v_xor_b32 v21, 2, v20
    v_mfma_f32_16x16x32_bf16 v[188:191], v[112:115], v[80:83], v[188:191]
    v_lshl_add_u32 v12, v21, 5, v19
    v_mfma_f32_16x16x32_bf16 v[192:195], v[100:103], v[84:87], v[192:195]
    v_xor_b32 v21, 3, v20
    v_mfma_f32_16x16x32_bf16 v[196:199], v[104:107], v[84:87], v[196:199]
    buffer_load_dwordx4 v[40:43], v6, s[8:11], s32 offen offset:2048 sc1
    v_lshl_add_u32 v13, v21, 5, v19
    v_mfma_f32_16x16x32_bf16 v[200:203], v[108:111], v[84:87], v[200:203]
    v_xor_b32 v21, 4, v20
    v_mfma_f32_16x16x32_bf16 v[204:207], v[112:115], v[84:87], v[204:207]
    v_lshl_add_u32 v14, v21, 5, v19
    v_mfma_f32_16x16x32_bf16 v[208:211], v[100:103], v[88:91], v[208:211]
    v_xor_b32 v21, 5, v20
    v_mfma_f32_16x16x32_bf16 v[212:215], v[104:107], v[88:91], v[212:215]
    buffer_load_dwordx4 v[44:47], v7, s[8:11], s32 offen offset:2048 sc1
    v_lshl_add_u32 v15, v21, 5, v19
    v_mfma_f32_16x16x32_bf16 v[216:219], v[108:111], v[88:91], v[216:219]
    v_xor_b32 v21, 6, v20
    v_mfma_f32_16x16x32_bf16 v[220:223], v[112:115], v[88:91], v[220:223]
    v_lshl_add_u32 v16, v21, 5, v19
    v_mfma_f32_16x16x32_bf16 v[224:227], v[100:103], v[92:95], v[224:227]
    v_xor_b32 v21, 7, v20
    v_mfma_f32_16x16x32_bf16 v[228:231], v[104:107], v[92:95], v[228:231]
    buffer_load_dwordx4 v[48:51], v6, s[8:11], s32 offen offset:3072 sc1
    v_lshl_add_u32 v17, v21, 5, v19
    v_mfma_f32_16x16x32_bf16 v[232:235], v[108:111], v[92:95], v[232:235]
    s_lshl_b32 s45, s29, 20
    v_mfma_f32_16x16x32_bf16 v[236:239], v[112:115], v[92:95], v[236:239]
    v_mfma_f32_16x16x32_bf16 v[240:243], v[100:103], v[96:99], v[240:243]
    v_mfma_f32_16x16x32_bf16 v[244:247], v[104:107], v[96:99], v[244:247]
    buffer_load_dwordx4 v[52:55], v7, s[8:11], s32 offen offset:3072 sc1
    v_mfma_f32_16x16x32_bf16 v[248:251], v[108:111], v[96:99], v[248:251]
    v_mfma_f32_16x16x32_bf16 v[252:255], v[112:115], v[96:99], v[252:255]
    s_branch L_p1_done
    .p2align 6
L_kv_vloop:
    s_waitcnt lgkmcnt(0)
    v_mfma_f32_16x16x32_bf16 v[128:131], v[20:23], v[52:55], v[128:131]
    ds_read_b128 v[68:71], v11 offset:0
    v_mfma_f32_16x16x32_bf16 v[160:163], v[20:23], v[56:59], v[160:163]
    ds_read_b64_tr_b16 v[100:101], v12 offset:8192
    v_mfma_f32_16x16x32_bf16 v[192:195], v[20:23], v[60:63], v[192:195]
    ds_read_b64_tr_b16 v[102:103], v12 offset:9216
    v_mfma_f32_16x16x32_bf16 v[224:227], v[20:23], v[64:67], v[224:227]
    ds_read_b64_tr_b16 v[104:105], v13 offset:8192
    v_mfma_f32_16x16x32_bf16 v[132:135], v[24:27], v[52:55], v[132:135]
    ds_read_b64_tr_b16 v[106:107], v13 offset:9216
    v_mfma_f32_16x16x32_bf16 v[164:167], v[24:27], v[56:59], v[164:167]
    ds_read_b64_tr_b16 v[108:109], v14 offset:8192
    v_mfma_f32_16x16x32_bf16 v[196:199], v[24:27], v[60:63], v[196:199]
    ds_read_b64_tr_b16 v[110:111], v14 offset:9216
    v_mfma_f32_16x16x32_bf16 v[228:231], v[24:27], v[64:67], v[228:231]
    ds_read_b64_tr_b16 v[112:113], v15 offset:8192
    v_mfma_f32_16x16x32_bf16 v[136:139], v[28:31], v[52:55], v[136:139]
    ds_read_b64_tr_b16 v[114:115], v15 offset:9216
    v_mfma_f32_16x16x32_bf16 v[168:171], v[28:31], v[56:59], v[168:171]
    ds_read_b128 v[72:75], v11 offset:2048
    v_mfma_f32_16x16x32_bf16 v[200:203], v[28:31], v[60:63], v[200:203]
    ds_read_b128 v[76:79], v11 offset:4096
    v_mfma_f32_16x16x32_bf16 v[232:235], v[28:31], v[64:67], v[232:235]
    ds_read_b128 v[80:83], v11 offset:6144
    v_mfma_f32_16x16x32_bf16 v[140:143], v[32:35], v[52:55], v[140:143]
    ds_read_b128 v[84:87], v11 offset:8192
    v_mfma_f32_16x16x32_bf16 v[172:175], v[32:35], v[56:59], v[172:175]
    ds_read_b128 v[88:91], v11 offset:10240
    v_mfma_f32_16x16x32_bf16 v[204:207], v[32:35], v[60:63], v[204:207]
    ds_read_b128 v[92:95], v11 offset:12288
    v_mfma_f32_16x16x32_bf16 v[236:239], v[32:35], v[64:67], v[236:239]
    ds_read_b128 v[96:99], v11 offset:14336
    v_mfma_f32_16x16x32_bf16 v[144:147], v[36:39], v[52:55], v[144:147]
    v_mfma_f32_16x16x32_bf16 v[176:179], v[36:39], v[56:59], v[176:179]
    v_mfma_f32_16x16x32_bf16 v[208:211], v[36:39], v[60:63], v[208:211]
    v_mfma_f32_16x16x32_bf16 v[240:243], v[36:39], v[64:67], v[240:243]
    v_mfma_f32_16x16x32_bf16 v[148:151], v[40:43], v[52:55], v[148:151]
    v_mfma_f32_16x16x32_bf16 v[180:183], v[40:43], v[56:59], v[180:183]
    v_mfma_f32_16x16x32_bf16 v[212:215], v[40:43], v[60:63], v[212:215]
    v_mfma_f32_16x16x32_bf16 v[244:247], v[40:43], v[64:67], v[244:247]
    v_mfma_f32_16x16x32_bf16 v[152:155], v[44:47], v[52:55], v[152:155]
    v_mfma_f32_16x16x32_bf16 v[184:187], v[44:47], v[56:59], v[184:187]
    v_mfma_f32_16x16x32_bf16 v[216:219], v[44:47], v[60:63], v[216:219]
    v_mfma_f32_16x16x32_bf16 v[248:251], v[44:47], v[64:67], v[248:251]
    v_mfma_f32_16x16x32_bf16 v[156:159], v[48:51], v[52:55], v[156:159]
    v_mfma_f32_16x16x32_bf16 v[188:191], v[48:51], v[56:59], v[188:191]
    v_mfma_f32_16x16x32_bf16 v[220:223], v[48:51], v[60:63], v[220:223]
    v_mfma_f32_16x16x32_bf16 v[252:255], v[48:51], v[64:67], v[252:255]
    s_cmp_lt_u32 s35, s44
    s_cbranch_scc1 L_recurrent_scan__compressed_kv_cla__moe_arch_mod__prompt_kernel_w0_27
    s_waitcnt vmcnt(1)
L_recurrent_scan__compressed_kv_cla__moe_arch_mod__prompt_kernel_w0b_28:
    s_waitcnt lgkmcnt(0)
    s_barrier
    s_add_u32 m0, s33, 0
    s_nop 0
    buffer_load_dwordx4 v2, s[4:7], s31 offen offset:0 lds
    buffer_load_dwordx4 v3, s[4:7], s31 offen offset:1024 lds
    buffer_load_dwordx4 v4, s[4:7], s31 offen offset:2048 lds
    buffer_load_dwordx4 v5, s[4:7], s31 offen offset:3072 lds
    s_add_u32 m0, s34, 0
    s_nop 0
    buffer_load_dwordx4 v6, s[8:11], s32 offen offset:0 nt lds
    buffer_load_dwordx4 v7, s[8:11], s32 offen offset:1024 nt lds
    buffer_load_dwordx4 v8, s[8:11], s32 offen offset:2048 nt lds
    buffer_load_dwordx4 v9, s[8:11], s32 offen offset:3072 nt lds
    s_add_u32 s31, s31, s40
    s_add_u32 s32, s32, s41
    s_cmp_eq_u32 s35, 0
    s_cbranch_scc1 L_recurrent_scan__compressed_kv_cla__moe_arch_mod__prompt_kernel_rare_32
L_recurrent_scan__compressed_kv_cla__moe_arch_mod__prompt_kernel_back_33:
    v_mfma_f32_16x16x32_bf16 v[128:131], v[68:71], v[100:103], v[128:131]
    ds_read_b128 v[20:23], v10 offset:32768
    v_mfma_f32_16x16x32_bf16 v[160:163], v[68:71], v[104:107], v[160:163]
    ds_read_b64_tr_b16 v[52:53], v12 offset:32768
    v_mfma_f32_16x16x32_bf16 v[192:195], v[68:71], v[108:111], v[192:195]
    ds_read_b64_tr_b16 v[54:55], v12 offset:33792
    v_mfma_f32_16x16x32_bf16 v[224:227], v[68:71], v[112:115], v[224:227]
    ds_read_b64_tr_b16 v[56:57], v13 offset:32768
    v_mfma_f32_16x16x32_bf16 v[132:135], v[72:75], v[100:103], v[132:135]
    ds_read_b64_tr_b16 v[58:59], v13 offset:33792
    v_mfma_f32_16x16x32_bf16 v[164:167], v[72:75], v[104:107], v[164:167]
    ds_read_b64_tr_b16 v[60:61], v14 offset:32768
    v_mfma_f32_16x16x32_bf16 v[196:199], v[72:75], v[108:111], v[196:199]
    ds_read_b64_tr_b16 v[62:63], v14 offset:33792
    v_mfma_f32_16x16x32_bf16 v[228:231], v[72:75], v[112:115], v[228:231]
    ds_read_b64_tr_b16 v[64:65], v15 offset:32768
    v_mfma_f32_16x16x32_bf16 v[136:139], v[76:79], v[100:103], v[136:139]
    ds_read_b64_tr_b16 v[66:67], v15 offset:33792
    v_mfma_f32_16x16x32_bf16 v[168:171], v[76:79], v[104:107], v[168:171]
    ds_read_b128 v[24:27], v10 offset:34816
    v_mfma_f32_16x16x32_bf16 v[200:203], v[76:79], v[108:111], v[200:203]
    ds_read_b128 v[28:31], v10 offset:36864
    v_mfma_f32_16x16x32_bf16 v[232:235], v[76:79], v[112:115], v[232:235]
    ds_read_b128 v[32:35], v10 offset:38912
    v_mfma_f32_16x16x32_bf16 v[140:143], v[80:83], v[100:103], v[140:143]
    ds_read_b128 v[36:39], v10 offset:40960
    v_mfma_f32_16x16x32_bf16 v[172:175], v[80:83], v[104:107], v[172:175]
    ds_read_b128 v[40:43], v10 offset:43008
    v_mfma_f32_16x16x32_bf16 v[204:207], v[80:83], v[108:111], v[204:207]
    ds_read_b128 v[44:47], v10 offset:45056
    v_mfma_f32_16x16x32_bf16 v[236:239], v[80:83], v[112:115], v[236:239]
    ds_read_b128 v[48:51], v10 offset:47104
    v_mfma_f32_16x16x32_bf16 v[144:147], v[84:87], v[100:103], v[144:147]
    v_mfma_f32_16x16x32_bf16 v[176:179], v[84:87], v[104:107], v[176:179]
    v_mfma_f32_16x16x32_bf16 v[208:211], v[84:87], v[108:111], v[208:211]
    v_mfma_f32_16x16x32_bf16 v[240:243], v[84:87], v[112:115], v[240:243]
    v_mfma_f32_16x16x32_bf16 v[148:151], v[88:91], v[100:103], v[148:151]
    v_mfma_f32_16x16x32_bf16 v[180:183], v[88:91], v[104:107], v[180:183]
    v_mfma_f32_16x16x32_bf16 v[212:215], v[88:91], v[108:111], v[212:215]
    v_mfma_f32_16x16x32_bf16 v[244:247], v[88:91], v[112:115], v[244:247]
    v_mfma_f32_16x16x32_bf16 v[152:155], v[92:95], v[100:103], v[152:155]
    v_mfma_f32_16x16x32_bf16 v[184:187], v[92:95], v[104:107], v[184:187]
    v_mfma_f32_16x16x32_bf16 v[216:219], v[92:95], v[108:111], v[216:219]
    v_mfma_f32_16x16x32_bf16 v[248:251], v[92:95], v[112:115], v[248:251]
    v_mfma_f32_16x16x32_bf16 v[156:159], v[96:99], v[100:103], v[156:159]
    v_mfma_f32_16x16x32_bf16 v[188:191], v[96:99], v[104:107], v[188:191]
    v_mfma_f32_16x16x32_bf16 v[220:223], v[96:99], v[108:111], v[220:223]
    v_mfma_f32_16x16x32_bf16 v[252:255], v[96:99], v[112:115], v[252:255]
    s_bitcmp1_b32 6, s35
    s_cselect_b32 exec_lo, 255, 1
    s_mov_b32 exec_hi, 0
    global_load_dword v0, v17, s[96:97]
    s_mov_b64 exec, -1
    s_cselect_b32 s36, s45, 0
    v_add_u32 v17, s36, v17
    v_min_u32 v17, 8388480, v17
    s_nop 1
    s_waitcnt lgkmcnt(0)
    v_mfma_f32_16x16x32_bf16 v[128:131], v[20:23], v[52:55], v[128:131]
    ds_read_b128 v[68:71], v11 offset:32768
    v_mfma_f32_16x16x32_bf16 v[160:163], v[20:23], v[56:59], v[160:163]
    ds_read_b64_tr_b16 v[100:101], v12 offset:40960
    v_mfma_f32_16x16x32_bf16 v[192:195], v[20:23], v[60:63], v[192:195]
    ds_read_b64_tr_b16 v[102:103], v12 offset:41984
    v_mfma_f32_16x16x32_bf16 v[224:227], v[20:23], v[64:67], v[224:227]
    ds_read_b64_tr_b16 v[104:105], v13 offset:40960
    v_mfma_f32_16x16x32_bf16 v[132:135], v[24:27], v[52:55], v[132:135]
    ds_read_b64_tr_b16 v[106:107], v13 offset:41984
    v_mfma_f32_16x16x32_bf16 v[164:167], v[24:27], v[56:59], v[164:167]
    ds_read_b64_tr_b16 v[108:109], v14 offset:40960
    v_mfma_f32_16x16x32_bf16 v[196:199], v[24:27], v[60:63], v[196:199]
    ds_read_b64_tr_b16 v[110:111], v14 offset:41984
    v_mfma_f32_16x16x32_bf16 v[228:231], v[24:27], v[64:67], v[228:231]
    ds_read_b64_tr_b16 v[112:113], v15 offset:40960
    v_mfma_f32_16x16x32_bf16 v[136:139], v[28:31], v[52:55], v[136:139]
    ds_read_b64_tr_b16 v[114:115], v15 offset:41984
    v_mfma_f32_16x16x32_bf16 v[168:171], v[28:31], v[56:59], v[168:171]
    ds_read_b128 v[72:75], v11 offset:34816
    v_mfma_f32_16x16x32_bf16 v[200:203], v[28:31], v[60:63], v[200:203]
    ds_read_b128 v[76:79], v11 offset:36864
    v_mfma_f32_16x16x32_bf16 v[232:235], v[28:31], v[64:67], v[232:235]
    ds_read_b128 v[80:83], v11 offset:38912
    v_mfma_f32_16x16x32_bf16 v[140:143], v[32:35], v[52:55], v[140:143]
    ds_read_b128 v[84:87], v11 offset:40960
    v_mfma_f32_16x16x32_bf16 v[172:175], v[32:35], v[56:59], v[172:175]
    ds_read_b128 v[88:91], v11 offset:43008
    v_mfma_f32_16x16x32_bf16 v[204:207], v[32:35], v[60:63], v[204:207]
    ds_read_b128 v[92:95], v11 offset:45056
    v_mfma_f32_16x16x32_bf16 v[236:239], v[32:35], v[64:67], v[236:239]
    ds_read_b128 v[96:99], v11 offset:47104
    v_mfma_f32_16x16x32_bf16 v[144:147], v[36:39], v[52:55], v[144:147]
    v_mfma_f32_16x16x32_bf16 v[176:179], v[36:39], v[56:59], v[176:179]
    v_mfma_f32_16x16x32_bf16 v[208:211], v[36:39], v[60:63], v[208:211]
    v_mfma_f32_16x16x32_bf16 v[240:243], v[36:39], v[64:67], v[240:243]
    v_mfma_f32_16x16x32_bf16 v[148:151], v[40:43], v[52:55], v[148:151]
    v_mfma_f32_16x16x32_bf16 v[180:183], v[40:43], v[56:59], v[180:183]
    v_mfma_f32_16x16x32_bf16 v[212:215], v[40:43], v[60:63], v[212:215]
    v_mfma_f32_16x16x32_bf16 v[244:247], v[40:43], v[64:67], v[244:247]
    v_mfma_f32_16x16x32_bf16 v[152:155], v[44:47], v[52:55], v[152:155]
    v_mfma_f32_16x16x32_bf16 v[184:187], v[44:47], v[56:59], v[184:187]
    v_mfma_f32_16x16x32_bf16 v[216:219], v[44:47], v[60:63], v[216:219]
    v_mfma_f32_16x16x32_bf16 v[248:251], v[44:47], v[64:67], v[248:251]
    v_mfma_f32_16x16x32_bf16 v[156:159], v[48:51], v[52:55], v[156:159]
    v_mfma_f32_16x16x32_bf16 v[188:191], v[48:51], v[56:59], v[188:191]
    v_mfma_f32_16x16x32_bf16 v[220:223], v[48:51], v[60:63], v[220:223]
    v_mfma_f32_16x16x32_bf16 v[252:255], v[48:51], v[64:67], v[252:255]
    s_waitcnt vmcnt(1) lgkmcnt(0)
    s_cmp_eq_u32 s35, 3
    s_barrier
    s_cbranch_scc1 L_p1_fin1
    s_add_u32 m0, s33, 32768
    s_nop 0
    buffer_load_dwordx4 v2, s[4:7], s31 offen offset:0 lds
    buffer_load_dwordx4 v3, s[4:7], s31 offen offset:1024 lds
    buffer_load_dwordx4 v4, s[4:7], s31 offen offset:2048 lds
    buffer_load_dwordx4 v5, s[4:7], s31 offen offset:3072 lds
    s_add_u32 m0, s34, 32768
    s_nop 0
    buffer_load_dwordx4 v6, s[8:11], s32 offen offset:0 nt lds
    buffer_load_dwordx4 v7, s[8:11], s32 offen offset:1024 nt lds
    buffer_load_dwordx4 v8, s[8:11], s32 offen offset:2048 nt lds
    buffer_load_dwordx4 v9, s[8:11], s32 offen offset:3072 nt lds
    s_add_u32 s31, s31, s40
    s_add_u32 s32, s32, s41
    s_cmp_eq_u32 s35, 2
    s_cbranch_scc1 L_recurrent_scan__compressed_kv_cla__moe_arch_mod__prompt_kernel_rare_36
L_recurrent_scan__compressed_kv_cla__moe_arch_mod__prompt_kernel_back_37:
    v_mfma_f32_16x16x32_bf16 v[128:131], v[68:71], v[100:103], v[128:131]
    ds_read_b128 v[20:23], v10 offset:0
    v_mfma_f32_16x16x32_bf16 v[160:163], v[68:71], v[104:107], v[160:163]
    ds_read_b64_tr_b16 v[52:53], v12 offset:0
    v_mfma_f32_16x16x32_bf16 v[192:195], v[68:71], v[108:111], v[192:195]
    ds_read_b64_tr_b16 v[54:55], v12 offset:1024
    v_mfma_f32_16x16x32_bf16 v[224:227], v[68:71], v[112:115], v[224:227]
    ds_read_b64_tr_b16 v[56:57], v13 offset:0
    v_mfma_f32_16x16x32_bf16 v[132:135], v[72:75], v[100:103], v[132:135]
    ds_read_b64_tr_b16 v[58:59], v13 offset:1024
    v_mfma_f32_16x16x32_bf16 v[164:167], v[72:75], v[104:107], v[164:167]
    ds_read_b64_tr_b16 v[60:61], v14 offset:0
    v_mfma_f32_16x16x32_bf16 v[196:199], v[72:75], v[108:111], v[196:199]
    ds_read_b64_tr_b16 v[62:63], v14 offset:1024
    v_mfma_f32_16x16x32_bf16 v[228:231], v[72:75], v[112:115], v[228:231]
    ds_read_b64_tr_b16 v[64:65], v15 offset:0
    v_mfma_f32_16x16x32_bf16 v[136:139], v[76:79], v[100:103], v[136:139]
    ds_read_b64_tr_b16 v[66:67], v15 offset:1024
    v_mfma_f32_16x16x32_bf16 v[168:171], v[76:79], v[104:107], v[168:171]
    ds_read_b128 v[24:27], v10 offset:2048
    v_mfma_f32_16x16x32_bf16 v[200:203], v[76:79], v[108:111], v[200:203]
    ds_read_b128 v[28:31], v10 offset:4096
    v_mfma_f32_16x16x32_bf16 v[232:235], v[76:79], v[112:115], v[232:235]
    ds_read_b128 v[32:35], v10 offset:6144
    v_mfma_f32_16x16x32_bf16 v[140:143], v[80:83], v[100:103], v[140:143]
    ds_read_b128 v[36:39], v10 offset:8192
    v_mfma_f32_16x16x32_bf16 v[172:175], v[80:83], v[104:107], v[172:175]
    ds_read_b128 v[40:43], v10 offset:10240
    v_mfma_f32_16x16x32_bf16 v[204:207], v[80:83], v[108:111], v[204:207]
    ds_read_b128 v[44:47], v10 offset:12288
    v_mfma_f32_16x16x32_bf16 v[236:239], v[80:83], v[112:115], v[236:239]
    ds_read_b128 v[48:51], v10 offset:14336
    v_mfma_f32_16x16x32_bf16 v[144:147], v[84:87], v[100:103], v[144:147]
    v_mfma_f32_16x16x32_bf16 v[176:179], v[84:87], v[104:107], v[176:179]
    v_mfma_f32_16x16x32_bf16 v[208:211], v[84:87], v[108:111], v[208:211]
    v_mfma_f32_16x16x32_bf16 v[240:243], v[84:87], v[112:115], v[240:243]
    v_mfma_f32_16x16x32_bf16 v[148:151], v[88:91], v[100:103], v[148:151]
    v_mfma_f32_16x16x32_bf16 v[180:183], v[88:91], v[104:107], v[180:183]
    v_mfma_f32_16x16x32_bf16 v[212:215], v[88:91], v[108:111], v[212:215]
    v_mfma_f32_16x16x32_bf16 v[244:247], v[88:91], v[112:115], v[244:247]
    v_mfma_f32_16x16x32_bf16 v[152:155], v[92:95], v[100:103], v[152:155]
    v_mfma_f32_16x16x32_bf16 v[184:187], v[92:95], v[104:107], v[184:187]
    v_mfma_f32_16x16x32_bf16 v[216:219], v[92:95], v[108:111], v[216:219]
    v_mfma_f32_16x16x32_bf16 v[248:251], v[92:95], v[112:115], v[248:251]
    v_mfma_f32_16x16x32_bf16 v[156:159], v[96:99], v[100:103], v[156:159]
    v_mfma_f32_16x16x32_bf16 v[188:191], v[96:99], v[104:107], v[188:191]
    v_mfma_f32_16x16x32_bf16 v[220:223], v[96:99], v[108:111], v[220:223]
    v_mfma_f32_16x16x32_bf16 v[252:255], v[96:99], v[112:115], v[252:255]
    s_bitcmp1_b32 3, s35
    s_cselect_b32 exec_lo, 255, 1
    s_mov_b32 exec_hi, 0
    global_load_dword v0, v17, s[96:97]
    s_mov_b64 exec, -1
    s_cselect_b32 s36, s45, 0
    v_add_u32 v17, s36, v17
    v_min_u32 v17, 8388480, v17
    s_nop 1
    s_add_u32 s35, s35, 1
    s_branch L_kv_vloop
L_p1_fin1:
    s_and_b32 s36, s28, 3
    s_sub_u32 s37, 15, s30
    s_cmp_lt_u32 s28, 4
    s_cselect_b32 s37, s37, s30
    s_lshl_b32 s37, s37, 2
    s_add_u32 s37, s37, s36
    s_lshl_b32 s37, s37, 16
    v_lshl_add_u32 v6, v1, 4, s37
    v_add_u32 v7, 32768, v6
    s_mov_b32 s32, 0
    s_mov_b32 s8, s54
    s_and_b32 s9, s55, 0xffff
    s_mov_b32 s10, 104857728
    s_mov_b32 s11, 0x20000
    v_mfma_f32_16x16x32_bf16 v[128:131], v[68:71], v[100:103], v[128:131]
    v_mfma_f32_16x16x32_bf16 v[160:163], v[68:71], v[104:107], v[160:163]
    buffer_load_dwordx4 v[24:27], v6, s[8:11], s32 offen offset:0 sc1
    v_mfma_f32_16x16x32_bf16 v[192:195], v[68:71], v[108:111], v[192:195]
    v_lshrrev_b32 v18, 4, v1
    v_mfma_f32_16x16x32_bf16 v[224:227], v[68:71], v[112:115], v[224:227]
    v_bfe_u32 v20, v1, 2, 2
    v_mfma_f32_16x16x32_bf16 v[132:135], v[72:75], v[100:103], v[132:135]
    v_lshl_add_u32 v19, v18, 3, v20
    v_mfma_f32_16x16x32_bf16 v[164:167], v[72:75], v[104:107], v[164:167]
    buffer_load_dwordx4 v[28:31], v7, s[8:11], s32 offen offset:0 sc1
    v_lshlrev_b32 v19, 8, v19
    v_mfma_f32_16x16x32_bf16 v[196:199], v[72:75], v[108:111], v[196:199]
    v_and_b32 v21, 3, v1
    v_mfma_f32_16x16x32_bf16 v[228:231], v[72:75], v[112:115], v[228:231]
    v_lshl_add_u32 v19, v21, 3, v19
    v_mfma_f32_16x16x32_bf16 v[136:139], v[76:79], v[100:103], v[136:139]
    v_and_b32 v21, 1, v18
    v_mfma_f32_16x16x32_bf16 v[168:171], v[76:79], v[104:107], v[168:171]
    buffer_load_dwordx4 v[32:35], v6, s[8:11], s32 offen offset:1024 sc1
    v_lshl_add_u32 v20, v21, 2, v20
    v_mfma_f32_16x16x32_bf16 v[200:203], v[76:79], v[108:111], v[200:203]
    v_xor_b32 v21, 0, v20
    v_mfma_f32_16x16x32_bf16 v[232:235], v[76:79], v[112:115], v[232:235]
    v_lshl_add_u32 v10, v21, 5, v19
    v_mfma_f32_16x16x32_bf16 v[140:143], v[80:83], v[100:103], v[140:143]
    v_xor_b32 v21, 1, v20
    v_mfma_f32_16x16x32_bf16 v[172:175], v[80:83], v[104:107], v[172:175]
    buffer_load_dwordx4 v[36:39], v7, s[8:11], s32 offen offset:1024 sc1
    v_lshl_add_u32 v11, v21, 5, v19
    v_mfma_f32_16x16x32_bf16 v[204:207], v[80:83], v[108:111], v[204:207]
    v_xor_b32 v21, 2, v20
    v_mfma_f32_16x16x32_bf16 v[236:239], v[80:83], v[112:115], v[236:239]
    v_lshl_add_u32 v12, v21, 5, v19
    v_mfma_f32_16x16x32_bf16 v[144:147], v[84:87], v[100:103], v[144:147]
    v_xor_b32 v21, 3, v20
    v_mfma_f32_16x16x32_bf16 v[176:179], v[84:87], v[104:107], v[176:179]
    buffer_load_dwordx4 v[40:43], v6, s[8:11], s32 offen offset:2048 sc1
    v_lshl_add_u32 v13, v21, 5, v19
    v_mfma_f32_16x16x32_bf16 v[208:211], v[84:87], v[108:111], v[208:211]
    v_xor_b32 v21, 4, v20
    v_mfma_f32_16x16x32_bf16 v[240:243], v[84:87], v[112:115], v[240:243]
    v_lshl_add_u32 v14, v21, 5, v19
    v_mfma_f32_16x16x32_bf16 v[148:151], v[88:91], v[100:103], v[148:151]
    v_xor_b32 v21, 5, v20
    v_mfma_f32_16x16x32_bf16 v[180:183], v[88:91], v[104:107], v[180:183]
    buffer_load_dwordx4 v[44:47], v7, s[8:11], s32 offen offset:2048 sc1
    v_lshl_add_u32 v15, v21, 5, v19
    v_mfma_f32_16x16x32_bf16 v[212:215], v[88:91], v[108:111], v[212:215]
    v_xor_b32 v21, 6, v20
    v_mfma_f32_16x16x32_bf16 v[244:247], v[88:91], v[112:115], v[244:247]
    v_lshl_add_u32 v16, v21, 5, v19
    v_mfma_f32_16x16x32_bf16 v[152:155], v[92:95], v[100:103], v[152:155]
    v_xor_b32 v21, 7, v20
    v_mfma_f32_16x16x32_bf16 v[184:187], v[92:95], v[104:107], v[184:187]
    buffer_load_dwordx4 v[48:51], v6, s[8:11], s32 offen offset:3072 sc1
    v_lshl_add_u32 v17, v21, 5, v19
    v_mfma_f32_16x16x32_bf16 v[216:219], v[92:95], v[108:111], v[216:219]
    s_lshl_b32 s45, s29, 20
    v_mfma_f32_16x16x32_bf16 v[248:251], v[92:95], v[112:115], v[248:251]
    v_mfma_f32_16x16x32_bf16 v[156:159], v[96:99], v[100:103], v[156:159]
    v_mfma_f32_16x16x32_bf16 v[188:191], v[96:99], v[104:107], v[188:191]
    buffer_load_dwordx4 v[52:55], v7, s[8:11], s32 offen offset:3072 sc1
    v_mfma_f32_16x16x32_bf16 v[220:223], v[96:99], v[108:111], v[220:223]
    v_mfma_f32_16x16x32_bf16 v[252:255], v[96:99], v[112:115], v[252:255]
L_p1_done:
    s_waitcnt vmcnt(8)
    ds_read_b64_tr_b16 v[64:65], v10 offset:0
    ds_read_b64_tr_b16 v[66:67], v10 offset:1024
    ds_read_b64_tr_b16 v[68:69], v11 offset:0
    ds_read_b64_tr_b16 v[70:71], v11 offset:1024
    ds_read_b64_tr_b16 v[72:73], v12 offset:0
    ds_read_b64_tr_b16 v[74:75], v12 offset:1024
    ds_read_b64_tr_b16 v[76:77], v13 offset:0
    ds_read_b64_tr_b16 v[78:79], v13 offset:1024
    ds_read_b64_tr_b16 v[80:81], v14 offset:0
    ds_read_b64_tr_b16 v[82:83], v14 offset:1024
    ds_read_b64_tr_b16 v[84:85], v15 offset:0
    ds_read_b64_tr_b16 v[86:87], v15 offset:1024
    s_add_u32 m0, s33, 32768
    s_add_u32 s32, s32, 4096
    v_cvt_pk_bf16_f32 v128, v128, v129
    v_cvt_pk_bf16_f32 v129, v130, v131
    v_cvt_pk_bf16_f32 v130, v132, v133
    v_cvt_pk_bf16_f32 v131, v134, v135
    v_cvt_pk_bf16_f32 v132, v136, v137
    v_cvt_pk_bf16_f32 v133, v138, v139
    buffer_load_dwordx4 v2, s[4:7], s31 offen offset:0 lds
    v_cvt_pk_bf16_f32 v134, v140, v141
    v_cvt_pk_bf16_f32 v135, v142, v143
    v_cvt_pk_bf16_f32 v136, v144, v145
    v_cvt_pk_bf16_f32 v137, v146, v147
    v_cvt_pk_bf16_f32 v138, v148, v149
    v_cvt_pk_bf16_f32 v139, v150, v151
    buffer_load_dwordx4 v3, s[4:7], s31 offen offset:1024 lds
    v_cvt_pk_bf16_f32 v140, v152, v153
    v_cvt_pk_bf16_f32 v141, v154, v155
    v_cvt_pk_bf16_f32 v142, v156, v157
    v_cvt_pk_bf16_f32 v143, v158, v159
    v_cvt_pk_bf16_f32 v144, v160, v161
    v_cvt_pk_bf16_f32 v145, v162, v163
    buffer_load_dwordx4 v4, s[4:7], s31 offen offset:2048 lds
    v_cvt_pk_bf16_f32 v146, v164, v165
    v_cvt_pk_bf16_f32 v147, v166, v167
    v_cvt_pk_bf16_f32 v148, v168, v169
    v_cvt_pk_bf16_f32 v149, v170, v171
    v_cvt_pk_bf16_f32 v150, v172, v173
    v_cvt_pk_bf16_f32 v151, v174, v175
    buffer_load_dwordx4 v5, s[4:7], s31 offen offset:3072 lds
    v_cvt_pk_bf16_f32 v152, v176, v177
    v_cvt_pk_bf16_f32 v153, v178, v179
    v_cvt_pk_bf16_f32 v154, v180, v181
    v_cvt_pk_bf16_f32 v155, v182, v183
    v_cvt_pk_bf16_f32 v156, v184, v185
    v_cvt_pk_bf16_f32 v157, v186, v187
    s_mov_b32 s31, 3145728
    s_add_u32 s34, s33, 98304
    v_cvt_pk_bf16_f32 v158, v188, v189
    v_cvt_pk_bf16_f32 v159, v190, v191
    v_cvt_pk_bf16_f32 v160, v192, v193
    v_cvt_pk_bf16_f32 v161, v194, v195
    v_cvt_pk_bf16_f32 v162, v196, v197
    v_cvt_pk_bf16_f32 v163, v198, v199
    buffer_load_dwordx4 v[96:99], v6, s[8:11], s32 offen offset:0 sc1
    v_cvt_pk_bf16_f32 v164, v200, v201
    v_cvt_pk_bf16_f32 v165, v202, v203
    v_cvt_pk_bf16_f32 v166, v204, v205
    v_cvt_pk_bf16_f32 v167, v206, v207
    v_cvt_pk_bf16_f32 v168, v208, v209
    v_cvt_pk_bf16_f32 v169, v210, v211
    buffer_load_dwordx4 v[100:103], v7, s[8:11], s32 offen offset:0 sc1
    v_cvt_pk_bf16_f32 v170, v212, v213
    v_cvt_pk_bf16_f32 v171, v214, v215
    v_cvt_pk_bf16_f32 v172, v216, v217
    v_cvt_pk_bf16_f32 v173, v218, v219
    v_cvt_pk_bf16_f32 v174, v220, v221
    v_cvt_pk_bf16_f32 v175, v222, v223
    buffer_load_dwordx4 v[104:107], v6, s[8:11], s32 offen offset:1024 sc1
    v_cvt_pk_bf16_f32 v176, v224, v225
    v_cvt_pk_bf16_f32 v177, v226, v227
    v_cvt_pk_bf16_f32 v178, v228, v229
    v_cvt_pk_bf16_f32 v179, v230, v231
    v_cvt_pk_bf16_f32 v180, v232, v233
    v_cvt_pk_bf16_f32 v181, v234, v235
    buffer_load_dwordx4 v[108:111], v7, s[8:11], s32 offen offset:1024 sc1
    v_cvt_pk_bf16_f32 v182, v236, v237
    v_cvt_pk_bf16_f32 v183, v238, v239
    v_cvt_pk_bf16_f32 v184, v240, v241
    v_cvt_pk_bf16_f32 v185, v242, v243
    v_cvt_pk_bf16_f32 v186, v244, v245
    v_cvt_pk_bf16_f32 v187, v246, v247
    buffer_load_dwordx4 v[112:115], v6, s[8:11], s32 offen offset:2048 sc1
    v_cvt_pk_bf16_f32 v188, v248, v249
    v_cvt_pk_bf16_f32 v189, v250, v251
    v_cvt_pk_bf16_f32 v190, v252, v253
    v_cvt_pk_bf16_f32 v191, v254, v255
    s_lshl_b32 s38, s29, 20
    s_lshl_b32 s37, s30, 17
    s_add_u32 s38, s38, s37
    s_bfe_u32 s37, s28, 0x10001
    s_lshl_b32 s37, s37, 16
    s_add_u32 s38, s38, s37
    s_lshr_b32 s36, s28, 2
    s_lshl_b32 s37, s36, 15
    s_add_u32 s38, s38, s37
    s_and_b32 s37, s28, 1
    s_add_u32 s36, s36, 11
    s_lshl_b32 s37, s37, s36
    s_add_u32 s38, s38, s37
    s_cmp_lt_u32 s28, 4
    s_cselect_b32 s36, 4, 32
    s_cselect_b32 s37, 16, 64
    s_cselect_b32 s39, 32, 4
    s_lshl_b32 s36, s36, 8
    s_lshl_b32 s37, s37, 8
    s_lshl_b32 s39, s39, 8
    s_mov_b64 s[16:17], s[12:13]
    s_mov_b64 s[18:19], s[14:15]
    s_cmp_eq_u32 s30, 0
    s_cselect_b32 s52, 2, 4
    v_lshlrev_b32 v58, 4, v1
    v_add_u32 v59, s36, v58
    v_add_u32 v60, s37, v58
    v_add_u32 v61, s36, v60
    v_mov_b64 v[192:193], 0
    v_mov_b64 v[194:195], 0
    v_mov_b64 v[196:197], 0
    v_mov_b64 v[198:199], 0
    v_mov_b64 v[200:201], 0
    v_mov_b64 v[202:203], 0
    v_mov_b64 v[204:205], 0
    v_mov_b64 v[206:207], 0
    v_mov_b64 v[208:209], 0
    v_mov_b64 v[210:211], 0
    v_mov_b64 v[212:213], 0
    v_mov_b64 v[214:215], 0
    v_mov_b64 v[216:217], 0
    v_mov_b64 v[218:219], 0
    v_mov_b64 v[220:221], 0
    v_mov_b64 v[222:223], 0
    v_mov_b64 v[224:225], 0
    v_mov_b64 v[226:227], 0
    v_mov_b64 v[228:229], 0
    v_mov_b64 v[230:231], 0
    v_mov_b64 v[232:233], 0
    v_mov_b64 v[234:235], 0
    v_mov_b64 v[236:237], 0
    v_mov_b64 v[238:239], 0
    v_mov_b64 v[240:241], 0
    v_mov_b64 v[242:243], 0
    v_mov_b64 v[244:245], 0
    v_mov_b64 v[246:247], 0
    v_mov_b64 v[248:249], 0
    v_mov_b64 v[250:251], 0
    v_mov_b64 v[252:253], 0
    v_mov_b64 v[254:255], 0
    buffer_load_dwordx4 v[116:119], v7, s[8:11], s32 offen offset:2048 sc1
    s_mov_b32 s35, 0
    s_mov_b32 s41, 0x1ffff
    s_waitcnt vmcnt(10)
    s_cmp_eq_u32 s30, 0
    s_cbranch_scc1 L_recurrent_scan__compressed_kv_cla__moe_arch_mod__prompt_kernel_rare_55
L_recurrent_scan__compressed_kv_cla__moe_arch_mod__prompt_kernel_back_56:
    .p2align 6
L_p2_loop:
    s_cmp_eq_u32 s35, 3
    s_cbranch_scc1 L_recurrent_scan__compressed_kv_cla__moe_arch_mod__prompt_kernel_rare_47
L_recurrent_scan__compressed_kv_cla__moe_arch_mod__prompt_kernel_back_48:
    s_waitcnt lgkmcnt(8)
    s_waitcnt vmcnt(22)
    v_mfma_f32_16x16x32_bf16 v[192:195], v[64:67], v[24:27], v[192:195]
    ds_read_b64_tr_b16 v[88:89], v16 offset:0
    v_mfma_f32_16x16x32_bf16 v[224:227], v[64:67], v[28:31], v[224:227]
    ds_read_b64_tr_b16 v[90:91], v16 offset:1024
    v_mfma_f32_16x16x32_bf16 v[196:199], v[68:71], v[24:27], v[196:199]
    ds_read_b64_tr_b16 v[92:93], v17 offset:0
    buffer_load_dwordx4 v[120:123], v6, s[8:11], s32 offen offset:3072 sc1
    v_mfma_f32_16x16x32_bf16 v[228:231], v[68:71], v[28:31], v[228:231]
    ds_read_b64_tr_b16 v[94:95], v17 offset:1024
    s_waitcnt lgkmcnt(8)
    v_mfma_f32_16x16x32_bf16 v[200:203], v[72:75], v[24:27], v[200:203]
    ds_read_b64_tr_b16 v[64:65], v10 offset:8192
    v_mfma_f32_16x16x32_bf16 v[232:235], v[72:75], v[28:31], v[232:235]
    ds_read_b64_tr_b16 v[66:67], v10 offset:9216
    v_mfma_f32_16x16x32_bf16 v[204:207], v[76:79], v[24:27], v[204:207]
    ds_read_b64_tr_b16 v[68:69], v11 offset:8192
    buffer_load_dwordx4 v[124:127], v7, s[8:11], s32 offen offset:3072 sc1
    v_mfma_f32_16x16x32_bf16 v[236:239], v[76:79], v[28:31], v[236:239]
    ds_read_b64_tr_b16 v[70:71], v11 offset:9216
    s_add_u32 s32, s32, 4096
    s_cmp_lt_u32 s35, s52
    s_cselect_b32 s18, s18, 0
    s_waitcnt lgkmcnt(8)
    v_mfma_f32_16x16x32_bf16 v[208:211], v[80:83], v[24:27], v[208:211]
    ds_read_b64_tr_b16 v[72:73], v12 offset:8192
    s_cmp_lt_u32 s35, 3
    s_cselect_b32 s10, s10, 0
    v_mfma_f32_16x16x32_bf16 v[240:243], v[80:83], v[28:31], v[240:243]
    ds_read_b64_tr_b16 v[74:75], v12 offset:9216
    v_mfma_f32_16x16x32_bf16 v[212:215], v[84:87], v[24:27], v[212:215]
    ds_read_b64_tr_b16 v[76:77], v13 offset:8192
    buffer_store_dwordx4 v[128:131], v58, s[16:19], s38 offen sc1
    v_mfma_f32_16x16x32_bf16 v[244:247], v[84:87], v[28:31], v[244:247]
    ds_read_b64_tr_b16 v[78:79], v13 offset:9216
    s_mov_b32 m0, s34
    s_waitcnt lgkmcnt(8)
    v_mfma_f32_16x16x32_bf16 v[216:219], v[88:91], v[24:27], v[216:219]
    ds_read_b64_tr_b16 v[80:81], v14 offset:8192
    v_mov_b64 v[128:129], v[144:145]
    buffer_load_dwordx4 v2, s[4:7], s31 offen offset:0 sc1 lds
    v_mfma_f32_16x16x32_bf16 v[248:251], v[88:91], v[28:31], v[248:251]
    ds_read_b64_tr_b16 v[82:83], v14 offset:9216
    v_mfma_f32_16x16x32_bf16 v[220:223], v[92:95], v[24:27], v[220:223]
    ds_read_b64_tr_b16 v[84:85], v15 offset:8192
    v_mov_b64 v[130:131], v[146:147]
    v_mfma_f32_16x16x32_bf16 v[252:255], v[92:95], v[28:31], v[252:255]
    ds_read_b64_tr_b16 v[86:87], v15 offset:9216
    s_waitcnt lgkmcnt(8)
    s_waitcnt vmcnt(22)
    v_mfma_f32_16x16x32_bf16 v[192:195], v[64:67], v[32:35], v[192:195]
    ds_read_b64_tr_b16 v[88:89], v16 offset:8192
    v_mov_b64 v[144:145], v[160:161]
    v_mfma_f32_16x16x32_bf16 v[224:227], v[64:67], v[36:39], v[224:227]
    ds_read_b64_tr_b16 v[90:91], v16 offset:9216
    v_mfma_f32_16x16x32_bf16 v[196:199], v[68:71], v[32:35], v[196:199]
    ds_read_b64_tr_b16 v[92:93], v17 offset:8192
    buffer_load_dwordx4 v[24:27], v6, s[8:11], s32 offen offset:0 sc1
    v_mov_b64 v[146:147], v[162:163]
    v_mfma_f32_16x16x32_bf16 v[228:231], v[68:71], v[36:39], v[228:231]
    ds_read_b64_tr_b16 v[94:95], v17 offset:9216
    s_waitcnt lgkmcnt(8)
    v_mfma_f32_16x16x32_bf16 v[200:203], v[72:75], v[32:35], v[200:203]
    ds_read_b64_tr_b16 v[64:65], v10 offset:16384
    v_mov_b64 v[160:161], v[176:177]
    v_mfma_f32_16x16x32_bf16 v[232:235], v[72:75], v[36:39], v[232:235]
    ds_read_b64_tr_b16 v[66:67], v10 offset:17408
    v_mfma_f32_16x16x32_bf16 v[204:207], v[76:79], v[32:35], v[204:207]
    ds_read_b64_tr_b16 v[68:69], v11 offset:16384
    buffer_load_dwordx4 v[28:31], v7, s[8:11], s32 offen offset:0 sc1
    v_mov_b64 v[162:163], v[178:179]
    v_mfma_f32_16x16x32_bf16 v[236:239], v[76:79], v[36:39], v[236:239]
    ds_read_b64_tr_b16 v[70:71], v11 offset:17408
    s_waitcnt lgkmcnt(8)
    v_mfma_f32_16x16x32_bf16 v[208:211], v[80:83], v[32:35], v[208:211]
    ds_read_b64_tr_b16 v[72:73], v12 offset:16384
    v_mfma_f32_16x16x32_bf16 v[240:243], v[80:83], v[36:39], v[240:243]
    ds_read_b64_tr_b16 v[74:75], v12 offset:17408
    v_mfma_f32_16x16x32_bf16 v[212:215], v[84:87], v[32:35], v[212:215]
    ds_read_b64_tr_b16 v[76:77], v13 offset:16384
    v_mfma_f32_16x16x32_bf16 v[244:247], v[84:87], v[36:39], v[244:247]
    ds_read_b64_tr_b16 v[78:79], v13 offset:17408
    s_waitcnt lgkmcnt(8)
    v_mfma_f32_16x16x32_bf16 v[216:219], v[88:91], v[32:35], v[216:219]
    ds_read_b64_tr_b16 v[80:81], v14 offset:16384
    buffer_load_dwordx4 v3, s[4:7], s31 offen offset:1024 sc1 lds
    v_mfma_f32_16x16x32_bf16 v[248:251], v[88:91], v[36:39], v[248:251]
    ds_read_b64_tr_b16 v[82:83], v14 offset:17408
    v_mfma_f32_16x16x32_bf16 v[220:223], v[92:95], v[32:35], v[220:223]
    ds_read_b64_tr_b16 v[84:85], v15 offset:16384
    buffer_store_dwordx4 v[132:135], v59, s[16:19], s38 offen sc1
    v_mfma_f32_16x16x32_bf16 v[252:255], v[92:95], v[36:39], v[252:255]
    ds_read_b64_tr_b16 v[86:87], v15 offset:17408
    s_waitcnt lgkmcnt(8)
    s_waitcnt vmcnt(23)
    v_mfma_f32_16x16x32_bf16 v[192:195], v[64:67], v[40:43], v[192:195]
    ds_read_b64_tr_b16 v[88:89], v16 offset:16384
    v_mov_b64 v[132:133], v[148:149]
    v_mfma_f32_16x16x32_bf16 v[224:227], v[64:67], v[44:47], v[224:227]
    ds_read_b64_tr_b16 v[90:91], v16 offset:17408
    v_mfma_f32_16x16x32_bf16 v[196:199], v[68:71], v[40:43], v[196:199]
    ds_read_b64_tr_b16 v[92:93], v17 offset:16384
    buffer_load_dwordx4 v[32:35], v6, s[8:11], s32 offen offset:1024 sc1
    v_mov_b64 v[134:135], v[150:151]
    v_mfma_f32_16x16x32_bf16 v[228:231], v[68:71], v[44:47], v[228:231]
    ds_read_b64_tr_b16 v[94:95], v17 offset:17408
    s_waitcnt lgkmcnt(8)
    v_mfma_f32_16x16x32_bf16 v[200:203], v[72:75], v[40:43], v[200:203]
    ds_read_b64_tr_b16 v[64:65], v10 offset:24576
    v_mov_b64 v[148:149], v[164:165]
    v_mfma_f32_16x16x32_bf16 v[232:235], v[72:75], v[44:47], v[232:235]
    ds_read_b64_tr_b16 v[66:67], v10 offset:25600
    v_mfma_f32_16x16x32_bf16 v[204:207], v[76:79], v[40:43], v[204:207]
    ds_read_b64_tr_b16 v[68:69], v11 offset:24576
    buffer_load_dwordx4 v[36:39], v7, s[8:11], s32 offen offset:1024 sc1
    v_mov_b64 v[150:151], v[166:167]
    v_mfma_f32_16x16x32_bf16 v[236:239], v[76:79], v[44:47], v[236:239]
    ds_read_b64_tr_b16 v[70:71], v11 offset:25600
    s_waitcnt lgkmcnt(8)
    v_mfma_f32_16x16x32_bf16 v[208:211], v[80:83], v[40:43], v[208:211]
    ds_read_b64_tr_b16 v[72:73], v12 offset:24576
    v_mov_b64 v[164:165], v[180:181]
    v_mfma_f32_16x16x32_bf16 v[240:243], v[80:83], v[44:47], v[240:243]
    ds_read_b64_tr_b16 v[74:75], v12 offset:25600
    v_mfma_f32_16x16x32_bf16 v[212:215], v[84:87], v[40:43], v[212:215]
    ds_read_b64_tr_b16 v[76:77], v13 offset:24576
    v_mov_b64 v[166:167], v[182:183]
    v_mfma_f32_16x16x32_bf16 v[244:247], v[84:87], v[44:47], v[244:247]
    ds_read_b64_tr_b16 v[78:79], v13 offset:25600
    s_waitcnt lgkmcnt(8)
    v_mfma_f32_16x16x32_bf16 v[216:219], v[88:91], v[40:43], v[216:219]
    ds_read_b64_tr_b16 v[80:81], v14 offset:24576
    buffer_load_dwordx4 v4, s[4:7], s31 offen offset:2048 sc1 lds
    v_mfma_f32_16x16x32_bf16 v[248:251], v[88:91], v[44:47], v[248:251]
    ds_read_b64_tr_b16 v[82:83], v14 offset:25600
    v_mfma_f32_16x16x32_bf16 v[220:223], v[92:95], v[40:43], v[220:223]
    ds_read_b64_tr_b16 v[84:85], v15 offset:24576
    v_mfma_f32_16x16x32_bf16 v[252:255], v[92:95], v[44:47], v[252:255]
    ds_read_b64_tr_b16 v[86:87], v15 offset:25600
    s_waitcnt lgkmcnt(8)
    s_waitcnt vmcnt(23)
    v_mfma_f32_16x16x32_bf16 v[192:195], v[64:67], v[48:51], v[192:195]
    ds_read_b64_tr_b16 v[88:89], v16 offset:24576
    v_mfma_f32_16x16x32_bf16 v[224:227], v[64:67], v[52:55], v[224:227]
    ds_read_b64_tr_b16 v[90:91], v16 offset:25600
    v_mfma_f32_16x16x32_bf16 v[196:199], v[68:71], v[48:51], v[196:199]
    ds_read_b64_tr_b16 v[92:93], v17 offset:24576
    buffer_load_dwordx4 v[40:43], v6, s[8:11], s32 offen offset:2048 sc1
    v_mfma_f32_16x16x32_bf16 v[228:231], v[68:71], v[52:55], v[228:231]
    ds_read_b64_tr_b16 v[94:95], v17 offset:25600
    s_waitcnt lgkmcnt(8)
    v_mfma_f32_16x16x32_bf16 v[200:203], v[72:75], v[48:51], v[200:203]
    v_mfma_f32_16x16x32_bf16 v[232:235], v[72:75], v[52:55], v[232:235]
    v_mfma_f32_16x16x32_bf16 v[204:207], v[76:79], v[48:51], v[204:207]
    buffer_load_dwordx4 v[44:47], v7, s[8:11], s32 offen offset:2048 sc1
    v_mfma_f32_16x16x32_bf16 v[236:239], v[76:79], v[52:55], v[236:239]
    s_cmp_eq_u32 s35, 3
    s_cbranch_scc1 L_recurrent_scan__compressed_kv_cla__moe_arch_mod__prompt_kernel_rare_45
L_recurrent_scan__compressed_kv_cla__moe_arch_mod__prompt_kernel_back_46:
    s_waitcnt lgkmcnt(0)
    s_waitcnt vmcnt(19)
    s_cmp_eq_u32 s35, s52
    s_cbranch_scc1 L_recurrent_scan__compressed_kv_cla__moe_arch_mod__prompt_kernel_rare_53
L_recurrent_scan__compressed_kv_cla__moe_arch_mod__prompt_kernel_back_54:
    s_barrier
    v_mfma_f32_16x16x32_bf16 v[208:211], v[80:83], v[48:51], v[208:211]
    ds_read_b64_tr_b16 v[64:65], v10 offset:32768
    ds_read_b64_tr_b16 v[66:67], v10 offset:33792
    v_mfma_f32_16x16x32_bf16 v[240:243], v[80:83], v[52:55], v[240:243]
    ds_read_b64_tr_b16 v[68:69], v11 offset:32768
    ds_read_b64_tr_b16 v[70:71], v11 offset:33792
    v_mfma_f32_16x16x32_bf16 v[212:215], v[84:87], v[48:51], v[212:215]
    ds_read_b64_tr_b16 v[72:73], v12 offset:32768
    ds_read_b64_tr_b16 v[74:75], v12 offset:33792
    v_mfma_f32_16x16x32_bf16 v[244:247], v[84:87], v[52:55], v[244:247]
    ds_read_b64_tr_b16 v[76:77], v13 offset:32768
    ds_read_b64_tr_b16 v[78:79], v13 offset:33792
    v_mfma_f32_16x16x32_bf16 v[216:219], v[88:91], v[48:51], v[216:219]
    ds_read_b64_tr_b16 v[80:81], v14 offset:32768
    ds_read_b64_tr_b16 v[82:83], v14 offset:33792
    buffer_load_dwordx4 v5, s[4:7], s31 offen offset:3072 sc1 lds
    v_mfma_f32_16x16x32_bf16 v[248:251], v[88:91], v[52:55], v[248:251]
    s_add_u32 s31, s31, s40
    s_add_u32 s34, s34, 32768
    s_and_b32 s34, s34, s41
    v_mfma_f32_16x16x32_bf16 v[220:223], v[92:95], v[48:51], v[220:223]
    ds_read_b64_tr_b16 v[84:85], v15 offset:32768
    ds_read_b64_tr_b16 v[86:87], v15 offset:33792
    v_mfma_f32_16x16x32_bf16 v[252:255], v[92:95], v[52:55], v[252:255]
    s_cmp_ge_u32 s35, 2
    s_cbranch_scc1 L_recurrent_scan__compressed_kv_cla__moe_arch_mod__prompt_kernel_rare_51
L_recurrent_scan__compressed_kv_cla__moe_arch_mod__prompt_kernel_back_52:
    s_waitcnt lgkmcnt(8)
    s_waitcnt vmcnt(18)
    v_mfma_f32_16x16x32_bf16 v[192:195], v[64:67], v[96:99], v[192:195]
    ds_read_b64_tr_b16 v[88:89], v16 offset:32768
    v_mfma_f32_16x16x32_bf16 v[224:227], v[64:67], v[100:103], v[224:227]
    ds_read_b64_tr_b16 v[90:91], v16 offset:33792
    v_mfma_f32_16x16x32_bf16 v[196:199], v[68:71], v[96:99], v[196:199]
    ds_read_b64_tr_b16 v[92:93], v17 offset:32768
    buffer_load_dwordx4 v[48:51], v6, s[8:11], s32 offen offset:3072 sc1
    v_mfma_f32_16x16x32_bf16 v[228:231], v[68:71], v[100:103], v[228:231]
    ds_read_b64_tr_b16 v[94:95], v17 offset:33792
    s_waitcnt lgkmcnt(8)
    v_mfma_f32_16x16x32_bf16 v[200:203], v[72:75], v[96:99], v[200:203]
    ds_read_b64_tr_b16 v[64:65], v10 offset:40960
    v_mfma_f32_16x16x32_bf16 v[232:235], v[72:75], v[100:103], v[232:235]
    ds_read_b64_tr_b16 v[66:67], v10 offset:41984
    v_mfma_f32_16x16x32_bf16 v[204:207], v[76:79], v[96:99], v[204:207]
    ds_read_b64_tr_b16 v[68:69], v11 offset:40960
    buffer_load_dwordx4 v[52:55], v7, s[8:11], s32 offen offset:3072 sc1
    v_mfma_f32_16x16x32_bf16 v[236:239], v[76:79], v[100:103], v[236:239]
    ds_read_b64_tr_b16 v[70:71], v11 offset:41984
    s_add_u32 s32, s32, 4096
    s_waitcnt lgkmcnt(8)
    v_mfma_f32_16x16x32_bf16 v[208:211], v[80:83], v[96:99], v[208:211]
    ds_read_b64_tr_b16 v[72:73], v12 offset:40960
    v_mfma_f32_16x16x32_bf16 v[240:243], v[80:83], v[100:103], v[240:243]
    ds_read_b64_tr_b16 v[74:75], v12 offset:41984
    v_mfma_f32_16x16x32_bf16 v[212:215], v[84:87], v[96:99], v[212:215]
    ds_read_b64_tr_b16 v[76:77], v13 offset:40960
    buffer_store_dwordx4 v[136:139], v60, s[16:19], s38 offen sc1
    v_mfma_f32_16x16x32_bf16 v[244:247], v[84:87], v[100:103], v[244:247]
    ds_read_b64_tr_b16 v[78:79], v13 offset:41984
    s_mov_b32 m0, s34
    s_waitcnt lgkmcnt(8)
    v_mfma_f32_16x16x32_bf16 v[216:219], v[88:91], v[96:99], v[216:219]
    ds_read_b64_tr_b16 v[80:81], v14 offset:40960
    v_mov_b64 v[136:137], v[152:153]
    buffer_load_dwordx4 v2, s[4:7], s31 offen offset:0 sc1 lds
    v_mfma_f32_16x16x32_bf16 v[248:251], v[88:91], v[100:103], v[248:251]
    ds_read_b64_tr_b16 v[82:83], v14 offset:41984
    v_mfma_f32_16x16x32_bf16 v[220:223], v[92:95], v[96:99], v[220:223]
    ds_read_b64_tr_b16 v[84:85], v15 offset:40960
    v_mov_b64 v[138:139], v[154:155]
    v_mfma_f32_16x16x32_bf16 v[252:255], v[92:95], v[100:103], v[252:255]
    ds_read_b64_tr_b16 v[86:87], v15 offset:41984
    s_waitcnt lgkmcnt(8)
    s_waitcnt vmcnt(20)
    v_mfma_f32_16x16x32_bf16 v[192:195], v[64:67], v[104:107], v[192:195]
    ds_read_b64_tr_b16 v[88:89], v16 offset:40960
    v_mov_b64 v[152:153], v[168:169]
    v_mfma_f32_16x16x32_bf16 v[224:227], v[64:67], v[108:111], v[224:227]
    ds_read_b64_tr_b16 v[90:91], v16 offset:41984
    v_mfma_f32_16x16x32_bf16 v[196:199], v[68:71], v[104:107], v[196:199]
    ds_read_b64_tr_b16 v[92:93], v17 offset:40960
    buffer_load_dwordx4 v[96:99], v6, s[8:11], s32 offen offset:0 sc1
    v_mov_b64 v[154:155], v[170:171]
    v_mfma_f32_16x16x32_bf16 v[228:231], v[68:71], v[108:111], v[228:231]
    ds_read_b64_tr_b16 v[94:95], v17 offset:41984
    s_waitcnt lgkmcnt(8)
    v_mfma_f32_16x16x32_bf16 v[200:203], v[72:75], v[104:107], v[200:203]
    ds_read_b64_tr_b16 v[64:65], v10 offset:49152
    v_mov_b64 v[168:169], v[184:185]
    v_mfma_f32_16x16x32_bf16 v[232:235], v[72:75], v[108:111], v[232:235]
    ds_read_b64_tr_b16 v[66:67], v10 offset:50176
    v_mfma_f32_16x16x32_bf16 v[204:207], v[76:79], v[104:107], v[204:207]
    ds_read_b64_tr_b16 v[68:69], v11 offset:49152
    buffer_load_dwordx4 v[100:103], v7, s[8:11], s32 offen offset:0 sc1
    v_mov_b64 v[170:171], v[186:187]
    v_mfma_f32_16x16x32_bf16 v[236:239], v[76:79], v[108:111], v[236:239]
    ds_read_b64_tr_b16 v[70:71], v11 offset:50176
    s_waitcnt lgkmcnt(8)
    v_mfma_f32_16x16x32_bf16 v[208:211], v[80:83], v[104:107], v[208:211]
    ds_read_b64_tr_b16 v[72:73], v12 offset:49152
    v_mfma_f32_16x16x32_bf16 v[240:243], v[80:83], v[108:111], v[240:243]
    ds_read_b64_tr_b16 v[74:75], v12 offset:50176
    v_mfma_f32_16x16x32_bf16 v[212:215], v[84:87], v[104:107], v[212:215]
    ds_read_b64_tr_b16 v[76:77], v13 offset:49152
    v_mfma_f32_16x16x32_bf16 v[244:247], v[84:87], v[108:111], v[244:247]
    ds_read_b64_tr_b16 v[78:79], v13 offset:50176
    s_waitcnt lgkmcnt(8)
    v_mfma_f32_16x16x32_bf16 v[216:219], v[88:91], v[104:107], v[216:219]
    ds_read_b64_tr_b16 v[80:81], v14 offset:49152
    buffer_load_dwordx4 v3, s[4:7], s31 offen offset:1024 sc1 lds
    v_mfma_f32_16x16x32_bf16 v[248:251], v[88:91], v[108:111], v[248:251]
    ds_read_b64_tr_b16 v[82:83], v14 offset:50176
    v_mfma_f32_16x16x32_bf16 v[220:223], v[92:95], v[104:107], v[220:223]
    ds_read_b64_tr_b16 v[84:85], v15 offset:49152
    buffer_store_dwordx4 v[140:143], v61, s[16:19], s38 offen sc1
    v_mfma_f32_16x16x32_bf16 v[252:255], v[92:95], v[108:111], v[252:255]
    ds_read_b64_tr_b16 v[86:87], v15 offset:50176
    s_add_u32 s38, s38, s39
    s_waitcnt lgkmcnt(8)
    s_waitcnt vmcnt(22)
    v_mfma_f32_16x16x32_bf16 v[192:195], v[64:67], v[112:115], v[192:195]
    ds_read_b64_tr_b16 v[88:89], v16 offset:49152
    v_mov_b64 v[140:141], v[156:157]
    v_mfma_f32_16x16x32_bf16 v[224:227], v[64:67], v[116:119], v[224:227]
    ds_read_b64_tr_b16 v[90:91], v16 offset:50176
    v_mfma_f32_16x16x32_bf16 v[196:199], v[68:71], v[112:115], v[196:199]
    ds_read_b64_tr_b16 v[92:93], v17 offset:49152
    buffer_load_dwordx4 v[104:107], v6, s[8:11], s32 offen offset:1024 sc1
    v_mov_b64 v[142:143], v[158:159]
    v_mfma_f32_16x16x32_bf16 v[228:231], v[68:71], v[116:119], v[228:231]
    ds_read_b64_tr_b16 v[94:95], v17 offset:50176
    s_waitcnt lgkmcnt(8)
    v_mfma_f32_16x16x32_bf16 v[200:203], v[72:75], v[112:115], v[200:203]
    ds_read_b64_tr_b16 v[64:65], v10 offset:57344
    v_mov_b64 v[156:157], v[172:173]
    v_mfma_f32_16x16x32_bf16 v[232:235], v[72:75], v[116:119], v[232:235]
    ds_read_b64_tr_b16 v[66:67], v10 offset:58368
    v_xor_b32 v10, 65536, v10
    v_mfma_f32_16x16x32_bf16 v[204:207], v[76:79], v[112:115], v[204:207]
    ds_read_b64_tr_b16 v[68:69], v11 offset:57344
    buffer_load_dwordx4 v[108:111], v7, s[8:11], s32 offen offset:1024 sc1
    v_mov_b64 v[158:159], v[174:175]
    v_mfma_f32_16x16x32_bf16 v[236:239], v[76:79], v[116:119], v[236:239]
    ds_read_b64_tr_b16 v[70:71], v11 offset:58368
    v_xor_b32 v11, 65536, v11
    s_waitcnt lgkmcnt(8)
    v_mfma_f32_16x16x32_bf16 v[208:211], v[80:83], v[112:115], v[208:211]
    ds_read_b64_tr_b16 v[72:73], v12 offset:57344
    v_mov_b64 v[172:173], v[188:189]
    v_mfma_f32_16x16x32_bf16 v[240:243], v[80:83], v[116:119], v[240:243]
    ds_read_b64_tr_b16 v[74:75], v12 offset:58368
    v_xor_b32 v12, 65536, v12
    v_mfma_f32_16x16x32_bf16 v[212:215], v[84:87], v[112:115], v[212:215]
    ds_read_b64_tr_b16 v[76:77], v13 offset:57344
    v_mov_b64 v[174:175], v[190:191]
    v_mfma_f32_16x16x32_bf16 v[244:247], v[84:87], v[116:119], v[244:247]
    ds_read_b64_tr_b16 v[78:79], v13 offset:58368
    v_xor_b32 v13, 65536, v13
    s_waitcnt lgkmcnt(8)
    v_mfma_f32_16x16x32_bf16 v[216:219], v[88:91], v[112:115], v[216:219]
    ds_read_b64_tr_b16 v[80:81], v14 offset:57344
    buffer_load_dwordx4 v4, s[4:7], s31 offen offset:2048 sc1 lds
    v_mfma_f32_16x16x32_bf16 v[248:251], v[88:91], v[116:119], v[248:251]
    ds_read_b64_tr_b16 v[82:83], v14 offset:58368
    v_xor_b32 v14, 65536, v14
    v_mfma_f32_16x16x32_bf16 v[220:223], v[92:95], v[112:115], v[220:223]
    ds_read_b64_tr_b16 v[84:85], v15 offset:57344
    v_mfma_f32_16x16x32_bf16 v[252:255], v[92:95], v[116:119], v[252:255]
    ds_read_b64_tr_b16 v[86:87], v15 offset:58368
    v_xor_b32 v15, 65536, v15
    s_waitcnt lgkmcnt(8)
    s_waitcnt vmcnt(23)
    v_mfma_f32_16x16x32_bf16 v[192:195], v[64:67], v[120:123], v[192:195]
    ds_read_b64_tr_b16 v[88:89], v16 offset:57344
    v_mfma_f32_16x16x32_bf16 v[224:227], v[64:67], v[124:127], v[224:227]
    ds_read_b64_tr_b16 v[90:91], v16 offset:58368
    v_xor_b32 v16, 65536, v16
    v_mfma_f32_16x16x32_bf16 v[196:199], v[68:71], v[120:123], v[196:199]
    ds_read_b64_tr_b16 v[92:93], v17 offset:57344
    buffer_load_dwordx4 v[112:115], v6, s[8:11], s32 offen offset:2048 sc1
    v_mfma_f32_16x16x32_bf16 v[228:231], v[68:71], v[124:127], v[228:231]
    ds_read_b64_tr_b16 v[94:95], v17 offset:58368
    v_xor_b32 v17, 65536, v17
    s_waitcnt lgkmcnt(8)
    v_mfma_f32_16x16x32_bf16 v[200:203], v[72:75], v[120:123], v[200:203]
    v_mfma_f32_16x16x32_bf16 v[232:235], v[72:75], v[124:127], v[232:235]
    v_mfma_f32_16x16x32_bf16 v[204:207], v[76:79], v[120:123], v[204:207]
    buffer_load_dwordx4 v[116:119], v7, s[8:11], s32 offen offset:2048 sc1
    v_mfma_f32_16x16x32_bf16 v[236:239], v[76:79], v[124:127], v[236:239]
    s_waitcnt lgkmcnt(0)
    s_barrier
    v_mfma_f32_16x16x32_bf16 v[208:211], v[80:83], v[120:123], v[208:211]
    ds_read_b64_tr_b16 v[64:65], v10 offset:0
    ds_read_b64_tr_b16 v[66:67], v10 offset:1024
    v_mfma_f32_16x16x32_bf16 v[240:243], v[80:83], v[124:127], v[240:243]
    ds_read_b64_tr_b16 v[68:69], v11 offset:0
    ds_read_b64_tr_b16 v[70:71], v11 offset:1024
    v_mfma_f32_16x16x32_bf16 v[212:215], v[84:87], v[120:123], v[212:215]
    ds_read_b64_tr_b16 v[72:73], v12 offset:0
    ds_read_b64_tr_b16 v[74:75], v12 offset:1024
    v_mfma_f32_16x16x32_bf16 v[244:247], v[84:87], v[124:127], v[244:247]
    ds_read_b64_tr_b16 v[76:77], v13 offset:0
    ds_read_b64_tr_b16 v[78:79], v13 offset:1024
    v_mfma_f32_16x16x32_bf16 v[216:219], v[88:91], v[120:123], v[216:219]
    ds_read_b64_tr_b16 v[80:81], v14 offset:0
    ds_read_b64_tr_b16 v[82:83], v14 offset:1024
    buffer_load_dwordx4 v5, s[4:7], s31 offen offset:3072 sc1 lds
    v_mfma_f32_16x16x32_bf16 v[248:251], v[88:91], v[124:127], v[248:251]
    s_add_u32 s31, s31, s40
    s_add_u32 s34, s34, 32768
    s_and_b32 s34, s34, s41
    v_mfma_f32_16x16x32_bf16 v[220:223], v[92:95], v[120:123], v[220:223]
    ds_read_b64_tr_b16 v[84:85], v15 offset:0
    ds_read_b64_tr_b16 v[86:87], v15 offset:1024
    v_mfma_f32_16x16x32_bf16 v[252:255], v[92:95], v[124:127], v[252:255]
    s_add_u32 s35, s35, 1
    s_cmp_lt_u32 s35, 4
    s_cbranch_scc1 L_p2_loop
    s_add_u32 m0, s33, 65536
    s_nop 0
    buffer_load_dwordx4 v2, s[4:7], s31 offen offset:0 sc1 lds
    buffer_load_dwordx4 v2, s[4:7], s31 offen offset:1024 sc1 lds
    buffer_load_dwordx4 v2, s[4:7], s31 offen offset:2048 sc1 lds
    buffer_load_dwordx4 v2, s[4:7], s31 offen offset:3072 sc1 lds
    s_load_dwordx2 s[32:33], s[0:1], 40
    s_load_dwordx2 s[34:35], s[0:1], 80
    s_load_dwordx2 s[96:97], s[0:1], 0
    s_load_dwordx2 s[98:99], s[0:1], 88
    s_cmp_lt_u32 s28, 4
    s_cbranch_scc0 L_grp1
    v_mov_b32 v20, 1040356334
    v_mov_b32 v21, v20
    s_and_b32 s37, s28, 3
    s_lshl_b32 s37, s37, 13
    v_lshlrev_b32 v7, 4, v1
    v_add_u32 v4, s37, v7
    v_add_u32 v19, 131072, v4
    v_add_u32 v6, 4096, v4
    s_add_u32 s43, s37, 32768
    s_add_u32 s44, s37, 98304
    s_waitcnt vmcnt(4) lgkmcnt(0)
    v_pk_mul_f32 v[192:193], v[192:193], v[20:21]
    v_pk_mul_f32 v[194:195], v[194:195], v[20:21]
    v_pk_mul_f32 v[196:197], v[196:197], v[20:21]
    v_pk_mul_f32 v[198:199], v[198:199], v[20:21]
    v_cvt_pk_bf16_f32 v128, v192, v193
    v_cvt_pk_bf16_f32 v129, v194, v195
    v_cvt_pk_bf16_f32 v130, v196, v197
    v_cvt_pk_bf16_f32 v131, v198, v199
    ds_write_b128 v19, v[128:131] offset:0
    v_pk_mul_f32 v[200:201], v[200:201], v[20:21]
    v_pk_mul_f32 v[202:203], v[202:203], v[20:21]
    v_pk_mul_f32 v[204:205], v[204:205], v[20:21]
    v_pk_mul_f32 v[206:207], v[206:207], v[20:21]
    v_cvt_pk_bf16_f32 v132, v200, v201
    v_cvt_pk_bf16_f32 v133, v202, v203
    v_cvt_pk_bf16_f32 v134, v204, v205
    v_cvt_pk_bf16_f32 v135, v206, v207
    ds_write_b128 v19, v[132:135] offset:1024
    v_pk_mul_f32 v[208:209], v[208:209], v[20:21]
    v_pk_mul_f32 v[210:211], v[210:211], v[20:21]
    v_pk_mul_f32 v[212:213], v[212:213], v[20:21]
    v_pk_mul_f32 v[214:215], v[214:215], v[20:21]
    v_cvt_pk_bf16_f32 v136, v208, v209
    v_cvt_pk_bf16_f32 v137, v210, v211
    v_cvt_pk_bf16_f32 v138, v212, v213
    v_cvt_pk_bf16_f32 v139, v214, v215
    ds_write_b128 v19, v[136:139] offset:2048
    v_pk_mul_f32 v[216:217], v[216:217], v[20:21]
    v_pk_mul_f32 v[218:219], v[218:219], v[20:21]
    v_pk_mul_f32 v[220:221], v[220:221], v[20:21]
    v_pk_mul_f32 v[222:223], v[222:223], v[20:21]
    v_cvt_pk_bf16_f32 v140, v216, v217
    v_cvt_pk_bf16_f32 v141, v218, v219
    v_cvt_pk_bf16_f32 v142, v220, v221
    v_cvt_pk_bf16_f32 v143, v222, v223
    ds_write_b128 v19, v[140:143] offset:3072
    v_pk_mul_f32 v[224:225], v[224:225], v[20:21]
    v_pk_mul_f32 v[226:227], v[226:227], v[20:21]
    v_pk_mul_f32 v[228:229], v[228:229], v[20:21]
    v_pk_mul_f32 v[230:231], v[230:231], v[20:21]
    v_cvt_pk_bf16_f32 v144, v224, v225
    v_cvt_pk_bf16_f32 v145, v226, v227
    v_cvt_pk_bf16_f32 v146, v228, v229
    v_cvt_pk_bf16_f32 v147, v230, v231
    ds_write_b128 v19, v[144:147] offset:4096
    v_pk_mul_f32 v[232:233], v[232:233], v[20:21]
    v_pk_mul_f32 v[234:235], v[234:235], v[20:21]
    v_pk_mul_f32 v[236:237], v[236:237], v[20:21]
    v_pk_mul_f32 v[238:239], v[238:239], v[20:21]
    v_cvt_pk_bf16_f32 v148, v232, v233
    v_cvt_pk_bf16_f32 v149, v234, v235
    v_cvt_pk_bf16_f32 v150, v236, v237
    v_cvt_pk_bf16_f32 v151, v238, v239
    ds_write_b128 v19, v[148:151] offset:5120
    v_pk_mul_f32 v[240:241], v[240:241], v[20:21]
    v_pk_mul_f32 v[242:243], v[242:243], v[20:21]
    v_pk_mul_f32 v[244:245], v[244:245], v[20:21]
    v_pk_mul_f32 v[246:247], v[246:247], v[20:21]
    v_cvt_pk_bf16_f32 v152, v240, v241
    v_cvt_pk_bf16_f32 v153, v242, v243
    v_cvt_pk_bf16_f32 v154, v244, v245
    v_cvt_pk_bf16_f32 v155, v246, v247
    ds_write_b128 v19, v[152:155] offset:6144
    v_pk_mul_f32 v[248:249], v[248:249], v[20:21]
    v_pk_mul_f32 v[250:251], v[250:251], v[20:21]
    v_pk_mul_f32 v[252:253], v[252:253], v[20:21]
    v_pk_mul_f32 v[254:255], v[254:255], v[20:21]
    v_cvt_pk_bf16_f32 v156, v248, v249
    v_cvt_pk_bf16_f32 v157, v250, v251
    v_cvt_pk_bf16_f32 v158, v252, v253
    v_cvt_pk_bf16_f32 v159, v254, v255
    ds_write_b128 v19, v[156:159] offset:7168
    v_mov_b32 v2, v7
    v_and_b32 v21, 15, v1
    v_lshrrev_b32 v22, 4, v1
    v_lshlrev_b32 v22, 2, v22
    v_sub_u32 v18, v21, v22
    s_mov_b32 s40, 0
    s_mov_b32 s41, 16384
    s_mov_b32 s49, 0xffff
    s_lshl_b32 s51, s30, 1
    s_add_u32 s51, s51, 1
    s_and_b32 s50, s28, 3
    s_lshl_b32 s50, s50, 5
    v_mov_b32 v36, 0x3f803f80
    v_mov_b32 v37, 0x3f803f80
    v_mov_b32 v38, 0x3f803f80
    v_mov_b32 v39, 0x3f803f80
    s_lshl_b32 s31, 1, s51
    s_or_b32 s31, s31, 0x8000
    s_add_u32 s36, s51, 1
    s_lshl_b32 s36, -1, s36
    s_or_b32 s48, s36, 0xaaaaaaab
    s_and_b32 s48, s48, 0x7fff
    s_or_b32 s39, s36, 0x55555555
    s_and_b32 s39, s39, 0xffff
    s_add_u32 s46, s45, 65536
    s_add_u32 s47, s45, 98304
    s_mov_b64 s[52:53], 0
    s_waitcnt lgkmcnt(0)
    s_barrier
    s_add_u32 s16, s54, 41943040
    s_addc_u32 s17, s55, 0
    s_and_b32 s17, s17, 0xffff
    s_mov_b32 s18, 117440640
    s_mov_b32 s19, 0x20000
    s_mov_b32 s4, s92
    s_and_b32 s5, s93, 0xffff
    s_mov_b32 s6, 7340032
    s_mov_b32 s7, 0x20000
    s_mov_b32 s8, s94
    s_and_b32 s9, s95, 0xffff
    s_mov_b32 s10, 7340032
    s_mov_b32 s11, 0x20000
    s_and_b32 s60, s29, 3
    s_add_u32 s60, s60, 4
    s_sub_u32 s3, s2, 32
    s_cmp_eq_u32 s28, 0
    s_cselect_b32 s36, 0xad, 0x2d
    s_cselect_b32 s42, 14, 12
    s_cmp_lt_u32 s3, 224
    s_cselect_b32 s36, s36, 0
    s_lshl_b32 s36, s36, s60
    s_or_b32 s42, s42, s36
    ds_read_b128 v[64:67], v2 offset:0
    ds_read_b128 v[68:71], v2 offset:1024
    ds_read_b128 v[72:75], v2 offset:2048
    ds_read_b128 v[76:79], v2 offset:3072
    ds_read_b128 v[80:83], v2 offset:4096
    ds_read_b128 v[84:87], v2 offset:5120
    ds_read_b128 v[88:91], v2 offset:6144
    ds_read_b128 v[92:95], v2 offset:7168
    s_waitcnt lgkmcnt(7)
    v_mfma_f32_16x16x32_bf16 v[96:99], v[64:67], v[128:131], 0
    v_mov_b64 v[192:193], 0
    v_mov_b64 v[194:195], 0
    v_mfma_f32_16x16x32_bf16 v[104:107], v[64:67], v[144:147], 0
    ds_read_b128 v[64:67], v2 offset:8192
    v_mov_b64 v[196:197], 0
    v_mov_b64 v[198:199], 0
    s_waitcnt lgkmcnt(7)
    v_mfma_f32_16x16x32_bf16 v[96:99], v[68:71], v[132:135], v[96:99]
    v_mov_b64 v[200:201], 0
    v_mov_b64 v[202:203], 0
    v_mfma_f32_16x16x32_bf16 v[104:107], v[68:71], v[148:151], v[104:107]
    ds_read_b128 v[68:71], v2 offset:9216
    v_mov_b64 v[204:205], 0
    v_mov_b64 v[206:207], 0
    s_waitcnt lgkmcnt(7)
    v_mfma_f32_16x16x32_bf16 v[96:99], v[72:75], v[136:139], v[96:99]
    v_mov_b64 v[208:209], 0
    v_mfma_f32_16x16x32_bf16 v[104:107], v[72:75], v[152:155], v[104:107]
    ds_read_b128 v[72:75], v2 offset:10240
    v_mov_b64 v[210:211], 0
    v_mov_b64 v[212:213], 0
    s_waitcnt lgkmcnt(7)
    v_mfma_f32_16x16x32_bf16 v[96:99], v[76:79], v[140:143], v[96:99]
    v_mov_b64 v[214:215], 0
    v_mov_b64 v[216:217], 0
    v_mfma_f32_16x16x32_bf16 v[104:107], v[76:79], v[156:159], v[104:107]
    ds_read_b128 v[76:79], v2 offset:11264
    v_mov_b64 v[218:219], 0
    v_mov_b64 v[220:221], 0
    s_waitcnt lgkmcnt(7)
    v_mfma_f32_16x16x32_bf16 v[100:103], v[80:83], v[128:131], 0
    v_mov_b64 v[222:223], 0
    v_mov_b64 v[224:225], 0
    v_mfma_f32_16x16x32_bf16 v[108:111], v[80:83], v[144:147], 0
    ds_read_b128 v[80:83], v2 offset:12288
    v_mov_b64 v[226:227], 0
    s_waitcnt lgkmcnt(7)
    v_mfma_f32_16x16x32_bf16 v[100:103], v[84:87], v[132:135], v[100:103]
    v_mov_b64 v[228:229], 0
    v_mov_b64 v[230:231], 0
    v_mfma_f32_16x16x32_bf16 v[108:111], v[84:87], v[148:151], v[108:111]
    ds_read_b128 v[84:87], v2 offset:13312
    v_mov_b64 v[232:233], 0
    v_mov_b64 v[234:235], 0
    s_waitcnt lgkmcnt(7)
    v_mfma_f32_16x16x32_bf16 v[100:103], v[88:91], v[136:139], v[100:103]
    v_mov_b64 v[236:237], 0
    v_mov_b64 v[238:239], 0
    v_mfma_f32_16x16x32_bf16 v[108:111], v[88:91], v[152:155], v[108:111]
    ds_read_b128 v[88:91], v2 offset:14336
    v_mov_b64 v[240:241], 0
    v_mov_b64 v[242:243], 0
    s_waitcnt lgkmcnt(7)
    v_mfma_f32_16x16x32_bf16 v[100:103], v[92:95], v[140:143], v[100:103]
    v_mov_b64 v[244:245], 0
    v_mfma_f32_16x16x32_bf16 v[108:111], v[92:95], v[156:159], v[108:111]
    ds_read_b128 v[92:95], v2 offset:15360
    v_mov_b64 v[246:247], 0
    v_mov_b64 v[248:249], 0
    s_waitcnt lgkmcnt(7)
    v_mfma_f32_16x16x32_bf16 v[112:115], v[64:67], v[128:131], 0
    v_mov_b64 v[250:251], 0
    v_mov_b64 v[252:253], 0
    v_mfma_f32_16x16x32_bf16 v[120:123], v[64:67], v[144:147], 0
    v_mov_b64 v[254:255], 0
    v_mov_b64 v[28:29], 0
    s_waitcnt lgkmcnt(6)
    v_mfma_f32_16x16x32_bf16 v[112:115], v[68:71], v[132:135], v[112:115]
    v_mov_b64 v[30:31], 0
    v_mov_b64 v[32:33], 0
    v_mfma_f32_16x16x32_bf16 v[120:123], v[68:71], v[148:151], v[120:123]
    v_mov_b64 v[34:35], 0
    s_waitcnt lgkmcnt(5)
    v_mfma_f32_16x16x32_bf16 v[112:115], v[72:75], v[136:139], v[112:115]
    v_mfma_f32_16x16x32_bf16 v[120:123], v[72:75], v[152:155], v[120:123]
    v_max3_f32 v22, v96, v97, v98
    v_max3_f32 v23, v104, v105, v106
    s_waitcnt lgkmcnt(4)
    v_mfma_f32_16x16x32_bf16 v[112:115], v[76:79], v[140:143], v[112:115]
    v_max3_f32 v22, v22, v99, v100
    v_max3_f32 v23, v23, v107, v108
    v_mfma_f32_16x16x32_bf16 v[120:123], v[76:79], v[156:159], v[120:123]
    v_max3_f32 v22, v22, v101, v102
    v_max3_f32 v23, v23, v109, v110
    s_waitcnt lgkmcnt(3)
    v_mfma_f32_16x16x32_bf16 v[116:119], v[80:83], v[128:131], 0
    v_max_f32 v22, v22, v103
    v_max_f32 v23, v23, v111
    v_mfma_f32_16x16x32_bf16 v[124:127], v[80:83], v[144:147], 0
    v_mov_b32 v24, v22
    v_mov_b32 v25, v23
    s_waitcnt lgkmcnt(2)
    v_mfma_f32_16x16x32_bf16 v[116:119], v[84:87], v[132:135], v[116:119]
    v_permlane16_swap_b32 v22, v24
    v_permlane16_swap_b32 v23, v25
    v_mfma_f32_16x16x32_bf16 v[124:127], v[84:87], v[148:151], v[124:127]
    v_max_f32 v22, v22, v24
    v_max_f32 v23, v23, v25
    s_waitcnt lgkmcnt(1)
    v_mfma_f32_16x16x32_bf16 v[116:119], v[88:91], v[136:139], v[116:119]
    v_mov_b32 v24, v22
    v_mov_b32 v25, v23
    v_mfma_f32_16x16x32_bf16 v[124:127], v[88:91], v[152:155], v[124:127]
    v_permlane32_swap_b32 v22, v24
    v_permlane32_swap_b32 v23, v25
    s_waitcnt lgkmcnt(0)
    v_mfma_f32_16x16x32_bf16 v[116:119], v[92:95], v[140:143], v[116:119]
    v_max_f32 v22, v22, v24
    v_max_f32 v23, v23, v25
    v_mfma_f32_16x16x32_bf16 v[124:127], v[92:95], v[156:159], v[124:127]
    v_sub_f32 v40, 0, v22
    v_sub_f32 v41, 0, v22
    v_sub_f32 v42, 0, v22
    v_sub_f32 v43, 0, v22
    v_sub_f32 v44, 0, v23
    v_sub_f32 v45, 0, v23
    v_sub_f32 v46, 0, v23
    v_sub_f32 v47, 0, v23
    v_add_u32 v3, 65536, v2
    v_add_u32 v2, s41, v2
    v_and_b32 v2, s49, v2
    s_waitcnt vmcnt(0)
    s_barrier
    s_cmp_eq_u32 s28, 0
    s_cbranch_scc1 L_recurrent_scan__compressed_kv_cla__moe_arch_mod__prompt_kernel_rare_57
L_recurrent_scan__compressed_kv_cla__moe_arch_mod__prompt_kernel_back_58:
    ds_read_b128 v[64:67], v2 offset:0
    ds_read_b128 v[68:71], v2 offset:1024
    ds_read_b128 v[72:75], v2 offset:2048
    ds_read_b128 v[76:79], v2 offset:3072
    ds_read_b128 v[80:83], v2 offset:4096
    ds_read_b128 v[84:87], v2 offset:5120
    ds_read_b128 v[88:91], v2 offset:6144
    ds_write_b32 v19, v40
    ds_write_b32 v19, v44 offset:4
    v_pk_add_f32 v[96:97], v[96:97], v[40:41]
    v_pk_add_f32 v[98:99], v[98:99], v[40:41]
    v_pk_add_f32 v[100:101], v[100:101], v[40:41]
    v_pk_add_f32 v[102:103], v[102:103], v[40:41]
    v_pk_add_f32 v[104:105], v[104:105], v[44:45]
    v_pk_add_f32 v[106:107], v[106:107], v[44:45]
    v_pk_add_f32 v[108:109], v[108:109], v[44:45]
    v_pk_add_f32 v[110:111], v[110:111], v[44:45]
    v_pk_add_f32 v[112:113], v[112:113], v[40:41]
    v_pk_add_f32 v[114:115], v[114:115], v[40:41]
    v_pk_add_f32 v[116:117], v[116:117], v[40:41]
    v_pk_add_f32 v[118:119], v[118:119], v[40:41]
    v_pk_add_f32 v[120:121], v[120:121], v[44:45]
    v_pk_add_f32 v[122:123], v[122:123], v[44:45]
    v_pk_add_f32 v[124:125], v[124:125], v[44:45]
    v_pk_add_f32 v[126:127], v[126:127], v[44:45]
    v_exp_f32 v96, v96
    v_exp_f32 v97, v97
    v_exp_f32 v98, v98
    v_exp_f32 v99, v99
    v_exp_f32 v104, v104
    v_exp_f32 v105, v105
    v_exp_f32 v106, v106
    v_exp_f32 v107, v107
    v_exp_f32 v100, v100
    v_exp_f32 v101, v101
    v_exp_f32 v102, v102
    v_exp_f32 v103, v103
    v_exp_f32 v108, v108
    v_exp_f32 v109, v109
    v_exp_f32 v110, v110
    v_exp_f32 v111, v111
    v_cvt_pk_bf16_f32 v48, v96, v97
    v_cvt_pk_bf16_f32 v49, v98, v99
    v_cvt_pk_bf16_f32 v52, v104, v105
    v_cvt_pk_bf16_f32 v53, v106, v107
    v_cvt_pk_bf16_f32 v50, v100, v101
    v_cvt_pk_bf16_f32 v51, v102, v103
    v_cvt_pk_bf16_f32 v54, v108, v109
    v_cvt_pk_bf16_f32 v55, v110, v111
    .p2align 6
L_body0:
    s_waitcnt lgkmcnt(5)
    v_mfma_f32_16x16x32_bf16 v[96:99], v[64:67], v[128:131], v[40:43]
    v_exp_f32 v112, v112
    v_mfma_f32_16x16x32_bf16 v[104:107], v[64:67], v[144:147], v[44:47]
    ds_read_b128 v[92:95], v2 offset:7168
    s_bitcmp1_b32 s48, s40
    s_cbranch_scc0 L_recurrent_scan__compressed_kv_cla__moe_arch_mod__prompt_kernel_nodma_81
    s_add_u32 m0, s43, 0
    s_nop 0
    buffer_load_dwordx4 v4, s[12:15], s46 offen offset:0 sc1 lds
    buffer_load_dwordx4 v4, s[12:15], s46 offen offset:1024 sc1 lds
L_recurrent_scan__compressed_kv_cla__moe_arch_mod__prompt_kernel_nodma_81:
    v_mfma_f32_16x16x32_bf16 v[96:99], v[68:71], v[132:135], v[96:99]
    v_exp_f32 v113, v113
    v_mfma_f32_16x16x32_bf16 v[104:107], v[68:71], v[148:151], v[104:107]
    ds_read_b128 v[64:67], v3 offset:0
    s_waitcnt lgkmcnt(5)
    v_mfma_f32_16x16x32_bf16 v[96:99], v[72:75], v[136:139], v[96:99]
    v_exp_f32 v114, v114
    v_mfma_f32_16x16x32_bf16 v[104:107], v[72:75], v[152:155], v[104:107]
    ds_read_b128 v[68:71], v3 offset:1024
    v_cvt_pk_bf16_f32 v56, v112, v113
    s_bitcmp1_b32 s48, s40
    s_cbranch_scc0 L_recurrent_scan__compressed_kv_cla__moe_arch_mod__prompt_kernel_nodma_82
    s_add_u32 m0, s43, 0
    s_nop 0
    buffer_load_dwordx4 v4, s[12:15], s46 offen offset:2048 sc1 lds
    buffer_load_dwordx4 v4, s[12:15], s46 offen offset:3072 sc1 lds
L_recurrent_scan__compressed_kv_cla__moe_arch_mod__prompt_kernel_nodma_82:
    v_mfma_f32_16x16x32_bf16 v[96:99], v[76:79], v[140:143], v[96:99]
    v_exp_f32 v115, v115
    v_mfma_f32_16x16x32_bf16 v[104:107], v[76:79], v[156:159], v[104:107]
    ds_read_b128 v[72:75], v3 offset:2048
    s_waitcnt lgkmcnt(5)
    v_mfma_f32_16x16x32_bf16 v[100:103], v[80:83], v[128:131], v[40:43]
    v_exp_f32 v120, v120
    v_mfma_f32_16x16x32_bf16 v[108:111], v[80:83], v[144:147], v[44:47]
    ds_read_b128 v[76:79], v3 offset:3072
    v_cvt_pk_bf16_f32 v57, v114, v115
    v_mfma_f32_16x16x32_bf16 v[100:103], v[84:87], v[132:135], v[100:103]
    v_exp_f32 v121, v121
    v_mfma_f32_16x16x32_bf16 v[108:111], v[84:87], v[148:151], v[108:111]
    ds_read_b128 v[80:83], v3 offset:4096
    s_bitcmp1_b32 s48, s40
    s_cbranch_scc0 L_recurrent_scan__compressed_kv_cla__moe_arch_mod__prompt_kernel_nodma_83
    s_add_u32 m0, s43, 4096
    s_nop 0
    buffer_load_dwordx4 v6, s[12:15], s46 offen offset:0 sc1 lds
    buffer_load_dwordx4 v6, s[12:15], s46 offen offset:1024 sc1 lds
L_recurrent_scan__compressed_kv_cla__moe_arch_mod__prompt_kernel_nodma_83:
    s_waitcnt lgkmcnt(5)
    v_mfma_f32_16x16x32_bf16 v[100:103], v[88:91], v[136:139], v[100:103]
    v_exp_f32 v122, v122
    v_mfma_f32_16x16x32_bf16 v[108:111], v[88:91], v[152:155], v[108:111]
    ds_read_b128 v[84:87], v3 offset:5120
    v_cvt_pk_bf16_f32 v60, v120, v121
    v_mfma_f32_16x16x32_bf16 v[100:103], v[92:95], v[140:143], v[100:103]
    v_exp_f32 v123, v123
    v_mfma_f32_16x16x32_bf16 v[108:111], v[92:95], v[156:159], v[108:111]
    ds_read_b128 v[88:91], v3 offset:6144
    s_bitcmp1_b32 s48, s40
    s_cbranch_scc0 L_recurrent_scan__compressed_kv_cla__moe_arch_mod__prompt_kernel_nodma_84
    s_add_u32 m0, s43, 4096
    s_nop 0
    buffer_load_dwordx4 v6, s[12:15], s46 offen offset:2048 sc1 lds
    buffer_load_dwordx4 v6, s[12:15], s46 offen offset:3072 sc1 lds
    s_add_u32 s46, s46, 65536
    s_xor_b32 s43, s43, 32768
L_recurrent_scan__compressed_kv_cla__moe_arch_mod__prompt_kernel_nodma_84:
    s_waitcnt lgkmcnt(5)
    v_mfma_f32_16x16x32_bf16 v[192:195], v[64:67], v[48:51], v[192:195]
    v_exp_f32 v116, v116
    v_mfma_f32_16x16x32_bf16 v[224:227], v[64:67], v[52:55], v[224:227]
    ds_read_b128 v[92:95], v3 offset:7168
    v_cvt_pk_bf16_f32 v61, v122, v123
    v_mfma_f32_16x16x32_bf16 v[196:199], v[68:71], v[48:51], v[196:199]
    v_exp_f32 v117, v117
    v_mfma_f32_16x16x32_bf16 v[228:231], v[68:71], v[52:55], v[228:231]
    ds_read_b128 v[64:67], v2 offset:8192
    s_waitcnt lgkmcnt(5)
    v_mfma_f32_16x16x32_bf16 v[200:203], v[72:75], v[48:51], v[200:203]
    v_exp_f32 v118, v118
    v_mfma_f32_16x16x32_bf16 v[232:235], v[72:75], v[52:55], v[232:235]
    v_mfma_f32_16x16x32_bf16 v[28:31], v[36:39], v[48:51], v[28:31]
    ds_read_b128 v[68:71], v2 offset:9216
    v_cvt_pk_bf16_f32 v58, v116, v117
    s_bitcmp1_b32 s39, s40
    s_cbranch_scc0 L_recurrent_scan__compressed_kv_cla__moe_arch_mod__prompt_kernel_nodma_85
    s_add_u32 m0, s44, 0
    s_nop 0
    buffer_load_dwordx4 v4, s[12:15], s47 offen offset:0 sc1 lds
    buffer_load_dwordx4 v4, s[12:15], s47 offen offset:1024 sc1 lds
L_recurrent_scan__compressed_kv_cla__moe_arch_mod__prompt_kernel_nodma_85:
    v_mfma_f32_16x16x32_bf16 v[204:207], v[76:79], v[48:51], v[204:207]
    v_exp_f32 v119, v119
    v_mfma_f32_16x16x32_bf16 v[236:239], v[76:79], v[52:55], v[236:239]
    ds_read_b128 v[72:75], v2 offset:10240
    s_waitcnt lgkmcnt(5)
    v_mfma_f32_16x16x32_bf16 v[208:211], v[80:83], v[48:51], v[208:211]
    v_exp_f32 v124, v124
    v_mfma_f32_16x16x32_bf16 v[240:243], v[80:83], v[52:55], v[240:243]
    ds_read_b128 v[76:79], v2 offset:11264
    v_cvt_pk_bf16_f32 v59, v118, v119
    s_bitcmp1_b32 s39, s40
    s_cbranch_scc0 L_recurrent_scan__compressed_kv_cla__moe_arch_mod__prompt_kernel_nodma_86
    s_add_u32 m0, s44, 0
    s_nop 0
    buffer_load_dwordx4 v4, s[12:15], s47 offen offset:2048 sc1 lds
    buffer_load_dwordx4 v4, s[12:15], s47 offen offset:3072 sc1 lds
L_recurrent_scan__compressed_kv_cla__moe_arch_mod__prompt_kernel_nodma_86:
    v_mfma_f32_16x16x32_bf16 v[212:215], v[84:87], v[48:51], v[212:215]
    v_exp_f32 v125, v125
    v_mfma_f32_16x16x32_bf16 v[244:247], v[84:87], v[52:55], v[244:247]
    ds_read_b128 v[80:83], v2 offset:12288
    s_waitcnt lgkmcnt(5)
    v_mfma_f32_16x16x32_bf16 v[216:219], v[88:91], v[48:51], v[216:219]
    v_exp_f32 v126, v126
    v_mfma_f32_16x16x32_bf16 v[248:251], v[88:91], v[52:55], v[248:251]
    v_mfma_f32_16x16x32_bf16 v[32:35], v[36:39], v[52:55], v[32:35]
    ds_read_b128 v[84:87], v2 offset:13312
    v_cvt_pk_bf16_f32 v62, v124, v125
    v_mfma_f32_16x16x32_bf16 v[220:223], v[92:95], v[48:51], v[220:223]
    v_exp_f32 v127, v127
    v_mfma_f32_16x16x32_bf16 v[252:255], v[92:95], v[52:55], v[252:255]
    ds_read_b128 v[88:91], v2 offset:14336
    v_cvt_pk_bf16_f32 v63, v126, v127
    s_bitcmp1_b32 s39, s40
    s_cbranch_scc0 L_recurrent_scan__compressed_kv_cla__moe_arch_mod__prompt_kernel_nodma_87
    s_add_u32 m0, s44, 4096
    s_nop 0
    buffer_load_dwordx4 v6, s[12:15], s47 offen offset:0 sc1 lds
    buffer_load_dwordx4 v6, s[12:15], s47 offen offset:1024 sc1 lds
L_recurrent_scan__compressed_kv_cla__moe_arch_mod__prompt_kernel_nodma_87:
    s_bitcmp1_b32 s31, s40
    s_cbranch_scc1 L_recurrent_scan__compressed_kv_cla__moe_arch_mod__prompt_kernel_rare_63
L_recurrent_scan__compressed_kv_cla__moe_arch_mod__prompt_kernel_back_64:
    s_waitcnt lgkmcnt(5)
    v_mfma_f32_16x16x32_bf16 v[112:115], v[64:67], v[128:131], v[40:43]
    v_exp_f32 v96, v96
    v_mfma_f32_16x16x32_bf16 v[120:123], v[64:67], v[144:147], v[44:47]
    ds_read_b128 v[92:95], v2 offset:15360
    v_mfma_f32_16x16x32_bf16 v[112:115], v[68:71], v[132:135], v[112:115]
    v_exp_f32 v97, v97
    v_mfma_f32_16x16x32_bf16 v[120:123], v[68:71], v[148:151], v[120:123]
    ds_read_b128 v[64:67], v3 offset:8192
    s_bitcmp1_b32 s39, s40
    s_cbranch_scc0 L_recurrent_scan__compressed_kv_cla__moe_arch_mod__prompt_kernel_nodma_88
    s_add_u32 m0, s44, 4096
    s_nop 0
    buffer_load_dwordx4 v6, s[12:15], s47 offen offset:2048 sc1 lds
    buffer_load_dwordx4 v6, s[12:15], s47 offen offset:3072 sc1 lds
    s_add_u32 s47, s47, 65536
    s_xor_b32 s44, s44, 32768
L_recurrent_scan__compressed_kv_cla__moe_arch_mod__prompt_kernel_nodma_88:
    s_waitcnt lgkmcnt(5)
    v_mfma_f32_16x16x32_bf16 v[112:115], v[72:75], v[136:139], v[112:115]
    v_exp_f32 v98, v98
    v_mfma_f32_16x16x32_bf16 v[120:123], v[72:75], v[152:155], v[120:123]
    ds_read_b128 v[68:71], v3 offset:9216
    v_cvt_pk_bf16_f32 v48, v96, v97
    v_mfma_f32_16x16x32_bf16 v[112:115], v[76:79], v[140:143], v[112:115]
    v_exp_f32 v99, v99
    v_mfma_f32_16x16x32_bf16 v[120:123], v[76:79], v[156:159], v[120:123]
    ds_read_b128 v[72:75], v3 offset:10240
    s_waitcnt lgkmcnt(5)
    v_mfma_f32_16x16x32_bf16 v[116:119], v[80:83], v[128:131], v[40:43]
    v_exp_f32 v104, v104
    v_mfma_f32_16x16x32_bf16 v[124:127], v[80:83], v[144:147], v[44:47]
    ds_read_b128 v[76:79], v3 offset:11264
    v_cvt_pk_bf16_f32 v49, v98, v99
    v_mfma_f32_16x16x32_bf16 v[116:119], v[84:87], v[132:135], v[116:119]
    v_exp_f32 v105, v105
    v_mfma_f32_16x16x32_bf16 v[124:127], v[84:87], v[148:151], v[124:127]
    ds_read_b128 v[80:83], v3 offset:12288
    s_waitcnt lgkmcnt(5)
    v_mfma_f32_16x16x32_bf16 v[116:119], v[88:91], v[136:139], v[116:119]
    v_exp_f32 v106, v106
    v_mfma_f32_16x16x32_bf16 v[124:127], v[88:91], v[152:155], v[124:127]
    ds_read_b128 v[84:87], v3 offset:13312
    v_cvt_pk_bf16_f32 v52, v104, v105
    v_mfma_f32_16x16x32_bf16 v[116:119], v[92:95], v[140:143], v[116:119]
    v_exp_f32 v107, v107
    v_mfma_f32_16x16x32_bf16 v[124:127], v[92:95], v[156:159], v[124:127]
    ds_read_b128 v[88:91], v3 offset:14336
    s_waitcnt lgkmcnt(5)
    v_mfma_f32_16x16x32_bf16 v[192:195], v[64:67], v[56:59], v[192:195]
    v_exp_f32 v100, v100
    v_mfma_f32_16x16x32_bf16 v[224:227], v[64:67], v[60:63], v[224:227]
    ds_read_b128 v[92:95], v3 offset:15360
    v_cvt_pk_bf16_f32 v53, v106, v107
    v_mfma_f32_16x16x32_bf16 v[196:199], v[68:71], v[56:59], v[196:199]
    v_exp_f32 v101, v101
    v_mfma_f32_16x16x32_bf16 v[228:231], v[68:71], v[60:63], v[228:231]
    v_add_u32 v3, 65536, v2
    v_add_u32 v2, s41, v2
    s_waitcnt lgkmcnt(4)
    v_mfma_f32_16x16x32_bf16 v[200:203], v[72:75], v[56:59], v[200:203]
    v_exp_f32 v102, v102
    s_add_u32 s40, s40, 1
    v_and_b32 v2, s49, v2
    v_mfma_f32_16x16x32_bf16 v[232:235], v[72:75], v[60:63], v[232:235]
    v_mfma_f32_16x16x32_bf16 v[28:31], v[36:39], v[56:59], v[28:31]
    v_cvt_pk_bf16_f32 v50, v100, v101
    s_waitcnt vmcnt(8) lgkmcnt(0)
    s_cmp_le_u32 s40, s51
    s_cbranch_scc1 L_recurrent_scan__compressed_kv_cla__moe_arch_mod__prompt_kernel_rlx_65
    s_waitcnt vmcnt(0)
L_recurrent_scan__compressed_kv_cla__moe_arch_mod__prompt_kernel_rlx_65:
    s_bitcmp1_b32 s42, s40
    s_cbranch_scc1 L_recurrent_scan__compressed_kv_cla__moe_arch_mod__prompt_kernel_rare_79
L_recurrent_scan__compressed_kv_cla__moe_arch_mod__prompt_kernel_back_80:
    s_barrier
    v_mfma_f32_16x16x32_bf16 v[204:207], v[76:79], v[56:59], v[204:207]
    v_exp_f32 v103, v103
    v_mfma_f32_16x16x32_bf16 v[236:239], v[76:79], v[60:63], v[236:239]
    ds_read_b128 v[68:71], v2 offset:1024
    ds_read_b128 v[64:67], v2 offset:0
    v_mfma_f32_16x16x32_bf16 v[208:211], v[80:83], v[56:59], v[208:211]
    v_exp_f32 v108, v108
    v_mfma_f32_16x16x32_bf16 v[240:243], v[80:83], v[60:63], v[240:243]
    ds_read_b128 v[76:79], v2 offset:3072
    ds_read_b128 v[72:75], v2 offset:2048
    v_cvt_pk_bf16_f32 v51, v102, v103
    v_mfma_f32_16x16x32_bf16 v[212:215], v[84:87], v[56:59], v[212:215]
    v_exp_f32 v109, v109
    v_mfma_f32_16x16x32_bf16 v[244:247], v[84:87], v[60:63], v[244:247]
    ds_read_b128 v[80:83], v2 offset:4096
    v_mfma_f32_16x16x32_bf16 v[216:219], v[88:91], v[56:59], v[216:219]
    v_exp_f32 v110, v110
    v_mfma_f32_16x16x32_bf16 v[248:251], v[88:91], v[60:63], v[248:251]
    v_mfma_f32_16x16x32_bf16 v[32:35], v[36:39], v[60:63], v[32:35]
    ds_read_b128 v[84:87], v2 offset:5120
    v_cvt_pk_bf16_f32 v54, v108, v109
    v_mfma_f32_16x16x32_bf16 v[220:223], v[92:95], v[56:59], v[220:223]
    v_exp_f32 v111, v111
    v_mfma_f32_16x16x32_bf16 v[252:255], v[92:95], v[60:63], v[252:255]
    ds_read_b128 v[88:91], v2 offset:6144
    v_cvt_pk_bf16_f32 v55, v110, v111
    s_cmp_lg_u32 s40, 16
    s_cbranch_scc1 L_body0
    s_lshr_b32 s36, s2, 5
    s_add_u32 s36, s36, 48
    s_lshl_b32 s36, s36, 7
    v_mov_b32 v12, s36
    global_load_dword v11, v12, s[90:91] sc1
    s_sub_u32 s36, 32, s50
    s_cmp_lt_i32 s36, 0
    s_cbranch_scc0 L_recurrent_scan__compressed_kv_cla__moe_arch_mod__prompt_kernel_rare_89
L_recurrent_scan__compressed_kv_cla__moe_arch_mod__prompt_kernel_back_90:
    s_lshl_b32 s37, s28, 13
    v_add_u32 v5, s37, v7
    s_waitcnt lgkmcnt(5)
    v_mfma_f32_16x16x32_bf16 v[192:195], v[64:67], v[48:51], v[192:195]
    v_exp_f32 v112, v112
    v_mfma_f32_16x16x32_bf16 v[224:227], v[64:67], v[52:55], v[224:227]
    ds_read_b128 v[92:95], v3 offset:7168
    v_exp_f32 v113, v113
    v_mfma_f32_16x16x32_bf16 v[196:199], v[68:71], v[48:51], v[196:199]
    v_cvt_pk_bf16_f32 v56, v112, v113
    v_exp_f32 v114, v114
    v_mfma_f32_16x16x32_bf16 v[228:231], v[68:71], v[52:55], v[228:231]
    ds_read_b128 v[64:67], v3 offset:8192
    v_exp_f32 v115, v115
    s_waitcnt lgkmcnt(5)
    v_mfma_f32_16x16x32_bf16 v[200:203], v[72:75], v[48:51], v[200:203]
    v_cvt_pk_bf16_f32 v57, v114, v115
    v_exp_f32 v120, v120
    v_mfma_f32_16x16x32_bf16 v[232:235], v[72:75], v[52:55], v[232:235]
    v_mfma_f32_16x16x32_bf16 v[28:31], v[36:39], v[48:51], v[28:31]
    ds_read_b128 v[68:71], v3 offset:9216
    v_exp_f32 v121, v121
    v_mfma_f32_16x16x32_bf16 v[204:207], v[76:79], v[48:51], v[204:207]
    v_cvt_pk_bf16_f32 v60, v120, v121
    v_exp_f32 v122, v122
    v_mfma_f32_16x16x32_bf16 v[236:239], v[76:79], v[52:55], v[236:239]
    ds_read_b128 v[72:75], v3 offset:10240
    v_exp_f32 v123, v123
    s_waitcnt lgkmcnt(6)
    v_mfma_f32_16x16x32_bf16 v[208:211], v[80:83], v[48:51], v[208:211]
    v_cvt_pk_bf16_f32 v61, v122, v123
    v_exp_f32 v116, v116
    v_mfma_f32_16x16x32_bf16 v[240:243], v[80:83], v[52:55], v[240:243]
    ds_read_b128 v[76:79], v3 offset:11264
    v_exp_f32 v117, v117
    s_waitcnt lgkmcnt(6)
    v_mfma_f32_16x16x32_bf16 v[212:215], v[84:87], v[48:51], v[212:215]
    v_cvt_pk_bf16_f32 v58, v116, v117
    v_exp_f32 v118, v118
    v_mfma_f32_16x16x32_bf16 v[244:247], v[84:87], v[52:55], v[244:247]
    ds_read_b128 v[80:83], v3 offset:12288
    v_exp_f32 v119, v119
    s_waitcnt lgkmcnt(6)
    v_mfma_f32_16x16x32_bf16 v[216:219], v[88:91], v[48:51], v[216:219]
    v_cvt_pk_bf16_f32 v59, v118, v119
    v_exp_f32 v124, v124
    v_mfma_f32_16x16x32_bf16 v[248:251], v[88:91], v[52:55], v[248:251]
    v_mfma_f32_16x16x32_bf16 v[32:35], v[36:39], v[52:55], v[32:35]
    ds_read_b128 v[84:87], v3 offset:13312
    v_exp_f32 v125, v125
    s_waitcnt lgkmcnt(6)
    v_mfma_f32_16x16x32_bf16 v[220:223], v[92:95], v[48:51], v[220:223]
    v_cvt_pk_bf16_f32 v62, v124, v125
    v_exp_f32 v126, v126
    v_mfma_f32_16x16x32_bf16 v[252:255], v[92:95], v[52:55], v[252:255]
    ds_read_b128 v[88:91], v3 offset:14336
    v_exp_f32 v127, v127
    s_nop 0
    v_cvt_pk_bf16_f32 v63, v126, v127
    s_nop 1
    s_waitcnt lgkmcnt(6)
    v_mfma_f32_16x16x32_bf16 v[192:195], v[64:67], v[56:59], v[192:195]
    s_mov_b32 s4, s34
    s_and_b32 s5, s35, 0xffff
    s_mov_b32 s6, 7340032
    s_mov_b32 s7, 0x20000
    s_mov_b32 s8, s32
    v_mfma_f32_16x16x32_bf16 v[224:227], v[64:67], v[60:63], v[224:227]
    ds_read_b128 v[92:95], v3 offset:15360
    s_and_b32 s9, s33, 0xffff
    s_mov_b32 s10, 8388608
    s_mov_b32 s11, 0x20000
    s_lshr_b32 s38, s2, 4
    s_waitcnt lgkmcnt(6)
    v_mfma_f32_16x16x32_bf16 v[196:199], v[68:71], v[56:59], v[196:199]
    s_mul_i32 s38, s38, 224
    s_and_b32 s39, s2, 15
    s_lshl_b32 s39, s39, 7
    v_lshrrev_b32 v25, 3, v1
    s_lshl_b32 s36, s28, 5
    v_mfma_f32_16x16x32_bf16 v[228:231], v[68:71], v[60:63], v[228:231]
    s_add_u32 s36, s36, s38
    v_add_u32 v25, s36, v25
    v_mul_u32_u24 v25, 2048, v25
    v_add_u32 v25, s39, v25
    s_waitcnt lgkmcnt(5)
    v_mfma_f32_16x16x32_bf16 v[200:203], v[72:75], v[56:59], v[200:203]
    v_bfe_u32 v26, v1, 4, 1
    v_lshlrev_b32 v26, 1, v26
    v_and_b32 v27, 7, v1
    v_xor_b32 v26, v26, v27
    v_mfma_f32_16x16x32_bf16 v[232:235], v[72:75], v[60:63], v[232:235]
    v_mfma_f32_16x16x32_bf16 v[28:31], v[36:39], v[56:59], v[28:31]
    v_lshl_add_u32 v24, v26, 4, v25
    v_xor_b32 v26, 4, v26
    v_lshl_add_u32 v25, v26, 4, v25
    v_add_u32 v25, 15360, v25
    v_add_u32 v26, 30720, v24
    s_waitcnt lgkmcnt(4)
    v_mfma_f32_16x16x32_bf16 v[204:207], v[76:79], v[56:59], v[204:207]
    v_add_u32 v27, 30720, v25
    s_lshl_b32 s36, s28, 12
    s_add_u32 s36, s36, 131072
    s_cmp_lt_u32 s28, 7
    s_cselect_b32 m0, s36, 0x30000
    s_cselect_b32 s6, 7340032, 0
    v_mfma_f32_16x16x32_bf16 v[236:239], v[76:79], v[60:63], v[236:239]
    buffer_load_dwordx4 v24, s[4:7], 0 offen offset:0 lds
    buffer_load_dwordx4 v25, s[4:7], 0 offen offset:1024 lds
    buffer_load_dwordx4 v26, s[4:7], 0 offen offset:2048 lds
    buffer_load_dwordx4 v27, s[4:7], 0 offen offset:3072 lds
    s_waitcnt lgkmcnt(3)
    v_mfma_f32_16x16x32_bf16 v[208:211], v[80:83], v[56:59], v[208:211]
    v_mfma_f32_16x16x32_bf16 v[240:243], v[80:83], v[60:63], v[240:243]
    ds_write_b128 v5, v[224:227] offset:0
    s_waitcnt lgkmcnt(3)
    v_mfma_f32_16x16x32_bf16 v[212:215], v[84:87], v[56:59], v[212:215]
    v_mfma_f32_16x16x32_bf16 v[244:247], v[84:87], v[60:63], v[244:247]
    ds_write_b128 v5, v[228:231] offset:1024
    s_waitcnt lgkmcnt(3)
    v_mfma_f32_16x16x32_bf16 v[216:219], v[88:91], v[56:59], v[216:219]
    v_mfma_f32_16x16x32_bf16 v[248:251], v[88:91], v[60:63], v[248:251]
    v_mfma_f32_16x16x32_bf16 v[32:35], v[36:39], v[60:63], v[32:35]
    ds_write_b128 v5, v[232:235] offset:2048
    s_waitcnt lgkmcnt(3)
    v_mfma_f32_16x16x32_bf16 v[220:223], v[92:95], v[56:59], v[220:223]
    v_mfma_f32_16x16x32_bf16 v[252:255], v[92:95], v[60:63], v[252:255]
    ds_write_b128 v5, v[236:239] offset:3072
    ds_write_b128 v5, v[240:243] offset:4096
    ds_write_b128 v5, v[244:247] offset:5120
    v_xor_b32 v106, 32768, v5
    s_lshl_b32 s37, s28, 8
    s_add_u32 s37, s37, 159744
    v_lshl_add_u32 v107, v1, 2, s37
    v_xor_b32 v108, 1024, v107
    ds_write_b128 v5, v[248:251] offset:6144
    ds_write_b128 v5, v[252:255] offset:7168
    ds_write_b32 v107, v32
    s_mov_b32 s36, 0x5d800000
    v_cmp_nge_f32 vcc, s36, v28
    s_nop 0
    s_or_b64 s[52:53], s[52:53], vcc
    v_cmp_nge_f32 vcc, s36, v32
    s_nop 0
    s_or_b64 s[52:53], s[52:53], vcc
    s_or_b32 s36, s52, s53
    v_mov_b32 v110, s36
    s_lshl_b32 s37, s28, 2
    s_add_u32 s37, s37, 161792
    v_mov_b32 v111, s37
    ds_write_b32 v111, v110
    v_mov_b32 v112, 161856
    v_mov_b32 v114, s56
    v_mov_b32 v115, s57
    v_mov_b32 v116, s58
    v_mov_b32 v117, s59
    ds_write_b128 v112, v[114:117]
    v_and_b32 v111, 7, v1
    v_lshlrev_b32 v111, 2, v111
    v_add_u32 v111, 161792, v111
    v_mov_b32 v113, v7
    s_sub_u32 s36, 15, s30
    s_lshl_b32 s38, s36, 3
    s_and_b32 s37, s28, 3
    s_lshl_b32 s37, s37, 1
    s_add_u32 s38, s38, s37
    s_lshl_b32 s38, s38, 17
    s_lshl_b32 s37, s29, 12
    s_add_u32 s38, s38, s37
    s_waitcnt vmcnt(4)
    v_readfirstlane_b32 s36, v11
    s_nop 0
    s_cmp_lt_u32 s36, 28
    s_cbranch_scc1 L_recurrent_scan__compressed_kv_cla__moe_arch_mod__prompt_kernel_rare_93
L_recurrent_scan__compressed_kv_cla__moe_arch_mod__prompt_kernel_back_94:
    s_lshr_b32 s36, s2, 4
    s_mul_i32 s36, s36, 7
    s_min_u32 s37, s28, 6
    s_add_u32 s36, s36, s37
    s_lshl_b32 s36, s36, 11
    s_add_u32 s36, s36, 58720256
    v_and_b32 v11, 15, v1
    v_lshlrev_b32 v11, 4, v11
    v_lshrrev_b32 v12, 4, v1
    v_lshl_add_u32 v11, v12, 9, v11
    buffer_load_dwordx4 v[96:99], v11, s[24:27], s36 offen offset:0 sc1
    buffer_load_dwordx4 v[100:103], v11, s[24:27], s36 offen offset:256 sc1
    s_waitcnt lgkmcnt(0)
    s_barrier
    ds_read_b32 v110, v111
    ds_read_b32 v109, v108
    ds_read_b128 v[64:67], v106 offset:0
    ds_read_b128 v[68:71], v106 offset:1024
    ds_read_b128 v[72:75], v106 offset:2048
    ds_read_b128 v[76:79], v106 offset:3072
    ds_read_b128 v[80:83], v106 offset:4096
    ds_read_b128 v[84:87], v106 offset:5120
    ds_read_b128 v[88:91], v106 offset:6144
    ds_read_b128 v[92:95], v106 offset:7168
    s_waitcnt lgkmcnt(8)
    v_add_f32 v109, v109, v28
    v_cmp_ne_u32 s[52:53], 0, v110
    v_rcp_f32 v109, v109
    s_nop 0
    v_mov_b32 v108, v109
    s_waitcnt lgkmcnt(6)
    v_pk_add_f32 v[192:193], v[192:193], v[64:65]
    v_pk_add_f32 v[194:195], v[194:195], v[66:67]
    v_pk_add_f32 v[196:197], v[196:197], v[68:69]
    v_pk_add_f32 v[198:199], v[198:199], v[70:71]
    v_pk_mul_f32 v[192:193], v[192:193], v[108:109]
    v_pk_mul_f32 v[194:195], v[194:195], v[108:109]
    v_pk_mul_f32 v[196:197], v[196:197], v[108:109]
    v_pk_mul_f32 v[198:199], v[198:199], v[108:109]
    v_cvt_pk_bf16_f32 v48, v192, v193
    v_cvt_pk_bf16_f32 v49, v194, v195
    v_cvt_pk_bf16_f32 v50, v196, v197
    v_cvt_pk_bf16_f32 v51, v198, v199
    buffer_store_dwordx4 v[48:51], v113, s[16:19], s38 offen offset:0 sc1
    s_waitcnt lgkmcnt(4)
    v_pk_add_f32 v[200:201], v[200:201], v[72:73]
    v_pk_add_f32 v[202:203], v[202:203], v[74:75]
    v_pk_add_f32 v[204:205], v[204:205], v[76:77]
    v_pk_add_f32 v[206:207], v[206:207], v[78:79]
    v_pk_mul_f32 v[200:201], v[200:201], v[108:109]
    v_pk_mul_f32 v[202:203], v[202:203], v[108:109]
    v_pk_mul_f32 v[204:205], v[204:205], v[108:109]
    v_pk_mul_f32 v[206:207], v[206:207], v[108:109]
    v_cvt_pk_bf16_f32 v52, v200, v201
    v_cvt_pk_bf16_f32 v53, v202, v203
    v_cvt_pk_bf16_f32 v54, v204, v205
    v_cvt_pk_bf16_f32 v55, v206, v207
    buffer_store_dwordx4 v[52:55], v113, s[16:19], s38 offen offset:1024 sc1
    s_waitcnt lgkmcnt(2)
    v_pk_add_f32 v[208:209], v[208:209], v[80:81]
    v_pk_add_f32 v[210:211], v[210:211], v[82:83]
    v_pk_add_f32 v[212:213], v[212:213], v[84:85]
    v_pk_add_f32 v[214:215], v[214:215], v[86:87]
    v_pk_mul_f32 v[208:209], v[208:209], v[108:109]
    v_pk_mul_f32 v[210:211], v[210:211], v[108:109]
    v_pk_mul_f32 v[212:213], v[212:213], v[108:109]
    v_pk_mul_f32 v[214:215], v[214:215], v[108:109]
    v_cvt_pk_bf16_f32 v56, v208, v209
    v_cvt_pk_bf16_f32 v57, v210, v211
    v_cvt_pk_bf16_f32 v58, v212, v213
    v_cvt_pk_bf16_f32 v59, v214, v215
    buffer_store_dwordx4 v[56:59], v113, s[16:19], s38 offen offset:2048 sc1
    s_waitcnt lgkmcnt(0)
    v_pk_add_f32 v[216:217], v[216:217], v[88:89]
    v_pk_add_f32 v[218:219], v[218:219], v[90:91]
    v_pk_add_f32 v[220:221], v[220:221], v[92:93]
    v_pk_add_f32 v[222:223], v[222:223], v[94:95]
    v_pk_mul_f32 v[216:217], v[216:217], v[108:109]
    v_pk_mul_f32 v[218:219], v[218:219], v[108:109]
    v_pk_mul_f32 v[220:221], v[220:221], v[108:109]
    v_pk_mul_f32 v[222:223], v[222:223], v[108:109]
    v_cvt_pk_bf16_f32 v60, v216, v217
    v_cvt_pk_bf16_f32 v61, v218, v219
    v_cvt_pk_bf16_f32 v62, v220, v221
    v_cvt_pk_bf16_f32 v63, v222, v223
    buffer_store_dwordx4 v[60:63], v113, s[16:19], s38 offen offset:3072 sc1
    s_cmp_eq_u64 s[52:53], 0
    s_cbranch_scc1 L_p3_done
    s_waitcnt vmcnt(0)
    v_mov_b32 v112, v96
    v_mov_b32 v113, v97
    v_mov_b32 v114, v98
    v_mov_b32 v115, v99
    v_mov_b32 v116, v100
    v_mov_b32 v117, v101
    v_mov_b32 v118, v102
    v_mov_b32 v119, v103
    v_mov_b32 v192, 0
    v_mov_b32 v193, 0
    v_mov_b32 v194, 0
    v_mov_b32 v195, 0
    v_mov_b32 v196, 0
    v_mov_b32 v197, 0
    v_mov_b32 v198, 0
    v_mov_b32 v199, 0
    v_mov_b32 v200, 0
    v_mov_b32 v201, 0
    v_mov_b32 v202, 0
    v_mov_b32 v203, 0
    v_mov_b32 v204, 0
    v_mov_b32 v205, 0
    v_mov_b32 v206, 0
    v_mov_b32 v207, 0
    v_mov_b32 v208, 0
    v_mov_b32 v209, 0
    v_mov_b32 v210, 0
    v_mov_b32 v211, 0
    v_mov_b32 v212, 0
    v_mov_b32 v213, 0
    v_mov_b32 v214, 0
    v_mov_b32 v215, 0
    v_mov_b32 v216, 0
    v_mov_b32 v217, 0
    v_mov_b32 v218, 0
    v_mov_b32 v219, 0
    v_mov_b32 v220, 0
    v_mov_b32 v221, 0
    v_mov_b32 v222, 0
    v_mov_b32 v223, 0
    v_mov_b32 v224, 0
    v_mov_b32 v225, 0
    v_mov_b32 v226, 0
    v_mov_b32 v227, 0
    v_mov_b32 v228, 0
    v_mov_b32 v229, 0
    v_mov_b32 v230, 0
    v_mov_b32 v231, 0
    v_mov_b32 v232, 0
    v_mov_b32 v233, 0
    v_mov_b32 v234, 0
    v_mov_b32 v235, 0
    v_mov_b32 v236, 0
    v_mov_b32 v237, 0
    v_mov_b32 v238, 0
    v_mov_b32 v239, 0
    v_mov_b32 v240, 0
    v_mov_b32 v241, 0
    v_mov_b32 v242, 0
    v_mov_b32 v243, 0
    v_mov_b32 v244, 0
    v_mov_b32 v245, 0
    v_mov_b32 v246, 0
    v_mov_b32 v247, 0
    v_mov_b32 v248, 0
    v_mov_b32 v249, 0
    v_mov_b32 v250, 0
    v_mov_b32 v251, 0
    v_mov_b32 v252, 0
    v_mov_b32 v253, 0
    v_mov_b32 v254, 0
    v_mov_b32 v255, 0
    v_mov_b32 v28, 0
    v_mov_b32 v40, 4048155338
    v_mov_b32 v32, 0
    v_mov_b32 v41, 4048155338
    s_lshl_b32 s43, s28, 12
    v_add_u32 v4, s43, v7
    s_mov_b32 s46, s45
    s_sub_u32 s40, 16, s30
    s_sub_u32 s39, 15, s30
    s_lshl_b32 s37, s39, 7
    s_and_b32 s36, s28, 3
    s_lshl_b32 s36, s36, 5
    s_add_u32 s36, s36, s37
    s_sub_u32 s50, 0, s36
L_recurrent_scan__compressed_kv_cla__moe_arch_mod__prompt_kernel_stile_95:
    s_waitcnt vmcnt(0) lgkmcnt(0)
    s_barrier
    s_mov_b32 m0, s43
    s_add_u32 s47, s46, 32768
    buffer_load_dwordx4 v4, s[12:15], s46 offen offset:0 sc1 lds
    buffer_load_dwordx4 v4, s[12:15], s46 offen offset:1024 sc1 lds
    buffer_load_dwordx4 v4, s[12:15], s46 offen offset:2048 sc1 lds
    buffer_load_dwordx4 v4, s[12:15], s46 offen offset:3072 sc1 lds
    s_add_u32 m0, s43, 32768
    s_add_u32 s46, s46, 65536
    buffer_load_dwordx4 v4, s[12:15], s47 offen offset:0 sc1 lds
    buffer_load_dwordx4 v4, s[12:15], s47 offen offset:1024 sc1 lds
    buffer_load_dwordx4 v4, s[12:15], s47 offen offset:2048 sc1 lds
    buffer_load_dwordx4 v4, s[12:15], s47 offen offset:3072 sc1 lds
    v_mov_b32 v2, v7
    s_mov_b32 s41, 4
    s_waitcnt vmcnt(0)
    s_barrier
L_recurrent_scan__compressed_kv_cla__moe_arch_mod__prompt_kernel_sunit_96:
    s_cmp_gt_i32 s50, 0
    s_cbranch_scc1 L_recurrent_scan__compressed_kv_cla__moe_arch_mod__prompt_kernel_snext_97
    ds_read_b128 v[64:67], v2 offset:0
    ds_read_b128 v[68:71], v2 offset:1024
    ds_read_b128 v[72:75], v2 offset:2048
    ds_read_b128 v[76:79], v2 offset:3072
    ds_read_b128 v[80:83], v2 offset:4096
    ds_read_b128 v[84:87], v2 offset:5120
    ds_read_b128 v[88:91], v2 offset:6144
    ds_read_b128 v[92:95], v2 offset:7168
    s_waitcnt lgkmcnt(0)
    v_mfma_f32_16x16x32_bf16 v[96:99], v[64:67], v[128:131], 0
    v_mfma_f32_16x16x32_bf16 v[104:107], v[64:67], v[144:147], 0
    v_mfma_f32_16x16x32_bf16 v[96:99], v[68:71], v[132:135], v[96:99]
    v_mfma_f32_16x16x32_bf16 v[104:107], v[68:71], v[148:151], v[104:107]
    v_mfma_f32_16x16x32_bf16 v[96:99], v[72:75], v[136:139], v[96:99]
    v_mfma_f32_16x16x32_bf16 v[104:107], v[72:75], v[152:155], v[104:107]
    v_mfma_f32_16x16x32_bf16 v[96:99], v[76:79], v[140:143], v[96:99]
    v_mfma_f32_16x16x32_bf16 v[104:107], v[76:79], v[156:159], v[104:107]
    v_mfma_f32_16x16x32_bf16 v[100:103], v[80:83], v[128:131], 0
    v_mfma_f32_16x16x32_bf16 v[108:111], v[80:83], v[144:147], 0
    v_mfma_f32_16x16x32_bf16 v[100:103], v[84:87], v[132:135], v[100:103]
    v_mfma_f32_16x16x32_bf16 v[108:111], v[84:87], v[148:151], v[108:111]
    v_mfma_f32_16x16x32_bf16 v[100:103], v[88:91], v[136:139], v[100:103]
    v_mfma_f32_16x16x32_bf16 v[108:111], v[88:91], v[152:155], v[108:111]
    v_mfma_f32_16x16x32_bf16 v[100:103], v[92:95], v[140:143], v[100:103]
    v_mfma_f32_16x16x32_bf16 v[108:111], v[92:95], v[156:159], v[108:111]
    ds_read_b128 v[64:67], v2 offset:32768
    ds_read_b128 v[68:71], v2 offset:33792
    ds_read_b128 v[72:75], v2 offset:34816
    ds_read_b128 v[76:79], v2 offset:35840
    ds_read_b128 v[80:83], v2 offset:36864
    ds_read_b128 v[84:87], v2 offset:37888
    ds_read_b128 v[88:91], v2 offset:38912
    ds_read_b128 v[92:95], v2 offset:39936
    s_nop 1
    s_cmp_lt_i32 s50, 0
    s_cbranch_scc0 L_recurrent_scan__compressed_kv_cla__moe_arch_mod__prompt_kernel_rare_98
L_recurrent_scan__compressed_kv_cla__moe_arch_mod__prompt_kernel_back_99:
    v_max3_f32 v22, v96, v97, v98
    v_max3_f32 v22, v22, v99, v100
    v_max3_f32 v22, v22, v101, v102
    v_max3_f32 v22, v22, v103, v40
    v_mov_b32 v24, v22
    s_nop 1
    v_permlane16_swap_b32 v22, v24
    s_nop 1
    v_max_f32 v22, v22, v24
    v_mov_b32 v24, v22
    s_nop 1
    v_permlane32_swap_b32 v22, v24
    s_nop 1
    v_max_f32 v22, v22, v24
    v_sub_f32 v25, v40, v22
    v_exp_f32 v25, v25
    v_mov_b32 v40, v22
    v_mul_f32 v28, v28, v25
    v_mul_f32 v192, v192, v25
    v_mul_f32 v193, v193, v25
    v_mul_f32 v194, v194, v25
    v_mul_f32 v195, v195, v25
    v_mul_f32 v196, v196, v25
    v_mul_f32 v197, v197, v25
    v_mul_f32 v198, v198, v25
    v_mul_f32 v199, v199, v25
    v_mul_f32 v200, v200, v25
    v_mul_f32 v201, v201, v25
    v_mul_f32 v202, v202, v25
    v_mul_f32 v203, v203, v25
    v_mul_f32 v204, v204, v25
    v_mul_f32 v205, v205, v25
    v_mul_f32 v206, v206, v25
    v_mul_f32 v207, v207, v25
    v_mul_f32 v208, v208, v25
    v_mul_f32 v209, v209, v25
    v_mul_f32 v210, v210, v25
    v_mul_f32 v211, v211, v25
    v_mul_f32 v212, v212, v25
    v_mul_f32 v213, v213, v25
    v_mul_f32 v214, v214, v25
    v_mul_f32 v215, v215, v25
    v_mul_f32 v216, v216, v25
    v_mul_f32 v217, v217, v25
    v_mul_f32 v218, v218, v25
    v_mul_f32 v219, v219, v25
    v_mul_f32 v220, v220, v25
    v_mul_f32 v221, v221, v25
    v_mul_f32 v222, v222, v25
    v_mul_f32 v223, v223, v25
    v_sub_f32 v96, v96, v22
    v_sub_f32 v97, v97, v22
    v_sub_f32 v98, v98, v22
    v_sub_f32 v99, v99, v22
    v_sub_f32 v100, v100, v22
    v_sub_f32 v101, v101, v22
    v_sub_f32 v102, v102, v22
    v_sub_f32 v103, v103, v22
    v_max3_f32 v23, v104, v105, v106
    v_max3_f32 v23, v23, v107, v108
    v_max3_f32 v23, v23, v109, v110
    v_max3_f32 v23, v23, v111, v41
    v_mov_b32 v24, v23
    s_nop 1
    v_permlane16_swap_b32 v23, v24
    s_nop 1
    v_max_f32 v23, v23, v24
    v_mov_b32 v24, v23
    s_nop 1
    v_permlane32_swap_b32 v23, v24
    s_nop 1
    v_max_f32 v23, v23, v24
    v_sub_f32 v25, v41, v23
    v_exp_f32 v25, v25
    v_mov_b32 v41, v23
    v_mul_f32 v32, v32, v25
    v_mul_f32 v224, v224, v25
    v_mul_f32 v225, v225, v25
    v_mul_f32 v226, v226, v25
    v_mul_f32 v227, v227, v25
    v_mul_f32 v228, v228, v25
    v_mul_f32 v229, v229, v25
    v_mul_f32 v230, v230, v25
    v_mul_f32 v231, v231, v25
    v_mul_f32 v232, v232, v25
    v_mul_f32 v233, v233, v25
    v_mul_f32 v234, v234, v25
    v_mul_f32 v235, v235, v25
    v_mul_f32 v236, v236, v25
    v_mul_f32 v237, v237, v25
    v_mul_f32 v238, v238, v25
    v_mul_f32 v239, v239, v25
    v_mul_f32 v240, v240, v25
    v_mul_f32 v241, v241, v25
    v_mul_f32 v242, v242, v25
    v_mul_f32 v243, v243, v25
    v_mul_f32 v244, v244, v25
    v_mul_f32 v245, v245, v25
    v_mul_f32 v246, v246, v25
    v_mul_f32 v247, v247, v25
    v_mul_f32 v248, v248, v25
    v_mul_f32 v249, v249, v25
    v_mul_f32 v250, v250, v25
    v_mul_f32 v251, v251, v25
    v_mul_f32 v252, v252, v25
    v_mul_f32 v253, v253, v25
    v_mul_f32 v254, v254, v25
    v_mul_f32 v255, v255, v25
    v_sub_f32 v104, v104, v23
    v_sub_f32 v105, v105, v23
    v_sub_f32 v106, v106, v23
    v_sub_f32 v107, v107, v23
    v_sub_f32 v108, v108, v23
    v_sub_f32 v109, v109, v23
    v_sub_f32 v110, v110, v23
    v_sub_f32 v111, v111, v23
    v_exp_f32 v96, v96
    v_exp_f32 v97, v97
    v_exp_f32 v98, v98
    v_exp_f32 v99, v99
    v_exp_f32 v104, v104
    v_exp_f32 v105, v105
    v_exp_f32 v106, v106
    v_exp_f32 v107, v107
    v_exp_f32 v100, v100
    v_exp_f32 v101, v101
    v_exp_f32 v102, v102
    v_exp_f32 v103, v103
    v_exp_f32 v108, v108
    v_exp_f32 v109, v109
    v_exp_f32 v110, v110
    v_exp_f32 v111, v111
    v_add_f32 v28, v28, v96
    v_add_f32 v28, v28, v97
    v_cvt_pk_bf16_f32 v48, v96, v97
    v_add_f32 v28, v28, v98
    v_add_f32 v28, v28, v99
    v_cvt_pk_bf16_f32 v49, v98, v99
    v_add_f32 v32, v32, v104
    v_add_f32 v32, v32, v105
    v_cvt_pk_bf16_f32 v52, v104, v105
    v_add_f32 v32, v32, v106
    v_add_f32 v32, v32, v107
    v_cvt_pk_bf16_f32 v53, v106, v107
    v_add_f32 v28, v28, v100
    v_add_f32 v28, v28, v101
    v_cvt_pk_bf16_f32 v50, v100, v101
    v_add_f32 v28, v28, v102
    v_add_f32 v28, v28, v103
    v_cvt_pk_bf16_f32 v51, v102, v103
    v_add_f32 v32, v32, v108
    v_add_f32 v32, v32, v109
    v_cvt_pk_bf16_f32 v54, v108, v109
    v_add_f32 v32, v32, v110
    v_add_f32 v32, v32, v111
    v_cvt_pk_bf16_f32 v55, v110, v111
    s_waitcnt lgkmcnt(0)
    s_nop 0
    v_mfma_f32_16x16x32_bf16 v[192:195], v[64:67], v[48:51], v[192:195]
    v_mfma_f32_16x16x32_bf16 v[224:227], v[64:67], v[52:55], v[224:227]
    v_mfma_f32_16x16x32_bf16 v[196:199], v[68:71], v[48:51], v[196:199]
    v_mfma_f32_16x16x32_bf16 v[228:231], v[68:71], v[52:55], v[228:231]
    v_mfma_f32_16x16x32_bf16 v[200:203], v[72:75], v[48:51], v[200:203]
    v_mfma_f32_16x16x32_bf16 v[232:235], v[72:75], v[52:55], v[232:235]
    v_mfma_f32_16x16x32_bf16 v[204:207], v[76:79], v[48:51], v[204:207]
    v_mfma_f32_16x16x32_bf16 v[236:239], v[76:79], v[52:55], v[236:239]
    v_mfma_f32_16x16x32_bf16 v[208:211], v[80:83], v[48:51], v[208:211]
    v_mfma_f32_16x16x32_bf16 v[240:243], v[80:83], v[52:55], v[240:243]
    v_mfma_f32_16x16x32_bf16 v[212:215], v[84:87], v[48:51], v[212:215]
    v_mfma_f32_16x16x32_bf16 v[244:247], v[84:87], v[52:55], v[244:247]
    v_mfma_f32_16x16x32_bf16 v[216:219], v[88:91], v[48:51], v[216:219]
    v_mfma_f32_16x16x32_bf16 v[248:251], v[88:91], v[52:55], v[248:251]
    v_mfma_f32_16x16x32_bf16 v[220:223], v[92:95], v[48:51], v[220:223]
    v_mfma_f32_16x16x32_bf16 v[252:255], v[92:95], v[52:55], v[252:255]
L_recurrent_scan__compressed_kv_cla__moe_arch_mod__prompt_kernel_snext_97:
    v_add_u32 v2, 8192, v2
    s_add_u32 s50, s50, 32
    s_sub_u32 s41, s41, 1
    s_cmp_lg_u32 s41, 0
    s_cbranch_scc1 L_recurrent_scan__compressed_kv_cla__moe_arch_mod__prompt_kernel_sunit_96
    s_sub_u32 s40, s40, 1
    s_cmp_lg_u32 s40, 0
    s_cbranch_scc1 L_recurrent_scan__compressed_kv_cla__moe_arch_mod__prompt_kernel_stile_95
    v_mov_b32 v20, v28
    s_nop 1
    v_permlane16_swap_b32 v28, v20
    s_nop 1
    v_add_f32 v28, v28, v20
    v_mov_b32 v20, v28
    s_nop 1
    v_permlane32_swap_b32 v28, v20
    s_nop 1
    v_add_f32 v28, v28, v20
    v_mov_b32 v20, v32
    s_nop 1
    v_permlane16_swap_b32 v32, v20
    s_nop 1
    v_add_f32 v32, v32, v20
    v_mov_b32 v20, v32
    s_nop 1
    v_permlane32_swap_b32 v32, v20
    s_nop 1
    v_add_f32 v32, v32, v20
    s_mov_b32 s36, 0x5d800000
    v_cmp_nge_f32 vcc, s36, v28
    s_nop 0
    s_or_b64 s[52:53], s[52:53], vcc
    v_cmp_nge_f32 vcc, s36, v32
    s_nop 0
    s_or_b64 s[52:53], s[52:53], vcc
    v_rcp_f32 v20, v28
    v_rcp_f32 v22, v32
    s_lshl_b32 s38, s39, 3
    s_and_b32 s37, s28, 3
    s_lshl_b32 s37, s37, 1
    s_add_u32 s38, s38, s37
    s_lshl_b32 s38, s38, 17
    s_lshl_b32 s37, s29, 12
    s_add_u32 s38, s38, s37
    v_mov_b32 v21, v20
    v_mov_b32 v23, v22
    v_mov_b32 v24, v7
    v_pk_mul_f32 v[192:193], v[192:193], v[20:21]
    v_pk_mul_f32 v[194:195], v[194:195], v[20:21]
    v_pk_mul_f32 v[196:197], v[196:197], v[20:21]
    v_pk_mul_f32 v[198:199], v[198:199], v[20:21]
    v_cvt_pk_bf16_f32 v192, v192, v193
    v_cvt_pk_bf16_f32 v193, v194, v195
    v_cvt_pk_bf16_f32 v194, v196, v197
    v_cvt_pk_bf16_f32 v195, v198, v199
    buffer_store_dwordx4 v[192:195], v24, s[16:19], s38 offen offset:0 sc1
    v_pk_mul_f32 v[200:201], v[200:201], v[20:21]
    v_pk_mul_f32 v[202:203], v[202:203], v[20:21]
    v_pk_mul_f32 v[204:205], v[204:205], v[20:21]
    v_pk_mul_f32 v[206:207], v[206:207], v[20:21]
    v_cvt_pk_bf16_f32 v200, v200, v201
    v_cvt_pk_bf16_f32 v201, v202, v203
    v_cvt_pk_bf16_f32 v202, v204, v205
    v_cvt_pk_bf16_f32 v203, v206, v207
    buffer_store_dwordx4 v[200:203], v24, s[16:19], s38 offen offset:1024 sc1
    v_pk_mul_f32 v[208:209], v[208:209], v[20:21]
    v_pk_mul_f32 v[210:211], v[210:211], v[20:21]
    v_pk_mul_f32 v[212:213], v[212:213], v[20:21]
    v_pk_mul_f32 v[214:215], v[214:215], v[20:21]
    v_cvt_pk_bf16_f32 v208, v208, v209
    v_cvt_pk_bf16_f32 v209, v210, v211
    v_cvt_pk_bf16_f32 v210, v212, v213
    v_cvt_pk_bf16_f32 v211, v214, v215
    buffer_store_dwordx4 v[208:211], v24, s[16:19], s38 offen offset:2048 sc1
    v_pk_mul_f32 v[216:217], v[216:217], v[20:21]
    v_pk_mul_f32 v[218:219], v[218:219], v[20:21]
    v_pk_mul_f32 v[220:221], v[220:221], v[20:21]
    v_pk_mul_f32 v[222:223], v[222:223], v[20:21]
    v_cvt_pk_bf16_f32 v216, v216, v217
    v_cvt_pk_bf16_f32 v217, v218, v219
    v_cvt_pk_bf16_f32 v218, v220, v221
    v_cvt_pk_bf16_f32 v219, v222, v223
    buffer_store_dwordx4 v[216:219], v24, s[16:19], s38 offen offset:3072 sc1
    s_add_u32 s38, s38, 131072
    v_pk_mul_f32 v[224:225], v[224:225], v[22:23]
    v_pk_mul_f32 v[226:227], v[226:227], v[22:23]
    v_pk_mul_f32 v[228:229], v[228:229], v[22:23]
    v_pk_mul_f32 v[230:231], v[230:231], v[22:23]
    v_cvt_pk_bf16_f32 v224, v224, v225
    v_cvt_pk_bf16_f32 v225, v226, v227
    v_cvt_pk_bf16_f32 v226, v228, v229
    v_cvt_pk_bf16_f32 v227, v230, v231
    buffer_store_dwordx4 v[224:227], v24, s[16:19], s38 offen offset:0 sc1
    v_pk_mul_f32 v[232:233], v[232:233], v[22:23]
    v_pk_mul_f32 v[234:235], v[234:235], v[22:23]
    v_pk_mul_f32 v[236:237], v[236:237], v[22:23]
    v_pk_mul_f32 v[238:239], v[238:239], v[22:23]
    v_cvt_pk_bf16_f32 v232, v232, v233
    v_cvt_pk_bf16_f32 v233, v234, v235
    v_cvt_pk_bf16_f32 v234, v236, v237
    v_cvt_pk_bf16_f32 v235, v238, v239
    buffer_store_dwordx4 v[232:235], v24, s[16:19], s38 offen offset:1024 sc1
    v_pk_mul_f32 v[240:241], v[240:241], v[22:23]
    v_pk_mul_f32 v[242:243], v[242:243], v[22:23]
    v_pk_mul_f32 v[244:245], v[244:245], v[22:23]
    v_pk_mul_f32 v[246:247], v[246:247], v[22:23]
    v_cvt_pk_bf16_f32 v240, v240, v241
    v_cvt_pk_bf16_f32 v241, v242, v243
    v_cvt_pk_bf16_f32 v242, v244, v245
    v_cvt_pk_bf16_f32 v243, v246, v247
    buffer_store_dwordx4 v[240:243], v24, s[16:19], s38 offen offset:2048 sc1
    v_pk_mul_f32 v[248:249], v[248:249], v[22:23]
    v_pk_mul_f32 v[250:251], v[250:251], v[22:23]
    v_pk_mul_f32 v[252:253], v[252:253], v[22:23]
    v_pk_mul_f32 v[254:255], v[254:255], v[22:23]
    v_cvt_pk_bf16_f32 v248, v248, v249
    v_cvt_pk_bf16_f32 v249, v250, v251
    v_cvt_pk_bf16_f32 v250, v252, v253
    v_cvt_pk_bf16_f32 v251, v254, v255
    buffer_store_dwordx4 v[248:251], v24, s[16:19], s38 offen offset:3072 sc1
    v_mov_b32 v96, v112
    v_mov_b32 v97, v113
    v_mov_b32 v98, v114
    v_mov_b32 v99, v115
    v_mov_b32 v100, v116
    v_mov_b32 v101, v117
    v_mov_b32 v102, v118
    v_mov_b32 v103, v119
    s_branch L_p3_done
L_recurrent_scan__compressed_kv_cla__moe_arch_mod__prompt_kernel_rare_1:
    s_mul_i32 s36, s28, 12288
    s_add_u32 s36, s36, 61865984
    v_lshl_add_u32 v16, v1, 4, s36
    v_mov_b32 v108, 0
    v_mov_b32 v109, 0
    v_mov_b32 v110, 0
    v_mov_b32 v111, 0
    global_store_dwordx4 v16, v[108:111], s[90:91] sc1
    v_add_u32 v16, 1024, v16
    global_store_dwordx4 v16, v[108:111], s[90:91] sc1
    v_add_u32 v16, 1024, v16
    global_store_dwordx4 v16, v[108:111], s[90:91] sc1
    v_add_u32 v16, 1024, v16
    global_store_dwordx4 v16, v[108:111], s[90:91] sc1
    v_add_u32 v16, 1024, v16
    global_store_dwordx4 v16, v[108:111], s[90:91] sc1
    v_add_u32 v16, 1024, v16
    global_store_dwordx4 v16, v[108:111], s[90:91] sc1
    v_add_u32 v16, 1024, v16
    global_store_dwordx4 v16, v[108:111], s[90:91] sc1
    v_add_u32 v16, 1024, v16
    global_store_dwordx4 v16, v[108:111], s[90:91] sc1
    v_add_u32 v16, 1024, v16
    global_store_dwordx4 v16, v[108:111], s[90:91] sc1
    v_add_u32 v16, 1024, v16
    global_store_dwordx4 v16, v[108:111], s[90:91] sc1
    v_add_u32 v16, 1024, v16
    global_store_dwordx4 v16, v[108:111], s[90:91] sc1
    v_add_u32 v16, 1024, v16
    global_store_dwordx4 v16, v[108:111], s[90:91] sc1
    v_add_u32 v16, 1024, v16
    s_branch L_recurrent_scan__compressed_kv_cla__moe_arch_mod__prompt_kernel_back_2
L_recurrent_scan__compressed_kv_cla__moe_arch_mod__prompt_kernel_rare_3:
    v_mov_b32 v19, 1
    s_mov_b64 exec, 1
    global_store_dword v118, v19, s[88:89] sc1
    s_mov_b64 exec, -1
    s_branch L_recurrent_scan__compressed_kv_cla__moe_arch_mod__prompt_kernel_back_4
L_recurrent_scan__compressed_kv_cla__moe_arch_mod__prompt_kernel_rare_5:
    v_lshrrev_b32 v3, 4, v1
    s_lshl_b32 s37, s28, 4
    v_add_u32 v19, s37, v3
    v_lshlrev_b32 v19, 13, v19
    s_lshl_b32 s37, s29, 8
    v_add_u32 v19, s37, v19
    v_and_b32 v16, 15, v1
    v_lshlrev_b32 v3, 1, v3
    v_xor_b32 v16, v16, v3
    v_lshl_add_u32 v2, v16, 4, v19
    v_add_u32 v3, 31744, v2
    v_xor_b32 v16, 8, v16
    v_lshl_add_u32 v4, v16, 4, v19
    v_add_u32 v4, 63488, v4
    v_add_u32 v5, 31744, v4
    s_mov_b32 s4, s96
    s_and_b32 s5, s97, 0xffff
    s_mov_b32 s6, 8388608
    s_mov_b32 s7, 0x20000
    s_mov_b32 s31, 0
    s_mov_b32 s40, 1048576
    s_mov_b64 s[8:9], s[4:5]
    s_mov_b32 s10, s6
    s_mov_b32 s32, 2097152
    v_mov_b32 v6, v2
    v_mov_b32 v7, v3
    v_mov_b32 v8, v4
    v_mov_b32 v9, v5
    s_branch L_recurrent_scan__compressed_kv_cla__moe_arch_mod__prompt_kernel_back_6
L_recurrent_scan__compressed_kv_cla__moe_arch_mod__prompt_kernel_w0_7:
    s_cmp_eq_u32 s35, 0
    s_cbranch_scc0 L_recurrent_scan__compressed_kv_cla__moe_arch_mod__prompt_kernel_swn_10
    v_and_b32 v16, 7, v1
    v_lshrrev_b32 v18, 3, v1
    v_mul_u32_u24 v19, 2064, v16
    v_lshl_add_u32 v19, v18, 4, v19
    s_lshl_b32 s36, s28, 8
    s_add_u32 s36, s36, 131072
    v_add_u32 v19, s36, v19
    ds_read_b128 v[120:123], v19
    ds_read_b128 v[124:127], v19 offset:128
    v_lshlrev_b32 v16, 4, v16
    v_lshl_add_u32 v16, v18, 8, v16
    s_lshr_b32 s36, s2, 1
    s_lshl_b32 s36, s36, 15
    s_and_b32 s37, s2, 1
    s_lshl_b32 s37, s37, 7
    s_add_u32 s36, s36, s37
    s_lshl_b32 s37, s28, 12
    s_add_u32 s36, s36, s37
    s_waitcnt lgkmcnt(0)
    buffer_store_dwordx4 v[120:123], v16, s[24:27], s36 offen sc1
    buffer_store_dwordx4 v[124:127], v16, s[24:27], s36 offen offset:2048 sc1
    s_waitcnt vmcnt(2)
    s_branch L_recurrent_scan__compressed_kv_cla__moe_arch_mod__prompt_kernel_swend_9
L_recurrent_scan__compressed_kv_cla__moe_arch_mod__prompt_kernel_swn_10:
    s_waitcnt vmcnt(2)
L_recurrent_scan__compressed_kv_cla__moe_arch_mod__prompt_kernel_swend_9:
    s_branch L_recurrent_scan__compressed_kv_cla__moe_arch_mod__prompt_kernel_w0b_8
L_recurrent_scan__compressed_kv_cla__moe_arch_mod__prompt_kernel_rare_13:
    s_cmp_eq_u32 s35, 0
    s_cbranch_scc0 L_recurrent_scan__compressed_kv_cla__moe_arch_mod__prompt_kernel_swn_12
    global_load_dword v116, v118, s[88:89] sc1
    s_branch L_recurrent_scan__compressed_kv_cla__moe_arch_mod__prompt_kernel_swend_11
L_recurrent_scan__compressed_kv_cla__moe_arch_mod__prompt_kernel_swn_12:
    v_and_b32 v117, 15, v1
    v_add_u32 v117, 112, v117
    v_lshlrev_b32 v117, 7, v117
    global_load_dword v116, v117, s[90:91] sc1
L_recurrent_scan__compressed_kv_cla__moe_arch_mod__prompt_kernel_swend_11:
    s_branch L_recurrent_scan__compressed_kv_cla__moe_arch_mod__prompt_kernel_back_14
L_recurrent_scan__compressed_kv_cla__moe_arch_mod__prompt_kernel_rare_19:
    s_mov_b32 s61, 0x40000
L_recurrent_scan__compressed_kv_cla__moe_arch_mod__prompt_kernel_spin_17:
    s_sub_u32 s61, s61, 1
    s_cbranch_scc1 L_recurrent_scan__compressed_kv_cla__moe_arch_mod__prompt_kernel_spinx_18
    s_sleep 8
    global_load_dword v116, v118, s[88:89] sc1
    s_waitcnt vmcnt(0)
    v_readfirstlane_b32 s36, v116
    s_nop 0
    s_cmp_lt_u32 s36, 1
    s_cbranch_scc1 L_recurrent_scan__compressed_kv_cla__moe_arch_mod__prompt_kernel_spin_17
L_recurrent_scan__compressed_kv_cla__moe_arch_mod__prompt_kernel_spinx_18:
    s_branch L_recurrent_scan__compressed_kv_cla__moe_arch_mod__prompt_kernel_back_20
L_recurrent_scan__compressed_kv_cla__moe_arch_mod__prompt_kernel_w0_15:
    s_waitcnt vmcnt(0)
    s_cmp_eq_u32 s35, 0
    s_cbranch_scc0 L_recurrent_scan__compressed_kv_cla__moe_arch_mod__prompt_kernel_swn_24
    v_readfirstlane_b32 s36, v116
    s_nop 0
    s_cmp_lt_u32 s36, 1
    s_cbranch_scc1 L_recurrent_scan__compressed_kv_cla__moe_arch_mod__prompt_kernel_rare_19
L_recurrent_scan__compressed_kv_cla__moe_arch_mod__prompt_kernel_back_20:
    s_branch L_recurrent_scan__compressed_kv_cla__moe_arch_mod__prompt_kernel_swend_23
L_recurrent_scan__compressed_kv_cla__moe_arch_mod__prompt_kernel_swn_24:
    s_mov_b32 s61, 0x40000
L_recurrent_scan__compressed_kv_cla__moe_arch_mod__prompt_kernel_lspin_21:
    v_cmp_gt_u32 vcc, 16, v116
    s_nop 0
    s_cmp_eq_u64 vcc, 0
    s_cbranch_scc1 L_recurrent_scan__compressed_kv_cla__moe_arch_mod__prompt_kernel_lspinx_22
    s_sub_u32 s61, s61, 1
    s_cbranch_scc1 L_recurrent_scan__compressed_kv_cla__moe_arch_mod__prompt_kernel_lspinx_22
    s_sleep 8
    global_load_dword v116, v117, s[90:91] sc1
    s_waitcnt vmcnt(0)
    s_branch L_recurrent_scan__compressed_kv_cla__moe_arch_mod__prompt_kernel_lspin_21
L_recurrent_scan__compressed_kv_cla__moe_arch_mod__prompt_kernel_lspinx_22:
L_recurrent_scan__compressed_kv_cla__moe_arch_mod__prompt_kernel_swend_23:
    s_branch L_recurrent_scan__compressed_kv_cla__moe_arch_mod__prompt_kernel_w0b_16
L_recurrent_scan__compressed_kv_cla__moe_arch_mod__prompt_kernel_rare_25:
    s_lshr_b32 s36, s2, 4
    s_add_u32 s36, s36, 112
    s_lshl_b32 s36, s36, 7
    v_mov_b32 v16, s36
    v_mov_b32 v19, 1
    s_mov_b64 exec, 1
    global_atomic_add v16, v19, s[90:91]
    s_mov_b64 exec, -1
    s_nop 3
    s_branch L_recurrent_scan__compressed_kv_cla__moe_arch_mod__prompt_kernel_back_26
L_recurrent_scan__compressed_kv_cla__moe_arch_mod__prompt_kernel_w0_27:
    s_cmp_eq_u32 s35, 0
    s_cbranch_scc0 L_recurrent_scan__compressed_kv_cla__moe_arch_mod__prompt_kernel_swn_30
    s_waitcnt vmcnt(2)
    s_branch L_recurrent_scan__compressed_kv_cla__moe_arch_mod__prompt_kernel_swend_29
L_recurrent_scan__compressed_kv_cla__moe_arch_mod__prompt_kernel_swn_30:
    s_waitcnt vmcnt(2)
L_recurrent_scan__compressed_kv_cla__moe_arch_mod__prompt_kernel_swend_29:
    s_branch L_recurrent_scan__compressed_kv_cla__moe_arch_mod__prompt_kernel_w0b_28
L_recurrent_scan__compressed_kv_cla__moe_arch_mod__prompt_kernel_rare_32:
    v_and_b32 v16, 7, v1
    v_lshrrev_b32 v18, 3, v1
    v_mul_u32_u24 v19, 2064, v16
    v_lshl_add_u32 v19, v18, 4, v19
    s_lshl_b32 s36, s28, 8
    s_add_u32 s36, s36, 131072
    v_add_u32 v19, s36, v19
    ds_read_b128 v[120:123], v19
    ds_read_b128 v[124:127], v19 offset:128
    v_lshlrev_b32 v16, 4, v16
    v_lshl_add_u32 v16, v18, 8, v16
    s_lshr_b32 s36, s2, 1
    s_lshl_b32 s36, s36, 15
    s_and_b32 s37, s2, 1
    s_lshl_b32 s37, s37, 7
    s_add_u32 s36, s36, s37
    s_lshl_b32 s37, s28, 12
    s_add_u32 s36, s36, s37
    s_waitcnt lgkmcnt(0)
    buffer_store_dwordx4 v[120:123], v16, s[24:27], s36 offen sc1
    buffer_store_dwordx4 v[124:127], v16, s[24:27], s36 offen offset:2048 sc1
    s_cmp_eq_u32 s28, 7
    s_cbranch_scc0 L_recurrent_scan__compressed_kv_cla__moe_arch_mod__prompt_kernel_l7_31
    v_and_b32 v120, 7, v1
    v_lshlrev_b32 v120, 3, v120
    v_add_u32 v121, 147712, v120
    ds_read_b64 v[122:123], v121
    ds_read_b32 v124, v121 offset:64
    s_lshl_b32 s36, s2, 6
    s_add_u32 s36, s36, 4194304
    s_lshl_b32 s37, s2, 3
    s_add_u32 s37, s37, 4276224
    s_waitcnt lgkmcnt(0)
    v_mov_b32 v126, v124
    s_nop 1
    v_max_u32_dpp v126, v126, v126 quad_perm:[1,0,3,2] row_mask:0xf bank_mask:0xf
    s_nop 1
    v_max_u32_dpp v126, v126, v126 quad_perm:[2,3,0,1] row_mask:0xf bank_mask:0xf
    s_nop 1
    v_max_u32_dpp v126, v126, v126 row_half_mirror row_mask:0xf bank_mask:0xf
    v_cmp_eq_u32 vcc, v126, v124
    s_nop 1
    v_cndmask_b32 v127, v124, v118, vcc
    s_nop 1
    v_max_u32_dpp v127, v127, v127 quad_perm:[1,0,3,2] row_mask:0xf bank_mask:0xf
    s_nop 1
    v_max_u32_dpp v127, v127, v127 quad_perm:[2,3,0,1] row_mask:0xf bank_mask:0xf
    s_nop 1
    v_max_u32_dpp v127, v127, v127 row_half_mirror row_mask:0xf bank_mask:0xf
    s_mov_b64 exec, 0xff
    buffer_store_dwordx2 v[122:123], v120, s[24:27], s36 offen sc1
    s_mov_b64 exec, 1
    buffer_store_dwordx2 v[126:127], v120, s[24:27], s37 offen sc1
    s_mov_b64 exec, -1
    s_nop 3
L_recurrent_scan__compressed_kv_cla__moe_arch_mod__prompt_kernel_l7_31:
    s_branch L_recurrent_scan__compressed_kv_cla__moe_arch_mod__prompt_kernel_back_33
L_recurrent_scan__compressed_kv_cla__moe_arch_mod__prompt_kernel_rare_36:
    v_lshrrev_b32 v3, 4, v1
    s_lshl_b32 s37, s28, 4
    v_add_u32 v19, s37, v3
    v_lshlrev_b32 v19, 13, v19
    s_lshl_b32 s37, s29, 8
    v_add_u32 v19, s37, v19
    v_and_b32 v16, 15, v1
    v_lshlrev_b32 v3, 1, v3
    v_xor_b32 v16, v16, v3
    v_lshl_add_u32 v2, v16, 4, v19
    v_add_u32 v3, 31744, v2
    v_xor_b32 v16, 8, v16
    v_lshl_add_u32 v4, v16, 4, v19
    v_add_u32 v4, 63488, v4
    v_add_u32 v5, 31744, v4
    s_mov_b32 s4, s96
    s_and_b32 s5, s97, 0xffff
    s_mov_b32 s6, 8388608
    s_mov_b32 s7, 0x20000
    s_mov_b32 s31, 0
    s_mov_b32 s40, 1048576
    s_mov_b64 s[8:9], s[4:5]
    s_mov_b32 s10, s6
    s_mov_b32 s32, 2097152
    v_mov_b32 v6, v2
    v_mov_b32 v7, v3
    v_mov_b32 v8, v4
    v_mov_b32 v9, v5
    s_branch L_recurrent_scan__compressed_kv_cla__moe_arch_mod__prompt_kernel_back_37
L_recurrent_scan__compressed_kv_cla__moe_arch_mod__prompt_kernel_rare_42:
    s_mov_b32 s61, 0x40000
L_recurrent_scan__compressed_kv_cla__moe_arch_mod__prompt_kernel_spin_40:
    s_sub_u32 s61, s61, 1
    s_cbranch_scc1 L_recurrent_scan__compressed_kv_cla__moe_arch_mod__prompt_kernel_spinx_41
    s_sleep 8
    global_load_dword v56, v57, s[90:91] sc1
    s_waitcnt vmcnt(0)
    v_readfirstlane_b32 s36, v56
    s_nop 0
    s_cmp_lt_u32 s36, 1
    s_cbranch_scc1 L_recurrent_scan__compressed_kv_cla__moe_arch_mod__prompt_kernel_spin_40
L_recurrent_scan__compressed_kv_cla__moe_arch_mod__prompt_kernel_spinx_41:
    s_branch L_recurrent_scan__compressed_kv_cla__moe_arch_mod__prompt_kernel_back_43
L_recurrent_scan__compressed_kv_cla__moe_arch_mod__prompt_kernel_rare_45:
    s_cmp_eq_u32 s28, 0
    s_cbranch_scc0 L_recurrent_scan__compressed_kv_cla__moe_arch_mod__prompt_kernel_g_44
    s_waitcnt vmcnt(13)
    v_readfirstlane_b32 s36, v56
    s_nop 0
    s_cmp_lt_u32 s36, 1
    s_cbranch_scc1 L_recurrent_scan__compressed_kv_cla__moe_arch_mod__prompt_kernel_rare_42
L_recurrent_scan__compressed_kv_cla__moe_arch_mod__prompt_kernel_back_43:
L_recurrent_scan__compressed_kv_cla__moe_arch_mod__prompt_kernel_g_44:
    s_branch L_recurrent_scan__compressed_kv_cla__moe_arch_mod__prompt_kernel_back_46
L_recurrent_scan__compressed_kv_cla__moe_arch_mod__prompt_kernel_rare_47:
    s_cmp_eq_u32 s28, 0
    s_cbranch_scc0 L_recurrent_scan__compressed_kv_cla__moe_arch_mod__prompt_kernel_g_39
    s_add_u32 s36, s29, 64
    s_lshl_b32 s36, s36, 7
    v_mov_b32 v57, s36
    global_load_dword v56, v57, s[90:91] sc1
L_recurrent_scan__compressed_kv_cla__moe_arch_mod__prompt_kernel_g_39:
    s_branch L_recurrent_scan__compressed_kv_cla__moe_arch_mod__prompt_kernel_back_48
L_recurrent_scan__compressed_kv_cla__moe_arch_mod__prompt_kernel_rare_51:
    s_cmp_eq_u32 s35, 2
    s_cbranch_scc0 L_recurrent_scan__compressed_kv_cla__moe_arch_mod__prompt_kernel_swn_50
    s_mov_b32 s6, 0
    s_mov_b32 s34, 0x30000
    s_mov_b32 s41, 0x37fff
    s_lshl_b32 s36, s30, 3
    s_add_u32 s36, s28, s36
    s_cmp_eq_u32 s36, 4
    s_cbranch_scc0 L_recurrent_scan__compressed_kv_cla__moe_arch_mod__prompt_kernel_g_38
    s_add_u32 s36, s29, 64
    s_lshl_b32 s36, s36, 7
    v_mov_b32 v62, s36
    v_mov_b32 v63, 1
    s_mov_b64 exec, 1
    global_atomic_add v62, v63, s[90:91]
    s_mov_b64 exec, -1
    s_nop 3
L_recurrent_scan__compressed_kv_cla__moe_arch_mod__prompt_kernel_g_38:
    s_branch L_recurrent_scan__compressed_kv_cla__moe_arch_mod__prompt_kernel_swend_49
L_recurrent_scan__compressed_kv_cla__moe_arch_mod__prompt_kernel_swn_50:
    s_mov_b64 s[4:5], s[12:13]
    s_mov_b32 s6, s14
    s_mov_b32 s31, s45
    s_mov_b32 s40, 32768
    s_mov_b32 s34, s33
    v_add_u32 v2, s33, v58
    v_mov_b32 v3, v2
    v_mov_b32 v4, v2
    v_mov_b32 v5, v2
L_recurrent_scan__compressed_kv_cla__moe_arch_mod__prompt_kernel_swend_49:
    s_branch L_recurrent_scan__compressed_kv_cla__moe_arch_mod__prompt_kernel_back_52
L_recurrent_scan__compressed_kv_cla__moe_arch_mod__prompt_kernel_rare_53:
    s_branch L_recurrent_scan__compressed_kv_cla__moe_arch_mod__prompt_kernel_back_54
L_recurrent_scan__compressed_kv_cla__moe_arch_mod__prompt_kernel_rare_55:
    s_lshl_b32 s36, s39, 1
    s_add_u32 s36, s36, s38
    s_add_u32 s37, s36, s39
    buffer_store_dwordx4 v[160:163], v58, s[16:19], s36 offen sc1
    buffer_store_dwordx4 v[164:167], v59, s[16:19], s36 offen sc1
    buffer_store_dwordx4 v[168:171], v60, s[16:19], s36 offen sc1
    buffer_store_dwordx4 v[172:175], v61, s[16:19], s36 offen sc1
    buffer_store_dwordx4 v[176:179], v58, s[16:19], s37 offen sc1
    buffer_store_dwordx4 v[180:183], v59, s[16:19], s37 offen sc1
    buffer_store_dwordx4 v[184:187], v60, s[16:19], s37 offen sc1
    buffer_store_dwordx4 v[188:191], v61, s[16:19], s37 offen sc1
    s_branch L_recurrent_scan__compressed_kv_cla__moe_arch_mod__prompt_kernel_back_56
L_recurrent_scan__compressed_kv_cla__moe_arch_mod__prompt_kernel_rare_57:
    s_lshl_b32 s36, s29, 7
    v_mov_b32 v13, s36
    global_load_dword v14, v13, s[90:91] sc1
    s_branch L_recurrent_scan__compressed_kv_cla__moe_arch_mod__prompt_kernel_back_58
L_recurrent_scan__compressed_kv_cla__moe_arch_mod__prompt_kernel_rare_63:
    s_mov_b32 s41, 32768
    s_cmp_eq_u32 s40, 15
    s_cbranch_scc0 L_recurrent_scan__compressed_kv_cla__moe_arch_mod__prompt_kernel_r_59
    s_mov_b32 s41, 65536
    s_mov_b32 s49, 0x1ffff
    s_sub_u32 s36, 0, s50
    s_cmp_lt_i32 s36, 0
    s_cbranch_scc1 L_recurrent_scan__compressed_kv_cla__moe_arch_mod__prompt_kernel_nm_62
    v_mov_b32 v20, 4048155338
    v_subrev_u32 v21, s36, v18
    v_cmp_gt_i32 s[20:21], 0, v21
    v_cmp_gt_i32 s[22:23], 1, v21
    v_cmp_gt_i32 s[62:63], 2, v21
    v_cmp_gt_i32 vcc, 3, v21
    v_cndmask_b32 v96, v96, v20, s[20:21]
    v_cndmask_b32 v97, v97, v20, s[22:23]
    v_cndmask_b32 v98, v98, v20, s[62:63]
    v_cndmask_b32 v99, v99, v20, vcc
    v_cmp_gt_i32 s[20:21], 16, v21
    v_cmp_gt_i32 s[22:23], 17, v21
    v_cmp_gt_i32 s[62:63], 18, v21
    v_cmp_gt_i32 vcc, 19, v21
    v_cndmask_b32 v100, v100, v20, s[20:21]
    v_cndmask_b32 v101, v101, v20, s[22:23]
    v_cndmask_b32 v102, v102, v20, s[62:63]
    v_cndmask_b32 v103, v103, v20, vcc
    v_cmp_gt_i32 s[20:21], -16, v21
    v_cmp_gt_i32 s[22:23], -15, v21
    v_cmp_gt_i32 s[62:63], -14, v21
    v_cmp_gt_i32 vcc, -13, v21
    v_cndmask_b32 v104, v104, v20, s[20:21]
    v_cndmask_b32 v105, v105, v20, s[22:23]
    v_cndmask_b32 v106, v106, v20, s[62:63]
    v_cndmask_b32 v107, v107, v20, vcc
    v_cmp_gt_i32 s[20:21], 0, v21
    v_cmp_gt_i32 s[22:23], 1, v21
    v_cmp_gt_i32 s[62:63], 2, v21
    v_cmp_gt_i32 vcc, 3, v21
    v_cndmask_b32 v108, v108, v20, s[20:21]
    v_cndmask_b32 v109, v109, v20, s[22:23]
    v_cndmask_b32 v110, v110, v20, s[62:63]
    v_cndmask_b32 v111, v111, v20, vcc
L_recurrent_scan__compressed_kv_cla__moe_arch_mod__prompt_kernel_nm_62:
L_recurrent_scan__compressed_kv_cla__moe_arch_mod__prompt_kernel_r_59:
    s_branch L_recurrent_scan__compressed_kv_cla__moe_arch_mod__prompt_kernel_back_64
L_recurrent_scan__compressed_kv_cla__moe_arch_mod__prompt_kernel_rare_73:
    s_mov_b32 s61, 0x40000
L_recurrent_scan__compressed_kv_cla__moe_arch_mod__prompt_kernel_spin_71:
    s_sub_u32 s61, s61, 1
    s_cbranch_scc1 L_recurrent_scan__compressed_kv_cla__moe_arch_mod__prompt_kernel_spinx_72
    s_sleep 8
    global_load_dword v14, v13, s[90:91] sc1
    s_waitcnt vmcnt(0)
    v_readfirstlane_b32 s36, v14
    s_nop 0
    s_cmp_lt_u32 s36, 7
    s_cbranch_scc1 L_recurrent_scan__compressed_kv_cla__moe_arch_mod__prompt_kernel_spin_71
L_recurrent_scan__compressed_kv_cla__moe_arch_mod__prompt_kernel_spinx_72:
    s_branch L_recurrent_scan__compressed_kv_cla__moe_arch_mod__prompt_kernel_back_74
L_recurrent_scan__compressed_kv_cla__moe_arch_mod__prompt_kernel_rare_79:
    s_cmp_eq_u32 s40, 1
    s_cbranch_scc0 L_recurrent_scan__compressed_kv_cla__moe_arch_mod__prompt_kernel_swn_76
    v_readfirstlane_b32 s36, v14
    s_nop 0
    s_cmp_lt_u32 s36, 7
    s_cbranch_scc1 L_recurrent_scan__compressed_kv_cla__moe_arch_mod__prompt_kernel_rare_73
L_recurrent_scan__compressed_kv_cla__moe_arch_mod__prompt_kernel_back_74:
    s_branch L_recurrent_scan__compressed_kv_cla__moe_arch_mod__prompt_kernel_swend_75
L_recurrent_scan__compressed_kv_cla__moe_arch_mod__prompt_kernel_swn_76:
    s_cmp_eq_u32 s40, 2
    s_cbranch_scc0 L_recurrent_scan__compressed_kv_cla__moe_arch_mod__prompt_kernel_swn_77
    s_mov_b32 s36, 4276224
    buffer_load_dwordx4 v[160:163], v7, s[24:27], s36 offen offset:0 sc1
    buffer_load_dwordx4 v[164:167], v7, s[24:27], s36 offen offset:1024 sc1
    s_branch L_recurrent_scan__compressed_kv_cla__moe_arch_mod__prompt_kernel_swend_75
L_recurrent_scan__compressed_kv_cla__moe_arch_mod__prompt_kernel_swn_77:
    s_cmp_eq_u32 s40, 3
    s_cbranch_scc0 L_recurrent_scan__compressed_kv_cla__moe_arch_mod__prompt_kernel_swn_78
    v_max_u32 v24, v160, v161
    v_min_u32 v25, v160, v161
    v_med3_u32 v25, v24, v25, v162
    v_max_u32 v24, v24, v162
    v_med3_u32 v25, v24, v25, v163
    v_max_u32 v24, v24, v163
    v_med3_u32 v25, v24, v25, v164
    v_max_u32 v24, v24, v164
    v_med3_u32 v25, v24, v25, v165
    v_max_u32 v24, v24, v165
    v_med3_u32 v25, v24, v25, v166
    v_max_u32 v24, v24, v166
    v_med3_u32 v25, v24, v25, v167
    v_max_u32 v24, v24, v167
    v_mov_b32 v26, v24
    s_nop 1
    v_max_u32_dpp v26, v26, v26 quad_perm:[1,0,3,2] row_mask:0xf bank_mask:0xf
    s_nop 1
    v_max_u32_dpp v26, v26, v26 quad_perm:[2,3,0,1] row_mask:0xf bank_mask:0xf
    s_nop 1
    v_max_u32_dpp v26, v26, v26 row_half_mirror row_mask:0xf bank_mask:0xf
    s_nop 1
    v_max_u32_dpp v26, v26, v26 row_mirror row_mask:0xf bank_mask:0xf
    s_nop 0
    v_readlane_b32 s20, v26, 0
    v_readlane_b32 s21, v26, 16
    v_readlane_b32 s22, v26, 32
    v_readlane_b32 s23, v26, 48
    s_max_u32 s20, s20, s21
    s_max_u32 s22, s22, s23
    s_max_u32 s20, s20, s22
    s_mov_b32 s58, s20
    v_cmp_eq_u32 vcc, s58, v24
    s_nop 1
    v_cndmask_b32 v26, v24, v25, vcc
    s_nop 1
    v_max_u32_dpp v26, v26, v26 quad_perm:[1,0,3,2] row_mask:0xf bank_mask:0xf
    s_nop 1
    v_max_u32_dpp v26, v26, v26 quad_perm:[2,3,0,1] row_mask:0xf bank_mask:0xf
    s_nop 1
    v_max_u32_dpp v26, v26, v26 row_half_mirror row_mask:0xf bank_mask:0xf
    s_nop 1
    v_max_u32_dpp v26, v26, v26 row_mirror row_mask:0xf bank_mask:0xf
    s_nop 0
    v_readlane_b32 s20, v26, 0
    v_readlane_b32 s21, v26, 16
    v_readlane_b32 s22, v26, 32
    v_readlane_b32 s23, v26, 48
    s_max_u32 s20, s20, s21
    s_max_u32 s22, s22, s23
    s_max_u32 s20, s20, s22
    s_mov_b32 s59, s20
    s_and_b32 s36, s58, 0xffff
    s_sub_u32 s56, 0xffff, s36
    s_and_b32 s36, s59, 0xffff
    s_sub_u32 s57, 0xffff, s36
    v_and_b32 v24, 1, v1
    v_mov_b32 v25, s56
    v_mov_b32 v26, s57
    v_cmp_eq_u32 vcc, 1, v24
    s_nop 1
    v_cndmask_b32 v25, v25, v26, vcc
    v_lshrrev_b32 v26, 4, v25
    v_lshlrev_b32 v26, 15, v26
    v_and_b32 v25, 15, v25
    v_lshl_add_u32 v26, v25, 4, v26
    v_lshrrev_b32 v27, 4, v1
    v_lshl_add_u32 v26, v27, 8, v26
    s_and_b32 s36, s3, 3
    s_lshl_b32 s36, s36, 13
    s_add_u32 s37, s36, 4096
    s_mov_b32 exec_lo, 0x00030003
    s_mov_b32 exec_hi, 0x00030003
    buffer_load_dwordx4 v[160:163], v26, s[24:27], s36 offen offset:0 sc1
    buffer_load_dwordx4 v[164:167], v26, s[24:27], s36 offen offset:1024 sc1
    buffer_load_dwordx4 v[168:171], v26, s[24:27], s36 offen offset:2048 sc1
    buffer_load_dwordx4 v[172:175], v26, s[24:27], s36 offen offset:3072 sc1
    buffer_load_dwordx4 v[176:179], v26, s[24:27], s37 offen offset:0 sc1
    buffer_load_dwordx4 v[180:183], v26, s[24:27], s37 offen offset:1024 sc1
    buffer_load_dwordx4 v[184:187], v26, s[24:27], s37 offen offset:2048 sc1
    buffer_load_dwordx4 v[188:191], v26, s[24:27], s37 offen offset:3072 sc1
    s_mov_b64 exec, -1
    s_branch L_recurrent_scan__compressed_kv_cla__moe_arch_mod__prompt_kernel_swend_75
L_recurrent_scan__compressed_kv_cla__moe_arch_mod__prompt_kernel_swn_78:
    s_sub_u32 s38, s40, s60
    s_cmp_eq_u32 s38, 0
    s_cbranch_scc0 L_recurrent_scan__compressed_kv_cla__moe_arch_mod__prompt_kernel_swn_67
    s_and_b32 s20, s3, 3
    s_lshl_b32 s20, s20, 8
    s_lshl_b32 s21, s28, 5
    s_add_u32 s20, s20, s21
    s_lshr_b32 s21, s3, 2
    s_lshl_b32 s21, s21, 7
    v_lshrrev_b32 v25, 3, v1
    s_lshl_b32 s36, s28, 5
    s_add_u32 s36, s36, s20
    v_add_u32 v25, s36, v25
    v_mul_u32_u24 v25, 7168, v25
    v_add_u32 v25, s21, v25
    v_bfe_u32 v26, v1, 4, 1
    v_lshlrev_b32 v26, 1, v26
    v_and_b32 v27, 7, v1
    v_xor_b32 v26, v26, v27
    v_lshl_add_u32 v24, v26, 4, v25
    v_xor_b32 v26, 4, v26
    v_lshl_add_u32 v25, v26, 4, v25
    v_add_u32 v25, 56320, v25
    v_add_u32 v26, 112640, v24
    v_add_u32 v27, 112640, v25
    s_lshl_b32 s36, s28, 13
    s_add_u32 m0, s36, 131072
    s_mov_b32 s37, 229376
    buffer_load_dwordx4 v24, s[4:7], 0 offen offset:0 nt lds
    buffer_load_dwordx4 v25, s[4:7], 0 offen offset:1024 nt lds
    buffer_load_dwordx4 v26, s[4:7], 0 offen offset:2048 nt lds
    buffer_load_dwordx4 v27, s[4:7], 0 offen offset:3072 nt lds
    s_add_u32 m0, s36, 135168
    s_nop 0
    buffer_load_dwordx4 v24, s[4:7], s37 offen offset:0 nt lds
    buffer_load_dwordx4 v25, s[4:7], s37 offen offset:1024 nt lds
    buffer_load_dwordx4 v26, s[4:7], s37 offen offset:2048 nt lds
    buffer_load_dwordx4 v27, s[4:7], s37 offen offset:3072 nt lds
    s_branch L_recurrent_scan__compressed_kv_cla__moe_arch_mod__prompt_kernel_swend_66
L_recurrent_scan__compressed_kv_cla__moe_arch_mod__prompt_kernel_swn_67:
    s_cmp_eq_u32 s38, 2
    s_cbranch_scc0 L_recurrent_scan__compressed_kv_cla__moe_arch_mod__prompt_kernel_swn_68
    v_lshrrev_b32 v8, 4, v1
    v_bfe_u32 v5, v1, 2, 2
    v_lshl_add_u32 v5, v8, 3, v5
    v_lshlrev_b32 v5, 7, v5
    v_and_b32 v9, 3, v1
    v_lshl_add_u32 v5, v9, 3, v5
    v_bfe_u32 v9, v1, 3, 2
    v_xor_b32 v9, s28, v9
    v_lshl_add_u32 v5, v9, 5, v5
    v_add_u32 v5, 131072, v5
    ds_read_b64_tr_b16 v[14:15], v5 offset:0
    ds_read_b64_tr_b16 v[16:17], v5 offset:512
    ds_read_b64_tr_b16 v[20:21], v5 offset:4096
    ds_read_b64_tr_b16 v[22:23], v5 offset:4608
    ds_read_b64_tr_b16 v[24:25], v5 offset:8192
    ds_read_b64_tr_b16 v[26:27], v5 offset:8704
    s_and_b32 s36, s3, 3
    s_lshl_b32 s36, s36, 6
    s_lshr_b32 s37, s3, 2
    s_lshl_b32 s37, s37, 12
    s_add_u32 s36, s36, s37
    s_lshl_b32 s37, s28, 10
    s_add_u32 s36, s36, s37
    s_add_u32 s36, s36, 58720256
    v_and_b32 v9, 1, v1
    v_lshlrev_b32 v9, 4, v9
    v_lshl_add_u32 v9, v8, 8, v9
    s_waitcnt lgkmcnt(4)
    v_mfma_f32_16x16x32_bf16 v[10:13], v[14:17], v[160:163], 0
    ds_read_b64_tr_b16 v[14:15], v5 offset:12288
    ds_read_b64_tr_b16 v[16:17], v5 offset:12800
    s_waitcnt lgkmcnt(4)
    v_mfma_f32_16x16x32_bf16 v[10:13], v[20:23], v[164:167], v[10:13]
    ds_read_b64_tr_b16 v[20:21], v5 offset:16384
    ds_read_b64_tr_b16 v[22:23], v5 offset:16896
    s_waitcnt lgkmcnt(4)
    v_mfma_f32_16x16x32_bf16 v[10:13], v[24:27], v[168:171], v[10:13]
    ds_read_b64_tr_b16 v[24:25], v5 offset:20480
    ds_read_b64_tr_b16 v[26:27], v5 offset:20992
    s_waitcnt lgkmcnt(4)
    v_mfma_f32_16x16x32_bf16 v[10:13], v[14:17], v[172:175], v[10:13]
    ds_read_b64_tr_b16 v[14:15], v5 offset:24576
    ds_read_b64_tr_b16 v[16:17], v5 offset:25088
    s_waitcnt lgkmcnt(4)
    v_mfma_f32_16x16x32_bf16 v[10:13], v[20:23], v[176:179], v[10:13]
    ds_read_b64_tr_b16 v[20:21], v5 offset:28672
    ds_read_b64_tr_b16 v[22:23], v5 offset:29184
    s_waitcnt lgkmcnt(4)
    v_mfma_f32_16x16x32_bf16 v[10:13], v[24:27], v[180:183], v[10:13]
    s_waitcnt lgkmcnt(2)
    v_mfma_f32_16x16x32_bf16 v[10:13], v[14:17], v[184:187], v[10:13]
    s_waitcnt lgkmcnt(0)
    v_mfma_f32_16x16x32_bf16 v[10:13], v[20:23], v[188:191], v[10:13]
    s_nop 5
    s_mov_b32 exec_lo, 0x00030003
    s_mov_b32 exec_hi, 0x00030003
    buffer_store_dwordx4 v[10:13], v9, s[24:27], s36 offen sc1
    s_mov_b64 exec, -1
    s_nop 1
    s_branch L_recurrent_scan__compressed_kv_cla__moe_arch_mod__prompt_kernel_swend_66
L_recurrent_scan__compressed_kv_cla__moe_arch_mod__prompt_kernel_swn_68:
    s_cmp_eq_u32 s38, 3
    s_cbranch_scc0 L_recurrent_scan__compressed_kv_cla__moe_arch_mod__prompt_kernel_swn_69
    s_and_b32 s20, s3, 3
    s_lshl_b32 s20, s20, 8
    s_lshl_b32 s21, s28, 5
    s_add_u32 s20, s20, s21
    s_lshr_b32 s21, s3, 2
    s_lshl_b32 s21, s21, 7
    v_lshrrev_b32 v25, 3, v1
    s_lshl_b32 s36, s28, 5
    s_add_u32 s36, s36, s20
    v_add_u32 v25, s36, v25
    v_mul_u32_u24 v25, 7168, v25
    v_add_u32 v25, s21, v25
    v_bfe_u32 v26, v1, 4, 1
    v_lshlrev_b32 v26, 1, v26
    v_and_b32 v27, 7, v1
    v_xor_b32 v26, v26, v27
    v_lshl_add_u32 v24, v26, 4, v25
    v_xor_b32 v26, 4, v26
    v_lshl_add_u32 v25, v26, 4, v25
    v_add_u32 v25, 56320, v25
    v_add_u32 v26, 112640, v24
    v_add_u32 v27, 112640, v25
    s_lshl_b32 s36, s28, 13
    s_add_u32 m0, s36, 131072
    s_mov_b32 s37, 229376
    buffer_load_dwordx4 v24, s[8:11], 0 offen offset:0 nt lds
    buffer_load_dwordx4 v25, s[8:11], 0 offen offset:1024 nt lds
    buffer_load_dwordx4 v26, s[8:11], 0 offen offset:2048 nt lds
    buffer_load_dwordx4 v27, s[8:11], 0 offen offset:3072 nt lds
    s_add_u32 m0, s36, 135168
    s_nop 0
    buffer_load_dwordx4 v24, s[8:11], s37 offen offset:0 nt lds
    buffer_load_dwordx4 v25, s[8:11], s37 offen offset:1024 nt lds
    buffer_load_dwordx4 v26, s[8:11], s37 offen offset:2048 nt lds
    buffer_load_dwordx4 v27, s[8:11], s37 offen offset:3072 nt lds
    s_branch L_recurrent_scan__compressed_kv_cla__moe_arch_mod__prompt_kernel_swend_66
L_recurrent_scan__compressed_kv_cla__moe_arch_mod__prompt_kernel_swn_69:
    s_cmp_eq_u32 s38, 5
    s_cbranch_scc0 L_recurrent_scan__compressed_kv_cla__moe_arch_mod__prompt_kernel_swn_70
    v_lshrrev_b32 v8, 4, v1
    v_bfe_u32 v5, v1, 2, 2
    v_lshl_add_u32 v5, v8, 3, v5
    v_lshlrev_b32 v5, 7, v5
    v_and_b32 v9, 3, v1
    v_lshl_add_u32 v5, v9, 3, v5
    v_bfe_u32 v9, v1, 3, 2
    v_xor_b32 v9, s28, v9
    v_lshl_add_u32 v5, v9, 5, v5
    v_add_u32 v5, 131072, v5
    ds_read_b64_tr_b16 v[14:15], v5 offset:0
    ds_read_b64_tr_b16 v[16:17], v5 offset:512
    ds_read_b64_tr_b16 v[20:21], v5 offset:4096
    ds_read_b64_tr_b16 v[22:23], v5 offset:4608
    ds_read_b64_tr_b16 v[24:25], v5 offset:8192
    ds_read_b64_tr_b16 v[26:27], v5 offset:8704
    s_and_b32 s36, s3, 3
    s_lshl_b32 s36, s36, 6
    s_lshr_b32 s37, s3, 2
    s_lshl_b32 s37, s37, 12
    s_add_u32 s36, s36, s37
    s_lshl_b32 s37, s28, 10
    s_add_u32 s36, s36, s37
    s_add_u32 s36, s36, 58720288
    v_and_b32 v9, 1, v1
    v_lshlrev_b32 v9, 4, v9
    v_lshl_add_u32 v9, v8, 8, v9
    s_waitcnt lgkmcnt(4)
    v_mfma_f32_16x16x32_bf16 v[10:13], v[14:17], v[160:163], 0
    ds_read_b64_tr_b16 v[14:15], v5 offset:12288
    ds_read_b64_tr_b16 v[16:17], v5 offset:12800
    s_waitcnt lgkmcnt(4)
    v_mfma_f32_16x16x32_bf16 v[10:13], v[20:23], v[164:167], v[10:13]
    ds_read_b64_tr_b16 v[20:21], v5 offset:16384
    ds_read_b64_tr_b16 v[22:23], v5 offset:16896
    s_waitcnt lgkmcnt(4)
    v_mfma_f32_16x16x32_bf16 v[10:13], v[24:27], v[168:171], v[10:13]
    ds_read_b64_tr_b16 v[24:25], v5 offset:20480
    ds_read_b64_tr_b16 v[26:27], v5 offset:20992
    s_waitcnt lgkmcnt(4)
    v_mfma_f32_16x16x32_bf16 v[10:13], v[14:17], v[172:175], v[10:13]
    ds_read_b64_tr_b16 v[14:15], v5 offset:24576
    ds_read_b64_tr_b16 v[16:17], v5 offset:25088
    s_waitcnt lgkmcnt(4)
    v_mfma_f32_16x16x32_bf16 v[10:13], v[20:23], v[176:179], v[10:13]
    ds_read_b64_tr_b16 v[20:21], v5 offset:28672
    ds_read_b64_tr_b16 v[22:23], v5 offset:29184
    s_waitcnt lgkmcnt(4)
    v_mfma_f32_16x16x32_bf16 v[10:13], v[24:27], v[180:183], v[10:13]
    s_waitcnt lgkmcnt(2)
    v_mfma_f32_16x16x32_bf16 v[10:13], v[14:17], v[184:187], v[10:13]
    s_waitcnt lgkmcnt(0)
    v_mfma_f32_16x16x32_bf16 v[10:13], v[20:23], v[188:191], v[10:13]
    s_nop 5
    s_mov_b32 exec_lo, 0x00030003
    s_mov_b32 exec_hi, 0x00030003
    buffer_store_dwordx4 v[10:13], v9, s[24:27], s36 offen sc1
    s_mov_b64 exec, -1
    s_nop 1
    s_branch L_recurrent_scan__compressed_kv_cla__moe_arch_mod__prompt_kernel_swend_66
L_recurrent_scan__compressed_kv_cla__moe_arch_mod__prompt_kernel_swn_70:
    s_mul_i32 s36, s3, 2341
    s_lshr_b32 s36, s36, 16
    s_add_u32 s36, s36, 48
    s_lshl_b32 s36, s36, 7
    v_mov_b32 v20, s36
    v_mov_b32 v21, 1
    s_mov_b64 exec, 1
    global_atomic_add v20, v21, s[90:91]
    s_mov_b64 exec, -1
    s_nop 3
L_recurrent_scan__compressed_kv_cla__moe_arch_mod__prompt_kernel_swend_66:
L_recurrent_scan__compressed_kv_cla__moe_arch_mod__prompt_kernel_swend_75:
    s_branch L_recurrent_scan__compressed_kv_cla__moe_arch_mod__prompt_kernel_back_80
L_recurrent_scan__compressed_kv_cla__moe_arch_mod__prompt_kernel_rare_89:
    v_mov_b32 v20, 4048155338
    v_subrev_u32 v21, s36, v18
    v_cmp_gt_i32 s[20:21], 0, v21
    v_cmp_gt_i32 s[22:23], 1, v21
    v_cmp_gt_i32 s[62:63], 2, v21
    v_cmp_gt_i32 vcc, 3, v21
    v_cndmask_b32 v112, v112, v20, s[20:21]
    v_cndmask_b32 v113, v113, v20, s[22:23]
    v_cndmask_b32 v114, v114, v20, s[62:63]
    v_cndmask_b32 v115, v115, v20, vcc
    v_cmp_gt_i32 s[20:21], 16, v21
    v_cmp_gt_i32 s[22:23], 17, v21
    v_cmp_gt_i32 s[62:63], 18, v21
    v_cmp_gt_i32 vcc, 19, v21
    v_cndmask_b32 v116, v116, v20, s[20:21]
    v_cndmask_b32 v117, v117, v20, s[22:23]
    v_cndmask_b32 v118, v118, v20, s[62:63]
    v_cndmask_b32 v119, v119, v20, vcc
    v_cmp_gt_i32 s[20:21], -16, v21
    v_cmp_gt_i32 s[22:23], -15, v21
    v_cmp_gt_i32 s[62:63], -14, v21
    v_cmp_gt_i32 vcc, -13, v21
    v_cndmask_b32 v120, v120, v20, s[20:21]
    v_cndmask_b32 v121, v121, v20, s[22:23]
    v_cndmask_b32 v122, v122, v20, s[62:63]
    v_cndmask_b32 v123, v123, v20, vcc
    v_cmp_gt_i32 s[20:21], 0, v21
    v_cmp_gt_i32 s[22:23], 1, v21
    v_cmp_gt_i32 s[62:63], 2, v21
    v_cmp_gt_i32 vcc, 3, v21
    v_cndmask_b32 v124, v124, v20, s[20:21]
    v_cndmask_b32 v125, v125, v20, s[22:23]
    v_cndmask_b32 v126, v126, v20, s[62:63]
    v_cndmask_b32 v127, v127, v20, vcc
    s_branch L_recurrent_scan__compressed_kv_cla__moe_arch_mod__prompt_kernel_back_90
L_recurrent_scan__compressed_kv_cla__moe_arch_mod__prompt_kernel_rare_93:
    s_mov_b32 s61, 0x40000
L_recurrent_scan__compressed_kv_cla__moe_arch_mod__prompt_kernel_spin_91:
    s_sub_u32 s61, s61, 1
    s_cbranch_scc1 L_recurrent_scan__compressed_kv_cla__moe_arch_mod__prompt_kernel_spinx_92
    s_sleep 8
    global_load_dword v11, v12, s[90:91] sc1
    s_waitcnt vmcnt(0)
    v_readfirstlane_b32 s36, v11
    s_nop 0
    s_cmp_lt_u32 s36, 28
    s_cbranch_scc1 L_recurrent_scan__compressed_kv_cla__moe_arch_mod__prompt_kernel_spin_91
L_recurrent_scan__compressed_kv_cla__moe_arch_mod__prompt_kernel_spinx_92:
    s_branch L_recurrent_scan__compressed_kv_cla__moe_arch_mod__prompt_kernel_back_94
L_recurrent_scan__compressed_kv_cla__moe_arch_mod__prompt_kernel_rare_98:
    v_mov_b32 v20, 4048155338
    v_subrev_u32 v21, s50, v18
    v_cmp_gt_i32 s[20:21], 0, v21
    v_cmp_gt_i32 s[22:23], 1, v21
    v_cmp_gt_i32 s[62:63], 2, v21
    v_cmp_gt_i32 vcc, 3, v21
    v_cndmask_b32 v96, v96, v20, s[20:21]
    v_cndmask_b32 v97, v97, v20, s[22:23]
    v_cndmask_b32 v98, v98, v20, s[62:63]
    v_cndmask_b32 v99, v99, v20, vcc
    v_cmp_gt_i32 s[20:21], 16, v21
    v_cmp_gt_i32 s[22:23], 17, v21
    v_cmp_gt_i32 s[62:63], 18, v21
    v_cmp_gt_i32 vcc, 19, v21
    v_cndmask_b32 v100, v100, v20, s[20:21]
    v_cndmask_b32 v101, v101, v20, s[22:23]
    v_cndmask_b32 v102, v102, v20, s[62:63]
    v_cndmask_b32 v103, v103, v20, vcc
    v_cmp_gt_i32 s[20:21], -16, v21
    v_cmp_gt_i32 s[22:23], -15, v21
    v_cmp_gt_i32 s[62:63], -14, v21
    v_cmp_gt_i32 vcc, -13, v21
    v_cndmask_b32 v104, v104, v20, s[20:21]
    v_cndmask_b32 v105, v105, v20, s[22:23]
    v_cndmask_b32 v106, v106, v20, s[62:63]
    v_cndmask_b32 v107, v107, v20, vcc
    v_cmp_gt_i32 s[20:21], 0, v21
    v_cmp_gt_i32 s[22:23], 1, v21
    v_cmp_gt_i32 s[62:63], 2, v21
    v_cmp_gt_i32 vcc, 3, v21
    v_cndmask_b32 v108, v108, v20, s[20:21]
    v_cndmask_b32 v109, v109, v20, s[22:23]
    v_cndmask_b32 v110, v110, v20, s[62:63]
    v_cndmask_b32 v111, v111, v20, vcc
    s_branch L_recurrent_scan__compressed_kv_cla__moe_arch_mod__prompt_kernel_back_99
L_grp1:
    v_mov_b32 v20, 1040356334
    v_mov_b32 v21, v20
    s_and_b32 s37, s28, 3
    s_lshl_b32 s37, s37, 13
    v_lshlrev_b32 v7, 4, v1
    v_add_u32 v4, s37, v7
    v_add_u32 v19, 131072, v4
    v_add_u32 v6, 4096, v4
    s_add_u32 s43, s37, 32768
    s_add_u32 s44, s37, 98304
    s_waitcnt vmcnt(4) lgkmcnt(0)
    v_pk_mul_f32 v[192:193], v[192:193], v[20:21]
    v_pk_mul_f32 v[194:195], v[194:195], v[20:21]
    v_pk_mul_f32 v[196:197], v[196:197], v[20:21]
    v_pk_mul_f32 v[198:199], v[198:199], v[20:21]
    v_cvt_pk_bf16_f32 v128, v192, v193
    v_cvt_pk_bf16_f32 v129, v194, v195
    v_cvt_pk_bf16_f32 v130, v196, v197
    v_cvt_pk_bf16_f32 v131, v198, v199
    v_pk_mul_f32 v[200:201], v[200:201], v[20:21]
    v_pk_mul_f32 v[202:203], v[202:203], v[20:21]
    v_pk_mul_f32 v[204:205], v[204:205], v[20:21]
    v_pk_mul_f32 v[206:207], v[206:207], v[20:21]
    v_cvt_pk_bf16_f32 v132, v200, v201
    v_cvt_pk_bf16_f32 v133, v202, v203
    v_cvt_pk_bf16_f32 v134, v204, v205
    v_cvt_pk_bf16_f32 v135, v206, v207
    v_pk_mul_f32 v[208:209], v[208:209], v[20:21]
    v_pk_mul_f32 v[210:211], v[210:211], v[20:21]
    v_pk_mul_f32 v[212:213], v[212:213], v[20:21]
    v_pk_mul_f32 v[214:215], v[214:215], v[20:21]
    v_cvt_pk_bf16_f32 v136, v208, v209
    v_cvt_pk_bf16_f32 v137, v210, v211
    v_cvt_pk_bf16_f32 v138, v212, v213
    v_cvt_pk_bf16_f32 v139, v214, v215
    v_pk_mul_f32 v[216:217], v[216:217], v[20:21]
    v_pk_mul_f32 v[218:219], v[218:219], v[20:21]
    v_pk_mul_f32 v[220:221], v[220:221], v[20:21]
    v_pk_mul_f32 v[222:223], v[222:223], v[20:21]
    v_cvt_pk_bf16_f32 v140, v216, v217
    v_cvt_pk_bf16_f32 v141, v218, v219
    v_cvt_pk_bf16_f32 v142, v220, v221
    v_cvt_pk_bf16_f32 v143, v222, v223
    v_pk_mul_f32 v[224:225], v[224:225], v[20:21]
    v_pk_mul_f32 v[226:227], v[226:227], v[20:21]
    v_pk_mul_f32 v[228:229], v[228:229], v[20:21]
    v_pk_mul_f32 v[230:231], v[230:231], v[20:21]
    v_cvt_pk_bf16_f32 v144, v224, v225
    v_cvt_pk_bf16_f32 v145, v226, v227
    v_cvt_pk_bf16_f32 v146, v228, v229
    v_cvt_pk_bf16_f32 v147, v230, v231
    v_pk_mul_f32 v[232:233], v[232:233], v[20:21]
    v_pk_mul_f32 v[234:235], v[234:235], v[20:21]
    v_pk_mul_f32 v[236:237], v[236:237], v[20:21]
    v_pk_mul_f32 v[238:239], v[238:239], v[20:21]
    v_cvt_pk_bf16_f32 v148, v232, v233
    v_cvt_pk_bf16_f32 v149, v234, v235
    v_cvt_pk_bf16_f32 v150, v236, v237
    v_cvt_pk_bf16_f32 v151, v238, v239
    v_pk_mul_f32 v[240:241], v[240:241], v[20:21]
    v_pk_mul_f32 v[242:243], v[242:243], v[20:21]
    v_pk_mul_f32 v[244:245], v[244:245], v[20:21]
    v_pk_mul_f32 v[246:247], v[246:247], v[20:21]
    v_cvt_pk_bf16_f32 v152, v240, v241
    v_cvt_pk_bf16_f32 v153, v242, v243
    v_cvt_pk_bf16_f32 v154, v244, v245
    v_cvt_pk_bf16_f32 v155, v246, v247
    v_pk_mul_f32 v[248:249], v[248:249], v[20:21]
    v_pk_mul_f32 v[250:251], v[250:251], v[20:21]
    v_pk_mul_f32 v[252:253], v[252:253], v[20:21]
    v_pk_mul_f32 v[254:255], v[254:255], v[20:21]
    v_cvt_pk_bf16_f32 v156, v248, v249
    v_cvt_pk_bf16_f32 v157, v250, v251
    v_cvt_pk_bf16_f32 v158, v252, v253
    v_cvt_pk_bf16_f32 v159, v254, v255
    v_mov_b32 v2, v7
    v_and_b32 v21, 15, v1
    v_lshrrev_b32 v22, 4, v1
    v_lshlrev_b32 v22, 2, v22
    v_sub_u32 v18, v21, v22
    s_mov_b32 s40, 0
    s_mov_b32 s41, 16384
    s_mov_b32 s49, 0xffff
    s_lshl_b32 s51, s30, 1
    s_add_u32 s51, s51, 1
    s_and_b32 s50, s28, 3
    s_lshl_b32 s50, s50, 5
    v_mov_b32 v36, 0x3f803f80
    v_mov_b32 v37, 0x3f803f80
    v_mov_b32 v38, 0x3f803f80
    v_mov_b32 v39, 0x3f803f80
    s_lshl_b32 s42, 7, s51
    s_lshr_b32 s42, s42, 2
    s_or_b32 s42, s42, 0x8001
    s_mov_b64 s[52:53], 0
    s_waitcnt lgkmcnt(0)
    s_barrier
    ds_read_b128 v[160:163], v19 offset:0
    ds_read_b128 v[164:167], v19 offset:1024
    ds_read_b128 v[168:171], v19 offset:2048
    ds_read_b128 v[172:175], v19 offset:3072
    ds_read_b128 v[176:179], v19 offset:4096
    ds_read_b128 v[180:183], v19 offset:5120
    ds_read_b128 v[184:187], v19 offset:6144
    ds_read_b128 v[188:191], v19 offset:7168
    s_add_u32 s16, s54, 41943040
    s_addc_u32 s17, s55, 0
    s_and_b32 s17, s17, 0xffff
    s_mov_b32 s18, 117440640
    s_mov_b32 s19, 0x20000
    s_cmp_eq_u32 s28, 4
    s_cbranch_scc1 L_recurrent_scan__compressed_kv_cla__moe_arch_mod__prompt_kernel_rare_100
L_recurrent_scan__compressed_kv_cla__moe_arch_mod__prompt_kernel_back_101:
    s_sub_u32 s36, s2, 160
    s_lshl_b32 s36, s36, 1
    s_and_b32 s37, s28, 1
    s_add_u32 s36, s36, s37
    s_min_u32 s36, s36, 1024
    s_mul_i32 s36, s36, 43776
    s_cmp_lt_u32 s28, 6
    s_cselect_b64 s[4:5], s[32:33], s[34:35]
    s_cselect_b32 s37, 32, 28
    s_lshl_b32 s37, s37, 18
    s_min_u32 s36, s36, s37
    s_sub_u32 s6, s37, s36
    s_min_u32 s6, s6, 43776
    s_add_u32 s4, s4, s36
    s_addc_u32 s5, s5, 0
    s_and_b32 s5, s5, 0xffff
    s_mov_b32 s7, 0x20000
    v_cmp_gt_u32 vcc, 32, v1
    v_lshlrev_b32 v13, 7, v1
    v_mov_b32 v12, 0x100000
    v_cndmask_b32 v13, v12, v13, vcc
    s_mov_b32 s48, 0
    s_cmp_eq_u32 s28, 5
    s_cselect_b32 s36, 0x1000, 0
    s_or_b32 s42, s42, s36
    ds_read_b128 v[64:67], v2 offset:0
    ds_read_b128 v[68:71], v2 offset:1024
    ds_read_b128 v[72:75], v2 offset:2048
    ds_read_b128 v[76:79], v2 offset:3072
    ds_read_b128 v[80:83], v2 offset:4096
    ds_read_b128 v[84:87], v2 offset:5120
    ds_read_b128 v[88:91], v2 offset:6144
    ds_read_b128 v[92:95], v2 offset:7168
    s_waitcnt lgkmcnt(7)
    v_mfma_f32_16x16x32_bf16 v[96:99], v[64:67], v[128:131], 0
    v_mov_b64 v[192:193], 0
    v_mov_b64 v[194:195], 0
    v_mfma_f32_16x16x32_bf16 v[104:107], v[64:67], v[144:147], 0
    ds_read_b128 v[64:67], v2 offset:8192
    v_mov_b64 v[196:197], 0
    v_mov_b64 v[198:199], 0
    s_waitcnt lgkmcnt(7)
    v_mfma_f32_16x16x32_bf16 v[96:99], v[68:71], v[132:135], v[96:99]
    v_mov_b64 v[200:201], 0
    v_mov_b64 v[202:203], 0
    v_mfma_f32_16x16x32_bf16 v[104:107], v[68:71], v[148:151], v[104:107]
    ds_read_b128 v[68:71], v2 offset:9216
    v_mov_b64 v[204:205], 0
    v_mov_b64 v[206:207], 0
    s_waitcnt lgkmcnt(7)
    v_mfma_f32_16x16x32_bf16 v[96:99], v[72:75], v[136:139], v[96:99]
    v_mov_b64 v[208:209], 0
    v_mfma_f32_16x16x32_bf16 v[104:107], v[72:75], v[152:155], v[104:107]
    ds_read_b128 v[72:75], v2 offset:10240
    v_mov_b64 v[210:211], 0
    v_mov_b64 v[212:213], 0
    s_waitcnt lgkmcnt(7)
    v_mfma_f32_16x16x32_bf16 v[96:99], v[76:79], v[140:143], v[96:99]
    v_mov_b64 v[214:215], 0
    v_mov_b64 v[216:217], 0
    v_mfma_f32_16x16x32_bf16 v[104:107], v[76:79], v[156:159], v[104:107]
    ds_read_b128 v[76:79], v2 offset:11264
    v_mov_b64 v[218:219], 0
    v_mov_b64 v[220:221], 0
    s_waitcnt lgkmcnt(7)
    v_mfma_f32_16x16x32_bf16 v[100:103], v[80:83], v[128:131], 0
    v_mov_b64 v[222:223], 0
    v_mov_b64 v[224:225], 0
    v_mfma_f32_16x16x32_bf16 v[108:111], v[80:83], v[144:147], 0
    ds_read_b128 v[80:83], v2 offset:12288
    v_mov_b64 v[226:227], 0
    s_waitcnt lgkmcnt(7)
    v_mfma_f32_16x16x32_bf16 v[100:103], v[84:87], v[132:135], v[100:103]
    v_mov_b64 v[228:229], 0
    v_mov_b64 v[230:231], 0
    v_mfma_f32_16x16x32_bf16 v[108:111], v[84:87], v[148:151], v[108:111]
    ds_read_b128 v[84:87], v2 offset:13312
    v_mov_b64 v[232:233], 0
    v_mov_b64 v[234:235], 0
    s_waitcnt lgkmcnt(7)
    v_mfma_f32_16x16x32_bf16 v[100:103], v[88:91], v[136:139], v[100:103]
    v_mov_b64 v[236:237], 0
    v_mov_b64 v[238:239], 0
    v_mfma_f32_16x16x32_bf16 v[108:111], v[88:91], v[152:155], v[108:111]
    ds_read_b128 v[88:91], v2 offset:14336
    v_mov_b64 v[240:241], 0
    v_mov_b64 v[242:243], 0
    s_waitcnt lgkmcnt(7)
    v_mfma_f32_16x16x32_bf16 v[100:103], v[92:95], v[140:143], v[100:103]
    v_mov_b64 v[244:245], 0
    v_mfma_f32_16x16x32_bf16 v[108:111], v[92:95], v[156:159], v[108:111]
    ds_read_b128 v[92:95], v2 offset:15360
    v_mov_b64 v[246:247], 0
    v_mov_b64 v[248:249], 0
    s_waitcnt lgkmcnt(7)
    v_mfma_f32_16x16x32_bf16 v[112:115], v[64:67], v[128:131], 0
    v_mov_b64 v[250:251], 0
    v_mov_b64 v[252:253], 0
    v_mfma_f32_16x16x32_bf16 v[120:123], v[64:67], v[144:147], 0
    v_mov_b64 v[254:255], 0
    v_mov_b64 v[28:29], 0
    s_waitcnt lgkmcnt(6)
    v_mfma_f32_16x16x32_bf16 v[112:115], v[68:71], v[132:135], v[112:115]
    v_mov_b64 v[30:31], 0
    v_mov_b64 v[32:33], 0
    v_mfma_f32_16x16x32_bf16 v[120:123], v[68:71], v[148:151], v[120:123]
    v_mov_b64 v[34:35], 0
    s_waitcnt lgkmcnt(5)
    v_mfma_f32_16x16x32_bf16 v[112:115], v[72:75], v[136:139], v[112:115]
    s_add_u32 s36, s30, s50
    s_cmp_eq_u32 s36, 0
    s_cbranch_scc1 L_recurrent_scan__compressed_kv_cla__moe_arch_mod__prompt_kernel_rare_103
L_recurrent_scan__compressed_kv_cla__moe_arch_mod__prompt_kernel_back_104:
    v_mfma_f32_16x16x32_bf16 v[120:123], v[72:75], v[152:155], v[120:123]
    v_max3_f32 v22, v96, v97, v98
    v_max3_f32 v23, v104, v105, v106
    s_waitcnt lgkmcnt(4)
    v_mfma_f32_16x16x32_bf16 v[112:115], v[76:79], v[140:143], v[112:115]
    v_max3_f32 v22, v22, v99, v100
    v_max3_f32 v23, v23, v107, v108
    v_mfma_f32_16x16x32_bf16 v[120:123], v[76:79], v[156:159], v[120:123]
    v_max3_f32 v22, v22, v101, v102
    v_max3_f32 v23, v23, v109, v110
    s_waitcnt lgkmcnt(3)
    v_mfma_f32_16x16x32_bf16 v[116:119], v[80:83], v[128:131], 0
    v_max_f32 v22, v22, v103
    v_max_f32 v23, v23, v111
    v_mfma_f32_16x16x32_bf16 v[124:127], v[80:83], v[144:147], 0
    v_mov_b32 v24, v22
    v_mov_b32 v25, v23
    s_waitcnt lgkmcnt(2)
    v_mfma_f32_16x16x32_bf16 v[116:119], v[84:87], v[132:135], v[116:119]
    v_permlane16_swap_b32 v22, v24
    v_permlane16_swap_b32 v23, v25
    v_mfma_f32_16x16x32_bf16 v[124:127], v[84:87], v[148:151], v[124:127]
    v_max_f32 v22, v22, v24
    v_max_f32 v23, v23, v25
    s_waitcnt lgkmcnt(1)
    v_mfma_f32_16x16x32_bf16 v[116:119], v[88:91], v[136:139], v[116:119]
    v_mov_b32 v24, v22
    v_mov_b32 v25, v23
    v_mfma_f32_16x16x32_bf16 v[124:127], v[88:91], v[152:155], v[124:127]
    v_permlane32_swap_b32 v22, v24
    v_permlane32_swap_b32 v23, v25
    s_waitcnt lgkmcnt(0)
    v_mfma_f32_16x16x32_bf16 v[116:119], v[92:95], v[140:143], v[116:119]
    v_max_f32 v22, v22, v24
    v_max_f32 v23, v23, v25
    v_mfma_f32_16x16x32_bf16 v[124:127], v[92:95], v[156:159], v[124:127]
    v_sub_f32 v40, 0, v22
    v_sub_f32 v41, 0, v22
    v_sub_f32 v42, 0, v22
    v_sub_f32 v43, 0, v22
    v_sub_f32 v44, 0, v23
    v_sub_f32 v45, 0, v23
    v_sub_f32 v46, 0, v23
    v_sub_f32 v47, 0, v23
    v_add_u32 v3, 65536, v2
    v_add_u32 v2, s41, v2
    v_and_b32 v2, s49, v2
    s_waitcnt vmcnt(1)
    s_cmp_eq_u32 s28, 4
    s_cbranch_scc1 L_recurrent_scan__compressed_kv_cla__moe_arch_mod__prompt_kernel_pw_105
    s_waitcnt vmcnt(0)
L_recurrent_scan__compressed_kv_cla__moe_arch_mod__prompt_kernel_pw_105:
    s_barrier
    ds_read_b128 v[64:67], v2 offset:0
    ds_read_b128 v[68:71], v2 offset:1024
    ds_read_b128 v[72:75], v2 offset:2048
    ds_read_b128 v[76:79], v2 offset:3072
    ds_read_b128 v[80:83], v2 offset:4096
    ds_read_b128 v[84:87], v2 offset:5120
    ds_read_b128 v[88:91], v2 offset:6144
    v_pk_add_f32 v[96:97], v[96:97], v[40:41]
    v_pk_add_f32 v[98:99], v[98:99], v[40:41]
    v_pk_add_f32 v[100:101], v[100:101], v[40:41]
    v_pk_add_f32 v[102:103], v[102:103], v[40:41]
    v_pk_add_f32 v[104:105], v[104:105], v[44:45]
    v_pk_add_f32 v[106:107], v[106:107], v[44:45]
    v_pk_add_f32 v[108:109], v[108:109], v[44:45]
    v_pk_add_f32 v[110:111], v[110:111], v[44:45]
    v_pk_add_f32 v[112:113], v[112:113], v[40:41]
    v_pk_add_f32 v[114:115], v[114:115], v[40:41]
    v_pk_add_f32 v[116:117], v[116:117], v[40:41]
    v_pk_add_f32 v[118:119], v[118:119], v[40:41]
    v_pk_add_f32 v[120:121], v[120:121], v[44:45]
    v_pk_add_f32 v[122:123], v[122:123], v[44:45]
    v_pk_add_f32 v[124:125], v[124:125], v[44:45]
    v_pk_add_f32 v[126:127], v[126:127], v[44:45]
    v_exp_f32 v96, v96
    v_exp_f32 v97, v97
    v_exp_f32 v98, v98
    v_exp_f32 v99, v99
    v_exp_f32 v104, v104
    v_exp_f32 v105, v105
    v_exp_f32 v106, v106
    v_exp_f32 v107, v107
    v_exp_f32 v100, v100
    v_exp_f32 v101, v101
    v_exp_f32 v102, v102
    v_exp_f32 v103, v103
    v_exp_f32 v108, v108
    v_exp_f32 v109, v109
    v_exp_f32 v110, v110
    v_exp_f32 v111, v111
    v_cvt_pk_bf16_f32 v48, v96, v97
    v_cvt_pk_bf16_f32 v49, v98, v99
    v_cvt_pk_bf16_f32 v52, v104, v105
    v_cvt_pk_bf16_f32 v53, v106, v107
    v_cvt_pk_bf16_f32 v50, v100, v101
    v_cvt_pk_bf16_f32 v51, v102, v103
    v_cvt_pk_bf16_f32 v54, v108, v109
    v_cvt_pk_bf16_f32 v55, v110, v111
    .p2align 6
L_body1:
    s_bitcmp1_b32 s42, s40
    s_cbranch_scc1 L_recurrent_scan__compressed_kv_cla__moe_arch_mod__prompt_kernel_rare_110
L_recurrent_scan__compressed_kv_cla__moe_arch_mod__prompt_kernel_back_111:
    s_waitcnt lgkmcnt(5)
    v_mfma_f32_16x16x32_bf16 v[96:99], v[64:67], v[128:131], v[40:43]
    v_exp_f32 v112, v112
    v_mfma_f32_16x16x32_bf16 v[104:107], v[64:67], v[144:147], v[44:47]
    ds_read_b128 v[92:95], v2 offset:7168
    v_mfma_f32_16x16x32_bf16 v[96:99], v[68:71], v[132:135], v[96:99]
    v_exp_f32 v113, v113
    v_mfma_f32_16x16x32_bf16 v[104:107], v[68:71], v[148:151], v[104:107]
    ds_read_b128 v[64:67], v3 offset:0
    s_waitcnt lgkmcnt(5)
    v_mfma_f32_16x16x32_bf16 v[96:99], v[72:75], v[136:139], v[96:99]
    v_exp_f32 v114, v114
    v_mfma_f32_16x16x32_bf16 v[104:107], v[72:75], v[152:155], v[104:107]
    ds_read_b128 v[68:71], v3 offset:1024
    v_cvt_pk_bf16_f32 v56, v112, v113
    v_mfma_f32_16x16x32_bf16 v[96:99], v[76:79], v[140:143], v[96:99]
    v_exp_f32 v115, v115
    v_mfma_f32_16x16x32_bf16 v[104:107], v[76:79], v[156:159], v[104:107]
    ds_read_b128 v[72:75], v3 offset:2048
    s_waitcnt lgkmcnt(5)
    v_mfma_f32_16x16x32_bf16 v[100:103], v[80:83], v[128:131], v[40:43]
    v_exp_f32 v120, v120
    v_mfma_f32_16x16x32_bf16 v[108:111], v[80:83], v[144:147], v[44:47]
    ds_read_b128 v[76:79], v3 offset:3072
    v_cvt_pk_bf16_f32 v57, v114, v115
    v_mfma_f32_16x16x32_bf16 v[100:103], v[84:87], v[132:135], v[100:103]
    v_exp_f32 v121, v121
    v_mfma_f32_16x16x32_bf16 v[108:111], v[84:87], v[148:151], v[108:111]
    ds_read_b128 v[80:83], v3 offset:4096
    s_waitcnt lgkmcnt(5)
    v_mfma_f32_16x16x32_bf16 v[100:103], v[88:91], v[136:139], v[100:103]
    v_exp_f32 v122, v122
    v_mfma_f32_16x16x32_bf16 v[108:111], v[88:91], v[152:155], v[108:111]
    ds_read_b128 v[84:87], v3 offset:5120
    v_cvt_pk_bf16_f32 v60, v120, v121
    v_mfma_f32_16x16x32_bf16 v[100:103], v[92:95], v[140:143], v[100:103]
    v_exp_f32 v123, v123
    v_mfma_f32_16x16x32_bf16 v[108:111], v[92:95], v[156:159], v[108:111]
    ds_read_b128 v[88:91], v3 offset:6144
    s_waitcnt lgkmcnt(5)
    v_mfma_f32_16x16x32_bf16 v[192:195], v[64:67], v[48:51], v[192:195]
    v_exp_f32 v116, v116
    v_mfma_f32_16x16x32_bf16 v[224:227], v[64:67], v[52:55], v[224:227]
    ds_read_b128 v[92:95], v3 offset:7168
    v_cvt_pk_bf16_f32 v61, v122, v123
    v_mfma_f32_16x16x32_bf16 v[196:199], v[68:71], v[48:51], v[196:199]
    v_exp_f32 v117, v117
    v_mfma_f32_16x16x32_bf16 v[228:231], v[68:71], v[52:55], v[228:231]
    ds_read_b128 v[64:67], v2 offset:8192
    s_waitcnt lgkmcnt(5)
    v_mfma_f32_16x16x32_bf16 v[200:203], v[72:75], v[48:51], v[200:203]
    v_exp_f32 v118, v118
    v_mfma_f32_16x16x32_bf16 v[232:235], v[72:75], v[52:55], v[232:235]
    v_mfma_f32_16x16x32_bf16 v[28:31], v[36:39], v[48:51], v[28:31]
    ds_read_b128 v[68:71], v2 offset:9216
    v_cvt_pk_bf16_f32 v58, v116, v117
    v_mfma_f32_16x16x32_bf16 v[204:207], v[76:79], v[48:51], v[204:207]
    v_exp_f32 v119, v119
    v_mfma_f32_16x16x32_bf16 v[236:239], v[76:79], v[52:55], v[236:239]
    ds_read_b128 v[72:75], v2 offset:10240
    s_waitcnt lgkmcnt(5)
    v_mfma_f32_16x16x32_bf16 v[208:211], v[80:83], v[48:51], v[208:211]
    v_exp_f32 v124, v124
    buffer_load_dword v0, v13, s[4:7], s48 offen
    s_add_u32 s48, s48, 4096
    v_mfma_f32_16x16x32_bf16 v[240:243], v[80:83], v[52:55], v[240:243]
    ds_read_b128 v[76:79], v2 offset:11264
    v_cvt_pk_bf16_f32 v59, v118, v119
    v_mfma_f32_16x16x32_bf16 v[212:215], v[84:87], v[48:51], v[212:215]
    v_exp_f32 v125, v125
    v_mfma_f32_16x16x32_bf16 v[244:247], v[84:87], v[52:55], v[244:247]
    ds_read_b128 v[80:83], v2 offset:12288
    s_waitcnt lgkmcnt(5)
    v_mfma_f32_16x16x32_bf16 v[216:219], v[88:91], v[48:51], v[216:219]
    v_exp_f32 v126, v126
    v_mfma_f32_16x16x32_bf16 v[248:251], v[88:91], v[52:55], v[248:251]
    v_mfma_f32_16x16x32_bf16 v[32:35], v[36:39], v[52:55], v[32:35]
    ds_read_b128 v[84:87], v2 offset:13312
    v_cvt_pk_bf16_f32 v62, v124, v125
    v_mfma_f32_16x16x32_bf16 v[220:223], v[92:95], v[48:51], v[220:223]
    v_exp_f32 v127, v127
    v_mfma_f32_16x16x32_bf16 v[252:255], v[92:95], v[52:55], v[252:255]
    ds_read_b128 v[88:91], v2 offset:14336
    v_cvt_pk_bf16_f32 v63, v126, v127
    s_bitcmp1_b32 s42, s40
    s_cbranch_scc1 L_recurrent_scan__compressed_kv_cla__moe_arch_mod__prompt_kernel_rare_113
L_recurrent_scan__compressed_kv_cla__moe_arch_mod__prompt_kernel_back_114:
    s_waitcnt lgkmcnt(5)
    v_mfma_f32_16x16x32_bf16 v[112:115], v[64:67], v[128:131], v[40:43]
    v_exp_f32 v96, v96
    v_mfma_f32_16x16x32_bf16 v[120:123], v[64:67], v[144:147], v[44:47]
    ds_read_b128 v[92:95], v2 offset:15360
    v_mfma_f32_16x16x32_bf16 v[112:115], v[68:71], v[132:135], v[112:115]
    v_exp_f32 v97, v97
    v_mfma_f32_16x16x32_bf16 v[120:123], v[68:71], v[148:151], v[120:123]
    ds_read_b128 v[64:67], v3 offset:8192
    s_waitcnt lgkmcnt(5)
    v_mfma_f32_16x16x32_bf16 v[112:115], v[72:75], v[136:139], v[112:115]
    v_exp_f32 v98, v98
    v_mfma_f32_16x16x32_bf16 v[120:123], v[72:75], v[152:155], v[120:123]
    ds_read_b128 v[68:71], v3 offset:9216
    v_cvt_pk_bf16_f32 v48, v96, v97
    v_mfma_f32_16x16x32_bf16 v[112:115], v[76:79], v[140:143], v[112:115]
    v_exp_f32 v99, v99
    v_mfma_f32_16x16x32_bf16 v[120:123], v[76:79], v[156:159], v[120:123]
    ds_read_b128 v[72:75], v3 offset:10240
    s_waitcnt lgkmcnt(5)
    v_mfma_f32_16x16x32_bf16 v[116:119], v[80:83], v[128:131], v[40:43]
    v_exp_f32 v104, v104
    v_mfma_f32_16x16x32_bf16 v[124:127], v[80:83], v[144:147], v[44:47]
    ds_read_b128 v[76:79], v3 offset:11264
    v_cvt_pk_bf16_f32 v49, v98, v99
    v_mfma_f32_16x16x32_bf16 v[116:119], v[84:87], v[132:135], v[116:119]
    v_exp_f32 v105, v105
    v_mfma_f32_16x16x32_bf16 v[124:127], v[84:87], v[148:151], v[124:127]
    ds_read_b128 v[80:83], v3 offset:12288
    s_waitcnt lgkmcnt(5)
    v_mfma_f32_16x16x32_bf16 v[116:119], v[88:91], v[136:139], v[116:119]
    v_exp_f32 v106, v106
    v_mfma_f32_16x16x32_bf16 v[124:127], v[88:91], v[152:155], v[124:127]
    ds_read_b128 v[84:87], v3 offset:13312
    v_cvt_pk_bf16_f32 v52, v104, v105
    v_mfma_f32_16x16x32_bf16 v[116:119], v[92:95], v[140:143], v[116:119]
    v_exp_f32 v107, v107
    v_mfma_f32_16x16x32_bf16 v[124:127], v[92:95], v[156:159], v[124:127]
    ds_read_b128 v[88:91], v3 offset:14336
    s_waitcnt lgkmcnt(5)
    v_mfma_f32_16x16x32_bf16 v[192:195], v[64:67], v[56:59], v[192:195]
    v_exp_f32 v100, v100
    v_mfma_f32_16x16x32_bf16 v[224:227], v[64:67], v[60:63], v[224:227]
    ds_read_b128 v[92:95], v3 offset:15360
    v_cvt_pk_bf16_f32 v53, v106, v107
    v_mfma_f32_16x16x32_bf16 v[196:199], v[68:71], v[56:59], v[196:199]
    v_exp_f32 v101, v101
    v_mfma_f32_16x16x32_bf16 v[228:231], v[68:71], v[60:63], v[228:231]
    v_add_u32 v3, 65536, v2
    v_add_u32 v2, s41, v2
    s_waitcnt lgkmcnt(4)
    v_mfma_f32_16x16x32_bf16 v[200:203], v[72:75], v[56:59], v[200:203]
    v_exp_f32 v102, v102
    v_and_b32 v2, s49, v2
    v_mfma_f32_16x16x32_bf16 v[232:235], v[72:75], v[60:63], v[232:235]
    v_mfma_f32_16x16x32_bf16 v[28:31], v[36:39], v[56:59], v[28:31]
    v_cvt_pk_bf16_f32 v50, v100, v101
    s_waitcnt lgkmcnt(0)
    s_barrier
    v_mfma_f32_16x16x32_bf16 v[204:207], v[76:79], v[56:59], v[204:207]
    v_exp_f32 v103, v103
    v_mfma_f32_16x16x32_bf16 v[236:239], v[76:79], v[60:63], v[236:239]
    ds_read_b128 v[68:71], v2 offset:1024
    ds_read_b128 v[64:67], v2 offset:0
    v_mfma_f32_16x16x32_bf16 v[208:211], v[80:83], v[56:59], v[208:211]
    v_exp_f32 v108, v108
    v_mfma_f32_16x16x32_bf16 v[240:243], v[80:83], v[60:63], v[240:243]
    ds_read_b128 v[76:79], v2 offset:3072
    ds_read_b128 v[72:75], v2 offset:2048
    v_cvt_pk_bf16_f32 v51, v102, v103
    v_mfma_f32_16x16x32_bf16 v[212:215], v[84:87], v[56:59], v[212:215]
    v_exp_f32 v109, v109
    v_mfma_f32_16x16x32_bf16 v[244:247], v[84:87], v[60:63], v[244:247]
    ds_read_b128 v[80:83], v2 offset:4096
    v_mfma_f32_16x16x32_bf16 v[216:219], v[88:91], v[56:59], v[216:219]
    v_exp_f32 v110, v110
    v_mfma_f32_16x16x32_bf16 v[248:251], v[88:91], v[60:63], v[248:251]
    v_mfma_f32_16x16x32_bf16 v[32:35], v[36:39], v[60:63], v[32:35]
    ds_read_b128 v[84:87], v2 offset:5120
    v_cvt_pk_bf16_f32 v54, v108, v109
    v_mfma_f32_16x16x32_bf16 v[220:223], v[92:95], v[56:59], v[220:223]
    v_exp_f32 v111, v111
    v_mfma_f32_16x16x32_bf16 v[252:255], v[92:95], v[60:63], v[252:255]
    ds_read_b128 v[88:91], v2 offset:6144
    v_cvt_pk_bf16_f32 v55, v110, v111
    s_bitcmp1_b32 s42, s40
    s_cbranch_scc1 L_recurrent_scan__compressed_kv_cla__moe_arch_mod__prompt_kernel_rare_123
L_recurrent_scan__compressed_kv_cla__moe_arch_mod__prompt_kernel_back_124:
    s_add_u32 s40, s40, 1
    s_cmp_lg_u32 s40, 16
    s_cbranch_scc1 L_body1
    s_lshr_b32 s36, s2, 5
    s_add_u32 s36, s36, 48
    s_lshl_b32 s36, s36, 7
    v_mov_b32 v12, s36
    global_load_dword v11, v12, s[90:91] sc1
    s_sub_u32 s36, 96, s50
    s_cmp_lt_i32 s36, 0
    s_cbranch_scc0 L_recurrent_scan__compressed_kv_cla__moe_arch_mod__prompt_kernel_rare_116
L_recurrent_scan__compressed_kv_cla__moe_arch_mod__prompt_kernel_back_117:
    s_lshl_b32 s37, s28, 13
    v_add_u32 v5, s37, v7
    s_waitcnt lgkmcnt(5)
    v_mfma_f32_16x16x32_bf16 v[192:195], v[64:67], v[48:51], v[192:195]
    v_exp_f32 v112, v112
    v_mfma_f32_16x16x32_bf16 v[224:227], v[64:67], v[52:55], v[224:227]
    ds_read_b128 v[92:95], v3 offset:7168
    v_exp_f32 v113, v113
    v_mfma_f32_16x16x32_bf16 v[196:199], v[68:71], v[48:51], v[196:199]
    v_cvt_pk_bf16_f32 v56, v112, v113
    v_exp_f32 v114, v114
    v_mfma_f32_16x16x32_bf16 v[228:231], v[68:71], v[52:55], v[228:231]
    ds_read_b128 v[64:67], v3 offset:8192
    v_exp_f32 v115, v115
    s_waitcnt lgkmcnt(5)
    v_mfma_f32_16x16x32_bf16 v[200:203], v[72:75], v[48:51], v[200:203]
    v_cvt_pk_bf16_f32 v57, v114, v115
    v_exp_f32 v120, v120
    v_mfma_f32_16x16x32_bf16 v[232:235], v[72:75], v[52:55], v[232:235]
    v_mfma_f32_16x16x32_bf16 v[28:31], v[36:39], v[48:51], v[28:31]
    ds_read_b128 v[68:71], v3 offset:9216
    v_exp_f32 v121, v121
    v_mfma_f32_16x16x32_bf16 v[204:207], v[76:79], v[48:51], v[204:207]
    v_cvt_pk_bf16_f32 v60, v120, v121
    v_exp_f32 v122, v122
    v_mfma_f32_16x16x32_bf16 v[236:239], v[76:79], v[52:55], v[236:239]
    ds_read_b128 v[72:75], v3 offset:10240
    v_exp_f32 v123, v123
    s_waitcnt lgkmcnt(6)
    v_mfma_f32_16x16x32_bf16 v[208:211], v[80:83], v[48:51], v[208:211]
    v_cvt_pk_bf16_f32 v61, v122, v123
    v_exp_f32 v116, v116
    v_mfma_f32_16x16x32_bf16 v[240:243], v[80:83], v[52:55], v[240:243]
    ds_read_b128 v[76:79], v3 offset:11264
    v_exp_f32 v117, v117
    s_waitcnt lgkmcnt(6)
    v_mfma_f32_16x16x32_bf16 v[212:215], v[84:87], v[48:51], v[212:215]
    v_cvt_pk_bf16_f32 v58, v116, v117
    v_exp_f32 v118, v118
    v_mfma_f32_16x16x32_bf16 v[244:247], v[84:87], v[52:55], v[244:247]
    ds_read_b128 v[80:83], v3 offset:12288
    v_exp_f32 v119, v119
    s_waitcnt lgkmcnt(6)
    v_mfma_f32_16x16x32_bf16 v[216:219], v[88:91], v[48:51], v[216:219]
    v_cvt_pk_bf16_f32 v59, v118, v119
    v_exp_f32 v124, v124
    v_mfma_f32_16x16x32_bf16 v[248:251], v[88:91], v[52:55], v[248:251]
    v_mfma_f32_16x16x32_bf16 v[32:35], v[36:39], v[52:55], v[32:35]
    ds_read_b128 v[84:87], v3 offset:13312
    v_exp_f32 v125, v125
    s_waitcnt lgkmcnt(6)
    v_mfma_f32_16x16x32_bf16 v[220:223], v[92:95], v[48:51], v[220:223]
    v_cvt_pk_bf16_f32 v62, v124, v125
    v_exp_f32 v126, v126
    v_mfma_f32_16x16x32_bf16 v[252:255], v[92:95], v[52:55], v[252:255]
    ds_read_b128 v[88:91], v3 offset:14336
    v_exp_f32 v127, v127
    s_nop 0
    v_cvt_pk_bf16_f32 v63, v126, v127
    s_nop 1
    s_waitcnt lgkmcnt(6)
    v_mfma_f32_16x16x32_bf16 v[192:195], v[64:67], v[56:59], v[192:195]
    s_mov_b32 s4, s34
    s_and_b32 s5, s35, 0xffff
    s_mov_b32 s6, 7340032
    s_mov_b32 s7, 0x20000
    s_mov_b32 s8, s32
    v_mfma_f32_16x16x32_bf16 v[224:227], v[64:67], v[60:63], v[224:227]
    ds_read_b128 v[92:95], v3 offset:15360
    s_and_b32 s9, s33, 0xffff
    s_mov_b32 s10, 8388608
    s_mov_b32 s11, 0x20000
    s_lshr_b32 s38, s2, 4
    s_waitcnt lgkmcnt(6)
    v_mfma_f32_16x16x32_bf16 v[196:199], v[68:71], v[56:59], v[196:199]
    s_mul_i32 s38, s38, 224
    s_and_b32 s39, s2, 15
    s_lshl_b32 s39, s39, 7
    v_lshrrev_b32 v25, 3, v1
    s_lshl_b32 s36, s28, 5
    v_mfma_f32_16x16x32_bf16 v[228:231], v[68:71], v[60:63], v[228:231]
    s_add_u32 s36, s36, s38
    v_add_u32 v25, s36, v25
    v_mul_u32_u24 v25, 2048, v25
    v_add_u32 v25, s39, v25
    s_waitcnt lgkmcnt(5)
    v_mfma_f32_16x16x32_bf16 v[200:203], v[72:75], v[56:59], v[200:203]
    v_bfe_u32 v26, v1, 4, 1
    v_lshlrev_b32 v26, 1, v26
    v_and_b32 v27, 7, v1
    v_xor_b32 v26, v26, v27
    v_mfma_f32_16x16x32_bf16 v[232:235], v[72:75], v[60:63], v[232:235]
    v_mfma_f32_16x16x32_bf16 v[28:31], v[36:39], v[56:59], v[28:31]
    v_lshl_add_u32 v24, v26, 4, v25
    v_xor_b32 v26, 4, v26
    v_lshl_add_u32 v25, v26, 4, v25
    v_add_u32 v25, 15360, v25
    v_add_u32 v26, 30720, v24
    s_waitcnt lgkmcnt(4)
    v_mfma_f32_16x16x32_bf16 v[204:207], v[76:79], v[56:59], v[204:207]
    v_add_u32 v27, 30720, v25
    s_lshl_b32 s36, s28, 12
    s_add_u32 s36, s36, 131072
    s_cmp_lt_u32 s28, 7
    s_cselect_b32 m0, s36, 0x30000
    s_cselect_b32 s6, 7340032, 0
    v_mfma_f32_16x16x32_bf16 v[236:239], v[76:79], v[60:63], v[236:239]
    buffer_load_dwordx4 v24, s[4:7], 0 offen offset:0 lds
    buffer_load_dwordx4 v25, s[4:7], 0 offen offset:1024 lds
    buffer_load_dwordx4 v26, s[4:7], 0 offen offset:2048 lds
    buffer_load_dwordx4 v27, s[4:7], 0 offen offset:3072 lds
    s_waitcnt lgkmcnt(3)
    v_mfma_f32_16x16x32_bf16 v[208:211], v[80:83], v[56:59], v[208:211]
    v_mfma_f32_16x16x32_bf16 v[240:243], v[80:83], v[60:63], v[240:243]
    ds_write_b128 v5, v[192:195] offset:0
    s_waitcnt lgkmcnt(3)
    v_mfma_f32_16x16x32_bf16 v[212:215], v[84:87], v[56:59], v[212:215]
    v_mfma_f32_16x16x32_bf16 v[244:247], v[84:87], v[60:63], v[244:247]
    ds_write_b128 v5, v[196:199] offset:1024
    s_waitcnt lgkmcnt(3)
    v_mfma_f32_16x16x32_bf16 v[216:219], v[88:91], v[56:59], v[216:219]
    v_mfma_f32_16x16x32_bf16 v[248:251], v[88:91], v[60:63], v[248:251]
    v_mfma_f32_16x16x32_bf16 v[32:35], v[36:39], v[60:63], v[32:35]
    ds_write_b128 v5, v[200:203] offset:2048
    s_waitcnt lgkmcnt(3)
    v_mfma_f32_16x16x32_bf16 v[220:223], v[92:95], v[56:59], v[220:223]
    v_mfma_f32_16x16x32_bf16 v[252:255], v[92:95], v[60:63], v[252:255]
    ds_write_b128 v5, v[204:207] offset:3072
    ds_write_b128 v5, v[208:211] offset:4096
    ds_write_b128 v5, v[212:215] offset:5120
    v_xor_b32 v106, 32768, v5
    s_lshl_b32 s37, s28, 8
    s_add_u32 s37, s37, 159744
    v_lshl_add_u32 v107, v1, 2, s37
    v_xor_b32 v108, 1024, v107
    ds_write_b128 v5, v[216:219] offset:6144
    ds_write_b128 v5, v[220:223] offset:7168
    ds_write_b32 v107, v28
    s_mov_b32 s36, 0x5d800000
    v_cmp_nge_f32 vcc, s36, v28
    s_nop 0
    s_or_b64 s[52:53], s[52:53], vcc
    v_cmp_nge_f32 vcc, s36, v32
    s_nop 0
    s_or_b64 s[52:53], s[52:53], vcc
    s_or_b32 s36, s52, s53
    v_mov_b32 v110, s36
    s_lshl_b32 s37, s28, 2
    s_add_u32 s37, s37, 161792
    v_mov_b32 v111, s37
    ds_write_b32 v111, v110
    v_mov_b32 v112, 161856
    v_and_b32 v111, 7, v1
    v_lshlrev_b32 v111, 2, v111
    v_add_u32 v111, 161792, v111
    v_mov_b32 v113, v7
    s_sub_u32 s36, 15, s30
    s_lshl_b32 s38, s36, 3
    s_and_b32 s37, s28, 3
    s_lshl_b32 s37, s37, 1
    s_add_u32 s38, s38, s37
    s_add_u32 s38, s38, 1
    s_lshl_b32 s38, s38, 17
    s_lshl_b32 s37, s29, 12
    s_add_u32 s38, s38, s37
    s_waitcnt vmcnt(4)
    v_readfirstlane_b32 s36, v11
    s_nop 0
    s_cmp_lt_u32 s36, 28
    s_cbranch_scc1 L_recurrent_scan__compressed_kv_cla__moe_arch_mod__prompt_kernel_rare_127
L_recurrent_scan__compressed_kv_cla__moe_arch_mod__prompt_kernel_back_128:
    s_lshr_b32 s36, s2, 4
    s_mul_i32 s36, s36, 7
    s_min_u32 s37, s28, 6
    s_add_u32 s36, s36, s37
    s_lshl_b32 s36, s36, 11
    s_add_u32 s36, s36, 58720256
    v_and_b32 v11, 15, v1
    v_lshlrev_b32 v11, 4, v11
    v_lshrrev_b32 v12, 4, v1
    v_lshl_add_u32 v11, v12, 9, v11
    buffer_load_dwordx4 v[96:99], v11, s[24:27], s36 offen offset:0 sc1
    buffer_load_dwordx4 v[100:103], v11, s[24:27], s36 offen offset:256 sc1
    s_waitcnt lgkmcnt(0)
    s_barrier
    ds_read_b128 v[114:117], v112
    ds_read_b32 v110, v111
    ds_read_b32 v109, v108
    ds_read_b128 v[64:67], v106 offset:0
    ds_read_b128 v[68:71], v106 offset:1024
    ds_read_b128 v[72:75], v106 offset:2048
    ds_read_b128 v[76:79], v106 offset:3072
    ds_read_b128 v[80:83], v106 offset:4096
    ds_read_b128 v[84:87], v106 offset:5120
    ds_read_b128 v[88:91], v106 offset:6144
    ds_read_b128 v[92:95], v106 offset:7168
    s_waitcnt lgkmcnt(8)
    v_add_f32 v109, v109, v32
    v_cmp_ne_u32 s[52:53], 0, v110
    v_readfirstlane_b32 s56, v114
    v_readfirstlane_b32 s57, v115
    v_readfirstlane_b32 s58, v116
    v_readfirstlane_b32 s59, v117
    v_rcp_f32 v109, v109
    s_nop 0
    v_mov_b32 v108, v109
    s_waitcnt lgkmcnt(6)
    v_pk_add_f32 v[224:225], v[224:225], v[64:65]
    v_pk_add_f32 v[226:227], v[226:227], v[66:67]
    v_pk_add_f32 v[228:229], v[228:229], v[68:69]
    v_pk_add_f32 v[230:231], v[230:231], v[70:71]
    v_pk_mul_f32 v[224:225], v[224:225], v[108:109]
    v_pk_mul_f32 v[226:227], v[226:227], v[108:109]
    v_pk_mul_f32 v[228:229], v[228:229], v[108:109]
    v_pk_mul_f32 v[230:231], v[230:231], v[108:109]
    v_cvt_pk_bf16_f32 v48, v224, v225
    v_cvt_pk_bf16_f32 v49, v226, v227
    v_cvt_pk_bf16_f32 v50, v228, v229
    v_cvt_pk_bf16_f32 v51, v230, v231
    buffer_store_dwordx4 v[48:51], v113, s[16:19], s38 offen offset:0 sc1
    s_waitcnt lgkmcnt(4)
    v_pk_add_f32 v[232:233], v[232:233], v[72:73]
    v_pk_add_f32 v[234:235], v[234:235], v[74:75]
    v_pk_add_f32 v[236:237], v[236:237], v[76:77]
    v_pk_add_f32 v[238:239], v[238:239], v[78:79]
    v_pk_mul_f32 v[232:233], v[232:233], v[108:109]
    v_pk_mul_f32 v[234:235], v[234:235], v[108:109]
    v_pk_mul_f32 v[236:237], v[236:237], v[108:109]
    v_pk_mul_f32 v[238:239], v[238:239], v[108:109]
    v_cvt_pk_bf16_f32 v52, v232, v233
    v_cvt_pk_bf16_f32 v53, v234, v235
    v_cvt_pk_bf16_f32 v54, v236, v237
    v_cvt_pk_bf16_f32 v55, v238, v239
    buffer_store_dwordx4 v[52:55], v113, s[16:19], s38 offen offset:1024 sc1
    s_waitcnt lgkmcnt(2)
    v_pk_add_f32 v[240:241], v[240:241], v[80:81]
    v_pk_add_f32 v[242:243], v[242:243], v[82:83]
    v_pk_add_f32 v[244:245], v[244:245], v[84:85]
    v_pk_add_f32 v[246:247], v[246:247], v[86:87]
    v_pk_mul_f32 v[240:241], v[240:241], v[108:109]
    v_pk_mul_f32 v[242:243], v[242:243], v[108:109]
    v_pk_mul_f32 v[244:245], v[244:245], v[108:109]
    v_pk_mul_f32 v[246:247], v[246:247], v[108:109]
    v_cvt_pk_bf16_f32 v56, v240, v241
    v_cvt_pk_bf16_f32 v57, v242, v243
    v_cvt_pk_bf16_f32 v58, v244, v245
    v_cvt_pk_bf16_f32 v59, v246, v247
    buffer_store_dwordx4 v[56:59], v113, s[16:19], s38 offen offset:2048 sc1
    s_waitcnt lgkmcnt(0)
    v_pk_add_f32 v[248:249], v[248:249], v[88:89]
    v_pk_add_f32 v[250:251], v[250:251], v[90:91]
    v_pk_add_f32 v[252:253], v[252:253], v[92:93]
    v_pk_add_f32 v[254:255], v[254:255], v[94:95]
    v_pk_mul_f32 v[248:249], v[248:249], v[108:109]
    v_pk_mul_f32 v[250:251], v[250:251], v[108:109]
    v_pk_mul_f32 v[252:253], v[252:253], v[108:109]
    v_pk_mul_f32 v[254:255], v[254:255], v[108:109]
    v_cvt_pk_bf16_f32 v60, v248, v249
    v_cvt_pk_bf16_f32 v61, v250, v251
    v_cvt_pk_bf16_f32 v62, v252, v253
    v_cvt_pk_bf16_f32 v63, v254, v255
    buffer_store_dwordx4 v[60:63], v113, s[16:19], s38 offen offset:3072 sc1
    s_cmp_eq_u64 s[52:53], 0
    s_cbranch_scc1 L_p3_done
    s_waitcnt vmcnt(0)
    v_mov_b32 v112, v96
    v_mov_b32 v113, v97
    v_mov_b32 v114, v98
    v_mov_b32 v115, v99
    v_mov_b32 v116, v100
    v_mov_b32 v117, v101
    v_mov_b32 v118, v102
    v_mov_b32 v119, v103
    v_swap_b32 v128, v160
    v_swap_b32 v129, v161
    v_swap_b32 v130, v162
    v_swap_b32 v131, v163
    v_swap_b32 v132, v164
    v_swap_b32 v133, v165
    v_swap_b32 v134, v166
    v_swap_b32 v135, v167
    v_swap_b32 v136, v168
    v_swap_b32 v137, v169
    v_swap_b32 v138, v170
    v_swap_b32 v139, v171
    v_swap_b32 v140, v172
    v_swap_b32 v141, v173
    v_swap_b32 v142, v174
    v_swap_b32 v143, v175
    v_swap_b32 v144, v176
    v_swap_b32 v145, v177
    v_swap_b32 v146, v178
    v_swap_b32 v147, v179
    v_swap_b32 v148, v180
    v_swap_b32 v149, v181
    v_swap_b32 v150, v182
    v_swap_b32 v151, v183
    v_swap_b32 v152, v184
    v_swap_b32 v153, v185
    v_swap_b32 v154, v186
    v_swap_b32 v155, v187
    v_swap_b32 v156, v188
    v_swap_b32 v157, v189
    v_swap_b32 v158, v190
    v_swap_b32 v159, v191
    v_mov_b32 v192, 0
    v_mov_b32 v193, 0
    v_mov_b32 v194, 0
    v_mov_b32 v195, 0
    v_mov_b32 v196, 0
    v_mov_b32 v197, 0
    v_mov_b32 v198, 0
    v_mov_b32 v199, 0
    v_mov_b32 v200, 0
    v_mov_b32 v201, 0
    v_mov_b32 v202, 0
    v_mov_b32 v203, 0
    v_mov_b32 v204, 0
    v_mov_b32 v205, 0
    v_mov_b32 v206, 0
    v_mov_b32 v207, 0
    v_mov_b32 v208, 0
    v_mov_b32 v209, 0
    v_mov_b32 v210, 0
    v_mov_b32 v211, 0
    v_mov_b32 v212, 0
    v_mov_b32 v213, 0
    v_mov_b32 v214, 0
    v_mov_b32 v215, 0
    v_mov_b32 v216, 0
    v_mov_b32 v217, 0
    v_mov_b32 v218, 0
    v_mov_b32 v219, 0
    v_mov_b32 v220, 0
    v_mov_b32 v221, 0
    v_mov_b32 v222, 0
    v_mov_b32 v223, 0
    v_mov_b32 v224, 0
    v_mov_b32 v225, 0
    v_mov_b32 v226, 0
    v_mov_b32 v227, 0
    v_mov_b32 v228, 0
    v_mov_b32 v229, 0
    v_mov_b32 v230, 0
    v_mov_b32 v231, 0
    v_mov_b32 v232, 0
    v_mov_b32 v233, 0
    v_mov_b32 v234, 0
    v_mov_b32 v235, 0
    v_mov_b32 v236, 0
    v_mov_b32 v237, 0
    v_mov_b32 v238, 0
    v_mov_b32 v239, 0
    v_mov_b32 v240, 0
    v_mov_b32 v241, 0
    v_mov_b32 v242, 0
    v_mov_b32 v243, 0
    v_mov_b32 v244, 0
    v_mov_b32 v245, 0
    v_mov_b32 v246, 0
    v_mov_b32 v247, 0
    v_mov_b32 v248, 0
    v_mov_b32 v249, 0
    v_mov_b32 v250, 0
    v_mov_b32 v251, 0
    v_mov_b32 v252, 0
    v_mov_b32 v253, 0
    v_mov_b32 v254, 0
    v_mov_b32 v255, 0
    v_mov_b32 v28, 0
    v_mov_b32 v40, 4048155338
    v_mov_b32 v32, 0
    v_mov_b32 v41, 4048155338
    s_lshl_b32 s43, s28, 12
    v_add_u32 v4, s43, v7
    s_mov_b32 s46, s45
    s_sub_u32 s40, 16, s30
    s_mov_b32 s39, s30
    s_lshl_b32 s37, s39, 7
    s_and_b32 s36, s28, 3
    s_lshl_b32 s36, s36, 5
    s_add_u32 s36, s36, s37
    s_sub_u32 s50, 0, s36
L_recurrent_scan__compressed_kv_cla__moe_arch_mod__prompt_kernel_stile_129:
    s_waitcnt vmcnt(0) lgkmcnt(0)
    s_barrier
    s_mov_b32 m0, s43
    s_add_u32 s47, s46, 32768
    buffer_load_dwordx4 v4, s[12:15], s46 offen offset:0 sc1 lds
    buffer_load_dwordx4 v4, s[12:15], s46 offen offset:1024 sc1 lds
    buffer_load_dwordx4 v4, s[12:15], s46 offen offset:2048 sc1 lds
    buffer_load_dwordx4 v4, s[12:15], s46 offen offset:3072 sc1 lds
    s_add_u32 m0, s43, 32768
    s_add_u32 s46, s46, 65536
    buffer_load_dwordx4 v4, s[12:15], s47 offen offset:0 sc1 lds
    buffer_load_dwordx4 v4, s[12:15], s47 offen offset:1024 sc1 lds
    buffer_load_dwordx4 v4, s[12:15], s47 offen offset:2048 sc1 lds
    buffer_load_dwordx4 v4, s[12:15], s47 offen offset:3072 sc1 lds
    v_mov_b32 v2, v7
    s_mov_b32 s41, 4
    s_waitcnt vmcnt(0)
    s_barrier
L_recurrent_scan__compressed_kv_cla__moe_arch_mod__prompt_kernel_sunit_130:
    s_cmp_gt_i32 s50, 0
    s_cbranch_scc1 L_recurrent_scan__compressed_kv_cla__moe_arch_mod__prompt_kernel_snext_131
    ds_read_b128 v[64:67], v2 offset:0
    ds_read_b128 v[68:71], v2 offset:1024
    ds_read_b128 v[72:75], v2 offset:2048
    ds_read_b128 v[76:79], v2 offset:3072
    ds_read_b128 v[80:83], v2 offset:4096
    ds_read_b128 v[84:87], v2 offset:5120
    ds_read_b128 v[88:91], v2 offset:6144
    ds_read_b128 v[92:95], v2 offset:7168
    s_waitcnt lgkmcnt(0)
    v_mfma_f32_16x16x32_bf16 v[96:99], v[64:67], v[128:131], 0
    v_mfma_f32_16x16x32_bf16 v[104:107], v[64:67], v[144:147], 0
    v_mfma_f32_16x16x32_bf16 v[96:99], v[68:71], v[132:135], v[96:99]
    v_mfma_f32_16x16x32_bf16 v[104:107], v[68:71], v[148:151], v[104:107]
    v_mfma_f32_16x16x32_bf16 v[96:99], v[72:75], v[136:139], v[96:99]
    v_mfma_f32_16x16x32_bf16 v[104:107], v[72:75], v[152:155], v[104:107]
    v_mfma_f32_16x16x32_bf16 v[96:99], v[76:79], v[140:143], v[96:99]
    v_mfma_f32_16x16x32_bf16 v[104:107], v[76:79], v[156:159], v[104:107]
    v_mfma_f32_16x16x32_bf16 v[100:103], v[80:83], v[128:131], 0
    v_mfma_f32_16x16x32_bf16 v[108:111], v[80:83], v[144:147], 0
    v_mfma_f32_16x16x32_bf16 v[100:103], v[84:87], v[132:135], v[100:103]
    v_mfma_f32_16x16x32_bf16 v[108:111], v[84:87], v[148:151], v[108:111]
    v_mfma_f32_16x16x32_bf16 v[100:103], v[88:91], v[136:139], v[100:103]
    v_mfma_f32_16x16x32_bf16 v[108:111], v[88:91], v[152:155], v[108:111]
    v_mfma_f32_16x16x32_bf16 v[100:103], v[92:95], v[140:143], v[100:103]
    v_mfma_f32_16x16x32_bf16 v[108:111], v[92:95], v[156:159], v[108:111]
    ds_read_b128 v[64:67], v2 offset:32768
    ds_read_b128 v[68:71], v2 offset:33792
    ds_read_b128 v[72:75], v2 offset:34816
    ds_read_b128 v[76:79], v2 offset:35840
    ds_read_b128 v[80:83], v2 offset:36864
    ds_read_b128 v[84:87], v2 offset:37888
    ds_read_b128 v[88:91], v2 offset:38912
    ds_read_b128 v[92:95], v2 offset:39936
    s_nop 1
    s_cmp_lt_i32 s50, 0
    s_cbranch_scc0 L_recurrent_scan__compressed_kv_cla__moe_arch_mod__prompt_kernel_rare_132
L_recurrent_scan__compressed_kv_cla__moe_arch_mod__prompt_kernel_back_133:
    v_max3_f32 v22, v96, v97, v98
    v_max3_f32 v22, v22, v99, v100
    v_max3_f32 v22, v22, v101, v102
    v_max3_f32 v22, v22, v103, v40
    v_mov_b32 v24, v22
    s_nop 1
    v_permlane16_swap_b32 v22, v24
    s_nop 1
    v_max_f32 v22, v22, v24
    v_mov_b32 v24, v22
    s_nop 1
    v_permlane32_swap_b32 v22, v24
    s_nop 1
    v_max_f32 v22, v22, v24
    v_sub_f32 v25, v40, v22
    v_exp_f32 v25, v25
    v_mov_b32 v40, v22
    v_mul_f32 v28, v28, v25
    v_mul_f32 v192, v192, v25
    v_mul_f32 v193, v193, v25
    v_mul_f32 v194, v194, v25
    v_mul_f32 v195, v195, v25
    v_mul_f32 v196, v196, v25
    v_mul_f32 v197, v197, v25
    v_mul_f32 v198, v198, v25
    v_mul_f32 v199, v199, v25
    v_mul_f32 v200, v200, v25
    v_mul_f32 v201, v201, v25
    v_mul_f32 v202, v202, v25
    v_mul_f32 v203, v203, v25
    v_mul_f32 v204, v204, v25
    v_mul_f32 v205, v205, v25
    v_mul_f32 v206, v206, v25
    v_mul_f32 v207, v207, v25
    v_mul_f32 v208, v208, v25
    v_mul_f32 v209, v209, v25
    v_mul_f32 v210, v210, v25
    v_mul_f32 v211, v211, v25
    v_mul_f32 v212, v212, v25
    v_mul_f32 v213, v213, v25
    v_mul_f32 v214, v214, v25
    v_mul_f32 v215, v215, v25
    v_mul_f32 v216, v216, v25
    v_mul_f32 v217, v217, v25
    v_mul_f32 v218, v218, v25
    v_mul_f32 v219, v219, v25
    v_mul_f32 v220, v220, v25
    v_mul_f32 v221, v221, v25
    v_mul_f32 v222, v222, v25
    v_mul_f32 v223, v223, v25
    v_sub_f32 v96, v96, v22
    v_sub_f32 v97, v97, v22
    v_sub_f32 v98, v98, v22
    v_sub_f32 v99, v99, v22
    v_sub_f32 v100, v100, v22
    v_sub_f32 v101, v101, v22
    v_sub_f32 v102, v102, v22
    v_sub_f32 v103, v103, v22
    v_max3_f32 v23, v104, v105, v106
    v_max3_f32 v23, v23, v107, v108
    v_max3_f32 v23, v23, v109, v110
    v_max3_f32 v23, v23, v111, v41
    v_mov_b32 v24, v23
    s_nop 1
    v_permlane16_swap_b32 v23, v24
    s_nop 1
    v_max_f32 v23, v23, v24
    v_mov_b32 v24, v23
    s_nop 1
    v_permlane32_swap_b32 v23, v24
    s_nop 1
    v_max_f32 v23, v23, v24
    v_sub_f32 v25, v41, v23
    v_exp_f32 v25, v25
    v_mov_b32 v41, v23
    v_mul_f32 v32, v32, v25
    v_mul_f32 v224, v224, v25
    v_mul_f32 v225, v225, v25
    v_mul_f32 v226, v226, v25
    v_mul_f32 v227, v227, v25
    v_mul_f32 v228, v228, v25
    v_mul_f32 v229, v229, v25
    v_mul_f32 v230, v230, v25
    v_mul_f32 v231, v231, v25
    v_mul_f32 v232, v232, v25
    v_mul_f32 v233, v233, v25
    v_mul_f32 v234, v234, v25
    v_mul_f32 v235, v235, v25
    v_mul_f32 v236, v236, v25
    v_mul_f32 v237, v237, v25
    v_mul_f32 v238, v238, v25
    v_mul_f32 v239, v239, v25
    v_mul_f32 v240, v240, v25
    v_mul_f32 v241, v241, v25
    v_mul_f32 v242, v242, v25
    v_mul_f32 v243, v243, v25
    v_mul_f32 v244, v244, v25
    v_mul_f32 v245, v245, v25
    v_mul_f32 v246, v246, v25
    v_mul_f32 v247, v247, v25
    v_mul_f32 v248, v248, v25
    v_mul_f32 v249, v249, v25
    v_mul_f32 v250, v250, v25
    v_mul_f32 v251, v251, v25
    v_mul_f32 v252, v252, v25
    v_mul_f32 v253, v253, v25
    v_mul_f32 v254, v254, v25
    v_mul_f32 v255, v255, v25
    v_sub_f32 v104, v104, v23
    v_sub_f32 v105, v105, v23
    v_sub_f32 v106, v106, v23
    v_sub_f32 v107, v107, v23
    v_sub_f32 v108, v108, v23
    v_sub_f32 v109, v109, v23
    v_sub_f32 v110, v110, v23
    v_sub_f32 v111, v111, v23
    v_exp_f32 v96, v96
    v_exp_f32 v97, v97
    v_exp_f32 v98, v98
    v_exp_f32 v99, v99
    v_exp_f32 v104, v104
    v_exp_f32 v105, v105
    v_exp_f32 v106, v106
    v_exp_f32 v107, v107
    v_exp_f32 v100, v100
    v_exp_f32 v101, v101
    v_exp_f32 v102, v102
    v_exp_f32 v103, v103
    v_exp_f32 v108, v108
    v_exp_f32 v109, v109
    v_exp_f32 v110, v110
    v_exp_f32 v111, v111
    v_add_f32 v28, v28, v96
    v_add_f32 v28, v28, v97
    v_cvt_pk_bf16_f32 v48, v96, v97
    v_add_f32 v28, v28, v98
    v_add_f32 v28, v28, v99
    v_cvt_pk_bf16_f32 v49, v98, v99
    v_add_f32 v32, v32, v104
    v_add_f32 v32, v32, v105
    v_cvt_pk_bf16_f32 v52, v104, v105
    v_add_f32 v32, v32, v106
    v_add_f32 v32, v32, v107
    v_cvt_pk_bf16_f32 v53, v106, v107
    v_add_f32 v28, v28, v100
    v_add_f32 v28, v28, v101
    v_cvt_pk_bf16_f32 v50, v100, v101
    v_add_f32 v28, v28, v102
    v_add_f32 v28, v28, v103
    v_cvt_pk_bf16_f32 v51, v102, v103
    v_add_f32 v32, v32, v108
    v_add_f32 v32, v32, v109
    v_cvt_pk_bf16_f32 v54, v108, v109
    v_add_f32 v32, v32, v110
    v_add_f32 v32, v32, v111
    v_cvt_pk_bf16_f32 v55, v110, v111
    s_waitcnt lgkmcnt(0)
    s_nop 0
    v_mfma_f32_16x16x32_bf16 v[192:195], v[64:67], v[48:51], v[192:195]
    v_mfma_f32_16x16x32_bf16 v[224:227], v[64:67], v[52:55], v[224:227]
    v_mfma_f32_16x16x32_bf16 v[196:199], v[68:71], v[48:51], v[196:199]
    v_mfma_f32_16x16x32_bf16 v[228:231], v[68:71], v[52:55], v[228:231]
    v_mfma_f32_16x16x32_bf16 v[200:203], v[72:75], v[48:51], v[200:203]
    v_mfma_f32_16x16x32_bf16 v[232:235], v[72:75], v[52:55], v[232:235]
    v_mfma_f32_16x16x32_bf16 v[204:207], v[76:79], v[48:51], v[204:207]
    v_mfma_f32_16x16x32_bf16 v[236:239], v[76:79], v[52:55], v[236:239]
    v_mfma_f32_16x16x32_bf16 v[208:211], v[80:83], v[48:51], v[208:211]
    v_mfma_f32_16x16x32_bf16 v[240:243], v[80:83], v[52:55], v[240:243]
    v_mfma_f32_16x16x32_bf16 v[212:215], v[84:87], v[48:51], v[212:215]
    v_mfma_f32_16x16x32_bf16 v[244:247], v[84:87], v[52:55], v[244:247]
    v_mfma_f32_16x16x32_bf16 v[216:219], v[88:91], v[48:51], v[216:219]
    v_mfma_f32_16x16x32_bf16 v[248:251], v[88:91], v[52:55], v[248:251]
    v_mfma_f32_16x16x32_bf16 v[220:223], v[92:95], v[48:51], v[220:223]
    v_mfma_f32_16x16x32_bf16 v[252:255], v[92:95], v[52:55], v[252:255]
L_recurrent_scan__compressed_kv_cla__moe_arch_mod__prompt_kernel_snext_131:
    v_add_u32 v2, 8192, v2
    s_add_u32 s50, s50, 32
    s_sub_u32 s41, s41, 1
    s_cmp_lg_u32 s41, 0
    s_cbranch_scc1 L_recurrent_scan__compressed_kv_cla__moe_arch_mod__prompt_kernel_sunit_130
    s_sub_u32 s40, s40, 1
    s_cmp_lg_u32 s40, 0
    s_cbranch_scc1 L_recurrent_scan__compressed_kv_cla__moe_arch_mod__prompt_kernel_stile_129
    v_mov_b32 v20, v28
    s_nop 1
    v_permlane16_swap_b32 v28, v20
    s_nop 1
    v_add_f32 v28, v28, v20
    v_mov_b32 v20, v28
    s_nop 1
    v_permlane32_swap_b32 v28, v20
    s_nop 1
    v_add_f32 v28, v28, v20
    v_mov_b32 v20, v32
    s_nop 1
    v_permlane16_swap_b32 v32, v20
    s_nop 1
    v_add_f32 v32, v32, v20
    v_mov_b32 v20, v32
    s_nop 1
    v_permlane32_swap_b32 v32, v20
    s_nop 1
    v_add_f32 v32, v32, v20
    s_mov_b32 s36, 0x5d800000
    v_cmp_nge_f32 vcc, s36, v28
    s_nop 0
    s_or_b64 s[52:53], s[52:53], vcc
    v_cmp_nge_f32 vcc, s36, v32
    s_nop 0
    s_or_b64 s[52:53], s[52:53], vcc
    v_rcp_f32 v20, v28
    v_rcp_f32 v22, v32
    s_lshl_b32 s38, s39, 3
    s_and_b32 s37, s28, 3
    s_lshl_b32 s37, s37, 1
    s_add_u32 s38, s38, s37
    s_lshl_b32 s38, s38, 17
    s_lshl_b32 s37, s29, 12
    s_add_u32 s38, s38, s37
    v_mov_b32 v21, v20
    v_mov_b32 v23, v22
    v_mov_b32 v24, v7
    v_pk_mul_f32 v[192:193], v[192:193], v[20:21]
    v_pk_mul_f32 v[194:195], v[194:195], v[20:21]
    v_pk_mul_f32 v[196:197], v[196:197], v[20:21]
    v_pk_mul_f32 v[198:199], v[198:199], v[20:21]
    v_cvt_pk_bf16_f32 v192, v192, v193
    v_cvt_pk_bf16_f32 v193, v194, v195
    v_cvt_pk_bf16_f32 v194, v196, v197
    v_cvt_pk_bf16_f32 v195, v198, v199
    buffer_store_dwordx4 v[192:195], v24, s[16:19], s38 offen offset:0 sc1
    v_pk_mul_f32 v[200:201], v[200:201], v[20:21]
    v_pk_mul_f32 v[202:203], v[202:203], v[20:21]
    v_pk_mul_f32 v[204:205], v[204:205], v[20:21]
    v_pk_mul_f32 v[206:207], v[206:207], v[20:21]
    v_cvt_pk_bf16_f32 v200, v200, v201
    v_cvt_pk_bf16_f32 v201, v202, v203
    v_cvt_pk_bf16_f32 v202, v204, v205
    v_cvt_pk_bf16_f32 v203, v206, v207
    buffer_store_dwordx4 v[200:203], v24, s[16:19], s38 offen offset:1024 sc1
    v_pk_mul_f32 v[208:209], v[208:209], v[20:21]
    v_pk_mul_f32 v[210:211], v[210:211], v[20:21]
    v_pk_mul_f32 v[212:213], v[212:213], v[20:21]
    v_pk_mul_f32 v[214:215], v[214:215], v[20:21]
    v_cvt_pk_bf16_f32 v208, v208, v209
    v_cvt_pk_bf16_f32 v209, v210, v211
    v_cvt_pk_bf16_f32 v210, v212, v213
    v_cvt_pk_bf16_f32 v211, v214, v215
    buffer_store_dwordx4 v[208:211], v24, s[16:19], s38 offen offset:2048 sc1
    v_pk_mul_f32 v[216:217], v[216:217], v[20:21]
    v_pk_mul_f32 v[218:219], v[218:219], v[20:21]
    v_pk_mul_f32 v[220:221], v[220:221], v[20:21]
    v_pk_mul_f32 v[222:223], v[222:223], v[20:21]
    v_cvt_pk_bf16_f32 v216, v216, v217
    v_cvt_pk_bf16_f32 v217, v218, v219
    v_cvt_pk_bf16_f32 v218, v220, v221
    v_cvt_pk_bf16_f32 v219, v222, v223
    buffer_store_dwordx4 v[216:219], v24, s[16:19], s38 offen offset:3072 sc1
    s_add_u32 s38, s38, 131072
    v_pk_mul_f32 v[224:225], v[224:225], v[22:23]
    v_pk_mul_f32 v[226:227], v[226:227], v[22:23]
    v_pk_mul_f32 v[228:229], v[228:229], v[22:23]
    v_pk_mul_f32 v[230:231], v[230:231], v[22:23]
    v_cvt_pk_bf16_f32 v224, v224, v225
    v_cvt_pk_bf16_f32 v225, v226, v227
    v_cvt_pk_bf16_f32 v226, v228, v229
    v_cvt_pk_bf16_f32 v227, v230, v231
    buffer_store_dwordx4 v[224:227], v24, s[16:19], s38 offen offset:0 sc1
    v_pk_mul_f32 v[232:233], v[232:233], v[22:23]
    v_pk_mul_f32 v[234:235], v[234:235], v[22:23]
    v_pk_mul_f32 v[236:237], v[236:237], v[22:23]
    v_pk_mul_f32 v[238:239], v[238:239], v[22:23]
    v_cvt_pk_bf16_f32 v232, v232, v233
    v_cvt_pk_bf16_f32 v233, v234, v235
    v_cvt_pk_bf16_f32 v234, v236, v237
    v_cvt_pk_bf16_f32 v235, v238, v239
    buffer_store_dwordx4 v[232:235], v24, s[16:19], s38 offen offset:1024 sc1
    v_pk_mul_f32 v[240:241], v[240:241], v[22:23]
    v_pk_mul_f32 v[242:243], v[242:243], v[22:23]
    v_pk_mul_f32 v[244:245], v[244:245], v[22:23]
    v_pk_mul_f32 v[246:247], v[246:247], v[22:23]
    v_cvt_pk_bf16_f32 v240, v240, v241
    v_cvt_pk_bf16_f32 v241, v242, v243
    v_cvt_pk_bf16_f32 v242, v244, v245
    v_cvt_pk_bf16_f32 v243, v246, v247
    buffer_store_dwordx4 v[240:243], v24, s[16:19], s38 offen offset:2048 sc1
    v_pk_mul_f32 v[248:249], v[248:249], v[22:23]
    v_pk_mul_f32 v[250:251], v[250:251], v[22:23]
    v_pk_mul_f32 v[252:253], v[252:253], v[22:23]
    v_pk_mul_f32 v[254:255], v[254:255], v[22:23]
    v_cvt_pk_bf16_f32 v248, v248, v249
    v_cvt_pk_bf16_f32 v249, v250, v251
    v_cvt_pk_bf16_f32 v250, v252, v253
    v_cvt_pk_bf16_f32 v251, v254, v255
    buffer_store_dwordx4 v[248:251], v24, s[16:19], s38 offen offset:3072 sc1
    v_mov_b32 v96, v112
    v_mov_b32 v97, v113
    v_mov_b32 v98, v114
    v_mov_b32 v99, v115
    v_mov_b32 v100, v116
    v_mov_b32 v101, v117
    v_mov_b32 v102, v118
    v_mov_b32 v103, v119
    s_branch L_p3_done
L_recurrent_scan__compressed_kv_cla__moe_arch_mod__prompt_kernel_rare_100:
    s_lshl_b32 s36, s29, 7
    s_cmp_eq_u32 s30, 0
    s_cselect_b32 s37, 4, 0
    s_add_u32 s36, s36, s37
    v_mov_b32 v20, s36
    v_mov_b32 v21, 1
    s_mov_b64 exec, 1
    global_atomic_add v20, v21, s[90:91]
    s_mov_b64 exec, -1
    s_nop 3
    s_branch L_recurrent_scan__compressed_kv_cla__moe_arch_mod__prompt_kernel_back_101
L_recurrent_scan__compressed_kv_cla__moe_arch_mod__prompt_kernel_rare_103:
    s_cmp_lt_i32 s36, 0
    s_cbranch_scc1 L_recurrent_scan__compressed_kv_cla__moe_arch_mod__prompt_kernel_nm_102
    v_mov_b32 v20, 4048155338
    v_subrev_u32 v21, s36, v18
    v_cmp_gt_i32 s[20:21], 0, v21
    v_cmp_gt_i32 s[22:23], 1, v21
    v_cmp_gt_i32 s[62:63], 2, v21
    v_cmp_gt_i32 vcc, 3, v21
    v_cndmask_b32 v96, v96, v20, s[20:21]
    v_cndmask_b32 v97, v97, v20, s[22:23]
    v_cndmask_b32 v98, v98, v20, s[62:63]
    v_cndmask_b32 v99, v99, v20, vcc
    v_cmp_gt_i32 s[20:21], 16, v21
    v_cmp_gt_i32 s[22:23], 17, v21
    v_cmp_gt_i32 s[62:63], 18, v21
    v_cmp_gt_i32 vcc, 19, v21
    v_cndmask_b32 v100, v100, v20, s[20:21]
    v_cndmask_b32 v101, v101, v20, s[22:23]
    v_cndmask_b32 v102, v102, v20, s[62:63]
    v_cndmask_b32 v103, v103, v20, vcc
    v_cmp_gt_i32 s[20:21], -16, v21
    v_cmp_gt_i32 s[22:23], -15, v21
    v_cmp_gt_i32 s[62:63], -14, v21
    v_cmp_gt_i32 vcc, -13, v21
    v_cndmask_b32 v104, v104, v20, s[20:21]
    v_cndmask_b32 v105, v105, v20, s[22:23]
    v_cndmask_b32 v106, v106, v20, s[62:63]
    v_cndmask_b32 v107, v107, v20, vcc
    v_cmp_gt_i32 s[20:21], 0, v21
    v_cmp_gt_i32 s[22:23], 1, v21
    v_cmp_gt_i32 s[62:63], 2, v21
    v_cmp_gt_i32 vcc, 3, v21
    v_cndmask_b32 v108, v108, v20, s[20:21]
    v_cndmask_b32 v109, v109, v20, s[22:23]
    v_cndmask_b32 v110, v110, v20, s[62:63]
    v_cndmask_b32 v111, v111, v20, vcc
L_recurrent_scan__compressed_kv_cla__moe_arch_mod__prompt_kernel_nm_102:
    s_branch L_recurrent_scan__compressed_kv_cla__moe_arch_mod__prompt_kernel_back_104
L_recurrent_scan__compressed_kv_cla__moe_arch_mod__prompt_kernel_rare_110:
    s_add_u32 s36, s40, 1
    s_sub_u32 s36, s36, s51
    s_cmp_lt_u32 s36, 2
    s_cbranch_scc0 L_recurrent_scan__compressed_kv_cla__moe_arch_mod__prompt_kernel_r_106
    s_lshl_b32 s36, s36, 6
    s_add_u32 s36, s36, 32
    s_sub_u32 s36, s36, s50
    s_cmp_lt_i32 s36, 0
    s_cbranch_scc1 L_recurrent_scan__compressed_kv_cla__moe_arch_mod__prompt_kernel_nm_109
    v_mov_b32 v20, 4048155338
    v_subrev_u32 v21, s36, v18
    v_cmp_gt_i32 s[20:21], 0, v21
    v_cmp_gt_i32 s[22:23], 1, v21
    v_cmp_gt_i32 s[62:63], 2, v21
    v_cmp_gt_i32 vcc, 3, v21
    v_cndmask_b32 v112, v112, v20, s[20:21]
    v_cndmask_b32 v113, v113, v20, s[22:23]
    v_cndmask_b32 v114, v114, v20, s[62:63]
    v_cndmask_b32 v115, v115, v20, vcc
    v_cmp_gt_i32 s[20:21], 16, v21
    v_cmp_gt_i32 s[22:23], 17, v21
    v_cmp_gt_i32 s[62:63], 18, v21
    v_cmp_gt_i32 vcc, 19, v21
    v_cndmask_b32 v116, v116, v20, s[20:21]
    v_cndmask_b32 v117, v117, v20, s[22:23]
    v_cndmask_b32 v118, v118, v20, s[62:63]
    v_cndmask_b32 v119, v119, v20, vcc
    v_cmp_gt_i32 s[20:21], -16, v21
    v_cmp_gt_i32 s[22:23], -15, v21
    v_cmp_gt_i32 s[62:63], -14, v21
    v_cmp_gt_i32 vcc, -13, v21
    v_cndmask_b32 v120, v120, v20, s[20:21]
    v_cndmask_b32 v121, v121, v20, s[22:23]
    v_cndmask_b32 v122, v122, v20, s[62:63]
    v_cndmask_b32 v123, v123, v20, vcc
    v_cmp_gt_i32 s[20:21], 0, v21
    v_cmp_gt_i32 s[22:23], 1, v21
    v_cmp_gt_i32 s[62:63], 2, v21
    v_cmp_gt_i32 vcc, 3, v21
    v_cndmask_b32 v124, v124, v20, s[20:21]
    v_cndmask_b32 v125, v125, v20, s[22:23]
    v_cndmask_b32 v126, v126, v20, s[62:63]
    v_cndmask_b32 v127, v127, v20, vcc
L_recurrent_scan__compressed_kv_cla__moe_arch_mod__prompt_kernel_nm_109:
L_recurrent_scan__compressed_kv_cla__moe_arch_mod__prompt_kernel_r_106:
    s_branch L_recurrent_scan__compressed_kv_cla__moe_arch_mod__prompt_kernel_back_111
L_recurrent_scan__compressed_kv_cla__moe_arch_mod__prompt_kernel_rare_113:
    s_add_u32 s36, s40, 2
    s_sub_u32 s36, s36, s51
    s_cmp_eq_u32 s36, 1
    s_cselect_b32 s41, 0x8000, s41
    s_cmp_eq_u32 s40, 15
    s_cbranch_scc0 L_recurrent_scan__compressed_kv_cla__moe_arch_mod__prompt_kernel_r_107
    s_mov_b32 s41, 65536
    s_mov_b32 s49, 0x1ffff
    s_mov_b32 s36, 1
L_recurrent_scan__compressed_kv_cla__moe_arch_mod__prompt_kernel_r_107:
    s_cmp_lt_u32 s36, 2
    s_cbranch_scc0 L_recurrent_scan__compressed_kv_cla__moe_arch_mod__prompt_kernel_r_108
    s_lshl_b32 s36, s36, 6
    s_sub_u32 s36, s36, s50
    s_cmp_lt_i32 s36, 0
    s_cbranch_scc1 L_recurrent_scan__compressed_kv_cla__moe_arch_mod__prompt_kernel_nm_112
    v_mov_b32 v20, 4048155338
    v_subrev_u32 v21, s36, v18
    v_cmp_gt_i32 s[20:21], 0, v21
    v_cmp_gt_i32 s[22:23], 1, v21
    v_cmp_gt_i32 s[62:63], 2, v21
    v_cmp_gt_i32 vcc, 3, v21
    v_cndmask_b32 v96, v96, v20, s[20:21]
    v_cndmask_b32 v97, v97, v20, s[22:23]
    v_cndmask_b32 v98, v98, v20, s[62:63]
    v_cndmask_b32 v99, v99, v20, vcc
    v_cmp_gt_i32 s[20:21], 16, v21
    v_cmp_gt_i32 s[22:23], 17, v21
    v_cmp_gt_i32 s[62:63], 18, v21
    v_cmp_gt_i32 vcc, 19, v21
    v_cndmask_b32 v100, v100, v20, s[20:21]
    v_cndmask_b32 v101, v101, v20, s[22:23]
    v_cndmask_b32 v102, v102, v20, s[62:63]
    v_cndmask_b32 v103, v103, v20, vcc
    v_cmp_gt_i32 s[20:21], -16, v21
    v_cmp_gt_i32 s[22:23], -15, v21
    v_cmp_gt_i32 s[62:63], -14, v21
    v_cmp_gt_i32 vcc, -13, v21
    v_cndmask_b32 v104, v104, v20, s[20:21]
    v_cndmask_b32 v105, v105, v20, s[22:23]
    v_cndmask_b32 v106, v106, v20, s[62:63]
    v_cndmask_b32 v107, v107, v20, vcc
    v_cmp_gt_i32 s[20:21], 0, v21
    v_cmp_gt_i32 s[22:23], 1, v21
    v_cmp_gt_i32 s[62:63], 2, v21
    v_cmp_gt_i32 vcc, 3, v21
    v_cndmask_b32 v108, v108, v20, s[20:21]
    v_cndmask_b32 v109, v109, v20, s[22:23]
    v_cndmask_b32 v110, v110, v20, s[62:63]
    v_cndmask_b32 v111, v111, v20, vcc
L_recurrent_scan__compressed_kv_cla__moe_arch_mod__prompt_kernel_nm_112:
L_recurrent_scan__compressed_kv_cla__moe_arch_mod__prompt_kernel_r_108:
    s_branch L_recurrent_scan__compressed_kv_cla__moe_arch_mod__prompt_kernel_back_114
L_recurrent_scan__compressed_kv_cla__moe_arch_mod__prompt_kernel_rare_116:
    v_mov_b32 v20, 4048155338
    v_subrev_u32 v21, s36, v18
    v_cmp_gt_i32 s[20:21], 0, v21
    v_cmp_gt_i32 s[22:23], 1, v21
    v_cmp_gt_i32 s[62:63], 2, v21
    v_cmp_gt_i32 vcc, 3, v21
    v_cndmask_b32 v112, v112, v20, s[20:21]
    v_cndmask_b32 v113, v113, v20, s[22:23]
    v_cndmask_b32 v114, v114, v20, s[62:63]
    v_cndmask_b32 v115, v115, v20, vcc
    v_cmp_gt_i32 s[20:21], 16, v21
    v_cmp_gt_i32 s[22:23], 17, v21
    v_cmp_gt_i32 s[62:63], 18, v21
    v_cmp_gt_i32 vcc, 19, v21
    v_cndmask_b32 v116, v116, v20, s[20:21]
    v_cndmask_b32 v117, v117, v20, s[22:23]
    v_cndmask_b32 v118, v118, v20, s[62:63]
    v_cndmask_b32 v119, v119, v20, vcc
    v_cmp_gt_i32 s[20:21], -16, v21
    v_cmp_gt_i32 s[22:23], -15, v21
    v_cmp_gt_i32 s[62:63], -14, v21
    v_cmp_gt_i32 vcc, -13, v21
    v_cndmask_b32 v120, v120, v20, s[20:21]
    v_cndmask_b32 v121, v121, v20, s[22:23]
    v_cndmask_b32 v122, v122, v20, s[62:63]
    v_cndmask_b32 v123, v123, v20, vcc
    v_cmp_gt_i32 s[20:21], 0, v21
    v_cmp_gt_i32 s[22:23], 1, v21
    v_cmp_gt_i32 s[62:63], 2, v21
    v_cmp_gt_i32 vcc, 3, v21
    v_cndmask_b32 v124, v124, v20, s[20:21]
    v_cndmask_b32 v125, v125, v20, s[22:23]
    v_cndmask_b32 v126, v126, v20, s[62:63]
    v_cndmask_b32 v127, v127, v20, vcc
    s_branch L_recurrent_scan__compressed_kv_cla__moe_arch_mod__prompt_kernel_back_117
L_recurrent_scan__compressed_kv_cla__moe_arch_mod__prompt_kernel_rare_123:
    s_cmp_eq_u32 s40, 0
    s_cbranch_scc0 L_recurrent_scan__compressed_kv_cla__moe_arch_mod__prompt_kernel_nm_118
    ds_read_b64 v[14:15], v19
    s_waitcnt lgkmcnt(0)
L_recurrent_scan__compressed_kv_cla__moe_arch_mod__prompt_kernel_nm_118:
    s_cmp_eq_u32 s40, 12
    s_cbranch_scc0 L_recurrent_scan__compressed_kv_cla__moe_arch_mod__prompt_kernel_bh_121
    s_getpc_b64 s[36:37]
L_recurrent_scan__compressed_kv_cla__moe_arch_mod__prompt_kernel_pc_122:
    s_sub_u32 s36, s36, L_recurrent_scan__compressed_kv_cla__moe_arch_mod__prompt_kernel_pc_122-L_pc
    s_subb_u32 s37, s37, 0
    s_lshr_b32 s38, s2, 3
    s_lshl_b32 s38, s38, 7
    v_lshl_add_u32 v26, v1, 12, s38
    v_min_u32 v26, L_end-L_pc-4, v26
    v_mov_b32 v27, s37
    v_add_co_u32 v26, vcc, s36, v26
    s_mov_b64 exec, 0xffff
    s_nop 0
    v_addc_co_u32 v27, vcc, 0, v27, vcc
    global_load_dword v0, v[26:27], off
    s_mov_b64 exec, -1
    s_nop 1
L_recurrent_scan__compressed_kv_cla__moe_arch_mod__prompt_kernel_bh_121:
    s_add_u32 s36, s40, 1
    s_cmp_eq_u32 s36, s51
    s_cbranch_scc0 L_recurrent_scan__compressed_kv_cla__moe_arch_mod__prompt_kernel_ns_119
    v_swap_b32 v128, v160
    v_swap_b32 v129, v161
    v_swap_b32 v130, v162
    v_swap_b32 v131, v163
    v_swap_b32 v132, v164
    v_swap_b32 v133, v165
    v_swap_b32 v134, v166
    v_swap_b32 v135, v167
    v_swap_b32 v136, v168
    v_swap_b32 v137, v169
    v_swap_b32 v138, v170
    v_swap_b32 v139, v171
    v_swap_b32 v140, v172
    v_swap_b32 v141, v173
    v_swap_b32 v142, v174
    v_swap_b32 v143, v175
    v_swap_b32 v144, v176
    v_swap_b32 v145, v177
    v_swap_b32 v146, v178
    v_swap_b32 v147, v179
    v_swap_b32 v148, v180
    v_swap_b32 v149, v181
    v_swap_b32 v150, v182
    v_swap_b32 v151, v183
    v_swap_b32 v152, v184
    v_swap_b32 v153, v185
    v_swap_b32 v154, v186
    v_swap_b32 v155, v187
    v_swap_b32 v156, v188
    v_swap_b32 v157, v189
    v_swap_b32 v158, v190
    v_swap_b32 v159, v191
    v_mov_b32 v40, v14
    v_mov_b32 v41, v14
    v_mov_b32 v42, v14
    v_mov_b32 v43, v14
    v_mov_b32 v44, v15
    v_mov_b32 v45, v15
    v_mov_b32 v46, v15
    v_mov_b32 v47, v15
    s_nop 1
L_recurrent_scan__compressed_kv_cla__moe_arch_mod__prompt_kernel_ns_119:
    s_cmp_eq_u32 s40, s51
    s_cbranch_scc0 L_recurrent_scan__compressed_kv_cla__moe_arch_mod__prompt_kernel_ne_120
    s_nop 4
    s_mov_b32 s36, 0x5d800000
    v_cmp_nge_f32 vcc, s36, v28
    s_nop 0
    s_or_b64 s[52:53], s[52:53], vcc
    v_cmp_nge_f32 vcc, s36, v32
    s_nop 0
    s_or_b64 s[52:53], s[52:53], vcc
    v_rcp_f32 v20, v28
    v_rcp_f32 v22, v32
    s_lshl_b32 s38, s30, 3
    s_and_b32 s37, s28, 3
    s_lshl_b32 s37, s37, 1
    s_add_u32 s38, s38, s37
    s_lshl_b32 s38, s38, 17
    s_lshl_b32 s37, s29, 12
    s_add_u32 s38, s38, s37
    v_mov_b32 v21, v20
    v_mov_b32 v23, v22
    v_mov_b32 v24, v7
    v_pk_mul_f32 v[192:193], v[192:193], v[20:21]
    v_pk_mul_f32 v[194:195], v[194:195], v[20:21]
    v_pk_mul_f32 v[196:197], v[196:197], v[20:21]
    v_pk_mul_f32 v[198:199], v[198:199], v[20:21]
    v_cvt_pk_bf16_f32 v192, v192, v193
    v_cvt_pk_bf16_f32 v193, v194, v195
    v_cvt_pk_bf16_f32 v194, v196, v197
    v_cvt_pk_bf16_f32 v195, v198, v199
    buffer_store_dwordx4 v[192:195], v24, s[16:19], s38 offen offset:0 sc1
    v_pk_mul_f32 v[200:201], v[200:201], v[20:21]
    v_pk_mul_f32 v[202:203], v[202:203], v[20:21]
    v_pk_mul_f32 v[204:205], v[204:205], v[20:21]
    v_pk_mul_f32 v[206:207], v[206:207], v[20:21]
    v_cvt_pk_bf16_f32 v200, v200, v201
    v_cvt_pk_bf16_f32 v201, v202, v203
    v_cvt_pk_bf16_f32 v202, v204, v205
    v_cvt_pk_bf16_f32 v203, v206, v207
    buffer_store_dwordx4 v[200:203], v24, s[16:19], s38 offen offset:1024 sc1
    v_pk_mul_f32 v[208:209], v[208:209], v[20:21]
    v_pk_mul_f32 v[210:211], v[210:211], v[20:21]
    v_pk_mul_f32 v[212:213], v[212:213], v[20:21]
    v_pk_mul_f32 v[214:215], v[214:215], v[20:21]
    v_cvt_pk_bf16_f32 v208, v208, v209
    v_cvt_pk_bf16_f32 v209, v210, v211
    v_cvt_pk_bf16_f32 v210, v212, v213
    v_cvt_pk_bf16_f32 v211, v214, v215
    buffer_store_dwordx4 v[208:211], v24, s[16:19], s38 offen offset:2048 sc1
    v_pk_mul_f32 v[216:217], v[216:217], v[20:21]
    v_pk_mul_f32 v[218:219], v[218:219], v[20:21]
    v_pk_mul_f32 v[220:221], v[220:221], v[20:21]
    v_pk_mul_f32 v[222:223], v[222:223], v[20:21]
    v_cvt_pk_bf16_f32 v216, v216, v217
    v_cvt_pk_bf16_f32 v217, v218, v219
    v_cvt_pk_bf16_f32 v218, v220, v221
    v_cvt_pk_bf16_f32 v219, v222, v223
    buffer_store_dwordx4 v[216:219], v24, s[16:19], s38 offen offset:3072 sc1
    s_add_u32 s38, s38, 131072
    v_pk_mul_f32 v[224:225], v[224:225], v[22:23]
    v_pk_mul_f32 v[226:227], v[226:227], v[22:23]
    v_pk_mul_f32 v[228:229], v[228:229], v[22:23]
    v_pk_mul_f32 v[230:231], v[230:231], v[22:23]
    v_cvt_pk_bf16_f32 v224, v224, v225
    v_cvt_pk_bf16_f32 v225, v226, v227
    v_cvt_pk_bf16_f32 v226, v228, v229
    v_cvt_pk_bf16_f32 v227, v230, v231
    buffer_store_dwordx4 v[224:227], v24, s[16:19], s38 offen offset:0 sc1
    v_pk_mul_f32 v[232:233], v[232:233], v[22:23]
    v_pk_mul_f32 v[234:235], v[234:235], v[22:23]
    v_pk_mul_f32 v[236:237], v[236:237], v[22:23]
    v_pk_mul_f32 v[238:239], v[238:239], v[22:23]
    v_cvt_pk_bf16_f32 v232, v232, v233
    v_cvt_pk_bf16_f32 v233, v234, v235
    v_cvt_pk_bf16_f32 v234, v236, v237
    v_cvt_pk_bf16_f32 v235, v238, v239
    buffer_store_dwordx4 v[232:235], v24, s[16:19], s38 offen offset:1024 sc1
    v_pk_mul_f32 v[240:241], v[240:241], v[22:23]
    v_pk_mul_f32 v[242:243], v[242:243], v[22:23]
    v_pk_mul_f32 v[244:245], v[244:245], v[22:23]
    v_pk_mul_f32 v[246:247], v[246:247], v[22:23]
    v_cvt_pk_bf16_f32 v240, v240, v241
    v_cvt_pk_bf16_f32 v241, v242, v243
    v_cvt_pk_bf16_f32 v242, v244, v245
    v_cvt_pk_bf16_f32 v243, v246, v247
    buffer_store_dwordx4 v[240:243], v24, s[16:19], s38 offen offset:2048 sc1
    v_pk_mul_f32 v[248:249], v[248:249], v[22:23]
    v_pk_mul_f32 v[250:251], v[250:251], v[22:23]
    v_pk_mul_f32 v[252:253], v[252:253], v[22:23]
    v_pk_mul_f32 v[254:255], v[254:255], v[22:23]
    v_cvt_pk_bf16_f32 v248, v248, v249
    v_cvt_pk_bf16_f32 v249, v250, v251
    v_cvt_pk_bf16_f32 v250, v252, v253
    v_cvt_pk_bf16_f32 v251, v254, v255
    buffer_store_dwordx4 v[248:251], v24, s[16:19], s38 offen offset:3072 sc1
    v_mov_b64 v[28:29], 0
    v_mov_b64 v[30:31], 0
    v_mov_b64 v[32:33], 0
    v_mov_b64 v[34:35], 0
    v_mov_b64 v[192:193], 0
    v_mov_b64 v[194:195], 0
    v_mov_b64 v[196:197], 0
    v_mov_b64 v[198:199], 0
    v_mov_b64 v[200:201], 0
    v_mov_b64 v[202:203], 0
    v_mov_b64 v[204:205], 0
    v_mov_b64 v[206:207], 0
    v_mov_b64 v[208:209], 0
    v_mov_b64 v[210:211], 0
    v_mov_b64 v[212:213], 0
    v_mov_b64 v[214:215], 0
    v_mov_b64 v[216:217], 0
    v_mov_b64 v[218:219], 0
    v_mov_b64 v[220:221], 0
    v_mov_b64 v[222:223], 0
    v_mov_b64 v[224:225], 0
    v_mov_b64 v[226:227], 0
    v_mov_b64 v[228:229], 0
    v_mov_b64 v[230:231], 0
    v_mov_b64 v[232:233], 0
    v_mov_b64 v[234:235], 0
    v_mov_b64 v[236:237], 0
    v_mov_b64 v[238:239], 0
    v_mov_b64 v[240:241], 0
    v_mov_b64 v[242:243], 0
    v_mov_b64 v[244:245], 0
    v_mov_b64 v[246:247], 0
    v_mov_b64 v[248:249], 0
    v_mov_b64 v[250:251], 0
    v_mov_b64 v[252:253], 0
    v_mov_b64 v[254:255], 0
L_recurrent_scan__compressed_kv_cla__moe_arch_mod__prompt_kernel_ne_120:
    s_branch L_recurrent_scan__compressed_kv_cla__moe_arch_mod__prompt_kernel_back_124
L_recurrent_scan__compressed_kv_cla__moe_arch_mod__prompt_kernel_rare_127:
    s_mov_b32 s61, 0x40000
L_recurrent_scan__compressed_kv_cla__moe_arch_mod__prompt_kernel_spin_125:
    s_sub_u32 s61, s61, 1
    s_cbranch_scc1 L_recurrent_scan__compressed_kv_cla__moe_arch_mod__prompt_kernel_spinx_126
    s_sleep 8
    global_load_dword v11, v12, s[90:91] sc1
    s_waitcnt vmcnt(0)
    v_readfirstlane_b32 s36, v11
    s_nop 0
    s_cmp_lt_u32 s36, 28
    s_cbranch_scc1 L_recurrent_scan__compressed_kv_cla__moe_arch_mod__prompt_kernel_spin_125
L_recurrent_scan__compressed_kv_cla__moe_arch_mod__prompt_kernel_spinx_126:
    s_branch L_recurrent_scan__compressed_kv_cla__moe_arch_mod__prompt_kernel_back_128
L_recurrent_scan__compressed_kv_cla__moe_arch_mod__prompt_kernel_rare_132:
    v_mov_b32 v20, 4048155338
    v_subrev_u32 v21, s50, v18
    v_cmp_gt_i32 s[20:21], 0, v21
    v_cmp_gt_i32 s[22:23], 1, v21
    v_cmp_gt_i32 s[62:63], 2, v21
    v_cmp_gt_i32 vcc, 3, v21
    v_cndmask_b32 v96, v96, v20, s[20:21]
    v_cndmask_b32 v97, v97, v20, s[22:23]
    v_cndmask_b32 v98, v98, v20, s[62:63]
    v_cndmask_b32 v99, v99, v20, vcc
    v_cmp_gt_i32 s[20:21], 16, v21
    v_cmp_gt_i32 s[22:23], 17, v21
    v_cmp_gt_i32 s[62:63], 18, v21
    v_cmp_gt_i32 vcc, 19, v21
    v_cndmask_b32 v100, v100, v20, s[20:21]
    v_cndmask_b32 v101, v101, v20, s[22:23]
    v_cndmask_b32 v102, v102, v20, s[62:63]
    v_cndmask_b32 v103, v103, v20, vcc
    v_cmp_gt_i32 s[20:21], -16, v21
    v_cmp_gt_i32 s[22:23], -15, v21
    v_cmp_gt_i32 s[62:63], -14, v21
    v_cmp_gt_i32 vcc, -13, v21
    v_cndmask_b32 v104, v104, v20, s[20:21]
    v_cndmask_b32 v105, v105, v20, s[22:23]
    v_cndmask_b32 v106, v106, v20, s[62:63]
    v_cndmask_b32 v107, v107, v20, vcc
    v_cmp_gt_i32 s[20:21], 0, v21
    v_cmp_gt_i32 s[22:23], 1, v21
    v_cmp_gt_i32 s[62:63], 2, v21
    v_cmp_gt_i32 vcc, 3, v21
    v_cndmask_b32 v108, v108, v20, s[20:21]
    v_cndmask_b32 v109, v109, v20, s[22:23]
    v_cndmask_b32 v110, v110, v20, s[62:63]
    v_cndmask_b32 v111, v111, v20, vcc
    s_branch L_recurrent_scan__compressed_kv_cla__moe_arch_mod__prompt_kernel_back_133
L_p3_done:
    s_and_b32 s36, s29, 28
    s_sub_u32 s40, 47, s30
    s_lshl_b32 s40, s40, 7
    s_add_u32 s40, s40, s36
    s_add_u32 s41, s30, 32
    s_lshl_b32 s41, s41, 7
    s_add_u32 s41, s41, s36
    s_lshr_b32 s63, s29, 4
    s_lshl_b32 s36, s30, 2
    s_lshr_b32 s30, 0x76534210, s36
    s_and_b32 s30, s30, 7
    s_and_b32 s36, s30, 4
    s_add_u32 s43, s30, s36
    s_lshl_b32 s36, s63, 2
    s_add_u32 s30, s43, s36
    s_and_b32 s29, s29, 15
    s_and_b32 s36, s28, 3
    s_lshl_b32 s37, s29, 2
    s_add_u32 s36, s36, s37
    s_lshl_b32 s36, s36, 18
    s_lshr_b32 s37, s28, 2
    s_lshl_b32 s37, s37, 12
    s_add_u32 s36, s36, s37
    s_lshl_b32 s37, s63, 16
    s_add_u32 s36, s36, s37
    s_lshr_b32 s37, s28, 2
    s_lshl_b32 s37, s37, 17
    s_add_u32 s36, s36, s37
    v_lshl_add_u32 v2, v1, 4, s36
    v_xor_b32 v3, 131072, v2
    v_lshrrev_b32 v19, 4, v1
    s_lshr_b32 s36, s28, 2
    s_lshl_b32 s36, s36, 7
    s_and_b32 s37, s28, 3
    s_lshl_b32 s37, s37, 4
    s_add_u32 s36, s36, s37
    s_lshl_b32 s33, s36, 8
    s_lshl_b32 s37, s63, 11
    s_add_u32 s36, s36, s37
    v_add_u32 v18, s36, v19
    v_lshlrev_b32 v18, 11, v18
    s_lshl_b32 s36, s43, 7
    v_add_u32 v18, s36, v18
    v_lshlrev_b32 v20, 1, v19
    v_and_b32 v21, 7, v1
    v_xor_b32 v20, v20, v21
    v_lshl_add_u32 v18, v20, 4, v18
    v_and_b32 v21, 8, v1
    v_lshl_add_u32 v6, v21, 6, v18
    v_xor_b32 v21, 8, v21
    v_lshl_add_u32 v7, v21, 6, v18
    v_add_u32 v7, 7168, v7
    v_add_u32 v8, 14336, v6
    v_add_u32 v9, 14336, v7
    s_add_u32 s36, s2, 1
    s_mov_b32 s62, 0
    s_lshl_b32 s31, s62, 14
    s_lshl_b32 s32, s62, 20
    s_add_u32 s4, s54, 41943040
    s_addc_u32 s5, s55, 0
    s_and_b32 s5, s5, 0xffff
    s_mov_b32 s6, 117440640
    s_mov_b32 s7, 0x20000
    s_mov_b32 s16, s96
    s_and_b32 s17, s97, 0xffff
    s_mov_b32 s18, 4194304
    s_mov_b32 s19, 0x20000
    s_mov_b32 s20, s98
    s_and_b32 s21, s99, 0xffff
    s_mov_b32 s22, 4194304
    s_mov_b32 s23, 0x20000
    s_lshl_b32 s36, s29, 7
    s_and_b32 s37, s28, 3
    s_lshl_b32 s37, s37, 5
    s_add_u32 s36, s36, s37
    s_lshr_b32 s37, s28, 2
    s_lshl_b32 s37, s37, 4
    s_add_u32 s38, s36, s37
    v_and_b32 v17, 15, v1
    v_add_u32 v14, s38, v17
    v_lshlrev_b32 v16, 3, v14
    v_lshrrev_b32 v15, 3, v1
    v_add_u32 v15, s38, v15
    v_lshlrev_b32 v15, 11, v15
    v_and_b32 v4, 7, v1
    v_lshl_add_u32 v15, v4, 4, v15
    s_lshl_b32 s36, s30, 7
    v_add_u32 v15, s36, v15
    s_lshl_b32 s36, s28, 12
    s_add_u32 s42, s36, 131072
    v_lshl_add_u32 v17, v17, 7, s42
    v_lshl_add_u32 v17, v19, 3, v17
    v_bfe_u32 v20, v1, 2, 2
    v_lshl_add_u32 v18, v19, 2, v20
    v_and_b32 v20, 7, v18
    s_lshl_b32 s36, s63, 2
    s_xor_b32 s36, s36, 4
    v_xor_b32 v20, s36, v20
    v_lshlrev_b32 v18, 8, v18
    s_lshr_b32 s36, s28, 2
    s_lshl_b32 s36, s36, 15
    s_add_u32 s36, s36, 65536
    v_add_u32 v18, s36, v18
    v_and_b32 v21, 3, v1
    v_lshl_add_u32 v18, v21, 3, v18
    v_xor_b32 v21, 0, v20
    v_lshl_add_u32 v50, v21, 5, v18
    v_xor_b32 v21, 1, v20
    v_lshl_add_u32 v51, v21, 5, v18
    v_xor_b32 v21, 2, v20
    v_lshl_add_u32 v52, v21, 5, v18
    v_xor_b32 v21, 3, v20
    v_lshl_add_u32 v53, v21, 5, v18
    v_xor_b32 v21, 4, v20
    v_lshl_add_u32 v54, v21, 5, v18
    v_xor_b32 v21, 5, v20
    v_lshl_add_u32 v55, v21, 5, v18
    v_xor_b32 v21, 6, v20
    v_lshl_add_u32 v56, v21, 5, v18
    v_xor_b32 v21, 7, v20
    v_lshl_add_u32 v57, v21, 5, v18
    v_mov_b64 v[192:193], 0
    v_mov_b64 v[194:195], 0
    v_mov_b64 v[196:197], 0
    v_mov_b64 v[198:199], 0
    v_mov_b64 v[200:201], 0
    v_mov_b64 v[202:203], 0
    v_mov_b64 v[204:205], 0
    v_mov_b64 v[206:207], 0
    v_mov_b64 v[208:209], 0
    v_mov_b64 v[210:211], 0
    v_mov_b64 v[212:213], 0
    v_mov_b64 v[214:215], 0
    v_mov_b64 v[216:217], 0
    v_mov_b64 v[218:219], 0
    v_mov_b64 v[220:221], 0
    v_mov_b64 v[222:223], 0
    v_mov_b64 v[224:225], 0
    v_mov_b64 v[226:227], 0
    v_mov_b64 v[228:229], 0
    v_mov_b64 v[230:231], 0
    v_mov_b64 v[232:233], 0
    v_mov_b64 v[234:235], 0
    v_mov_b64 v[236:237], 0
    v_mov_b64 v[238:239], 0
    v_mov_b64 v[240:241], 0
    v_mov_b64 v[242:243], 0
    v_mov_b64 v[244:245], 0
    v_mov_b64 v[246:247], 0
    v_mov_b64 v[248:249], 0
    v_mov_b64 v[250:251], 0
    v_mov_b64 v[252:253], 0
    v_mov_b64 v[254:255], 0
    s_waitcnt vmcnt(0)
    s_barrier
    s_cmp_eq_u32 s28, 0
    s_cbranch_scc1 L_recurrent_scan__compressed_kv_cla__moe_arch_mod__prompt_kernel_rare_134
L_recurrent_scan__compressed_kv_cla__moe_arch_mod__prompt_kernel_back_135:
    s_bitcmp1_b32 0x70, s28
    s_cbranch_scc1 L_recurrent_scan__compressed_kv_cla__moe_arch_mod__prompt_kernel_f2m_161
L_recurrent_scan__compressed_kv_cla__moe_arch_mod__prompt_kernel_f2a_162:
    s_mov_b32 s34, s33
    s_add_u32 m0, s34, 65536
    s_nop 0
    buffer_load_dwordx4 v6, s[8:11], s32 offen offset:0 lds
    buffer_load_dwordx4 v7, s[8:11], s32 offen offset:1024 lds
    buffer_load_dwordx4 v8, s[8:11], s32 offen offset:2048 lds
    buffer_load_dwordx4 v9, s[8:11], s32 offen offset:3072 lds
    s_add_u32 s32, s32, 131072
    s_add_u32 m0, s34, 81920
    s_nop 0
    buffer_load_dwordx4 v6, s[8:11], s32 offen offset:0 lds
    buffer_load_dwordx4 v7, s[8:11], s32 offen offset:1024 lds
    buffer_load_dwordx4 v8, s[8:11], s32 offen offset:2048 lds
    buffer_load_dwordx4 v9, s[8:11], s32 offen offset:3072 lds
    s_add_u32 s32, s32, 393216
    s_and_b32 s32, s32, 0x3fffff
    s_add_u32 m0, s34, 0
    s_nop 0
    buffer_load_dwordx4 v6, s[8:11], s32 offen offset:0 lds
    buffer_load_dwordx4 v7, s[8:11], s32 offen offset:1024 lds
    buffer_load_dwordx4 v8, s[8:11], s32 offen offset:2048 lds
    buffer_load_dwordx4 v9, s[8:11], s32 offen offset:3072 lds
    s_add_u32 s32, s32, 131072
    s_cmp_lt_u32 s28, 4
    s_cbranch_scc1 L_recurrent_scan__compressed_kv_cla__moe_arch_mod__prompt_kernel_f2m_161
L_recurrent_scan__compressed_kv_cla__moe_arch_mod__prompt_kernel_f2b_163:
    s_mov_b32 s60, 15
    s_cmp_eq_u32 s28, 3
    s_cbranch_scc0 L_recurrent_scan__compressed_kv_cla__moe_arch_mod__prompt_kernel_w7j_164
    v_add_u32 v58, s62, v1
    v_and_b32 v58, 3, v58
    s_add_u32 s36, s29, 32
    s_lshl_b32 s36, s36, 7
    s_lshl_b32 s37, s63, 4
    s_add_u32 s36, s36, s37
    v_lshl_add_u32 v58, v58, 2, s36
    s_mov_b32 s61, 0x40000
L_recurrent_scan__compressed_kv_cla__moe_arch_mod__prompt_kernel_cspin_165:
    s_sub_u32 s61, s61, 1
    s_cbranch_scc1 L_recurrent_scan__compressed_kv_cla__moe_arch_mod__prompt_kernel_cspinx_166
    global_load_dword v59, v58, s[90:91] sc1
    s_waitcnt vmcnt(0)
L_recurrent_scan__compressed_kv_cla__moe_arch_mod__prompt_kernel_cchk_167:
    v_cmp_le_u32 vcc, 4, v59
    s_nop 0
    s_and_b32 s60, vcc_lo, 15
    s_and_b32 s36, s60, 3
    s_cmp_eq_u32 s36, 3
    s_cbranch_scc1 L_recurrent_scan__compressed_kv_cla__moe_arch_mod__prompt_kernel_cspinx_166
    s_sleep 6
    s_branch L_recurrent_scan__compressed_kv_cla__moe_arch_mod__prompt_kernel_cspin_165
L_recurrent_scan__compressed_kv_cla__moe_arch_mod__prompt_kernel_cspinx_166:
L_recurrent_scan__compressed_kv_cla__moe_arch_mod__prompt_kernel_w7j_164:
    s_waitcnt vmcnt(8)
    s_waitcnt lgkmcnt(0)
    s_barrier
    buffer_load_dwordx4 v[128:131], v2, s[4:7], s31 offen offset:0 sc1
    buffer_load_dwordx4 v[132:135], v3, s[4:7], s31 offen offset:0 sc1
    buffer_load_dwordx4 v[136:139], v2, s[4:7], s31 offen offset:1024 sc1
    buffer_load_dwordx4 v[140:143], v3, s[4:7], s31 offen offset:1024 sc1
    buffer_load_dwordx4 v[144:147], v2, s[4:7], s31 offen offset:2048 sc1
    buffer_load_dwordx4 v[148:151], v3, s[4:7], s31 offen offset:2048 sc1
    buffer_load_dwordx4 v[152:155], v2, s[4:7], s31 offen offset:3072 sc1
    buffer_load_dwordx4 v[156:159], v3, s[4:7], s31 offen offset:3072 sc1
    s_add_u32 s31, s31, 8192
    s_and_b32 s31, s31, 0xffff
    s_cmp_lt_u32 s28, 4
    s_cbranch_scc0 L_recurrent_scan__compressed_kv_cla__moe_arch_mod__prompt_kernel_g_136
    s_lshl_b32 s36, s28, 10
    s_add_u32 s36, s36, 131072
    v_lshl_add_u32 v28, v1, 4, s36
    ds_read_b128 v[96:99], v28 offset:0
    ds_read_b128 v[100:103], v28 offset:4096
    ds_read_b128 v[104:107], v28 offset:8192
    ds_read_b128 v[108:111], v28 offset:12288
    ds_read_b128 v[112:115], v28 offset:16384
    ds_read_b128 v[116:119], v28 offset:20480
    ds_read_b128 v[120:123], v28 offset:24576
    s_lshr_b32 s36, s2, 4
    s_lshl_b32 s36, s36, 13
    s_and_b32 s37, s2, 15
    s_lshl_b32 s37, s37, 8
    s_add_u32 s36, s36, s37
    s_lshl_b32 s37, s28, 6
    s_add_u32 s36, s36, s37
    s_add_u32 s36, s36, 59768832
    v_and_b32 v28, 1, v1
    v_lshlrev_b32 v28, 12, v28
    v_lshl_add_u32 v28, v19, 4, v28
    s_waitcnt lgkmcnt(0)
    v_add_f32 v96, v96, v100
    v_add_f32 v97, v97, v101
    v_add_f32 v98, v98, v102
    v_add_f32 v99, v99, v103
    v_add_f32 v96, v96, v104
    v_add_f32 v97, v97, v105
    v_add_f32 v98, v98, v106
    v_add_f32 v99, v99, v107
    v_add_f32 v96, v96, v108
    v_add_f32 v97, v97, v109
    v_add_f32 v98, v98, v110
    v_add_f32 v99, v99, v111
    v_add_f32 v96, v96, v112
    v_add_f32 v97, v97, v113
    v_add_f32 v98, v98, v114
    v_add_f32 v99, v99, v115
    v_add_f32 v96, v96, v116
    v_add_f32 v97, v97, v117
    v_add_f32 v98, v98, v118
    v_add_f32 v99, v99, v119
    v_add_f32 v96, v96, v120
    v_add_f32 v97, v97, v121
    v_add_f32 v98, v98, v122
    v_add_f32 v99, v99, v123
    s_mov_b32 exec_lo, 0x00030003
    s_mov_b32 exec_hi, 0x00030003
    buffer_store_dwordx4 v[96:99], v28, s[24:27], s36 offen sc1
    s_mov_b64 exec, -1
    s_nop 3
L_recurrent_scan__compressed_kv_cla__moe_arch_mod__prompt_kernel_g_136:
    v_lshlrev_b32 v22, 4, v1
    v_mov_b32 v18, v22
    v_add_u32 v20, s42, v22
    v_xor_b32 v21, 16384, v20
    s_lshl_b32 s36, s2, 15
    s_lshl_b32 s37, s28, 12
    s_add_u32 s36, s36, s37
    s_add_u32 s36, s36, 67108864
    s_mov_b32 s41, s36
    s_xor_b32 s39, s36, 131072
    s_add_u32 s40, s2, 128
    s_lshl_b32 s40, s40, 7
    ds_read_b64_tr_b16 v[64:65], v50 offset:0
    ds_read_b64_tr_b16 v[66:67], v50 offset:4096
    ds_read_b64_tr_b16 v[68:69], v51 offset:0
    ds_read_b64_tr_b16 v[70:71], v51 offset:4096
    ds_read_b64_tr_b16 v[72:73], v52 offset:0
    ds_read_b64_tr_b16 v[74:75], v52 offset:4096
    ds_read_b64_tr_b16 v[76:77], v53 offset:0
    ds_read_b64_tr_b16 v[78:79], v53 offset:4096
    ds_read_b64_tr_b16 v[80:81], v54 offset:0
    ds_read_b64_tr_b16 v[82:83], v54 offset:4096
    ds_read_b64_tr_b16 v[84:85], v55 offset:0
    ds_read_b64_tr_b16 v[86:87], v55 offset:4096
    s_mov_b32 s35, 0
    s_waitcnt vmcnt(0)
    buffer_load_dwordx4 v[160:163], v2, s[4:7], s31 offen offset:0 sc1
    buffer_load_dwordx4 v[164:167], v3, s[4:7], s31 offen offset:0 sc1
    buffer_load_dwordx4 v[168:171], v2, s[4:7], s31 offen offset:1024 sc1
    buffer_load_dwordx4 v[172:175], v3, s[4:7], s31 offen offset:1024 sc1
    .p2align 6
L_p4_loop:
    s_cmp_lg_u32 s35, 0
    s_cbranch_scc1 L_recurrent_scan__compressed_kv_cla__moe_arch_mod__prompt_kernel_rare_144
L_recurrent_scan__compressed_kv_cla__moe_arch_mod__prompt_kernel_back_145:
    s_waitcnt lgkmcnt(8)
    v_mfma_f32_16x16x32_bf16 v[192:195], v[64:67], v[128:131], v[192:195]
    ds_read_b64_tr_b16 v[88:89], v56 offset:0
    buffer_load_dwordx4 v[176:179], v2, s[4:7], s31 offen offset:2048 sc1
    v_mfma_f32_16x16x32_bf16 v[224:227], v[64:67], v[132:135], v[224:227]
    ds_read_b64_tr_b16 v[90:91], v56 offset:4096
    v_mfma_f32_16x16x32_bf16 v[196:199], v[68:71], v[128:131], v[196:199]
    ds_read_b64_tr_b16 v[92:93], v57 offset:0
    v_mfma_f32_16x16x32_bf16 v[228:231], v[68:71], v[132:135], v[228:231]
    ds_read_b64_tr_b16 v[94:95], v57 offset:4096
    s_add_u32 m0, s34, 16384
    s_waitcnt lgkmcnt(8)
    v_mfma_f32_16x16x32_bf16 v[200:203], v[72:75], v[128:131], v[200:203]
    ds_read_b64_tr_b16 v[64:65], v50 offset:8192
    buffer_load_dwordx4 v6, s[8:11], s32 offen offset:0 lds
    v_mfma_f32_16x16x32_bf16 v[232:235], v[72:75], v[132:135], v[232:235]
    ds_read_b64_tr_b16 v[66:67], v50 offset:12288
    v_mfma_f32_16x16x32_bf16 v[204:207], v[76:79], v[128:131], v[204:207]
    ds_read_b64_tr_b16 v[68:69], v51 offset:8192
    v_mfma_f32_16x16x32_bf16 v[236:239], v[76:79], v[132:135], v[236:239]
    ds_read_b64_tr_b16 v[70:71], v51 offset:12288
    s_waitcnt lgkmcnt(8)
    v_mfma_f32_16x16x32_bf16 v[208:211], v[80:83], v[128:131], v[208:211]
    ds_read_b64_tr_b16 v[72:73], v52 offset:8192
    buffer_load_dwordx4 v[180:183], v3, s[4:7], s31 offen offset:2048 sc1
    v_mfma_f32_16x16x32_bf16 v[240:243], v[80:83], v[132:135], v[240:243]
    ds_read_b64_tr_b16 v[74:75], v52 offset:12288
    v_mfma_f32_16x16x32_bf16 v[212:215], v[84:87], v[128:131], v[212:215]
    ds_read_b64_tr_b16 v[76:77], v53 offset:8192
    v_mfma_f32_16x16x32_bf16 v[244:247], v[84:87], v[132:135], v[244:247]
    ds_read_b64_tr_b16 v[78:79], v53 offset:12288
    s_waitcnt lgkmcnt(8)
    v_mfma_f32_16x16x32_bf16 v[216:219], v[88:91], v[128:131], v[216:219]
    ds_read_b64_tr_b16 v[80:81], v54 offset:8192
    buffer_load_dwordx4 v7, s[8:11], s32 offen offset:1024 lds
    v_mfma_f32_16x16x32_bf16 v[248:251], v[88:91], v[132:135], v[248:251]
    ds_read_b64_tr_b16 v[82:83], v54 offset:12288
    v_mfma_f32_16x16x32_bf16 v[220:223], v[92:95], v[128:131], v[220:223]
    ds_read_b64_tr_b16 v[84:85], v55 offset:8192
    v_mfma_f32_16x16x32_bf16 v[252:255], v[92:95], v[132:135], v[252:255]
    ds_read_b64_tr_b16 v[86:87], v55 offset:12288
    s_waitcnt lgkmcnt(8)
    v_mfma_f32_16x16x32_bf16 v[192:195], v[64:67], v[136:139], v[192:195]
    ds_read_b64_tr_b16 v[88:89], v56 offset:8192
    buffer_load_dwordx4 v[184:187], v2, s[4:7], s31 offen offset:3072 sc1
    v_mfma_f32_16x16x32_bf16 v[224:227], v[64:67], v[140:143], v[224:227]
    ds_read_b64_tr_b16 v[90:91], v56 offset:12288
    v_mfma_f32_16x16x32_bf16 v[196:199], v[68:71], v[136:139], v[196:199]
    ds_read_b64_tr_b16 v[92:93], v57 offset:8192
    v_mfma_f32_16x16x32_bf16 v[228:231], v[68:71], v[140:143], v[228:231]
    ds_read_b64_tr_b16 v[94:95], v57 offset:12288
    buffer_load_dwordx4 v8, s[8:11], s32 offen offset:2048 lds
    s_waitcnt lgkmcnt(8)
    v_mfma_f32_16x16x32_bf16 v[200:203], v[72:75], v[136:139], v[200:203]
    v_mfma_f32_16x16x32_bf16 v[232:235], v[72:75], v[140:143], v[232:235]
    v_mfma_f32_16x16x32_bf16 v[204:207], v[76:79], v[136:139], v[204:207]
    buffer_load_dwordx4 v[188:191], v3, s[4:7], s31 offen offset:3072 sc1
    s_add_u32 s31, s31, 8192
    s_and_b32 s31, s31, 0xffff
    v_mfma_f32_16x16x32_bf16 v[236:239], v[76:79], v[140:143], v[236:239]
    s_waitcnt lgkmcnt(0)
    s_waitcnt vmcnt(15)
    s_barrier
    v_mfma_f32_16x16x32_bf16 v[208:211], v[80:83], v[136:139], v[208:211]
    ds_read_b64_tr_b16 v[64:65], v50 offset:16384
    ds_read_b64_tr_b16 v[66:67], v50 offset:20480
    v_mfma_f32_16x16x32_bf16 v[240:243], v[80:83], v[140:143], v[240:243]
    ds_read_b64_tr_b16 v[68:69], v51 offset:16384
    ds_read_b64_tr_b16 v[70:71], v51 offset:20480
    v_mfma_f32_16x16x32_bf16 v[212:215], v[84:87], v[136:139], v[212:215]
    ds_read_b64_tr_b16 v[72:73], v52 offset:16384
    ds_read_b64_tr_b16 v[74:75], v52 offset:20480
    v_mfma_f32_16x16x32_bf16 v[244:247], v[84:87], v[140:143], v[244:247]
    ds_read_b64_tr_b16 v[76:77], v53 offset:16384
    ds_read_b64_tr_b16 v[78:79], v53 offset:20480
    v_mfma_f32_16x16x32_bf16 v[216:219], v[88:91], v[136:139], v[216:219]
    ds_read_b64_tr_b16 v[80:81], v54 offset:16384
    ds_read_b64_tr_b16 v[82:83], v54 offset:20480
    buffer_load_dwordx4 v9, s[8:11], s32 offen offset:3072 lds
    v_mfma_f32_16x16x32_bf16 v[248:251], v[88:91], v[140:143], v[248:251]
    s_add_u32 s32, s32, 393216
    s_and_b32 s32, s32, 0x3fffff
    v_mfma_f32_16x16x32_bf16 v[220:223], v[92:95], v[136:139], v[220:223]
    ds_read_b64_tr_b16 v[84:85], v55 offset:16384
    ds_read_b64_tr_b16 v[86:87], v55 offset:20480
    v_mfma_f32_16x16x32_bf16 v[252:255], v[92:95], v[140:143], v[252:255]
    s_waitcnt lgkmcnt(8)
    v_mfma_f32_16x16x32_bf16 v[192:195], v[64:67], v[144:147], v[192:195]
    ds_read_b64_tr_b16 v[88:89], v56 offset:16384
    buffer_load_dwordx4 v[128:131], v2, s[4:7], s31 offen offset:0 sc1
    v_mfma_f32_16x16x32_bf16 v[224:227], v[64:67], v[148:151], v[224:227]
    ds_read_b64_tr_b16 v[90:91], v56 offset:20480
    v_mfma_f32_16x16x32_bf16 v[196:199], v[68:71], v[144:147], v[196:199]
    ds_read_b64_tr_b16 v[92:93], v57 offset:16384
    v_mfma_f32_16x16x32_bf16 v[228:231], v[68:71], v[148:151], v[228:231]
    ds_read_b64_tr_b16 v[94:95], v57 offset:20480
    s_add_u32 m0, s34, 65536
    s_waitcnt lgkmcnt(8)
    v_mfma_f32_16x16x32_bf16 v[200:203], v[72:75], v[144:147], v[200:203]
    ds_read_b64_tr_b16 v[64:65], v50 offset:24576
    buffer_load_dwordx4 v6, s[8:11], s32 offen offset:0 lds
    v_mfma_f32_16x16x32_bf16 v[232:235], v[72:75], v[148:151], v[232:235]
    ds_read_b64_tr_b16 v[66:67], v50 offset:28672
    v_xor_b32 v50, 65536, v50
    v_mfma_f32_16x16x32_bf16 v[204:207], v[76:79], v[144:147], v[204:207]
    ds_read_b64_tr_b16 v[68:69], v51 offset:24576
    v_mfma_f32_16x16x32_bf16 v[236:239], v[76:79], v[148:151], v[236:239]
    ds_read_b64_tr_b16 v[70:71], v51 offset:28672
    v_xor_b32 v51, 65536, v51
    s_waitcnt lgkmcnt(8)
    v_mfma_f32_16x16x32_bf16 v[208:211], v[80:83], v[144:147], v[208:211]
    ds_read_b64_tr_b16 v[72:73], v52 offset:24576
    buffer_load_dwordx4 v[132:135], v3, s[4:7], s31 offen offset:0 sc1
    v_mfma_f32_16x16x32_bf16 v[240:243], v[80:83], v[148:151], v[240:243]
    ds_read_b64_tr_b16 v[74:75], v52 offset:28672
    v_xor_b32 v52, 65536, v52
    v_mfma_f32_16x16x32_bf16 v[212:215], v[84:87], v[144:147], v[212:215]
    ds_read_b64_tr_b16 v[76:77], v53 offset:24576
    v_mfma_f32_16x16x32_bf16 v[244:247], v[84:87], v[148:151], v[244:247]
    ds_read_b64_tr_b16 v[78:79], v53 offset:28672
    v_xor_b32 v53, 65536, v53
    s_waitcnt lgkmcnt(8)
    v_mfma_f32_16x16x32_bf16 v[216:219], v[88:91], v[144:147], v[216:219]
    ds_read_b64_tr_b16 v[80:81], v54 offset:24576
    buffer_load_dwordx4 v7, s[8:11], s32 offen offset:1024 lds
    v_mfma_f32_16x16x32_bf16 v[248:251], v[88:91], v[148:151], v[248:251]
    ds_read_b64_tr_b16 v[82:83], v54 offset:28672
    v_xor_b32 v54, 65536, v54
    v_mfma_f32_16x16x32_bf16 v[220:223], v[92:95], v[144:147], v[220:223]
    ds_read_b64_tr_b16 v[84:85], v55 offset:24576
    v_mfma_f32_16x16x32_bf16 v[252:255], v[92:95], v[148:151], v[252:255]
    ds_read_b64_tr_b16 v[86:87], v55 offset:28672
    v_xor_b32 v55, 65536, v55
    s_waitcnt lgkmcnt(8)
    v_mfma_f32_16x16x32_bf16 v[192:195], v[64:67], v[152:155], v[192:195]
    ds_read_b64_tr_b16 v[88:89], v56 offset:24576
    buffer_load_dwordx4 v[136:139], v2, s[4:7], s31 offen offset:1024 sc1
    v_mfma_f32_16x16x32_bf16 v[224:227], v[64:67], v[156:159], v[224:227]
    ds_read_b64_tr_b16 v[90:91], v56 offset:28672
    v_xor_b32 v56, 65536, v56
    v_mfma_f32_16x16x32_bf16 v[196:199], v[68:71], v[152:155], v[196:199]
    ds_read_b64_tr_b16 v[92:93], v57 offset:24576
    v_mfma_f32_16x16x32_bf16 v[228:231], v[68:71], v[156:159], v[228:231]
    ds_read_b64_tr_b16 v[94:95], v57 offset:28672
    v_xor_b32 v57, 65536, v57
    buffer_load_dwordx4 v8, s[8:11], s32 offen offset:2048 lds
    s_waitcnt lgkmcnt(8)
    v_mfma_f32_16x16x32_bf16 v[200:203], v[72:75], v[152:155], v[200:203]
    v_mfma_f32_16x16x32_bf16 v[232:235], v[72:75], v[156:159], v[232:235]
    v_mfma_f32_16x16x32_bf16 v[204:207], v[76:79], v[152:155], v[204:207]
    buffer_load_dwordx4 v[140:143], v3, s[4:7], s31 offen offset:1024 sc1
    v_mfma_f32_16x16x32_bf16 v[236:239], v[76:79], v[156:159], v[236:239]
    s_waitcnt lgkmcnt(0)
    s_waitcnt vmcnt(15)
    s_barrier
    v_mfma_f32_16x16x32_bf16 v[208:211], v[80:83], v[152:155], v[208:211]
    ds_read_b64_tr_b16 v[64:65], v50 offset:0
    ds_read_b64_tr_b16 v[66:67], v50 offset:4096
    v_mfma_f32_16x16x32_bf16 v[240:243], v[80:83], v[156:159], v[240:243]
    ds_read_b64_tr_b16 v[68:69], v51 offset:0
    ds_read_b64_tr_b16 v[70:71], v51 offset:4096
    v_mfma_f32_16x16x32_bf16 v[212:215], v[84:87], v[152:155], v[212:215]
    ds_read_b64_tr_b16 v[72:73], v52 offset:0
    ds_read_b64_tr_b16 v[74:75], v52 offset:4096
    v_mfma_f32_16x16x32_bf16 v[244:247], v[84:87], v[156:159], v[244:247]
    ds_read_b64_tr_b16 v[76:77], v53 offset:0
    ds_read_b64_tr_b16 v[78:79], v53 offset:4096
    v_mfma_f32_16x16x32_bf16 v[216:219], v[88:91], v[152:155], v[216:219]
    ds_read_b64_tr_b16 v[80:81], v54 offset:0
    ds_read_b64_tr_b16 v[82:83], v54 offset:4096
    buffer_load_dwordx4 v9, s[8:11], s32 offen offset:3072 lds
    v_mfma_f32_16x16x32_bf16 v[248:251], v[88:91], v[156:159], v[248:251]
    s_add_u32 s32, s32, 131072
    v_mfma_f32_16x16x32_bf16 v[220:223], v[92:95], v[152:155], v[220:223]
    ds_read_b64_tr_b16 v[84:85], v55 offset:0
    ds_read_b64_tr_b16 v[86:87], v55 offset:4096
    v_mfma_f32_16x16x32_bf16 v[252:255], v[92:95], v[156:159], v[252:255]
    s_cmp_eq_u32 s35, 2
    s_cbranch_scc1 L_recurrent_scan__compressed_kv_cla__moe_arch_mod__prompt_kernel_rare_147
L_recurrent_scan__compressed_kv_cla__moe_arch_mod__prompt_kernel_back_148:
    s_waitcnt lgkmcnt(8)
    s_waitcnt vmcnt(18)
    v_mfma_f32_16x16x32_bf16 v[192:195], v[64:67], v[160:163], v[192:195]
    ds_read_b64_tr_b16 v[88:89], v56 offset:0
    buffer_load_dwordx4 v[144:147], v2, s[4:7], s31 offen offset:2048 sc1
    v_mfma_f32_16x16x32_bf16 v[224:227], v[64:67], v[164:167], v[224:227]
    ds_read_b64_tr_b16 v[90:91], v56 offset:4096
    v_mfma_f32_16x16x32_bf16 v[196:199], v[68:71], v[160:163], v[196:199]
    ds_read_b64_tr_b16 v[92:93], v57 offset:0
    v_mfma_f32_16x16x32_bf16 v[228:231], v[68:71], v[164:167], v[228:231]
    ds_read_b64_tr_b16 v[94:95], v57 offset:4096
    s_add_u32 m0, s34, 81920
    s_waitcnt lgkmcnt(8)
    v_mfma_f32_16x16x32_bf16 v[200:203], v[72:75], v[160:163], v[200:203]
    ds_read_b64_tr_b16 v[64:65], v50 offset:8192
    buffer_load_dwordx4 v6, s[8:11], s32 offen offset:0 lds
    v_mfma_f32_16x16x32_bf16 v[232:235], v[72:75], v[164:167], v[232:235]
    ds_read_b64_tr_b16 v[66:67], v50 offset:12288
    v_mfma_f32_16x16x32_bf16 v[204:207], v[76:79], v[160:163], v[204:207]
    ds_read_b64_tr_b16 v[68:69], v51 offset:8192
    v_mfma_f32_16x16x32_bf16 v[236:239], v[76:79], v[164:167], v[236:239]
    ds_read_b64_tr_b16 v[70:71], v51 offset:12288
    s_waitcnt lgkmcnt(8)
    v_mfma_f32_16x16x32_bf16 v[208:211], v[80:83], v[160:163], v[208:211]
    ds_read_b64_tr_b16 v[72:73], v52 offset:8192
    buffer_load_dwordx4 v[148:151], v3, s[4:7], s31 offen offset:2048 sc1
    v_mfma_f32_16x16x32_bf16 v[240:243], v[80:83], v[164:167], v[240:243]
    ds_read_b64_tr_b16 v[74:75], v52 offset:12288
    v_mfma_f32_16x16x32_bf16 v[212:215], v[84:87], v[160:163], v[212:215]
    ds_read_b64_tr_b16 v[76:77], v53 offset:8192
    v_mfma_f32_16x16x32_bf16 v[244:247], v[84:87], v[164:167], v[244:247]
    ds_read_b64_tr_b16 v[78:79], v53 offset:12288
    s_waitcnt lgkmcnt(8)
    v_mfma_f32_16x16x32_bf16 v[216:219], v[88:91], v[160:163], v[216:219]
    ds_read_b64_tr_b16 v[80:81], v54 offset:8192
    buffer_load_dwordx4 v7, s[8:11], s32 offen offset:1024 lds
    v_mfma_f32_16x16x32_bf16 v[248:251], v[88:91], v[164:167], v[248:251]
    ds_read_b64_tr_b16 v[82:83], v54 offset:12288
    v_mfma_f32_16x16x32_bf16 v[220:223], v[92:95], v[160:163], v[220:223]
    ds_read_b64_tr_b16 v[84:85], v55 offset:8192
    v_mfma_f32_16x16x32_bf16 v[252:255], v[92:95], v[164:167], v[252:255]
    ds_read_b64_tr_b16 v[86:87], v55 offset:12288
    s_waitcnt lgkmcnt(8)
    s_waitcnt vmcnt(20)
    v_mfma_f32_16x16x32_bf16 v[192:195], v[64:67], v[168:171], v[192:195]
    ds_read_b64_tr_b16 v[88:89], v56 offset:8192
    buffer_load_dwordx4 v[152:155], v2, s[4:7], s31 offen offset:3072 sc1
    v_mfma_f32_16x16x32_bf16 v[224:227], v[64:67], v[172:175], v[224:227]
    ds_read_b64_tr_b16 v[90:91], v56 offset:12288
    v_mfma_f32_16x16x32_bf16 v[196:199], v[68:71], v[168:171], v[196:199]
    ds_read_b64_tr_b16 v[92:93], v57 offset:8192
    v_mfma_f32_16x16x32_bf16 v[228:231], v[68:71], v[172:175], v[228:231]
    ds_read_b64_tr_b16 v[94:95], v57 offset:12288
    buffer_load_dwordx4 v8, s[8:11], s32 offen offset:2048 lds
    s_waitcnt lgkmcnt(8)
    v_mfma_f32_16x16x32_bf16 v[200:203], v[72:75], v[168:171], v[200:203]
    v_mfma_f32_16x16x32_bf16 v[232:235], v[72:75], v[172:175], v[232:235]
    v_mfma_f32_16x16x32_bf16 v[204:207], v[76:79], v[168:171], v[204:207]
    buffer_load_dwordx4 v[156:159], v3, s[4:7], s31 offen offset:3072 sc1
    s_add_u32 s31, s31, 8192
    s_and_b32 s31, s31, 0xffff
    v_mfma_f32_16x16x32_bf16 v[236:239], v[76:79], v[172:175], v[236:239]
    s_cmp_lt_u32 s60, 15
    s_cbranch_scc1 L_recurrent_scan__compressed_kv_cla__moe_arch_mod__prompt_kernel_rare_149
L_recurrent_scan__compressed_kv_cla__moe_arch_mod__prompt_kernel_back_150:
    s_waitcnt lgkmcnt(0)
    s_waitcnt vmcnt(15)
    s_barrier
    v_mfma_f32_16x16x32_bf16 v[208:211], v[80:83], v[168:171], v[208:211]
    ds_read_b64_tr_b16 v[64:65], v50 offset:16384
    ds_read_b64_tr_b16 v[66:67], v50 offset:20480
    v_mfma_f32_16x16x32_bf16 v[240:243], v[80:83], v[172:175], v[240:243]
    ds_read_b64_tr_b16 v[68:69], v51 offset:16384
    ds_read_b64_tr_b16 v[70:71], v51 offset:20480
    v_mfma_f32_16x16x32_bf16 v[212:215], v[84:87], v[168:171], v[212:215]
    ds_read_b64_tr_b16 v[72:73], v52 offset:16384
    ds_read_b64_tr_b16 v[74:75], v52 offset:20480
    v_mfma_f32_16x16x32_bf16 v[244:247], v[84:87], v[172:175], v[244:247]
    ds_read_b64_tr_b16 v[76:77], v53 offset:16384
    ds_read_b64_tr_b16 v[78:79], v53 offset:20480
    v_mfma_f32_16x16x32_bf16 v[216:219], v[88:91], v[168:171], v[216:219]
    ds_read_b64_tr_b16 v[80:81], v54 offset:16384
    ds_read_b64_tr_b16 v[82:83], v54 offset:20480
    buffer_load_dwordx4 v9, s[8:11], s32 offen offset:3072 lds
    v_mfma_f32_16x16x32_bf16 v[248:251], v[88:91], v[172:175], v[248:251]
    s_add_u32 s32, s32, 393216
    s_and_b32 s32, s32, 0x3fffff
    v_mfma_f32_16x16x32_bf16 v[220:223], v[92:95], v[168:171], v[220:223]
    ds_read_b64_tr_b16 v[84:85], v55 offset:16384
    ds_read_b64_tr_b16 v[86:87], v55 offset:20480
    v_mfma_f32_16x16x32_bf16 v[252:255], v[92:95], v[172:175], v[252:255]
    s_waitcnt lgkmcnt(8)
    v_mfma_f32_16x16x32_bf16 v[192:195], v[64:67], v[176:179], v[192:195]
    ds_read_b64_tr_b16 v[88:89], v56 offset:16384
    buffer_load_dwordx4 v[160:163], v2, s[4:7], s31 offen offset:0 sc1
    v_mfma_f32_16x16x32_bf16 v[224:227], v[64:67], v[180:183], v[224:227]
    ds_read_b64_tr_b16 v[90:91], v56 offset:20480
    v_mfma_f32_16x16x32_bf16 v[196:199], v[68:71], v[176:179], v[196:199]
    ds_read_b64_tr_b16 v[92:93], v57 offset:16384
    v_mfma_f32_16x16x32_bf16 v[228:231], v[68:71], v[180:183], v[228:231]
    ds_read_b64_tr_b16 v[94:95], v57 offset:20480
    s_add_u32 m0, s34, 0
    s_waitcnt lgkmcnt(8)
    v_mfma_f32_16x16x32_bf16 v[200:203], v[72:75], v[176:179], v[200:203]
    ds_read_b64_tr_b16 v[64:65], v50 offset:24576
    buffer_load_dwordx4 v6, s[8:11], s32 offen offset:0 lds
    v_mfma_f32_16x16x32_bf16 v[232:235], v[72:75], v[180:183], v[232:235]
    ds_read_b64_tr_b16 v[66:67], v50 offset:28672
    v_xor_b32 v50, 65536, v50
    v_mfma_f32_16x16x32_bf16 v[204:207], v[76:79], v[176:179], v[204:207]
    ds_read_b64_tr_b16 v[68:69], v51 offset:24576
    v_mfma_f32_16x16x32_bf16 v[236:239], v[76:79], v[180:183], v[236:239]
    ds_read_b64_tr_b16 v[70:71], v51 offset:28672
    v_xor_b32 v51, 65536, v51
    s_waitcnt lgkmcnt(8)
    v_mfma_f32_16x16x32_bf16 v[208:211], v[80:83], v[176:179], v[208:211]
    ds_read_b64_tr_b16 v[72:73], v52 offset:24576
    buffer_load_dwordx4 v[164:167], v3, s[4:7], s31 offen offset:0 sc1
    v_mfma_f32_16x16x32_bf16 v[240:243], v[80:83], v[180:183], v[240:243]
    ds_read_b64_tr_b16 v[74:75], v52 offset:28672
    v_xor_b32 v52, 65536, v52
    v_mfma_f32_16x16x32_bf16 v[212:215], v[84:87], v[176:179], v[212:215]
    ds_read_b64_tr_b16 v[76:77], v53 offset:24576
    v_mfma_f32_16x16x32_bf16 v[244:247], v[84:87], v[180:183], v[244:247]
    ds_read_b64_tr_b16 v[78:79], v53 offset:28672
    v_xor_b32 v53, 65536, v53
    s_waitcnt lgkmcnt(8)
    v_mfma_f32_16x16x32_bf16 v[216:219], v[88:91], v[176:179], v[216:219]
    ds_read_b64_tr_b16 v[80:81], v54 offset:24576
    buffer_load_dwordx4 v7, s[8:11], s32 offen offset:1024 lds
    v_mfma_f32_16x16x32_bf16 v[248:251], v[88:91], v[180:183], v[248:251]
    ds_read_b64_tr_b16 v[82:83], v54 offset:28672
    v_xor_b32 v54, 65536, v54
    v_mfma_f32_16x16x32_bf16 v[220:223], v[92:95], v[176:179], v[220:223]
    ds_read_b64_tr_b16 v[84:85], v55 offset:24576
    v_mfma_f32_16x16x32_bf16 v[252:255], v[92:95], v[180:183], v[252:255]
    ds_read_b64_tr_b16 v[86:87], v55 offset:28672
    v_xor_b32 v55, 65536, v55
    s_waitcnt lgkmcnt(8)
    v_mfma_f32_16x16x32_bf16 v[192:195], v[64:67], v[184:187], v[192:195]
    ds_read_b64_tr_b16 v[88:89], v56 offset:24576
    buffer_load_dwordx4 v[168:171], v2, s[4:7], s31 offen offset:1024 sc1
    v_mfma_f32_16x16x32_bf16 v[224:227], v[64:67], v[188:191], v[224:227]
    ds_read_b64_tr_b16 v[90:91], v56 offset:28672
    v_xor_b32 v56, 65536, v56
    v_mfma_f32_16x16x32_bf16 v[196:199], v[68:71], v[184:187], v[196:199]
    ds_read_b64_tr_b16 v[92:93], v57 offset:24576
    v_mfma_f32_16x16x32_bf16 v[228:231], v[68:71], v[188:191], v[228:231]
    ds_read_b64_tr_b16 v[94:95], v57 offset:28672
    v_xor_b32 v57, 65536, v57
    buffer_load_dwordx4 v8, s[8:11], s32 offen offset:2048 lds
    s_waitcnt lgkmcnt(8)
    v_mfma_f32_16x16x32_bf16 v[200:203], v[72:75], v[184:187], v[200:203]
    v_mfma_f32_16x16x32_bf16 v[232:235], v[72:75], v[188:191], v[232:235]
    v_mfma_f32_16x16x32_bf16 v[204:207], v[76:79], v[184:187], v[204:207]
    buffer_load_dwordx4 v[172:175], v3, s[4:7], s31 offen offset:1024 sc1
    v_mfma_f32_16x16x32_bf16 v[236:239], v[76:79], v[188:191], v[236:239]
    s_cmp_lt_u32 s60, 15
    s_cbranch_scc1 L_recurrent_scan__compressed_kv_cla__moe_arch_mod__prompt_kernel_rare_159
L_recurrent_scan__compressed_kv_cla__moe_arch_mod__prompt_kernel_back_160:
    s_waitcnt lgkmcnt(0)
    s_waitcnt vmcnt(15)
    s_barrier
    v_mfma_f32_16x16x32_bf16 v[208:211], v[80:83], v[184:187], v[208:211]
    ds_read_b64_tr_b16 v[64:65], v50 offset:0
    ds_read_b64_tr_b16 v[66:67], v50 offset:4096
    v_mfma_f32_16x16x32_bf16 v[240:243], v[80:83], v[188:191], v[240:243]
    ds_read_b64_tr_b16 v[68:69], v51 offset:0
    ds_read_b64_tr_b16 v[70:71], v51 offset:4096
    v_mfma_f32_16x16x32_bf16 v[212:215], v[84:87], v[184:187], v[212:215]
    ds_read_b64_tr_b16 v[72:73], v52 offset:0
    ds_read_b64_tr_b16 v[74:75], v52 offset:4096
    v_mfma_f32_16x16x32_bf16 v[244:247], v[84:87], v[188:191], v[244:247]
    ds_read_b64_tr_b16 v[76:77], v53 offset:0
    ds_read_b64_tr_b16 v[78:79], v53 offset:4096
    v_mfma_f32_16x16x32_bf16 v[216:219], v[88:91], v[184:187], v[216:219]
    ds_read_b64_tr_b16 v[80:81], v54 offset:0
    ds_read_b64_tr_b16 v[82:83], v54 offset:4096
    buffer_load_dwordx4 v9, s[8:11], s32 offen offset:3072 lds
    v_mfma_f32_16x16x32_bf16 v[248:251], v[88:91], v[188:191], v[248:251]
    s_add_u32 s32, s32, 131072
    v_mfma_f32_16x16x32_bf16 v[220:223], v[92:95], v[184:187], v[220:223]
    ds_read_b64_tr_b16 v[84:85], v55 offset:0
    ds_read_b64_tr_b16 v[86:87], v55 offset:4096
    v_mfma_f32_16x16x32_bf16 v[252:255], v[92:95], v[188:191], v[252:255]
    s_add_u32 s35, s35, 1
    s_cmp_lt_u32 s35, 3
    s_cbranch_scc1 L_p4_loop
    s_sub_u32 s36, s56, s38
    s_sub_u32 s37, s57, s38
    s_min_u32 s36, s36, s37
    s_cmp_lt_u32 s36, 16
    s_cbranch_scc1 L_recurrent_scan__compressed_kv_cla__moe_arch_mod__prompt_kernel_rare_168
L_recurrent_scan__compressed_kv_cla__moe_arch_mod__prompt_kernel_back_169:
    s_xor_b32 s37, s40, 512
    v_mov_b32 v5, s37
    s_waitcnt vmcnt(16)
    ds_read_b64 v[40:41], v17 offset:0
    ds_read_b64 v[42:43], v17 offset:32
    ds_read_b64 v[44:45], v17 offset:64
    ds_read_b64 v[46:47], v17 offset:96
    s_waitcnt lgkmcnt(12)
    v_mfma_f32_16x16x32_bf16 v[192:195], v[64:67], v[128:131], v[192:195]
    ds_read_b64_tr_b16 v[88:89], v56 offset:0
    s_add_u32 m0, s34, 16384
    v_mfma_f32_16x16x32_bf16 v[224:227], v[64:67], v[132:135], v[224:227]
    ds_read_b64_tr_b16 v[90:91], v56 offset:4096
    v_mfma_f32_16x16x32_bf16 v[196:199], v[68:71], v[128:131], v[196:199]
    ds_read_b64_tr_b16 v[92:93], v57 offset:0
    v_mfma_f32_16x16x32_bf16 v[228:231], v[68:71], v[132:135], v[228:231]
    ds_read_b64_tr_b16 v[94:95], v57 offset:4096
    buffer_load_dwordx4 v6, s[8:11], s32 offen offset:0 lds
    s_waitcnt lgkmcnt(12)
    v_mfma_f32_16x16x32_bf16 v[200:203], v[72:75], v[128:131], v[200:203]
    ds_read_b64_tr_b16 v[64:65], v50 offset:8192
    v_mfma_f32_16x16x32_bf16 v[232:235], v[72:75], v[132:135], v[232:235]
    ds_read_b64_tr_b16 v[66:67], v50 offset:12288
    v_mfma_f32_16x16x32_bf16 v[204:207], v[76:79], v[128:131], v[204:207]
    ds_read_b64_tr_b16 v[68:69], v51 offset:8192
    buffer_load_dwordx4 v7, s[8:11], s32 offen offset:1024 lds
    v_mfma_f32_16x16x32_bf16 v[236:239], v[76:79], v[132:135], v[236:239]
    ds_read_b64_tr_b16 v[70:71], v51 offset:12288
    s_waitcnt lgkmcnt(12)
    s_waitcnt lgkmcnt(8)
    v_mfma_f32_16x16x32_bf16 v[208:211], v[80:83], v[128:131], v[208:211]
    ds_read_b64_tr_b16 v[72:73], v52 offset:8192
    v_lshlrev_b32 v96, 16, v40
    v_and_b32 v97, 0xffff0000, v40
    v_mfma_f32_16x16x32_bf16 v[240:243], v[80:83], v[132:135], v[240:243]
    ds_read_b64_tr_b16 v[74:75], v52 offset:12288
    buffer_load_dwordx4 v8, s[8:11], s32 offen offset:2048 lds
    v_sub_f32 v112, v96, v48
    v_sub_f32 v113, v97, v48
    v_mfma_f32_16x16x32_bf16 v[212:215], v[84:87], v[128:131], v[212:215]
    ds_read_b64_tr_b16 v[76:77], v53 offset:8192
    v_cvt_pk_bf16_f32 v10, v112, v113
    v_lshlrev_b32 v112, 16, v10
    v_mfma_f32_16x16x32_bf16 v[244:247], v[84:87], v[132:135], v[244:247]
    ds_read_b64_tr_b16 v[78:79], v53 offset:12288
    v_and_b32 v113, 0xffff0000, v10
    v_mul_f32 v112, v112, v49
    s_waitcnt vmcnt(11)
    s_barrier
    s_waitcnt lgkmcnt(8)
    v_mfma_f32_16x16x32_bf16 v[216:219], v[88:91], v[128:131], v[216:219]
    ds_read_b64_tr_b16 v[80:81], v50 offset:16384
    buffer_load_dwordx4 v9, s[8:11], s32 offen offset:3072 lds
    v_mul_f32 v113, v113, v49
    v_cvt_pk_bf16_f32 v10, v112, v113
    v_mfma_f32_16x16x32_bf16 v[248:251], v[88:91], v[132:135], v[248:251]
    ds_read_b64_tr_b16 v[82:83], v50 offset:20480
    v_lshlrev_b32 v112, 16, v10
    v_and_b32 v113, 0xffff0000, v10
    v_mfma_f32_16x16x32_bf16 v[220:223], v[92:95], v[128:131], v[220:223]
    ds_read_b64_tr_b16 v[84:85], v51 offset:16384
    v_mul_f32 v11, 0xbfb8aa3b, v112
    v_mul_f32 v12, 0xbfb8aa3b, v113
    v_mfma_f32_16x16x32_bf16 v[252:255], v[92:95], v[132:135], v[252:255]
    ds_read_b64_tr_b16 v[86:87], v51 offset:20480
    buffer_load_dwordx4 v[176:179], v2, s[4:7], s31 offen offset:2048 sc1
    s_waitcnt lgkmcnt(8)
    v_mfma_f32_16x16x32_bf16 v[192:195], v[64:67], v[136:139], v[192:195]
    ds_read_b64_tr_b16 v[88:89], v52 offset:16384
    v_exp_f32 v11, v11
    v_exp_f32 v12, v12
    v_mfma_f32_16x16x32_bf16 v[224:227], v[64:67], v[140:143], v[224:227]
    ds_read_b64_tr_b16 v[90:91], v52 offset:20480
    v_add_f32 v11, 1.0, v11
    v_add_f32 v12, 1.0, v12
    v_mfma_f32_16x16x32_bf16 v[196:199], v[68:71], v[136:139], v[196:199]
    ds_read_b64_tr_b16 v[92:93], v53 offset:16384
    buffer_load_dwordx4 v[180:183], v3, s[4:7], s31 offen offset:2048 sc1
    v_rcp_f32 v11, v11
    v_rcp_f32 v12, v12
    v_mfma_f32_16x16x32_bf16 v[228:231], v[68:71], v[140:143], v[228:231]
    ds_read_b64_tr_b16 v[94:95], v53 offset:20480
    v_mul_f32 v112, v112, v11
    v_mul_f32 v113, v113, v12
    s_waitcnt lgkmcnt(8)
    v_mfma_f32_16x16x32_bf16 v[200:203], v[72:75], v[136:139], v[200:203]
    ds_read_b64_tr_b16 v[64:65], v50 offset:24576
    v_cvt_pk_bf16_f32 v10, v112, v113
    v_lshlrev_b32 v112, 16, v10
    v_mfma_f32_16x16x32_bf16 v[232:235], v[72:75], v[140:143], v[232:235]
    ds_read_b64_tr_b16 v[66:67], v50 offset:28672
    v_xor_b32 v50, 65536, v50
    buffer_load_dwordx4 v[184:187], v2, s[4:7], s31 offen offset:3072 sc1
    v_and_b32 v113, 0xffff0000, v10
    v_lshlrev_b32 v98, 16, v41
    v_mfma_f32_16x16x32_bf16 v[204:207], v[76:79], v[136:139], v[204:207]
    ds_read_b64_tr_b16 v[68:69], v51 offset:24576
    v_mfma_f32_16x16x32_bf16 v[236:239], v[76:79], v[140:143], v[236:239]
    ds_read_b64_tr_b16 v[70:71], v51 offset:28672
    v_xor_b32 v51, 65536, v51
    v_and_b32 v99, 0xffff0000, v41
    v_sub_f32 v114, v98, v48
    s_waitcnt lgkmcnt(8)
    v_mfma_f32_16x16x32_bf16 v[192:195], v[80:83], v[144:147], v[192:195]
    ds_read_b64_tr_b16 v[72:73], v52 offset:24576
    buffer_load_dwordx4 v[188:191], v3, s[4:7], s31 offen offset:3072 sc1
    v_sub_f32 v115, v99, v48
    v_cvt_pk_bf16_f32 v10, v114, v115
    v_mfma_f32_16x16x32_bf16 v[224:227], v[80:83], v[148:151], v[224:227]
    ds_read_b64_tr_b16 v[74:75], v52 offset:28672
    v_xor_b32 v52, 65536, v52
    v_lshlrev_b32 v114, 16, v10
    v_and_b32 v115, 0xffff0000, v10
    v_mfma_f32_16x16x32_bf16 v[196:199], v[84:87], v[144:147], v[196:199]
    ds_read_b64_tr_b16 v[76:77], v53 offset:24576
    v_mul_f32 v114, v114, v49
    v_mul_f32 v115, v115, v49
    v_mfma_f32_16x16x32_bf16 v[228:231], v[84:87], v[148:151], v[228:231]
    ds_read_b64_tr_b16 v[78:79], v53 offset:28672
    v_xor_b32 v53, 65536, v53
    v_cvt_pk_bf16_f32 v10, v114, v115
    v_lshlrev_b32 v114, 16, v10
    s_waitcnt vmcnt(8)
    s_barrier
    s_waitcnt lgkmcnt(8)
    v_mfma_f32_16x16x32_bf16 v[200:203], v[88:91], v[144:147], v[200:203]
    ds_read_b64_tr_b16 v[80:81], v50 offset:0
    v_and_b32 v115, 0xffff0000, v10
    v_mul_f32 v11, 0xbfb8aa3b, v114
    v_mfma_f32_16x16x32_bf16 v[232:235], v[88:91], v[148:151], v[232:235]
    ds_read_b64_tr_b16 v[82:83], v50 offset:4096
    v_mfma_f32_16x16x32_bf16 v[204:207], v[92:95], v[144:147], v[204:207]
    ds_read_b64_tr_b16 v[84:85], v51 offset:0
    v_mul_f32 v12, 0xbfb8aa3b, v115
    v_exp_f32 v11, v11
    v_mfma_f32_16x16x32_bf16 v[236:239], v[92:95], v[148:151], v[236:239]
    ds_read_b64_tr_b16 v[86:87], v51 offset:4096
    v_exp_f32 v12, v12
    v_add_f32 v11, 1.0, v11
    s_waitcnt lgkmcnt(8)
    v_mfma_f32_16x16x32_bf16 v[192:195], v[64:67], v[152:155], v[192:195]
    ds_read_b64_tr_b16 v[88:89], v52 offset:0
    v_add_f32 v12, 1.0, v12
    v_rcp_f32 v11, v11
    v_mfma_f32_16x16x32_bf16 v[224:227], v[64:67], v[156:159], v[224:227]
    ds_read_b64_tr_b16 v[90:91], v52 offset:4096
    v_rcp_f32 v12, v12
    v_mul_f32 v114, v114, v11
    v_mfma_f32_16x16x32_bf16 v[196:199], v[68:71], v[152:155], v[196:199]
    ds_read_b64_tr_b16 v[92:93], v53 offset:0
    v_mul_f32 v115, v115, v12
    v_cvt_pk_bf16_f32 v10, v114, v115
    v_mfma_f32_16x16x32_bf16 v[228:231], v[68:71], v[156:159], v[228:231]
    ds_read_b64_tr_b16 v[94:95], v53 offset:4096
    v_lshlrev_b32 v114, 16, v10
    v_and_b32 v115, 0xffff0000, v10
    s_waitcnt lgkmcnt(8)
    v_mfma_f32_16x16x32_bf16 v[200:203], v[72:75], v[152:155], v[200:203]
    ds_read_b64_tr_b16 v[64:65], v50 offset:8192
    v_mfma_f32_16x16x32_bf16 v[232:235], v[72:75], v[156:159], v[232:235]
    ds_read_b64_tr_b16 v[66:67], v50 offset:12288
    v_lshlrev_b32 v100, 16, v42
    v_and_b32 v101, 0xffff0000, v42
    v_mfma_f32_16x16x32_bf16 v[204:207], v[76:79], v[152:155], v[204:207]
    ds_read_b64_tr_b16 v[68:69], v51 offset:8192
    v_sub_f32 v116, v100, v48
    v_sub_f32 v117, v101, v48
    v_mfma_f32_16x16x32_bf16 v[236:239], v[76:79], v[156:159], v[236:239]
    ds_read_b64_tr_b16 v[70:71], v51 offset:12288
    v_cvt_pk_bf16_f32 v10, v116, v117
    v_lshlrev_b32 v116, 16, v10
    s_waitcnt lgkmcnt(8)
    v_mfma_f32_16x16x32_bf16 v[192:195], v[80:83], v[160:163], v[192:195]
    ds_read_b64_tr_b16 v[72:73], v52 offset:8192
    v_and_b32 v117, 0xffff0000, v10
    v_mul_f32 v116, v116, v49
    v_mfma_f32_16x16x32_bf16 v[224:227], v[80:83], v[164:167], v[224:227]
    ds_read_b64_tr_b16 v[74:75], v52 offset:12288
    v_mul_f32 v117, v117, v49
    v_cvt_pk_bf16_f32 v10, v116, v117
    v_mfma_f32_16x16x32_bf16 v[196:199], v[84:87], v[160:163], v[196:199]
    ds_read_b64_tr_b16 v[76:77], v53 offset:8192
    v_lshlrev_b32 v116, 16, v10
    v_and_b32 v117, 0xffff0000, v10
    v_mfma_f32_16x16x32_bf16 v[228:231], v[84:87], v[164:167], v[228:231]
    ds_read_b64_tr_b16 v[78:79], v53 offset:12288
    v_mul_f32 v11, 0xbfb8aa3b, v116
    v_mul_f32 v12, 0xbfb8aa3b, v117
    s_waitcnt vmcnt(4)
    s_barrier
    s_waitcnt lgkmcnt(8)
    v_mfma_f32_16x16x32_bf16 v[200:203], v[88:91], v[160:163], v[200:203]
    ds_read_b64_tr_b16 v[80:81], v50 offset:16384
    v_mfma_f32_16x16x32_bf16 v[232:235], v[88:91], v[164:167], v[232:235]
    ds_read_b64_tr_b16 v[82:83], v50 offset:20480
    v_exp_f32 v11, v11
    v_exp_f32 v12, v12
    v_mfma_f32_16x16x32_bf16 v[204:207], v[92:95], v[160:163], v[204:207]
    ds_read_b64_tr_b16 v[84:85], v51 offset:16384
    v_add_f32 v11, 1.0, v11
    v_add_f32 v12, 1.0, v12
    v_mfma_f32_16x16x32_bf16 v[236:239], v[92:95], v[164:167], v[236:239]
    ds_read_b64_tr_b16 v[86:87], v51 offset:20480
    v_rcp_f32 v11, v11
    v_rcp_f32 v12, v12
    s_waitcnt lgkmcnt(8)
    v_mfma_f32_16x16x32_bf16 v[192:195], v[64:67], v[168:171], v[192:195]
    ds_read_b64_tr_b16 v[88:89], v52 offset:16384
    v_mul_f32 v116, v116, v11
    v_mul_f32 v117, v117, v12
    v_mfma_f32_16x16x32_bf16 v[224:227], v[64:67], v[172:175], v[224:227]
    ds_read_b64_tr_b16 v[90:91], v52 offset:20480
    v_cvt_pk_bf16_f32 v10, v116, v117
    v_lshlrev_b32 v116, 16, v10
    v_mfma_f32_16x16x32_bf16 v[196:199], v[68:71], v[168:171], v[196:199]
    ds_read_b64_tr_b16 v[92:93], v53 offset:16384
    v_and_b32 v117, 0xffff0000, v10
    v_lshlrev_b32 v102, 16, v43
    v_mfma_f32_16x16x32_bf16 v[228:231], v[68:71], v[172:175], v[228:231]
    ds_read_b64_tr_b16 v[94:95], v53 offset:20480
    s_waitcnt lgkmcnt(8)
    v_mfma_f32_16x16x32_bf16 v[200:203], v[72:75], v[168:171], v[200:203]
    ds_read_b64_tr_b16 v[64:65], v50 offset:24576
    v_and_b32 v103, 0xffff0000, v43
    v_sub_f32 v118, v102, v48
    v_mfma_f32_16x16x32_bf16 v[232:235], v[72:75], v[172:175], v[232:235]
    ds_read_b64_tr_b16 v[66:67], v50 offset:28672
    v_sub_f32 v119, v103, v48
    v_cvt_pk_bf16_f32 v10, v118, v119
    v_mfma_f32_16x16x32_bf16 v[204:207], v[76:79], v[168:171], v[204:207]
    ds_read_b64_tr_b16 v[68:69], v51 offset:24576
    v_lshlrev_b32 v118, 16, v10
    v_and_b32 v119, 0xffff0000, v10
    v_mfma_f32_16x16x32_bf16 v[236:239], v[76:79], v[172:175], v[236:239]
    ds_read_b64_tr_b16 v[70:71], v51 offset:28672
    v_mul_f32 v118, v118, v49
    v_mul_f32 v119, v119, v49
    s_waitcnt lgkmcnt(8)
    s_waitcnt vmcnt(2)
    v_mfma_f32_16x16x32_bf16 v[192:195], v[80:83], v[176:179], v[192:195]
    ds_read_b64_tr_b16 v[72:73], v52 offset:24576
    v_cvt_pk_bf16_f32 v10, v118, v119
    v_lshlrev_b32 v118, 16, v10
    v_mfma_f32_16x16x32_bf16 v[224:227], v[80:83], v[180:183], v[224:227]
    ds_read_b64_tr_b16 v[74:75], v52 offset:28672
    v_and_b32 v119, 0xffff0000, v10
    v_mul_f32 v11, 0xbfb8aa3b, v118
    v_mfma_f32_16x16x32_bf16 v[196:199], v[84:87], v[176:179], v[196:199]
    ds_read_b64_tr_b16 v[76:77], v53 offset:24576
    v_mfma_f32_16x16x32_bf16 v[228:231], v[84:87], v[180:183], v[228:231]
    ds_read_b64_tr_b16 v[78:79], v53 offset:28672
    v_mul_f32 v12, 0xbfb8aa3b, v119
    v_exp_f32 v11, v11
    s_waitcnt lgkmcnt(8)
    v_mfma_f32_16x16x32_bf16 v[200:203], v[88:91], v[176:179], v[200:203]
    ds_read_b64_tr_b16 v[80:81], v54 offset:8192
    v_exp_f32 v12, v12
    v_add_f32 v11, 1.0, v11
    v_mfma_f32_16x16x32_bf16 v[232:235], v[88:91], v[180:183], v[232:235]
    ds_read_b64_tr_b16 v[82:83], v54 offset:12288
    v_add_f32 v12, 1.0, v12
    v_rcp_f32 v11, v11
    v_mfma_f32_16x16x32_bf16 v[204:207], v[92:95], v[176:179], v[204:207]
    ds_read_b64_tr_b16 v[84:85], v55 offset:8192
    v_rcp_f32 v12, v12
    v_mul_f32 v118, v118, v11
    v_mfma_f32_16x16x32_bf16 v[236:239], v[92:95], v[180:183], v[236:239]
    ds_read_b64_tr_b16 v[86:87], v55 offset:12288
    v_mul_f32 v119, v119, v12
    v_cvt_pk_bf16_f32 v10, v118, v119
    s_waitcnt lgkmcnt(8)
    s_waitcnt vmcnt(0)
    v_mfma_f32_16x16x32_bf16 v[192:195], v[64:67], v[184:187], v[192:195]
    ds_read_b64_tr_b16 v[88:89], v56 offset:8192
    v_lshlrev_b32 v118, 16, v10
    v_and_b32 v119, 0xffff0000, v10
    v_mfma_f32_16x16x32_bf16 v[224:227], v[64:67], v[188:191], v[224:227]
    ds_read_b64_tr_b16 v[90:91], v56 offset:12288
    v_mfma_f32_16x16x32_bf16 v[196:199], v[68:71], v[184:187], v[196:199]
    ds_read_b64_tr_b16 v[92:93], v57 offset:8192
    v_lshlrev_b32 v104, 16, v44
    v_and_b32 v105, 0xffff0000, v44
    v_mfma_f32_16x16x32_bf16 v[228:231], v[68:71], v[188:191], v[228:231]
    ds_read_b64_tr_b16 v[94:95], v57 offset:12288
    v_sub_f32 v120, v104, v48
    v_sub_f32 v121, v105, v48
    s_waitcnt lgkmcnt(8)
    v_mfma_f32_16x16x32_bf16 v[200:203], v[72:75], v[184:187], v[200:203]
    ds_read_b64_tr_b16 v[64:65], v54 offset:16384
    v_cvt_pk_bf16_f32 v10, v120, v121
    v_lshlrev_b32 v120, 16, v10
    v_mfma_f32_16x16x32_bf16 v[232:235], v[72:75], v[188:191], v[232:235]
    ds_read_b64_tr_b16 v[66:67], v54 offset:20480
    v_and_b32 v121, 0xffff0000, v10
    v_mul_f32 v120, v120, v49
    v_mfma_f32_16x16x32_bf16 v[204:207], v[76:79], v[184:187], v[204:207]
    ds_read_b64_tr_b16 v[68:69], v55 offset:16384
    v_mul_f32 v121, v121, v49
    v_cvt_pk_bf16_f32 v10, v120, v121
    v_mfma_f32_16x16x32_bf16 v[236:239], v[76:79], v[188:191], v[236:239]
    ds_read_b64_tr_b16 v[70:71], v55 offset:20480
    v_lshlrev_b32 v120, 16, v10
    v_and_b32 v121, 0xffff0000, v10
    s_waitcnt lgkmcnt(8)
    v_mfma_f32_16x16x32_bf16 v[208:211], v[80:83], v[136:139], v[208:211]
    ds_read_b64_tr_b16 v[72:73], v56 offset:16384
    v_mul_f32 v11, 0xbfb8aa3b, v120
    v_mul_f32 v12, 0xbfb8aa3b, v121
    v_mfma_f32_16x16x32_bf16 v[240:243], v[80:83], v[140:143], v[240:243]
    ds_read_b64_tr_b16 v[74:75], v56 offset:20480
    v_mfma_f32_16x16x32_bf16 v[212:215], v[84:87], v[136:139], v[212:215]
    ds_read_b64_tr_b16 v[76:77], v57 offset:16384
    v_exp_f32 v11, v11
    v_exp_f32 v12, v12
    ds_write_b128 v20, v[224:227] offset:0
    v_mfma_f32_16x16x32_bf16 v[244:247], v[84:87], v[140:143], v[244:247]
    ds_read_b64_tr_b16 v[78:79], v57 offset:20480
    v_add_f32 v11, 1.0, v11
    v_add_f32 v12, 1.0, v12
    ds_write_b128 v20, v[228:231] offset:1024
    s_waitcnt lgkmcnt(10)
    v_mfma_f32_16x16x32_bf16 v[216:219], v[88:91], v[136:139], v[216:219]
    ds_read_b64_tr_b16 v[80:81], v54 offset:24576
    v_rcp_f32 v11, v11
    v_rcp_f32 v12, v12
    ds_write_b128 v20, v[232:235] offset:2048
    v_mfma_f32_16x16x32_bf16 v[248:251], v[88:91], v[140:143], v[248:251]
    ds_read_b64_tr_b16 v[82:83], v54 offset:28672
    v_xor_b32 v54, 65536, v54
    v_mul_f32 v120, v120, v11
    v_mul_f32 v121, v121, v12
    ds_write_b128 v20, v[236:239] offset:3072
    v_mfma_f32_16x16x32_bf16 v[220:223], v[92:95], v[136:139], v[220:223]
    ds_read_b64_tr_b16 v[84:85], v55 offset:24576
    v_cvt_pk_bf16_f32 v10, v120, v121
    v_lshlrev_b32 v120, 16, v10
    v_mfma_f32_16x16x32_bf16 v[252:255], v[92:95], v[140:143], v[252:255]
    ds_read_b64_tr_b16 v[86:87], v55 offset:28672
    v_xor_b32 v55, 65536, v55
    v_and_b32 v121, 0xffff0000, v10
    v_lshlrev_b32 v106, 16, v45
    s_waitcnt lgkmcnt(12)
    v_mfma_f32_16x16x32_bf16 v[208:211], v[64:67], v[144:147], v[208:211]
    ds_read_b64_tr_b16 v[88:89], v56 offset:24576
    v_mfma_f32_16x16x32_bf16 v[240:243], v[64:67], v[148:151], v[240:243]
    ds_read_b64_tr_b16 v[90:91], v56 offset:28672
    v_xor_b32 v56, 65536, v56
    v_and_b32 v107, 0xffff0000, v45
    v_sub_f32 v122, v106, v48
    v_mfma_f32_16x16x32_bf16 v[212:215], v[68:71], v[144:147], v[212:215]
    ds_read_b64_tr_b16 v[92:93], v57 offset:24576
    v_sub_f32 v123, v107, v48
    v_cvt_pk_bf16_f32 v10, v122, v123
    s_waitcnt lgkmcnt(5)
    s_barrier
    v_mfma_f32_16x16x32_bf16 v[244:247], v[68:71], v[148:151], v[244:247]
    ds_read_b64_tr_b16 v[94:95], v57 offset:28672
    v_xor_b32 v57, 65536, v57
    v_lshlrev_b32 v122, 16, v10
    v_and_b32 v123, 0xffff0000, v10
    ds_read_b128 v[224:227], v21 offset:0
    ds_read_b128 v[228:231], v21 offset:1024
    v_mfma_f32_16x16x32_bf16 v[216:219], v[72:75], v[144:147], v[216:219]
    ds_read_b64_tr_b16 v[64:65], v54 offset:0
    v_mul_f32 v122, v122, v49
    v_mul_f32 v123, v123, v49
    ds_read_b128 v[232:235], v21 offset:2048
    ds_read_b128 v[236:239], v21 offset:3072
    v_mfma_f32_16x16x32_bf16 v[248:251], v[72:75], v[148:151], v[248:251]
    ds_read_b64_tr_b16 v[66:67], v54 offset:4096
    v_cvt_pk_bf16_f32 v10, v122, v123
    v_lshlrev_b32 v122, 16, v10
    v_mfma_f32_16x16x32_bf16 v[220:223], v[76:79], v[144:147], v[220:223]
    ds_read_b64_tr_b16 v[68:69], v55 offset:0
    v_and_b32 v123, 0xffff0000, v10
    v_mul_f32 v11, 0xbfb8aa3b, v122
    v_mfma_f32_16x16x32_bf16 v[252:255], v[76:79], v[148:151], v[252:255]
    ds_read_b64_tr_b16 v[70:71], v55 offset:4096
    s_waitcnt lgkmcnt(12)
    v_mfma_f32_16x16x32_bf16 v[208:211], v[80:83], v[152:155], v[208:211]
    ds_read_b64_tr_b16 v[72:73], v56 offset:0
    v_mul_f32 v12, 0xbfb8aa3b, v123
    v_exp_f32 v11, v11
    s_waitcnt lgkmcnt(8)
    v_add_f32 v192, v192, v224
    v_add_f32 v193, v193, v225
    v_mfma_f32_16x16x32_bf16 v[240:243], v[80:83], v[156:159], v[240:243]
    ds_read_b64_tr_b16 v[74:75], v56 offset:4096
    v_exp_f32 v12, v12
    v_add_f32 v11, 1.0, v11
    v_add_f32 v194, v194, v226
    v_add_f32 v195, v195, v227
    buffer_store_dwordx4 v[192:195], v18, s[24:27], s41 offen offset:0 sc1
    v_mfma_f32_16x16x32_bf16 v[212:215], v[84:87], v[152:155], v[212:215]
    ds_read_b64_tr_b16 v[76:77], v57 offset:0
    v_add_f32 v12, 1.0, v12
    v_rcp_f32 v11, v11
    s_waitcnt lgkmcnt(9)
    v_add_f32 v196, v196, v228
    v_add_f32 v197, v197, v229
    v_mfma_f32_16x16x32_bf16 v[244:247], v[84:87], v[156:159], v[244:247]
    ds_read_b64_tr_b16 v[78:79], v57 offset:4096
    v_rcp_f32 v12, v12
    v_mul_f32 v122, v122, v11
    v_add_f32 v198, v198, v230
    v_add_f32 v199, v199, v231
    buffer_store_dwordx4 v[196:199], v18, s[24:27], s41 offen offset:1024 sc1
    v_mfma_f32_16x16x32_bf16 v[216:219], v[88:91], v[152:155], v[216:219]
    ds_read_b64_tr_b16 v[80:81], v54 offset:8192
    v_mul_f32 v123, v123, v12
    v_cvt_pk_bf16_f32 v10, v122, v123
    s_waitcnt lgkmcnt(9)
    v_add_f32 v200, v200, v232
    v_add_f32 v201, v201, v233
    v_mfma_f32_16x16x32_bf16 v[248:251], v[88:91], v[156:159], v[248:251]
    ds_read_b64_tr_b16 v[82:83], v54 offset:12288
    v_lshlrev_b32 v122, 16, v10
    v_and_b32 v123, 0xffff0000, v10
    v_add_f32 v202, v202, v234
    v_add_f32 v203, v203, v235
    buffer_store_dwordx4 v[200:203], v18, s[24:27], s41 offen offset:2048 sc1
    v_mfma_f32_16x16x32_bf16 v[220:223], v[92:95], v[152:155], v[220:223]
    ds_read_b64_tr_b16 v[84:85], v55 offset:8192
    s_waitcnt lgkmcnt(10)
    v_add_f32 v204, v204, v236
    v_add_f32 v205, v205, v237
    v_mfma_f32_16x16x32_bf16 v[252:255], v[92:95], v[156:159], v[252:255]
    ds_read_b64_tr_b16 v[86:87], v55 offset:12288
    v_lshlrev_b32 v108, 16, v46
    v_and_b32 v109, 0xffff0000, v46
    v_add_f32 v206, v206, v238
    v_add_f32 v207, v207, v239
    buffer_store_dwordx4 v[204:207], v18, s[24:27], s41 offen offset:3072 sc1
    s_waitcnt lgkmcnt(8)
    v_mfma_f32_16x16x32_bf16 v[208:211], v[64:67], v[160:163], v[208:211]
    ds_read_b64_tr_b16 v[88:89], v56 offset:8192
    v_sub_f32 v124, v108, v48
    v_sub_f32 v125, v109, v48
    v_mfma_f32_16x16x32_bf16 v[240:243], v[64:67], v[164:167], v[240:243]
    ds_read_b64_tr_b16 v[90:91], v56 offset:12288
    v_cvt_pk_bf16_f32 v10, v124, v125
    v_lshlrev_b32 v124, 16, v10
    v_mfma_f32_16x16x32_bf16 v[212:215], v[68:71], v[160:163], v[212:215]
    ds_read_b64_tr_b16 v[92:93], v57 offset:8192
    v_and_b32 v125, 0xffff0000, v10
    v_mul_f32 v124, v124, v49
    v_mfma_f32_16x16x32_bf16 v[244:247], v[68:71], v[164:167], v[244:247]
    ds_read_b64_tr_b16 v[94:95], v57 offset:12288
    v_mul_f32 v125, v125, v49
    v_cvt_pk_bf16_f32 v10, v124, v125
    s_waitcnt lgkmcnt(8)
    v_mfma_f32_16x16x32_bf16 v[216:219], v[72:75], v[160:163], v[216:219]
    ds_read_b64_tr_b16 v[64:65], v54 offset:16384
    v_lshlrev_b32 v124, 16, v10
    v_and_b32 v125, 0xffff0000, v10
    v_mfma_f32_16x16x32_bf16 v[248:251], v[72:75], v[164:167], v[248:251]
    ds_read_b64_tr_b16 v[66:67], v54 offset:20480
    v_mul_f32 v11, 0xbfb8aa3b, v124
    v_mul_f32 v12, 0xbfb8aa3b, v125
    v_mfma_f32_16x16x32_bf16 v[220:223], v[76:79], v[160:163], v[220:223]
    ds_read_b64_tr_b16 v[68:69], v55 offset:16384
    v_mfma_f32_16x16x32_bf16 v[252:255], v[76:79], v[164:167], v[252:255]
    ds_read_b64_tr_b16 v[70:71], v55 offset:20480
    v_exp_f32 v11, v11
    v_exp_f32 v12, v12
    s_waitcnt lgkmcnt(8)
    v_mfma_f32_16x16x32_bf16 v[208:211], v[80:83], v[168:171], v[208:211]
    ds_read_b64_tr_b16 v[72:73], v56 offset:16384
    v_add_f32 v11, 1.0, v11
    v_add_f32 v12, 1.0, v12
    v_mfma_f32_16x16x32_bf16 v[240:243], v[80:83], v[172:175], v[240:243]
    ds_read_b64_tr_b16 v[74:75], v56 offset:20480
    v_rcp_f32 v11, v11
    v_rcp_f32 v12, v12
    v_mfma_f32_16x16x32_bf16 v[212:215], v[84:87], v[168:171], v[212:215]
    ds_read_b64_tr_b16 v[76:77], v57 offset:16384
    v_mul_f32 v124, v124, v11
    v_mul_f32 v125, v125, v12
    v_mfma_f32_16x16x32_bf16 v[244:247], v[84:87], v[172:175], v[244:247]
    ds_read_b64_tr_b16 v[78:79], v57 offset:20480
    v_cvt_pk_bf16_f32 v10, v124, v125
    v_lshlrev_b32 v124, 16, v10
    s_waitcnt lgkmcnt(8)
    v_mfma_f32_16x16x32_bf16 v[216:219], v[88:91], v[168:171], v[216:219]
    ds_read_b64_tr_b16 v[80:81], v54 offset:24576
    v_and_b32 v125, 0xffff0000, v10
    v_lshlrev_b32 v110, 16, v47
    v_mfma_f32_16x16x32_bf16 v[248:251], v[88:91], v[172:175], v[248:251]
    ds_read_b64_tr_b16 v[82:83], v54 offset:28672
    v_mfma_f32_16x16x32_bf16 v[220:223], v[92:95], v[168:171], v[220:223]
    ds_read_b64_tr_b16 v[84:85], v55 offset:24576
    v_and_b32 v111, 0xffff0000, v47
    v_sub_f32 v126, v110, v48
    v_mfma_f32_16x16x32_bf16 v[252:255], v[92:95], v[172:175], v[252:255]
    ds_read_b64_tr_b16 v[86:87], v55 offset:28672
    v_sub_f32 v127, v111, v48
    v_cvt_pk_bf16_f32 v10, v126, v127
    s_waitcnt lgkmcnt(8)
    v_mfma_f32_16x16x32_bf16 v[208:211], v[64:67], v[176:179], v[208:211]
    ds_read_b64_tr_b16 v[88:89], v56 offset:24576
    v_lshlrev_b32 v126, 16, v10
    v_and_b32 v127, 0xffff0000, v10
    v_mfma_f32_16x16x32_bf16 v[240:243], v[64:67], v[180:183], v[240:243]
    ds_read_b64_tr_b16 v[90:91], v56 offset:28672
    v_mul_f32 v126, v126, v49
    v_mul_f32 v127, v127, v49
    v_mfma_f32_16x16x32_bf16 v[212:215], v[68:71], v[176:179], v[212:215]
    ds_read_b64_tr_b16 v[92:93], v57 offset:24576
    v_cvt_pk_bf16_f32 v10, v126, v127
    v_lshlrev_b32 v126, 16, v10
    v_mfma_f32_16x16x32_bf16 v[244:247], v[68:71], v[180:183], v[244:247]
    ds_read_b64_tr_b16 v[94:95], v57 offset:28672
    v_and_b32 v127, 0xffff0000, v10
    v_mul_f32 v11, 0xbfb8aa3b, v126
    s_waitcnt lgkmcnt(8)
    v_mfma_f32_16x16x32_bf16 v[216:219], v[72:75], v[176:179], v[216:219]
    v_mfma_f32_16x16x32_bf16 v[248:251], v[72:75], v[180:183], v[248:251]
    v_mul_f32 v12, 0xbfb8aa3b, v127
    v_exp_f32 v11, v11
    v_mfma_f32_16x16x32_bf16 v[220:223], v[76:79], v[176:179], v[220:223]
    v_exp_f32 v12, v12
    v_add_f32 v11, 1.0, v11
    v_mfma_f32_16x16x32_bf16 v[252:255], v[76:79], v[180:183], v[252:255]
    v_add_f32 v12, 1.0, v12
    v_rcp_f32 v11, v11
    s_waitcnt lgkmcnt(4)
    v_mfma_f32_16x16x32_bf16 v[208:211], v[80:83], v[184:187], v[208:211]
    v_rcp_f32 v12, v12
    v_mul_f32 v126, v126, v11
    v_mfma_f32_16x16x32_bf16 v[240:243], v[80:83], v[188:191], v[240:243]
    v_mul_f32 v127, v127, v12
    v_cvt_pk_bf16_f32 v10, v126, v127
    v_mfma_f32_16x16x32_bf16 v[212:215], v[84:87], v[184:187], v[212:215]
    v_lshlrev_b32 v126, 16, v10
    v_and_b32 v127, 0xffff0000, v10
    s_lshr_b32 s36, s28, 2
    s_lshl_b32 s36, s36, 15
    s_and_b32 s37, s28, 3
    v_mfma_f32_16x16x32_bf16 v[244:247], v[84:87], v[188:191], v[244:247]
    s_lshl_b32 s37, s37, 12
    s_add_u32 s36, s36, s37
    s_add_u32 s36, s36, 65536
    s_waitcnt lgkmcnt(0)
    v_mfma_f32_16x16x32_bf16 v[216:219], v[88:91], v[184:187], v[216:219]
    v_add_u32 v20, s36, v22
    v_xor_b32 v21, 32768, v20
    v_mfma_f32_16x16x32_bf16 v[248:251], v[88:91], v[188:191], v[248:251]
    v_mfma_f32_16x16x32_bf16 v[220:223], v[92:95], v[184:187], v[220:223]
    v_mfma_f32_16x16x32_bf16 v[252:255], v[92:95], v[188:191], v[252:255]
    s_waitcnt vmcnt(0)
    v_mov_b32 v4, s40
    v_mov_b32 v13, 1
    s_mov_b64 exec, 1
    global_atomic_add v4, v13, s[90:91]
    s_mov_b64 exec, -1
    s_nop 3
    s_nop 4
    ds_write_b128 v20, v[240:243] offset:0
    ds_write_b128 v20, v[244:247] offset:1024
    ds_write_b128 v20, v[248:251] offset:2048
    ds_write_b128 v20, v[252:255] offset:3072
    s_sub_u32 s36, s56, s38
    s_sub_u32 s37, s57, s38
    s_min_u32 s36, s36, s37
    s_cmp_lt_u32 s36, 16
    s_cbranch_scc1 L_recurrent_scan__compressed_kv_cla__moe_arch_mod__prompt_kernel_rare_170
L_recurrent_scan__compressed_kv_cla__moe_arch_mod__prompt_kernel_back_171:
    s_cmp_eq_u32 s28, 3
    s_cbranch_scc1 L_recurrent_scan__compressed_kv_cla__moe_arch_mod__prompt_kernel_rare_174
L_recurrent_scan__compressed_kv_cla__moe_arch_mod__prompt_kernel_back_175:
    s_waitcnt lgkmcnt(0)
    s_barrier
    buffer_load_dwordx4 v[64:67], v18, s[24:27], s39 offen offset:0 sc1
    buffer_load_dwordx4 v[68:71], v18, s[24:27], s39 offen offset:1024 sc1
    buffer_load_dwordx4 v[72:75], v18, s[24:27], s39 offen offset:2048 sc1
    buffer_load_dwordx4 v[76:79], v18, s[24:27], s39 offen offset:3072 sc1
    ds_read_b128 v[128:131], v21 offset:0
    ds_read_b128 v[132:135], v21 offset:1024
    ds_read_b128 v[136:139], v21 offset:2048
    ds_read_b128 v[140:143], v21 offset:3072
    s_waitcnt lgkmcnt(3)
    v_pk_add_f32 v[128:129], v[128:129], v[208:209]
    v_pk_add_f32 v[130:131], v[130:131], v[210:211]
    s_waitcnt lgkmcnt(2)
    v_pk_add_f32 v[132:133], v[132:133], v[212:213]
    v_pk_add_f32 v[134:135], v[134:135], v[214:215]
    s_waitcnt lgkmcnt(1)
    v_pk_add_f32 v[136:137], v[136:137], v[216:217]
    v_pk_add_f32 v[138:139], v[138:139], v[218:219]
    s_waitcnt lgkmcnt(0)
    v_pk_add_f32 v[140:141], v[140:141], v[220:221]
    v_pk_add_f32 v[142:143], v[142:143], v[222:223]
    s_waitcnt vmcnt(3)
    v_pk_add_f32 v[128:129], v[128:129], v[64:65]
    v_cvt_pk_bf16_f32 v23, v128, v129
    v_lshlrev_b32 v128, 16, v23
    v_and_b32 v129, 0xffff0000, v23
    v_pk_mul_f32 v[128:129], v[128:129], v[112:113]
    v_cvt_pk_bf16_f32 v23, v128, v129
    v_lshlrev_b32 v128, 16, v23
    v_and_b32 v129, 0xffff0000, v23
    v_pk_add_f32 v[128:129], v[128:129], v[96:97]
    v_cvt_pk_bf16_f32 v80, v128, v129
    v_pk_add_f32 v[130:131], v[130:131], v[66:67]
    v_cvt_pk_bf16_f32 v23, v130, v131
    v_lshlrev_b32 v130, 16, v23
    v_and_b32 v131, 0xffff0000, v23
    v_pk_mul_f32 v[130:131], v[130:131], v[114:115]
    v_cvt_pk_bf16_f32 v23, v130, v131
    v_lshlrev_b32 v130, 16, v23
    v_and_b32 v131, 0xffff0000, v23
    v_pk_add_f32 v[130:131], v[130:131], v[98:99]
    v_cvt_pk_bf16_f32 v81, v130, v131
    ds_write_b64 v17, v[80:81] offset:0
    s_waitcnt vmcnt(2)
    v_pk_add_f32 v[132:133], v[132:133], v[68:69]
    v_cvt_pk_bf16_f32 v23, v132, v133
    v_lshlrev_b32 v132, 16, v23
    v_and_b32 v133, 0xffff0000, v23
    v_pk_mul_f32 v[132:133], v[132:133], v[116:117]
    v_cvt_pk_bf16_f32 v23, v132, v133
    v_lshlrev_b32 v132, 16, v23
    v_and_b32 v133, 0xffff0000, v23
    v_pk_add_f32 v[132:133], v[132:133], v[100:101]
    v_cvt_pk_bf16_f32 v82, v132, v133
    v_pk_add_f32 v[134:135], v[134:135], v[70:71]
    v_cvt_pk_bf16_f32 v23, v134, v135
    v_lshlrev_b32 v134, 16, v23
    v_and_b32 v135, 0xffff0000, v23
    v_pk_mul_f32 v[134:135], v[134:135], v[118:119]
    v_cvt_pk_bf16_f32 v23, v134, v135
    v_lshlrev_b32 v134, 16, v23
    v_and_b32 v135, 0xffff0000, v23
    v_pk_add_f32 v[134:135], v[134:135], v[102:103]
    v_cvt_pk_bf16_f32 v83, v134, v135
    ds_write_b64 v17, v[82:83] offset:32
    s_waitcnt vmcnt(1)
    v_pk_add_f32 v[136:137], v[136:137], v[72:73]
    v_cvt_pk_bf16_f32 v23, v136, v137
    v_lshlrev_b32 v136, 16, v23
    v_and_b32 v137, 0xffff0000, v23
    v_pk_mul_f32 v[136:137], v[136:137], v[120:121]
    v_cvt_pk_bf16_f32 v23, v136, v137
    v_lshlrev_b32 v136, 16, v23
    v_and_b32 v137, 0xffff0000, v23
    v_pk_add_f32 v[136:137], v[136:137], v[104:105]
    v_cvt_pk_bf16_f32 v84, v136, v137
    v_pk_add_f32 v[138:139], v[138:139], v[74:75]
    v_cvt_pk_bf16_f32 v23, v138, v139
    v_lshlrev_b32 v138, 16, v23
    v_and_b32 v139, 0xffff0000, v23
    v_pk_mul_f32 v[138:139], v[138:139], v[122:123]
    v_cvt_pk_bf16_f32 v23, v138, v139
    v_lshlrev_b32 v138, 16, v23
    v_and_b32 v139, 0xffff0000, v23
    v_pk_add_f32 v[138:139], v[138:139], v[106:107]
    v_cvt_pk_bf16_f32 v85, v138, v139
    ds_write_b64 v17, v[84:85] offset:64
    s_waitcnt vmcnt(0)
    v_pk_add_f32 v[140:141], v[140:141], v[76:77]
    v_cvt_pk_bf16_f32 v23, v140, v141
    v_lshlrev_b32 v140, 16, v23
    v_and_b32 v141, 0xffff0000, v23
    v_pk_mul_f32 v[140:141], v[140:141], v[124:125]
    v_cvt_pk_bf16_f32 v23, v140, v141
    v_lshlrev_b32 v140, 16, v23
    v_and_b32 v141, 0xffff0000, v23
    v_pk_add_f32 v[140:141], v[140:141], v[108:109]
    v_cvt_pk_bf16_f32 v86, v140, v141
    v_pk_add_f32 v[142:143], v[142:143], v[78:79]
    v_cvt_pk_bf16_f32 v23, v142, v143
    v_lshlrev_b32 v142, 16, v23
    v_and_b32 v143, 0xffff0000, v23
    v_pk_mul_f32 v[142:143], v[142:143], v[126:127]
    v_cvt_pk_bf16_f32 v23, v142, v143
    v_lshlrev_b32 v142, 16, v23
    v_and_b32 v143, 0xffff0000, v23
    v_pk_add_f32 v[142:143], v[142:143], v[110:111]
    v_cvt_pk_bf16_f32 v87, v142, v143
    ds_write_b64 v17, v[86:87] offset:96
    v_add_u32 v22, s42, v22
    s_mov_b32 s36, 16384
    s_waitcnt lgkmcnt(0)
    ds_read_b128 v[64:67], v22
    ds_read_b128 v[68:71], v22 offset:1024
    s_waitcnt lgkmcnt(1)
    buffer_store_dwordx4 v[64:67], v15, s[20:23], 0 offen sc1
    s_waitcnt lgkmcnt(0)
    buffer_store_dwordx4 v[68:71], v15, s[20:23], s36 offen sc1
    s_endpgm
L_recurrent_scan__compressed_kv_cla__moe_arch_mod__prompt_kernel_rare_134:
    v_mov_b32 v26, s40
    v_mov_b32 v28, 1
    v_writelane_b32 v26, s41, 1
    s_mov_b64 exec, 3
    global_atomic_add v26, v28, s[90:91]
    s_mov_b64 exec, -1
    s_branch L_recurrent_scan__compressed_kv_cla__moe_arch_mod__prompt_kernel_back_135
L_recurrent_scan__compressed_kv_cla__moe_arch_mod__prompt_kernel_rt1_rare_3:
    s_mov_b32 s61, 0x40000
L_recurrent_scan__compressed_kv_cla__moe_arch_mod__prompt_kernel_rt1_spin_1:
    s_sub_u32 s61, s61, 1
    s_cbranch_scc1 L_recurrent_scan__compressed_kv_cla__moe_arch_mod__prompt_kernel_rt1_spinx_2
    s_sleep 1
    global_load_dword v61, v60, s[90:91] sc1
    s_waitcnt vmcnt(0)
    v_readfirstlane_b32 s36, v61
    s_nop 0
    s_cmp_lt_u32 s36, 16
    s_cbranch_scc1 L_recurrent_scan__compressed_kv_cla__moe_arch_mod__prompt_kernel_rt1_spin_1
L_recurrent_scan__compressed_kv_cla__moe_arch_mod__prompt_kernel_rt1_spinx_2:
    s_branch L_recurrent_scan__compressed_kv_cla__moe_arch_mod__prompt_kernel_rt1_back_4
L_recurrent_scan__compressed_kv_cla__moe_arch_mod__prompt_kernel_rare_144:
    s_cmp_eq_u32 s35, 1
    s_cbranch_scc0 L_recurrent_scan__compressed_kv_cla__moe_arch_mod__prompt_kernel_swn_143
    s_cmp_eq_u32 s28, 0
    s_cbranch_scc0 L_recurrent_scan__compressed_kv_cla__moe_arch_mod__prompt_kernel_g_137
    s_and_b32 s36, s2, 15
    s_add_u32 s36, s36, 96
    s_lshl_b32 s36, s36, 7
    v_mov_b32 v26, s36
    v_mov_b32 v27, 1
    s_mov_b64 exec, 1
    global_atomic_add v26, v27, s[90:91]
    s_mov_b64 exec, -1
    s_nop 3
L_recurrent_scan__compressed_kv_cla__moe_arch_mod__prompt_kernel_g_137:
    s_branch L_recurrent_scan__compressed_kv_cla__moe_arch_mod__prompt_kernel_swend_142
L_recurrent_scan__compressed_kv_cla__moe_arch_mod__prompt_kernel_swn_143:
    s_sub_u32 s36, s56, s38
    s_sub_u32 s37, s57, s38
    s_min_u32 s36, s36, s37
    s_cmp_lt_u32 s36, 16
    s_cbranch_scc0 L_recurrent_scan__compressed_kv_cla__moe_arch_mod__prompt_kernel_nrt_138
    s_add_u32 s36, s30, 96
    s_lshl_b32 s36, s36, 7
    v_mov_b32 v60, s36
    global_load_dword v61, v60, s[90:91] sc1
L_recurrent_scan__compressed_kv_cla__moe_arch_mod__prompt_kernel_nrt_138:
    s_mov_b32 m0, s42
    s_mov_b32 s36, 15360
    buffer_load_dwordx4 v15, s[16:19], 0 offen lds
    buffer_load_dwordx4 v15, s[16:19], s36 offen offset:1024 lds
    s_mov_b32 s36, 4194304
    buffer_load_dwordx2 v[48:49], v16, s[24:27], s36 offen sc1
L_recurrent_scan__compressed_kv_cla__moe_arch_mod__prompt_kernel_swend_142:
    s_branch L_recurrent_scan__compressed_kv_cla__moe_arch_mod__prompt_kernel_back_145
L_recurrent_scan__compressed_kv_cla__moe_arch_mod__prompt_kernel_rare_147:
    s_cmp_eq_u32 s28, 0
    s_cbranch_scc0 L_recurrent_scan__compressed_kv_cla__moe_arch_mod__prompt_kernel_g_141
    s_mov_b32 s43, s38
    s_getpc_b64 s[36:37]
L_recurrent_scan__compressed_kv_cla__moe_arch_mod__prompt_kernel_pc_140:
    s_sub_u32 s36, s36, L_recurrent_scan__compressed_kv_cla__moe_arch_mod__prompt_kernel_pc_140-L_pc
    s_subb_u32 s37, s37, 0
    s_lshr_b32 s38, s2, 3
    s_lshl_b32 s38, s38, 7
    v_lshl_add_u32 v4, v1, 12, s38
    v_min_u32 v4, L_end-L_pc-4, v4
    v_mov_b32 v5, s37
    v_add_co_u32 v4, vcc, s36, v4
    s_mov_b64 exec, 0xffff
    s_nop 0
    v_addc_co_u32 v5, vcc, 0, v5, vcc
    global_load_dword v63, v[4:5], off
    s_mov_b64 exec, -1
    s_nop 1
    s_mov_b32 s38, s43
L_recurrent_scan__compressed_kv_cla__moe_arch_mod__prompt_kernel_g_141:
    s_sub_u32 s36, s56, s38
    s_sub_u32 s37, s57, s38
    s_min_u32 s36, s36, s37
    s_cmp_lt_u32 s36, 16
    s_cbranch_scc0 L_recurrent_scan__compressed_kv_cla__moe_arch_mod__prompt_kernel_nrt_139
    s_waitcnt vmcnt(16)
    v_readfirstlane_b32 s36, v61
    s_nop 0
    s_cmp_lt_u32 s36, 16
    s_cbranch_scc1 L_recurrent_scan__compressed_kv_cla__moe_arch_mod__prompt_kernel_rt1_rare_3
L_recurrent_scan__compressed_kv_cla__moe_arch_mod__prompt_kernel_rt1_back_4:
    s_lshl_b32 s37, s30, 8
    s_add_u32 s36, s37, 59768832
    s_add_u32 s37, s36, 4096
    v_and_b32 v60, 15, v1
    v_lshlrev_b32 v60, 13, v60
    v_lshl_add_u32 v60, v19, 4, v60
    buffer_load_dwordx4 v[96:99], v60, s[24:27], s36 offen offset:0 sc1
    buffer_load_dwordx4 v[100:103], v60, s[24:27], s36 offen offset:64 sc1
    buffer_load_dwordx4 v[104:107], v60, s[24:27], s36 offen offset:128 sc1
    buffer_load_dwordx4 v[108:111], v60, s[24:27], s36 offen offset:192 sc1
    buffer_load_dwordx4 v[112:115], v60, s[24:27], s37 offen offset:0 sc1
    buffer_load_dwordx4 v[116:119], v60, s[24:27], s37 offen offset:64 sc1
    buffer_load_dwordx4 v[120:123], v60, s[24:27], s37 offen offset:128 sc1
    buffer_load_dwordx4 v[124:127], v60, s[24:27], s37 offen offset:192 sc1
L_recurrent_scan__compressed_kv_cla__moe_arch_mod__prompt_kernel_nrt_139:
L_recurrent_scan__compressed_kv_cla__moe_arch_mod__prompt_kernel_swend_146:
    s_branch L_recurrent_scan__compressed_kv_cla__moe_arch_mod__prompt_kernel_back_148
L_recurrent_scan__compressed_kv_cla__moe_arch_mod__prompt_kernel_rare_149:
    global_load_dword v59, v58, s[90:91] sc1
    s_branch L_recurrent_scan__compressed_kv_cla__moe_arch_mod__prompt_kernel_back_150
L_recurrent_scan__compressed_kv_cla__moe_arch_mod__prompt_kernel_rare_159:
    s_cmp_eq_u32 s35, 0
    s_cbranch_scc0 L_recurrent_scan__compressed_kv_cla__moe_arch_mod__prompt_kernel_swn_158
    s_mov_b32 s61, 0x40000
    s_waitcnt vmcnt(7)
    s_branch L_recurrent_scan__compressed_kv_cla__moe_arch_mod__prompt_kernel_cchk_153
L_recurrent_scan__compressed_kv_cla__moe_arch_mod__prompt_kernel_cspin_151:
    s_sub_u32 s61, s61, 1
    s_cbranch_scc1 L_recurrent_scan__compressed_kv_cla__moe_arch_mod__prompt_kernel_cspinx_152
    global_load_dword v59, v58, s[90:91] sc1
    s_waitcnt vmcnt(0)
L_recurrent_scan__compressed_kv_cla__moe_arch_mod__prompt_kernel_cchk_153:
    v_cmp_le_u32 vcc, 4, v59
    s_nop 0
    s_and_b32 s60, vcc_lo, 15
    s_and_b32 s36, s60, 7
    s_cmp_eq_u32 s36, 7
    s_cbranch_scc1 L_recurrent_scan__compressed_kv_cla__moe_arch_mod__prompt_kernel_cspinx_152
    s_sleep 6
    s_branch L_recurrent_scan__compressed_kv_cla__moe_arch_mod__prompt_kernel_cspin_151
L_recurrent_scan__compressed_kv_cla__moe_arch_mod__prompt_kernel_cspinx_152:
    s_branch L_recurrent_scan__compressed_kv_cla__moe_arch_mod__prompt_kernel_swend_157
L_recurrent_scan__compressed_kv_cla__moe_arch_mod__prompt_kernel_swn_158:
    s_mov_b32 s61, 0x40000
    s_waitcnt vmcnt(7)
    s_branch L_recurrent_scan__compressed_kv_cla__moe_arch_mod__prompt_kernel_cchk_156
L_recurrent_scan__compressed_kv_cla__moe_arch_mod__prompt_kernel_cspin_154:
    s_sub_u32 s61, s61, 1
    s_cbranch_scc1 L_recurrent_scan__compressed_kv_cla__moe_arch_mod__prompt_kernel_cspinx_155
    global_load_dword v59, v58, s[90:91] sc1
    s_waitcnt vmcnt(0)
L_recurrent_scan__compressed_kv_cla__moe_arch_mod__prompt_kernel_cchk_156:
    v_cmp_le_u32 vcc, 4, v59
    s_nop 0
    s_and_b32 s60, vcc_lo, 15
    s_and_b32 s36, s60, 15
    s_cmp_eq_u32 s36, 15
    s_cbranch_scc1 L_recurrent_scan__compressed_kv_cla__moe_arch_mod__prompt_kernel_cspinx_155
    s_sleep 6
    s_branch L_recurrent_scan__compressed_kv_cla__moe_arch_mod__prompt_kernel_cspin_154
L_recurrent_scan__compressed_kv_cla__moe_arch_mod__prompt_kernel_cspinx_155:
L_recurrent_scan__compressed_kv_cla__moe_arch_mod__prompt_kernel_swend_157:
    s_branch L_recurrent_scan__compressed_kv_cla__moe_arch_mod__prompt_kernel_back_160
L_recurrent_scan__compressed_kv_cla__moe_arch_mod__prompt_kernel_f2m_161:
    v_lshrrev_b32 v28, 4, v1
    v_bfe_u32 v26, v1, 2, 2
    v_lshl_add_u32 v26, v28, 3, v26
    v_lshlrev_b32 v26, 7, v26
    v_and_b32 v27, 3, v1
    v_lshl_add_u32 v26, v27, 3, v26
    v_bfe_u32 v27, v1, 3, 2
    s_lshl_b32 s36, s28, 12
    s_add_u32 s36, s36, 131072
    v_add_u32 v26, s36, v26
    v_xor_b32 v28, 0, v27
    v_lshl_add_u32 v28, v28, 5, v26
    ds_read_b64_tr_b16 v[112:113], v28 offset:0
    ds_read_b64_tr_b16 v[114:115], v28 offset:512
    v_xor_b32 v28, 1, v27
    v_lshl_add_u32 v28, v28, 5, v26
    ds_read_b64_tr_b16 v[116:117], v28 offset:0
    ds_read_b64_tr_b16 v[118:119], v28 offset:512
    v_xor_b32 v28, 2, v27
    v_lshl_add_u32 v28, v28, 5, v26
    ds_read_b64_tr_b16 v[120:121], v28 offset:0
    ds_read_b64_tr_b16 v[122:123], v28 offset:512
    v_xor_b32 v28, 3, v27
    v_lshl_add_u32 v28, v28, 5, v26
    ds_read_b64_tr_b16 v[124:125], v28 offset:0
    ds_read_b64_tr_b16 v[126:127], v28 offset:512
    v_add_f32_dpp v96, v96, v96 row_ror:4 row_mask:0xf bank_mask:0xf
    v_add_f32_dpp v97, v97, v97 row_ror:4 row_mask:0xf bank_mask:0xf
    v_add_f32_dpp v98, v98, v98 row_ror:4 row_mask:0xf bank_mask:0xf
    v_add_f32_dpp v99, v99, v99 row_ror:4 row_mask:0xf bank_mask:0xf
    v_add_f32_dpp v100, v100, v100 row_ror:4 row_mask:0xf bank_mask:0xf
    v_add_f32_dpp v101, v101, v101 row_ror:4 row_mask:0xf bank_mask:0xf
    v_add_f32_dpp v102, v102, v102 row_ror:4 row_mask:0xf bank_mask:0xf
    v_add_f32_dpp v103, v103, v103 row_ror:4 row_mask:0xf bank_mask:0xf
    v_add_f32_dpp v96, v96, v96 row_ror:8 row_mask:0xf bank_mask:0xf
    v_add_f32_dpp v97, v97, v97 row_ror:8 row_mask:0xf bank_mask:0xf
    v_add_f32_dpp v98, v98, v98 row_ror:8 row_mask:0xf bank_mask:0xf
    v_add_f32_dpp v99, v99, v99 row_ror:8 row_mask:0xf bank_mask:0xf
    v_add_f32_dpp v100, v100, v100 row_ror:8 row_mask:0xf bank_mask:0xf
    v_add_f32_dpp v101, v101, v101 row_ror:8 row_mask:0xf bank_mask:0xf
    v_add_f32_dpp v102, v102, v102 row_ror:8 row_mask:0xf bank_mask:0xf
    v_add_f32_dpp v103, v103, v103 row_ror:8 row_mask:0xf bank_mask:0xf
    v_cvt_pk_bf16_f32 v29, v96, v97
    v_lshlrev_b32 v96, 16, v29
    v_and_b32 v97, 0xffff0000, v29
    v_cvt_pk_bf16_f32 v29, v98, v99
    v_lshlrev_b32 v98, 16, v29
    v_and_b32 v99, 0xffff0000, v29
    v_cvt_pk_bf16_f32 v29, v100, v101
    v_lshlrev_b32 v100, 16, v29
    v_and_b32 v101, 0xffff0000, v29
    v_cvt_pk_bf16_f32 v29, v102, v103
    v_lshlrev_b32 v102, 16, v29
    v_and_b32 v103, 0xffff0000, v29
    v_mul_f32 v104, 0xbfb8aa3b, v96
    v_mul_f32 v105, 0xbfb8aa3b, v97
    v_mul_f32 v106, 0xbfb8aa3b, v98
    v_mul_f32 v107, 0xbfb8aa3b, v99
    v_mul_f32 v108, 0xbfb8aa3b, v100
    v_mul_f32 v109, 0xbfb8aa3b, v101
    v_mul_f32 v110, 0xbfb8aa3b, v102
    v_mul_f32 v111, 0xbfb8aa3b, v103
    v_exp_f32 v104, v104
    v_exp_f32 v105, v105
    v_exp_f32 v106, v106
    v_exp_f32 v107, v107
    v_exp_f32 v108, v108
    v_exp_f32 v109, v109
    v_exp_f32 v110, v110
    v_exp_f32 v111, v111
    v_add_f32 v104, 1.0, v104
    v_add_f32 v105, 1.0, v105
    v_add_f32 v106, 1.0, v106
    v_add_f32 v107, 1.0, v107
    v_add_f32 v108, 1.0, v108
    v_add_f32 v109, 1.0, v109
    v_add_f32 v110, 1.0, v110
    v_add_f32 v111, 1.0, v111
    v_rcp_f32 v104, v104
    v_rcp_f32 v105, v105
    v_rcp_f32 v106, v106
    v_rcp_f32 v107, v107
    v_rcp_f32 v108, v108
    v_rcp_f32 v109, v109
    v_rcp_f32 v110, v110
    v_rcp_f32 v111, v111
    v_mul_f32 v104, v96, v104
    v_mul_f32 v105, v97, v105
    v_mul_f32 v106, v98, v106
    v_mul_f32 v107, v99, v107
    v_mul_f32 v108, v100, v108
    v_mul_f32 v109, v101, v109
    v_mul_f32 v110, v102, v110
    v_mul_f32 v111, v103, v111
    v_cvt_pk_bf16_f32 v29, v104, v105
    v_lshlrev_b32 v104, 16, v29
    v_and_b32 v105, 0xffff0000, v29
    v_cvt_pk_bf16_f32 v29, v106, v107
    v_lshlrev_b32 v106, 16, v29
    v_and_b32 v107, 0xffff0000, v29
    v_cvt_pk_bf16_f32 v29, v108, v109
    v_lshlrev_b32 v108, 16, v29
    v_and_b32 v109, 0xffff0000, v29
    v_cvt_pk_bf16_f32 v29, v110, v111
    v_lshlrev_b32 v110, 16, v29
    v_and_b32 v111, 0xffff0000, v29
    v_mul_f32_dpp v96, v96, v104 quad_perm:[2,3,0,1] row_mask:0xf bank_mask:0xf
    v_mul_f32_dpp v97, v97, v105 quad_perm:[2,3,0,1] row_mask:0xf bank_mask:0xf
    v_mul_f32_dpp v98, v98, v106 quad_perm:[2,3,0,1] row_mask:0xf bank_mask:0xf
    v_mul_f32_dpp v99, v99, v107 quad_perm:[2,3,0,1] row_mask:0xf bank_mask:0xf
    v_mul_f32_dpp v100, v100, v108 quad_perm:[2,3,0,1] row_mask:0xf bank_mask:0xf
    v_mul_f32_dpp v101, v101, v109 quad_perm:[2,3,0,1] row_mask:0xf bank_mask:0xf
    v_mul_f32_dpp v102, v102, v110 quad_perm:[2,3,0,1] row_mask:0xf bank_mask:0xf
    v_mul_f32_dpp v103, v103, v111 quad_perm:[2,3,0,1] row_mask:0xf bank_mask:0xf
    v_cvt_pk_bf16_f32 v36, v96, v97
    v_cvt_pk_bf16_f32 v37, v98, v99
    v_cvt_pk_bf16_f32 v38, v100, v101
    v_cvt_pk_bf16_f32 v39, v102, v103
    s_waitcnt lgkmcnt(0)
    v_lshl_add_u32 v28, v1, 4, s36
    v_mfma_f32_16x16x32_bf16 v[96:99], v[112:115], v[36:39], 0
    v_mfma_f32_16x16x32_bf16 v[100:103], v[116:119], v[36:39], 0
    v_mfma_f32_16x16x32_bf16 v[104:107], v[120:123], v[36:39], 0
    v_mfma_f32_16x16x32_bf16 v[108:111], v[124:127], v[36:39], 0
    s_nop 7
    ds_write_b128 v28, v[96:99] offset:0
    ds_write_b128 v28, v[100:103] offset:1024
    ds_write_b128 v28, v[104:107] offset:2048
    ds_write_b128 v28, v[108:111] offset:3072
    s_cmp_lt_u32 s28, 4
    s_cbranch_scc1 L_recurrent_scan__compressed_kv_cla__moe_arch_mod__prompt_kernel_f2b_163
    s_branch L_recurrent_scan__compressed_kv_cla__moe_arch_mod__prompt_kernel_f2a_162
L_recurrent_scan__compressed_kv_cla__moe_arch_mod__prompt_kernel_rare_168:
    v_mov_b64 v[24:25], 0
    v_mov_b64 v[26:27], 0
    v_mov_b64 v[28:29], 0
    v_mov_b64 v[30:31], 0
    v_mov_b64 v[32:33], 0
    v_mov_b64 v[34:35], 0
    v_mov_b64 v[36:37], 0
    v_mov_b64 v[38:39], 0
    s_waitcnt vmcnt(16)
    s_sub_u32 s36, s56, s38
    s_cmp_lt_u32 s36, 16
    s_cbranch_scc0 L_recurrent_scan__compressed_kv_cla__moe_arch_mod__prompt_kernel_rt2_noy_1
    s_and_b32 s36, s58, 0xffff0000
    s_cmp_lt_i32 s36, 0
    s_cselect_b32 s37, 0x80000000, -1
    s_xor_b32 s36, s36, s37
    s_and_b32 s36, s36, 0xffff0000
    v_mov_b32 v62, s36
    v_mul_f32 v62, 0xbfb8aa3b, v62
    v_exp_f32 v62, v62
    s_nop 0
    v_add_f32 v62, 1.0, v62
    v_rcp_f32 v62, v62
    s_nop 0
    v_cvt_pk_bf16_f32 v62, v62, v62
    v_lshlrev_b32 v62, 16, v62
    v_add_f32_dpp v96, v96, v96 quad_perm:[1,0,3,2] row_mask:0xf bank_mask:0xf
    v_add_f32_dpp v97, v97, v97 quad_perm:[1,0,3,2] row_mask:0xf bank_mask:0xf
    v_add_f32_dpp v98, v98, v98 quad_perm:[1,0,3,2] row_mask:0xf bank_mask:0xf
    v_add_f32_dpp v99, v99, v99 quad_perm:[1,0,3,2] row_mask:0xf bank_mask:0xf
    v_add_f32_dpp v100, v100, v100 quad_perm:[1,0,3,2] row_mask:0xf bank_mask:0xf
    v_add_f32_dpp v101, v101, v101 quad_perm:[1,0,3,2] row_mask:0xf bank_mask:0xf
    v_add_f32_dpp v102, v102, v102 quad_perm:[1,0,3,2] row_mask:0xf bank_mask:0xf
    v_add_f32_dpp v103, v103, v103 quad_perm:[1,0,3,2] row_mask:0xf bank_mask:0xf
    v_add_f32_dpp v104, v104, v104 quad_perm:[1,0,3,2] row_mask:0xf bank_mask:0xf
    v_add_f32_dpp v105, v105, v105 quad_perm:[1,0,3,2] row_mask:0xf bank_mask:0xf
    v_add_f32_dpp v106, v106, v106 quad_perm:[1,0,3,2] row_mask:0xf bank_mask:0xf
    v_add_f32_dpp v107, v107, v107 quad_perm:[1,0,3,2] row_mask:0xf bank_mask:0xf
    v_add_f32_dpp v108, v108, v108 quad_perm:[1,0,3,2] row_mask:0xf bank_mask:0xf
    v_add_f32_dpp v109, v109, v109 quad_perm:[1,0,3,2] row_mask:0xf bank_mask:0xf
    v_add_f32_dpp v110, v110, v110 quad_perm:[1,0,3,2] row_mask:0xf bank_mask:0xf
    v_add_f32_dpp v111, v111, v111 quad_perm:[1,0,3,2] row_mask:0xf bank_mask:0xf
    v_add_f32_dpp v96, v96, v96 quad_perm:[2,3,0,1] row_mask:0xf bank_mask:0xf
    v_add_f32_dpp v97, v97, v97 quad_perm:[2,3,0,1] row_mask:0xf bank_mask:0xf
    v_add_f32_dpp v98, v98, v98 quad_perm:[2,3,0,1] row_mask:0xf bank_mask:0xf
    v_add_f32_dpp v99, v99, v99 quad_perm:[2,3,0,1] row_mask:0xf bank_mask:0xf
    v_add_f32_dpp v100, v100, v100 quad_perm:[2,3,0,1] row_mask:0xf bank_mask:0xf
    v_add_f32_dpp v101, v101, v101 quad_perm:[2,3,0,1] row_mask:0xf bank_mask:0xf
    v_add_f32_dpp v102, v102, v102 quad_perm:[2,3,0,1] row_mask:0xf bank_mask:0xf
    v_add_f32_dpp v103, v103, v103 quad_perm:[2,3,0,1] row_mask:0xf bank_mask:0xf
    v_add_f32_dpp v104, v104, v104 quad_perm:[2,3,0,1] row_mask:0xf bank_mask:0xf
    v_add_f32_dpp v105, v105, v105 quad_perm:[2,3,0,1] row_mask:0xf bank_mask:0xf
    v_add_f32_dpp v106, v106, v106 quad_perm:[2,3,0,1] row_mask:0xf bank_mask:0xf
    v_add_f32_dpp v107, v107, v107 quad_perm:[2,3,0,1] row_mask:0xf bank_mask:0xf
    v_add_f32_dpp v108, v108, v108 quad_perm:[2,3,0,1] row_mask:0xf bank_mask:0xf
    v_add_f32_dpp v109, v109, v109 quad_perm:[2,3,0,1] row_mask:0xf bank_mask:0xf
    v_add_f32_dpp v110, v110, v110 quad_perm:[2,3,0,1] row_mask:0xf bank_mask:0xf
    v_add_f32_dpp v111, v111, v111 quad_perm:[2,3,0,1] row_mask:0xf bank_mask:0xf
    v_add_f32_dpp v96, v96, v96 row_half_mirror row_mask:0xf bank_mask:0xf
    v_add_f32_dpp v97, v97, v97 row_half_mirror row_mask:0xf bank_mask:0xf
    v_add_f32_dpp v98, v98, v98 row_half_mirror row_mask:0xf bank_mask:0xf
    v_add_f32_dpp v99, v99, v99 row_half_mirror row_mask:0xf bank_mask:0xf
    v_add_f32_dpp v100, v100, v100 row_half_mirror row_mask:0xf bank_mask:0xf
    v_add_f32_dpp v101, v101, v101 row_half_mirror row_mask:0xf bank_mask:0xf
    v_add_f32_dpp v102, v102, v102 row_half_mirror row_mask:0xf bank_mask:0xf
    v_add_f32_dpp v103, v103, v103 row_half_mirror row_mask:0xf bank_mask:0xf
    v_add_f32_dpp v104, v104, v104 row_half_mirror row_mask:0xf bank_mask:0xf
    v_add_f32_dpp v105, v105, v105 row_half_mirror row_mask:0xf bank_mask:0xf
    v_add_f32_dpp v106, v106, v106 row_half_mirror row_mask:0xf bank_mask:0xf
    v_add_f32_dpp v107, v107, v107 row_half_mirror row_mask:0xf bank_mask:0xf
    v_add_f32_dpp v108, v108, v108 row_half_mirror row_mask:0xf bank_mask:0xf
    v_add_f32_dpp v109, v109, v109 row_half_mirror row_mask:0xf bank_mask:0xf
    v_add_f32_dpp v110, v110, v110 row_half_mirror row_mask:0xf bank_mask:0xf
    v_add_f32_dpp v111, v111, v111 row_half_mirror row_mask:0xf bank_mask:0xf
    v_add_f32_dpp v96, v96, v96 row_mirror row_mask:0xf bank_mask:0xf
    v_add_f32_dpp v97, v97, v97 row_mirror row_mask:0xf bank_mask:0xf
    v_add_f32_dpp v98, v98, v98 row_mirror row_mask:0xf bank_mask:0xf
    v_add_f32_dpp v99, v99, v99 row_mirror row_mask:0xf bank_mask:0xf
    v_add_f32_dpp v100, v100, v100 row_mirror row_mask:0xf bank_mask:0xf
    v_add_f32_dpp v101, v101, v101 row_mirror row_mask:0xf bank_mask:0xf
    v_add_f32_dpp v102, v102, v102 row_mirror row_mask:0xf bank_mask:0xf
    v_add_f32_dpp v103, v103, v103 row_mirror row_mask:0xf bank_mask:0xf
    v_add_f32_dpp v104, v104, v104 row_mirror row_mask:0xf bank_mask:0xf
    v_add_f32_dpp v105, v105, v105 row_mirror row_mask:0xf bank_mask:0xf
    v_add_f32_dpp v106, v106, v106 row_mirror row_mask:0xf bank_mask:0xf
    v_add_f32_dpp v107, v107, v107 row_mirror row_mask:0xf bank_mask:0xf
    v_add_f32_dpp v108, v108, v108 row_mirror row_mask:0xf bank_mask:0xf
    v_add_f32_dpp v109, v109, v109 row_mirror row_mask:0xf bank_mask:0xf
    v_add_f32_dpp v110, v110, v110 row_mirror row_mask:0xf bank_mask:0xf
    v_add_f32_dpp v111, v111, v111 row_mirror row_mask:0xf bank_mask:0xf
    v_cmp_eq_u32 vcc, s56, v14
    v_cvt_pk_bf16_f32 v63, v96, v97
    v_lshlrev_b32 v96, 16, v63
    v_and_b32 v97, 0xffff0000, v63
    v_mul_f32 v96, v62, v96
    v_mul_f32 v97, v62, v97
    v_cvt_pk_bf16_f32 v63, v96, v97
    v_lshlrev_b32 v96, 16, v63
    v_and_b32 v97, 0xffff0000, v63
    v_cndmask_b32 v24, v24, v96, vcc
    v_cndmask_b32 v25, v25, v97, vcc
    v_cvt_pk_bf16_f32 v63, v98, v99
    v_lshlrev_b32 v98, 16, v63
    v_and_b32 v99, 0xffff0000, v63
    v_mul_f32 v98, v62, v98
    v_mul_f32 v99, v62, v99
    v_cvt_pk_bf16_f32 v63, v98, v99
    v_lshlrev_b32 v98, 16, v63
    v_and_b32 v99, 0xffff0000, v63
    v_cndmask_b32 v26, v26, v98, vcc
    v_cndmask_b32 v27, v27, v99, vcc
    v_cvt_pk_bf16_f32 v63, v100, v101
    v_lshlrev_b32 v100, 16, v63
    v_and_b32 v101, 0xffff0000, v63
    v_mul_f32 v100, v62, v100
    v_mul_f32 v101, v62, v101
    v_cvt_pk_bf16_f32 v63, v100, v101
    v_lshlrev_b32 v100, 16, v63
    v_and_b32 v101, 0xffff0000, v63
    v_cndmask_b32 v28, v28, v100, vcc
    v_cndmask_b32 v29, v29, v101, vcc
    v_cvt_pk_bf16_f32 v63, v102, v103
    v_lshlrev_b32 v102, 16, v63
    v_and_b32 v103, 0xffff0000, v63
    v_mul_f32 v102, v62, v102
    v_mul_f32 v103, v62, v103
    v_cvt_pk_bf16_f32 v63, v102, v103
    v_lshlrev_b32 v102, 16, v63
    v_and_b32 v103, 0xffff0000, v63
    v_cndmask_b32 v30, v30, v102, vcc
    v_cndmask_b32 v31, v31, v103, vcc
    v_cvt_pk_bf16_f32 v63, v104, v105
    v_lshlrev_b32 v104, 16, v63
    v_and_b32 v105, 0xffff0000, v63
    v_mul_f32 v104, v62, v104
    v_mul_f32 v105, v62, v105
    v_cvt_pk_bf16_f32 v63, v104, v105
    v_lshlrev_b32 v104, 16, v63
    v_and_b32 v105, 0xffff0000, v63
    v_cndmask_b32 v32, v32, v104, vcc
    v_cndmask_b32 v33, v33, v105, vcc
    v_cvt_pk_bf16_f32 v63, v106, v107
    v_lshlrev_b32 v106, 16, v63
    v_and_b32 v107, 0xffff0000, v63
    v_mul_f32 v106, v62, v106
    v_mul_f32 v107, v62, v107
    v_cvt_pk_bf16_f32 v63, v106, v107
    v_lshlrev_b32 v106, 16, v63
    v_and_b32 v107, 0xffff0000, v63
    v_cndmask_b32 v34, v34, v106, vcc
    v_cndmask_b32 v35, v35, v107, vcc
    v_cvt_pk_bf16_f32 v63, v108, v109
    v_lshlrev_b32 v108, 16, v63
    v_and_b32 v109, 0xffff0000, v63
    v_mul_f32 v108, v62, v108
    v_mul_f32 v109, v62, v109
    v_cvt_pk_bf16_f32 v63, v108, v109
    v_lshlrev_b32 v108, 16, v63
    v_and_b32 v109, 0xffff0000, v63
    v_cndmask_b32 v36, v36, v108, vcc
    v_cndmask_b32 v37, v37, v109, vcc
    v_cvt_pk_bf16_f32 v63, v110, v111
    v_lshlrev_b32 v110, 16, v63
    v_and_b32 v111, 0xffff0000, v63
    v_mul_f32 v110, v62, v110
    v_mul_f32 v111, v62, v111
    v_cvt_pk_bf16_f32 v63, v110, v111
    v_lshlrev_b32 v110, 16, v63
    v_and_b32 v111, 0xffff0000, v63
    v_cndmask_b32 v38, v38, v110, vcc
    v_cndmask_b32 v39, v39, v111, vcc
L_recurrent_scan__compressed_kv_cla__moe_arch_mod__prompt_kernel_rt2_noy_1:
    s_sub_u32 s36, s57, s38
    s_cmp_lt_u32 s36, 16
    s_cbranch_scc0 L_recurrent_scan__compressed_kv_cla__moe_arch_mod__prompt_kernel_rt2_noy_2
    s_and_b32 s36, s59, 0xffff0000
    s_cmp_lt_i32 s36, 0
    s_cselect_b32 s37, 0x80000000, -1
    s_xor_b32 s36, s36, s37
    s_and_b32 s36, s36, 0xffff0000
    v_mov_b32 v62, s36
    v_mul_f32 v62, 0xbfb8aa3b, v62
    v_exp_f32 v62, v62
    s_nop 0
    v_add_f32 v62, 1.0, v62
    v_rcp_f32 v62, v62
    s_nop 0
    v_cvt_pk_bf16_f32 v62, v62, v62
    v_lshlrev_b32 v62, 16, v62
    v_add_f32_dpp v112, v112, v112 quad_perm:[1,0,3,2] row_mask:0xf bank_mask:0xf
    v_add_f32_dpp v113, v113, v113 quad_perm:[1,0,3,2] row_mask:0xf bank_mask:0xf
    v_add_f32_dpp v114, v114, v114 quad_perm:[1,0,3,2] row_mask:0xf bank_mask:0xf
    v_add_f32_dpp v115, v115, v115 quad_perm:[1,0,3,2] row_mask:0xf bank_mask:0xf
    v_add_f32_dpp v116, v116, v116 quad_perm:[1,0,3,2] row_mask:0xf bank_mask:0xf
    v_add_f32_dpp v117, v117, v117 quad_perm:[1,0,3,2] row_mask:0xf bank_mask:0xf
    v_add_f32_dpp v118, v118, v118 quad_perm:[1,0,3,2] row_mask:0xf bank_mask:0xf
    v_add_f32_dpp v119, v119, v119 quad_perm:[1,0,3,2] row_mask:0xf bank_mask:0xf
    v_add_f32_dpp v120, v120, v120 quad_perm:[1,0,3,2] row_mask:0xf bank_mask:0xf
    v_add_f32_dpp v121, v121, v121 quad_perm:[1,0,3,2] row_mask:0xf bank_mask:0xf
    v_add_f32_dpp v122, v122, v122 quad_perm:[1,0,3,2] row_mask:0xf bank_mask:0xf
    v_add_f32_dpp v123, v123, v123 quad_perm:[1,0,3,2] row_mask:0xf bank_mask:0xf
    v_add_f32_dpp v124, v124, v124 quad_perm:[1,0,3,2] row_mask:0xf bank_mask:0xf
    v_add_f32_dpp v125, v125, v125 quad_perm:[1,0,3,2] row_mask:0xf bank_mask:0xf
    v_add_f32_dpp v126, v126, v126 quad_perm:[1,0,3,2] row_mask:0xf bank_mask:0xf
    v_add_f32_dpp v127, v127, v127 quad_perm:[1,0,3,2] row_mask:0xf bank_mask:0xf
    v_add_f32_dpp v112, v112, v112 quad_perm:[2,3,0,1] row_mask:0xf bank_mask:0xf
    v_add_f32_dpp v113, v113, v113 quad_perm:[2,3,0,1] row_mask:0xf bank_mask:0xf
    v_add_f32_dpp v114, v114, v114 quad_perm:[2,3,0,1] row_mask:0xf bank_mask:0xf
    v_add_f32_dpp v115, v115, v115 quad_perm:[2,3,0,1] row_mask:0xf bank_mask:0xf
    v_add_f32_dpp v116, v116, v116 quad_perm:[2,3,0,1] row_mask:0xf bank_mask:0xf
    v_add_f32_dpp v117, v117, v117 quad_perm:[2,3,0,1] row_mask:0xf bank_mask:0xf
    v_add_f32_dpp v118, v118, v118 quad_perm:[2,3,0,1] row_mask:0xf bank_mask:0xf
    v_add_f32_dpp v119, v119, v119 quad_perm:[2,3,0,1] row_mask:0xf bank_mask:0xf
    v_add_f32_dpp v120, v120, v120 quad_perm:[2,3,0,1] row_mask:0xf bank_mask:0xf
    v_add_f32_dpp v121, v121, v121 quad_perm:[2,3,0,1] row_mask:0xf bank_mask:0xf
    v_add_f32_dpp v122, v122, v122 quad_perm:[2,3,0,1] row_mask:0xf bank_mask:0xf
    v_add_f32_dpp v123, v123, v123 quad_perm:[2,3,0,1] row_mask:0xf bank_mask:0xf
    v_add_f32_dpp v124, v124, v124 quad_perm:[2,3,0,1] row_mask:0xf bank_mask:0xf
    v_add_f32_dpp v125, v125, v125 quad_perm:[2,3,0,1] row_mask:0xf bank_mask:0xf
    v_add_f32_dpp v126, v126, v126 quad_perm:[2,3,0,1] row_mask:0xf bank_mask:0xf
    v_add_f32_dpp v127, v127, v127 quad_perm:[2,3,0,1] row_mask:0xf bank_mask:0xf
    v_add_f32_dpp v112, v112, v112 row_half_mirror row_mask:0xf bank_mask:0xf
    v_add_f32_dpp v113, v113, v113 row_half_mirror row_mask:0xf bank_mask:0xf
    v_add_f32_dpp v114, v114, v114 row_half_mirror row_mask:0xf bank_mask:0xf
    v_add_f32_dpp v115, v115, v115 row_half_mirror row_mask:0xf bank_mask:0xf
    v_add_f32_dpp v116, v116, v116 row_half_mirror row_mask:0xf bank_mask:0xf
    v_add_f32_dpp v117, v117, v117 row_half_mirror row_mask:0xf bank_mask:0xf
    v_add_f32_dpp v118, v118, v118 row_half_mirror row_mask:0xf bank_mask:0xf
    v_add_f32_dpp v119, v119, v119 row_half_mirror row_mask:0xf bank_mask:0xf
    v_add_f32_dpp v120, v120, v120 row_half_mirror row_mask:0xf bank_mask:0xf
    v_add_f32_dpp v121, v121, v121 row_half_mirror row_mask:0xf bank_mask:0xf
    v_add_f32_dpp v122, v122, v122 row_half_mirror row_mask:0xf bank_mask:0xf
    v_add_f32_dpp v123, v123, v123 row_half_mirror row_mask:0xf bank_mask:0xf
    v_add_f32_dpp v124, v124, v124 row_half_mirror row_mask:0xf bank_mask:0xf
    v_add_f32_dpp v125, v125, v125 row_half_mirror row_mask:0xf bank_mask:0xf
    v_add_f32_dpp v126, v126, v126 row_half_mirror row_mask:0xf bank_mask:0xf
    v_add_f32_dpp v127, v127, v127 row_half_mirror row_mask:0xf bank_mask:0xf
    v_add_f32_dpp v112, v112, v112 row_mirror row_mask:0xf bank_mask:0xf
    v_add_f32_dpp v113, v113, v113 row_mirror row_mask:0xf bank_mask:0xf
    v_add_f32_dpp v114, v114, v114 row_mirror row_mask:0xf bank_mask:0xf
    v_add_f32_dpp v115, v115, v115 row_mirror row_mask:0xf bank_mask:0xf
    v_add_f32_dpp v116, v116, v116 row_mirror row_mask:0xf bank_mask:0xf
    v_add_f32_dpp v117, v117, v117 row_mirror row_mask:0xf bank_mask:0xf
    v_add_f32_dpp v118, v118, v118 row_mirror row_mask:0xf bank_mask:0xf
    v_add_f32_dpp v119, v119, v119 row_mirror row_mask:0xf bank_mask:0xf
    v_add_f32_dpp v120, v120, v120 row_mirror row_mask:0xf bank_mask:0xf
    v_add_f32_dpp v121, v121, v121 row_mirror row_mask:0xf bank_mask:0xf
    v_add_f32_dpp v122, v122, v122 row_mirror row_mask:0xf bank_mask:0xf
    v_add_f32_dpp v123, v123, v123 row_mirror row_mask:0xf bank_mask:0xf
    v_add_f32_dpp v124, v124, v124 row_mirror row_mask:0xf bank_mask:0xf
    v_add_f32_dpp v125, v125, v125 row_mirror row_mask:0xf bank_mask:0xf
    v_add_f32_dpp v126, v126, v126 row_mirror row_mask:0xf bank_mask:0xf
    v_add_f32_dpp v127, v127, v127 row_mirror row_mask:0xf bank_mask:0xf
    v_cmp_eq_u32 vcc, s57, v14
    v_cvt_pk_bf16_f32 v63, v112, v113
    v_lshlrev_b32 v112, 16, v63
    v_and_b32 v113, 0xffff0000, v63
    v_mul_f32 v112, v62, v112
    v_mul_f32 v113, v62, v113
    v_cvt_pk_bf16_f32 v63, v112, v113
    v_lshlrev_b32 v112, 16, v63
    v_and_b32 v113, 0xffff0000, v63
    v_cndmask_b32 v24, v24, v112, vcc
    v_cndmask_b32 v25, v25, v113, vcc
    v_cvt_pk_bf16_f32 v63, v114, v115
    v_lshlrev_b32 v114, 16, v63
    v_and_b32 v115, 0xffff0000, v63
    v_mul_f32 v114, v62, v114
    v_mul_f32 v115, v62, v115
    v_cvt_pk_bf16_f32 v63, v114, v115
    v_lshlrev_b32 v114, 16, v63
    v_and_b32 v115, 0xffff0000, v63
    v_cndmask_b32 v26, v26, v114, vcc
    v_cndmask_b32 v27, v27, v115, vcc
    v_cvt_pk_bf16_f32 v63, v116, v117
    v_lshlrev_b32 v116, 16, v63
    v_and_b32 v117, 0xffff0000, v63
    v_mul_f32 v116, v62, v116
    v_mul_f32 v117, v62, v117
    v_cvt_pk_bf16_f32 v63, v116, v117
    v_lshlrev_b32 v116, 16, v63
    v_and_b32 v117, 0xffff0000, v63
    v_cndmask_b32 v28, v28, v116, vcc
    v_cndmask_b32 v29, v29, v117, vcc
    v_cvt_pk_bf16_f32 v63, v118, v119
    v_lshlrev_b32 v118, 16, v63
    v_and_b32 v119, 0xffff0000, v63
    v_mul_f32 v118, v62, v118
    v_mul_f32 v119, v62, v119
    v_cvt_pk_bf16_f32 v63, v118, v119
    v_lshlrev_b32 v118, 16, v63
    v_and_b32 v119, 0xffff0000, v63
    v_cndmask_b32 v30, v30, v118, vcc
    v_cndmask_b32 v31, v31, v119, vcc
    v_cvt_pk_bf16_f32 v63, v120, v121
    v_lshlrev_b32 v120, 16, v63
    v_and_b32 v121, 0xffff0000, v63
    v_mul_f32 v120, v62, v120
    v_mul_f32 v121, v62, v121
    v_cvt_pk_bf16_f32 v63, v120, v121
    v_lshlrev_b32 v120, 16, v63
    v_and_b32 v121, 0xffff0000, v63
    v_cndmask_b32 v32, v32, v120, vcc
    v_cndmask_b32 v33, v33, v121, vcc
    v_cvt_pk_bf16_f32 v63, v122, v123
    v_lshlrev_b32 v122, 16, v63
    v_and_b32 v123, 0xffff0000, v63
    v_mul_f32 v122, v62, v122
    v_mul_f32 v123, v62, v123
    v_cvt_pk_bf16_f32 v63, v122, v123
    v_lshlrev_b32 v122, 16, v63
    v_and_b32 v123, 0xffff0000, v63
    v_cndmask_b32 v34, v34, v122, vcc
    v_cndmask_b32 v35, v35, v123, vcc
    v_cvt_pk_bf16_f32 v63, v124, v125
    v_lshlrev_b32 v124, 16, v63
    v_and_b32 v125, 0xffff0000, v63
    v_mul_f32 v124, v62, v124
    v_mul_f32 v125, v62, v125
    v_cvt_pk_bf16_f32 v63, v124, v125
    v_lshlrev_b32 v124, 16, v63
    v_and_b32 v125, 0xffff0000, v63
    v_cndmask_b32 v36, v36, v124, vcc
    v_cndmask_b32 v37, v37, v125, vcc
    v_cvt_pk_bf16_f32 v63, v126, v127
    v_lshlrev_b32 v126, 16, v63
    v_and_b32 v127, 0xffff0000, v63
    v_mul_f32 v126, v62, v126
    v_mul_f32 v127, v62, v127
    v_cvt_pk_bf16_f32 v63, v126, v127
    v_lshlrev_b32 v126, 16, v63
    v_and_b32 v127, 0xffff0000, v63
    v_cndmask_b32 v38, v38, v126, vcc
    v_cndmask_b32 v39, v39, v127, vcc
L_recurrent_scan__compressed_kv_cla__moe_arch_mod__prompt_kernel_rt2_noy_2:
    s_branch L_recurrent_scan__compressed_kv_cla__moe_arch_mod__prompt_kernel_back_169
L_recurrent_scan__compressed_kv_cla__moe_arch_mod__prompt_kernel_rare_170:
    v_lshlrev_b32 v96, 16, v40
    v_and_b32 v97, 0xffff0000, v40
    v_sub_f32 v112, v96, v48
    v_sub_f32 v113, v97, v48
    v_cvt_pk_bf16_f32 v10, v112, v113
    v_lshlrev_b32 v112, 16, v10
    v_and_b32 v113, 0xffff0000, v10
    v_mul_f32 v112, v112, v49
    v_mul_f32 v113, v113, v49
    v_cvt_pk_bf16_f32 v10, v112, v113
    v_lshlrev_b32 v112, 16, v10
    v_and_b32 v113, 0xffff0000, v10
    v_add_f32 v112, v112, v24
    v_add_f32 v113, v113, v25
    v_cvt_pk_bf16_f32 v10, v112, v113
    v_lshlrev_b32 v112, 16, v10
    v_and_b32 v113, 0xffff0000, v10
    v_mul_f32 v11, 0xbfb8aa3b, v112
    v_mul_f32 v12, 0xbfb8aa3b, v113
    v_exp_f32 v11, v11
    v_exp_f32 v12, v12
    s_nop 0
    v_add_f32 v11, 1.0, v11
    v_add_f32 v12, 1.0, v12
    v_rcp_f32 v11, v11
    v_rcp_f32 v12, v12
    s_nop 0
    v_mul_f32 v112, v112, v11
    v_mul_f32 v113, v113, v12
    v_cvt_pk_bf16_f32 v10, v112, v113
    v_lshlrev_b32 v112, 16, v10
    v_and_b32 v113, 0xffff0000, v10
    v_lshlrev_b32 v98, 16, v41
    v_and_b32 v99, 0xffff0000, v41
    v_sub_f32 v114, v98, v48
    v_sub_f32 v115, v99, v48
    v_cvt_pk_bf16_f32 v10, v114, v115
    v_lshlrev_b32 v114, 16, v10
    v_and_b32 v115, 0xffff0000, v10
    v_mul_f32 v114, v114, v49
    v_mul_f32 v115, v115, v49
    v_cvt_pk_bf16_f32 v10, v114, v115
    v_lshlrev_b32 v114, 16, v10
    v_and_b32 v115, 0xffff0000, v10
    v_add_f32 v114, v114, v26
    v_add_f32 v115, v115, v27
    v_cvt_pk_bf16_f32 v10, v114, v115
    v_lshlrev_b32 v114, 16, v10
    v_and_b32 v115, 0xffff0000, v10
    v_mul_f32 v11, 0xbfb8aa3b, v114
    v_mul_f32 v12, 0xbfb8aa3b, v115
    v_exp_f32 v11, v11
    v_exp_f32 v12, v12
    s_nop 0
    v_add_f32 v11, 1.0, v11
    v_add_f32 v12, 1.0, v12
    v_rcp_f32 v11, v11
    v_rcp_f32 v12, v12
    s_nop 0
    v_mul_f32 v114, v114, v11
    v_mul_f32 v115, v115, v12
    v_cvt_pk_bf16_f32 v10, v114, v115
    v_lshlrev_b32 v114, 16, v10
    v_and_b32 v115, 0xffff0000, v10
    v_lshlrev_b32 v100, 16, v42
    v_and_b32 v101, 0xffff0000, v42
    v_sub_f32 v116, v100, v48
    v_sub_f32 v117, v101, v48
    v_cvt_pk_bf16_f32 v10, v116, v117
    v_lshlrev_b32 v116, 16, v10
    v_and_b32 v117, 0xffff0000, v10
    v_mul_f32 v116, v116, v49
    v_mul_f32 v117, v117, v49
    v_cvt_pk_bf16_f32 v10, v116, v117
    v_lshlrev_b32 v116, 16, v10
    v_and_b32 v117, 0xffff0000, v10
    v_add_f32 v116, v116, v28
    v_add_f32 v117, v117, v29
    v_cvt_pk_bf16_f32 v10, v116, v117
    v_lshlrev_b32 v116, 16, v10
    v_and_b32 v117, 0xffff0000, v10
    v_mul_f32 v11, 0xbfb8aa3b, v116
    v_mul_f32 v12, 0xbfb8aa3b, v117
    v_exp_f32 v11, v11
    v_exp_f32 v12, v12
    s_nop 0
    v_add_f32 v11, 1.0, v11
    v_add_f32 v12, 1.0, v12
    v_rcp_f32 v11, v11
    v_rcp_f32 v12, v12
    s_nop 0
    v_mul_f32 v116, v116, v11
    v_mul_f32 v117, v117, v12
    v_cvt_pk_bf16_f32 v10, v116, v117
    v_lshlrev_b32 v116, 16, v10
    v_and_b32 v117, 0xffff0000, v10
    v_lshlrev_b32 v102, 16, v43
    v_and_b32 v103, 0xffff0000, v43
    v_sub_f32 v118, v102, v48
    v_sub_f32 v119, v103, v48
    v_cvt_pk_bf16_f32 v10, v118, v119
    v_lshlrev_b32 v118, 16, v10
    v_and_b32 v119, 0xffff0000, v10
    v_mul_f32 v118, v118, v49
    v_mul_f32 v119, v119, v49
    v_cvt_pk_bf16_f32 v10, v118, v119
    v_lshlrev_b32 v118, 16, v10
    v_and_b32 v119, 0xffff0000, v10
    v_add_f32 v118, v118, v30
    v_add_f32 v119, v119, v31
    v_cvt_pk_bf16_f32 v10, v118, v119
    v_lshlrev_b32 v118, 16, v10
    v_and_b32 v119, 0xffff0000, v10
    v_mul_f32 v11, 0xbfb8aa3b, v118
    v_mul_f32 v12, 0xbfb8aa3b, v119
    v_exp_f32 v11, v11
    v_exp_f32 v12, v12
    s_nop 0
    v_add_f32 v11, 1.0, v11
    v_add_f32 v12, 1.0, v12
    v_rcp_f32 v11, v11
    v_rcp_f32 v12, v12
    s_nop 0
    v_mul_f32 v118, v118, v11
    v_mul_f32 v119, v119, v12
    v_cvt_pk_bf16_f32 v10, v118, v119
    v_lshlrev_b32 v118, 16, v10
    v_and_b32 v119, 0xffff0000, v10
    v_lshlrev_b32 v104, 16, v44
    v_and_b32 v105, 0xffff0000, v44
    v_sub_f32 v120, v104, v48
    v_sub_f32 v121, v105, v48
    v_cvt_pk_bf16_f32 v10, v120, v121
    v_lshlrev_b32 v120, 16, v10
    v_and_b32 v121, 0xffff0000, v10
    v_mul_f32 v120, v120, v49
    v_mul_f32 v121, v121, v49
    v_cvt_pk_bf16_f32 v10, v120, v121
    v_lshlrev_b32 v120, 16, v10
    v_and_b32 v121, 0xffff0000, v10
    v_add_f32 v120, v120, v32
    v_add_f32 v121, v121, v33
    v_cvt_pk_bf16_f32 v10, v120, v121
    v_lshlrev_b32 v120, 16, v10
    v_and_b32 v121, 0xffff0000, v10
    v_mul_f32 v11, 0xbfb8aa3b, v120
    v_mul_f32 v12, 0xbfb8aa3b, v121
    v_exp_f32 v11, v11
    v_exp_f32 v12, v12
    s_nop 0
    v_add_f32 v11, 1.0, v11
    v_add_f32 v12, 1.0, v12
    v_rcp_f32 v11, v11
    v_rcp_f32 v12, v12
    s_nop 0
    v_mul_f32 v120, v120, v11
    v_mul_f32 v121, v121, v12
    v_cvt_pk_bf16_f32 v10, v120, v121
    v_lshlrev_b32 v120, 16, v10
    v_and_b32 v121, 0xffff0000, v10
    v_lshlrev_b32 v106, 16, v45
    v_and_b32 v107, 0xffff0000, v45
    v_sub_f32 v122, v106, v48
    v_sub_f32 v123, v107, v48
    v_cvt_pk_bf16_f32 v10, v122, v123
    v_lshlrev_b32 v122, 16, v10
    v_and_b32 v123, 0xffff0000, v10
    v_mul_f32 v122, v122, v49
    v_mul_f32 v123, v123, v49
    v_cvt_pk_bf16_f32 v10, v122, v123
    v_lshlrev_b32 v122, 16, v10
    v_and_b32 v123, 0xffff0000, v10
    v_add_f32 v122, v122, v34
    v_add_f32 v123, v123, v35
    v_cvt_pk_bf16_f32 v10, v122, v123
    v_lshlrev_b32 v122, 16, v10
    v_and_b32 v123, 0xffff0000, v10
    v_mul_f32 v11, 0xbfb8aa3b, v122
    v_mul_f32 v12, 0xbfb8aa3b, v123
    v_exp_f32 v11, v11
    v_exp_f32 v12, v12
    s_nop 0
    v_add_f32 v11, 1.0, v11
    v_add_f32 v12, 1.0, v12
    v_rcp_f32 v11, v11
    v_rcp_f32 v12, v12
    s_nop 0
    v_mul_f32 v122, v122, v11
    v_mul_f32 v123, v123, v12
    v_cvt_pk_bf16_f32 v10, v122, v123
    v_lshlrev_b32 v122, 16, v10
    v_and_b32 v123, 0xffff0000, v10
    v_lshlrev_b32 v108, 16, v46
    v_and_b32 v109, 0xffff0000, v46
    v_sub_f32 v124, v108, v48
    v_sub_f32 v125, v109, v48
    v_cvt_pk_bf16_f32 v10, v124, v125
    v_lshlrev_b32 v124, 16, v10
    v_and_b32 v125, 0xffff0000, v10
    v_mul_f32 v124, v124, v49
    v_mul_f32 v125, v125, v49
    v_cvt_pk_bf16_f32 v10, v124, v125
    v_lshlrev_b32 v124, 16, v10
    v_and_b32 v125, 0xffff0000, v10
    v_add_f32 v124, v124, v36
    v_add_f32 v125, v125, v37
    v_cvt_pk_bf16_f32 v10, v124, v125
    v_lshlrev_b32 v124, 16, v10
    v_and_b32 v125, 0xffff0000, v10
    v_mul_f32 v11, 0xbfb8aa3b, v124
    v_mul_f32 v12, 0xbfb8aa3b, v125
    v_exp_f32 v11, v11
    v_exp_f32 v12, v12
    s_nop 0
    v_add_f32 v11, 1.0, v11
    v_add_f32 v12, 1.0, v12
    v_rcp_f32 v11, v11
    v_rcp_f32 v12, v12
    s_nop 0
    v_mul_f32 v124, v124, v11
    v_mul_f32 v125, v125, v12
    v_cvt_pk_bf16_f32 v10, v124, v125
    v_lshlrev_b32 v124, 16, v10
    v_and_b32 v125, 0xffff0000, v10
    v_lshlrev_b32 v110, 16, v47
    v_and_b32 v111, 0xffff0000, v47
    v_sub_f32 v126, v110, v48
    v_sub_f32 v127, v111, v48
    v_cvt_pk_bf16_f32 v10, v126, v127
    v_lshlrev_b32 v126, 16, v10
    v_and_b32 v127, 0xffff0000, v10
    v_mul_f32 v126, v126, v49
    v_mul_f32 v127, v127, v49
    v_cvt_pk_bf16_f32 v10, v126, v127
    v_lshlrev_b32 v126, 16, v10
    v_and_b32 v127, 0xffff0000, v10
    v_add_f32 v126, v126, v38
    v_add_f32 v127, v127, v39
    v_cvt_pk_bf16_f32 v10, v126, v127
    v_lshlrev_b32 v126, 16, v10
    v_and_b32 v127, 0xffff0000, v10
    v_mul_f32 v11, 0xbfb8aa3b, v126
    v_mul_f32 v12, 0xbfb8aa3b, v127
    v_exp_f32 v11, v11
    v_exp_f32 v12, v12
    s_nop 0
    v_add_f32 v11, 1.0, v11
    v_add_f32 v12, 1.0, v12
    v_rcp_f32 v11, v11
    v_rcp_f32 v12, v12
    s_nop 0
    v_mul_f32 v126, v126, v11
    v_mul_f32 v127, v127, v12
    v_cvt_pk_bf16_f32 v10, v126, v127
    v_lshlrev_b32 v126, 16, v10
    v_and_b32 v127, 0xffff0000, v10
    s_branch L_recurrent_scan__compressed_kv_cla__moe_arch_mod__prompt_kernel_back_171
L_recurrent_scan__compressed_kv_cla__moe_arch_mod__prompt_kernel_rare_174:
    s_mov_b32 s61, 0x40000
L_recurrent_scan__compressed_kv_cla__moe_arch_mod__prompt_kernel_spin_172:
    s_sub_u32 s61, s61, 1
    s_cbranch_scc1 L_recurrent_scan__compressed_kv_cla__moe_arch_mod__prompt_kernel_spinx_173
    s_sleep 1
    global_load_dword v23, v5, s[90:91] sc1
    s_waitcnt vmcnt(0)
    v_readfirstlane_b32 s36, v23
    s_nop 0
    s_cmp_lt_u32 s36, 8
    s_cbranch_scc1 L_recurrent_scan__compressed_kv_cla__moe_arch_mod__prompt_kernel_spin_172
L_recurrent_scan__compressed_kv_cla__moe_arch_mod__prompt_kernel_spinx_173:
    s_branch L_recurrent_scan__compressed_kv_cla__moe_arch_mod__prompt_kernel_back_175
L_end:
    s_endpgm
.section .rodata,"a"
.p2align 6
.amdhsa_kernel recurrent_scan__compressed_kv_cla__moe_arch_mod__prompt_kernel
  .amdhsa_next_free_vgpr 256
  .amdhsa_next_free_sgpr 102
  .amdhsa_accum_offset 256
  .amdhsa_group_segment_fixed_size 0
  .amdhsa_kernarg_size 112
  .amdhsa_user_sgpr_count 2
  .amdhsa_user_sgpr_kernarg_segment_ptr 1
  .amdhsa_system_sgpr_workgroup_id_x 1
.end_amdhsa_kernel
```

```asm
; @launch kernel=recurrent_scan__compressed_kv_cla__moe_arch_mod__prompt_kernel grid=(256,1,1) block=(512,1,1) lds=163840
.amdgcn_target "amdgcn-amd-amdhsa--gfx950"
.text
.globl recurrent_scan__compressed_kv_cla__moe_arch_mod__prompt_kernel
.p2align 8
.type recurrent_scan__compressed_kv_cla__moe_arch_mod__prompt_kernel,@function
recurrent_scan__compressed_kv_cla__moe_arch_mod__prompt_kernel:
    s_cmp_ge_u32 s2, 256
    s_cbranch_scc1 L_end
    s_load_dwordx4 s[44:47], s[0:1], 0
    s_load_dwordx2 s[52:53], s[0:1], 56
    s_load_dwordx4 s[48:51], s[0:1], 24
    s_getpc_b64 s[36:37]
L_pc:
    s_lshr_b32 s38, s2, 3
    s_lshl_b32 s38, s38, 7
    v_lshl_add_u32 v16, v0, 12, s38
    v_cmp_gt_u32 vcc, L_end-L_pc-4, v16
    v_mov_b32 v17, s37
    s_and_b64 exec, exec, vcc
    s_cbranch_execz L_nocpf
    v_add_co_u32 v16, vcc, s36, v16
    s_nop 1
    v_addc_co_u32 v17, vcc, 0, v17, vcc
    global_load_dword v119, v[16:17], off
L_nocpf:
    s_mov_b64 exec, -1
    v_lshrrev_b32 v16, 6, v0
    v_and_b32 v1, 63, v0
    v_readfirstlane_b32 s28, v16
    v_lshlrev_b32 v116, 4, v1
    s_lshl_b32 s42, s2, 3
    s_cmp_lt_u32 s28, 4
    s_cbranch_scc1 L_nox
    s_add_u32 s43, s42, s28
    s_sub_u32 s42, s43, 4
    v_lshl_add_u32 v18, s42, 11, v116
    v_add_u32 v19, 8192, v18
    s_waitcnt lgkmcnt(0)
    global_load_dwordx4 v[20:23], v18, s[44:45]
    global_load_dwordx4 v[24:27], v18, s[44:45] offset:1024
    global_load_dwordx4 v[28:31], v19, s[44:45]
    global_load_dwordx4 v[32:35], v19, s[44:45] offset:1024
    global_load_dwordx4 v[36:39], v116, s[52:53]
    global_load_dwordx4 v[40:43], v116, s[52:53] offset:1024
    s_barrier
L_nox:
    s_load_dwordx4 s[88:91], s[0:1], 96
    s_load_dwordx4 s[92:95], s[0:1], 64
    s_load_dwordx2 s[96:97], s[0:1], 16
    s_and_b32 s29, s2, 7
    s_lshl_b32 s29, s29, 2
    s_lshr_b32 s29, 0x75643120, s29
    s_and_b32 s29, s29, 7
    s_lshl_b32 s29, s29, 2
    s_bfe_u32 s36, s2, 0x20003
    s_add_u32 s29, s29, s36
    s_lshr_b32 s30, s2, 5
    v_lshrrev_b32 v16, 3, v1
    s_lshl_b32 s36, s30, 8
    s_lshl_b32 s37, s28, 5
    s_add_u32 s36, s36, s37
    v_add_u32 v16, s36, v16
    v_lshlrev_b32 v16, 10, v16
    v_lshrrev_b32 v18, 4, v1
    v_and_b32 v19, 7, v1
    v_xor_b32 v19, v19, v18
    v_lshl_add_u32 v2, v19, 4, v16
    v_xor_b32 v19, 4, v19
    v_lshl_add_u32 v3, v19, 4, v16
    v_add_u32 v3, 7168, v3
    v_add_u32 v4, 14336, v2
    v_add_u32 v5, 14336, v3
    s_and_b32 s36, s28, 3
    s_lshl_b32 s37, s36, 4
    v_add_u32 v16, s37, v18
    v_lshlrev_b32 v16, 13, v16
    s_lshl_b32 s37, s29, 8
    v_add_u32 v16, s37, v16
    v_and_b32 v19, 15, v1
    v_lshlrev_b32 v18, 1, v18
    v_xor_b32 v19, v19, v18
    v_lshl_add_u32 v6, v19, 4, v16
    v_add_u32 v7, 31744, v6
    v_xor_b32 v19, 8, v19
    v_lshl_add_u32 v8, v19, 4, v16
    v_add_u32 v8, 63488, v8
    v_add_u32 v9, 31744, v8
    s_lshl_b32 s33, s28, 12
    s_add_u32 s34, s33, 65536
    s_mov_b32 s31, 0
    s_mov_b32 s32, 0
    s_mov_b32 s40, 128
    s_mov_b32 s41, 524288
    s_waitcnt lgkmcnt(0)
    s_mov_b32 s4, s46
    s_and_b32 s5, s47, 0xffff
    s_mov_b32 s6, 2097152
    s_mov_b32 s7, 0x20000
    s_mov_b32 s8, s48
    s_and_b32 s9, s49, 0xffff
    s_mov_b32 s10, 4194304
    s_mov_b32 s11, 0x20000
    s_mov_b32 s20, s50
    s_and_b32 s21, s51, 0xffff
    s_mov_b32 s22, 4194304
    s_mov_b32 s23, 0x20000
    s_cmp_lt_u32 s28, 4
    s_cbranch_scc0 L_pro_s
    s_barrier
    s_cmp_eq_u32 s2, 0
    s_cbranch_scc1 L_recurrent_scan__compressed_kv_cla__moe_arch_mod__prompt_kernel_rare_1
L_recurrent_scan__compressed_kv_cla__moe_arch_mod__prompt_kernel_back_2:
    s_add_u32 m0, s33, 0
    s_add_u32 s36, s31, 131072
    buffer_load_dwordx4 v2, s[4:7], s31 offen offset:0 lds
    buffer_load_dwordx4 v3, s[4:7], s31 offen offset:1024 lds
    buffer_load_dwordx4 v4, s[4:7], s31 offen offset:2048 lds
    buffer_load_dwordx4 v5, s[4:7], s31 offen offset:3072 lds
    s_add_u32 m0, s34, 0
    s_nop 0
    buffer_load_dwordx4 v6, s[8:11], s32 offen offset:0 nt lds
    buffer_load_dwordx4 v7, s[8:11], s32 offen offset:1024 nt lds
    buffer_load_dwordx4 v8, s[8:11], s32 offen offset:2048 nt lds
    buffer_load_dwordx4 v9, s[8:11], s32 offen offset:3072 nt lds
    s_add_u32 m0, s33, 16384
    s_nop 0
    buffer_load_dwordx4 v2, s[4:7], s36 offen offset:0 lds
    buffer_load_dwordx4 v3, s[4:7], s36 offen offset:1024 lds
    buffer_load_dwordx4 v4, s[4:7], s36 offen offset:2048 lds
    buffer_load_dwordx4 v5, s[4:7], s36 offen offset:3072 lds
    s_add_u32 m0, s34, 16384
    s_nop 0
    buffer_load_dwordx4 v6, s[20:23], s32 offen offset:0 nt lds
    buffer_load_dwordx4 v7, s[20:23], s32 offen offset:1024 nt lds
    buffer_load_dwordx4 v8, s[20:23], s32 offen offset:2048 nt lds
    buffer_load_dwordx4 v9, s[20:23], s32 offen offset:3072 nt lds
    s_add_u32 s31, s31, s40
    s_add_u32 s32, s32, s41
L_pro_s:
    s_add_u32 s54, s90, 0
    s_addc_u32 s55, s91, 0
    s_add_u32 s12, s54, 8388608
    s_addc_u32 s13, s55, 0
    s_and_b32 s13, s13, 0xffff
    s_mov_b32 s14, 134217856
    s_mov_b32 s15, 0x20000
    s_mov_b32 s24, s54
    s_and_b32 s25, s55, 0xffff
    s_mov_b32 s26, 184549504
    s_mov_b32 s27, 0x20000
    s_add_u32 s90, s54, 61865984
    s_addc_u32 s91, s55, 0
    v_and_b32 v16, 15, v1
    v_lshrrev_b32 v17, 4, v1
    s_bfe_u32 s36, s28, 0x10001
    s_lshl_b32 s36, s36, 14
    v_lshl_add_u32 v18, v16, 7, s36
    v_lshrrev_b32 v19, 1, v16
    v_xor_b32 v19, v19, v17
    v_lshl_add_u32 v10, v19, 4, v18
    v_xor_b32 v19, 4, v19
    v_lshl_add_u32 v11, v19, 4, v18
    v_lshrrev_b32 v16, 2, v16
    v_lshl_add_u32 v18, v17, 3, v16
    v_lshlrev_b32 v18, 8, v18
    s_lshr_b32 s36, s28, 2
    s_lshl_b32 s36, s36, 14
    s_add_u32 s36, s36, 65536
    v_add_u32 v18, s36, v18
    v_and_b32 v19, 3, v1
    v_lshl_add_u32 v18, v19, 3, v18
    v_and_b32 v17, 1, v17
    v_lshl_add_u32 v16, v17, 2, v16
    s_and_b32 s36, s28, 1
    s_lshl_b32 s36, s36, 2
    s_add_u32 s37, s36, 0
    v_xor_b32 v19, s37, v16
    v_lshl_add_u32 v12, v19, 5, v18
    s_add_u32 s37, s36, 1
    v_xor_b32 v19, s37, v16
    v_lshl_add_u32 v13, v19, 5, v18
    s_add_u32 s37, s36, 2
    v_xor_b32 v19, s37, v16
    v_lshl_add_u32 v14, v19, 5, v18
    s_add_u32 s37, s36, 3
    v_xor_b32 v19, s37, v16
    v_lshl_add_u32 v15, v19, 5, v18
    v_mov_b64 v[128:129], 0
    v_mov_b64 v[130:131], 0
    v_mov_b64 v[132:133], 0
    v_mov_b64 v[134:135], 0
    v_mov_b64 v[136:137], 0
    v_mov_b64 v[138:139], 0
    v_mov_b64 v[140:141], 0
    v_mov_b64 v[142:143], 0
    v_mov_b64 v[144:145], 0
    v_mov_b64 v[146:147], 0
    v_mov_b64 v[148:149], 0
    v_mov_b64 v[150:151], 0
    v_mov_b64 v[152:153], 0
    v_mov_b64 v[154:155], 0
    v_mov_b64 v[156:157], 0
    v_mov_b64 v[158:159], 0
    v_mov_b64 v[160:161], 0
    v_mov_b64 v[162:163], 0
    v_mov_b64 v[164:165], 0
    v_mov_b64 v[166:167], 0
    v_mov_b64 v[168:169], 0
    v_mov_b64 v[170:171], 0
    v_mov_b64 v[172:173], 0
    v_mov_b64 v[174:175], 0
    v_mov_b64 v[176:177], 0
    v_mov_b64 v[178:179], 0
    v_mov_b64 v[180:181], 0
    v_mov_b64 v[182:183], 0
    v_mov_b64 v[184:185], 0
    v_mov_b64 v[186:187], 0
    v_mov_b64 v[188:189], 0
    v_mov_b64 v[190:191], 0
    v_mov_b64 v[192:193], 0
    v_mov_b64 v[194:195], 0
    v_mov_b64 v[196:197], 0
    v_mov_b64 v[198:199], 0
    v_mov_b64 v[200:201], 0
    v_mov_b64 v[202:203], 0
    v_mov_b64 v[204:205], 0
    v_mov_b64 v[206:207], 0
    v_mov_b64 v[208:209], 0
    v_mov_b64 v[210:211], 0
    v_mov_b64 v[212:213], 0
    v_mov_b64 v[214:215], 0
    v_mov_b64 v[216:217], 0
    v_mov_b64 v[218:219], 0
    v_mov_b64 v[220:221], 0
    v_mov_b64 v[222:223], 0
    v_mov_b64 v[224:225], 0
    v_mov_b64 v[226:227], 0
    v_mov_b64 v[228:229], 0
    v_mov_b64 v[230:231], 0
    v_mov_b64 v[232:233], 0
    v_mov_b64 v[234:235], 0
    v_mov_b64 v[236:237], 0
    v_mov_b64 v[238:239], 0
    v_mov_b64 v[240:241], 0
    v_mov_b64 v[242:243], 0
    v_mov_b64 v[244:245], 0
    v_mov_b64 v[246:247], 0
    v_mov_b64 v[248:249], 0
    v_mov_b64 v[250:251], 0
    v_mov_b64 v[252:253], 0
    v_mov_b64 v[254:255], 0
    v_mov_b32 v118, 0
    v_mov_b32 v117, 0
    s_lshr_b32 s36, s2, 3
    s_lshl_b32 s36, s36, 5
    s_lshl_b32 s37, s28, 2
    s_add_u32 s36, s36, s37
    v_bfe_u32 v17, v1, 3, 2
    v_add_u32 v17, s36, v17
    v_lshlrev_b32 v17, 13, v17
    v_and_b32 v19, 7, v1
    v_lshl_add_u32 v17, v19, 7, v17
    s_and_b32 s36, s29, 28
    s_lshl_b32 s36, s36, 8
    v_add_u32 v17, s36, v17
    s_mov_b32 s45, 8192
    s_cmp_lt_u32 s28, 4
    s_cbranch_scc0 L_pro_b
    s_add_u32 m0, s33, 32768
    s_add_u32 s36, s31, 131072
    buffer_load_dwordx4 v2, s[4:7], s31 offen offset:0 lds
    buffer_load_dwordx4 v3, s[4:7], s31 offen offset:1024 lds
    buffer_load_dwordx4 v4, s[4:7], s31 offen offset:2048 lds
    buffer_load_dwordx4 v5, s[4:7], s31 offen offset:3072 lds
    s_add_u32 m0, s34, 32768
    s_nop 0
    buffer_load_dwordx4 v6, s[8:11], s32 offen offset:0 nt lds
    buffer_load_dwordx4 v7, s[8:11], s32 offen offset:1024 nt lds
    buffer_load_dwordx4 v8, s[8:11], s32 offen offset:2048 nt lds
    buffer_load_dwordx4 v9, s[8:11], s32 offen offset:3072 nt lds
    s_add_u32 m0, s33, 49152
    s_nop 0
    buffer_load_dwordx4 v2, s[4:7], s36 offen offset:0 lds
    buffer_load_dwordx4 v3, s[4:7], s36 offen offset:1024 lds
    buffer_load_dwordx4 v4, s[4:7], s36 offen offset:2048 lds
    buffer_load_dwordx4 v5, s[4:7], s36 offen offset:3072 lds
    s_add_u32 m0, s34, 49152
    s_nop 0
    buffer_load_dwordx4 v6, s[20:23], s32 offen offset:0 nt lds
    buffer_load_dwordx4 v7, s[20:23], s32 offen offset:1024 nt lds
    buffer_load_dwordx4 v8, s[20:23], s32 offen offset:2048 nt lds
    buffer_load_dwordx4 v9, s[20:23], s32 offen offset:3072 nt lds
    s_add_u32 s31, s31, s40
    s_add_u32 s32, s32, s41
    s_waitcnt vmcnt(16)
    s_branch L_pro_j
L_pro_b:
    s_mov_b64 s[8:9], s[20:21]
    s_mov_b32 s31, 256
    s_mov_b32 s32, 1048576
    s_and_b32 s60, s28, 3
    s_waitcnt vmcnt(0)
    s_mov_b32 s3, 0
L_ln:
    v_lshlrev_b32 v44, 16, v36
    v_and_b32 v45, 0xffff0000, v36
    v_lshlrev_b32 v46, 16, v37
    v_and_b32 v47, 0xffff0000, v37
    v_lshlrev_b32 v48, 16, v38
    v_and_b32 v49, 0xffff0000, v38
    v_lshlrev_b32 v50, 16, v39
    v_and_b32 v51, 0xffff0000, v39
    v_lshlrev_b32 v52, 16, v40
    v_and_b32 v53, 0xffff0000, v40
    v_lshlrev_b32 v54, 16, v41
    v_and_b32 v55, 0xffff0000, v41
    v_lshlrev_b32 v56, 16, v42
    v_and_b32 v57, 0xffff0000, v42
    v_lshlrev_b32 v58, 16, v43
    v_and_b32 v59, 0xffff0000, v43
    v_lshlrev_b32 v60, 16, v20
    v_lshlrev_b32 v76, 16, v28
    v_and_b32 v61, 0xffff0000, v20
    v_and_b32 v77, 0xffff0000, v28
    v_lshlrev_b32 v62, 16, v21
    v_lshlrev_b32 v78, 16, v29
    v_and_b32 v63, 0xffff0000, v21
    v_and_b32 v79, 0xffff0000, v29
    v_lshlrev_b32 v64, 16, v22
    v_lshlrev_b32 v80, 16, v30
    v_and_b32 v65, 0xffff0000, v22
    v_and_b32 v81, 0xffff0000, v30
    v_lshlrev_b32 v66, 16, v23
    v_lshlrev_b32 v82, 16, v31
    v_and_b32 v67, 0xffff0000, v23
    v_and_b32 v83, 0xffff0000, v31
    v_lshlrev_b32 v68, 16, v24
    v_lshlrev_b32 v84, 16, v32
    v_and_b32 v69, 0xffff0000, v24
    v_and_b32 v85, 0xffff0000, v32
    v_lshlrev_b32 v70, 16, v25
    v_lshlrev_b32 v86, 16, v33
    v_and_b32 v71, 0xffff0000, v25
    v_and_b32 v87, 0xffff0000, v33
    v_lshlrev_b32 v72, 16, v26
    v_lshlrev_b32 v88, 16, v34
    v_and_b32 v73, 0xffff0000, v26
    v_and_b32 v89, 0xffff0000, v34
    v_lshlrev_b32 v74, 16, v27
    v_lshlrev_b32 v90, 16, v35
    v_and_b32 v75, 0xffff0000, v27
    v_and_b32 v91, 0xffff0000, v35
    v_pk_add_f32 v[92:93], v[60:61], v[62:63]
    v_pk_add_f32 v[100:101], v[76:77], v[78:79]
    v_pk_add_f32 v[92:93], v[92:93], v[64:65]
    v_pk_add_f32 v[100:101], v[100:101], v[80:81]
    v_pk_add_f32 v[92:93], v[92:93], v[66:67]
    v_pk_add_f32 v[100:101], v[100:101], v[82:83]
    v_pk_add_f32 v[92:93], v[92:93], v[68:69]
    v_pk_add_f32 v[100:101], v[100:101], v[84:85]
    v_pk_add_f32 v[92:93], v[92:93], v[70:71]
    v_pk_add_f32 v[100:101], v[100:101], v[86:87]
    v_pk_add_f32 v[92:93], v[92:93], v[72:73]
    v_pk_add_f32 v[100:101], v[100:101], v[88:89]
    v_pk_add_f32 v[92:93], v[92:93], v[74:75]
    v_pk_add_f32 v[100:101], v[100:101], v[90:91]
    v_add_f32 v92, v92, v93
    v_add_f32 v100, v100, v101
    s_nop 0
    v_add_f32_dpp v92, v92, v92 quad_perm:[1,0,3,2] row_mask:0xf bank_mask:0xf
    v_add_f32_dpp v100, v100, v100 quad_perm:[1,0,3,2] row_mask:0xf bank_mask:0xf
    s_nop 0
    v_add_f32_dpp v92, v92, v92 quad_perm:[2,3,0,1] row_mask:0xf bank_mask:0xf
    v_add_f32_dpp v100, v100, v100 quad_perm:[2,3,0,1] row_mask:0xf bank_mask:0xf
    s_nop 0
    v_add_f32_dpp v92, v92, v92 row_half_mirror row_mask:0xf bank_mask:0xf
    v_add_f32_dpp v100, v100, v100 row_half_mirror row_mask:0xf bank_mask:0xf
    s_nop 0
    v_add_f32_dpp v92, v92, v92 row_mirror row_mask:0xf bank_mask:0xf
    v_add_f32_dpp v100, v100, v100 row_mirror row_mask:0xf bank_mask:0xf
    v_readlane_b32 s36, v92, 0
    v_readlane_b32 s56, v100, 0
    v_readlane_b32 s37, v92, 16
    v_readlane_b32 s57, v100, 16
    v_readlane_b32 s38, v92, 32
    v_readlane_b32 s58, v100, 32
    v_readlane_b32 s39, v92, 48
    v_readlane_b32 s59, v100, 48
    v_mov_b32 v96, s36
    v_mov_b32 v104, s56
    v_add_f32 v96, s37, v96
    v_add_f32 v104, s57, v104
    v_add_f32 v96, s38, v96
    v_add_f32 v104, s58, v104
    v_add_f32 v96, s39, v96
    v_add_f32 v104, s59, v104
    v_mul_f32 v96, 0xba800000, v96
    v_mul_f32 v104, 0xba800000, v104
    v_mov_b32 v97, v96
    v_mov_b32 v105, v104
    v_pk_add_f32 v[94:95], v[60:61], v[96:97]
    v_pk_add_f32 v[102:103], v[76:77], v[104:105]
    v_pk_mul_f32 v[92:93], v[94:95], v[94:95]
    v_pk_mul_f32 v[100:101], v[102:103], v[102:103]
    v_pk_add_f32 v[94:95], v[62:63], v[96:97]
    v_pk_add_f32 v[102:103], v[78:79], v[104:105]
    v_pk_fma_f32 v[92:93], v[94:95], v[94:95], v[92:93]
    v_pk_fma_f32 v[100:101], v[102:103], v[102:103], v[100:101]
    v_pk_add_f32 v[94:95], v[64:65], v[96:97]
    v_pk_add_f32 v[102:103], v[80:81], v[104:105]
    v_pk_fma_f32 v[92:93], v[94:95], v[94:95], v[92:93]
    v_pk_fma_f32 v[100:101], v[102:103], v[102:103], v[100:101]
    v_pk_add_f32 v[94:95], v[66:67], v[96:97]
    v_pk_add_f32 v[102:103], v[82:83], v[104:105]
    v_pk_fma_f32 v[92:93], v[94:95], v[94:95], v[92:93]
    v_pk_fma_f32 v[100:101], v[102:103], v[102:103], v[100:101]
    v_pk_add_f32 v[94:95], v[68:69], v[96:97]
    v_pk_add_f32 v[102:103], v[84:85], v[104:105]
    v_pk_fma_f32 v[92:93], v[94:95], v[94:95], v[92:93]
    v_pk_fma_f32 v[100:101], v[102:103], v[102:103], v[100:101]
    v_pk_add_f32 v[94:95], v[70:71], v[96:97]
    v_pk_add_f32 v[102:103], v[86:87], v[104:105]
    v_pk_fma_f32 v[92:93], v[94:95], v[94:95], v[92:93]
    v_pk_fma_f32 v[100:101], v[102:103], v[102:103], v[100:101]
    v_pk_add_f32 v[94:95], v[72:73], v[96:97]
    v_pk_add_f32 v[102:103], v[88:89], v[104:105]
    v_pk_fma_f32 v[92:93], v[94:95], v[94:95], v[92:93]
    v_pk_fma_f32 v[100:101], v[102:103], v[102:103], v[100:101]
    v_pk_add_f32 v[94:95], v[74:75], v[96:97]
    v_pk_add_f32 v[102:103], v[90:91], v[104:105]
    v_pk_fma_f32 v[92:93], v[94:95], v[94:95], v[92:93]
    v_pk_fma_f32 v[100:101], v[102:103], v[102:103], v[100:101]
    v_add_f32 v92, v92, v93
    v_add_f32 v100, v100, v101
    s_nop 0
    v_add_f32_dpp v92, v92, v92 quad_perm:[1,0,3,2] row_mask:0xf bank_mask:0xf
    v_add_f32_dpp v100, v100, v100 quad_perm:[1,0,3,2] row_mask:0xf bank_mask:0xf
    s_nop 0
    v_add_f32_dpp v92, v92, v92 quad_perm:[2,3,0,1] row_mask:0xf bank_mask:0xf
    v_add_f32_dpp v100, v100, v100 quad_perm:[2,3,0,1] row_mask:0xf bank_mask:0xf
    s_nop 0
    v_add_f32_dpp v92, v92, v92 row_half_mirror row_mask:0xf bank_mask:0xf
    v_add_f32_dpp v100, v100, v100 row_half_mirror row_mask:0xf bank_mask:0xf
    s_nop 0
    v_add_f32_dpp v92, v92, v92 row_mirror row_mask:0xf bank_mask:0xf
    v_add_f32_dpp v100, v100, v100 row_mirror row_mask:0xf bank_mask:0xf
    v_readlane_b32 s36, v92, 0
    v_readlane_b32 s56, v100, 0
    v_readlane_b32 s37, v92, 16
    v_readlane_b32 s57, v100, 16
    v_readlane_b32 s38, v92, 32
    v_readlane_b32 s58, v100, 32
    v_readlane_b32 s39, v92, 48
    v_readlane_b32 s59, v100, 48
    v_mov_b32 v94, s36
    v_mov_b32 v102, s56
    v_add_f32 v94, s37, v94
    v_add_f32 v102, s57, v102
    v_add_f32 v94, s38, v94
    v_add_f32 v102, s58, v102
    v_add_f32 v94, s39, v94
    v_add_f32 v102, s59, v102
    v_mul_f32 v94, 0x3a800000, v94
    v_mul_f32 v102, 0x3a800000, v102
    v_cvt_pk_bf16_f32 v95, v96, v94
    v_cvt_pk_bf16_f32 v103, v104, v102
    v_lshlrev_b32 v96, 16, v95
    v_lshlrev_b32 v104, 16, v103
    v_and_b32 v94, 0xffff0000, v95
    v_and_b32 v102, 0xffff0000, v103
    v_add_f32 v94, 0x3727c5ac, v94
    v_add_f32 v102, 0x3727c5ac, v102
    v_cvt_pk_bf16_f32 v94, v94, v94
    v_cvt_pk_bf16_f32 v102, v102, v102
    v_lshlrev_b32 v94, 16, v94
    v_lshlrev_b32 v102, 16, v102
    v_sqrt_f32 v94, v94
    v_sqrt_f32 v102, v102
    v_mov_b32 v97, v96
    v_mov_b32 v105, v104
    v_cvt_pk_bf16_f32 v94, v94, v94
    v_cvt_pk_bf16_f32 v102, v102, v102
    v_lshlrev_b32 v94, 16, v94
    v_lshlrev_b32 v102, 16, v102
    v_rcp_f32 v99, v94
    v_rcp_f32 v107, v102
    v_fma_f32 v95, -v94, v99, 1.0
    v_fma_f32 v103, -v102, v107, 1.0
    v_fma_f32 v99, v95, v99, v99
    v_fma_f32 v107, v103, v107, v107
    v_mov_b32 v98, v99
    v_mov_b32 v106, v107
    v_pk_add_f32 v[60:61], v[60:61], v[96:97]
    v_pk_add_f32 v[76:77], v[76:77], v[104:105]
    v_cvt_pk_bf16_f32 v94, v60, v61
    v_cvt_pk_bf16_f32 v102, v76, v77
    v_lshlrev_b32 v60, 16, v94
    v_lshlrev_b32 v76, 16, v102
    v_and_b32 v61, 0xffff0000, v94
    v_and_b32 v77, 0xffff0000, v102
    v_pk_mul_f32 v[60:61], v[60:61], v[98:99]
    v_pk_mul_f32 v[76:77], v[76:77], v[106:107]
    v_cvt_pk_bf16_f32 v108, v60, v61
    v_cvt_pk_bf16_f32 v120, v76, v77
    v_lshlrev_b32 v60, 16, v108
    v_lshlrev_b32 v76, 16, v120
    v_and_b32 v61, 0xffff0000, v108
    v_and_b32 v77, 0xffff0000, v120
    v_pk_mul_f32 v[92:93], v[60:61], v[44:45]
    v_pk_mul_f32 v[100:101], v[76:77], v[44:45]
    v_pk_add_f32 v[62:63], v[62:63], v[96:97]
    v_pk_add_f32 v[78:79], v[78:79], v[104:105]
    v_cvt_pk_bf16_f32 v94, v62, v63
    v_cvt_pk_bf16_f32 v102, v78, v79
    v_lshlrev_b32 v62, 16, v94
    v_lshlrev_b32 v78, 16, v102
    v_and_b32 v63, 0xffff0000, v94
    v_and_b32 v79, 0xffff0000, v102
    v_pk_mul_f32 v[62:63], v[62:63], v[98:99]
    v_pk_mul_f32 v[78:79], v[78:79], v[106:107]
    v_cvt_pk_bf16_f32 v109, v62, v63
    v_cvt_pk_bf16_f32 v121, v78, v79
    v_lshlrev_b32 v62, 16, v109
    v_lshlrev_b32 v78, 16, v121
    v_and_b32 v63, 0xffff0000, v109
    v_and_b32 v79, 0xffff0000, v121
    v_pk_fma_f32 v[92:93], v[62:63], v[46:47], v[92:93]
    v_pk_fma_f32 v[100:101], v[78:79], v[46:47], v[100:101]
    v_pk_add_f32 v[64:65], v[64:65], v[96:97]
    v_pk_add_f32 v[80:81], v[80:81], v[104:105]
    v_cvt_pk_bf16_f32 v94, v64, v65
    v_cvt_pk_bf16_f32 v102, v80, v81
    v_lshlrev_b32 v64, 16, v94
    v_lshlrev_b32 v80, 16, v102
    v_and_b32 v65, 0xffff0000, v94
    v_and_b32 v81, 0xffff0000, v102
    v_pk_mul_f32 v[64:65], v[64:65], v[98:99]
    v_pk_mul_f32 v[80:81], v[80:81], v[106:107]
    v_cvt_pk_bf16_f32 v110, v64, v65
    v_cvt_pk_bf16_f32 v122, v80, v81
    v_lshlrev_b32 v64, 16, v110
    v_lshlrev_b32 v80, 16, v122
    v_and_b32 v65, 0xffff0000, v110
    v_and_b32 v81, 0xffff0000, v122
    v_pk_fma_f32 v[92:93], v[64:65], v[48:49], v[92:93]
    v_pk_fma_f32 v[100:101], v[80:81], v[48:49], v[100:101]
    v_pk_add_f32 v[66:67], v[66:67], v[96:97]
    v_pk_add_f32 v[82:83], v[82:83], v[104:105]
    v_cvt_pk_bf16_f32 v94, v66, v67
    v_cvt_pk_bf16_f32 v102, v82, v83
    v_lshlrev_b32 v66, 16, v94
    v_lshlrev_b32 v82, 16, v102
    v_and_b32 v67, 0xffff0000, v94
    v_and_b32 v83, 0xffff0000, v102
    v_pk_mul_f32 v[66:67], v[66:67], v[98:99]
    v_pk_mul_f32 v[82:83], v[82:83], v[106:107]
    v_cvt_pk_bf16_f32 v111, v66, v67
    v_cvt_pk_bf16_f32 v123, v82, v83
    v_lshlrev_b32 v66, 16, v111
    v_lshlrev_b32 v82, 16, v123
    v_and_b32 v67, 0xffff0000, v111
    v_and_b32 v83, 0xffff0000, v123
    v_pk_fma_f32 v[92:93], v[66:67], v[50:51], v[92:93]
    v_pk_fma_f32 v[100:101], v[82:83], v[50:51], v[100:101]
    v_pk_add_f32 v[68:69], v[68:69], v[96:97]
    v_pk_add_f32 v[84:85], v[84:85], v[104:105]
    v_cvt_pk_bf16_f32 v94, v68, v69
    v_cvt_pk_bf16_f32 v102, v84, v85
    v_lshlrev_b32 v68, 16, v94
    v_lshlrev_b32 v84, 16, v102
    v_and_b32 v69, 0xffff0000, v94
    v_and_b32 v85, 0xffff0000, v102
    v_pk_mul_f32 v[68:69], v[68:69], v[98:99]
    v_pk_mul_f32 v[84:85], v[84:85], v[106:107]
    v_cvt_pk_bf16_f32 v112, v68, v69
    v_cvt_pk_bf16_f32 v124, v84, v85
    v_lshlrev_b32 v68, 16, v112
    v_lshlrev_b32 v84, 16, v124
    v_and_b32 v69, 0xffff0000, v112
    v_and_b32 v85, 0xffff0000, v124
    v_pk_fma_f32 v[92:93], v[68:69], v[52:53], v[92:93]
    v_pk_fma_f32 v[100:101], v[84:85], v[52:53], v[100:101]
    v_pk_add_f32 v[70:71], v[70:71], v[96:97]
    v_pk_add_f32 v[86:87], v[86:87], v[104:105]
    v_cvt_pk_bf16_f32 v94, v70, v71
    v_cvt_pk_bf16_f32 v102, v86, v87
    v_lshlrev_b32 v70, 16, v94
    v_lshlrev_b32 v86, 16, v102
    v_and_b32 v71, 0xffff0000, v94
    v_and_b32 v87, 0xffff0000, v102
    v_pk_mul_f32 v[70:71], v[70:71], v[98:99]
    v_pk_mul_f32 v[86:87], v[86:87], v[106:107]
    v_cvt_pk_bf16_f32 v113, v70, v71
    v_cvt_pk_bf16_f32 v125, v86, v87
    v_lshlrev_b32 v70, 16, v113
    v_lshlrev_b32 v86, 16, v125
    v_and_b32 v71, 0xffff0000, v113
    v_and_b32 v87, 0xffff0000, v125
    v_pk_fma_f32 v[92:93], v[70:71], v[54:55], v[92:93]
    v_pk_fma_f32 v[100:101], v[86:87], v[54:55], v[100:101]
    v_pk_add_f32 v[72:73], v[72:73], v[96:97]
    v_pk_add_f32 v[88:89], v[88:89], v[104:105]
    v_cvt_pk_bf16_f32 v94, v72, v73
    v_cvt_pk_bf16_f32 v102, v88, v89
    v_lshlrev_b32 v72, 16, v94
    v_lshlrev_b32 v88, 16, v102
    v_and_b32 v73, 0xffff0000, v94
    v_and_b32 v89, 0xffff0000, v102
    v_pk_mul_f32 v[72:73], v[72:73], v[98:99]
    v_pk_mul_f32 v[88:89], v[88:89], v[106:107]
    v_cvt_pk_bf16_f32 v114, v72, v73
    v_cvt_pk_bf16_f32 v126, v88, v89
    v_lshlrev_b32 v72, 16, v114
    v_lshlrev_b32 v88, 16, v126
    v_and_b32 v73, 0xffff0000, v114
    v_and_b32 v89, 0xffff0000, v126
    v_pk_fma_f32 v[92:93], v[72:73], v[56:57], v[92:93]
    v_pk_fma_f32 v[100:101], v[88:89], v[56:57], v[100:101]
    v_pk_add_f32 v[74:75], v[74:75], v[96:97]
    v_pk_add_f32 v[90:91], v[90:91], v[104:105]
    v_cvt_pk_bf16_f32 v94, v74, v75
    v_cvt_pk_bf16_f32 v102, v90, v91
    v_lshlrev_b32 v74, 16, v94
    v_lshlrev_b32 v90, 16, v102
    v_and_b32 v75, 0xffff0000, v94
    v_and_b32 v91, 0xffff0000, v102
    v_pk_mul_f32 v[74:75], v[74:75], v[98:99]
    v_pk_mul_f32 v[90:91], v[90:91], v[106:107]
    v_cvt_pk_bf16_f32 v115, v74, v75
    v_cvt_pk_bf16_f32 v127, v90, v91
    v_lshlrev_b32 v74, 16, v115
    v_lshlrev_b32 v90, 16, v127
    v_and_b32 v75, 0xffff0000, v115
    v_and_b32 v91, 0xffff0000, v127
    v_pk_fma_f32 v[92:93], v[74:75], v[58:59], v[92:93]
    v_pk_fma_f32 v[100:101], v[90:91], v[58:59], v[100:101]
    v_add_f32 v92, v92, v93
    v_add_f32 v100, v100, v101
    v_xor_b32 v98, 0x80000000, v96
    v_xor_b32 v106, 0x80000000, v104
    s_mul_i32 s36, s60, 2064
    s_mul_i32 s56, s28, 2064
    s_add_u32 s36, s36, 131072
    s_add_u32 s56, s56, 131072
    v_lshl_add_u32 v95, v1, 4, s36
    v_lshl_add_u32 v103, v1, 4, s56
    ds_write_b128 v95, v[108:111]
    ds_write_b128 v103, v[120:123]
    ds_write_b128 v95, v[112:115] offset:1024
    ds_write_b128 v103, v[124:127] offset:1024
    s_nop 0
    v_add_f32_dpp v92, v92, v92 quad_perm:[1,0,3,2] row_mask:0xf bank_mask:0xf
    v_add_f32_dpp v100, v100, v100 quad_perm:[1,0,3,2] row_mask:0xf bank_mask:0xf
    s_nop 0
    v_add_f32_dpp v92, v92, v92 quad_perm:[2,3,0,1] row_mask:0xf bank_mask:0xf
    v_add_f32_dpp v100, v100, v100 quad_perm:[2,3,0,1] row_mask:0xf bank_mask:0xf
    s_nop 0
    v_add_f32_dpp v92, v92, v92 row_half_mirror row_mask:0xf bank_mask:0xf
    v_add_f32_dpp v100, v100, v100 row_half_mirror row_mask:0xf bank_mask:0xf
    s_nop 0
    v_add_f32_dpp v92, v92, v92 row_mirror row_mask:0xf bank_mask:0xf
    v_add_f32_dpp v100, v100, v100 row_mirror row_mask:0xf bank_mask:0xf
    v_readlane_b32 s36, v92, 0
    v_readlane_b32 s56, v100, 0
    v_readlane_b32 s37, v92, 16
    v_readlane_b32 s57, v100, 16
    v_readlane_b32 s38, v92, 32
    v_readlane_b32 s58, v100, 32
    v_readlane_b32 s39, v92, 48
    v_readlane_b32 s59, v100, 48
    v_mov_b32 v93, s36
    v_mov_b32 v101, s56
    v_add_f32 v93, s37, v93
    v_add_f32 v101, s57, v101
    v_add_f32 v93, s38, v93
    v_add_f32 v101, s58, v101
    v_add_f32 v93, s39, v93
    v_add_f32 v101, s59, v101
    v_cvt_pk_bf16_f32 v93, v93, v93
    v_cvt_pk_bf16_f32 v101, v101, v101
    v_lshlrev_b32 v93, 16, v93
    v_lshlrev_b32 v101, 16, v101
    v_ashrrev_i32 v95, 31, v93
    v_ashrrev_i32 v103, 31, v101
    v_or_b32 v95, 0x80000000, v95
    v_or_b32 v103, 0x80000000, v103
    v_xor_b32 v95, v93, v95
    v_xor_b32 v103, v101, v103
    v_and_b32 v95, 0xffff0000, v95
    v_and_b32 v103, 0xffff0000, v103
    s_sub_u32 s36, 0xffff, s42
    s_sub_u32 s56, 0xffff, s43
    v_or_b32 v95, s36, v95
    v_or_b32 v103, s56, v103
    s_lshl_b32 s37, s60, 3
    s_lshl_b32 s57, s28, 3
    s_add_u32 s37, s37, 147712
    s_add_u32 s57, s57, 147712
    v_mov_b32 v94, s37
    v_mov_b32 v102, s57
    ds_write_b64 v94, v[98:99]
    ds_write_b64 v102, v[106:107]
    ds_write_b32 v94, v95 offset:64
    ds_write_b32 v102, v103 offset:64
    s_lshl_b32 s36, s2, 13
    s_lshl_b32 s37, s60, 11
    s_add_u32 s36, s36, s37
    v_lshl_add_u32 v16, v1, 7, s36
    s_cmp_lt_u32 s60, 2
    s_cselect_b64 s[38:39], s[48:49], s[50:51]
    s_lshr_b32 s36, s2, 3
    s_lshl_b32 s36, s36, 1
    s_and_b32 s37, s60, 1
    s_add_u32 s36, s36, s37
    s_lshl_b32 s36, s36, 16
    s_and_b32 s37, s29, 28
    s_lshl_b32 s37, s37, 8
    s_add_u32 s36, s36, s37
    s_sub_u32 s37, 256, s38
    s_and_b32 s37, s37, 0x300
    s_add_u32 s36, s36, s37
    v_lshrrev_b32 v18, 1, v1
    v_lshl_add_u32 v18, v18, 13, s36
    v_and_b32 v19, 1, v1
    v_lshl_add_u32 v18, v19, 7, v18
    s_mov_b64 exec, 0xffff
    global_load_dword v0, v16, s[46:47]
    global_load_dword v0, v18, s[38:39]
    s_mov_b64 exec, -1
    s_waitcnt lgkmcnt(0)
    s_cmp_eq_u32 s3, 0
    s_mov_b32 s3, 0
    s_cbranch_scc0 L_ln
L_pro_j:
    s_barrier
    ds_read_b128 v[20:23], v10 offset:0
    ds_read_b64_tr_b16 v[52:53], v12 offset:0
    ds_read_b64_tr_b16 v[54:55], v12 offset:1024
    ds_read_b64_tr_b16 v[56:57], v13 offset:0
    ds_read_b64_tr_b16 v[58:59], v13 offset:1024
    ds_read_b64_tr_b16 v[60:61], v14 offset:0
    ds_read_b64_tr_b16 v[62:63], v14 offset:1024
    ds_read_b64_tr_b16 v[64:65], v15 offset:0
    ds_read_b64_tr_b16 v[66:67], v15 offset:1024
    ds_read_b128 v[24:27], v10 offset:2048
    ds_read_b128 v[28:31], v10 offset:4096
    ds_read_b128 v[32:35], v10 offset:6144
    ds_read_b128 v[36:39], v10 offset:8192
    ds_read_b128 v[40:43], v10 offset:10240
    ds_read_b128 v[44:47], v10 offset:12288
    ds_read_b128 v[48:51], v10 offset:14336
    s_add_u32 s36, s2, s28
    s_cmp_eq_u32 s36, 0
    s_cbranch_scc1 L_recurrent_scan__compressed_kv_cla__moe_arch_mod__prompt_kernel_rare_3
L_recurrent_scan__compressed_kv_cla__moe_arch_mod__prompt_kernel_back_4:
    s_mov_b32 s35, 0
    s_cmp_eq_u32 s28, 0
    s_cselect_b32 s43, 9, 0
    s_cselect_b32 s44, 2, 1
    s_cmp_lt_u32 s28, 4
    s_cbranch_scc0 L_kv_vloop
    .p2align 6
L_kv_kloop:
    s_waitcnt lgkmcnt(0)
    v_mfma_f32_16x16x32_bf16 v[128:131], v[52:55], v[20:23], v[128:131]
    ds_read_b128 v[68:71], v11 offset:0
    v_mfma_f32_16x16x32_bf16 v[132:135], v[56:59], v[20:23], v[132:135]
    ds_read_b64_tr_b16 v[100:101], v12 offset:8192
    v_mfma_f32_16x16x32_bf16 v[136:139], v[60:63], v[20:23], v[136:139]
    ds_read_b64_tr_b16 v[102:103], v12 offset:9216
    v_mfma_f32_16x16x32_bf16 v[140:143], v[64:67], v[20:23], v[140:143]
    ds_read_b64_tr_b16 v[104:105], v13 offset:8192
    v_mfma_f32_16x16x32_bf16 v[144:147], v[52:55], v[24:27], v[144:147]
    ds_read_b64_tr_b16 v[106:107], v13 offset:9216
    v_mfma_f32_16x16x32_bf16 v[148:151], v[56:59], v[24:27], v[148:151]
    ds_read_b64_tr_b16 v[108:109], v14 offset:8192
    v_mfma_f32_16x16x32_bf16 v[152:155], v[60:63], v[24:27], v[152:155]
    ds_read_b64_tr_b16 v[110:111], v14 offset:9216
    v_mfma_f32_16x16x32_bf16 v[156:159], v[64:67], v[24:27], v[156:159]
    ds_read_b64_tr_b16 v[112:113], v15 offset:8192
    v_mfma_f32_16x16x32_bf16 v[160:163], v[52:55], v[28:31], v[160:163]
    ds_read_b64_tr_b16 v[114:115], v15 offset:9216
    v_mfma_f32_16x16x32_bf16 v[164:167], v[56:59], v[28:31], v[164:167]
    ds_read_b128 v[72:75], v11 offset:2048
    v_mfma_f32_16x16x32_bf16 v[168:171], v[60:63], v[28:31], v[168:171]
    ds_read_b128 v[76:79], v11 offset:4096
    v_mfma_f32_16x16x32_bf16 v[172:175], v[64:67], v[28:31], v[172:175]
    ds_read_b128 v[80:83], v11 offset:6144
    v_mfma_f32_16x16x32_bf16 v[176:179], v[52:55], v[32:35], v[176:179]
    ds_read_b128 v[84:87], v11 offset:8192
    v_mfma_f32_16x16x32_bf16 v[180:183], v[56:59], v[32:35], v[180:183]
    ds_read_b128 v[88:91], v11 offset:10240
    v_mfma_f32_16x16x32_bf16 v[184:187], v[60:63], v[32:35], v[184:187]
    ds_read_b128 v[92:95], v11 offset:12288
    v_mfma_f32_16x16x32_bf16 v[188:191], v[64:67], v[32:35], v[188:191]
    ds_read_b128 v[96:99], v11 offset:14336
    v_mfma_f32_16x16x32_bf16 v[192:195], v[52:55], v[36:39], v[192:195]
    v_mfma_f32_16x16x32_bf16 v[196:199], v[56:59], v[36:39], v[196:199]
    v_mfma_f32_16x16x32_bf16 v[200:203], v[60:63], v[36:39], v[200:203]
    v_mfma_f32_16x16x32_bf16 v[204:207], v[64:67], v[36:39], v[204:207]
    v_mfma_f32_16x16x32_bf16 v[208:211], v[52:55], v[40:43], v[208:211]
    v_mfma_f32_16x16x32_bf16 v[212:215], v[56:59], v[40:43], v[212:215]
    v_mfma_f32_16x16x32_bf16 v[216:219], v[60:63], v[40:43], v[216:219]
    v_mfma_f32_16x16x32_bf16 v[220:223], v[64:67], v[40:43], v[220:223]
    v_mfma_f32_16x16x32_bf16 v[224:227], v[52:55], v[44:47], v[224:227]
    v_mfma_f32_16x16x32_bf16 v[228:231], v[56:59], v[44:47], v[228:231]
    v_mfma_f32_16x16x32_bf16 v[232:235], v[60:63], v[44:47], v[232:235]
    v_mfma_f32_16x16x32_bf16 v[236:239], v[64:67], v[44:47], v[236:239]
    v_mfma_f32_16x16x32_bf16 v[240:243], v[52:55], v[48:51], v[240:243]
    v_mfma_f32_16x16x32_bf16 v[244:247], v[56:59], v[48:51], v[244:247]
    v_mfma_f32_16x16x32_bf16 v[248:251], v[60:63], v[48:51], v[248:251]
    v_mfma_f32_16x16x32_bf16 v[252:255], v[64:67], v[48:51], v[252:255]
    s_cmp_eq_u32 s35, 3
    s_cbranch_scc1 L_recurrent_scan__compressed_kv_cla__moe_arch_mod__prompt_kernel_rare_5
L_recurrent_scan__compressed_kv_cla__moe_arch_mod__prompt_kernel_back_6:
    s_cmp_lt_u32 s35, s44
    s_cbranch_scc1 L_recurrent_scan__compressed_kv_cla__moe_arch_mod__prompt_kernel_w0_7
    s_waitcnt vmcnt(1)
L_recurrent_scan__compressed_kv_cla__moe_arch_mod__prompt_kernel_w0b_8:
    s_waitcnt lgkmcnt(0)
    s_barrier
    v_mfma_f32_16x16x32_bf16 v[128:131], v[100:103], v[68:71], v[128:131]
    ds_read_b128 v[20:23], v10 offset:32768
    s_add_u32 m0, s33, 0
    v_mfma_f32_16x16x32_bf16 v[132:135], v[104:107], v[68:71], v[132:135]
    ds_read_b64_tr_b16 v[52:53], v12 offset:32768
    buffer_load_dwordx4 v2, s[4:7], s31 offen offset:0 lds
    v_mfma_f32_16x16x32_bf16 v[136:139], v[108:111], v[68:71], v[136:139]
    ds_read_b64_tr_b16 v[54:55], v12 offset:33792
    v_mfma_f32_16x16x32_bf16 v[140:143], v[112:115], v[68:71], v[140:143]
    ds_read_b64_tr_b16 v[56:57], v13 offset:32768
    v_mfma_f32_16x16x32_bf16 v[144:147], v[100:103], v[72:75], v[144:147]
    ds_read_b64_tr_b16 v[58:59], v13 offset:33792
    buffer_load_dwordx4 v3, s[4:7], s31 offen offset:1024 lds
    v_mfma_f32_16x16x32_bf16 v[148:151], v[104:107], v[72:75], v[148:151]
    ds_read_b64_tr_b16 v[60:61], v14 offset:32768
    v_mfma_f32_16x16x32_bf16 v[152:155], v[108:111], v[72:75], v[152:155]
    ds_read_b64_tr_b16 v[62:63], v14 offset:33792
    v_mfma_f32_16x16x32_bf16 v[156:159], v[112:115], v[72:75], v[156:159]
    ds_read_b64_tr_b16 v[64:65], v15 offset:32768
    buffer_load_dwordx4 v4, s[4:7], s31 offen offset:2048 lds
    v_mfma_f32_16x16x32_bf16 v[160:163], v[100:103], v[76:79], v[160:163]
    ds_read_b64_tr_b16 v[66:67], v15 offset:33792
    v_mfma_f32_16x16x32_bf16 v[164:167], v[104:107], v[76:79], v[164:167]
    ds_read_b128 v[24:27], v10 offset:34816
    v_mfma_f32_16x16x32_bf16 v[168:171], v[108:111], v[76:79], v[168:171]
    ds_read_b128 v[28:31], v10 offset:36864
    buffer_load_dwordx4 v5, s[4:7], s31 offen offset:3072 lds
    v_mfma_f32_16x16x32_bf16 v[172:175], v[112:115], v[76:79], v[172:175]
    ds_read_b128 v[32:35], v10 offset:38912
    v_mfma_f32_16x16x32_bf16 v[176:179], v[100:103], v[80:83], v[176:179]
    ds_read_b128 v[36:39], v10 offset:40960
    s_add_u32 m0, s34, 0
    v_mfma_f32_16x16x32_bf16 v[180:183], v[104:107], v[80:83], v[180:183]
    ds_read_b128 v[40:43], v10 offset:43008
    buffer_load_dwordx4 v6, s[8:11], s32 offen offset:0 nt lds
    v_mfma_f32_16x16x32_bf16 v[184:187], v[108:111], v[80:83], v[184:187]
    ds_read_b128 v[44:47], v10 offset:45056
    v_mfma_f32_16x16x32_bf16 v[188:191], v[112:115], v[80:83], v[188:191]
    ds_read_b128 v[48:51], v10 offset:47104
    v_mfma_f32_16x16x32_bf16 v[192:195], v[100:103], v[84:87], v[192:195]
    buffer_load_dwordx4 v7, s[8:11], s32 offen offset:1024 nt lds
    v_mfma_f32_16x16x32_bf16 v[196:199], v[104:107], v[84:87], v[196:199]
    v_mfma_f32_16x16x32_bf16 v[200:203], v[108:111], v[84:87], v[200:203]
    v_mfma_f32_16x16x32_bf16 v[204:207], v[112:115], v[84:87], v[204:207]
    buffer_load_dwordx4 v8, s[8:11], s32 offen offset:2048 nt lds
    v_mfma_f32_16x16x32_bf16 v[208:211], v[100:103], v[88:91], v[208:211]
    v_mfma_f32_16x16x32_bf16 v[212:215], v[104:107], v[88:91], v[212:215]
    v_mfma_f32_16x16x32_bf16 v[216:219], v[108:111], v[88:91], v[216:219]
    buffer_load_dwordx4 v9, s[8:11], s32 offen offset:3072 nt lds
    v_mfma_f32_16x16x32_bf16 v[220:223], v[112:115], v[88:91], v[220:223]
    v_mfma_f32_16x16x32_bf16 v[224:227], v[100:103], v[92:95], v[224:227]
    v_mfma_f32_16x16x32_bf16 v[228:231], v[104:107], v[92:95], v[228:231]
    v_mfma_f32_16x16x32_bf16 v[232:235], v[108:111], v[92:95], v[232:235]
    v_mfma_f32_16x16x32_bf16 v[236:239], v[112:115], v[92:95], v[236:239]
    v_mfma_f32_16x16x32_bf16 v[240:243], v[100:103], v[96:99], v[240:243]
    v_mfma_f32_16x16x32_bf16 v[244:247], v[104:107], v[96:99], v[244:247]
    v_mfma_f32_16x16x32_bf16 v[248:251], v[108:111], v[96:99], v[248:251]
    v_mfma_f32_16x16x32_bf16 v[252:255], v[112:115], v[96:99], v[252:255]
    s_bitcmp1_b32 6, s35
    s_cselect_b32 exec_lo, 255, 1
    s_mov_b32 exec_hi, 0
    global_load_dword v0, v17, s[96:97]
    s_mov_b64 exec, -1
    s_cselect_b32 s36, s45, 0
    v_add_u32 v17, s36, v17
    v_min_u32 v17, 8388480, v17
    s_nop 1
    s_add_u32 s31, s31, s40
    s_add_u32 s32, s32, s41
    s_waitcnt lgkmcnt(0)
    v_mfma_f32_16x16x32_bf16 v[128:131], v[52:55], v[20:23], v[128:131]
    ds_read_b128 v[68:71], v11 offset:32768
    v_mfma_f32_16x16x32_bf16 v[132:135], v[56:59], v[20:23], v[132:135]
    ds_read_b64_tr_b16 v[100:101], v12 offset:40960
    v_mfma_f32_16x16x32_bf16 v[136:139], v[60:63], v[20:23], v[136:139]
    ds_read_b64_tr_b16 v[102:103], v12 offset:41984
    v_mfma_f32_16x16x32_bf16 v[140:143], v[64:67], v[20:23], v[140:143]
    ds_read_b64_tr_b16 v[104:105], v13 offset:40960
    v_mfma_f32_16x16x32_bf16 v[144:147], v[52:55], v[24:27], v[144:147]
    ds_read_b64_tr_b16 v[106:107], v13 offset:41984
    v_mfma_f32_16x16x32_bf16 v[148:151], v[56:59], v[24:27], v[148:151]
    ds_read_b64_tr_b16 v[108:109], v14 offset:40960
    v_mfma_f32_16x16x32_bf16 v[152:155], v[60:63], v[24:27], v[152:155]
    ds_read_b64_tr_b16 v[110:111], v14 offset:41984
    v_mfma_f32_16x16x32_bf16 v[156:159], v[64:67], v[24:27], v[156:159]
    ds_read_b64_tr_b16 v[112:113], v15 offset:40960
    v_mfma_f32_16x16x32_bf16 v[160:163], v[52:55], v[28:31], v[160:163]
    ds_read_b64_tr_b16 v[114:115], v15 offset:41984
    v_mfma_f32_16x16x32_bf16 v[164:167], v[56:59], v[28:31], v[164:167]
    ds_read_b128 v[72:75], v11 offset:34816
    v_mfma_f32_16x16x32_bf16 v[168:171], v[60:63], v[28:31], v[168:171]
    ds_read_b128 v[76:79], v11 offset:36864
    v_mfma_f32_16x16x32_bf16 v[172:175], v[64:67], v[28:31], v[172:175]
    ds_read_b128 v[80:83], v11 offset:38912
    v_mfma_f32_16x16x32_bf16 v[176:179], v[52:55], v[32:35], v[176:179]
    ds_read_b128 v[84:87], v11 offset:40960
    v_mfma_f32_16x16x32_bf16 v[180:183], v[56:59], v[32:35], v[180:183]
    ds_read_b128 v[88:91], v11 offset:43008
    v_mfma_f32_16x16x32_bf16 v[184:187], v[60:63], v[32:35], v[184:187]
    ds_read_b128 v[92:95], v11 offset:45056
    v_mfma_f32_16x16x32_bf16 v[188:191], v[64:67], v[32:35], v[188:191]
    ds_read_b128 v[96:99], v11 offset:47104
    v_mfma_f32_16x16x32_bf16 v[192:195], v[52:55], v[36:39], v[192:195]
    v_mfma_f32_16x16x32_bf16 v[196:199], v[56:59], v[36:39], v[196:199]
    v_mfma_f32_16x16x32_bf16 v[200:203], v[60:63], v[36:39], v[200:203]
    v_mfma_f32_16x16x32_bf16 v[204:207], v[64:67], v[36:39], v[204:207]
    v_mfma_f32_16x16x32_bf16 v[208:211], v[52:55], v[40:43], v[208:211]
    s_bitcmp1_b32 s43, s35
    s_cbranch_scc1 L_recurrent_scan__compressed_kv_cla__moe_arch_mod__prompt_kernel_rare_13
L_recurrent_scan__compressed_kv_cla__moe_arch_mod__prompt_kernel_back_14:
    v_mfma_f32_16x16x32_bf16 v[212:215], v[56:59], v[40:43], v[212:215]
    v_mfma_f32_16x16x32_bf16 v[216:219], v[60:63], v[40:43], v[216:219]
    v_mfma_f32_16x16x32_bf16 v[220:223], v[64:67], v[40:43], v[220:223]
    v_mfma_f32_16x16x32_bf16 v[224:227], v[52:55], v[44:47], v[224:227]
    v_mfma_f32_16x16x32_bf16 v[228:231], v[56:59], v[44:47], v[228:231]
    v_mfma_f32_16x16x32_bf16 v[232:235], v[60:63], v[44:47], v[232:235]
    v_mfma_f32_16x16x32_bf16 v[236:239], v[64:67], v[44:47], v[236:239]
    v_mfma_f32_16x16x32_bf16 v[240:243], v[52:55], v[48:51], v[240:243]
    v_mfma_f32_16x16x32_bf16 v[244:247], v[56:59], v[48:51], v[244:247]
    v_mfma_f32_16x16x32_bf16 v[248:251], v[60:63], v[48:51], v[248:251]
    v_mfma_f32_16x16x32_bf16 v[252:255], v[64:67], v[48:51], v[252:255]
    s_bitcmp1_b32 s43, s35
    s_cbranch_scc1 L_recurrent_scan__compressed_kv_cla__moe_arch_mod__prompt_kernel_w0_15
    s_waitcnt vmcnt(1)
L_recurrent_scan__compressed_kv_cla__moe_arch_mod__prompt_kernel_w0b_16:
    s_waitcnt lgkmcnt(0)
    s_cmp_eq_u32 s35, 3
    s_barrier
    s_cbranch_scc1 L_p1_fin0
    v_mfma_f32_16x16x32_bf16 v[128:131], v[100:103], v[68:71], v[128:131]
    ds_read_b128 v[20:23], v10 offset:0
    s_add_u32 m0, s33, 32768
    v_mfma_f32_16x16x32_bf16 v[132:135], v[104:107], v[68:71], v[132:135]
    ds_read_b64_tr_b16 v[52:53], v12 offset:0
    buffer_load_dwordx4 v2, s[4:7], s31 offen offset:0 lds
    v_mfma_f32_16x16x32_bf16 v[136:139], v[108:111], v[68:71], v[136:139]
    ds_read_b64_tr_b16 v[54:55], v12 offset:1024
    v_mfma_f32_16x16x32_bf16 v[140:143], v[112:115], v[68:71], v[140:143]
    ds_read_b64_tr_b16 v[56:57], v13 offset:0
    v_mfma_f32_16x16x32_bf16 v[144:147], v[100:103], v[72:75], v[144:147]
    ds_read_b64_tr_b16 v[58:59], v13 offset:1024
    buffer_load_dwordx4 v3, s[4:7], s31 offen offset:1024 lds
    v_mfma_f32_16x16x32_bf16 v[148:151], v[104:107], v[72:75], v[148:151]
    ds_read_b64_tr_b16 v[60:61], v14 offset:0
    v_mfma_f32_16x16x32_bf16 v[152:155], v[108:111], v[72:75], v[152:155]
    ds_read_b64_tr_b16 v[62:63], v14 offset:1024
    v_mfma_f32_16x16x32_bf16 v[156:159], v[112:115], v[72:75], v[156:159]
    ds_read_b64_tr_b16 v[64:65], v15 offset:0
    buffer_load_dwordx4 v4, s[4:7], s31 offen offset:2048 lds
    v_mfma_f32_16x16x32_bf16 v[160:163], v[100:103], v[76:79], v[160:163]
    ds_read_b64_tr_b16 v[66:67], v15 offset:1024
    v_mfma_f32_16x16x32_bf16 v[164:167], v[104:107], v[76:79], v[164:167]
    ds_read_b128 v[24:27], v10 offset:2048
    v_mfma_f32_16x16x32_bf16 v[168:171], v[108:111], v[76:79], v[168:171]
    ds_read_b128 v[28:31], v10 offset:4096
    buffer_load_dwordx4 v5, s[4:7], s31 offen offset:3072 lds
    v_mfma_f32_16x16x32_bf16 v[172:175], v[112:115], v[76:79], v[172:175]
    ds_read_b128 v[32:35], v10 offset:6144
    v_mfma_f32_16x16x32_bf16 v[176:179], v[100:103], v[80:83], v[176:179]
    ds_read_b128 v[36:39], v10 offset:8192
    s_add_u32 m0, s34, 32768
    v_mfma_f32_16x16x32_bf16 v[180:183], v[104:107], v[80:83], v[180:183]
    ds_read_b128 v[40:43], v10 offset:10240
    buffer_load_dwordx4 v6, s[8:11], s32 offen offset:0 nt lds
    v_mfma_f32_16x16x32_bf16 v[184:187], v[108:111], v[80:83], v[184:187]
    ds_read_b128 v[44:47], v10 offset:12288
    v_mfma_f32_16x16x32_bf16 v[188:191], v[112:115], v[80:83], v[188:191]
    ds_read_b128 v[48:51], v10 offset:14336
    v_mfma_f32_16x16x32_bf16 v[192:195], v[100:103], v[84:87], v[192:195]
    buffer_load_dwordx4 v7, s[8:11], s32 offen offset:1024 nt lds
    v_mfma_f32_16x16x32_bf16 v[196:199], v[104:107], v[84:87], v[196:199]
    v_mfma_f32_16x16x32_bf16 v[200:203], v[108:111], v[84:87], v[200:203]
    v_mfma_f32_16x16x32_bf16 v[204:207], v[112:115], v[84:87], v[204:207]
    buffer_load_dwordx4 v8, s[8:11], s32 offen offset:2048 nt lds
    v_mfma_f32_16x16x32_bf16 v[208:211], v[100:103], v[88:91], v[208:211]
    v_mfma_f32_16x16x32_bf16 v[212:215], v[104:107], v[88:91], v[212:215]
    v_mfma_f32_16x16x32_bf16 v[216:219], v[108:111], v[88:91], v[216:219]
    buffer_load_dwordx4 v9, s[8:11], s32 offen offset:3072 nt lds
    v_mfma_f32_16x16x32_bf16 v[220:223], v[112:115], v[88:91], v[220:223]
    v_mfma_f32_16x16x32_bf16 v[224:227], v[100:103], v[92:95], v[224:227]
    v_mfma_f32_16x16x32_bf16 v[228:231], v[104:107], v[92:95], v[228:231]
    v_mfma_f32_16x16x32_bf16 v[232:235], v[108:111], v[92:95], v[232:235]
    v_mfma_f32_16x16x32_bf16 v[236:239], v[112:115], v[92:95], v[236:239]
    v_mfma_f32_16x16x32_bf16 v[240:243], v[100:103], v[96:99], v[240:243]
    v_mfma_f32_16x16x32_bf16 v[244:247], v[104:107], v[96:99], v[244:247]
    v_mfma_f32_16x16x32_bf16 v[248:251], v[108:111], v[96:99], v[248:251]
    s_add_u32 s36, s35, s28
    s_cmp_eq_u32 s36, 0
    s_cbranch_scc1 L_recurrent_scan__compressed_kv_cla__moe_arch_mod__prompt_kernel_rare_25
L_recurrent_scan__compressed_kv_cla__moe_arch_mod__prompt_kernel_back_26:
    v_mfma_f32_16x16x32_bf16 v[252:255], v[112:115], v[96:99], v[252:255]
    s_bitcmp1_b32 3, s35
    s_cselect_b32 exec_lo, 255, 1
    s_mov_b32 exec_hi, 0
    global_load_dword v0, v17, s[96:97]
    s_mov_b64 exec, -1
    s_cselect_b32 s36, s45, 0
    v_add_u32 v17, s36, v17
    v_min_u32 v17, 8388480, v17
    s_nop 1
    s_add_u32 s31, s31, s40
    s_add_u32 s32, s32, s41
    s_add_u32 s35, s35, 1
    s_branch L_kv_kloop
L_p1_fin0:
    v_mfma_f32_16x16x32_bf16 v[128:131], v[100:103], v[68:71], v[128:131]
    s_and_b32 s36, s28, 3
    s_sub_u32 s37, 15, s30
    s_cmp_lt_u32 s28, 4
    s_cselect_b32 s37, s37, s30
    s_lshl_b32 s37, s37, 2
    s_add_u32 s37, s37, s36
    s_lshl_b32 s37, s37, 16
    v_lshl_add_u32 v6, v1, 4, s37
    v_add_u32 v7, 32768, v6
    s_mov_b32 s32, 0
    s_mov_b32 s8, s54
    s_and_b32 s9, s55, 0xffff
    s_mov_b32 s10, 104857728
    s_mov_b32 s11, 0x20000
    v_mfma_f32_16x16x32_bf16 v[132:135], v[104:107], v[68:71], v[132:135]
    buffer_load_dwordx4 v[24:27], v6, s[8:11], s32 offen offset:0 sc1
    v_mfma_f32_16x16x32_bf16 v[136:139], v[108:111], v[68:71], v[136:139]
    v_lshrrev_b32 v18, 4, v1
    v_mfma_f32_16x16x32_bf16 v[140:143], v[112:115], v[68:71], v[140:143]
    v_bfe_u32 v20, v1, 2, 2
    v_mfma_f32_16x16x32_bf16 v[144:147], v[100:103], v[72:75], v[144:147]
    v_lshl_add_u32 v19, v18, 3, v20
    v_mfma_f32_16x16x32_bf16 v[148:151], v[104:107], v[72:75], v[148:151]
    buffer_load_dwordx4 v[28:31], v7, s[8:11], s32 offen offset:0 sc1
    v_lshlrev_b32 v19, 8, v19
    v_mfma_f32_16x16x32_bf16 v[152:155], v[108:111], v[72:75], v[152:155]
    v_and_b32 v21, 3, v1
    v_mfma_f32_16x16x32_bf16 v[156:159], v[112:115], v[72:75], v[156:159]
    v_lshl_add_u32 v19, v21, 3, v19
    v_mfma_f32_16x16x32_bf16 v[160:163], v[100:103], v[76:79], v[160:163]
    v_and_b32 v21, 1, v18
    v_mfma_f32_16x16x32_bf16 v[164:167], v[104:107], v[76:79], v[164:167]
    buffer_load_dwordx4 v[32:35], v6, s[8:11], s32 offen offset:1024 sc1
    v_lshl_add_u32 v20, v21, 2, v20
    v_mfma_f32_16x16x32_bf16 v[168:171], v[108:111], v[76:79], v[168:171]
    v_xor_b32 v21, 0, v20
    v_mfma_f32_16x16x32_bf16 v[172:175], v[112:115], v[76:79], v[172:175]
    v_lshl_add_u32 v10, v21, 5, v19
    v_mfma_f32_16x16x32_bf16 v[176:179], v[100:103], v[80:83], v[176:179]
    v_xor_b32 v21, 1, v20
    v_mfma_f32_16x16x32_bf16 v[180:183], v[104:107], v[80:83], v[180:183]
    buffer_load_dwordx4 v[36:39], v7, s[8:11], s32 offen offset:1024 sc1
    v_lshl_add_u32 v11, v21, 5, v19
    v_mfma_f32_16x16x32_bf16 v[184:187], v[108:111], v[80:83], v[184:187]
    v_xor_b32 v21, 2, v20
    v_mfma_f32_16x16x32_bf16 v[188:191], v[112:115], v[80:83], v[188:191]
    v_lshl_add_u32 v12, v21, 5, v19
    v_mfma_f32_16x16x32_bf16 v[192:195], v[100:103], v[84:87], v[192:195]
    v_xor_b32 v21, 3, v20
    v_mfma_f32_16x16x32_bf16 v[196:199], v[104:107], v[84:87], v[196:199]
    buffer_load_dwordx4 v[40:43], v6, s[8:11], s32 offen offset:2048 sc1
    v_lshl_add_u32 v13, v21, 5, v19
    v_mfma_f32_16x16x32_bf16 v[200:203], v[108:111], v[84:87], v[200:203]
    v_xor_b32 v21, 4, v20
    v_mfma_f32_16x16x32_bf16 v[204:207], v[112:115], v[84:87], v[204:207]
    v_lshl_add_u32 v14, v21, 5, v19
    v_mfma_f32_16x16x32_bf16 v[208:211], v[100:103], v[88:91], v[208:211]
    v_xor_b32 v21, 5, v20
    v_mfma_f32_16x16x32_bf16 v[212:215], v[104:107], v[88:91], v[212:215]
    buffer_load_dwordx4 v[44:47], v7, s[8:11], s32 offen offset:2048 sc1
    v_lshl_add_u32 v15, v21, 5, v19
    v_mfma_f32_16x16x32_bf16 v[216:219], v[108:111], v[88:91], v[216:219]
    v_xor_b32 v21, 6, v20
    v_mfma_f32_16x16x32_bf16 v[220:223], v[112:115], v[88:91], v[220:223]
    v_lshl_add_u32 v16, v21, 5, v19
    v_mfma_f32_16x16x32_bf16 v[224:227], v[100:103], v[92:95], v[224:227]
    v_xor_b32 v21, 7, v20
    v_mfma_f32_16x16x32_bf16 v[228:231], v[104:107], v[92:95], v[228:231]
    buffer_load_dwordx4 v[48:51], v6, s[8:11], s32 offen offset:3072 sc1
    v_lshl_add_u32 v17, v21, 5, v19
    v_mfma_f32_16x16x32_bf16 v[232:235], v[108:111], v[92:95], v[232:235]
    s_lshl_b32 s45, s29, 20
    v_mfma_f32_16x16x32_bf16 v[236:239], v[112:115], v[92:95], v[236:239]
    v_mfma_f32_16x16x32_bf16 v[240:243], v[100:103], v[96:99], v[240:243]
    v_mfma_f32_16x16x32_bf16 v[244:247], v[104:107], v[96:99], v[244:247]
    buffer_load_dwordx4 v[52:55], v7, s[8:11], s32 offen offset:3072 sc1
    v_mfma_f32_16x16x32_bf16 v[248:251], v[108:111], v[96:99], v[248:251]
    v_mfma_f32_16x16x32_bf16 v[252:255], v[112:115], v[96:99], v[252:255]
    s_branch L_p1_done
    .p2align 6
L_kv_vloop:
    s_waitcnt lgkmcnt(0)
    v_mfma_f32_16x16x32_bf16 v[128:131], v[20:23], v[52:55], v[128:131]
    ds_read_b128 v[68:71], v11 offset:0
    v_mfma_f32_16x16x32_bf16 v[160:163], v[20:23], v[56:59], v[160:163]
    ds_read_b64_tr_b16 v[100:101], v12 offset:8192
    v_mfma_f32_16x16x32_bf16 v[192:195], v[20:23], v[60:63], v[192:195]
    ds_read_b64_tr_b16 v[102:103], v12 offset:9216
    v_mfma_f32_16x16x32_bf16 v[224:227], v[20:23], v[64:67], v[224:227]
    ds_read_b64_tr_b16 v[104:105], v13 offset:8192
    v_mfma_f32_16x16x32_bf16 v[132:135], v[24:27], v[52:55], v[132:135]
    ds_read_b64_tr_b16 v[106:107], v13 offset:9216
    v_mfma_f32_16x16x32_bf16 v[164:167], v[24:27], v[56:59], v[164:167]
    ds_read_b64_tr_b16 v[108:109], v14 offset:8192
    v_mfma_f32_16x16x32_bf16 v[196:199], v[24:27], v[60:63], v[196:199]
    ds_read_b64_tr_b16 v[110:111], v14 offset:9216
    v_mfma_f32_16x16x32_bf16 v[228:231], v[24:27], v[64:67], v[228:231]
    ds_read_b64_tr_b16 v[112:113], v15 offset:8192
    v_mfma_f32_16x16x32_bf16 v[136:139], v[28:31], v[52:55], v[136:139]
    ds_read_b64_tr_b16 v[114:115], v15 offset:9216
    v_mfma_f32_16x16x32_bf16 v[168:171], v[28:31], v[56:59], v[168:171]
    ds_read_b128 v[72:75], v11 offset:2048
    v_mfma_f32_16x16x32_bf16 v[200:203], v[28:31], v[60:63], v[200:203]
    ds_read_b128 v[76:79], v11 offset:4096
    v_mfma_f32_16x16x32_bf16 v[232:235], v[28:31], v[64:67], v[232:235]
    ds_read_b128 v[80:83], v11 offset:6144
    v_mfma_f32_16x16x32_bf16 v[140:143], v[32:35], v[52:55], v[140:143]
    ds_read_b128 v[84:87], v11 offset:8192
    v_mfma_f32_16x16x32_bf16 v[172:175], v[32:35], v[56:59], v[172:175]
    ds_read_b128 v[88:91], v11 offset:10240
    v_mfma_f32_16x16x32_bf16 v[204:207], v[32:35], v[60:63], v[204:207]
    ds_read_b128 v[92:95], v11 offset:12288
    v_mfma_f32_16x16x32_bf16 v[236:239], v[32:35], v[64:67], v[236:239]
    ds_read_b128 v[96:99], v11 offset:14336
    v_mfma_f32_16x16x32_bf16 v[144:147], v[36:39], v[52:55], v[144:147]
    v_mfma_f32_16x16x32_bf16 v[176:179], v[36:39], v[56:59], v[176:179]
    v_mfma_f32_16x16x32_bf16 v[208:211], v[36:39], v[60:63], v[208:211]
    v_mfma_f32_16x16x32_bf16 v[240:243], v[36:39], v[64:67], v[240:243]
    v_mfma_f32_16x16x32_bf16 v[148:151], v[40:43], v[52:55], v[148:151]
    v_mfma_f32_16x16x32_bf16 v[180:183], v[40:43], v[56:59], v[180:183]
    v_mfma_f32_16x16x32_bf16 v[212:215], v[40:43], v[60:63], v[212:215]
    v_mfma_f32_16x16x32_bf16 v[244:247], v[40:43], v[64:67], v[244:247]
    v_mfma_f32_16x16x32_bf16 v[152:155], v[44:47], v[52:55], v[152:155]
    v_mfma_f32_16x16x32_bf16 v[184:187], v[44:47], v[56:59], v[184:187]
    v_mfma_f32_16x16x32_bf16 v[216:219], v[44:47], v[60:63], v[216:219]
    v_mfma_f32_16x16x32_bf16 v[248:251], v[44:47], v[64:67], v[248:251]
    v_mfma_f32_16x16x32_bf16 v[156:159], v[48:51], v[52:55], v[156:159]
    v_mfma_f32_16x16x32_bf16 v[188:191], v[48:51], v[56:59], v[188:191]
    v_mfma_f32_16x16x32_bf16 v[220:223], v[48:51], v[60:63], v[220:223]
    v_mfma_f32_16x16x32_bf16 v[252:255], v[48:51], v[64:67], v[252:255]
    s_cmp_lt_u32 s35, s44
    s_cbranch_scc1 L_recurrent_scan__compressed_kv_cla__moe_arch_mod__prompt_kernel_w0_27
    s_waitcnt vmcnt(1)
L_recurrent_scan__compressed_kv_cla__moe_arch_mod__prompt_kernel_w0b_28:
    s_waitcnt lgkmcnt(0)
    s_barrier
    s_add_u32 m0, s33, 0
    s_nop 0
    buffer_load_dwordx4 v2, s[4:7], s31 offen offset:0 lds
    buffer_load_dwordx4 v3, s[4:7], s31 offen offset:1024 lds
    buffer_load_dwordx4 v4, s[4:7], s31 offen offset:2048 lds
    buffer_load_dwordx4 v5, s[4:7], s31 offen offset:3072 lds
    s_add_u32 m0, s34, 0
    s_nop 0
    buffer_load_dwordx4 v6, s[8:11], s32 offen offset:0 nt lds
    buffer_load_dwordx4 v7, s[8:11], s32 offen offset:1024 nt lds
    buffer_load_dwordx4 v8, s[8:11], s32 offen offset:2048 nt lds
    buffer_load_dwordx4 v9, s[8:11], s32 offen offset:3072 nt lds
    s_add_u32 s31, s31, s40
    s_add_u32 s32, s32, s41
    s_cmp_eq_u32 s35, 0
    s_cbranch_scc1 L_recurrent_scan__compressed_kv_cla__moe_arch_mod__prompt_kernel_rare_32
L_recurrent_scan__compressed_kv_cla__moe_arch_mod__prompt_kernel_back_33:
    v_mfma_f32_16x16x32_bf16 v[128:131], v[68:71], v[100:103], v[128:131]
    ds_read_b128 v[20:23], v10 offset:32768
    v_mfma_f32_16x16x32_bf16 v[160:163], v[68:71], v[104:107], v[160:163]
    ds_read_b64_tr_b16 v[52:53], v12 offset:32768
    v_mfma_f32_16x16x32_bf16 v[192:195], v[68:71], v[108:111], v[192:195]
    ds_read_b64_tr_b16 v[54:55], v12 offset:33792
    v_mfma_f32_16x16x32_bf16 v[224:227], v[68:71], v[112:115], v[224:227]
    ds_read_b64_tr_b16 v[56:57], v13 offset:32768
    v_mfma_f32_16x16x32_bf16 v[132:135], v[72:75], v[100:103], v[132:135]
    ds_read_b64_tr_b16 v[58:59], v13 offset:33792
    v_mfma_f32_16x16x32_bf16 v[164:167], v[72:75], v[104:107], v[164:167]
    ds_read_b64_tr_b16 v[60:61], v14 offset:32768
    v_mfma_f32_16x16x32_bf16 v[196:199], v[72:75], v[108:111], v[196:199]
    ds_read_b64_tr_b16 v[62:63], v14 offset:33792
    v_mfma_f32_16x16x32_bf16 v[228:231], v[72:75], v[112:115], v[228:231]
    ds_read_b64_tr_b16 v[64:65], v15 offset:32768
    v_mfma_f32_16x16x32_bf16 v[136:139], v[76:79], v[100:103], v[136:139]
    ds_read_b64_tr_b16 v[66:67], v15 offset:33792
    v_mfma_f32_16x16x32_bf16 v[168:171], v[76:79], v[104:107], v[168:171]
    ds_read_b128 v[24:27], v10 offset:34816
    v_mfma_f32_16x16x32_bf16 v[200:203], v[76:79], v[108:111], v[200:203]
    ds_read_b128 v[28:31], v10 offset:36864
    v_mfma_f32_16x16x32_bf16 v[232:235], v[76:79], v[112:115], v[232:235]
    ds_read_b128 v[32:35], v10 offset:38912
    v_mfma_f32_16x16x32_bf16 v[140:143], v[80:83], v[100:103], v[140:143]
    ds_read_b128 v[36:39], v10 offset:40960
    v_mfma_f32_16x16x32_bf16 v[172:175], v[80:83], v[104:107], v[172:175]
    ds_read_b128 v[40:43], v10 offset:43008
    v_mfma_f32_16x16x32_bf16 v[204:207], v[80:83], v[108:111], v[204:207]
    ds_read_b128 v[44:47], v10 offset:45056
    v_mfma_f32_16x16x32_bf16 v[236:239], v[80:83], v[112:115], v[236:239]
    ds_read_b128 v[48:51], v10 offset:47104
    v_mfma_f32_16x16x32_bf16 v[144:147], v[84:87], v[100:103], v[144:147]
    v_mfma_f32_16x16x32_bf16 v[176:179], v[84:87], v[104:107], v[176:179]
    v_mfma_f32_16x16x32_bf16 v[208:211], v[84:87], v[108:111], v[208:211]
    v_mfma_f32_16x16x32_bf16 v[240:243], v[84:87], v[112:115], v[240:243]
    v_mfma_f32_16x16x32_bf16 v[148:151], v[88:91], v[100:103], v[148:151]
    v_mfma_f32_16x16x32_bf16 v[180:183], v[88:91], v[104:107], v[180:183]
    v_mfma_f32_16x16x32_bf16 v[212:215], v[88:91], v[108:111], v[212:215]
    v_mfma_f32_16x16x32_bf16 v[244:247], v[88:91], v[112:115], v[244:247]
    v_mfma_f32_16x16x32_bf16 v[152:155], v[92:95], v[100:103], v[152:155]
    v_mfma_f32_16x16x32_bf16 v[184:187], v[92:95], v[104:107], v[184:187]
    v_mfma_f32_16x16x32_bf16 v[216:219], v[92:95], v[108:111], v[216:219]
    v_mfma_f32_16x16x32_bf16 v[248:251], v[92:95], v[112:115], v[248:251]
    v_mfma_f32_16x16x32_bf16 v[156:159], v[96:99], v[100:103], v[156:159]
    v_mfma_f32_16x16x32_bf16 v[188:191], v[96:99], v[104:107], v[188:191]
    v_mfma_f32_16x16x32_bf16 v[220:223], v[96:99], v[108:111], v[220:223]
    v_mfma_f32_16x16x32_bf16 v[252:255], v[96:99], v[112:115], v[252:255]
    s_bitcmp1_b32 6, s35
    s_cselect_b32 exec_lo, 255, 1
    s_mov_b32 exec_hi, 0
    global_load_dword v0, v17, s[96:97]
    s_mov_b64 exec, -1
    s_cselect_b32 s36, s45, 0
    v_add_u32 v17, s36, v17
    v_min_u32 v17, 8388480, v17
    s_nop 1
    s_waitcnt lgkmcnt(0)
    v_mfma_f32_16x16x32_bf16 v[128:131], v[20:23], v[52:55], v[128:131]
    ds_read_b128 v[68:71], v11 offset:32768
    v_mfma_f32_16x16x32_bf16 v[160:163], v[20:23], v[56:59], v[160:163]
    ds_read_b64_tr_b16 v[100:101], v12 offset:40960
    v_mfma_f32_16x16x32_bf16 v[192:195], v[20:23], v[60:63], v[192:195]
    ds_read_b64_tr_b16 v[102:103], v12 offset:41984
    v_mfma_f32_16x16x32_bf16 v[224:227], v[20:23], v[64:67], v[224:227]
    ds_read_b64_tr_b16 v[104:105], v13 offset:40960
    v_mfma_f32_16x16x32_bf16 v[132:135], v[24:27], v[52:55], v[132:135]
    ds_read_b64_tr_b16 v[106:107], v13 offset:41984
    v_mfma_f32_16x16x32_bf16 v[164:167], v[24:27], v[56:59], v[164:167]
    ds_read_b64_tr_b16 v[108:109], v14 offset:40960
    v_mfma_f32_16x16x32_bf16 v[196:199], v[24:27], v[60:63], v[196:199]
    ds_read_b64_tr_b16 v[110:111], v14 offset:41984
    v_mfma_f32_16x16x32_bf16 v[228:231], v[24:27], v[64:67], v[228:231]
    ds_read_b64_tr_b16 v[112:113], v15 offset:40960
    v_mfma_f32_16x16x32_bf16 v[136:139], v[28:31], v[52:55], v[136:139]
    ds_read_b64_tr_b16 v[114:115], v15 offset:41984
    v_mfma_f32_16x16x32_bf16 v[168:171], v[28:31], v[56:59], v[168:171]
    ds_read_b128 v[72:75], v11 offset:34816
    v_mfma_f32_16x16x32_bf16 v[200:203], v[28:31], v[60:63], v[200:203]
    ds_read_b128 v[76:79], v11 offset:36864
    v_mfma_f32_16x16x32_bf16 v[232:235], v[28:31], v[64:67], v[232:235]
    ds_read_b128 v[80:83], v11 offset:38912
    v_mfma_f32_16x16x32_bf16 v[140:143], v[32:35], v[52:55], v[140:143]
    ds_read_b128 v[84:87], v11 offset:40960
    v_mfma_f32_16x16x32_bf16 v[172:175], v[32:35], v[56:59], v[172:175]
    ds_read_b128 v[88:91], v11 offset:43008
    v_mfma_f32_16x16x32_bf16 v[204:207], v[32:35], v[60:63], v[204:207]
    ds_read_b128 v[92:95], v11 offset:45056
    v_mfma_f32_16x16x32_bf16 v[236:239], v[32:35], v[64:67], v[236:239]
    ds_read_b128 v[96:99], v11 offset:47104
    v_mfma_f32_16x16x32_bf16 v[144:147], v[36:39], v[52:55], v[144:147]
    v_mfma_f32_16x16x32_bf16 v[176:179], v[36:39], v[56:59], v[176:179]
    v_mfma_f32_16x16x32_bf16 v[208:211], v[36:39], v[60:63], v[208:211]
    v_mfma_f32_16x16x32_bf16 v[240:243], v[36:39], v[64:67], v[240:243]
    v_mfma_f32_16x16x32_bf16 v[148:151], v[40:43], v[52:55], v[148:151]
    v_mfma_f32_16x16x32_bf16 v[180:183], v[40:43], v[56:59], v[180:183]
    v_mfma_f32_16x16x32_bf16 v[212:215], v[40:43], v[60:63], v[212:215]
    v_mfma_f32_16x16x32_bf16 v[244:247], v[40:43], v[64:67], v[244:247]
    v_mfma_f32_16x16x32_bf16 v[152:155], v[44:47], v[52:55], v[152:155]
    v_mfma_f32_16x16x32_bf16 v[184:187], v[44:47], v[56:59], v[184:187]
    v_mfma_f32_16x16x32_bf16 v[216:219], v[44:47], v[60:63], v[216:219]
    v_mfma_f32_16x16x32_bf16 v[248:251], v[44:47], v[64:67], v[248:251]
    v_mfma_f32_16x16x32_bf16 v[156:159], v[48:51], v[52:55], v[156:159]
    v_mfma_f32_16x16x32_bf16 v[188:191], v[48:51], v[56:59], v[188:191]
    v_mfma_f32_16x16x32_bf16 v[220:223], v[48:51], v[60:63], v[220:223]
    v_mfma_f32_16x16x32_bf16 v[252:255], v[48:51], v[64:67], v[252:255]
    s_waitcnt vmcnt(1) lgkmcnt(0)
    s_cmp_eq_u32 s35, 3
    s_barrier
    s_cbranch_scc1 L_p1_fin1
    s_add_u32 m0, s33, 32768
    s_nop 0
    buffer_load_dwordx4 v2, s[4:7], s31 offen offset:0 lds
    buffer_load_dwordx4 v3, s[4:7], s31 offen offset:1024 lds
    buffer_load_dwordx4 v4, s[4:7], s31 offen offset:2048 lds
    buffer_load_dwordx4 v5, s[4:7], s31 offen offset:3072 lds
    s_add_u32 m0, s34, 32768
    s_nop 0
    buffer_load_dwordx4 v6, s[8:11], s32 offen offset:0 nt lds
    buffer_load_dwordx4 v7, s[8:11], s32 offen offset:1024 nt lds
    buffer_load_dwordx4 v8, s[8:11], s32 offen offset:2048 nt lds
    buffer_load_dwordx4 v9, s[8:11], s32 offen offset:3072 nt lds
    s_add_u32 s31, s31, s40
    s_add_u32 s32, s32, s41
    s_cmp_eq_u32 s35, 2
    s_cbranch_scc1 L_recurrent_scan__compressed_kv_cla__moe_arch_mod__prompt_kernel_rare_36
L_recurrent_scan__compressed_kv_cla__moe_arch_mod__prompt_kernel_back_37:
    v_mfma_f32_16x16x32_bf16 v[128:131], v[68:71], v[100:103], v[128:131]
    ds_read_b128 v[20:23], v10 offset:0
    v_mfma_f32_16x16x32_bf16 v[160:163], v[68:71], v[104:107], v[160:163]
    ds_read_b64_tr_b16 v[52:53], v12 offset:0
    v_mfma_f32_16x16x32_bf16 v[192:195], v[68:71], v[108:111], v[192:195]
    ds_read_b64_tr_b16 v[54:55], v12 offset:1024
    v_mfma_f32_16x16x32_bf16 v[224:227], v[68:71], v[112:115], v[224:227]
    ds_read_b64_tr_b16 v[56:57], v13 offset:0
    v_mfma_f32_16x16x32_bf16 v[132:135], v[72:75], v[100:103], v[132:135]
    ds_read_b64_tr_b16 v[58:59], v13 offset:1024
    v_mfma_f32_16x16x32_bf16 v[164:167], v[72:75], v[104:107], v[164:167]
    ds_read_b64_tr_b16 v[60:61], v14 offset:0
    v_mfma_f32_16x16x32_bf16 v[196:199], v[72:75], v[108:111], v[196:199]
    ds_read_b64_tr_b16 v[62:63], v14 offset:1024
    v_mfma_f32_16x16x32_bf16 v[228:231], v[72:75], v[112:115], v[228:231]
    ds_read_b64_tr_b16 v[64:65], v15 offset:0
    v_mfma_f32_16x16x32_bf16 v[136:139], v[76:79], v[100:103], v[136:139]
    ds_read_b64_tr_b16 v[66:67], v15 offset:1024
    v_mfma_f32_16x16x32_bf16 v[168:171], v[76:79], v[104:107], v[168:171]
    ds_read_b128 v[24:27], v10 offset:2048
    v_mfma_f32_16x16x32_bf16 v[200:203], v[76:79], v[108:111], v[200:203]
    ds_read_b128 v[28:31], v10 offset:4096
    v_mfma_f32_16x16x32_bf16 v[232:235], v[76:79], v[112:115], v[232:235]
    ds_read_b128 v[32:35], v10 offset:6144
    v_mfma_f32_16x16x32_bf16 v[140:143], v[80:83], v[100:103], v[140:143]
    ds_read_b128 v[36:39], v10 offset:8192
    v_mfma_f32_16x16x32_bf16 v[172:175], v[80:83], v[104:107], v[172:175]
    ds_read_b128 v[40:43], v10 offset:10240
    v_mfma_f32_16x16x32_bf16 v[204:207], v[80:83], v[108:111], v[204:207]
    ds_read_b128 v[44:47], v10 offset:12288
    v_mfma_f32_16x16x32_bf16 v[236:239], v[80:83], v[112:115], v[236:239]
    ds_read_b128 v[48:51], v10 offset:14336
    v_mfma_f32_16x16x32_bf16 v[144:147], v[84:87], v[100:103], v[144:147]
    v_mfma_f32_16x16x32_bf16 v[176:179], v[84:87], v[104:107], v[176:179]
    v_mfma_f32_16x16x32_bf16 v[208:211], v[84:87], v[108:111], v[208:211]
    v_mfma_f32_16x16x32_bf16 v[240:243], v[84:87], v[112:115], v[240:243]
    v_mfma_f32_16x16x32_bf16 v[148:151], v[88:91], v[100:103], v[148:151]
    v_mfma_f32_16x16x32_bf16 v[180:183], v[88:91], v[104:107], v[180:183]
    v_mfma_f32_16x16x32_bf16 v[212:215], v[88:91], v[108:111], v[212:215]
    v_mfma_f32_16x16x32_bf16 v[244:247], v[88:91], v[112:115], v[244:247]
    v_mfma_f32_16x16x32_bf16 v[152:155], v[92:95], v[100:103], v[152:155]
    v_mfma_f32_16x16x32_bf16 v[184:187], v[92:95], v[104:107], v[184:187]
    v_mfma_f32_16x16x32_bf16 v[216:219], v[92:95], v[108:111], v[216:219]
    v_mfma_f32_16x16x32_bf16 v[248:251], v[92:95], v[112:115], v[248:251]
    v_mfma_f32_16x16x32_bf16 v[156:159], v[96:99], v[100:103], v[156:159]
    v_mfma_f32_16x16x32_bf16 v[188:191], v[96:99], v[104:107], v[188:191]
    v_mfma_f32_16x16x32_bf16 v[220:223], v[96:99], v[108:111], v[220:223]
    v_mfma_f32_16x16x32_bf16 v[252:255], v[96:99], v[112:115], v[252:255]
    s_bitcmp1_b32 3, s35
    s_cselect_b32 exec_lo, 255, 1
    s_mov_b32 exec_hi, 0
    global_load_dword v0, v17, s[96:97]
    s_mov_b64 exec, -1
    s_cselect_b32 s36, s45, 0
    v_add_u32 v17, s36, v17
    v_min_u32 v17, 8388480, v17
    s_nop 1
    s_add_u32 s35, s35, 1
    s_branch L_kv_vloop
L_p1_fin1:
    s_and_b32 s36, s28, 3
    s_sub_u32 s37, 15, s30
    s_cmp_lt_u32 s28, 4
    s_cselect_b32 s37, s37, s30
    s_lshl_b32 s37, s37, 2
    s_add_u32 s37, s37, s36
    s_lshl_b32 s37, s37, 16
    v_lshl_add_u32 v6, v1, 4, s37
    v_add_u32 v7, 32768, v6
    s_mov_b32 s32, 0
    s_mov_b32 s8, s54
    s_and_b32 s9, s55, 0xffff
    s_mov_b32 s10, 104857728
    s_mov_b32 s11, 0x20000
    v_mfma_f32_16x16x32_bf16 v[128:131], v[68:71], v[100:103], v[128:131]
    v_mfma_f32_16x16x32_bf16 v[160:163], v[68:71], v[104:107], v[160:163]
    buffer_load_dwordx4 v[24:27], v6, s[8:11], s32 offen offset:0 sc1
    v_mfma_f32_16x16x32_bf16 v[192:195], v[68:71], v[108:111], v[192:195]
    v_lshrrev_b32 v18, 4, v1
    v_mfma_f32_16x16x32_bf16 v[224:227], v[68:71], v[112:115], v[224:227]
    v_bfe_u32 v20, v1, 2, 2
    v_mfma_f32_16x16x32_bf16 v[132:135], v[72:75], v[100:103], v[132:135]
    v_lshl_add_u32 v19, v18, 3, v20
    v_mfma_f32_16x16x32_bf16 v[164:167], v[72:75], v[104:107], v[164:167]
    buffer_load_dwordx4 v[28:31], v7, s[8:11], s32 offen offset:0 sc1
    v_lshlrev_b32 v19, 8, v19
    v_mfma_f32_16x16x32_bf16 v[196:199], v[72:75], v[108:111], v[196:199]
    v_and_b32 v21, 3, v1
    v_mfma_f32_16x16x32_bf16 v[228:231], v[72:75], v[112:115], v[228:231]
    v_lshl_add_u32 v19, v21, 3, v19
    v_mfma_f32_16x16x32_bf16 v[136:139], v[76:79], v[100:103], v[136:139]
    v_and_b32 v21, 1, v18
    v_mfma_f32_16x16x32_bf16 v[168:171], v[76:79], v[104:107], v[168:171]
    buffer_load_dwordx4 v[32:35], v6, s[8:11], s32 offen offset:1024 sc1
    v_lshl_add_u32 v20, v21, 2, v20
    v_mfma_f32_16x16x32_bf16 v[200:203], v[76:79], v[108:111], v[200:203]
    v_xor_b32 v21, 0, v20
    v_mfma_f32_16x16x32_bf16 v[232:235], v[76:79], v[112:115], v[232:235]
    v_lshl_add_u32 v10, v21, 5, v19
    v_mfma_f32_16x16x32_bf16 v[140:143], v[80:83], v[100:103], v[140:143]
    v_xor_b32 v21, 1, v20
    v_mfma_f32_16x16x32_bf16 v[172:175], v[80:83], v[104:107], v[172:175]
    buffer_load_dwordx4 v[36:39], v7, s[8:11], s32 offen offset:1024 sc1
    v_lshl_add_u32 v11, v21, 5, v19
    v_mfma_f32_16x16x32_bf16 v[204:207], v[80:83], v[108:111], v[204:207]
    v_xor_b32 v21, 2, v20
    v_mfma_f32_16x16x32_bf16 v[236:239], v[80:83], v[112:115], v[236:239]
    v_lshl_add_u32 v12, v21, 5, v19
    v_mfma_f32_16x16x32_bf16 v[144:147], v[84:87], v[100:103], v[144:147]
    v_xor_b32 v21, 3, v20
    v_mfma_f32_16x16x32_bf16 v[176:179], v[84:87], v[104:107], v[176:179]
    buffer_load_dwordx4 v[40:43], v6, s[8:11], s32 offen offset:2048 sc1
    v_lshl_add_u32 v13, v21, 5, v19
    v_mfma_f32_16x16x32_bf16 v[208:211], v[84:87], v[108:111], v[208:211]
    v_xor_b32 v21, 4, v20
    v_mfma_f32_16x16x32_bf16 v[240:243], v[84:87], v[112:115], v[240:243]
    v_lshl_add_u32 v14, v21, 5, v19
    v_mfma_f32_16x16x32_bf16 v[148:151], v[88:91], v[100:103], v[148:151]
    v_xor_b32 v21, 5, v20
    v_mfma_f32_16x16x32_bf16 v[180:183], v[88:91], v[104:107], v[180:183]
    buffer_load_dwordx4 v[44:47], v7, s[8:11], s32 offen offset:2048 sc1
    v_lshl_add_u32 v15, v21, 5, v19
    v_mfma_f32_16x16x32_bf16 v[212:215], v[88:91], v[108:111], v[212:215]
    v_xor_b32 v21, 6, v20
    v_mfma_f32_16x16x32_bf16 v[244:247], v[88:91], v[112:115], v[244:247]
    v_lshl_add_u32 v16, v21, 5, v19
    v_mfma_f32_16x16x32_bf16 v[152:155], v[92:95], v[100:103], v[152:155]
    v_xor_b32 v21, 7, v20
    v_mfma_f32_16x16x32_bf16 v[184:187], v[92:95], v[104:107], v[184:187]
    buffer_load_dwordx4 v[48:51], v6, s[8:11], s32 offen offset:3072 sc1
    v_lshl_add_u32 v17, v21, 5, v19
    v_mfma_f32_16x16x32_bf16 v[216:219], v[92:95], v[108:111], v[216:219]
    s_lshl_b32 s45, s29, 20
    v_mfma_f32_16x16x32_bf16 v[248:251], v[92:95], v[112:115], v[248:251]
    v_mfma_f32_16x16x32_bf16 v[156:159], v[96:99], v[100:103], v[156:159]
    v_mfma_f32_16x16x32_bf16 v[188:191], v[96:99], v[104:107], v[188:191]
    buffer_load_dwordx4 v[52:55], v7, s[8:11], s32 offen offset:3072 sc1
    v_mfma_f32_16x16x32_bf16 v[220:223], v[96:99], v[108:111], v[220:223]
    v_mfma_f32_16x16x32_bf16 v[252:255], v[96:99], v[112:115], v[252:255]
L_p1_done:
    s_waitcnt vmcnt(8)
    ds_read_b64_tr_b16 v[64:65], v10 offset:0
    ds_read_b64_tr_b16 v[66:67], v10 offset:1024
    ds_read_b64_tr_b16 v[68:69], v11 offset:0
    ds_read_b64_tr_b16 v[70:71], v11 offset:1024
    ds_read_b64_tr_b16 v[72:73], v12 offset:0
    ds_read_b64_tr_b16 v[74:75], v12 offset:1024
    ds_read_b64_tr_b16 v[76:77], v13 offset:0
    ds_read_b64_tr_b16 v[78:79], v13 offset:1024
    ds_read_b64_tr_b16 v[80:81], v14 offset:0
    ds_read_b64_tr_b16 v[82:83], v14 offset:1024
    ds_read_b64_tr_b16 v[84:85], v15 offset:0
    ds_read_b64_tr_b16 v[86:87], v15 offset:1024
    s_add_u32 m0, s33, 32768
    s_add_u32 s32, s32, 4096
    v_cvt_pk_bf16_f32 v128, v128, v129
    v_cvt_pk_bf16_f32 v129, v130, v131
    v_cvt_pk_bf16_f32 v130, v132, v133
    v_cvt_pk_bf16_f32 v131, v134, v135
    v_cvt_pk_bf16_f32 v132, v136, v137
    v_cvt_pk_bf16_f32 v133, v138, v139
    buffer_load_dwordx4 v2, s[4:7], s31 offen offset:0 lds
    v_cvt_pk_bf16_f32 v134, v140, v141
    v_cvt_pk_bf16_f32 v135, v142, v143
    v_cvt_pk_bf16_f32 v136, v144, v145
    v_cvt_pk_bf16_f32 v137, v146, v147
    v_cvt_pk_bf16_f32 v138, v148, v149
    v_cvt_pk_bf16_f32 v139, v150, v151
    buffer_load_dwordx4 v3, s[4:7], s31 offen offset:1024 lds
    v_cvt_pk_bf16_f32 v140, v152, v153
    v_cvt_pk_bf16_f32 v141, v154, v155
    v_cvt_pk_bf16_f32 v142, v156, v157
    v_cvt_pk_bf16_f32 v143, v158, v159
    v_cvt_pk_bf16_f32 v144, v160, v161
    v_cvt_pk_bf16_f32 v145, v162, v163
    buffer_load_dwordx4 v4, s[4:7], s31 offen offset:2048 lds
    v_cvt_pk_bf16_f32 v146, v164, v165
    v_cvt_pk_bf16_f32 v147, v166, v167
    v_cvt_pk_bf16_f32 v148, v168, v169
    v_cvt_pk_bf16_f32 v149, v170, v171
    v_cvt_pk_bf16_f32 v150, v172, v173
    v_cvt_pk_bf16_f32 v151, v174, v175
    buffer_load_dwordx4 v5, s[4:7], s31 offen offset:3072 lds
    v_cvt_pk_bf16_f32 v152, v176, v177
    v_cvt_pk_bf16_f32 v153, v178, v179
    v_cvt_pk_bf16_f32 v154, v180, v181
    v_cvt_pk_bf16_f32 v155, v182, v183
    v_cvt_pk_bf16_f32 v156, v184, v185
    v_cvt_pk_bf16_f32 v157, v186, v187
    s_mov_b32 s31, 3145728
    s_add_u32 s34, s33, 98304
    v_cvt_pk_bf16_f32 v158, v188, v189
    v_cvt_pk_bf16_f32 v159, v190, v191
    v_cvt_pk_bf16_f32 v160, v192, v193
    v_cvt_pk_bf16_f32 v161, v194, v195
    v_cvt_pk_bf16_f32 v162, v196, v197
    v_cvt_pk_bf16_f32 v163, v198, v199
    buffer_load_dwordx4 v[96:99], v6, s[8:11], s32 offen offset:0 sc1
    v_cvt_pk_bf16_f32 v164, v200, v201
    v_cvt_pk_bf16_f32 v165, v202, v203
    v_cvt_pk_bf16_f32 v166, v204, v205
    v_cvt_pk_bf16_f32 v167, v206, v207
    v_cvt_pk_bf16_f32 v168, v208, v209
    v_cvt_pk_bf16_f32 v169, v210, v211
    buffer_load_dwordx4 v[100:103], v7, s[8:11], s32 offen offset:0 sc1
    v_cvt_pk_bf16_f32 v170, v212, v213
    v_cvt_pk_bf16_f32 v171, v214, v215
    v_cvt_pk_bf16_f32 v172, v216, v217
    v_cvt_pk_bf16_f32 v173, v218, v219
    v_cvt_pk_bf16_f32 v174, v220, v221
    v_cvt_pk_bf16_f32 v175, v222, v223
    buffer_load_dwordx4 v[104:107], v6, s[8:11], s32 offen offset:1024 sc1
    v_cvt_pk_bf16_f32 v176, v224, v225
    v_cvt_pk_bf16_f32 v177, v226, v227
    v_cvt_pk_bf16_f32 v178, v228, v229
    v_cvt_pk_bf16_f32 v179, v230, v231
    v_cvt_pk_bf16_f32 v180, v232, v233
    v_cvt_pk_bf16_f32 v181, v234, v235
    buffer_load_dwordx4 v[108:111], v7, s[8:11], s32 offen offset:1024 sc1
    v_cvt_pk_bf16_f32 v182, v236, v237
    v_cvt_pk_bf16_f32 v183, v238, v239
    v_cvt_pk_bf16_f32 v184, v240, v241
    v_cvt_pk_bf16_f32 v185, v242, v243
    v_cvt_pk_bf16_f32 v186, v244, v245
    v_cvt_pk_bf16_f32 v187, v246, v247
    buffer_load_dwordx4 v[112:115], v6, s[8:11], s32 offen offset:2048 sc1
    v_cvt_pk_bf16_f32 v188, v248, v249
    v_cvt_pk_bf16_f32 v189, v250, v251
    v_cvt_pk_bf16_f32 v190, v252, v253
    v_cvt_pk_bf16_f32 v191, v254, v255
    s_lshl_b32 s38, s29, 20
    s_lshl_b32 s37, s30, 17
    s_add_u32 s38, s38, s37
    s_bfe_u32 s37, s28, 0x10001
    s_lshl_b32 s37, s37, 16
    s_add_u32 s38, s38, s37
    s_lshr_b32 s36, s28, 2
    s_lshl_b32 s37, s36, 15
    s_add_u32 s38, s38, s37
    s_and_b32 s37, s28, 1
    s_add_u32 s36, s36, 11
    s_lshl_b32 s37, s37, s36
    s_add_u32 s38, s38, s37
    s_cmp_lt_u32 s28, 4
    s_cselect_b32 s36, 4, 32
    s_cselect_b32 s37, 16, 64
    s_cselect_b32 s39, 32, 4
    s_lshl_b32 s36, s36, 8
    s_lshl_b32 s37, s37, 8
    s_lshl_b32 s39, s39, 8
    s_mov_b64 s[16:17], s[12:13]
    s_mov_b64 s[18:19], s[14:15]
    s_cmp_eq_u32 s30, 0
    s_cselect_b32 s52, 2, 4
    v_lshlrev_b32 v58, 4, v1
    v_add_u32 v59, s36, v58
    v_add_u32 v60, s37, v58
    v_add_u32 v61, s36, v60
    v_mov_b64 v[192:193], 0
    v_mov_b64 v[194:195], 0
    v_mov_b64 v[196:197], 0
    v_mov_b64 v[198:199], 0
    v_mov_b64 v[200:201], 0
    v_mov_b64 v[202:203], 0
    v_mov_b64 v[204:205], 0
    v_mov_b64 v[206:207], 0
    v_mov_b64 v[208:209], 0
    v_mov_b64 v[210:211], 0
    v_mov_b64 v[212:213], 0
    v_mov_b64 v[214:215], 0
    v_mov_b64 v[216:217], 0
    v_mov_b64 v[218:219], 0
    v_mov_b64 v[220:221], 0
    v_mov_b64 v[222:223], 0
    v_mov_b64 v[224:225], 0
    v_mov_b64 v[226:227], 0
    v_mov_b64 v[228:229], 0
    v_mov_b64 v[230:231], 0
    v_mov_b64 v[232:233], 0
    v_mov_b64 v[234:235], 0
    v_mov_b64 v[236:237], 0
    v_mov_b64 v[238:239], 0
    v_mov_b64 v[240:241], 0
    v_mov_b64 v[242:243], 0
    v_mov_b64 v[244:245], 0
    v_mov_b64 v[246:247], 0
    v_mov_b64 v[248:249], 0
    v_mov_b64 v[250:251], 0
    v_mov_b64 v[252:253], 0
    v_mov_b64 v[254:255], 0
    buffer_load_dwordx4 v[116:119], v7, s[8:11], s32 offen offset:2048 sc1
    s_mov_b32 s35, 0
    s_mov_b32 s41, 0x1ffff
    s_waitcnt vmcnt(10)
    s_cmp_eq_u32 s30, 0
    s_cbranch_scc1 L_recurrent_scan__compressed_kv_cla__moe_arch_mod__prompt_kernel_rare_55
L_recurrent_scan__compressed_kv_cla__moe_arch_mod__prompt_kernel_back_56:
    .p2align 6
L_p2_loop:
    s_cmp_eq_u32 s35, 3
    s_cbranch_scc1 L_recurrent_scan__compressed_kv_cla__moe_arch_mod__prompt_kernel_rare_47
L_recurrent_scan__compressed_kv_cla__moe_arch_mod__prompt_kernel_back_48:
    s_waitcnt lgkmcnt(8)
    s_waitcnt vmcnt(22)
    v_mfma_f32_16x16x32_bf16 v[192:195], v[64:67], v[24:27], v[192:195]
    ds_read_b64_tr_b16 v[88:89], v16 offset:0
    v_mfma_f32_16x16x32_bf16 v[224:227], v[64:67], v[28:31], v[224:227]
    ds_read_b64_tr_b16 v[90:91], v16 offset:1024
    v_mfma_f32_16x16x32_bf16 v[196:199], v[68:71], v[24:27], v[196:199]
    ds_read_b64_tr_b16 v[92:93], v17 offset:0
    buffer_load_dwordx4 v[120:123], v6, s[8:11], s32 offen offset:3072 sc1
    v_mfma_f32_16x16x32_bf16 v[228:231], v[68:71], v[28:31], v[228:231]
    ds_read_b64_tr_b16 v[94:95], v17 offset:1024
    s_waitcnt lgkmcnt(8)
    v_mfma_f32_16x16x32_bf16 v[200:203], v[72:75], v[24:27], v[200:203]
    ds_read_b64_tr_b16 v[64:65], v10 offset:8192
    v_mfma_f32_16x16x32_bf16 v[232:235], v[72:75], v[28:31], v[232:235]
    ds_read_b64_tr_b16 v[66:67], v10 offset:9216
    v_mfma_f32_16x16x32_bf16 v[204:207], v[76:79], v[24:27], v[204:207]
    ds_read_b64_tr_b16 v[68:69], v11 offset:8192
    buffer_load_dwordx4 v[124:127], v7, s[8:11], s32 offen offset:3072 sc1
    v_mfma_f32_16x16x32_bf16 v[236:239], v[76:79], v[28:31], v[236:239]
    ds_read_b64_tr_b16 v[70:71], v11 offset:9216
    s_add_u32 s32, s32, 4096
    s_cmp_lt_u32 s35, s52
    s_cselect_b32 s18, s18, 0
    s_waitcnt lgkmcnt(8)
    v_mfma_f32_16x16x32_bf16 v[208:211], v[80:83], v[24:27], v[208:211]
    ds_read_b64_tr_b16 v[72:73], v12 offset:8192
    s_cmp_lt_u32 s35, 3
    s_cselect_b32 s10, s10, 0
    v_mfma_f32_16x16x32_bf16 v[240:243], v[80:83], v[28:31], v[240:243]
    ds_read_b64_tr_b16 v[74:75], v12 offset:9216
    v_mfma_f32_16x16x32_bf16 v[212:215], v[84:87], v[24:27], v[212:215]
    ds_read_b64_tr_b16 v[76:77], v13 offset:8192
    buffer_store_dwordx4 v[128:131], v58, s[16:19], s38 offen sc1
    v_mfma_f32_16x16x32_bf16 v[244:247], v[84:87], v[28:31], v[244:247]
    ds_read_b64_tr_b16 v[78:79], v13 offset:9216
    s_mov_b32 m0, s34
    s_waitcnt lgkmcnt(8)
    v_mfma_f32_16x16x32_bf16 v[216:219], v[88:91], v[24:27], v[216:219]
    ds_read_b64_tr_b16 v[80:81], v14 offset:8192
    v_mov_b64 v[128:129], v[144:145]
    buffer_load_dwordx4 v2, s[4:7], s31 offen offset:0 sc1 lds
    v_mfma_f32_16x16x32_bf16 v[248:251], v[88:91], v[28:31], v[248:251]
    ds_read_b64_tr_b16 v[82:83], v14 offset:9216
    v_mfma_f32_16x16x32_bf16 v[220:223], v[92:95], v[24:27], v[220:223]
    ds_read_b64_tr_b16 v[84:85], v15 offset:8192
    v_mov_b64 v[130:131], v[146:147]
    v_mfma_f32_16x16x32_bf16 v[252:255], v[92:95], v[28:31], v[252:255]
    ds_read_b64_tr_b16 v[86:87], v15 offset:9216
    s_waitcnt lgkmcnt(8)
    s_waitcnt vmcnt(22)
    v_mfma_f32_16x16x32_bf16 v[192:195], v[64:67], v[32:35], v[192:195]
    ds_read_b64_tr_b16 v[88:89], v16 offset:8192
    v_mov_b64 v[144:145], v[160:161]
    v_mfma_f32_16x16x32_bf16 v[224:227], v[64:67], v[36:39], v[224:227]
    ds_read_b64_tr_b16 v[90:91], v16 offset:9216
    v_mfma_f32_16x16x32_bf16 v[196:199], v[68:71], v[32:35], v[196:199]
    ds_read_b64_tr_b16 v[92:93], v17 offset:8192
    buffer_load_dwordx4 v[24:27], v6, s[8:11], s32 offen offset:0 sc1
    v_mov_b64 v[146:147], v[162:163]
    v_mfma_f32_16x16x32_bf16 v[228:231], v[68:71], v[36:39], v[228:231]
    ds_read_b64_tr_b16 v[94:95], v17 offset:9216
    s_waitcnt lgkmcnt(8)
    v_mfma_f32_16x16x32_bf16 v[200:203], v[72:75], v[32:35], v[200:203]
    ds_read_b64_tr_b16 v[64:65], v10 offset:16384
    v_mov_b64 v[160:161], v[176:177]
    v_mfma_f32_16x16x32_bf16 v[232:235], v[72:75], v[36:39], v[232:235]
    ds_read_b64_tr_b16 v[66:67], v10 offset:17408
    v_mfma_f32_16x16x32_bf16 v[204:207], v[76:79], v[32:35], v[204:207]
    ds_read_b64_tr_b16 v[68:69], v11 offset:16384
    buffer_load_dwordx4 v[28:31], v7, s[8:11], s32 offen offset:0 sc1
    v_mov_b64 v[162:163], v[178:179]
    v_mfma_f32_16x16x32_bf16 v[236:239], v[76:79], v[36:39], v[236:239]
    ds_read_b64_tr_b16 v[70:71], v11 offset:17408
    s_waitcnt lgkmcnt(8)
    v_mfma_f32_16x16x32_bf16 v[208:211], v[80:83], v[32:35], v[208:211]
    ds_read_b64_tr_b16 v[72:73], v12 offset:16384
    v_mfma_f32_16x16x32_bf16 v[240:243], v[80:83], v[36:39], v[240:243]
    ds_read_b64_tr_b16 v[74:75], v12 offset:17408
    v_mfma_f32_16x16x32_bf16 v[212:215], v[84:87], v[32:35], v[212:215]
    ds_read_b64_tr_b16 v[76:77], v13 offset:16384
    v_mfma_f32_16x16x32_bf16 v[244:247], v[84:87], v[36:39], v[244:247]
    ds_read_b64_tr_b16 v[78:79], v13 offset:17408
    s_waitcnt lgkmcnt(8)
    v_mfma_f32_16x16x32_bf16 v[216:219], v[88:91], v[32:35], v[216:219]
    ds_read_b64_tr_b16 v[80:81], v14 offset:16384
    buffer_load_dwordx4 v3, s[4:7], s31 offen offset:1024 sc1 lds
    v_mfma_f32_16x16x32_bf16 v[248:251], v[88:91], v[36:39], v[248:251]
    ds_read_b64_tr_b16 v[82:83], v14 offset:17408
    v_mfma_f32_16x16x32_bf16 v[220:223], v[92:95], v[32:35], v[220:223]
    ds_read_b64_tr_b16 v[84:85], v15 offset:16384
    buffer_store_dwordx4 v[132:135], v59, s[16:19], s38 offen sc1
    v_mfma_f32_16x16x32_bf16 v[252:255], v[92:95], v[36:39], v[252:255]
    ds_read_b64_tr_b16 v[86:87], v15 offset:17408
    s_waitcnt lgkmcnt(8)
    s_waitcnt vmcnt(23)
    v_mfma_f32_16x16x32_bf16 v[192:195], v[64:67], v[40:43], v[192:195]
    ds_read_b64_tr_b16 v[88:89], v16 offset:16384
    v_mov_b64 v[132:133], v[148:149]
    v_mfma_f32_16x16x32_bf16 v[224:227], v[64:67], v[44:47], v[224:227]
    ds_read_b64_tr_b16 v[90:91], v16 offset:17408
    v_mfma_f32_16x16x32_bf16 v[196:199], v[68:71], v[40:43], v[196:199]
    ds_read_b64_tr_b16 v[92:93], v17 offset:16384
    buffer_load_dwordx4 v[32:35], v6, s[8:11], s32 offen offset:1024 sc1
    v_mov_b64 v[134:135], v[150:151]
    v_mfma_f32_16x16x32_bf16 v[228:231], v[68:71], v[44:47], v[228:231]
    ds_read_b64_tr_b16 v[94:95], v17 offset:17408
    s_waitcnt lgkmcnt(8)
    v_mfma_f32_16x16x32_bf16 v[200:203], v[72:75], v[40:43], v[200:203]
    ds_read_b64_tr_b16 v[64:65], v10 offset:24576
    v_mov_b64 v[148:149], v[164:165]
    v_mfma_f32_16x16x32_bf16 v[232:235], v[72:75], v[44:47], v[232:235]
    ds_read_b64_tr_b16 v[66:67], v10 offset:25600
    v_mfma_f32_16x16x32_bf16 v[204:207], v[76:79], v[40:43], v[204:207]
    ds_read_b64_tr_b16 v[68:69], v11 offset:24576
    buffer_load_dwordx4 v[36:39], v7, s[8:11], s32 offen offset:1024 sc1
    v_mov_b64 v[150:151], v[166:167]
    v_mfma_f32_16x16x32_bf16 v[236:239], v[76:79], v[44:47], v[236:239]
    ds_read_b64_tr_b16 v[70:71], v11 offset:25600
    s_waitcnt lgkmcnt(8)
    v_mfma_f32_16x16x32_bf16 v[208:211], v[80:83], v[40:43], v[208:211]
    ds_read_b64_tr_b16 v[72:73], v12 offset:24576
    v_mov_b64 v[164:165], v[180:181]
    v_mfma_f32_16x16x32_bf16 v[240:243], v[80:83], v[44:47], v[240:243]
    ds_read_b64_tr_b16 v[74:75], v12 offset:25600
    v_mfma_f32_16x16x32_bf16 v[212:215], v[84:87], v[40:43], v[212:215]
    ds_read_b64_tr_b16 v[76:77], v13 offset:24576
    v_mov_b64 v[166:167], v[182:183]
    v_mfma_f32_16x16x32_bf16 v[244:247], v[84:87], v[44:47], v[244:247]
    ds_read_b64_tr_b16 v[78:79], v13 offset:25600
    s_waitcnt lgkmcnt(8)
    v_mfma_f32_16x16x32_bf16 v[216:219], v[88:91], v[40:43], v[216:219]
    ds_read_b64_tr_b16 v[80:81], v14 offset:24576
    buffer_load_dwordx4 v4, s[4:7], s31 offen offset:2048 sc1 lds
    v_mfma_f32_16x16x32_bf16 v[248:251], v[88:91], v[44:47], v[248:251]
    ds_read_b64_tr_b16 v[82:83], v14 offset:25600
    v_mfma_f32_16x16x32_bf16 v[220:223], v[92:95], v[40:43], v[220:223]
    ds_read_b64_tr_b16 v[84:85], v15 offset:24576
    v_mfma_f32_16x16x32_bf16 v[252:255], v[92:95], v[44:47], v[252:255]
    ds_read_b64_tr_b16 v[86:87], v15 offset:25600
    s_waitcnt lgkmcnt(8)
    s_waitcnt vmcnt(23)
    v_mfma_f32_16x16x32_bf16 v[192:195], v[64:67], v[48:51], v[192:195]
    ds_read_b64_tr_b16 v[88:89], v16 offset:24576
    v_mfma_f32_16x16x32_bf16 v[224:227], v[64:67], v[52:55], v[224:227]
    ds_read_b64_tr_b16 v[90:91], v16 offset:25600
    v_mfma_f32_16x16x32_bf16 v[196:199], v[68:71], v[48:51], v[196:199]
    ds_read_b64_tr_b16 v[92:93], v17 offset:24576
    buffer_load_dwordx4 v[40:43], v6, s[8:11], s32 offen offset:2048 sc1
    v_mfma_f32_16x16x32_bf16 v[228:231], v[68:71], v[52:55], v[228:231]
    ds_read_b64_tr_b16 v[94:95], v17 offset:25600
    s_waitcnt lgkmcnt(8)
    v_mfma_f32_16x16x32_bf16 v[200:203], v[72:75], v[48:51], v[200:203]
    v_mfma_f32_16x16x32_bf16 v[232:235], v[72:75], v[52:55], v[232:235]
    v_mfma_f32_16x16x32_bf16 v[204:207], v[76:79], v[48:51], v[204:207]
    buffer_load_dwordx4 v[44:47], v7, s[8:11], s32 offen offset:2048 sc1
    v_mfma_f32_16x16x32_bf16 v[236:239], v[76:79], v[52:55], v[236:239]
    s_cmp_eq_u32 s35, 3
    s_cbranch_scc1 L_recurrent_scan__compressed_kv_cla__moe_arch_mod__prompt_kernel_rare_45
L_recurrent_scan__compressed_kv_cla__moe_arch_mod__prompt_kernel_back_46:
    s_waitcnt lgkmcnt(0)
    s_waitcnt vmcnt(19)
    s_cmp_eq_u32 s35, s52
    s_cbranch_scc1 L_recurrent_scan__compressed_kv_cla__moe_arch_mod__prompt_kernel_rare_53
L_recurrent_scan__compressed_kv_cla__moe_arch_mod__prompt_kernel_back_54:
    s_barrier
    v_mfma_f32_16x16x32_bf16 v[208:211], v[80:83], v[48:51], v[208:211]
    ds_read_b64_tr_b16 v[64:65], v10 offset:32768
    ds_read_b64_tr_b16 v[66:67], v10 offset:33792
    v_mfma_f32_16x16x32_bf16 v[240:243], v[80:83], v[52:55], v[240:243]
    ds_read_b64_tr_b16 v[68:69], v11 offset:32768
    ds_read_b64_tr_b16 v[70:71], v11 offset:33792
    v_mfma_f32_16x16x32_bf16 v[212:215], v[84:87], v[48:51], v[212:215]
    ds_read_b64_tr_b16 v[72:73], v12 offset:32768
    ds_read_b64_tr_b16 v[74:75], v12 offset:33792
    v_mfma_f32_16x16x32_bf16 v[244:247], v[84:87], v[52:55], v[244:247]
    ds_read_b64_tr_b16 v[76:77], v13 offset:32768
    ds_read_b64_tr_b16 v[78:79], v13 offset:33792
    v_mfma_f32_16x16x32_bf16 v[216:219], v[88:91], v[48:51], v[216:219]
    ds_read_b64_tr_b16 v[80:81], v14 offset:32768
    ds_read_b64_tr_b16 v[82:83], v14 offset:33792
    buffer_load_dwordx4 v5, s[4:7], s31 offen offset:3072 sc1 lds
    v_mfma_f32_16x16x32_bf16 v[248:251], v[88:91], v[52:55], v[248:251]
    s_add_u32 s31, s31, s40
    s_add_u32 s34, s34, 32768
    s_and_b32 s34, s34, s41
    v_mfma_f32_16x16x32_bf16 v[220:223], v[92:95], v[48:51], v[220:223]
    ds_read_b64_tr_b16 v[84:85], v15 offset:32768
    ds_read_b64_tr_b16 v[86:87], v15 offset:33792
    v_mfma_f32_16x16x32_bf16 v[252:255], v[92:95], v[52:55], v[252:255]
    s_cmp_ge_u32 s35, 2
    s_cbranch_scc1 L_recurrent_scan__compressed_kv_cla__moe_arch_mod__prompt_kernel_rare_51
L_recurrent_scan__compressed_kv_cla__moe_arch_mod__prompt_kernel_back_52:
    s_waitcnt lgkmcnt(8)
    s_waitcnt vmcnt(18)
    v_mfma_f32_16x16x32_bf16 v[192:195], v[64:67], v[96:99], v[192:195]
    ds_read_b64_tr_b16 v[88:89], v16 offset:32768
    v_mfma_f32_16x16x32_bf16 v[224:227], v[64:67], v[100:103], v[224:227]
    ds_read_b64_tr_b16 v[90:91], v16 offset:33792
    v_mfma_f32_16x16x32_bf16 v[196:199], v[68:71], v[96:99], v[196:199]
    ds_read_b64_tr_b16 v[92:93], v17 offset:32768
    buffer_load_dwordx4 v[48:51], v6, s[8:11], s32 offen offset:3072 sc1
    v_mfma_f32_16x16x32_bf16 v[228:231], v[68:71], v[100:103], v[228:231]
    ds_read_b64_tr_b16 v[94:95], v17 offset:33792
    s_waitcnt lgkmcnt(8)
    v_mfma_f32_16x16x32_bf16 v[200:203], v[72:75], v[96:99], v[200:203]
    ds_read_b64_tr_b16 v[64:65], v10 offset:40960
    v_mfma_f32_16x16x32_bf16 v[232:235], v[72:75], v[100:103], v[232:235]
    ds_read_b64_tr_b16 v[66:67], v10 offset:41984
    v_mfma_f32_16x16x32_bf16 v[204:207], v[76:79], v[96:99], v[204:207]
    ds_read_b64_tr_b16 v[68:69], v11 offset:40960
    buffer_load_dwordx4 v[52:55], v7, s[8:11], s32 offen offset:3072 sc1
    v_mfma_f32_16x16x32_bf16 v[236:239], v[76:79], v[100:103], v[236:239]
    ds_read_b64_tr_b16 v[70:71], v11 offset:41984
    s_add_u32 s32, s32, 4096
    s_waitcnt lgkmcnt(8)
    v_mfma_f32_16x16x32_bf16 v[208:211], v[80:83], v[96:99], v[208:211]
    ds_read_b64_tr_b16 v[72:73], v12 offset:40960
    v_mfma_f32_16x16x32_bf16 v[240:243], v[80:83], v[100:103], v[240:243]
    ds_read_b64_tr_b16 v[74:75], v12 offset:41984
    v_mfma_f32_16x16x32_bf16 v[212:215], v[84:87], v[96:99], v[212:215]
    ds_read_b64_tr_b16 v[76:77], v13 offset:40960
    buffer_store_dwordx4 v[136:139], v60, s[16:19], s38 offen sc1
    v_mfma_f32_16x16x32_bf16 v[244:247], v[84:87], v[100:103], v[244:247]
    ds_read_b64_tr_b16 v[78:79], v13 offset:41984
    s_mov_b32 m0, s34
    s_waitcnt lgkmcnt(8)
    v_mfma_f32_16x16x32_bf16 v[216:219], v[88:91], v[96:99], v[216:219]
    ds_read_b64_tr_b16 v[80:81], v14 offset:40960
    v_mov_b64 v[136:137], v[152:153]
    buffer_load_dwordx4 v2, s[4:7], s31 offen offset:0 sc1 lds
    v_mfma_f32_16x16x32_bf16 v[248:251], v[88:91], v[100:103], v[248:251]
    ds_read_b64_tr_b16 v[82:83], v14 offset:41984
    v_mfma_f32_16x16x32_bf16 v[220:223], v[92:95], v[96:99], v[220:223]
    ds_read_b64_tr_b16 v[84:85], v15 offset:40960
    v_mov_b64 v[138:139], v[154:155]
    v_mfma_f32_16x16x32_bf16 v[252:255], v[92:95], v[100:103], v[252:255]
    ds_read_b64_tr_b16 v[86:87], v15 offset:41984
    s_waitcnt lgkmcnt(8)
    s_waitcnt vmcnt(20)
    v_mfma_f32_16x16x32_bf16 v[192:195], v[64:67], v[104:107], v[192:195]
    ds_read_b64_tr_b16 v[88:89], v16 offset:40960
    v_mov_b64 v[152:153], v[168:169]
    v_mfma_f32_16x16x32_bf16 v[224:227], v[64:67], v[108:111], v[224:227]
    ds_read_b64_tr_b16 v[90:91], v16 offset:41984
    v_mfma_f32_16x16x32_bf16 v[196:199], v[68:71], v[104:107], v[196:199]
    ds_read_b64_tr_b16 v[92:93], v17 offset:40960
    buffer_load_dwordx4 v[96:99], v6, s[8:11], s32 offen offset:0 sc1
    v_mov_b64 v[154:155], v[170:171]
    v_mfma_f32_16x16x32_bf16 v[228:231], v[68:71], v[108:111], v[228:231]
    ds_read_b64_tr_b16 v[94:95], v17 offset:41984
    s_waitcnt lgkmcnt(8)
    v_mfma_f32_16x16x32_bf16 v[200:203], v[72:75], v[104:107], v[200:203]
    ds_read_b64_tr_b16 v[64:65], v10 offset:49152
    v_mov_b64 v[168:169], v[184:185]
    v_mfma_f32_16x16x32_bf16 v[232:235], v[72:75], v[108:111], v[232:235]
    ds_read_b64_tr_b16 v[66:67], v10 offset:50176
    v_mfma_f32_16x16x32_bf16 v[204:207], v[76:79], v[104:107], v[204:207]
    ds_read_b64_tr_b16 v[68:69], v11 offset:49152
    buffer_load_dwordx4 v[100:103], v7, s[8:11], s32 offen offset:0 sc1
    v_mov_b64 v[170:171], v[186:187]
    v_mfma_f32_16x16x32_bf16 v[236:239], v[76:79], v[108:111], v[236:239]
    ds_read_b64_tr_b16 v[70:71], v11 offset:50176
    s_waitcnt lgkmcnt(8)
    v_mfma_f32_16x16x32_bf16 v[208:211], v[80:83], v[104:107], v[208:211]
    ds_read_b64_tr_b16 v[72:73], v12 offset:49152
    v_mfma_f32_16x16x32_bf16 v[240:243], v[80:83], v[108:111], v[240:243]
    ds_read_b64_tr_b16 v[74:75], v12 offset:50176
    v_mfma_f32_16x16x32_bf16 v[212:215], v[84:87], v[104:107], v[212:215]
    ds_read_b64_tr_b16 v[76:77], v13 offset:49152
    v_mfma_f32_16x16x32_bf16 v[244:247], v[84:87], v[108:111], v[244:247]
    ds_read_b64_tr_b16 v[78:79], v13 offset:50176
    s_waitcnt lgkmcnt(8)
    v_mfma_f32_16x16x32_bf16 v[216:219], v[88:91], v[104:107], v[216:219]
    ds_read_b64_tr_b16 v[80:81], v14 offset:49152
    buffer_load_dwordx4 v3, s[4:7], s31 offen offset:1024 sc1 lds
    v_mfma_f32_16x16x32_bf16 v[248:251], v[88:91], v[108:111], v[248:251]
    ds_read_b64_tr_b16 v[82:83], v14 offset:50176
    v_mfma_f32_16x16x32_bf16 v[220:223], v[92:95], v[104:107], v[220:223]
    ds_read_b64_tr_b16 v[84:85], v15 offset:49152
    buffer_store_dwordx4 v[140:143], v61, s[16:19], s38 offen sc1
    v_mfma_f32_16x16x32_bf16 v[252:255], v[92:95], v[108:111], v[252:255]
    ds_read_b64_tr_b16 v[86:87], v15 offset:50176
    s_add_u32 s38, s38, s39
    s_waitcnt lgkmcnt(8)
    s_waitcnt vmcnt(22)
    v_mfma_f32_16x16x32_bf16 v[192:195], v[64:67], v[112:115], v[192:195]
    ds_read_b64_tr_b16 v[88:89], v16 offset:49152
    v_mov_b64 v[140:141], v[156:157]
    v_mfma_f32_16x16x32_bf16 v[224:227], v[64:67], v[116:119], v[224:227]
    ds_read_b64_tr_b16 v[90:91], v16 offset:50176
    v_mfma_f32_16x16x32_bf16 v[196:199], v[68:71], v[112:115], v[196:199]
    ds_read_b64_tr_b16 v[92:93], v17 offset:49152
    buffer_load_dwordx4 v[104:107], v6, s[8:11], s32 offen offset:1024 sc1
    v_mov_b64 v[142:143], v[158:159]
    v_mfma_f32_16x16x32_bf16 v[228:231], v[68:71], v[116:119], v[228:231]
    ds_read_b64_tr_b16 v[94:95], v17 offset:50176
    s_waitcnt lgkmcnt(8)
    v_mfma_f32_16x16x32_bf16 v[200:203], v[72:75], v[112:115], v[200:203]
    ds_read_b64_tr_b16 v[64:65], v10 offset:57344
    v_mov_b64 v[156:157], v[172:173]
    v_mfma_f32_16x16x32_bf16 v[232:235], v[72:75], v[116:119], v[232:235]
    ds_read_b64_tr_b16 v[66:67], v10 offset:58368
    v_xor_b32 v10, 65536, v10
    v_mfma_f32_16x16x32_bf16 v[204:207], v[76:79], v[112:115], v[204:207]
    ds_read_b64_tr_b16 v[68:69], v11 offset:57344
    buffer_load_dwordx4 v[108:111], v7, s[8:11], s32 offen offset:1024 sc1
    v_mov_b64 v[158:159], v[174:175]
    v_mfma_f32_16x16x32_bf16 v[236:239], v[76:79], v[116:119], v[236:239]
    ds_read_b64_tr_b16 v[70:71], v11 offset:58368
    v_xor_b32 v11, 65536, v11
    s_waitcnt lgkmcnt(8)
    v_mfma_f32_16x16x32_bf16 v[208:211], v[80:83], v[112:115], v[208:211]
    ds_read_b64_tr_b16 v[72:73], v12 offset:57344
    v_mov_b64 v[172:173], v[188:189]
    v_mfma_f32_16x16x32_bf16 v[240:243], v[80:83], v[116:119], v[240:243]
    ds_read_b64_tr_b16 v[74:75], v12 offset:58368
    v_xor_b32 v12, 65536, v12
    v_mfma_f32_16x16x32_bf16 v[212:215], v[84:87], v[112:115], v[212:215]
    ds_read_b64_tr_b16 v[76:77], v13 offset:57344
    v_mov_b64 v[174:175], v[190:191]
    v_mfma_f32_16x16x32_bf16 v[244:247], v[84:87], v[116:119], v[244:247]
    ds_read_b64_tr_b16 v[78:79], v13 offset:58368
    v_xor_b32 v13, 65536, v13
    s_waitcnt lgkmcnt(8)
    v_mfma_f32_16x16x32_bf16 v[216:219], v[88:91], v[112:115], v[216:219]
    ds_read_b64_tr_b16 v[80:81], v14 offset:57344
    buffer_load_dwordx4 v4, s[4:7], s31 offen offset:2048 sc1 lds
    v_mfma_f32_16x16x32_bf16 v[248:251], v[88:91], v[116:119], v[248:251]
    ds_read_b64_tr_b16 v[82:83], v14 offset:58368
    v_xor_b32 v14, 65536, v14
    v_mfma_f32_16x16x32_bf16 v[220:223], v[92:95], v[112:115], v[220:223]
    ds_read_b64_tr_b16 v[84:85], v15 offset:57344
    v_mfma_f32_16x16x32_bf16 v[252:255], v[92:95], v[116:119], v[252:255]
    ds_read_b64_tr_b16 v[86:87], v15 offset:58368
    v_xor_b32 v15, 65536, v15
    s_waitcnt lgkmcnt(8)
    s_waitcnt vmcnt(23)
    v_mfma_f32_16x16x32_bf16 v[192:195], v[64:67], v[120:123], v[192:195]
    ds_read_b64_tr_b16 v[88:89], v16 offset:57344
    v_mfma_f32_16x16x32_bf16 v[224:227], v[64:67], v[124:127], v[224:227]
    ds_read_b64_tr_b16 v[90:91], v16 offset:58368
    v_xor_b32 v16, 65536, v16
    v_mfma_f32_16x16x32_bf16 v[196:199], v[68:71], v[120:123], v[196:199]
    ds_read_b64_tr_b16 v[92:93], v17 offset:57344
    buffer_load_dwordx4 v[112:115], v6, s[8:11], s32 offen offset:2048 sc1
    v_mfma_f32_16x16x32_bf16 v[228:231], v[68:71], v[124:127], v[228:231]
    ds_read_b64_tr_b16 v[94:95], v17 offset:58368
    v_xor_b32 v17, 65536, v17
    s_waitcnt lgkmcnt(8)
    v_mfma_f32_16x16x32_bf16 v[200:203], v[72:75], v[120:123], v[200:203]
    v_mfma_f32_16x16x32_bf16 v[232:235], v[72:75], v[124:127], v[232:235]
    v_mfma_f32_16x16x32_bf16 v[204:207], v[76:79], v[120:123], v[204:207]
    buffer_load_dwordx4 v[116:119], v7, s[8:11], s32 offen offset:2048 sc1
    v_mfma_f32_16x16x32_bf16 v[236:239], v[76:79], v[124:127], v[236:239]
    s_waitcnt lgkmcnt(0)
    s_barrier
    v_mfma_f32_16x16x32_bf16 v[208:211], v[80:83], v[120:123], v[208:211]
    ds_read_b64_tr_b16 v[64:65], v10 offset:0
    ds_read_b64_tr_b16 v[66:67], v10 offset:1024
    v_mfma_f32_16x16x32_bf16 v[240:243], v[80:83], v[124:127], v[240:243]
    ds_read_b64_tr_b16 v[68:69], v11 offset:0
    ds_read_b64_tr_b16 v[70:71], v11 offset:1024
    v_mfma_f32_16x16x32_bf16 v[212:215], v[84:87], v[120:123], v[212:215]
    ds_read_b64_tr_b16 v[72:73], v12 offset:0
    ds_read_b64_tr_b16 v[74:75], v12 offset:1024
    v_mfma_f32_16x16x32_bf16 v[244:247], v[84:87], v[124:127], v[244:247]
    ds_read_b64_tr_b16 v[76:77], v13 offset:0
    ds_read_b64_tr_b16 v[78:79], v13 offset:1024
    v_mfma_f32_16x16x32_bf16 v[216:219], v[88:91], v[120:123], v[216:219]
    ds_read_b64_tr_b16 v[80:81], v14 offset:0
    ds_read_b64_tr_b16 v[82:83], v14 offset:1024
    buffer_load_dwordx4 v5, s[4:7], s31 offen offset:3072 sc1 lds
    v_mfma_f32_16x16x32_bf16 v[248:251], v[88:91], v[124:127], v[248:251]
    s_add_u32 s31, s31, s40
    s_add_u32 s34, s34, 32768
    s_and_b32 s34, s34, s41
    v_mfma_f32_16x16x32_bf16 v[220:223], v[92:95], v[120:123], v[220:223]
    ds_read_b64_tr_b16 v[84:85], v15 offset:0
    ds_read_b64_tr_b16 v[86:87], v15 offset:1024
    v_mfma_f32_16x16x32_bf16 v[252:255], v[92:95], v[124:127], v[252:255]
    s_add_u32 s35, s35, 1
    s_cmp_lt_u32 s35, 4
    s_cbranch_scc1 L_p2_loop
    s_add_u32 m0, s33, 65536
    s_nop 0
    buffer_load_dwordx4 v2, s[4:7], s31 offen offset:0 sc1 lds
    buffer_load_dwordx4 v2, s[4:7], s31 offen offset:1024 sc1 lds
    buffer_load_dwordx4 v2, s[4:7], s31 offen offset:2048 sc1 lds
    buffer_load_dwordx4 v2, s[4:7], s31 offen offset:3072 sc1 lds
    s_load_dwordx2 s[32:33], s[0:1], 40
    s_load_dwordx2 s[34:35], s[0:1], 80
    s_load_dwordx2 s[96:97], s[0:1], 0
    s_load_dwordx2 s[98:99], s[0:1], 88
    s_cmp_lt_u32 s28, 4
    s_cbranch_scc0 L_grp1
    v_mov_b32 v20, 1040356334
    v_mov_b32 v21, v20
    s_and_b32 s37, s28, 3
    s_lshl_b32 s37, s37, 13
    v_lshlrev_b32 v7, 4, v1
    v_add_u32 v4, s37, v7
    v_add_u32 v19, 131072, v4
    v_add_u32 v6, 4096, v4
    s_add_u32 s43, s37, 32768
    s_add_u32 s44, s37, 98304
    s_waitcnt vmcnt(4) lgkmcnt(0)
    v_pk_mul_f32 v[192:193], v[192:193], v[20:21]
    v_pk_mul_f32 v[194:195], v[194:195], v[20:21]
    v_pk_mul_f32 v[196:197], v[196:197], v[20:21]
    v_pk_mul_f32 v[198:199], v[198:199], v[20:21]
    v_cvt_pk_bf16_f32 v128, v192, v193
    v_cvt_pk_bf16_f32 v129, v194, v195
    v_cvt_pk_bf16_f32 v130, v196, v197
    v_cvt_pk_bf16_f32 v131, v198, v199
    ds_write_b128 v19, v[128:131] offset:0
    v_pk_mul_f32 v[200:201], v[200:201], v[20:21]
    v_pk_mul_f32 v[202:203], v[202:203], v[20:21]
    v_pk_mul_f32 v[204:205], v[204:205], v[20:21]
    v_pk_mul_f32 v[206:207], v[206:207], v[20:21]
    v_cvt_pk_bf16_f32 v132, v200, v201
    v_cvt_pk_bf16_f32 v133, v202, v203
    v_cvt_pk_bf16_f32 v134, v204, v205
    v_cvt_pk_bf16_f32 v135, v206, v207
    ds_write_b128 v19, v[132:135] offset:1024
    v_pk_mul_f32 v[208:209], v[208:209], v[20:21]
    v_pk_mul_f32 v[210:211], v[210:211], v[20:21]
    v_pk_mul_f32 v[212:213], v[212:213], v[20:21]
    v_pk_mul_f32 v[214:215], v[214:215], v[20:21]
    v_cvt_pk_bf16_f32 v136, v208, v209
    v_cvt_pk_bf16_f32 v137, v210, v211
    v_cvt_pk_bf16_f32 v138, v212, v213
    v_cvt_pk_bf16_f32 v139, v214, v215
    ds_write_b128 v19, v[136:139] offset:2048
    v_pk_mul_f32 v[216:217], v[216:217], v[20:21]
    v_pk_mul_f32 v[218:219], v[218:219], v[20:21]
    v_pk_mul_f32 v[220:221], v[220:221], v[20:21]
    v_pk_mul_f32 v[222:223], v[222:223], v[20:21]
    v_cvt_pk_bf16_f32 v140, v216, v217
    v_cvt_pk_bf16_f32 v141, v218, v219
    v_cvt_pk_bf16_f32 v142, v220, v221
    v_cvt_pk_bf16_f32 v143, v222, v223
    ds_write_b128 v19, v[140:143] offset:3072
    v_pk_mul_f32 v[224:225], v[224:225], v[20:21]
    v_pk_mul_f32 v[226:227], v[226:227], v[20:21]
    v_pk_mul_f32 v[228:229], v[228:229], v[20:21]
    v_pk_mul_f32 v[230:231], v[230:231], v[20:21]
    v_cvt_pk_bf16_f32 v144, v224, v225
    v_cvt_pk_bf16_f32 v145, v226, v227
    v_cvt_pk_bf16_f32 v146, v228, v229
    v_cvt_pk_bf16_f32 v147, v230, v231
    ds_write_b128 v19, v[144:147] offset:4096
    v_pk_mul_f32 v[232:233], v[232:233], v[20:21]
    v_pk_mul_f32 v[234:235], v[234:235], v[20:21]
    v_pk_mul_f32 v[236:237], v[236:237], v[20:21]
    v_pk_mul_f32 v[238:239], v[238:239], v[20:21]
    v_cvt_pk_bf16_f32 v148, v232, v233
    v_cvt_pk_bf16_f32 v149, v234, v235
    v_cvt_pk_bf16_f32 v150, v236, v237
    v_cvt_pk_bf16_f32 v151, v238, v239
    ds_write_b128 v19, v[148:151] offset:5120
    v_pk_mul_f32 v[240:241], v[240:241], v[20:21]
    v_pk_mul_f32 v[242:243], v[242:243], v[20:21]
    v_pk_mul_f32 v[244:245], v[244:245], v[20:21]
    v_pk_mul_f32 v[246:247], v[246:247], v[20:21]
    v_cvt_pk_bf16_f32 v152, v240, v241
    v_cvt_pk_bf16_f32 v153, v242, v243
    v_cvt_pk_bf16_f32 v154, v244, v245
    v_cvt_pk_bf16_f32 v155, v246, v247
    ds_write_b128 v19, v[152:155] offset:6144
    v_pk_mul_f32 v[248:249], v[248:249], v[20:21]
    v_pk_mul_f32 v[250:251], v[250:251], v[20:21]
    v_pk_mul_f32 v[252:253], v[252:253], v[20:21]
    v_pk_mul_f32 v[254:255], v[254:255], v[20:21]
    v_cvt_pk_bf16_f32 v156, v248, v249
    v_cvt_pk_bf16_f32 v157, v250, v251
    v_cvt_pk_bf16_f32 v158, v252, v253
    v_cvt_pk_bf16_f32 v159, v254, v255
    ds_write_b128 v19, v[156:159] offset:7168
    v_mov_b32 v2, v7
    v_and_b32 v21, 15, v1
    v_lshrrev_b32 v22, 4, v1
    v_lshlrev_b32 v22, 2, v22
    v_sub_u32 v18, v21, v22
    s_mov_b32 s40, 0
    s_mov_b32 s41, 16384
    s_mov_b32 s49, 0xffff
    s_lshl_b32 s51, s30, 1
    s_add_u32 s51, s51, 1
    s_and_b32 s50, s28, 3
    s_lshl_b32 s50, s50, 5
    v_mov_b32 v36, 0x3f803f80
    v_mov_b32 v37, 0x3f803f80
    v_mov_b32 v38, 0x3f803f80
    v_mov_b32 v39, 0x3f803f80
    s_lshl_b32 s31, 1, s51
    s_or_b32 s31, s31, 0x8000
    s_add_u32 s36, s51, 1
    s_lshl_b32 s36, -1, s36
    s_or_b32 s48, s36, 0xaaaaaaab
    s_and_b32 s48, s48, 0x7fff
    s_or_b32 s39, s36, 0x55555555
    s_and_b32 s39, s39, 0xffff
    s_add_u32 s46, s45, 65536
    s_add_u32 s47, s45, 98304
    s_mov_b64 s[52:53], 0
    s_waitcnt lgkmcnt(0)
    s_barrier
    s_add_u32 s16, s54, 41943040
    s_addc_u32 s17, s55, 0
    s_and_b32 s17, s17, 0xffff
    s_mov_b32 s18, 117440640
    s_mov_b32 s19, 0x20000
    s_mov_b32 s4, s92
    s_and_b32 s5, s93, 0xffff
    s_mov_b32 s6, 7340032
    s_mov_b32 s7, 0x20000
    s_mov_b32 s8, s94
    s_and_b32 s9, s95, 0xffff
    s_mov_b32 s10, 7340032
    s_mov_b32 s11, 0x20000
    s_and_b32 s60, s29, 3
    s_add_u32 s60, s60, 4
    s_sub_u32 s3, s2, 32
    s_cmp_eq_u32 s28, 0
    s_cselect_b32 s36, 0xad, 0x2d
    s_cselect_b32 s42, 14, 12
    s_cmp_lt_u32 s3, 224
    s_cselect_b32 s36, s36, 0
    s_lshl_b32 s36, s36, s60
    s_or_b32 s42, s42, s36
    ds_read_b128 v[64:67], v2 offset:0
    ds_read_b128 v[68:71], v2 offset:1024
    ds_read_b128 v[72:75], v2 offset:2048
    ds_read_b128 v[76:79], v2 offset:3072
    ds_read_b128 v[80:83], v2 offset:4096
    ds_read_b128 v[84:87], v2 offset:5120
    ds_read_b128 v[88:91], v2 offset:6144
    ds_read_b128 v[92:95], v2 offset:7168
    s_waitcnt lgkmcnt(7)
    v_mfma_f32_16x16x32_bf16 v[96:99], v[64:67], v[128:131], 0
    v_mov_b64 v[192:193], 0
    v_mov_b64 v[194:195], 0
    v_mfma_f32_16x16x32_bf16 v[104:107], v[64:67], v[144:147], 0
    ds_read_b128 v[64:67], v2 offset:8192
    v_mov_b64 v[196:197], 0
    v_mov_b64 v[198:199], 0
    s_waitcnt lgkmcnt(7)
    v_mfma_f32_16x16x32_bf16 v[96:99], v[68:71], v[132:135], v[96:99]
    v_mov_b64 v[200:201], 0
    v_mov_b64 v[202:203], 0
    v_mfma_f32_16x16x32_bf16 v[104:107], v[68:71], v[148:151], v[104:107]
    ds_read_b128 v[68:71], v2 offset:9216
    v_mov_b64 v[204:205], 0
    v_mov_b64 v[206:207], 0
    s_waitcnt lgkmcnt(7)
    v_mfma_f32_16x16x32_bf16 v[96:99], v[72:75], v[136:139], v[96:99]
    v_mov_b64 v[208:209], 0
    v_mfma_f32_16x16x32_bf16 v[104:107], v[72:75], v[152:155], v[104:107]
    ds_read_b128 v[72:75], v2 offset:10240
    v_mov_b64 v[210:211], 0
    v_mov_b64 v[212:213], 0
    s_waitcnt lgkmcnt(7)
    v_mfma_f32_16x16x32_bf16 v[96:99], v[76:79], v[140:143], v[96:99]
    v_mov_b64 v[214:215], 0
    v_mov_b64 v[216:217], 0
    v_mfma_f32_16x16x32_bf16 v[104:107], v[76:79], v[156:159], v[104:107]
    ds_read_b128 v[76:79], v2 offset:11264
    v_mov_b64 v[218:219], 0
    v_mov_b64 v[220:221], 0
    s_waitcnt lgkmcnt(7)
    v_mfma_f32_16x16x32_bf16 v[100:103], v[80:83], v[128:131], 0
    v_mov_b64 v[222:223], 0
    v_mov_b64 v[224:225], 0
    v_mfma_f32_16x16x32_bf16 v[108:111], v[80:83], v[144:147], 0
    ds_read_b128 v[80:83], v2 offset:12288
    v_mov_b64 v[226:227], 0
    s_waitcnt lgkmcnt(7)
    v_mfma_f32_16x16x32_bf16 v[100:103], v[84:87], v[132:135], v[100:103]
    v_mov_b64 v[228:229], 0
    v_mov_b64 v[230:231], 0
    v_mfma_f32_16x16x32_bf16 v[108:111], v[84:87], v[148:151], v[108:111]
    ds_read_b128 v[84:87], v2 offset:13312
    v_mov_b64 v[232:233], 0
    v_mov_b64 v[234:235], 0
    s_waitcnt lgkmcnt(7)
    v_mfma_f32_16x16x32_bf16 v[100:103], v[88:91], v[136:139], v[100:103]
    v_mov_b64 v[236:237], 0
    v_mov_b64 v[238:239], 0
    v_mfma_f32_16x16x32_bf16 v[108:111], v[88:91], v[152:155], v[108:111]
    ds_read_b128 v[88:91], v2 offset:14336
    v_mov_b64 v[240:241], 0
    v_mov_b64 v[242:243], 0
    s_waitcnt lgkmcnt(7)
    v_mfma_f32_16x16x32_bf16 v[100:103], v[92:95], v[140:143], v[100:103]
    v_mov_b64 v[244:245], 0
    v_mfma_f32_16x16x32_bf16 v[108:111], v[92:95], v[156:159], v[108:111]
    ds_read_b128 v[92:95], v2 offset:15360
    v_mov_b64 v[246:247], 0
    v_mov_b64 v[248:249], 0
    s_waitcnt lgkmcnt(7)
    v_mfma_f32_16x16x32_bf16 v[112:115], v[64:67], v[128:131], 0
    v_mov_b64 v[250:251], 0
    v_mov_b64 v[252:253], 0
    v_mfma_f32_16x16x32_bf16 v[120:123], v[64:67], v[144:147], 0
    v_mov_b64 v[254:255], 0
    v_mov_b64 v[28:29], 0
    s_waitcnt lgkmcnt(6)
    v_mfma_f32_16x16x32_bf16 v[112:115], v[68:71], v[132:135], v[112:115]
    v_mov_b64 v[30:31], 0
    v_mov_b64 v[32:33], 0
    v_mfma_f32_16x16x32_bf16 v[120:123], v[68:71], v[148:151], v[120:123]
    v_mov_b64 v[34:35], 0
    s_waitcnt lgkmcnt(5)
    v_mfma_f32_16x16x32_bf16 v[112:115], v[72:75], v[136:139], v[112:115]
    v_mfma_f32_16x16x32_bf16 v[120:123], v[72:75], v[152:155], v[120:123]
    v_max3_f32 v22, v96, v97, v98
    v_max3_f32 v23, v104, v105, v106
    s_waitcnt lgkmcnt(4)
    v_mfma_f32_16x16x32_bf16 v[112:115], v[76:79], v[140:143], v[112:115]
    v_max3_f32 v22, v22, v99, v100
    v_max3_f32 v23, v23, v107, v108
    v_mfma_f32_16x16x32_bf16 v[120:123], v[76:79], v[156:159], v[120:123]
    v_max3_f32 v22, v22, v101, v102
    v_max3_f32 v23, v23, v109, v110
    s_waitcnt lgkmcnt(3)
    v_mfma_f32_16x16x32_bf16 v[116:119], v[80:83], v[128:131], 0
    v_max_f32 v22, v22, v103
    v_max_f32 v23, v23, v111
    v_mfma_f32_16x16x32_bf16 v[124:127], v[80:83], v[144:147], 0
    v_mov_b32 v24, v22
    v_mov_b32 v25, v23
    s_waitcnt lgkmcnt(2)
    v_mfma_f32_16x16x32_bf16 v[116:119], v[84:87], v[132:135], v[116:119]
    v_permlane16_swap_b32 v22, v24
    v_permlane16_swap_b32 v23, v25
    v_mfma_f32_16x16x32_bf16 v[124:127], v[84:87], v[148:151], v[124:127]
    v_max_f32 v22, v22, v24
    v_max_f32 v23, v23, v25
    s_waitcnt lgkmcnt(1)
    v_mfma_f32_16x16x32_bf16 v[116:119], v[88:91], v[136:139], v[116:119]
    v_mov_b32 v24, v22
    v_mov_b32 v25, v23
    v_mfma_f32_16x16x32_bf16 v[124:127], v[88:91], v[152:155], v[124:127]
    v_permlane32_swap_b32 v22, v24
    v_permlane32_swap_b32 v23, v25
    s_waitcnt lgkmcnt(0)
    v_mfma_f32_16x16x32_bf16 v[116:119], v[92:95], v[140:143], v[116:119]
    v_max_f32 v22, v22, v24
    v_max_f32 v23, v23, v25
    v_mfma_f32_16x16x32_bf16 v[124:127], v[92:95], v[156:159], v[124:127]
    v_sub_f32 v40, 0, v22
    v_sub_f32 v41, 0, v22
    v_sub_f32 v42, 0, v22
    v_sub_f32 v43, 0, v22
    v_sub_f32 v44, 0, v23
    v_sub_f32 v45, 0, v23
    v_sub_f32 v46, 0, v23
    v_sub_f32 v47, 0, v23
    v_add_u32 v3, 65536, v2
    v_add_u32 v2, s41, v2
    v_and_b32 v2, s49, v2
    s_waitcnt vmcnt(0)
    s_barrier
    s_cmp_eq_u32 s28, 0
    s_cbranch_scc1 L_recurrent_scan__compressed_kv_cla__moe_arch_mod__prompt_kernel_rare_57
L_recurrent_scan__compressed_kv_cla__moe_arch_mod__prompt_kernel_back_58:
    ds_read_b128 v[64:67], v2 offset:0
    ds_read_b128 v[68:71], v2 offset:1024
    ds_read_b128 v[72:75], v2 offset:2048
    ds_read_b128 v[76:79], v2 offset:3072
    ds_read_b128 v[80:83], v2 offset:4096
    ds_read_b128 v[84:87], v2 offset:5120
    ds_read_b128 v[88:91], v2 offset:6144
    ds_write_b32 v19, v40
    ds_write_b32 v19, v44 offset:4
    v_pk_add_f32 v[96:97], v[96:97], v[40:41]
    v_pk_add_f32 v[98:99], v[98:99], v[40:41]
    v_pk_add_f32 v[100:101], v[100:101], v[40:41]
    v_pk_add_f32 v[102:103], v[102:103], v[40:41]
    v_pk_add_f32 v[104:105], v[104:105], v[44:45]
    v_pk_add_f32 v[106:107], v[106:107], v[44:45]
    v_pk_add_f32 v[108:109], v[108:109], v[44:45]
    v_pk_add_f32 v[110:111], v[110:111], v[44:45]
    v_pk_add_f32 v[112:113], v[112:113], v[40:41]
    v_pk_add_f32 v[114:115], v[114:115], v[40:41]
    v_pk_add_f32 v[116:117], v[116:117], v[40:41]
    v_pk_add_f32 v[118:119], v[118:119], v[40:41]
    v_pk_add_f32 v[120:121], v[120:121], v[44:45]
    v_pk_add_f32 v[122:123], v[122:123], v[44:45]
    v_pk_add_f32 v[124:125], v[124:125], v[44:45]
    v_pk_add_f32 v[126:127], v[126:127], v[44:45]
    v_exp_f32 v96, v96
    v_exp_f32 v97, v97
    v_exp_f32 v98, v98
    v_exp_f32 v99, v99
    v_exp_f32 v104, v104
    v_exp_f32 v105, v105
    v_exp_f32 v106, v106
    v_exp_f32 v107, v107
    v_exp_f32 v100, v100
    v_exp_f32 v101, v101
    v_exp_f32 v102, v102
    v_exp_f32 v103, v103
    v_exp_f32 v108, v108
    v_exp_f32 v109, v109
    v_exp_f32 v110, v110
    v_exp_f32 v111, v111
    v_cvt_pk_bf16_f32 v48, v96, v97
    v_cvt_pk_bf16_f32 v49, v98, v99
    v_cvt_pk_bf16_f32 v52, v104, v105
    v_cvt_pk_bf16_f32 v53, v106, v107
    v_cvt_pk_bf16_f32 v50, v100, v101
    v_cvt_pk_bf16_f32 v51, v102, v103
    v_cvt_pk_bf16_f32 v54, v108, v109
    v_cvt_pk_bf16_f32 v55, v110, v111
    .p2align 6
L_body0:
    s_waitcnt lgkmcnt(5)
    v_mfma_f32_16x16x32_bf16 v[96:99], v[64:67], v[128:131], v[40:43]
    v_exp_f32 v112, v112
    v_mfma_f32_16x16x32_bf16 v[104:107], v[64:67], v[144:147], v[44:47]
    ds_read_b128 v[92:95], v2 offset:7168
    s_bitcmp1_b32 s48, s40
    s_cbranch_scc0 L_recurrent_scan__compressed_kv_cla__moe_arch_mod__prompt_kernel_nodma_81
    s_add_u32 m0, s43, 0
    s_nop 0
    buffer_load_dwordx4 v4, s[12:15], s46 offen offset:0 sc1 lds
    buffer_load_dwordx4 v4, s[12:15], s46 offen offset:1024 sc1 lds
L_recurrent_scan__compressed_kv_cla__moe_arch_mod__prompt_kernel_nodma_81:
    v_mfma_f32_16x16x32_bf16 v[96:99], v[68:71], v[132:135], v[96:99]
    v_exp_f32 v113, v113
    v_mfma_f32_16x16x32_bf16 v[104:107], v[68:71], v[148:151], v[104:107]
    ds_read_b128 v[64:67], v3 offset:0
    s_waitcnt lgkmcnt(5)
    v_mfma_f32_16x16x32_bf16 v[96:99], v[72:75], v[136:139], v[96:99]
    v_exp_f32 v114, v114
    v_mfma_f32_16x16x32_bf16 v[104:107], v[72:75], v[152:155], v[104:107]
    ds_read_b128 v[68:71], v3 offset:1024
    v_cvt_pk_bf16_f32 v56, v112, v113
    s_bitcmp1_b32 s48, s40
    s_cbranch_scc0 L_recurrent_scan__compressed_kv_cla__moe_arch_mod__prompt_kernel_nodma_82
    s_add_u32 m0, s43, 0
    s_nop 0
    buffer_load_dwordx4 v4, s[12:15], s46 offen offset:2048 sc1 lds
    buffer_load_dwordx4 v4, s[12:15], s46 offen offset:3072 sc1 lds
L_recurrent_scan__compressed_kv_cla__moe_arch_mod__prompt_kernel_nodma_82:
    v_mfma_f32_16x16x32_bf16 v[96:99], v[76:79], v[140:143], v[96:99]
    v_exp_f32 v115, v115
    v_mfma_f32_16x16x32_bf16 v[104:107], v[76:79], v[156:159], v[104:107]
    ds_read_b128 v[72:75], v3 offset:2048
    s_waitcnt lgkmcnt(5)
    v_mfma_f32_16x16x32_bf16 v[100:103], v[80:83], v[128:131], v[40:43]
    v_exp_f32 v120, v120
    v_mfma_f32_16x16x32_bf16 v[108:111], v[80:83], v[144:147], v[44:47]
    ds_read_b128 v[76:79], v3 offset:3072
    v_cvt_pk_bf16_f32 v57, v114, v115
    v_mfma_f32_16x16x32_bf16 v[100:103], v[84:87], v[132:135], v[100:103]
    v_exp_f32 v121, v121
    v_mfma_f32_16x16x32_bf16 v[108:111], v[84:87], v[148:151], v[108:111]
    ds_read_b128 v[80:83], v3 offset:4096
    s_bitcmp1_b32 s48, s40
    s_cbranch_scc0 L_recurrent_scan__compressed_kv_cla__moe_arch_mod__prompt_kernel_nodma_83
    s_add_u32 m0, s43, 4096
    s_nop 0
    buffer_load_dwordx4 v6, s[12:15], s46 offen offset:0 sc1 lds
    buffer_load_dwordx4 v6, s[12:15], s46 offen offset:1024 sc1 lds
L_recurrent_scan__compressed_kv_cla__moe_arch_mod__prompt_kernel_nodma_83:
    s_waitcnt lgkmcnt(5)
    v_mfma_f32_16x16x32_bf16 v[100:103], v[88:91], v[136:139], v[100:103]
    v_exp_f32 v122, v122
    v_mfma_f32_16x16x32_bf16 v[108:111], v[88:91], v[152:155], v[108:111]
    ds_read_b128 v[84:87], v3 offset:5120
    v_cvt_pk_bf16_f32 v60, v120, v121
    v_mfma_f32_16x16x32_bf16 v[100:103], v[92:95], v[140:143], v[100:103]
    v_exp_f32 v123, v123
    v_mfma_f32_16x16x32_bf16 v[108:111], v[92:95], v[156:159], v[108:111]
    ds_read_b128 v[88:91], v3 offset:6144
    s_bitcmp1_b32 s48, s40
    s_cbranch_scc0 L_recurrent_scan__compressed_kv_cla__moe_arch_mod__prompt_kernel_nodma_84
    s_add_u32 m0, s43, 4096
    s_nop 0
    buffer_load_dwordx4 v6, s[12:15], s46 offen offset:2048 sc1 lds
    buffer_load_dwordx4 v6, s[12:15], s46 offen offset:3072 sc1 lds
    s_add_u32 s46, s46, 65536
    s_xor_b32 s43, s43, 32768
L_recurrent_scan__compressed_kv_cla__moe_arch_mod__prompt_kernel_nodma_84:
    s_waitcnt lgkmcnt(5)
    v_mfma_f32_16x16x32_bf16 v[192:195], v[64:67], v[48:51], v[192:195]
    v_exp_f32 v116, v116
    v_mfma_f32_16x16x32_bf16 v[224:227], v[64:67], v[52:55], v[224:227]
    ds_read_b128 v[92:95], v3 offset:7168
    v_cvt_pk_bf16_f32 v61, v122, v123
    v_mfma_f32_16x16x32_bf16 v[196:199], v[68:71], v[48:51], v[196:199]
    v_exp_f32 v117, v117
    v_mfma_f32_16x16x32_bf16 v[228:231], v[68:71], v[52:55], v[228:231]
    ds_read_b128 v[64:67], v2 offset:8192
    s_waitcnt lgkmcnt(5)
    v_mfma_f32_16x16x32_bf16 v[200:203], v[72:75], v[48:51], v[200:203]
    v_exp_f32 v118, v118
    v_mfma_f32_16x16x32_bf16 v[232:235], v[72:75], v[52:55], v[232:235]
    v_mfma_f32_16x16x32_bf16 v[28:31], v[36:39], v[48:51], v[28:31]
    ds_read_b128 v[68:71], v2 offset:9216
    v_cvt_pk_bf16_f32 v58, v116, v117
    s_bitcmp1_b32 s39, s40
    s_cbranch_scc0 L_recurrent_scan__compressed_kv_cla__moe_arch_mod__prompt_kernel_nodma_85
    s_add_u32 m0, s44, 0
    s_nop 0
    buffer_load_dwordx4 v4, s[12:15], s47 offen offset:0 sc1 lds
    buffer_load_dwordx4 v4, s[12:15], s47 offen offset:1024 sc1 lds
L_recurrent_scan__compressed_kv_cla__moe_arch_mod__prompt_kernel_nodma_85:
    v_mfma_f32_16x16x32_bf16 v[204:207], v[76:79], v[48:51], v[204:207]
    v_exp_f32 v119, v119
    v_mfma_f32_16x16x32_bf16 v[236:239], v[76:79], v[52:55], v[236:239]
    ds_read_b128 v[72:75], v2 offset:10240
    s_waitcnt lgkmcnt(5)
    v_mfma_f32_16x16x32_bf16 v[208:211], v[80:83], v[48:51], v[208:211]
    v_exp_f32 v124, v124
    v_mfma_f32_16x16x32_bf16 v[240:243], v[80:83], v[52:55], v[240:243]
    ds_read_b128 v[76:79], v2 offset:11264
    v_cvt_pk_bf16_f32 v59, v118, v119
    s_bitcmp1_b32 s39, s40
    s_cbranch_scc0 L_recurrent_scan__compressed_kv_cla__moe_arch_mod__prompt_kernel_nodma_86
    s_add_u32 m0, s44, 0
    s_nop 0
    buffer_load_dwordx4 v4, s[12:15], s47 offen offset:2048 sc1 lds
    buffer_load_dwordx4 v4, s[12:15], s47 offen offset:3072 sc1 lds
L_recurrent_scan__compressed_kv_cla__moe_arch_mod__prompt_kernel_nodma_86:
    v_mfma_f32_16x16x32_bf16 v[212:215], v[84:87], v[48:51], v[212:215]
    v_exp_f32 v125, v125
    v_mfma_f32_16x16x32_bf16 v[244:247], v[84:87], v[52:55], v[244:247]
    ds_read_b128 v[80:83], v2 offset:12288
    s_waitcnt lgkmcnt(5)
    v_mfma_f32_16x16x32_bf16 v[216:219], v[88:91], v[48:51], v[216:219]
    v_exp_f32 v126, v126
    v_mfma_f32_16x16x32_bf16 v[248:251], v[88:91], v[52:55], v[248:251]
    v_mfma_f32_16x16x32_bf16 v[32:35], v[36:39], v[52:55], v[32:35]
    ds_read_b128 v[84:87], v2 offset:13312
    v_cvt_pk_bf16_f32 v62, v124, v125
    v_mfma_f32_16x16x32_bf16 v[220:223], v[92:95], v[48:51], v[220:223]
    v_exp_f32 v127, v127
    v_mfma_f32_16x16x32_bf16 v[252:255], v[92:95], v[52:55], v[252:255]
    ds_read_b128 v[88:91], v2 offset:14336
    v_cvt_pk_bf16_f32 v63, v126, v127
    s_bitcmp1_b32 s39, s40
    s_cbranch_scc0 L_recurrent_scan__compressed_kv_cla__moe_arch_mod__prompt_kernel_nodma_87
    s_add_u32 m0, s44, 4096
    s_nop 0
    buffer_load_dwordx4 v6, s[12:15], s47 offen offset:0 sc1 lds
    buffer_load_dwordx4 v6, s[12:15], s47 offen offset:1024 sc1 lds
L_recurrent_scan__compressed_kv_cla__moe_arch_mod__prompt_kernel_nodma_87:
    s_bitcmp1_b32 s31, s40
    s_cbranch_scc1 L_recurrent_scan__compressed_kv_cla__moe_arch_mod__prompt_kernel_rare_63
L_recurrent_scan__compressed_kv_cla__moe_arch_mod__prompt_kernel_back_64:
    s_waitcnt lgkmcnt(5)
    v_mfma_f32_16x16x32_bf16 v[112:115], v[64:67], v[128:131], v[40:43]
    v_exp_f32 v96, v96
    v_mfma_f32_16x16x32_bf16 v[120:123], v[64:67], v[144:147], v[44:47]
    ds_read_b128 v[92:95], v2 offset:15360
    v_mfma_f32_16x16x32_bf16 v[112:115], v[68:71], v[132:135], v[112:115]
    v_exp_f32 v97, v97
    v_mfma_f32_16x16x32_bf16 v[120:123], v[68:71], v[148:151], v[120:123]
    ds_read_b128 v[64:67], v3 offset:8192
    s_bitcmp1_b32 s39, s40
    s_cbranch_scc0 L_recurrent_scan__compressed_kv_cla__moe_arch_mod__prompt_kernel_nodma_88
    s_add_u32 m0, s44, 4096
    s_nop 0
    buffer_load_dwordx4 v6, s[12:15], s47 offen offset:2048 sc1 lds
    buffer_load_dwordx4 v6, s[12:15], s47 offen offset:3072 sc1 lds
    s_add_u32 s47, s47, 65536
    s_xor_b32 s44, s44, 32768
L_recurrent_scan__compressed_kv_cla__moe_arch_mod__prompt_kernel_nodma_88:
    s_waitcnt lgkmcnt(5)
    v_mfma_f32_16x16x32_bf16 v[112:115], v[72:75], v[136:139], v[112:115]
    v_exp_f32 v98, v98
    v_mfma_f32_16x16x32_bf16 v[120:123], v[72:75], v[152:155], v[120:123]
    ds_read_b128 v[68:71], v3 offset:9216
    v_cvt_pk_bf16_f32 v48, v96, v97
    v_mfma_f32_16x16x32_bf16 v[112:115], v[76:79], v[140:143], v[112:115]
    v_exp_f32 v99, v99
    v_mfma_f32_16x16x32_bf16 v[120:123], v[76:79], v[156:159], v[120:123]
    ds_read_b128 v[72:75], v3 offset:10240
    s_waitcnt lgkmcnt(5)
    v_mfma_f32_16x16x32_bf16 v[116:119], v[80:83], v[128:131], v[40:43]
    v_exp_f32 v104, v104
    v_mfma_f32_16x16x32_bf16 v[124:127], v[80:83], v[144:147], v[44:47]
    ds_read_b128 v[76:79], v3 offset:11264
    v_cvt_pk_bf16_f32 v49, v98, v99
    v_mfma_f32_16x16x32_bf16 v[116:119], v[84:87], v[132:135], v[116:119]
    v_exp_f32 v105, v105
    v_mfma_f32_16x16x32_bf16 v[124:127], v[84:87], v[148:151], v[124:127]
    ds_read_b128 v[80:83], v3 offset:12288
    s_waitcnt lgkmcnt(5)
    v_mfma_f32_16x16x32_bf16 v[116:119], v[88:91], v[136:139], v[116:119]
    v_exp_f32 v106, v106
    v_mfma_f32_16x16x32_bf16 v[124:127], v[88:91], v[152:155], v[124:127]
    ds_read_b128 v[84:87], v3 offset:13312
    v_cvt_pk_bf16_f32 v52, v104, v105
    v_mfma_f32_16x16x32_bf16 v[116:119], v[92:95], v[140:143], v[116:119]
    v_exp_f32 v107, v107
    v_mfma_f32_16x16x32_bf16 v[124:127], v[92:95], v[156:159], v[124:127]
    ds_read_b128 v[88:91], v3 offset:14336
    s_waitcnt lgkmcnt(5)
    v_mfma_f32_16x16x32_bf16 v[192:195], v[64:67], v[56:59], v[192:195]
    v_exp_f32 v100, v100
    v_mfma_f32_16x16x32_bf16 v[224:227], v[64:67], v[60:63], v[224:227]
    ds_read_b128 v[92:95], v3 offset:15360
    v_cvt_pk_bf16_f32 v53, v106, v107
    v_mfma_f32_16x16x32_bf16 v[196:199], v[68:71], v[56:59], v[196:199]
    v_exp_f32 v101, v101
    v_mfma_f32_16x16x32_bf16 v[228:231], v[68:71], v[60:63], v[228:231]
    v_add_u32 v3, 65536, v2
    v_add_u32 v2, s41, v2
    s_waitcnt lgkmcnt(4)
    v_mfma_f32_16x16x32_bf16 v[200:203], v[72:75], v[56:59], v[200:203]
    v_exp_f32 v102, v102
    s_add_u32 s40, s40, 1
    v_and_b32 v2, s49, v2
    v_mfma_f32_16x16x32_bf16 v[232:235], v[72:75], v[60:63], v[232:235]
    v_mfma_f32_16x16x32_bf16 v[28:31], v[36:39], v[56:59], v[28:31]
    v_cvt_pk_bf16_f32 v50, v100, v101
    s_waitcnt vmcnt(8) lgkmcnt(0)
    s_cmp_le_u32 s40, s51
    s_cbranch_scc1 L_recurrent_scan__compressed_kv_cla__moe_arch_mod__prompt_kernel_rlx_65
    s_waitcnt vmcnt(0)
L_recurrent_scan__compressed_kv_cla__moe_arch_mod__prompt_kernel_rlx_65:
    s_bitcmp1_b32 s42, s40
    s_cbranch_scc1 L_recurrent_scan__compressed_kv_cla__moe_arch_mod__prompt_kernel_rare_79
L_recurrent_scan__compressed_kv_cla__moe_arch_mod__prompt_kernel_back_80:
    s_barrier
    v_mfma_f32_16x16x32_bf16 v[204:207], v[76:79], v[56:59], v[204:207]
    v_exp_f32 v103, v103
    v_mfma_f32_16x16x32_bf16 v[236:239], v[76:79], v[60:63], v[236:239]
    ds_read_b128 v[68:71], v2 offset:1024
    ds_read_b128 v[64:67], v2 offset:0
    v_mfma_f32_16x16x32_bf16 v[208:211], v[80:83], v[56:59], v[208:211]
    v_exp_f32 v108, v108
    v_mfma_f32_16x16x32_bf16 v[240:243], v[80:83], v[60:63], v[240:243]
    ds_read_b128 v[76:79], v2 offset:3072
    ds_read_b128 v[72:75], v2 offset:2048
    v_cvt_pk_bf16_f32 v51, v102, v103
    v_mfma_f32_16x16x32_bf16 v[212:215], v[84:87], v[56:59], v[212:215]
    v_exp_f32 v109, v109
    v_mfma_f32_16x16x32_bf16 v[244:247], v[84:87], v[60:63], v[244:247]
    ds_read_b128 v[80:83], v2 offset:4096
    v_mfma_f32_16x16x32_bf16 v[216:219], v[88:91], v[56:59], v[216:219]
    v_exp_f32 v110, v110
    v_mfma_f32_16x16x32_bf16 v[248:251], v[88:91], v[60:63], v[248:251]
    v_mfma_f32_16x16x32_bf16 v[32:35], v[36:39], v[60:63], v[32:35]
    ds_read_b128 v[84:87], v2 offset:5120
    v_cvt_pk_bf16_f32 v54, v108, v109
    v_mfma_f32_16x16x32_bf16 v[220:223], v[92:95], v[56:59], v[220:223]
    v_exp_f32 v111, v111
    v_mfma_f32_16x16x32_bf16 v[252:255], v[92:95], v[60:63], v[252:255]
    ds_read_b128 v[88:91], v2 offset:6144
    v_cvt_pk_bf16_f32 v55, v110, v111
    s_cmp_lg_u32 s40, 16
    s_cbranch_scc1 L_body0
    s_lshr_b32 s36, s2, 5
    s_add_u32 s36, s36, 48
    s_lshl_b32 s36, s36, 7
    v_mov_b32 v12, s36
    global_load_dword v11, v12, s[90:91] sc1
    s_sub_u32 s36, 32, s50
    s_cmp_lt_i32 s36, 0
    s_cbranch_scc0 L_recurrent_scan__compressed_kv_cla__moe_arch_mod__prompt_kernel_rare_89
L_recurrent_scan__compressed_kv_cla__moe_arch_mod__prompt_kernel_back_90:
    s_lshl_b32 s37, s28, 13
    v_add_u32 v5, s37, v7
    s_waitcnt lgkmcnt(5)
    v_mfma_f32_16x16x32_bf16 v[192:195], v[64:67], v[48:51], v[192:195]
    v_exp_f32 v112, v112
    v_mfma_f32_16x16x32_bf16 v[224:227], v[64:67], v[52:55], v[224:227]
    ds_read_b128 v[92:95], v3 offset:7168
    v_exp_f32 v113, v113
    v_mfma_f32_16x16x32_bf16 v[196:199], v[68:71], v[48:51], v[196:199]
    v_cvt_pk_bf16_f32 v56, v112, v113
    v_exp_f32 v114, v114
    v_mfma_f32_16x16x32_bf16 v[228:231], v[68:71], v[52:55], v[228:231]
    ds_read_b128 v[64:67], v3 offset:8192
    v_exp_f32 v115, v115
    s_waitcnt lgkmcnt(5)
    v_mfma_f32_16x16x32_bf16 v[200:203], v[72:75], v[48:51], v[200:203]
    v_cvt_pk_bf16_f32 v57, v114, v115
    v_exp_f32 v120, v120
    v_mfma_f32_16x16x32_bf16 v[232:235], v[72:75], v[52:55], v[232:235]
    v_mfma_f32_16x16x32_bf16 v[28:31], v[36:39], v[48:51], v[28:31]
    ds_read_b128 v[68:71], v3 offset:9216
    v_exp_f32 v121, v121
    v_mfma_f32_16x16x32_bf16 v[204:207], v[76:79], v[48:51], v[204:207]
    v_cvt_pk_bf16_f32 v60, v120, v121
    v_exp_f32 v122, v122
    v_mfma_f32_16x16x32_bf16 v[236:239], v[76:79], v[52:55], v[236:239]
    ds_read_b128 v[72:75], v3 offset:10240
    v_exp_f32 v123, v123
    s_waitcnt lgkmcnt(6)
    v_mfma_f32_16x16x32_bf16 v[208:211], v[80:83], v[48:51], v[208:211]
    v_cvt_pk_bf16_f32 v61, v122, v123
    v_exp_f32 v116, v116
    v_mfma_f32_16x16x32_bf16 v[240:243], v[80:83], v[52:55], v[240:243]
    ds_read_b128 v[76:79], v3 offset:11264
    v_exp_f32 v117, v117
    s_waitcnt lgkmcnt(6)
    v_mfma_f32_16x16x32_bf16 v[212:215], v[84:87], v[48:51], v[212:215]
    v_cvt_pk_bf16_f32 v58, v116, v117
    v_exp_f32 v118, v118
    v_mfma_f32_16x16x32_bf16 v[244:247], v[84:87], v[52:55], v[244:247]
    ds_read_b128 v[80:83], v3 offset:12288
    v_exp_f32 v119, v119
    s_waitcnt lgkmcnt(6)
    v_mfma_f32_16x16x32_bf16 v[216:219], v[88:91], v[48:51], v[216:219]
    v_cvt_pk_bf16_f32 v59, v118, v119
    v_exp_f32 v124, v124
    v_mfma_f32_16x16x32_bf16 v[248:251], v[88:91], v[52:55], v[248:251]
    v_mfma_f32_16x16x32_bf16 v[32:35], v[36:39], v[52:55], v[32:35]
    ds_read_b128 v[84:87], v3 offset:13312
    v_exp_f32 v125, v125
    s_waitcnt lgkmcnt(6)
    v_mfma_f32_16x16x32_bf16 v[220:223], v[92:95], v[48:51], v[220:223]
    v_cvt_pk_bf16_f32 v62, v124, v125
    v_exp_f32 v126, v126
    v_mfma_f32_16x16x32_bf16 v[252:255], v[92:95], v[52:55], v[252:255]
    ds_read_b128 v[88:91], v3 offset:14336
    v_exp_f32 v127, v127
    s_nop 0
    v_cvt_pk_bf16_f32 v63, v126, v127
    s_nop 1
    s_waitcnt lgkmcnt(6)
    v_mfma_f32_16x16x32_bf16 v[192:195], v[64:67], v[56:59], v[192:195]
    s_mov_b32 s4, s34
    s_and_b32 s5, s35, 0xffff
    s_mov_b32 s6, 7340032
    s_mov_b32 s7, 0x20000
    s_mov_b32 s8, s32
    v_mfma_f32_16x16x32_bf16 v[224:227], v[64:67], v[60:63], v[224:227]
    ds_read_b128 v[92:95], v3 offset:15360
    s_and_b32 s9, s33, 0xffff
    s_mov_b32 s10, 8388608
    s_mov_b32 s11, 0x20000
    s_lshr_b32 s38, s2, 4
    s_waitcnt lgkmcnt(6)
    v_mfma_f32_16x16x32_bf16 v[196:199], v[68:71], v[56:59], v[196:199]
    s_mul_i32 s38, s38, 224
    s_and_b32 s39, s2, 15
    s_lshl_b32 s39, s39, 7
    v_lshrrev_b32 v25, 3, v1
    s_lshl_b32 s36, s28, 5
    v_mfma_f32_16x16x32_bf16 v[228:231], v[68:71], v[60:63], v[228:231]
    s_add_u32 s36, s36, s38
    v_add_u32 v25, s36, v25
    v_mul_u32_u24 v25, 2048, v25
    v_add_u32 v25, s39, v25
    s_waitcnt lgkmcnt(5)
    v_mfma_f32_16x16x32_bf16 v[200:203], v[72:75], v[56:59], v[200:203]
    v_bfe_u32 v26, v1, 4, 1
    v_lshlrev_b32 v26, 1, v26
    v_and_b32 v27, 7, v1
    v_xor_b32 v26, v26, v27
    v_mfma_f32_16x16x32_bf16 v[232:235], v[72:75], v[60:63], v[232:235]
    v_mfma_f32_16x16x32_bf16 v[28:31], v[36:39], v[56:59], v[28:31]
    v_lshl_add_u32 v24, v26, 4, v25
    v_xor_b32 v26, 4, v26
    v_lshl_add_u32 v25, v26, 4, v25
    v_add_u32 v25, 15360, v25
    v_add_u32 v26, 30720, v24
    s_waitcnt lgkmcnt(4)
    v_mfma_f32_16x16x32_bf16 v[204:207], v[76:79], v[56:59], v[204:207]
    v_add_u32 v27, 30720, v25
    s_lshl_b32 s36, s28, 12
    s_add_u32 s36, s36, 131072
    s_cmp_lt_u32 s28, 7
    s_cselect_b32 m0, s36, 0x30000
    s_cselect_b32 s6, 7340032, 0
    v_mfma_f32_16x16x32_bf16 v[236:239], v[76:79], v[60:63], v[236:239]
    buffer_load_dwordx4 v24, s[4:7], 0 offen offset:0 lds
    buffer_load_dwordx4 v25, s[4:7], 0 offen offset:1024 lds
    buffer_load_dwordx4 v26, s[4:7], 0 offen offset:2048 lds
    buffer_load_dwordx4 v27, s[4:7], 0 offen offset:3072 lds
    s_waitcnt lgkmcnt(3)
    v_mfma_f32_16x16x32_bf16 v[208:211], v[80:83], v[56:59], v[208:211]
    v_mfma_f32_16x16x32_bf16 v[240:243], v[80:83], v[60:63], v[240:243]
    ds_write_b128 v5, v[224:227] offset:0
    s_waitcnt lgkmcnt(3)
    v_mfma_f32_16x16x32_bf16 v[212:215], v[84:87], v[56:59], v[212:215]
    v_mfma_f32_16x16x32_bf16 v[244:247], v[84:87], v[60:63], v[244:247]
    ds_write_b128 v5, v[228:231] offset:1024
    s_waitcnt lgkmcnt(3)
    v_mfma_f32_16x16x32_bf16 v[216:219], v[88:91], v[56:59], v[216:219]
    v_mfma_f32_16x16x32_bf16 v[248:251], v[88:91], v[60:63], v[248:251]
    v_mfma_f32_16x16x32_bf16 v[32:35], v[36:39], v[60:63], v[32:35]
    ds_write_b128 v5, v[232:235] offset:2048
    s_waitcnt lgkmcnt(3)
    v_mfma_f32_16x16x32_bf16 v[220:223], v[92:95], v[56:59], v[220:223]
    v_mfma_f32_16x16x32_bf16 v[252:255], v[92:95], v[60:63], v[252:255]
    ds_write_b128 v5, v[236:239] offset:3072
    ds_write_b128 v5, v[240:243] offset:4096
    ds_write_b128 v5, v[244:247] offset:5120
    v_xor_b32 v106, 32768, v5
    s_lshl_b32 s37, s28, 8
    s_add_u32 s37, s37, 159744
    v_lshl_add_u32 v107, v1, 2, s37
    v_xor_b32 v108, 1024, v107
    ds_write_b128 v5, v[248:251] offset:6144
    ds_write_b128 v5, v[252:255] offset:7168
    ds_write_b32 v107, v32
    s_mov_b32 s36, 0x5d800000
    v_cmp_nge_f32 vcc, s36, v28
    s_nop 0
    s_or_b64 s[52:53], s[52:53], vcc
    v_cmp_nge_f32 vcc, s36, v32
    s_nop 0
    s_or_b64 s[52:53], s[52:53], vcc
    s_or_b32 s36, s52, s53
    v_mov_b32 v110, s36
    s_lshl_b32 s37, s28, 2
    s_add_u32 s37, s37, 161792
    v_mov_b32 v111, s37
    ds_write_b32 v111, v110
    v_mov_b32 v112, 161856
    v_mov_b32 v114, s56
    v_mov_b32 v115, s57
    v_mov_b32 v116, s58
    v_mov_b32 v117, s59
    ds_write_b128 v112, v[114:117]
    v_and_b32 v111, 7, v1
    v_lshlrev_b32 v111, 2, v111
    v_add_u32 v111, 161792, v111
    v_mov_b32 v113, v7
    s_sub_u32 s36, 15, s30
    s_lshl_b32 s38, s36, 3
    s_and_b32 s37, s28, 3
    s_lshl_b32 s37, s37, 1
    s_add_u32 s38, s38, s37
    s_lshl_b32 s38, s38, 17
    s_lshl_b32 s37, s29, 12
    s_add_u32 s38, s38, s37
    s_waitcnt vmcnt(4)
    v_readfirstlane_b32 s36, v11
    s_nop 0
    s_cmp_lt_u32 s36, 28
    s_cbranch_scc1 L_recurrent_scan__compressed_kv_cla__moe_arch_mod__prompt_kernel_rare_93
L_recurrent_scan__compressed_kv_cla__moe_arch_mod__prompt_kernel_back_94:
    s_lshr_b32 s36, s2, 4
    s_mul_i32 s36, s36, 7
    s_min_u32 s37, s28, 6
    s_add_u32 s36, s36, s37
    s_lshl_b32 s36, s36, 11
    s_add_u32 s36, s36, 58720256
    v_and_b32 v11, 15, v1
    v_lshlrev_b32 v11, 4, v11
    v_lshrrev_b32 v12, 4, v1
    v_lshl_add_u32 v11, v12, 9, v11
    buffer_load_dwordx4 v[96:99], v11, s[24:27], s36 offen offset:0 sc1
    buffer_load_dwordx4 v[100:103], v11, s[24:27], s36 offen offset:256 sc1
    s_waitcnt lgkmcnt(0)
    s_barrier
    ds_read_b32 v110, v111
    ds_read_b32 v109, v108
    ds_read_b128 v[64:67], v106 offset:0
    ds_read_b128 v[68:71], v106 offset:1024
    ds_read_b128 v[72:75], v106 offset:2048
    ds_read_b128 v[76:79], v106 offset:3072
    ds_read_b128 v[80:83], v106 offset:4096
    ds_read_b128 v[84:87], v106 offset:5120
    ds_read_b128 v[88:91], v106 offset:6144
    ds_read_b128 v[92:95], v106 offset:7168
    s_waitcnt lgkmcnt(8)
    v_add_f32 v109, v109, v28
    v_cmp_ne_u32 s[52:53], 0, v110
    v_rcp_f32 v109, v109
    s_nop 0
    v_mov_b32 v108, v109
    s_waitcnt lgkmcnt(6)
    v_pk_add_f32 v[192:193], v[192:193], v[64:65]
    v_pk_add_f32 v[194:195], v[194:195], v[66:67]
    v_pk_add_f32 v[196:197], v[196:197], v[68:69]
    v_pk_add_f32 v[198:199], v[198:199], v[70:71]
    v_pk_mul_f32 v[192:193], v[192:193], v[108:109]
    v_pk_mul_f32 v[194:195], v[194:195], v[108:109]
    v_pk_mul_f32 v[196:197], v[196:197], v[108:109]
    v_pk_mul_f32 v[198:199], v[198:199], v[108:109]
    v_cvt_pk_bf16_f32 v48, v192, v193
    v_cvt_pk_bf16_f32 v49, v194, v195
    v_cvt_pk_bf16_f32 v50, v196, v197
    v_cvt_pk_bf16_f32 v51, v198, v199
    buffer_store_dwordx4 v[48:51], v113, s[16:19], s38 offen offset:0 sc1
    s_waitcnt lgkmcnt(4)
    v_pk_add_f32 v[200:201], v[200:201], v[72:73]
    v_pk_add_f32 v[202:203], v[202:203], v[74:75]
    v_pk_add_f32 v[204:205], v[204:205], v[76:77]
    v_pk_add_f32 v[206:207], v[206:207], v[78:79]
    v_pk_mul_f32 v[200:201], v[200:201], v[108:109]
    v_pk_mul_f32 v[202:203], v[202:203], v[108:109]
    v_pk_mul_f32 v[204:205], v[204:205], v[108:109]
    v_pk_mul_f32 v[206:207], v[206:207], v[108:109]
    v_cvt_pk_bf16_f32 v52, v200, v201
    v_cvt_pk_bf16_f32 v53, v202, v203
    v_cvt_pk_bf16_f32 v54, v204, v205
    v_cvt_pk_bf16_f32 v55, v206, v207
    buffer_store_dwordx4 v[52:55], v113, s[16:19], s38 offen offset:1024 sc1
    s_waitcnt lgkmcnt(2)
    v_pk_add_f32 v[208:209], v[208:209], v[80:81]
    v_pk_add_f32 v[210:211], v[210:211], v[82:83]
    v_pk_add_f32 v[212:213], v[212:213], v[84:85]
    v_pk_add_f32 v[214:215], v[214:215], v[86:87]
    v_pk_mul_f32 v[208:209], v[208:209], v[108:109]
    v_pk_mul_f32 v[210:211], v[210:211], v[108:109]
    v_pk_mul_f32 v[212:213], v[212:213], v[108:109]
    v_pk_mul_f32 v[214:215], v[214:215], v[108:109]
    v_cvt_pk_bf16_f32 v56, v208, v209
    v_cvt_pk_bf16_f32 v57, v210, v211
    v_cvt_pk_bf16_f32 v58, v212, v213
    v_cvt_pk_bf16_f32 v59, v214, v215
    buffer_store_dwordx4 v[56:59], v113, s[16:19], s38 offen offset:2048 sc1
    s_waitcnt lgkmcnt(0)
    v_pk_add_f32 v[216:217], v[216:217], v[88:89]
    v_pk_add_f32 v[218:219], v[218:219], v[90:91]
    v_pk_add_f32 v[220:221], v[220:221], v[92:93]
    v_pk_add_f32 v[222:223], v[222:223], v[94:95]
    v_pk_mul_f32 v[216:217], v[216:217], v[108:109]
    v_pk_mul_f32 v[218:219], v[218:219], v[108:109]
    v_pk_mul_f32 v[220:221], v[220:221], v[108:109]
    v_pk_mul_f32 v[222:223], v[222:223], v[108:109]
    v_cvt_pk_bf16_f32 v60, v216, v217
    v_cvt_pk_bf16_f32 v61, v218, v219
    v_cvt_pk_bf16_f32 v62, v220, v221
    v_cvt_pk_bf16_f32 v63, v222, v223
    buffer_store_dwordx4 v[60:63], v113, s[16:19], s38 offen offset:3072 sc1
    s_cmp_eq_u64 s[52:53], 0
    s_cbranch_scc1 L_p3_done
    s_waitcnt vmcnt(0)
    v_mov_b32 v112, v96
    v_mov_b32 v113, v97
    v_mov_b32 v114, v98
    v_mov_b32 v115, v99
    v_mov_b32 v116, v100
    v_mov_b32 v117, v101
    v_mov_b32 v118, v102
    v_mov_b32 v119, v103
    v_mov_b32 v192, 0
    v_mov_b32 v193, 0
    v_mov_b32 v194, 0
    v_mov_b32 v195, 0
    v_mov_b32 v196, 0
    v_mov_b32 v197, 0
    v_mov_b32 v198, 0
    v_mov_b32 v199, 0
    v_mov_b32 v200, 0
    v_mov_b32 v201, 0
    v_mov_b32 v202, 0
    v_mov_b32 v203, 0
    v_mov_b32 v204, 0
    v_mov_b32 v205, 0
    v_mov_b32 v206, 0
    v_mov_b32 v207, 0
    v_mov_b32 v208, 0
    v_mov_b32 v209, 0
    v_mov_b32 v210, 0
    v_mov_b32 v211, 0
    v_mov_b32 v212, 0
    v_mov_b32 v213, 0
    v_mov_b32 v214, 0
    v_mov_b32 v215, 0
    v_mov_b32 v216, 0
    v_mov_b32 v217, 0
    v_mov_b32 v218, 0
    v_mov_b32 v219, 0
    v_mov_b32 v220, 0
    v_mov_b32 v221, 0
    v_mov_b32 v222, 0
    v_mov_b32 v223, 0
    v_mov_b32 v224, 0
    v_mov_b32 v225, 0
    v_mov_b32 v226, 0
    v_mov_b32 v227, 0
    v_mov_b32 v228, 0
    v_mov_b32 v229, 0
    v_mov_b32 v230, 0
    v_mov_b32 v231, 0
    v_mov_b32 v232, 0
    v_mov_b32 v233, 0
    v_mov_b32 v234, 0
    v_mov_b32 v235, 0
    v_mov_b32 v236, 0
    v_mov_b32 v237, 0
    v_mov_b32 v238, 0
    v_mov_b32 v239, 0
    v_mov_b32 v240, 0
    v_mov_b32 v241, 0
    v_mov_b32 v242, 0
    v_mov_b32 v243, 0
    v_mov_b32 v244, 0
    v_mov_b32 v245, 0
    v_mov_b32 v246, 0
    v_mov_b32 v247, 0
    v_mov_b32 v248, 0
    v_mov_b32 v249, 0
    v_mov_b32 v250, 0
    v_mov_b32 v251, 0
    v_mov_b32 v252, 0
    v_mov_b32 v253, 0
    v_mov_b32 v254, 0
    v_mov_b32 v255, 0
    v_mov_b32 v28, 0
    v_mov_b32 v40, 4048155338
    v_mov_b32 v32, 0
    v_mov_b32 v41, 4048155338
    s_lshl_b32 s43, s28, 12
    v_add_u32 v4, s43, v7
    s_mov_b32 s46, s45
    s_sub_u32 s40, 16, s30
    s_sub_u32 s39, 15, s30
    s_lshl_b32 s37, s39, 7
    s_and_b32 s36, s28, 3
    s_lshl_b32 s36, s36, 5
    s_add_u32 s36, s36, s37
    s_sub_u32 s50, 0, s36
L_recurrent_scan__compressed_kv_cla__moe_arch_mod__prompt_kernel_stile_95:
    s_waitcnt vmcnt(0) lgkmcnt(0)
    s_barrier
    s_mov_b32 m0, s43
    s_add_u32 s47, s46, 32768
    buffer_load_dwordx4 v4, s[12:15], s46 offen offset:0 sc1 lds
    buffer_load_dwordx4 v4, s[12:15], s46 offen offset:1024 sc1 lds
    buffer_load_dwordx4 v4, s[12:15], s46 offen offset:2048 sc1 lds
    buffer_load_dwordx4 v4, s[12:15], s46 offen offset:3072 sc1 lds
    s_add_u32 m0, s43, 32768
    s_add_u32 s46, s46, 65536
    buffer_load_dwordx4 v4, s[12:15], s47 offen offset:0 sc1 lds
    buffer_load_dwordx4 v4, s[12:15], s47 offen offset:1024 sc1 lds
    buffer_load_dwordx4 v4, s[12:15], s47 offen offset:2048 sc1 lds
    buffer_load_dwordx4 v4, s[12:15], s47 offen offset:3072 sc1 lds
    v_mov_b32 v2, v7
    s_mov_b32 s41, 4
    s_waitcnt vmcnt(0)
    s_barrier
L_recurrent_scan__compressed_kv_cla__moe_arch_mod__prompt_kernel_sunit_96:
    s_cmp_gt_i32 s50, 0
    s_cbranch_scc1 L_recurrent_scan__compressed_kv_cla__moe_arch_mod__prompt_kernel_snext_97
    ds_read_b128 v[64:67], v2 offset:0
    ds_read_b128 v[68:71], v2 offset:1024
    ds_read_b128 v[72:75], v2 offset:2048
    ds_read_b128 v[76:79], v2 offset:3072
    ds_read_b128 v[80:83], v2 offset:4096
    ds_read_b128 v[84:87], v2 offset:5120
    ds_read_b128 v[88:91], v2 offset:6144
    ds_read_b128 v[92:95], v2 offset:7168
    s_waitcnt lgkmcnt(0)
    v_mfma_f32_16x16x32_bf16 v[96:99], v[64:67], v[128:131], 0
    v_mfma_f32_16x16x32_bf16 v[104:107], v[64:67], v[144:147], 0
    v_mfma_f32_16x16x32_bf16 v[96:99], v[68:71], v[132:135], v[96:99]
    v_mfma_f32_16x16x32_bf16 v[104:107], v[68:71], v[148:151], v[104:107]
    v_mfma_f32_16x16x32_bf16 v[96:99], v[72:75], v[136:139], v[96:99]
    v_mfma_f32_16x16x32_bf16 v[104:107], v[72:75], v[152:155], v[104:107]
    v_mfma_f32_16x16x32_bf16 v[96:99], v[76:79], v[140:143], v[96:99]
    v_mfma_f32_16x16x32_bf16 v[104:107], v[76:79], v[156:159], v[104:107]
    v_mfma_f32_16x16x32_bf16 v[100:103], v[80:83], v[128:131], 0
    v_mfma_f32_16x16x32_bf16 v[108:111], v[80:83], v[144:147], 0
    v_mfma_f32_16x16x32_bf16 v[100:103], v[84:87], v[132:135], v[100:103]
    v_mfma_f32_16x16x32_bf16 v[108:111], v[84:87], v[148:151], v[108:111]
    v_mfma_f32_16x16x32_bf16 v[100:103], v[88:91], v[136:139], v[100:103]
    v_mfma_f32_16x16x32_bf16 v[108:111], v[88:91], v[152:155], v[108:111]
    v_mfma_f32_16x16x32_bf16 v[100:103], v[92:95], v[140:143], v[100:103]
    v_mfma_f32_16x16x32_bf16 v[108:111], v[92:95], v[156:159], v[108:111]
    ds_read_b128 v[64:67], v2 offset:32768
    ds_read_b128 v[68:71], v2 offset:33792
    ds_read_b128 v[72:75], v2 offset:34816
    ds_read_b128 v[76:79], v2 offset:35840
    ds_read_b128 v[80:83], v2 offset:36864
    ds_read_b128 v[84:87], v2 offset:37888
    ds_read_b128 v[88:91], v2 offset:38912
    ds_read_b128 v[92:95], v2 offset:39936
    s_nop 1
    s_cmp_lt_i32 s50, 0
    s_cbranch_scc0 L_recurrent_scan__compressed_kv_cla__moe_arch_mod__prompt_kernel_rare_98
L_recurrent_scan__compressed_kv_cla__moe_arch_mod__prompt_kernel_back_99:
    v_max3_f32 v22, v96, v97, v98
    v_max3_f32 v22, v22, v99, v100
    v_max3_f32 v22, v22, v101, v102
    v_max3_f32 v22, v22, v103, v40
    v_mov_b32 v24, v22
    s_nop 1
    v_permlane16_swap_b32 v22, v24
    s_nop 1
    v_max_f32 v22, v22, v24
    v_mov_b32 v24, v22
    s_nop 1
    v_permlane32_swap_b32 v22, v24
    s_nop 1
    v_max_f32 v22, v22, v24
    v_sub_f32 v25, v40, v22
    v_exp_f32 v25, v25
    v_mov_b32 v40, v22
    v_mul_f32 v28, v28, v25
    v_mul_f32 v192, v192, v25
    v_mul_f32 v193, v193, v25
    v_mul_f32 v194, v194, v25
    v_mul_f32 v195, v195, v25
    v_mul_f32 v196, v196, v25
    v_mul_f32 v197, v197, v25
    v_mul_f32 v198, v198, v25
    v_mul_f32 v199, v199, v25
    v_mul_f32 v200, v200, v25
    v_mul_f32 v201, v201, v25
    v_mul_f32 v202, v202, v25
    v_mul_f32 v203, v203, v25
    v_mul_f32 v204, v204, v25
    v_mul_f32 v205, v205, v25
    v_mul_f32 v206, v206, v25
    v_mul_f32 v207, v207, v25
    v_mul_f32 v208, v208, v25
    v_mul_f32 v209, v209, v25
    v_mul_f32 v210, v210, v25
    v_mul_f32 v211, v211, v25
    v_mul_f32 v212, v212, v25
    v_mul_f32 v213, v213, v25
    v_mul_f32 v214, v214, v25
    v_mul_f32 v215, v215, v25
    v_mul_f32 v216, v216, v25
    v_mul_f32 v217, v217, v25
    v_mul_f32 v218, v218, v25
    v_mul_f32 v219, v219, v25
    v_mul_f32 v220, v220, v25
    v_mul_f32 v221, v221, v25
    v_mul_f32 v222, v222, v25
    v_mul_f32 v223, v223, v25
    v_sub_f32 v96, v96, v22
    v_sub_f32 v97, v97, v22
    v_sub_f32 v98, v98, v22
    v_sub_f32 v99, v99, v22
    v_sub_f32 v100, v100, v22
    v_sub_f32 v101, v101, v22
    v_sub_f32 v102, v102, v22
    v_sub_f32 v103, v103, v22
    v_max3_f32 v23, v104, v105, v106
    v_max3_f32 v23, v23, v107, v108
    v_max3_f32 v23, v23, v109, v110
    v_max3_f32 v23, v23, v111, v41
    v_mov_b32 v24, v23
    s_nop 1
    v_permlane16_swap_b32 v23, v24
    s_nop 1
    v_max_f32 v23, v23, v24
    v_mov_b32 v24, v23
    s_nop 1
    v_permlane32_swap_b32 v23, v24
    s_nop 1
    v_max_f32 v23, v23, v24
    v_sub_f32 v25, v41, v23
    v_exp_f32 v25, v25
    v_mov_b32 v41, v23
    v_mul_f32 v32, v32, v25
    v_mul_f32 v224, v224, v25
    v_mul_f32 v225, v225, v25
    v_mul_f32 v226, v226, v25
    v_mul_f32 v227, v227, v25
    v_mul_f32 v228, v228, v25
    v_mul_f32 v229, v229, v25
    v_mul_f32 v230, v230, v25
    v_mul_f32 v231, v231, v25
    v_mul_f32 v232, v232, v25
    v_mul_f32 v233, v233, v25
    v_mul_f32 v234, v234, v25
    v_mul_f32 v235, v235, v25
    v_mul_f32 v236, v236, v25
    v_mul_f32 v237, v237, v25
    v_mul_f32 v238, v238, v25
    v_mul_f32 v239, v239, v25
    v_mul_f32 v240, v240, v25
    v_mul_f32 v241, v241, v25
    v_mul_f32 v242, v242, v25
    v_mul_f32 v243, v243, v25
    v_mul_f32 v244, v244, v25
    v_mul_f32 v245, v245, v25
    v_mul_f32 v246, v246, v25
    v_mul_f32 v247, v247, v25
    v_mul_f32 v248, v248, v25
    v_mul_f32 v249, v249, v25
    v_mul_f32 v250, v250, v25
    v_mul_f32 v251, v251, v25
    v_mul_f32 v252, v252, v25
    v_mul_f32 v253, v253, v25
    v_mul_f32 v254, v254, v25
    v_mul_f32 v255, v255, v25
    v_sub_f32 v104, v104, v23
    v_sub_f32 v105, v105, v23
    v_sub_f32 v106, v106, v23
    v_sub_f32 v107, v107, v23
    v_sub_f32 v108, v108, v23
    v_sub_f32 v109, v109, v23
    v_sub_f32 v110, v110, v23
    v_sub_f32 v111, v111, v23
    v_exp_f32 v96, v96
    v_exp_f32 v97, v97
    v_exp_f32 v98, v98
    v_exp_f32 v99, v99
    v_exp_f32 v104, v104
    v_exp_f32 v105, v105
    v_exp_f32 v106, v106
    v_exp_f32 v107, v107
    v_exp_f32 v100, v100
    v_exp_f32 v101, v101
    v_exp_f32 v102, v102
    v_exp_f32 v103, v103
    v_exp_f32 v108, v108
    v_exp_f32 v109, v109
    v_exp_f32 v110, v110
    v_exp_f32 v111, v111
    v_add_f32 v28, v28, v96
    v_add_f32 v28, v28, v97
    v_cvt_pk_bf16_f32 v48, v96, v97
    v_add_f32 v28, v28, v98
    v_add_f32 v28, v28, v99
    v_cvt_pk_bf16_f32 v49, v98, v99
    v_add_f32 v32, v32, v104
    v_add_f32 v32, v32, v105
    v_cvt_pk_bf16_f32 v52, v104, v105
    v_add_f32 v32, v32, v106
    v_add_f32 v32, v32, v107
    v_cvt_pk_bf16_f32 v53, v106, v107
    v_add_f32 v28, v28, v100
    v_add_f32 v28, v28, v101
    v_cvt_pk_bf16_f32 v50, v100, v101
    v_add_f32 v28, v28, v102
    v_add_f32 v28, v28, v103
    v_cvt_pk_bf16_f32 v51, v102, v103
    v_add_f32 v32, v32, v108
    v_add_f32 v32, v32, v109
    v_cvt_pk_bf16_f32 v54, v108, v109
    v_add_f32 v32, v32, v110
    v_add_f32 v32, v32, v111
    v_cvt_pk_bf16_f32 v55, v110, v111
    s_waitcnt lgkmcnt(0)
    s_nop 0
    v_mfma_f32_16x16x32_bf16 v[192:195], v[64:67], v[48:51], v[192:195]
    v_mfma_f32_16x16x32_bf16 v[224:227], v[64:67], v[52:55], v[224:227]
    v_mfma_f32_16x16x32_bf16 v[196:199], v[68:71], v[48:51], v[196:199]
    v_mfma_f32_16x16x32_bf16 v[228:231], v[68:71], v[52:55], v[228:231]
    v_mfma_f32_16x16x32_bf16 v[200:203], v[72:75], v[48:51], v[200:203]
    v_mfma_f32_16x16x32_bf16 v[232:235], v[72:75], v[52:55], v[232:235]
    v_mfma_f32_16x16x32_bf16 v[204:207], v[76:79], v[48:51], v[204:207]
    v_mfma_f32_16x16x32_bf16 v[236:239], v[76:79], v[52:55], v[236:239]
    v_mfma_f32_16x16x32_bf16 v[208:211], v[80:83], v[48:51], v[208:211]
    v_mfma_f32_16x16x32_bf16 v[240:243], v[80:83], v[52:55], v[240:243]
    v_mfma_f32_16x16x32_bf16 v[212:215], v[84:87], v[48:51], v[212:215]
    v_mfma_f32_16x16x32_bf16 v[244:247], v[84:87], v[52:55], v[244:247]
    v_mfma_f32_16x16x32_bf16 v[216:219], v[88:91], v[48:51], v[216:219]
    v_mfma_f32_16x16x32_bf16 v[248:251], v[88:91], v[52:55], v[248:251]
    v_mfma_f32_16x16x32_bf16 v[220:223], v[92:95], v[48:51], v[220:223]
    v_mfma_f32_16x16x32_bf16 v[252:255], v[92:95], v[52:55], v[252:255]
L_recurrent_scan__compressed_kv_cla__moe_arch_mod__prompt_kernel_snext_97:
    v_add_u32 v2, 8192, v2
    s_add_u32 s50, s50, 32
    s_sub_u32 s41, s41, 1
    s_cmp_lg_u32 s41, 0
    s_cbranch_scc1 L_recurrent_scan__compressed_kv_cla__moe_arch_mod__prompt_kernel_sunit_96
    s_sub_u32 s40, s40, 1
    s_cmp_lg_u32 s40, 0
    s_cbranch_scc1 L_recurrent_scan__compressed_kv_cla__moe_arch_mod__prompt_kernel_stile_95
    v_mov_b32 v20, v28
    s_nop 1
    v_permlane16_swap_b32 v28, v20
    s_nop 1
    v_add_f32 v28, v28, v20
    v_mov_b32 v20, v28
    s_nop 1
    v_permlane32_swap_b32 v28, v20
    s_nop 1
    v_add_f32 v28, v28, v20
    v_mov_b32 v20, v32
    s_nop 1
    v_permlane16_swap_b32 v32, v20
    s_nop 1
    v_add_f32 v32, v32, v20
    v_mov_b32 v20, v32
    s_nop 1
    v_permlane32_swap_b32 v32, v20
    s_nop 1
    v_add_f32 v32, v32, v20
    s_mov_b32 s36, 0x5d800000
    v_cmp_nge_f32 vcc, s36, v28
    s_nop 0
    s_or_b64 s[52:53], s[52:53], vcc
    v_cmp_nge_f32 vcc, s36, v32
    s_nop 0
    s_or_b64 s[52:53], s[52:53], vcc
    v_rcp_f32 v20, v28
    v_rcp_f32 v22, v32
    s_lshl_b32 s38, s39, 3
    s_and_b32 s37, s28, 3
    s_lshl_b32 s37, s37, 1
    s_add_u32 s38, s38, s37
    s_lshl_b32 s38, s38, 17
    s_lshl_b32 s37, s29, 12
    s_add_u32 s38, s38, s37
    v_mov_b32 v21, v20
    v_mov_b32 v23, v22
    v_mov_b32 v24, v7
    v_pk_mul_f32 v[192:193], v[192:193], v[20:21]
    v_pk_mul_f32 v[194:195], v[194:195], v[20:21]
    v_pk_mul_f32 v[196:197], v[196:197], v[20:21]
    v_pk_mul_f32 v[198:199], v[198:199], v[20:21]
    v_cvt_pk_bf16_f32 v192, v192, v193
    v_cvt_pk_bf16_f32 v193, v194, v195
    v_cvt_pk_bf16_f32 v194, v196, v197
    v_cvt_pk_bf16_f32 v195, v198, v199
    buffer_store_dwordx4 v[192:195], v24, s[16:19], s38 offen offset:0 sc1
    v_pk_mul_f32 v[200:201], v[200:201], v[20:21]
    v_pk_mul_f32 v[202:203], v[202:203], v[20:21]
    v_pk_mul_f32 v[204:205], v[204:205], v[20:21]
    v_pk_mul_f32 v[206:207], v[206:207], v[20:21]
    v_cvt_pk_bf16_f32 v200, v200, v201
    v_cvt_pk_bf16_f32 v201, v202, v203
    v_cvt_pk_bf16_f32 v202, v204, v205
    v_cvt_pk_bf16_f32 v203, v206, v207
    buffer_store_dwordx4 v[200:203], v24, s[16:19], s38 offen offset:1024 sc1
    v_pk_mul_f32 v[208:209], v[208:209], v[20:21]
    v_pk_mul_f32 v[210:211], v[210:211], v[20:21]
    v_pk_mul_f32 v[212:213], v[212:213], v[20:21]
    v_pk_mul_f32 v[214:215], v[214:215], v[20:21]
    v_cvt_pk_bf16_f32 v208, v208, v209
    v_cvt_pk_bf16_f32 v209, v210, v211
    v_cvt_pk_bf16_f32 v210, v212, v213
    v_cvt_pk_bf16_f32 v211, v214, v215
    buffer_store_dwordx4 v[208:211], v24, s[16:19], s38 offen offset:2048 sc1
    v_pk_mul_f32 v[216:217], v[216:217], v[20:21]
    v_pk_mul_f32 v[218:219], v[218:219], v[20:21]
    v_pk_mul_f32 v[220:221], v[220:221], v[20:21]
    v_pk_mul_f32 v[222:223], v[222:223], v[20:21]
    v_cvt_pk_bf16_f32 v216, v216, v217
    v_cvt_pk_bf16_f32 v217, v218, v219
    v_cvt_pk_bf16_f32 v218, v220, v221
    v_cvt_pk_bf16_f32 v219, v222, v223
    buffer_store_dwordx4 v[216:219], v24, s[16:19], s38 offen offset:3072 sc1
    s_add_u32 s38, s38, 131072
    v_pk_mul_f32 v[224:225], v[224:225], v[22:23]
    v_pk_mul_f32 v[226:227], v[226:227], v[22:23]
    v_pk_mul_f32 v[228:229], v[228:229], v[22:23]
    v_pk_mul_f32 v[230:231], v[230:231], v[22:23]
    v_cvt_pk_bf16_f32 v224, v224, v225
    v_cvt_pk_bf16_f32 v225, v226, v227
    v_cvt_pk_bf16_f32 v226, v228, v229
    v_cvt_pk_bf16_f32 v227, v230, v231
    buffer_store_dwordx4 v[224:227], v24, s[16:19], s38 offen offset:0 sc1
    v_pk_mul_f32 v[232:233], v[232:233], v[22:23]
    v_pk_mul_f32 v[234:235], v[234:235], v[22:23]
    v_pk_mul_f32 v[236:237], v[236:237], v[22:23]
    v_pk_mul_f32 v[238:239], v[238:239], v[22:23]
    v_cvt_pk_bf16_f32 v232, v232, v233
    v_cvt_pk_bf16_f32 v233, v234, v235
    v_cvt_pk_bf16_f32 v234, v236, v237
    v_cvt_pk_bf16_f32 v235, v238, v239
    buffer_store_dwordx4 v[232:235], v24, s[16:19], s38 offen offset:1024 sc1
    v_pk_mul_f32 v[240:241], v[240:241], v[22:23]
    v_pk_mul_f32 v[242:243], v[242:243], v[22:23]
    v_pk_mul_f32 v[244:245], v[244:245], v[22:23]
    v_pk_mul_f32 v[246:247], v[246:247], v[22:23]
    v_cvt_pk_bf16_f32 v240, v240, v241
    v_cvt_pk_bf16_f32 v241, v242, v243
    v_cvt_pk_bf16_f32 v242, v244, v245
    v_cvt_pk_bf16_f32 v243, v246, v247
    buffer_store_dwordx4 v[240:243], v24, s[16:19], s38 offen offset:2048 sc1
    v_pk_mul_f32 v[248:249], v[248:249], v[22:23]
    v_pk_mul_f32 v[250:251], v[250:251], v[22:23]
    v_pk_mul_f32 v[252:253], v[252:253], v[22:23]
    v_pk_mul_f32 v[254:255], v[254:255], v[22:23]
    v_cvt_pk_bf16_f32 v248, v248, v249
    v_cvt_pk_bf16_f32 v249, v250, v251
    v_cvt_pk_bf16_f32 v250, v252, v253
    v_cvt_pk_bf16_f32 v251, v254, v255
    buffer_store_dwordx4 v[248:251], v24, s[16:19], s38 offen offset:3072 sc1
    v_mov_b32 v96, v112
    v_mov_b32 v97, v113
    v_mov_b32 v98, v114
    v_mov_b32 v99, v115
    v_mov_b32 v100, v116
    v_mov_b32 v101, v117
    v_mov_b32 v102, v118
    v_mov_b32 v103, v119
    s_branch L_p3_done
L_recurrent_scan__compressed_kv_cla__moe_arch_mod__prompt_kernel_rare_1:
    s_mul_i32 s36, s28, 12288
    s_add_u32 s36, s36, 61865984
    v_lshl_add_u32 v16, v1, 4, s36
    v_mov_b32 v108, 0
    v_mov_b32 v109, 0
    v_mov_b32 v110, 0
    v_mov_b32 v111, 0
    global_store_dwordx4 v16, v[108:111], s[90:91] sc1
    v_add_u32 v16, 1024, v16
    global_store_dwordx4 v16, v[108:111], s[90:91] sc1
    v_add_u32 v16, 1024, v16
    global_store_dwordx4 v16, v[108:111], s[90:91] sc1
    v_add_u32 v16, 1024, v16
    global_store_dwordx4 v16, v[108:111], s[90:91] sc1
    v_add_u32 v16, 1024, v16
    global_store_dwordx4 v16, v[108:111], s[90:91] sc1
    v_add_u32 v16, 1024, v16
    global_store_dwordx4 v16, v[108:111], s[90:91] sc1
    v_add_u32 v16, 1024, v16
    global_store_dwordx4 v16, v[108:111], s[90:91] sc1
    v_add_u32 v16, 1024, v16
    global_store_dwordx4 v16, v[108:111], s[90:91] sc1
    v_add_u32 v16, 1024, v16
    global_store_dwordx4 v16, v[108:111], s[90:91] sc1
    v_add_u32 v16, 1024, v16
    global_store_dwordx4 v16, v[108:111], s[90:91] sc1
    v_add_u32 v16, 1024, v16
    global_store_dwordx4 v16, v[108:111], s[90:91] sc1
    v_add_u32 v16, 1024, v16
    global_store_dwordx4 v16, v[108:111], s[90:91] sc1
    v_add_u32 v16, 1024, v16
    s_branch L_recurrent_scan__compressed_kv_cla__moe_arch_mod__prompt_kernel_back_2
L_recurrent_scan__compressed_kv_cla__moe_arch_mod__prompt_kernel_rare_3:
    v_mov_b32 v19, 1
    s_mov_b64 exec, 1
    global_store_dword v118, v19, s[88:89] sc1
    s_mov_b64 exec, -1
    s_branch L_recurrent_scan__compressed_kv_cla__moe_arch_mod__prompt_kernel_back_4
L_recurrent_scan__compressed_kv_cla__moe_arch_mod__prompt_kernel_rare_5:
    v_lshrrev_b32 v3, 4, v1
    s_lshl_b32 s37, s28, 4
    v_add_u32 v19, s37, v3
    v_lshlrev_b32 v19, 13, v19
    s_lshl_b32 s37, s29, 8
    v_add_u32 v19, s37, v19
    v_and_b32 v16, 15, v1
    v_lshlrev_b32 v3, 1, v3
    v_xor_b32 v16, v16, v3
    v_lshl_add_u32 v2, v16, 4, v19
    v_add_u32 v3, 31744, v2
    v_xor_b32 v16, 8, v16
    v_lshl_add_u32 v4, v16, 4, v19
    v_add_u32 v4, 63488, v4
    v_add_u32 v5, 31744, v4
    s_mov_b32 s4, s96
    s_and_b32 s5, s97, 0xffff
    s_mov_b32 s6, 8388608
    s_mov_b32 s7, 0x20000
    s_mov_b32 s31, 0
    s_mov_b32 s40, 1048576
    s_mov_b64 s[8:9], s[4:5]
    s_mov_b32 s10, s6
    s_mov_b32 s32, 2097152
    v_mov_b32 v6, v2
    v_mov_b32 v7, v3
    v_mov_b32 v8, v4
    v_mov_b32 v9, v5
    s_branch L_recurrent_scan__compressed_kv_cla__moe_arch_mod__prompt_kernel_back_6
L_recurrent_scan__compressed_kv_cla__moe_arch_mod__prompt_kernel_w0_7:
    s_cmp_eq_u32 s35, 0
    s_cbranch_scc0 L_recurrent_scan__compressed_kv_cla__moe_arch_mod__prompt_kernel_swn_10
    v_and_b32 v16, 7, v1
    v_lshrrev_b32 v18, 3, v1
    v_mul_u32_u24 v19, 2064, v16
    v_lshl_add_u32 v19, v18, 4, v19
    s_lshl_b32 s36, s28, 8
    s_add_u32 s36, s36, 131072
    v_add_u32 v19, s36, v19
    ds_read_b128 v[120:123], v19
    ds_read_b128 v[124:127], v19 offset:128
    v_lshlrev_b32 v16, 4, v16
    v_lshl_add_u32 v16, v18, 8, v16
    s_lshr_b32 s36, s2, 1
    s_lshl_b32 s36, s36, 15
    s_and_b32 s37, s2, 1
    s_lshl_b32 s37, s37, 7
    s_add_u32 s36, s36, s37
    s_lshl_b32 s37, s28, 12
    s_add_u32 s36, s36, s37
    s_waitcnt lgkmcnt(0)
    buffer_store_dwordx4 v[120:123], v16, s[24:27], s36 offen sc1
    buffer_store_dwordx4 v[124:127], v16, s[24:27], s36 offen offset:2048 sc1
    s_waitcnt vmcnt(2)
    s_branch L_recurrent_scan__compressed_kv_cla__moe_arch_mod__prompt_kernel_swend_9
L_recurrent_scan__compressed_kv_cla__moe_arch_mod__prompt_kernel_swn_10:
    s_waitcnt vmcnt(2)
L_recurrent_scan__compressed_kv_cla__moe_arch_mod__prompt_kernel_swend_9:
    s_branch L_recurrent_scan__compressed_kv_cla__moe_arch_mod__prompt_kernel_w0b_8
L_recurrent_scan__compressed_kv_cla__moe_arch_mod__prompt_kernel_rare_13:
    s_cmp_eq_u32 s35, 0
    s_cbranch_scc0 L_recurrent_scan__compressed_kv_cla__moe_arch_mod__prompt_kernel_swn_12
    global_load_dword v116, v118, s[88:89] sc1
    s_branch L_recurrent_scan__compressed_kv_cla__moe_arch_mod__prompt_kernel_swend_11
L_recurrent_scan__compressed_kv_cla__moe_arch_mod__prompt_kernel_swn_12:
    v_and_b32 v117, 15, v1
    v_add_u32 v117, 112, v117
    v_lshlrev_b32 v117, 7, v117
    global_load_dword v116, v117, s[90:91] sc1
L_recurrent_scan__compressed_kv_cla__moe_arch_mod__prompt_kernel_swend_11:
    s_branch L_recurrent_scan__compressed_kv_cla__moe_arch_mod__prompt_kernel_back_14
L_recurrent_scan__compressed_kv_cla__moe_arch_mod__prompt_kernel_rare_19:
    s_mov_b32 s61, 0x40000
L_recurrent_scan__compressed_kv_cla__moe_arch_mod__prompt_kernel_spin_17:
    s_sub_u32 s61, s61, 1
    s_cbranch_scc1 L_recurrent_scan__compressed_kv_cla__moe_arch_mod__prompt_kernel_spinx_18
    s_sleep 8
    global_load_dword v116, v118, s[88:89] sc1
    s_waitcnt vmcnt(0)
    v_readfirstlane_b32 s36, v116
    s_nop 0
    s_cmp_lt_u32 s36, 1
    s_cbranch_scc1 L_recurrent_scan__compressed_kv_cla__moe_arch_mod__prompt_kernel_spin_17
L_recurrent_scan__compressed_kv_cla__moe_arch_mod__prompt_kernel_spinx_18:
    s_branch L_recurrent_scan__compressed_kv_cla__moe_arch_mod__prompt_kernel_back_20
L_recurrent_scan__compressed_kv_cla__moe_arch_mod__prompt_kernel_w0_15:
    s_waitcnt vmcnt(0)
    s_cmp_eq_u32 s35, 0
    s_cbranch_scc0 L_recurrent_scan__compressed_kv_cla__moe_arch_mod__prompt_kernel_swn_24
    v_readfirstlane_b32 s36, v116
    s_nop 0
    s_cmp_lt_u32 s36, 1
    s_cbranch_scc1 L_recurrent_scan__compressed_kv_cla__moe_arch_mod__prompt_kernel_rare_19
L_recurrent_scan__compressed_kv_cla__moe_arch_mod__prompt_kernel_back_20:
    s_branch L_recurrent_scan__compressed_kv_cla__moe_arch_mod__prompt_kernel_swend_23
L_recurrent_scan__compressed_kv_cla__moe_arch_mod__prompt_kernel_swn_24:
    s_mov_b32 s61, 0x40000
L_recurrent_scan__compressed_kv_cla__moe_arch_mod__prompt_kernel_lspin_21:
    v_cmp_gt_u32 vcc, 16, v116
    s_nop 0
    s_cmp_eq_u64 vcc, 0
    s_cbranch_scc1 L_recurrent_scan__compressed_kv_cla__moe_arch_mod__prompt_kernel_lspinx_22
    s_sub_u32 s61, s61, 1
    s_cbranch_scc1 L_recurrent_scan__compressed_kv_cla__moe_arch_mod__prompt_kernel_lspinx_22
    s_sleep 8
    global_load_dword v116, v117, s[90:91] sc1
    s_waitcnt vmcnt(0)
    s_branch L_recurrent_scan__compressed_kv_cla__moe_arch_mod__prompt_kernel_lspin_21
L_recurrent_scan__compressed_kv_cla__moe_arch_mod__prompt_kernel_lspinx_22:
L_recurrent_scan__compressed_kv_cla__moe_arch_mod__prompt_kernel_swend_23:
    s_branch L_recurrent_scan__compressed_kv_cla__moe_arch_mod__prompt_kernel_w0b_16
L_recurrent_scan__compressed_kv_cla__moe_arch_mod__prompt_kernel_rare_25:
    s_lshr_b32 s36, s2, 4
    s_add_u32 s36, s36, 112
    s_lshl_b32 s36, s36, 7
    v_mov_b32 v16, s36
    v_mov_b32 v19, 1
    s_mov_b64 exec, 1
    global_atomic_add v16, v19, s[90:91]
    s_mov_b64 exec, -1
    s_nop 3
    s_branch L_recurrent_scan__compressed_kv_cla__moe_arch_mod__prompt_kernel_back_26
L_recurrent_scan__compressed_kv_cla__moe_arch_mod__prompt_kernel_w0_27:
    s_cmp_eq_u32 s35, 0
    s_cbranch_scc0 L_recurrent_scan__compressed_kv_cla__moe_arch_mod__prompt_kernel_swn_30
    s_waitcnt vmcnt(2)
    s_branch L_recurrent_scan__compressed_kv_cla__moe_arch_mod__prompt_kernel_swend_29
L_recurrent_scan__compressed_kv_cla__moe_arch_mod__prompt_kernel_swn_30:
    s_waitcnt vmcnt(2)
L_recurrent_scan__compressed_kv_cla__moe_arch_mod__prompt_kernel_swend_29:
    s_branch L_recurrent_scan__compressed_kv_cla__moe_arch_mod__prompt_kernel_w0b_28
L_recurrent_scan__compressed_kv_cla__moe_arch_mod__prompt_kernel_rare_32:
    v_and_b32 v16, 7, v1
    v_lshrrev_b32 v18, 3, v1
    v_mul_u32_u24 v19, 2064, v16
    v_lshl_add_u32 v19, v18, 4, v19
    s_lshl_b32 s36, s28, 8
    s_add_u32 s36, s36, 131072
    v_add_u32 v19, s36, v19
    ds_read_b128 v[120:123], v19
    ds_read_b128 v[124:127], v19 offset:128
    v_lshlrev_b32 v16, 4, v16
    v_lshl_add_u32 v16, v18, 8, v16
    s_lshr_b32 s36, s2, 1
    s_lshl_b32 s36, s36, 15
    s_and_b32 s37, s2, 1
    s_lshl_b32 s37, s37, 7
    s_add_u32 s36, s36, s37
    s_lshl_b32 s37, s28, 12
    s_add_u32 s36, s36, s37
    s_waitcnt lgkmcnt(0)
    buffer_store_dwordx4 v[120:123], v16, s[24:27], s36 offen sc1
    buffer_store_dwordx4 v[124:127], v16, s[24:27], s36 offen offset:2048 sc1
    s_cmp_eq_u32 s28, 7
    s_cbranch_scc0 L_recurrent_scan__compressed_kv_cla__moe_arch_mod__prompt_kernel_l7_31
    v_and_b32 v120, 7, v1
    v_lshlrev_b32 v120, 3, v120
    v_add_u32 v121, 147712, v120
    ds_read_b64 v[122:123], v121
    ds_read_b32 v124, v121 offset:64
    s_lshl_b32 s36, s2, 6
    s_add_u32 s36, s36, 4194304
    s_lshl_b32 s37, s2, 3
    s_add_u32 s37, s37, 4276224
    s_waitcnt lgkmcnt(0)
    v_mov_b32 v126, v124
    s_nop 1
    v_max_u32_dpp v126, v126, v126 quad_perm:[1,0,3,2] row_mask:0xf bank_mask:0xf
    s_nop 1
    v_max_u32_dpp v126, v126, v126 quad_perm:[2,3,0,1] row_mask:0xf bank_mask:0xf
    s_nop 1
    v_max_u32_dpp v126, v126, v126 row_half_mirror row_mask:0xf bank_mask:0xf
    v_cmp_eq_u32 vcc, v126, v124
    s_nop 1
    v_cndmask_b32 v127, v124, v118, vcc
    s_nop 1
    v_max_u32_dpp v127, v127, v127 quad_perm:[1,0,3,2] row_mask:0xf bank_mask:0xf
    s_nop 1
    v_max_u32_dpp v127, v127, v127 quad_perm:[2,3,0,1] row_mask:0xf bank_mask:0xf
    s_nop 1
    v_max_u32_dpp v127, v127, v127 row_half_mirror row_mask:0xf bank_mask:0xf
    s_mov_b64 exec, 0xff
    buffer_store_dwordx2 v[122:123], v120, s[24:27], s36 offen sc1
    s_mov_b64 exec, 1
    buffer_store_dwordx2 v[126:127], v120, s[24:27], s37 offen sc1
    s_mov_b64 exec, -1
    s_nop 3
L_recurrent_scan__compressed_kv_cla__moe_arch_mod__prompt_kernel_l7_31:
    s_branch L_recurrent_scan__compressed_kv_cla__moe_arch_mod__prompt_kernel_back_33
L_recurrent_scan__compressed_kv_cla__moe_arch_mod__prompt_kernel_rare_36:
    v_lshrrev_b32 v3, 4, v1
    s_lshl_b32 s37, s28, 4
    v_add_u32 v19, s37, v3
    v_lshlrev_b32 v19, 13, v19
    s_lshl_b32 s37, s29, 8
    v_add_u32 v19, s37, v19
    v_and_b32 v16, 15, v1
    v_lshlrev_b32 v3, 1, v3
    v_xor_b32 v16, v16, v3
    v_lshl_add_u32 v2, v16, 4, v19
    v_add_u32 v3, 31744, v2
    v_xor_b32 v16, 8, v16
    v_lshl_add_u32 v4, v16, 4, v19
    v_add_u32 v4, 63488, v4
    v_add_u32 v5, 31744, v4
    s_mov_b32 s4, s96
    s_and_b32 s5, s97, 0xffff
    s_mov_b32 s6, 8388608
    s_mov_b32 s7, 0x20000
    s_mov_b32 s31, 0
    s_mov_b32 s40, 1048576
    s_mov_b64 s[8:9], s[4:5]
    s_mov_b32 s10, s6
    s_mov_b32 s32, 2097152
    v_mov_b32 v6, v2
    v_mov_b32 v7, v3
    v_mov_b32 v8, v4
    v_mov_b32 v9, v5
    s_branch L_recurrent_scan__compressed_kv_cla__moe_arch_mod__prompt_kernel_back_37
L_recurrent_scan__compressed_kv_cla__moe_arch_mod__prompt_kernel_rare_42:
    s_mov_b32 s61, 0x40000
L_recurrent_scan__compressed_kv_cla__moe_arch_mod__prompt_kernel_spin_40:
    s_sub_u32 s61, s61, 1
    s_cbranch_scc1 L_recurrent_scan__compressed_kv_cla__moe_arch_mod__prompt_kernel_spinx_41
    s_sleep 8
    global_load_dword v56, v57, s[90:91] sc1
    s_waitcnt vmcnt(0)
    v_readfirstlane_b32 s36, v56
    s_nop 0
    s_cmp_lt_u32 s36, 1
    s_cbranch_scc1 L_recurrent_scan__compressed_kv_cla__moe_arch_mod__prompt_kernel_spin_40
L_recurrent_scan__compressed_kv_cla__moe_arch_mod__prompt_kernel_spinx_41:
    s_branch L_recurrent_scan__compressed_kv_cla__moe_arch_mod__prompt_kernel_back_43
L_recurrent_scan__compressed_kv_cla__moe_arch_mod__prompt_kernel_rare_45:
    s_cmp_eq_u32 s28, 0
    s_cbranch_scc0 L_recurrent_scan__compressed_kv_cla__moe_arch_mod__prompt_kernel_g_44
    s_waitcnt vmcnt(13)
    v_readfirstlane_b32 s36, v56
    s_nop 0
    s_cmp_lt_u32 s36, 1
    s_cbranch_scc1 L_recurrent_scan__compressed_kv_cla__moe_arch_mod__prompt_kernel_rare_42
L_recurrent_scan__compressed_kv_cla__moe_arch_mod__prompt_kernel_back_43:
L_recurrent_scan__compressed_kv_cla__moe_arch_mod__prompt_kernel_g_44:
    s_branch L_recurrent_scan__compressed_kv_cla__moe_arch_mod__prompt_kernel_back_46
L_recurrent_scan__compressed_kv_cla__moe_arch_mod__prompt_kernel_rare_47:
    s_cmp_eq_u32 s28, 0
    s_cbranch_scc0 L_recurrent_scan__compressed_kv_cla__moe_arch_mod__prompt_kernel_g_39
    s_add_u32 s36, s29, 64
    s_lshl_b32 s36, s36, 7
    v_mov_b32 v57, s36
    global_load_dword v56, v57, s[90:91] sc1
L_recurrent_scan__compressed_kv_cla__moe_arch_mod__prompt_kernel_g_39:
    s_branch L_recurrent_scan__compressed_kv_cla__moe_arch_mod__prompt_kernel_back_48
L_recurrent_scan__compressed_kv_cla__moe_arch_mod__prompt_kernel_rare_51:
    s_cmp_eq_u32 s35, 2
    s_cbranch_scc0 L_recurrent_scan__compressed_kv_cla__moe_arch_mod__prompt_kernel_swn_50
    s_mov_b32 s6, 0
    s_mov_b32 s34, 0x30000
    s_mov_b32 s41, 0x37fff
    s_lshl_b32 s36, s30, 3
    s_add_u32 s36, s28, s36
    s_cmp_eq_u32 s36, 4
    s_cbranch_scc0 L_recurrent_scan__compressed_kv_cla__moe_arch_mod__prompt_kernel_g_38
    s_add_u32 s36, s29, 64
    s_lshl_b32 s36, s36, 7
    v_mov_b32 v62, s36
    v_mov_b32 v63, 1
    s_mov_b64 exec, 1
    global_atomic_add v62, v63, s[90:91]
    s_mov_b64 exec, -1
    s_nop 3
L_recurrent_scan__compressed_kv_cla__moe_arch_mod__prompt_kernel_g_38:
    s_branch L_recurrent_scan__compressed_kv_cla__moe_arch_mod__prompt_kernel_swend_49
L_recurrent_scan__compressed_kv_cla__moe_arch_mod__prompt_kernel_swn_50:
    s_mov_b64 s[4:5], s[12:13]
    s_mov_b32 s6, s14
    s_mov_b32 s31, s45
    s_mov_b32 s40, 32768
    s_mov_b32 s34, s33
    v_add_u32 v2, s33, v58
    v_mov_b32 v3, v2
    v_mov_b32 v4, v2
    v_mov_b32 v5, v2
L_recurrent_scan__compressed_kv_cla__moe_arch_mod__prompt_kernel_swend_49:
    s_branch L_recurrent_scan__compressed_kv_cla__moe_arch_mod__prompt_kernel_back_52
L_recurrent_scan__compressed_kv_cla__moe_arch_mod__prompt_kernel_rare_53:
    s_branch L_recurrent_scan__compressed_kv_cla__moe_arch_mod__prompt_kernel_back_54
L_recurrent_scan__compressed_kv_cla__moe_arch_mod__prompt_kernel_rare_55:
    s_lshl_b32 s36, s39, 1
    s_add_u32 s36, s36, s38
    s_add_u32 s37, s36, s39
    buffer_store_dwordx4 v[160:163], v58, s[16:19], s36 offen sc1
    buffer_store_dwordx4 v[164:167], v59, s[16:19], s36 offen sc1
    buffer_store_dwordx4 v[168:171], v60, s[16:19], s36 offen sc1
    buffer_store_dwordx4 v[172:175], v61, s[16:19], s36 offen sc1
    buffer_store_dwordx4 v[176:179], v58, s[16:19], s37 offen sc1
    buffer_store_dwordx4 v[180:183], v59, s[16:19], s37 offen sc1
    buffer_store_dwordx4 v[184:187], v60, s[16:19], s37 offen sc1
    buffer_store_dwordx4 v[188:191], v61, s[16:19], s37 offen sc1
    s_branch L_recurrent_scan__compressed_kv_cla__moe_arch_mod__prompt_kernel_back_56
L_recurrent_scan__compressed_kv_cla__moe_arch_mod__prompt_kernel_rare_57:
    s_lshl_b32 s36, s29, 7
    v_mov_b32 v13, s36
    global_load_dword v14, v13, s[90:91] sc1
    s_branch L_recurrent_scan__compressed_kv_cla__moe_arch_mod__prompt_kernel_back_58
L_recurrent_scan__compressed_kv_cla__moe_arch_mod__prompt_kernel_rare_63:
    s_mov_b32 s41, 32768
    s_cmp_eq_u32 s40, 15
    s_cbranch_scc0 L_recurrent_scan__compressed_kv_cla__moe_arch_mod__prompt_kernel_r_59
    s_mov_b32 s41, 65536
    s_mov_b32 s49, 0x1ffff
    s_sub_u32 s36, 0, s50
    s_cmp_lt_i32 s36, 0
    s_cbranch_scc1 L_recurrent_scan__compressed_kv_cla__moe_arch_mod__prompt_kernel_nm_62
    v_mov_b32 v20, 4048155338
    v_subrev_u32 v21, s36, v18
    v_cmp_gt_i32 s[20:21], 0, v21
    v_cmp_gt_i32 s[22:23], 1, v21
    v_cmp_gt_i32 s[62:63], 2, v21
    v_cmp_gt_i32 vcc, 3, v21
    v_cndmask_b32 v96, v96, v20, s[20:21]
    v_cndmask_b32 v97, v97, v20, s[22:23]
    v_cndmask_b32 v98, v98, v20, s[62:63]
    v_cndmask_b32 v99, v99, v20, vcc
    v_cmp_gt_i32 s[20:21], 16, v21
    v_cmp_gt_i32 s[22:23], 17, v21
    v_cmp_gt_i32 s[62:63], 18, v21
    v_cmp_gt_i32 vcc, 19, v21
    v_cndmask_b32 v100, v100, v20, s[20:21]
    v_cndmask_b32 v101, v101, v20, s[22:23]
    v_cndmask_b32 v102, v102, v20, s[62:63]
    v_cndmask_b32 v103, v103, v20, vcc
    v_cmp_gt_i32 s[20:21], -16, v21
    v_cmp_gt_i32 s[22:23], -15, v21
    v_cmp_gt_i32 s[62:63], -14, v21
    v_cmp_gt_i32 vcc, -13, v21
    v_cndmask_b32 v104, v104, v20, s[20:21]
    v_cndmask_b32 v105, v105, v20, s[22:23]
    v_cndmask_b32 v106, v106, v20, s[62:63]
    v_cndmask_b32 v107, v107, v20, vcc
    v_cmp_gt_i32 s[20:21], 0, v21
    v_cmp_gt_i32 s[22:23], 1, v21
    v_cmp_gt_i32 s[62:63], 2, v21
    v_cmp_gt_i32 vcc, 3, v21
    v_cndmask_b32 v108, v108, v20, s[20:21]
    v_cndmask_b32 v109, v109, v20, s[22:23]
    v_cndmask_b32 v110, v110, v20, s[62:63]
    v_cndmask_b32 v111, v111, v20, vcc
L_recurrent_scan__compressed_kv_cla__moe_arch_mod__prompt_kernel_nm_62:
L_recurrent_scan__compressed_kv_cla__moe_arch_mod__prompt_kernel_r_59:
    s_branch L_recurrent_scan__compressed_kv_cla__moe_arch_mod__prompt_kernel_back_64
L_recurrent_scan__compressed_kv_cla__moe_arch_mod__prompt_kernel_rare_73:
    s_mov_b32 s61, 0x40000
L_recurrent_scan__compressed_kv_cla__moe_arch_mod__prompt_kernel_spin_71:
    s_sub_u32 s61, s61, 1
    s_cbranch_scc1 L_recurrent_scan__compressed_kv_cla__moe_arch_mod__prompt_kernel_spinx_72
    s_sleep 8
    global_load_dword v14, v13, s[90:91] sc1
    s_waitcnt vmcnt(0)
    v_readfirstlane_b32 s36, v14
    s_nop 0
    s_cmp_lt_u32 s36, 7
    s_cbranch_scc1 L_recurrent_scan__compressed_kv_cla__moe_arch_mod__prompt_kernel_spin_71
L_recurrent_scan__compressed_kv_cla__moe_arch_mod__prompt_kernel_spinx_72:
    s_branch L_recurrent_scan__compressed_kv_cla__moe_arch_mod__prompt_kernel_back_74
L_recurrent_scan__compressed_kv_cla__moe_arch_mod__prompt_kernel_rare_79:
    s_cmp_eq_u32 s40, 1
    s_cbranch_scc0 L_recurrent_scan__compressed_kv_cla__moe_arch_mod__prompt_kernel_swn_76
    v_readfirstlane_b32 s36, v14
    s_nop 0
    s_cmp_lt_u32 s36, 7
    s_cbranch_scc1 L_recurrent_scan__compressed_kv_cla__moe_arch_mod__prompt_kernel_rare_73
L_recurrent_scan__compressed_kv_cla__moe_arch_mod__prompt_kernel_back_74:
    s_branch L_recurrent_scan__compressed_kv_cla__moe_arch_mod__prompt_kernel_swend_75
L_recurrent_scan__compressed_kv_cla__moe_arch_mod__prompt_kernel_swn_76:
    s_cmp_eq_u32 s40, 2
    s_cbranch_scc0 L_recurrent_scan__compressed_kv_cla__moe_arch_mod__prompt_kernel_swn_77
    s_mov_b32 s36, 4276224
    buffer_load_dwordx4 v[160:163], v7, s[24:27], s36 offen offset:0 sc1
    buffer_load_dwordx4 v[164:167], v7, s[24:27], s36 offen offset:1024 sc1
    s_branch L_recurrent_scan__compressed_kv_cla__moe_arch_mod__prompt_kernel_swend_75
L_recurrent_scan__compressed_kv_cla__moe_arch_mod__prompt_kernel_swn_77:
    s_cmp_eq_u32 s40, 3
    s_cbranch_scc0 L_recurrent_scan__compressed_kv_cla__moe_arch_mod__prompt_kernel_swn_78
    v_max_u32 v24, v160, v161
    v_min_u32 v25, v160, v161
    v_med3_u32 v25, v24, v25, v162
    v_max_u32 v24, v24, v162
    v_med3_u32 v25, v24, v25, v163
    v_max_u32 v24, v24, v163
    v_med3_u32 v25, v24, v25, v164
    v_max_u32 v24, v24, v164
    v_med3_u32 v25, v24, v25, v165
    v_max_u32 v24, v24, v165
    v_med3_u32 v25, v24, v25, v166
    v_max_u32 v24, v24, v166
    v_med3_u32 v25, v24, v25, v167
    v_max_u32 v24, v24, v167
    v_mov_b32 v26, v24
    s_nop 1
    v_max_u32_dpp v26, v26, v26 quad_perm:[1,0,3,2] row_mask:0xf bank_mask:0xf
    s_nop 1
    v_max_u32_dpp v26, v26, v26 quad_perm:[2,3,0,1] row_mask:0xf bank_mask:0xf
    s_nop 1
    v_max_u32_dpp v26, v26, v26 row_half_mirror row_mask:0xf bank_mask:0xf
    s_nop 1
    v_max_u32_dpp v26, v26, v26 row_mirror row_mask:0xf bank_mask:0xf
    s_nop 0
    v_readlane_b32 s20, v26, 0
    v_readlane_b32 s21, v26, 16
    v_readlane_b32 s22, v26, 32
    v_readlane_b32 s23, v26, 48
    s_max_u32 s20, s20, s21
    s_max_u32 s22, s22, s23
    s_max_u32 s20, s20, s22
    s_mov_b32 s58, s20
    v_cmp_eq_u32 vcc, s58, v24
    s_nop 1
    v_cndmask_b32 v26, v24, v25, vcc
    s_nop 1
    v_max_u32_dpp v26, v26, v26 quad_perm:[1,0,3,2] row_mask:0xf bank_mask:0xf
    s_nop 1
    v_max_u32_dpp v26, v26, v26 quad_perm:[2,3,0,1] row_mask:0xf bank_mask:0xf
    s_nop 1
    v_max_u32_dpp v26, v26, v26 row_half_mirror row_mask:0xf bank_mask:0xf
    s_nop 1
    v_max_u32_dpp v26, v26, v26 row_mirror row_mask:0xf bank_mask:0xf
    s_nop 0
    v_readlane_b32 s20, v26, 0
    v_readlane_b32 s21, v26, 16
    v_readlane_b32 s22, v26, 32
    v_readlane_b32 s23, v26, 48
    s_max_u32 s20, s20, s21
    s_max_u32 s22, s22, s23
    s_max_u32 s20, s20, s22
    s_mov_b32 s59, s20
    s_and_b32 s36, s58, 0xffff
    s_sub_u32 s56, 0xffff, s36
    s_and_b32 s36, s59, 0xffff
    s_sub_u32 s57, 0xffff, s36
    v_and_b32 v24, 1, v1
    v_mov_b32 v25, s56
    v_mov_b32 v26, s57
    v_cmp_eq_u32 vcc, 1, v24
    s_nop 1
    v_cndmask_b32 v25, v25, v26, vcc
    v_lshrrev_b32 v26, 4, v25
    v_lshlrev_b32 v26, 15, v26
    v_and_b32 v25, 15, v25
    v_lshl_add_u32 v26, v25, 4, v26
    v_lshrrev_b32 v27, 4, v1
    v_lshl_add_u32 v26, v27, 8, v26
    s_and_b32 s36, s3, 3
    s_lshl_b32 s36, s36, 13
    s_add_u32 s37, s36, 4096
    s_mov_b32 exec_lo, 0x00030003
    s_mov_b32 exec_hi, 0x00030003
    buffer_load_dwordx4 v[160:163], v26, s[24:27], s36 offen offset:0 sc1
    buffer_load_dwordx4 v[164:167], v26, s[24:27], s36 offen offset:1024 sc1
    buffer_load_dwordx4 v[168:171], v26, s[24:27], s36 offen offset:2048 sc1
    buffer_load_dwordx4 v[172:175], v26, s[24:27], s36 offen offset:3072 sc1
    buffer_load_dwordx4 v[176:179], v26, s[24:27], s37 offen offset:0 sc1
    buffer_load_dwordx4 v[180:183], v26, s[24:27], s37 offen offset:1024 sc1
    buffer_load_dwordx4 v[184:187], v26, s[24:27], s37 offen offset:2048 sc1
    buffer_load_dwordx4 v[188:191], v26, s[24:27], s37 offen offset:3072 sc1
    s_mov_b64 exec, -1
    s_branch L_recurrent_scan__compressed_kv_cla__moe_arch_mod__prompt_kernel_swend_75
L_recurrent_scan__compressed_kv_cla__moe_arch_mod__prompt_kernel_swn_78:
    s_sub_u32 s38, s40, s60
    s_cmp_eq_u32 s38, 0
    s_cbranch_scc0 L_recurrent_scan__compressed_kv_cla__moe_arch_mod__prompt_kernel_swn_67
    s_and_b32 s20, s3, 3
    s_lshl_b32 s20, s20, 8
    s_lshl_b32 s21, s28, 5
    s_add_u32 s20, s20, s21
    s_lshr_b32 s21, s3, 2
    s_lshl_b32 s21, s21, 7
    v_lshrrev_b32 v25, 3, v1
    s_lshl_b32 s36, s28, 5
    s_add_u32 s36, s36, s20
    v_add_u32 v25, s36, v25
    v_mul_u32_u24 v25, 7168, v25
    v_add_u32 v25, s21, v25
    v_bfe_u32 v26, v1, 4, 1
    v_lshlrev_b32 v26, 1, v26
    v_and_b32 v27, 7, v1
    v_xor_b32 v26, v26, v27
    v_lshl_add_u32 v24, v26, 4, v25
    v_xor_b32 v26, 4, v26
    v_lshl_add_u32 v25, v26, 4, v25
    v_add_u32 v25, 56320, v25
    v_add_u32 v26, 112640, v24
    v_add_u32 v27, 112640, v25
    s_lshl_b32 s36, s28, 13
    s_add_u32 m0, s36, 131072
    s_mov_b32 s37, 229376
    buffer_load_dwordx4 v24, s[4:7], 0 offen offset:0 nt lds
    buffer_load_dwordx4 v25, s[4:7], 0 offen offset:1024 nt lds
    buffer_load_dwordx4 v26, s[4:7], 0 offen offset:2048 nt lds
    buffer_load_dwordx4 v27, s[4:7], 0 offen offset:3072 nt lds
    s_add_u32 m0, s36, 135168
    s_nop 0
    buffer_load_dwordx4 v24, s[4:7], s37 offen offset:0 nt lds
    buffer_load_dwordx4 v25, s[4:7], s37 offen offset:1024 nt lds
    buffer_load_dwordx4 v26, s[4:7], s37 offen offset:2048 nt lds
    buffer_load_dwordx4 v27, s[4:7], s37 offen offset:3072 nt lds
    s_branch L_recurrent_scan__compressed_kv_cla__moe_arch_mod__prompt_kernel_swend_66
L_recurrent_scan__compressed_kv_cla__moe_arch_mod__prompt_kernel_swn_67:
    s_cmp_eq_u32 s38, 2
    s_cbranch_scc0 L_recurrent_scan__compressed_kv_cla__moe_arch_mod__prompt_kernel_swn_68
    v_lshrrev_b32 v8, 4, v1
    v_bfe_u32 v5, v1, 2, 2
    v_lshl_add_u32 v5, v8, 3, v5
    v_lshlrev_b32 v5, 7, v5
    v_and_b32 v9, 3, v1
    v_lshl_add_u32 v5, v9, 3, v5
    v_bfe_u32 v9, v1, 3, 2
    v_xor_b32 v9, s28, v9
    v_lshl_add_u32 v5, v9, 5, v5
    v_add_u32 v5, 131072, v5
    ds_read_b64_tr_b16 v[14:15], v5 offset:0
    ds_read_b64_tr_b16 v[16:17], v5 offset:512
    ds_read_b64_tr_b16 v[20:21], v5 offset:4096
    ds_read_b64_tr_b16 v[22:23], v5 offset:4608
    ds_read_b64_tr_b16 v[24:25], v5 offset:8192
    ds_read_b64_tr_b16 v[26:27], v5 offset:8704
    s_and_b32 s36, s3, 3
    s_lshl_b32 s36, s36, 6
    s_lshr_b32 s37, s3, 2
    s_lshl_b32 s37, s37, 12
    s_add_u32 s36, s36, s37
    s_lshl_b32 s37, s28, 10
    s_add_u32 s36, s36, s37
    s_add_u32 s36, s36, 58720256
    v_and_b32 v9, 1, v1
    v_lshlrev_b32 v9, 4, v9
    v_lshl_add_u32 v9, v8, 8, v9
    s_waitcnt lgkmcnt(4)
    v_mfma_f32_16x16x32_bf16 v[10:13], v[14:17], v[160:163], 0
    ds_read_b64_tr_b16 v[14:15], v5 offset:12288
    ds_read_b64_tr_b16 v[16:17], v5 offset:12800
    s_waitcnt lgkmcnt(4)
    v_mfma_f32_16x16x32_bf16 v[10:13], v[20:23], v[164:167], v[10:13]
    ds_read_b64_tr_b16 v[20:21], v5 offset:16384
    ds_read_b64_tr_b16 v[22:23], v5 offset:16896
    s_waitcnt lgkmcnt(4)
    v_mfma_f32_16x16x32_bf16 v[10:13], v[24:27], v[168:171], v[10:13]
    ds_read_b64_tr_b16 v[24:25], v5 offset:20480
    ds_read_b64_tr_b16 v[26:27], v5 offset:20992
    s_waitcnt lgkmcnt(4)
    v_mfma_f32_16x16x32_bf16 v[10:13], v[14:17], v[172:175], v[10:13]
    ds_read_b64_tr_b16 v[14:15], v5 offset:24576
    ds_read_b64_tr_b16 v[16:17], v5 offset:25088
    s_waitcnt lgkmcnt(4)
    v_mfma_f32_16x16x32_bf16 v[10:13], v[20:23], v[176:179], v[10:13]
    ds_read_b64_tr_b16 v[20:21], v5 offset:28672
    ds_read_b64_tr_b16 v[22:23], v5 offset:29184
    s_waitcnt lgkmcnt(4)
    v_mfma_f32_16x16x32_bf16 v[10:13], v[24:27], v[180:183], v[10:13]
    s_waitcnt lgkmcnt(2)
    v_mfma_f32_16x16x32_bf16 v[10:13], v[14:17], v[184:187], v[10:13]
    s_waitcnt lgkmcnt(0)
    v_mfma_f32_16x16x32_bf16 v[10:13], v[20:23], v[188:191], v[10:13]
    s_nop 5
    s_mov_b32 exec_lo, 0x00030003
    s_mov_b32 exec_hi, 0x00030003
    buffer_store_dwordx4 v[10:13], v9, s[24:27], s36 offen sc1
    s_mov_b64 exec, -1
    s_nop 1
    s_branch L_recurrent_scan__compressed_kv_cla__moe_arch_mod__prompt_kernel_swend_66
L_recurrent_scan__compressed_kv_cla__moe_arch_mod__prompt_kernel_swn_68:
    s_cmp_eq_u32 s38, 3
    s_cbranch_scc0 L_recurrent_scan__compressed_kv_cla__moe_arch_mod__prompt_kernel_swn_69
    s_and_b32 s20, s3, 3
    s_lshl_b32 s20, s20, 8
    s_lshl_b32 s21, s28, 5
    s_add_u32 s20, s20, s21
    s_lshr_b32 s21, s3, 2
    s_lshl_b32 s21, s21, 7
    v_lshrrev_b32 v25, 3, v1
    s_lshl_b32 s36, s28, 5
    s_add_u32 s36, s36, s20
    v_add_u32 v25, s36, v25
    v_mul_u32_u24 v25, 7168, v25
    v_add_u32 v25, s21, v25
    v_bfe_u32 v26, v1, 4, 1
    v_lshlrev_b32 v26, 1, v26
    v_and_b32 v27, 7, v1
    v_xor_b32 v26, v26, v27
    v_lshl_add_u32 v24, v26, 4, v25
    v_xor_b32 v26, 4, v26
    v_lshl_add_u32 v25, v26, 4, v25
    v_add_u32 v25, 56320, v25
    v_add_u32 v26, 112640, v24
    v_add_u32 v27, 112640, v25
    s_lshl_b32 s36, s28, 13
    s_add_u32 m0, s36, 131072
    s_mov_b32 s37, 229376
    buffer_load_dwordx4 v24, s[8:11], 0 offen offset:0 nt lds
    buffer_load_dwordx4 v25, s[8:11], 0 offen offset:1024 nt lds
    buffer_load_dwordx4 v26, s[8:11], 0 offen offset:2048 nt lds
    buffer_load_dwordx4 v27, s[8:11], 0 offen offset:3072 nt lds
    s_add_u32 m0, s36, 135168
    s_nop 0
    buffer_load_dwordx4 v24, s[8:11], s37 offen offset:0 nt lds
    buffer_load_dwordx4 v25, s[8:11], s37 offen offset:1024 nt lds
    buffer_load_dwordx4 v26, s[8:11], s37 offen offset:2048 nt lds
    buffer_load_dwordx4 v27, s[8:11], s37 offen offset:3072 nt lds
    s_branch L_recurrent_scan__compressed_kv_cla__moe_arch_mod__prompt_kernel_swend_66
L_recurrent_scan__compressed_kv_cla__moe_arch_mod__prompt_kernel_swn_69:
    s_cmp_eq_u32 s38, 5
    s_cbranch_scc0 L_recurrent_scan__compressed_kv_cla__moe_arch_mod__prompt_kernel_swn_70
    v_lshrrev_b32 v8, 4, v1
    v_bfe_u32 v5, v1, 2, 2
    v_lshl_add_u32 v5, v8, 3, v5
    v_lshlrev_b32 v5, 7, v5
    v_and_b32 v9, 3, v1
    v_lshl_add_u32 v5, v9, 3, v5
    v_bfe_u32 v9, v1, 3, 2
    v_xor_b32 v9, s28, v9
    v_lshl_add_u32 v5, v9, 5, v5
    v_add_u32 v5, 131072, v5
    ds_read_b64_tr_b16 v[14:15], v5 offset:0
    ds_read_b64_tr_b16 v[16:17], v5 offset:512
    ds_read_b64_tr_b16 v[20:21], v5 offset:4096
    ds_read_b64_tr_b16 v[22:23], v5 offset:4608
    ds_read_b64_tr_b16 v[24:25], v5 offset:8192
    ds_read_b64_tr_b16 v[26:27], v5 offset:8704
    s_and_b32 s36, s3, 3
    s_lshl_b32 s36, s36, 6
    s_lshr_b32 s37, s3, 2
    s_lshl_b32 s37, s37, 12
    s_add_u32 s36, s36, s37
    s_lshl_b32 s37, s28, 10
    s_add_u32 s36, s36, s37
    s_add_u32 s36, s36, 58720288
    v_and_b32 v9, 1, v1
    v_lshlrev_b32 v9, 4, v9
    v_lshl_add_u32 v9, v8, 8, v9
    s_waitcnt lgkmcnt(4)
    v_mfma_f32_16x16x32_bf16 v[10:13], v[14:17], v[160:163], 0
    ds_read_b64_tr_b16 v[14:15], v5 offset:12288
    ds_read_b64_tr_b16 v[16:17], v5 offset:12800
    s_waitcnt lgkmcnt(4)
    v_mfma_f32_16x16x32_bf16 v[10:13], v[20:23], v[164:167], v[10:13]
    ds_read_b64_tr_b16 v[20:21], v5 offset:16384
    ds_read_b64_tr_b16 v[22:23], v5 offset:16896
    s_waitcnt lgkmcnt(4)
    v_mfma_f32_16x16x32_bf16 v[10:13], v[24:27], v[168:171], v[10:13]
    ds_read_b64_tr_b16 v[24:25], v5 offset:20480
    ds_read_b64_tr_b16 v[26:27], v5 offset:20992
    s_waitcnt lgkmcnt(4)
    v_mfma_f32_16x16x32_bf16 v[10:13], v[14:17], v[172:175], v[10:13]
    ds_read_b64_tr_b16 v[14:15], v5 offset:24576
    ds_read_b64_tr_b16 v[16:17], v5 offset:25088
    s_waitcnt lgkmcnt(4)
    v_mfma_f32_16x16x32_bf16 v[10:13], v[20:23], v[176:179], v[10:13]
    ds_read_b64_tr_b16 v[20:21], v5 offset:28672
    ds_read_b64_tr_b16 v[22:23], v5 offset:29184
    s_waitcnt lgkmcnt(4)
    v_mfma_f32_16x16x32_bf16 v[10:13], v[24:27], v[180:183], v[10:13]
    s_waitcnt lgkmcnt(2)
    v_mfma_f32_16x16x32_bf16 v[10:13], v[14:17], v[184:187], v[10:13]
    s_waitcnt lgkmcnt(0)
    v_mfma_f32_16x16x32_bf16 v[10:13], v[20:23], v[188:191], v[10:13]
    s_nop 5
    s_mov_b32 exec_lo, 0x00030003
    s_mov_b32 exec_hi, 0x00030003
    buffer_store_dwordx4 v[10:13], v9, s[24:27], s36 offen sc1
    s_mov_b64 exec, -1
    s_nop 1
    s_branch L_recurrent_scan__compressed_kv_cla__moe_arch_mod__prompt_kernel_swend_66
L_recurrent_scan__compressed_kv_cla__moe_arch_mod__prompt_kernel_swn_70:
    s_mul_i32 s36, s3, 2341
    s_lshr_b32 s36, s36, 16
    s_add_u32 s36, s36, 48
    s_lshl_b32 s36, s36, 7
    v_mov_b32 v20, s36
    v_mov_b32 v21, 1
    s_mov_b64 exec, 1
    global_atomic_add v20, v21, s[90:91]
    s_mov_b64 exec, -1
    s_nop 3
L_recurrent_scan__compressed_kv_cla__moe_arch_mod__prompt_kernel_swend_66:
L_recurrent_scan__compressed_kv_cla__moe_arch_mod__prompt_kernel_swend_75:
    s_branch L_recurrent_scan__compressed_kv_cla__moe_arch_mod__prompt_kernel_back_80
L_recurrent_scan__compressed_kv_cla__moe_arch_mod__prompt_kernel_rare_89:
    v_mov_b32 v20, 4048155338
    v_subrev_u32 v21, s36, v18
    v_cmp_gt_i32 s[20:21], 0, v21
    v_cmp_gt_i32 s[22:23], 1, v21
    v_cmp_gt_i32 s[62:63], 2, v21
    v_cmp_gt_i32 vcc, 3, v21
    v_cndmask_b32 v112, v112, v20, s[20:21]
    v_cndmask_b32 v113, v113, v20, s[22:23]
    v_cndmask_b32 v114, v114, v20, s[62:63]
    v_cndmask_b32 v115, v115, v20, vcc
    v_cmp_gt_i32 s[20:21], 16, v21
    v_cmp_gt_i32 s[22:23], 17, v21
    v_cmp_gt_i32 s[62:63], 18, v21
    v_cmp_gt_i32 vcc, 19, v21
    v_cndmask_b32 v116, v116, v20, s[20:21]
    v_cndmask_b32 v117, v117, v20, s[22:23]
    v_cndmask_b32 v118, v118, v20, s[62:63]
    v_cndmask_b32 v119, v119, v20, vcc
    v_cmp_gt_i32 s[20:21], -16, v21
    v_cmp_gt_i32 s[22:23], -15, v21
    v_cmp_gt_i32 s[62:63], -14, v21
    v_cmp_gt_i32 vcc, -13, v21
    v_cndmask_b32 v120, v120, v20, s[20:21]
    v_cndmask_b32 v121, v121, v20, s[22:23]
    v_cndmask_b32 v122, v122, v20, s[62:63]
    v_cndmask_b32 v123, v123, v20, vcc
    v_cmp_gt_i32 s[20:21], 0, v21
    v_cmp_gt_i32 s[22:23], 1, v21
    v_cmp_gt_i32 s[62:63], 2, v21
    v_cmp_gt_i32 vcc, 3, v21
    v_cndmask_b32 v124, v124, v20, s[20:21]
    v_cndmask_b32 v125, v125, v20, s[22:23]
    v_cndmask_b32 v126, v126, v20, s[62:63]
    v_cndmask_b32 v127, v127, v20, vcc
    s_branch L_recurrent_scan__compressed_kv_cla__moe_arch_mod__prompt_kernel_back_90
L_recurrent_scan__compressed_kv_cla__moe_arch_mod__prompt_kernel_rare_93:
    s_mov_b32 s61, 0x40000
L_recurrent_scan__compressed_kv_cla__moe_arch_mod__prompt_kernel_spin_91:
    s_sub_u32 s61, s61, 1
    s_cbranch_scc1 L_recurrent_scan__compressed_kv_cla__moe_arch_mod__prompt_kernel_spinx_92
    s_sleep 8
    global_load_dword v11, v12, s[90:91] sc1
    s_waitcnt vmcnt(0)
    v_readfirstlane_b32 s36, v11
    s_nop 0
    s_cmp_lt_u32 s36, 28
    s_cbranch_scc1 L_recurrent_scan__compressed_kv_cla__moe_arch_mod__prompt_kernel_spin_91
L_recurrent_scan__compressed_kv_cla__moe_arch_mod__prompt_kernel_spinx_92:
    s_branch L_recurrent_scan__compressed_kv_cla__moe_arch_mod__prompt_kernel_back_94
L_recurrent_scan__compressed_kv_cla__moe_arch_mod__prompt_kernel_rare_98:
    v_mov_b32 v20, 4048155338
    v_subrev_u32 v21, s50, v18
    v_cmp_gt_i32 s[20:21], 0, v21
    v_cmp_gt_i32 s[22:23], 1, v21
    v_cmp_gt_i32 s[62:63], 2, v21
    v_cmp_gt_i32 vcc, 3, v21
    v_cndmask_b32 v96, v96, v20, s[20:21]
    v_cndmask_b32 v97, v97, v20, s[22:23]
    v_cndmask_b32 v98, v98, v20, s[62:63]
    v_cndmask_b32 v99, v99, v20, vcc
    v_cmp_gt_i32 s[20:21], 16, v21
    v_cmp_gt_i32 s[22:23], 17, v21
    v_cmp_gt_i32 s[62:63], 18, v21
    v_cmp_gt_i32 vcc, 19, v21
    v_cndmask_b32 v100, v100, v20, s[20:21]
    v_cndmask_b32 v101, v101, v20, s[22:23]
    v_cndmask_b32 v102, v102, v20, s[62:63]
    v_cndmask_b32 v103, v103, v20, vcc
    v_cmp_gt_i32 s[20:21], -16, v21
    v_cmp_gt_i32 s[22:23], -15, v21
    v_cmp_gt_i32 s[62:63], -14, v21
    v_cmp_gt_i32 vcc, -13, v21
    v_cndmask_b32 v104, v104, v20, s[20:21]
    v_cndmask_b32 v105, v105, v20, s[22:23]
    v_cndmask_b32 v106, v106, v20, s[62:63]
    v_cndmask_b32 v107, v107, v20, vcc
    v_cmp_gt_i32 s[20:21], 0, v21
    v_cmp_gt_i32 s[22:23], 1, v21
    v_cmp_gt_i32 s[62:63], 2, v21
    v_cmp_gt_i32 vcc, 3, v21
    v_cndmask_b32 v108, v108, v20, s[20:21]
    v_cndmask_b32 v109, v109, v20, s[22:23]
    v_cndmask_b32 v110, v110, v20, s[62:63]
    v_cndmask_b32 v111, v111, v20, vcc
    s_branch L_recurrent_scan__compressed_kv_cla__moe_arch_mod__prompt_kernel_back_99
L_grp1:
    v_mov_b32 v20, 1040356334
    v_mov_b32 v21, v20
    s_and_b32 s37, s28, 3
    s_lshl_b32 s37, s37, 13
    v_lshlrev_b32 v7, 4, v1
    v_add_u32 v4, s37, v7
    v_add_u32 v19, 131072, v4
    v_add_u32 v6, 4096, v4
    s_add_u32 s43, s37, 32768
    s_add_u32 s44, s37, 98304
    s_waitcnt vmcnt(4) lgkmcnt(0)
    v_pk_mul_f32 v[192:193], v[192:193], v[20:21]
    v_pk_mul_f32 v[194:195], v[194:195], v[20:21]
    v_pk_mul_f32 v[196:197], v[196:197], v[20:21]
    v_pk_mul_f32 v[198:199], v[198:199], v[20:21]
    v_cvt_pk_bf16_f32 v128, v192, v193
    v_cvt_pk_bf16_f32 v129, v194, v195
    v_cvt_pk_bf16_f32 v130, v196, v197
    v_cvt_pk_bf16_f32 v131, v198, v199
    v_pk_mul_f32 v[200:201], v[200:201], v[20:21]
    v_pk_mul_f32 v[202:203], v[202:203], v[20:21]
    v_pk_mul_f32 v[204:205], v[204:205], v[20:21]
    v_pk_mul_f32 v[206:207], v[206:207], v[20:21]
    v_cvt_pk_bf16_f32 v132, v200, v201
    v_cvt_pk_bf16_f32 v133, v202, v203
    v_cvt_pk_bf16_f32 v134, v204, v205
    v_cvt_pk_bf16_f32 v135, v206, v207
    v_pk_mul_f32 v[208:209], v[208:209], v[20:21]
    v_pk_mul_f32 v[210:211], v[210:211], v[20:21]
    v_pk_mul_f32 v[212:213], v[212:213], v[20:21]
    v_pk_mul_f32 v[214:215], v[214:215], v[20:21]
    v_cvt_pk_bf16_f32 v136, v208, v209
    v_cvt_pk_bf16_f32 v137, v210, v211
    v_cvt_pk_bf16_f32 v138, v212, v213
    v_cvt_pk_bf16_f32 v139, v214, v215
    v_pk_mul_f32 v[216:217], v[216:217], v[20:21]
    v_pk_mul_f32 v[218:219], v[218:219], v[20:21]
    v_pk_mul_f32 v[220:221], v[220:221], v[20:21]
    v_pk_mul_f32 v[222:223], v[222:223], v[20:21]
    v_cvt_pk_bf16_f32 v140, v216, v217
    v_cvt_pk_bf16_f32 v141, v218, v219
    v_cvt_pk_bf16_f32 v142, v220, v221
    v_cvt_pk_bf16_f32 v143, v222, v223
    v_pk_mul_f32 v[224:225], v[224:225], v[20:21]
    v_pk_mul_f32 v[226:227], v[226:227], v[20:21]
    v_pk_mul_f32 v[228:229], v[228:229], v[20:21]
    v_pk_mul_f32 v[230:231], v[230:231], v[20:21]
    v_cvt_pk_bf16_f32 v144, v224, v225
    v_cvt_pk_bf16_f32 v145, v226, v227
    v_cvt_pk_bf16_f32 v146, v228, v229
    v_cvt_pk_bf16_f32 v147, v230, v231
    v_pk_mul_f32 v[232:233], v[232:233], v[20:21]
    v_pk_mul_f32 v[234:235], v[234:235], v[20:21]
    v_pk_mul_f32 v[236:237], v[236:237], v[20:21]
    v_pk_mul_f32 v[238:239], v[238:239], v[20:21]
    v_cvt_pk_bf16_f32 v148, v232, v233
    v_cvt_pk_bf16_f32 v149, v234, v235
    v_cvt_pk_bf16_f32 v150, v236, v237
    v_cvt_pk_bf16_f32 v151, v238, v239
    v_pk_mul_f32 v[240:241], v[240:241], v[20:21]
    v_pk_mul_f32 v[242:243], v[242:243], v[20:21]
    v_pk_mul_f32 v[244:245], v[244:245], v[20:21]
    v_pk_mul_f32 v[246:247], v[246:247], v[20:21]
    v_cvt_pk_bf16_f32 v152, v240, v241
    v_cvt_pk_bf16_f32 v153, v242, v243
    v_cvt_pk_bf16_f32 v154, v244, v245
    v_cvt_pk_bf16_f32 v155, v246, v247
    v_pk_mul_f32 v[248:249], v[248:249], v[20:21]
    v_pk_mul_f32 v[250:251], v[250:251], v[20:21]
    v_pk_mul_f32 v[252:253], v[252:253], v[20:21]
    v_pk_mul_f32 v[254:255], v[254:255], v[20:21]
    v_cvt_pk_bf16_f32 v156, v248, v249
    v_cvt_pk_bf16_f32 v157, v250, v251
    v_cvt_pk_bf16_f32 v158, v252, v253
    v_cvt_pk_bf16_f32 v159, v254, v255
    v_mov_b32 v2, v7
    v_and_b32 v21, 15, v1
    v_lshrrev_b32 v22, 4, v1
    v_lshlrev_b32 v22, 2, v22
    v_sub_u32 v18, v21, v22
    s_mov_b32 s40, 0
    s_mov_b32 s41, 16384
    s_mov_b32 s49, 0xffff
    s_lshl_b32 s51, s30, 1
    s_add_u32 s51, s51, 1
    s_and_b32 s50, s28, 3
    s_lshl_b32 s50, s50, 5
    v_mov_b32 v36, 0x3f803f80
    v_mov_b32 v37, 0x3f803f80
    v_mov_b32 v38, 0x3f803f80
    v_mov_b32 v39, 0x3f803f80
    s_lshl_b32 s42, 7, s51
    s_lshr_b32 s42, s42, 2
    s_or_b32 s42, s42, 0x8001
    s_mov_b64 s[52:53], 0
    s_waitcnt lgkmcnt(0)
    s_barrier
    ds_read_b128 v[160:163], v19 offset:0
    ds_read_b128 v[164:167], v19 offset:1024
    ds_read_b128 v[168:171], v19 offset:2048
    ds_read_b128 v[172:175], v19 offset:3072
    ds_read_b128 v[176:179], v19 offset:4096
    ds_read_b128 v[180:183], v19 offset:5120
    ds_read_b128 v[184:187], v19 offset:6144
    ds_read_b128 v[188:191], v19 offset:7168
    s_add_u32 s16, s54, 41943040
    s_addc_u32 s17, s55, 0
    s_and_b32 s17, s17, 0xffff
    s_mov_b32 s18, 117440640
    s_mov_b32 s19, 0x20000
    s_cmp_eq_u32 s28, 4
    s_cbranch_scc1 L_recurrent_scan__compressed_kv_cla__moe_arch_mod__prompt_kernel_rare_100
L_recurrent_scan__compressed_kv_cla__moe_arch_mod__prompt_kernel_back_101:
    s_sub_u32 s36, s2, 160
    s_lshl_b32 s36, s36, 1
    s_and_b32 s37, s28, 1
    s_add_u32 s36, s36, s37
    s_min_u32 s36, s36, 1024
    s_mul_i32 s36, s36, 43776
    s_cmp_lt_u32 s28, 6
    s_cselect_b64 s[4:5], s[32:33], s[34:35]
    s_cselect_b32 s37, 32, 28
    s_lshl_b32 s37, s37, 18
    s_min_u32 s36, s36, s37
    s_sub_u32 s6, s37, s36
    s_min_u32 s6, s6, 43776
    s_add_u32 s4, s4, s36
    s_addc_u32 s5, s5, 0
    s_and_b32 s5, s5, 0xffff
    s_mov_b32 s7, 0x20000
    v_cmp_gt_u32 vcc, 32, v1
    v_lshlrev_b32 v13, 7, v1
    v_mov_b32 v12, 0x100000
    v_cndmask_b32 v13, v12, v13, vcc
    s_mov_b32 s48, 0
    s_cmp_eq_u32 s28, 5
    s_cselect_b32 s36, 0x1000, 0
    s_or_b32 s42, s42, s36
    ds_read_b128 v[64:67], v2 offset:0
    ds_read_b128 v[68:71], v2 offset:1024
    ds_read_b128 v[72:75], v2 offset:2048
    ds_read_b128 v[76:79], v2 offset:3072
    ds_read_b128 v[80:83], v2 offset:4096
    ds_read_b128 v[84:87], v2 offset:5120
    ds_read_b128 v[88:91], v2 offset:6144
    ds_read_b128 v[92:95], v2 offset:7168
    s_waitcnt lgkmcnt(7)
    v_mfma_f32_16x16x32_bf16 v[96:99], v[64:67], v[128:131], 0
    v_mov_b64 v[192:193], 0
    v_mov_b64 v[194:195], 0
    v_mfma_f32_16x16x32_bf16 v[104:107], v[64:67], v[144:147], 0
    ds_read_b128 v[64:67], v2 offset:8192
    v_mov_b64 v[196:197], 0
    v_mov_b64 v[198:199], 0
    s_waitcnt lgkmcnt(7)
    v_mfma_f32_16x16x32_bf16 v[96:99], v[68:71], v[132:135], v[96:99]
    v_mov_b64 v[200:201], 0
    v_mov_b64 v[202:203], 0
    v_mfma_f32_16x16x32_bf16 v[104:107], v[68:71], v[148:151], v[104:107]
    ds_read_b128 v[68:71], v2 offset:9216
    v_mov_b64 v[204:205], 0
    v_mov_b64 v[206:207], 0
    s_waitcnt lgkmcnt(7)
    v_mfma_f32_16x16x32_bf16 v[96:99], v[72:75], v[136:139], v[96:99]
    v_mov_b64 v[208:209], 0
    v_mfma_f32_16x16x32_bf16 v[104:107], v[72:75], v[152:155], v[104:107]
    ds_read_b128 v[72:75], v2 offset:10240
    v_mov_b64 v[210:211], 0
    v_mov_b64 v[212:213], 0
    s_waitcnt lgkmcnt(7)
    v_mfma_f32_16x16x32_bf16 v[96:99], v[76:79], v[140:143], v[96:99]
    v_mov_b64 v[214:215], 0
    v_mov_b64 v[216:217], 0
    v_mfma_f32_16x16x32_bf16 v[104:107], v[76:79], v[156:159], v[104:107]
    ds_read_b128 v[76:79], v2 offset:11264
    v_mov_b64 v[218:219], 0
    v_mov_b64 v[220:221], 0
    s_waitcnt lgkmcnt(7)
    v_mfma_f32_16x16x32_bf16 v[100:103], v[80:83], v[128:131], 0
    v_mov_b64 v[222:223], 0
    v_mov_b64 v[224:225], 0
    v_mfma_f32_16x16x32_bf16 v[108:111], v[80:83], v[144:147], 0
    ds_read_b128 v[80:83], v2 offset:12288
    v_mov_b64 v[226:227], 0
    s_waitcnt lgkmcnt(7)
    v_mfma_f32_16x16x32_bf16 v[100:103], v[84:87], v[132:135], v[100:103]
    v_mov_b64 v[228:229], 0
    v_mov_b64 v[230:231], 0
    v_mfma_f32_16x16x32_bf16 v[108:111], v[84:87], v[148:151], v[108:111]
    ds_read_b128 v[84:87], v2 offset:13312
    v_mov_b64 v[232:233], 0
    v_mov_b64 v[234:235], 0
    s_waitcnt lgkmcnt(7)
    v_mfma_f32_16x16x32_bf16 v[100:103], v[88:91], v[136:139], v[100:103]
    v_mov_b64 v[236:237], 0
    v_mov_b64 v[238:239], 0
    v_mfma_f32_16x16x32_bf16 v[108:111], v[88:91], v[152:155], v[108:111]
    ds_read_b128 v[88:91], v2 offset:14336
    v_mov_b64 v[240:241], 0
    v_mov_b64 v[242:243], 0
    s_waitcnt lgkmcnt(7)
    v_mfma_f32_16x16x32_bf16 v[100:103], v[92:95], v[140:143], v[100:103]
    v_mov_b64 v[244:245], 0
    v_mfma_f32_16x16x32_bf16 v[108:111], v[92:95], v[156:159], v[108:111]
    ds_read_b128 v[92:95], v2 offset:15360
    v_mov_b64 v[246:247], 0
    v_mov_b64 v[248:249], 0
    s_waitcnt lgkmcnt(7)
    v_mfma_f32_16x16x32_bf16 v[112:115], v[64:67], v[128:131], 0
    v_mov_b64 v[250:251], 0
    v_mov_b64 v[252:253], 0
    v_mfma_f32_16x16x32_bf16 v[120:123], v[64:67], v[144:147], 0
    v_mov_b64 v[254:255], 0
    v_mov_b64 v[28:29], 0
    s_waitcnt lgkmcnt(6)
    v_mfma_f32_16x16x32_bf16 v[112:115], v[68:71], v[132:135], v[112:115]
    v_mov_b64 v[30:31], 0
    v_mov_b64 v[32:33], 0
    v_mfma_f32_16x16x32_bf16 v[120:123], v[68:71], v[148:151], v[120:123]
    v_mov_b64 v[34:35], 0
    s_waitcnt lgkmcnt(5)
    v_mfma_f32_16x16x32_bf16 v[112:115], v[72:75], v[136:139], v[112:115]
    s_add_u32 s36, s30, s50
    s_cmp_eq_u32 s36, 0
    s_cbranch_scc1 L_recurrent_scan__compressed_kv_cla__moe_arch_mod__prompt_kernel_rare_103
L_recurrent_scan__compressed_kv_cla__moe_arch_mod__prompt_kernel_back_104:
    v_mfma_f32_16x16x32_bf16 v[120:123], v[72:75], v[152:155], v[120:123]
    v_max3_f32 v22, v96, v97, v98
    v_max3_f32 v23, v104, v105, v106
    s_waitcnt lgkmcnt(4)
    v_mfma_f32_16x16x32_bf16 v[112:115], v[76:79], v[140:143], v[112:115]
    v_max3_f32 v22, v22, v99, v100
    v_max3_f32 v23, v23, v107, v108
    v_mfma_f32_16x16x32_bf16 v[120:123], v[76:79], v[156:159], v[120:123]
    v_max3_f32 v22, v22, v101, v102
    v_max3_f32 v23, v23, v109, v110
    s_waitcnt lgkmcnt(3)
    v_mfma_f32_16x16x32_bf16 v[116:119], v[80:83], v[128:131], 0
    v_max_f32 v22, v22, v103
    v_max_f32 v23, v23, v111
    v_mfma_f32_16x16x32_bf16 v[124:127], v[80:83], v[144:147], 0
    v_mov_b32 v24, v22
    v_mov_b32 v25, v23
    s_waitcnt lgkmcnt(2)
    v_mfma_f32_16x16x32_bf16 v[116:119], v[84:87], v[132:135], v[116:119]
    v_permlane16_swap_b32 v22, v24
    v_permlane16_swap_b32 v23, v25
    v_mfma_f32_16x16x32_bf16 v[124:127], v[84:87], v[148:151], v[124:127]
    v_max_f32 v22, v22, v24
    v_max_f32 v23, v23, v25
    s_waitcnt lgkmcnt(1)
    v_mfma_f32_16x16x32_bf16 v[116:119], v[88:91], v[136:139], v[116:119]
    v_mov_b32 v24, v22
    v_mov_b32 v25, v23
    v_mfma_f32_16x16x32_bf16 v[124:127], v[88:91], v[152:155], v[124:127]
    v_permlane32_swap_b32 v22, v24
    v_permlane32_swap_b32 v23, v25
    s_waitcnt lgkmcnt(0)
    v_mfma_f32_16x16x32_bf16 v[116:119], v[92:95], v[140:143], v[116:119]
    v_max_f32 v22, v22, v24
    v_max_f32 v23, v23, v25
    v_mfma_f32_16x16x32_bf16 v[124:127], v[92:95], v[156:159], v[124:127]
    v_sub_f32 v40, 0, v22
    v_sub_f32 v41, 0, v22
    v_sub_f32 v42, 0, v22
    v_sub_f32 v43, 0, v22
    v_sub_f32 v44, 0, v23
    v_sub_f32 v45, 0, v23
    v_sub_f32 v46, 0, v23
    v_sub_f32 v47, 0, v23
    v_add_u32 v3, 65536, v2
    v_add_u32 v2, s41, v2
    v_and_b32 v2, s49, v2
    s_waitcnt vmcnt(1)
    s_cmp_eq_u32 s28, 4
    s_cbranch_scc1 L_recurrent_scan__compressed_kv_cla__moe_arch_mod__prompt_kernel_pw_105
    s_waitcnt vmcnt(0)
L_recurrent_scan__compressed_kv_cla__moe_arch_mod__prompt_kernel_pw_105:
    s_barrier
    ds_read_b128 v[64:67], v2 offset:0
    ds_read_b128 v[68:71], v2 offset:1024
    ds_read_b128 v[72:75], v2 offset:2048
    ds_read_b128 v[76:79], v2 offset:3072
    ds_read_b128 v[80:83], v2 offset:4096
    ds_read_b128 v[84:87], v2 offset:5120
    ds_read_b128 v[88:91], v2 offset:6144
    v_pk_add_f32 v[96:97], v[96:97], v[40:41]
    v_pk_add_f32 v[98:99], v[98:99], v[40:41]
    v_pk_add_f32 v[100:101], v[100:101], v[40:41]
    v_pk_add_f32 v[102:103], v[102:103], v[40:41]
    v_pk_add_f32 v[104:105], v[104:105], v[44:45]
    v_pk_add_f32 v[106:107], v[106:107], v[44:45]
    v_pk_add_f32 v[108:109], v[108:109], v[44:45]
    v_pk_add_f32 v[110:111], v[110:111], v[44:45]
    v_pk_add_f32 v[112:113], v[112:113], v[40:41]
    v_pk_add_f32 v[114:115], v[114:115], v[40:41]
    v_pk_add_f32 v[116:117], v[116:117], v[40:41]
    v_pk_add_f32 v[118:119], v[118:119], v[40:41]
    v_pk_add_f32 v[120:121], v[120:121], v[44:45]
    v_pk_add_f32 v[122:123], v[122:123], v[44:45]
    v_pk_add_f32 v[124:125], v[124:125], v[44:45]
    v_pk_add_f32 v[126:127], v[126:127], v[44:45]
    v_exp_f32 v96, v96
    v_exp_f32 v97, v97
    v_exp_f32 v98, v98
    v_exp_f32 v99, v99
    v_exp_f32 v104, v104
    v_exp_f32 v105, v105
    v_exp_f32 v106, v106
    v_exp_f32 v107, v107
    v_exp_f32 v100, v100
    v_exp_f32 v101, v101
    v_exp_f32 v102, v102
    v_exp_f32 v103, v103
    v_exp_f32 v108, v108
    v_exp_f32 v109, v109
    v_exp_f32 v110, v110
    v_exp_f32 v111, v111
    v_cvt_pk_bf16_f32 v48, v96, v97
    v_cvt_pk_bf16_f32 v49, v98, v99
    v_cvt_pk_bf16_f32 v52, v104, v105
    v_cvt_pk_bf16_f32 v53, v106, v107
    v_cvt_pk_bf16_f32 v50, v100, v101
    v_cvt_pk_bf16_f32 v51, v102, v103
    v_cvt_pk_bf16_f32 v54, v108, v109
    v_cvt_pk_bf16_f32 v55, v110, v111
    .p2align 6
L_body1:
    s_bitcmp1_b32 s42, s40
    s_cbranch_scc1 L_recurrent_scan__compressed_kv_cla__moe_arch_mod__prompt_kernel_rare_110
L_recurrent_scan__compressed_kv_cla__moe_arch_mod__prompt_kernel_back_111:
    s_waitcnt lgkmcnt(5)
    v_mfma_f32_16x16x32_bf16 v[96:99], v[64:67], v[128:131], v[40:43]
    v_exp_f32 v112, v112
    v_mfma_f32_16x16x32_bf16 v[104:107], v[64:67], v[144:147], v[44:47]
    ds_read_b128 v[92:95], v2 offset:7168
    v_mfma_f32_16x16x32_bf16 v[96:99], v[68:71], v[132:135], v[96:99]
    v_exp_f32 v113, v113
    v_mfma_f32_16x16x32_bf16 v[104:107], v[68:71], v[148:151], v[104:107]
    ds_read_b128 v[64:67], v3 offset:0
    s_waitcnt lgkmcnt(5)
    v_mfma_f32_16x16x32_bf16 v[96:99], v[72:75], v[136:139], v[96:99]
    v_exp_f32 v114, v114
    v_mfma_f32_16x16x32_bf16 v[104:107], v[72:75], v[152:155], v[104:107]
    ds_read_b128 v[68:71], v3 offset:1024
    v_cvt_pk_bf16_f32 v56, v112, v113
    v_mfma_f32_16x16x32_bf16 v[96:99], v[76:79], v[140:143], v[96:99]
    v_exp_f32 v115, v115
    v_mfma_f32_16x16x32_bf16 v[104:107], v[76:79], v[156:159], v[104:107]
    ds_read_b128 v[72:75], v3 offset:2048
    s_waitcnt lgkmcnt(5)
    v_mfma_f32_16x16x32_bf16 v[100:103], v[80:83], v[128:131], v[40:43]
    v_exp_f32 v120, v120
    v_mfma_f32_16x16x32_bf16 v[108:111], v[80:83], v[144:147], v[44:47]
    ds_read_b128 v[76:79], v3 offset:3072
    v_cvt_pk_bf16_f32 v57, v114, v115
    v_mfma_f32_16x16x32_bf16 v[100:103], v[84:87], v[132:135], v[100:103]
    v_exp_f32 v121, v121
    v_mfma_f32_16x16x32_bf16 v[108:111], v[84:87], v[148:151], v[108:111]
    ds_read_b128 v[80:83], v3 offset:4096
    s_waitcnt lgkmcnt(5)
    v_mfma_f32_16x16x32_bf16 v[100:103], v[88:91], v[136:139], v[100:103]
    v_exp_f32 v122, v122
    v_mfma_f32_16x16x32_bf16 v[108:111], v[88:91], v[152:155], v[108:111]
    ds_read_b128 v[84:87], v3 offset:5120
    v_cvt_pk_bf16_f32 v60, v120, v121
    v_mfma_f32_16x16x32_bf16 v[100:103], v[92:95], v[140:143], v[100:103]
    v_exp_f32 v123, v123
    v_mfma_f32_16x16x32_bf16 v[108:111], v[92:95], v[156:159], v[108:111]
    ds_read_b128 v[88:91], v3 offset:6144
    s_waitcnt lgkmcnt(5)
    v_mfma_f32_16x16x32_bf16 v[192:195], v[64:67], v[48:51], v[192:195]
    v_exp_f32 v116, v116
    v_mfma_f32_16x16x32_bf16 v[224:227], v[64:67], v[52:55], v[224:227]
    ds_read_b128 v[92:95], v3 offset:7168
    v_cvt_pk_bf16_f32 v61, v122, v123
    v_mfma_f32_16x16x32_bf16 v[196:199], v[68:71], v[48:51], v[196:199]
    v_exp_f32 v117, v117
    v_mfma_f32_16x16x32_bf16 v[228:231], v[68:71], v[52:55], v[228:231]
    ds_read_b128 v[64:67], v2 offset:8192
    s_waitcnt lgkmcnt(5)
    v_mfma_f32_16x16x32_bf16 v[200:203], v[72:75], v[48:51], v[200:203]
    v_exp_f32 v118, v118
    v_mfma_f32_16x16x32_bf16 v[232:235], v[72:75], v[52:55], v[232:235]
    v_mfma_f32_16x16x32_bf16 v[28:31], v[36:39], v[48:51], v[28:31]
    ds_read_b128 v[68:71], v2 offset:9216
    v_cvt_pk_bf16_f32 v58, v116, v117
    v_mfma_f32_16x16x32_bf16 v[204:207], v[76:79], v[48:51], v[204:207]
    v_exp_f32 v119, v119
    v_mfma_f32_16x16x32_bf16 v[236:239], v[76:79], v[52:55], v[236:239]
    ds_read_b128 v[72:75], v2 offset:10240
    s_waitcnt lgkmcnt(5)
    v_mfma_f32_16x16x32_bf16 v[208:211], v[80:83], v[48:51], v[208:211]
    v_exp_f32 v124, v124
    buffer_load_dword v0, v13, s[4:7], s48 offen
    s_add_u32 s48, s48, 4096
    v_mfma_f32_16x16x32_bf16 v[240:243], v[80:83], v[52:55], v[240:243]
    ds_read_b128 v[76:79], v2 offset:11264
    v_cvt_pk_bf16_f32 v59, v118, v119
    v_mfma_f32_16x16x32_bf16 v[212:215], v[84:87], v[48:51], v[212:215]
    v_exp_f32 v125, v125
    v_mfma_f32_16x16x32_bf16 v[244:247], v[84:87], v[52:55], v[244:247]
    ds_read_b128 v[80:83], v2 offset:12288
    s_waitcnt lgkmcnt(5)
    v_mfma_f32_16x16x32_bf16 v[216:219], v[88:91], v[48:51], v[216:219]
    v_exp_f32 v126, v126
    v_mfma_f32_16x16x32_bf16 v[248:251], v[88:91], v[52:55], v[248:251]
    v_mfma_f32_16x16x32_bf16 v[32:35], v[36:39], v[52:55], v[32:35]
    ds_read_b128 v[84:87], v2 offset:13312
    v_cvt_pk_bf16_f32 v62, v124, v125
    v_mfma_f32_16x16x32_bf16 v[220:223], v[92:95], v[48:51], v[220:223]
    v_exp_f32 v127, v127
    v_mfma_f32_16x16x32_bf16 v[252:255], v[92:95], v[52:55], v[252:255]
    ds_read_b128 v[88:91], v2 offset:14336
    v_cvt_pk_bf16_f32 v63, v126, v127
    s_bitcmp1_b32 s42, s40
    s_cbranch_scc1 L_recurrent_scan__compressed_kv_cla__moe_arch_mod__prompt_kernel_rare_113
L_recurrent_scan__compressed_kv_cla__moe_arch_mod__prompt_kernel_back_114:
    s_waitcnt lgkmcnt(5)
    v_mfma_f32_16x16x32_bf16 v[112:115], v[64:67], v[128:131], v[40:43]
    v_exp_f32 v96, v96
    v_mfma_f32_16x16x32_bf16 v[120:123], v[64:67], v[144:147], v[44:47]
    ds_read_b128 v[92:95], v2 offset:15360
    v_mfma_f32_16x16x32_bf16 v[112:115], v[68:71], v[132:135], v[112:115]
    v_exp_f32 v97, v97
    v_mfma_f32_16x16x32_bf16 v[120:123], v[68:71], v[148:151], v[120:123]
    ds_read_b128 v[64:67], v3 offset:8192
    s_waitcnt lgkmcnt(5)
    v_mfma_f32_16x16x32_bf16 v[112:115], v[72:75], v[136:139], v[112:115]
    v_exp_f32 v98, v98
    v_mfma_f32_16x16x32_bf16 v[120:123], v[72:75], v[152:155], v[120:123]
    ds_read_b128 v[68:71], v3 offset:9216
    v_cvt_pk_bf16_f32 v48, v96, v97
    v_mfma_f32_16x16x32_bf16 v[112:115], v[76:79], v[140:143], v[112:115]
    v_exp_f32 v99, v99
    v_mfma_f32_16x16x32_bf16 v[120:123], v[76:79], v[156:159], v[120:123]
    ds_read_b128 v[72:75], v3 offset:10240
    s_waitcnt lgkmcnt(5)
    v_mfma_f32_16x16x32_bf16 v[116:119], v[80:83], v[128:131], v[40:43]
    v_exp_f32 v104, v104
    v_mfma_f32_16x16x32_bf16 v[124:127], v[80:83], v[144:147], v[44:47]
    ds_read_b128 v[76:79], v3 offset:11264
    v_cvt_pk_bf16_f32 v49, v98, v99
    v_mfma_f32_16x16x32_bf16 v[116:119], v[84:87], v[132:135], v[116:119]
    v_exp_f32 v105, v105
    v_mfma_f32_16x16x32_bf16 v[124:127], v[84:87], v[148:151], v[124:127]
    ds_read_b128 v[80:83], v3 offset:12288
    s_waitcnt lgkmcnt(5)
    v_mfma_f32_16x16x32_bf16 v[116:119], v[88:91], v[136:139], v[116:119]
    v_exp_f32 v106, v106
    v_mfma_f32_16x16x32_bf16 v[124:127], v[88:91], v[152:155], v[124:127]
    ds_read_b128 v[84:87], v3 offset:13312
    v_cvt_pk_bf16_f32 v52, v104, v105
    v_mfma_f32_16x16x32_bf16 v[116:119], v[92:95], v[140:143], v[116:119]
    v_exp_f32 v107, v107
    v_mfma_f32_16x16x32_bf16 v[124:127], v[92:95], v[156:159], v[124:127]
    ds_read_b128 v[88:91], v3 offset:14336
    s_waitcnt lgkmcnt(5)
    v_mfma_f32_16x16x32_bf16 v[192:195], v[64:67], v[56:59], v[192:195]
    v_exp_f32 v100, v100
    v_mfma_f32_16x16x32_bf16 v[224:227], v[64:67], v[60:63], v[224:227]
    ds_read_b128 v[92:95], v3 offset:15360
    v_cvt_pk_bf16_f32 v53, v106, v107
    v_mfma_f32_16x16x32_bf16 v[196:199], v[68:71], v[56:59], v[196:199]
    v_exp_f32 v101, v101
    v_mfma_f32_16x16x32_bf16 v[228:231], v[68:71], v[60:63], v[228:231]
    v_add_u32 v3, 65536, v2
    v_add_u32 v2, s41, v2
    s_waitcnt lgkmcnt(4)
    v_mfma_f32_16x16x32_bf16 v[200:203], v[72:75], v[56:59], v[200:203]
    v_exp_f32 v102, v102
    v_and_b32 v2, s49, v2
    v_mfma_f32_16x16x32_bf16 v[232:235], v[72:75], v[60:63], v[232:235]
    v_mfma_f32_16x16x32_bf16 v[28:31], v[36:39], v[56:59], v[28:31]
    v_cvt_pk_bf16_f32 v50, v100, v101
    s_waitcnt lgkmcnt(0)
    s_barrier
    v_mfma_f32_16x16x32_bf16 v[204:207], v[76:79], v[56:59], v[204:207]
    v_exp_f32 v103, v103
    v_mfma_f32_16x16x32_bf16 v[236:239], v[76:79], v[60:63], v[236:239]
    ds_read_b128 v[68:71], v2 offset:1024
    ds_read_b128 v[64:67], v2 offset:0
    v_mfma_f32_16x16x32_bf16 v[208:211], v[80:83], v[56:59], v[208:211]
    v_exp_f32 v108, v108
    v_mfma_f32_16x16x32_bf16 v[240:243], v[80:83], v[60:63], v[240:243]
    ds_read_b128 v[76:79], v2 offset:3072
    ds_read_b128 v[72:75], v2 offset:2048
    v_cvt_pk_bf16_f32 v51, v102, v103
    v_mfma_f32_16x16x32_bf16 v[212:215], v[84:87], v[56:59], v[212:215]
    v_exp_f32 v109, v109
    v_mfma_f32_16x16x32_bf16 v[244:247], v[84:87], v[60:63], v[244:247]
    ds_read_b128 v[80:83], v2 offset:4096
    v_mfma_f32_16x16x32_bf16 v[216:219], v[88:91], v[56:59], v[216:219]
    v_exp_f32 v110, v110
    v_mfma_f32_16x16x32_bf16 v[248:251], v[88:91], v[60:63], v[248:251]
    v_mfma_f32_16x16x32_bf16 v[32:35], v[36:39], v[60:63], v[32:35]
    ds_read_b128 v[84:87], v2 offset:5120
    v_cvt_pk_bf16_f32 v54, v108, v109
    v_mfma_f32_16x16x32_bf16 v[220:223], v[92:95], v[56:59], v[220:223]
    v_exp_f32 v111, v111
    v_mfma_f32_16x16x32_bf16 v[252:255], v[92:95], v[60:63], v[252:255]
    ds_read_b128 v[88:91], v2 offset:6144
    v_cvt_pk_bf16_f32 v55, v110, v111
    s_bitcmp1_b32 s42, s40
    s_cbranch_scc1 L_recurrent_scan__compressed_kv_cla__moe_arch_mod__prompt_kernel_rare_123
L_recurrent_scan__compressed_kv_cla__moe_arch_mod__prompt_kernel_back_124:
    s_add_u32 s40, s40, 1
    s_cmp_lg_u32 s40, 16
    s_cbranch_scc1 L_body1
    s_lshr_b32 s36, s2, 5
    s_add_u32 s36, s36, 48
    s_lshl_b32 s36, s36, 7
    v_mov_b32 v12, s36
    global_load_dword v11, v12, s[90:91] sc1
    s_sub_u32 s36, 96, s50
    s_cmp_lt_i32 s36, 0
    s_cbranch_scc0 L_recurrent_scan__compressed_kv_cla__moe_arch_mod__prompt_kernel_rare_116
L_recurrent_scan__compressed_kv_cla__moe_arch_mod__prompt_kernel_back_117:
    s_lshl_b32 s37, s28, 13
    v_add_u32 v5, s37, v7
    s_waitcnt lgkmcnt(5)
    v_mfma_f32_16x16x32_bf16 v[192:195], v[64:67], v[48:51], v[192:195]
    v_exp_f32 v112, v112
    v_mfma_f32_16x16x32_bf16 v[224:227], v[64:67], v[52:55], v[224:227]
    ds_read_b128 v[92:95], v3 offset:7168
    v_exp_f32 v113, v113
    v_mfma_f32_16x16x32_bf16 v[196:199], v[68:71], v[48:51], v[196:199]
    v_cvt_pk_bf16_f32 v56, v112, v113
    v_exp_f32 v114, v114
    v_mfma_f32_16x16x32_bf16 v[228:231], v[68:71], v[52:55], v[228:231]
    ds_read_b128 v[64:67], v3 offset:8192
    v_exp_f32 v115, v115
    s_waitcnt lgkmcnt(5)
    v_mfma_f32_16x16x32_bf16 v[200:203], v[72:75], v[48:51], v[200:203]
    v_cvt_pk_bf16_f32 v57, v114, v115
    v_exp_f32 v120, v120
    v_mfma_f32_16x16x32_bf16 v[232:235], v[72:75], v[52:55], v[232:235]
    v_mfma_f32_16x16x32_bf16 v[28:31], v[36:39], v[48:51], v[28:31]
    ds_read_b128 v[68:71], v3 offset:9216
    v_exp_f32 v121, v121
    v_mfma_f32_16x16x32_bf16 v[204:207], v[76:79], v[48:51], v[204:207]
    v_cvt_pk_bf16_f32 v60, v120, v121
    v_exp_f32 v122, v122
    v_mfma_f32_16x16x32_bf16 v[236:239], v[76:79], v[52:55], v[236:239]
    ds_read_b128 v[72:75], v3 offset:10240
    v_exp_f32 v123, v123
    s_waitcnt lgkmcnt(6)
    v_mfma_f32_16x16x32_bf16 v[208:211], v[80:83], v[48:51], v[208:211]
    v_cvt_pk_bf16_f32 v61, v122, v123
    v_exp_f32 v116, v116
    v_mfma_f32_16x16x32_bf16 v[240:243], v[80:83], v[52:55], v[240:243]
    ds_read_b128 v[76:79], v3 offset:11264
    v_exp_f32 v117, v117
    s_waitcnt lgkmcnt(6)
    v_mfma_f32_16x16x32_bf16 v[212:215], v[84:87], v[48:51], v[212:215]
    v_cvt_pk_bf16_f32 v58, v116, v117
    v_exp_f32 v118, v118
    v_mfma_f32_16x16x32_bf16 v[244:247], v[84:87], v[52:55], v[244:247]
    ds_read_b128 v[80:83], v3 offset:12288
    v_exp_f32 v119, v119
    s_waitcnt lgkmcnt(6)
    v_mfma_f32_16x16x32_bf16 v[216:219], v[88:91], v[48:51], v[216:219]
    v_cvt_pk_bf16_f32 v59, v118, v119
    v_exp_f32 v124, v124
    v_mfma_f32_16x16x32_bf16 v[248:251], v[88:91], v[52:55], v[248:251]
    v_mfma_f32_16x16x32_bf16 v[32:35], v[36:39], v[52:55], v[32:35]
    ds_read_b128 v[84:87], v3 offset:13312
    v_exp_f32 v125, v125
    s_waitcnt lgkmcnt(6)
    v_mfma_f32_16x16x32_bf16 v[220:223], v[92:95], v[48:51], v[220:223]
    v_cvt_pk_bf16_f32 v62, v124, v125
    v_exp_f32 v126, v126
    v_mfma_f32_16x16x32_bf16 v[252:255], v[92:95], v[52:55], v[252:255]
    ds_read_b128 v[88:91], v3 offset:14336
    v_exp_f32 v127, v127
    s_nop 0
    v_cvt_pk_bf16_f32 v63, v126, v127
    s_nop 1
    s_waitcnt lgkmcnt(6)
    v_mfma_f32_16x16x32_bf16 v[192:195], v[64:67], v[56:59], v[192:195]
    s_mov_b32 s4, s34
    s_and_b32 s5, s35, 0xffff
    s_mov_b32 s6, 7340032
    s_mov_b32 s7, 0x20000
    s_mov_b32 s8, s32
    v_mfma_f32_16x16x32_bf16 v[224:227], v[64:67], v[60:63], v[224:227]
    ds_read_b128 v[92:95], v3 offset:15360
    s_and_b32 s9, s33, 0xffff
    s_mov_b32 s10, 8388608
    s_mov_b32 s11, 0x20000
    s_lshr_b32 s38, s2, 4
    s_waitcnt lgkmcnt(6)
    v_mfma_f32_16x16x32_bf16 v[196:199], v[68:71], v[56:59], v[196:199]
    s_mul_i32 s38, s38, 224
    s_and_b32 s39, s2, 15
    s_lshl_b32 s39, s39, 7
    v_lshrrev_b32 v25, 3, v1
    s_lshl_b32 s36, s28, 5
    v_mfma_f32_16x16x32_bf16 v[228:231], v[68:71], v[60:63], v[228:231]
    s_add_u32 s36, s36, s38
    v_add_u32 v25, s36, v25
    v_mul_u32_u24 v25, 2048, v25
    v_add_u32 v25, s39, v25
    s_waitcnt lgkmcnt(5)
    v_mfma_f32_16x16x32_bf16 v[200:203], v[72:75], v[56:59], v[200:203]
    v_bfe_u32 v26, v1, 4, 1
    v_lshlrev_b32 v26, 1, v26
    v_and_b32 v27, 7, v1
    v_xor_b32 v26, v26, v27
    v_mfma_f32_16x16x32_bf16 v[232:235], v[72:75], v[60:63], v[232:235]
    v_mfma_f32_16x16x32_bf16 v[28:31], v[36:39], v[56:59], v[28:31]
    v_lshl_add_u32 v24, v26, 4, v25
    v_xor_b32 v26, 4, v26
    v_lshl_add_u32 v25, v26, 4, v25
    v_add_u32 v25, 15360, v25
    v_add_u32 v26, 30720, v24
    s_waitcnt lgkmcnt(4)
    v_mfma_f32_16x16x32_bf16 v[204:207], v[76:79], v[56:59], v[204:207]
    v_add_u32 v27, 30720, v25
    s_lshl_b32 s36, s28, 12
    s_add_u32 s36, s36, 131072
    s_cmp_lt_u32 s28, 7
    s_cselect_b32 m0, s36, 0x30000
    s_cselect_b32 s6, 7340032, 0
    v_mfma_f32_16x16x32_bf16 v[236:239], v[76:79], v[60:63], v[236:239]
    buffer_load_dwordx4 v24, s[4:7], 0 offen offset:0 lds
    buffer_load_dwordx4 v25, s[4:7], 0 offen offset:1024 lds
    buffer_load_dwordx4 v26, s[4:7], 0 offen offset:2048 lds
    buffer_load_dwordx4 v27, s[4:7], 0 offen offset:3072 lds
    s_waitcnt lgkmcnt(3)
    v_mfma_f32_16x16x32_bf16 v[208:211], v[80:83], v[56:59], v[208:211]
    v_mfma_f32_16x16x32_bf16 v[240:243], v[80:83], v[60:63], v[240:243]
    ds_write_b128 v5, v[192:195] offset:0
    s_waitcnt lgkmcnt(3)
    v_mfma_f32_16x16x32_bf16 v[212:215], v[84:87], v[56:59], v[212:215]
    v_mfma_f32_16x16x32_bf16 v[244:247], v[84:87], v[60:63], v[244:247]
    ds_write_b128 v5, v[196:199] offset:1024
    s_waitcnt lgkmcnt(3)
    v_mfma_f32_16x16x32_bf16 v[216:219], v[88:91], v[56:59], v[216:219]
    v_mfma_f32_16x16x32_bf16 v[248:251], v[88:91], v[60:63], v[248:251]
    v_mfma_f32_16x16x32_bf16 v[32:35], v[36:39], v[60:63], v[32:35]
    ds_write_b128 v5, v[200:203] offset:2048
    s_waitcnt lgkmcnt(3)
    v_mfma_f32_16x16x32_bf16 v[220:223], v[92:95], v[56:59], v[220:223]
    v_mfma_f32_16x16x32_bf16 v[252:255], v[92:95], v[60:63], v[252:255]
    ds_write_b128 v5, v[204:207] offset:3072
    ds_write_b128 v5, v[208:211] offset:4096
    ds_write_b128 v5, v[212:215] offset:5120
    v_xor_b32 v106, 32768, v5
    s_lshl_b32 s37, s28, 8
    s_add_u32 s37, s37, 159744
    v_lshl_add_u32 v107, v1, 2, s37
    v_xor_b32 v108, 1024, v107
    ds_write_b128 v5, v[216:219] offset:6144
    ds_write_b128 v5, v[220:223] offset:7168
    ds_write_b32 v107, v28
    s_mov_b32 s36, 0x5d800000
    v_cmp_nge_f32 vcc, s36, v28
    s_nop 0
    s_or_b64 s[52:53], s[52:53], vcc
    v_cmp_nge_f32 vcc, s36, v32
    s_nop 0
    s_or_b64 s[52:53], s[52:53], vcc
    s_or_b32 s36, s52, s53
    v_mov_b32 v110, s36
    s_lshl_b32 s37, s28, 2
    s_add_u32 s37, s37, 161792
    v_mov_b32 v111, s37
    ds_write_b32 v111, v110
    v_mov_b32 v112, 161856
    v_and_b32 v111, 7, v1
    v_lshlrev_b32 v111, 2, v111
    v_add_u32 v111, 161792, v111
    v_mov_b32 v113, v7
    s_sub_u32 s36, 15, s30
    s_lshl_b32 s38, s36, 3
    s_and_b32 s37, s28, 3
    s_lshl_b32 s37, s37, 1
    s_add_u32 s38, s38, s37
    s_add_u32 s38, s38, 1
    s_lshl_b32 s38, s38, 17
    s_lshl_b32 s37, s29, 12
    s_add_u32 s38, s38, s37
    s_waitcnt vmcnt(4)
    v_readfirstlane_b32 s36, v11
    s_nop 0
    s_cmp_lt_u32 s36, 28
    s_cbranch_scc1 L_recurrent_scan__compressed_kv_cla__moe_arch_mod__prompt_kernel_rare_127
L_recurrent_scan__compressed_kv_cla__moe_arch_mod__prompt_kernel_back_128:
    s_lshr_b32 s36, s2, 4
    s_mul_i32 s36, s36, 7
    s_min_u32 s37, s28, 6
    s_add_u32 s36, s36, s37
    s_lshl_b32 s36, s36, 11
    s_add_u32 s36, s36, 58720256
    v_and_b32 v11, 15, v1
    v_lshlrev_b32 v11, 4, v11
    v_lshrrev_b32 v12, 4, v1
    v_lshl_add_u32 v11, v12, 9, v11
    buffer_load_dwordx4 v[96:99], v11, s[24:27], s36 offen offset:0 sc1
    buffer_load_dwordx4 v[100:103], v11, s[24:27], s36 offen offset:256 sc1
    s_waitcnt lgkmcnt(0)
    s_barrier
    ds_read_b128 v[114:117], v112
    ds_read_b32 v110, v111
    ds_read_b32 v109, v108
    ds_read_b128 v[64:67], v106 offset:0
    ds_read_b128 v[68:71], v106 offset:1024
    ds_read_b128 v[72:75], v106 offset:2048
    ds_read_b128 v[76:79], v106 offset:3072
    ds_read_b128 v[80:83], v106 offset:4096
    ds_read_b128 v[84:87], v106 offset:5120
    ds_read_b128 v[88:91], v106 offset:6144
    ds_read_b128 v[92:95], v106 offset:7168
    s_waitcnt lgkmcnt(8)
    v_add_f32 v109, v109, v32
    v_cmp_ne_u32 s[52:53], 0, v110
    v_readfirstlane_b32 s56, v114
    v_readfirstlane_b32 s57, v115
    v_readfirstlane_b32 s58, v116
    v_readfirstlane_b32 s59, v117
    v_rcp_f32 v109, v109
    s_nop 0
    v_mov_b32 v108, v109
    s_waitcnt lgkmcnt(6)
    v_pk_add_f32 v[224:225], v[224:225], v[64:65]
    v_pk_add_f32 v[226:227], v[226:227], v[66:67]
    v_pk_add_f32 v[228:229], v[228:229], v[68:69]
    v_pk_add_f32 v[230:231], v[230:231], v[70:71]
    v_pk_mul_f32 v[224:225], v[224:225], v[108:109]
    v_pk_mul_f32 v[226:227], v[226:227], v[108:109]
    v_pk_mul_f32 v[228:229], v[228:229], v[108:109]
    v_pk_mul_f32 v[230:231], v[230:231], v[108:109]
    v_cvt_pk_bf16_f32 v48, v224, v225
    v_cvt_pk_bf16_f32 v49, v226, v227
    v_cvt_pk_bf16_f32 v50, v228, v229
    v_cvt_pk_bf16_f32 v51, v230, v231
    buffer_store_dwordx4 v[48:51], v113, s[16:19], s38 offen offset:0 sc1
    s_waitcnt lgkmcnt(4)
    v_pk_add_f32 v[232:233], v[232:233], v[72:73]
    v_pk_add_f32 v[234:235], v[234:235], v[74:75]
    v_pk_add_f32 v[236:237], v[236:237], v[76:77]
    v_pk_add_f32 v[238:239], v[238:239], v[78:79]
    v_pk_mul_f32 v[232:233], v[232:233], v[108:109]
    v_pk_mul_f32 v[234:235], v[234:235], v[108:109]
    v_pk_mul_f32 v[236:237], v[236:237], v[108:109]
    v_pk_mul_f32 v[238:239], v[238:239], v[108:109]
    v_cvt_pk_bf16_f32 v52, v232, v233
    v_cvt_pk_bf16_f32 v53, v234, v235
    v_cvt_pk_bf16_f32 v54, v236, v237
    v_cvt_pk_bf16_f32 v55, v238, v239
    buffer_store_dwordx4 v[52:55], v113, s[16:19], s38 offen offset:1024 sc1
    s_waitcnt lgkmcnt(2)
    v_pk_add_f32 v[240:241], v[240:241], v[80:81]
    v_pk_add_f32 v[242:243], v[242:243], v[82:83]
    v_pk_add_f32 v[244:245], v[244:245], v[84:85]
    v_pk_add_f32 v[246:247], v[246:247], v[86:87]
    v_pk_mul_f32 v[240:241], v[240:241], v[108:109]
    v_pk_mul_f32 v[242:243], v[242:243], v[108:109]
    v_pk_mul_f32 v[244:245], v[244:245], v[108:109]
    v_pk_mul_f32 v[246:247], v[246:247], v[108:109]
    v_cvt_pk_bf16_f32 v56, v240, v241
    v_cvt_pk_bf16_f32 v57, v242, v243
    v_cvt_pk_bf16_f32 v58, v244, v245
    v_cvt_pk_bf16_f32 v59, v246, v247
    buffer_store_dwordx4 v[56:59], v113, s[16:19], s38 offen offset:2048 sc1
    s_waitcnt lgkmcnt(0)
    v_pk_add_f32 v[248:249], v[248:249], v[88:89]
    v_pk_add_f32 v[250:251], v[250:251], v[90:91]
    v_pk_add_f32 v[252:253], v[252:253], v[92:93]
    v_pk_add_f32 v[254:255], v[254:255], v[94:95]
    v_pk_mul_f32 v[248:249], v[248:249], v[108:109]
    v_pk_mul_f32 v[250:251], v[250:251], v[108:109]
    v_pk_mul_f32 v[252:253], v[252:253], v[108:109]
    v_pk_mul_f32 v[254:255], v[254:255], v[108:109]
    v_cvt_pk_bf16_f32 v60, v248, v249
    v_cvt_pk_bf16_f32 v61, v250, v251
    v_cvt_pk_bf16_f32 v62, v252, v253
    v_cvt_pk_bf16_f32 v63, v254, v255
    buffer_store_dwordx4 v[60:63], v113, s[16:19], s38 offen offset:3072 sc1
    s_cmp_eq_u64 s[52:53], 0
    s_cbranch_scc1 L_p3_done
    s_waitcnt vmcnt(0)
    v_mov_b32 v112, v96
    v_mov_b32 v113, v97
    v_mov_b32 v114, v98
    v_mov_b32 v115, v99
    v_mov_b32 v116, v100
    v_mov_b32 v117, v101
    v_mov_b32 v118, v102
    v_mov_b32 v119, v103
    v_swap_b32 v128, v160
    v_swap_b32 v129, v161
    v_swap_b32 v130, v162
    v_swap_b32 v131, v163
    v_swap_b32 v132, v164
    v_swap_b32 v133, v165
    v_swap_b32 v134, v166
    v_swap_b32 v135, v167
    v_swap_b32 v136, v168
    v_swap_b32 v137, v169
    v_swap_b32 v138, v170
    v_swap_b32 v139, v171
    v_swap_b32 v140, v172
    v_swap_b32 v141, v173
    v_swap_b32 v142, v174
    v_swap_b32 v143, v175
    v_swap_b32 v144, v176
    v_swap_b32 v145, v177
    v_swap_b32 v146, v178
    v_swap_b32 v147, v179
    v_swap_b32 v148, v180
    v_swap_b32 v149, v181
    v_swap_b32 v150, v182
    v_swap_b32 v151, v183
    v_swap_b32 v152, v184
    v_swap_b32 v153, v185
    v_swap_b32 v154, v186
    v_swap_b32 v155, v187
    v_swap_b32 v156, v188
    v_swap_b32 v157, v189
    v_swap_b32 v158, v190
    v_swap_b32 v159, v191
    v_mov_b32 v192, 0
    v_mov_b32 v193, 0
    v_mov_b32 v194, 0
    v_mov_b32 v195, 0
    v_mov_b32 v196, 0
    v_mov_b32 v197, 0
    v_mov_b32 v198, 0
    v_mov_b32 v199, 0
    v_mov_b32 v200, 0
    v_mov_b32 v201, 0
    v_mov_b32 v202, 0
    v_mov_b32 v203, 0
    v_mov_b32 v204, 0
    v_mov_b32 v205, 0
    v_mov_b32 v206, 0
    v_mov_b32 v207, 0
    v_mov_b32 v208, 0
    v_mov_b32 v209, 0
    v_mov_b32 v210, 0
    v_mov_b32 v211, 0
    v_mov_b32 v212, 0
    v_mov_b32 v213, 0
    v_mov_b32 v214, 0
    v_mov_b32 v215, 0
    v_mov_b32 v216, 0
    v_mov_b32 v217, 0
    v_mov_b32 v218, 0
    v_mov_b32 v219, 0
    v_mov_b32 v220, 0
    v_mov_b32 v221, 0
    v_mov_b32 v222, 0
    v_mov_b32 v223, 0
    v_mov_b32 v224, 0
    v_mov_b32 v225, 0
    v_mov_b32 v226, 0
    v_mov_b32 v227, 0
    v_mov_b32 v228, 0
    v_mov_b32 v229, 0
    v_mov_b32 v230, 0
    v_mov_b32 v231, 0
    v_mov_b32 v232, 0
    v_mov_b32 v233, 0
    v_mov_b32 v234, 0
    v_mov_b32 v235, 0
    v_mov_b32 v236, 0
    v_mov_b32 v237, 0
    v_mov_b32 v238, 0
    v_mov_b32 v239, 0
    v_mov_b32 v240, 0
    v_mov_b32 v241, 0
    v_mov_b32 v242, 0
    v_mov_b32 v243, 0
    v_mov_b32 v244, 0
    v_mov_b32 v245, 0
    v_mov_b32 v246, 0
    v_mov_b32 v247, 0
    v_mov_b32 v248, 0
    v_mov_b32 v249, 0
    v_mov_b32 v250, 0
    v_mov_b32 v251, 0
    v_mov_b32 v252, 0
    v_mov_b32 v253, 0
    v_mov_b32 v254, 0
    v_mov_b32 v255, 0
    v_mov_b32 v28, 0
    v_mov_b32 v40, 4048155338
    v_mov_b32 v32, 0
    v_mov_b32 v41, 4048155338
    s_lshl_b32 s43, s28, 12
    v_add_u32 v4, s43, v7
    s_mov_b32 s46, s45
    s_sub_u32 s40, 16, s30
    s_mov_b32 s39, s30
    s_lshl_b32 s37, s39, 7
    s_and_b32 s36, s28, 3
    s_lshl_b32 s36, s36, 5
    s_add_u32 s36, s36, s37
    s_sub_u32 s50, 0, s36
L_recurrent_scan__compressed_kv_cla__moe_arch_mod__prompt_kernel_stile_129:
    s_waitcnt vmcnt(0) lgkmcnt(0)
    s_barrier
    s_mov_b32 m0, s43
    s_add_u32 s47, s46, 32768
    buffer_load_dwordx4 v4, s[12:15], s46 offen offset:0 sc1 lds
    buffer_load_dwordx4 v4, s[12:15], s46 offen offset:1024 sc1 lds
    buffer_load_dwordx4 v4, s[12:15], s46 offen offset:2048 sc1 lds
    buffer_load_dwordx4 v4, s[12:15], s46 offen offset:3072 sc1 lds
    s_add_u32 m0, s43, 32768
    s_add_u32 s46, s46, 65536
    buffer_load_dwordx4 v4, s[12:15], s47 offen offset:0 sc1 lds
    buffer_load_dwordx4 v4, s[12:15], s47 offen offset:1024 sc1 lds
    buffer_load_dwordx4 v4, s[12:15], s47 offen offset:2048 sc1 lds
    buffer_load_dwordx4 v4, s[12:15], s47 offen offset:3072 sc1 lds
    v_mov_b32 v2, v7
    s_mov_b32 s41, 4
    s_waitcnt vmcnt(0)
    s_barrier
L_recurrent_scan__compressed_kv_cla__moe_arch_mod__prompt_kernel_sunit_130:
    s_cmp_gt_i32 s50, 0
    s_cbranch_scc1 L_recurrent_scan__compressed_kv_cla__moe_arch_mod__prompt_kernel_snext_131
    ds_read_b128 v[64:67], v2 offset:0
    ds_read_b128 v[68:71], v2 offset:1024
    ds_read_b128 v[72:75], v2 offset:2048
    ds_read_b128 v[76:79], v2 offset:3072
    ds_read_b128 v[80:83], v2 offset:4096
    ds_read_b128 v[84:87], v2 offset:5120
    ds_read_b128 v[88:91], v2 offset:6144
    ds_read_b128 v[92:95], v2 offset:7168
    s_waitcnt lgkmcnt(0)
    v_mfma_f32_16x16x32_bf16 v[96:99], v[64:67], v[128:131], 0
    v_mfma_f32_16x16x32_bf16 v[104:107], v[64:67], v[144:147], 0
    v_mfma_f32_16x16x32_bf16 v[96:99], v[68:71], v[132:135], v[96:99]
    v_mfma_f32_16x16x32_bf16 v[104:107], v[68:71], v[148:151], v[104:107]
    v_mfma_f32_16x16x32_bf16 v[96:99], v[72:75], v[136:139], v[96:99]
    v_mfma_f32_16x16x32_bf16 v[104:107], v[72:75], v[152:155], v[104:107]
    v_mfma_f32_16x16x32_bf16 v[96:99], v[76:79], v[140:143], v[96:99]
    v_mfma_f32_16x16x32_bf16 v[104:107], v[76:79], v[156:159], v[104:107]
    v_mfma_f32_16x16x32_bf16 v[100:103], v[80:83], v[128:131], 0
    v_mfma_f32_16x16x32_bf16 v[108:111], v[80:83], v[144:147], 0
    v_mfma_f32_16x16x32_bf16 v[100:103], v[84:87], v[132:135], v[100:103]
    v_mfma_f32_16x16x32_bf16 v[108:111], v[84:87], v[148:151], v[108:111]
    v_mfma_f32_16x16x32_bf16 v[100:103], v[88:91], v[136:139], v[100:103]
    v_mfma_f32_16x16x32_bf16 v[108:111], v[88:91], v[152:155], v[108:111]
    v_mfma_f32_16x16x32_bf16 v[100:103], v[92:95], v[140:143], v[100:103]
    v_mfma_f32_16x16x32_bf16 v[108:111], v[92:95], v[156:159], v[108:111]
    ds_read_b128 v[64:67], v2 offset:32768
    ds_read_b128 v[68:71], v2 offset:33792
    ds_read_b128 v[72:75], v2 offset:34816
    ds_read_b128 v[76:79], v2 offset:35840
    ds_read_b128 v[80:83], v2 offset:36864
    ds_read_b128 v[84:87], v2 offset:37888
    ds_read_b128 v[88:91], v2 offset:38912
    ds_read_b128 v[92:95], v2 offset:39936
    s_nop 1
    s_cmp_lt_i32 s50, 0
    s_cbranch_scc0 L_recurrent_scan__compressed_kv_cla__moe_arch_mod__prompt_kernel_rare_132
L_recurrent_scan__compressed_kv_cla__moe_arch_mod__prompt_kernel_back_133:
    v_max3_f32 v22, v96, v97, v98
    v_max3_f32 v22, v22, v99, v100
    v_max3_f32 v22, v22, v101, v102
    v_max3_f32 v22, v22, v103, v40
    v_mov_b32 v24, v22
    s_nop 1
    v_permlane16_swap_b32 v22, v24
    s_nop 1
    v_max_f32 v22, v22, v24
    v_mov_b32 v24, v22
    s_nop 1
    v_permlane32_swap_b32 v22, v24
    s_nop 1
    v_max_f32 v22, v22, v24
    v_sub_f32 v25, v40, v22
    v_exp_f32 v25, v25
    v_mov_b32 v40, v22
    v_mul_f32 v28, v28, v25
    v_mul_f32 v192, v192, v25
    v_mul_f32 v193, v193, v25
    v_mul_f32 v194, v194, v25
    v_mul_f32 v195, v195, v25
    v_mul_f32 v196, v196, v25
    v_mul_f32 v197, v197, v25
    v_mul_f32 v198, v198, v25
    v_mul_f32 v199, v199, v25
    v_mul_f32 v200, v200, v25
    v_mul_f32 v201, v201, v25
    v_mul_f32 v202, v202, v25
    v_mul_f32 v203, v203, v25
    v_mul_f32 v204, v204, v25
    v_mul_f32 v205, v205, v25
    v_mul_f32 v206, v206, v25
    v_mul_f32 v207, v207, v25
    v_mul_f32 v208, v208, v25
    v_mul_f32 v209, v209, v25
    v_mul_f32 v210, v210, v25
    v_mul_f32 v211, v211, v25
    v_mul_f32 v212, v212, v25
    v_mul_f32 v213, v213, v25
    v_mul_f32 v214, v214, v25
    v_mul_f32 v215, v215, v25
    v_mul_f32 v216, v216, v25
    v_mul_f32 v217, v217, v25
    v_mul_f32 v218, v218, v25
    v_mul_f32 v219, v219, v25
    v_mul_f32 v220, v220, v25
    v_mul_f32 v221, v221, v25
    v_mul_f32 v222, v222, v25
    v_mul_f32 v223, v223, v25
    v_sub_f32 v96, v96, v22
    v_sub_f32 v97, v97, v22
    v_sub_f32 v98, v98, v22
    v_sub_f32 v99, v99, v22
    v_sub_f32 v100, v100, v22
    v_sub_f32 v101, v101, v22
    v_sub_f32 v102, v102, v22
    v_sub_f32 v103, v103, v22
    v_max3_f32 v23, v104, v105, v106
    v_max3_f32 v23, v23, v107, v108
    v_max3_f32 v23, v23, v109, v110
    v_max3_f32 v23, v23, v111, v41
    v_mov_b32 v24, v23
    s_nop 1
    v_permlane16_swap_b32 v23, v24
    s_nop 1
    v_max_f32 v23, v23, v24
    v_mov_b32 v24, v23
    s_nop 1
    v_permlane32_swap_b32 v23, v24
    s_nop 1
    v_max_f32 v23, v23, v24
    v_sub_f32 v25, v41, v23
    v_exp_f32 v25, v25
    v_mov_b32 v41, v23
    v_mul_f32 v32, v32, v25
    v_mul_f32 v224, v224, v25
    v_mul_f32 v225, v225, v25
    v_mul_f32 v226, v226, v25
    v_mul_f32 v227, v227, v25
    v_mul_f32 v228, v228, v25
    v_mul_f32 v229, v229, v25
    v_mul_f32 v230, v230, v25
    v_mul_f32 v231, v231, v25
    v_mul_f32 v232, v232, v25
    v_mul_f32 v233, v233, v25
    v_mul_f32 v234, v234, v25
    v_mul_f32 v235, v235, v25
    v_mul_f32 v236, v236, v25
    v_mul_f32 v237, v237, v25
    v_mul_f32 v238, v238, v25
    v_mul_f32 v239, v239, v25
    v_mul_f32 v240, v240, v25
    v_mul_f32 v241, v241, v25
    v_mul_f32 v242, v242, v25
    v_mul_f32 v243, v243, v25
    v_mul_f32 v244, v244, v25
    v_mul_f32 v245, v245, v25
    v_mul_f32 v246, v246, v25
    v_mul_f32 v247, v247, v25
    v_mul_f32 v248, v248, v25
    v_mul_f32 v249, v249, v25
    v_mul_f32 v250, v250, v25
    v_mul_f32 v251, v251, v25
    v_mul_f32 v252, v252, v25
    v_mul_f32 v253, v253, v25
    v_mul_f32 v254, v254, v25
    v_mul_f32 v255, v255, v25
    v_sub_f32 v104, v104, v23
    v_sub_f32 v105, v105, v23
    v_sub_f32 v106, v106, v23
    v_sub_f32 v107, v107, v23
    v_sub_f32 v108, v108, v23
    v_sub_f32 v109, v109, v23
    v_sub_f32 v110, v110, v23
    v_sub_f32 v111, v111, v23
    v_exp_f32 v96, v96
    v_exp_f32 v97, v97
    v_exp_f32 v98, v98
    v_exp_f32 v99, v99
    v_exp_f32 v104, v104
    v_exp_f32 v105, v105
    v_exp_f32 v106, v106
    v_exp_f32 v107, v107
    v_exp_f32 v100, v100
    v_exp_f32 v101, v101
    v_exp_f32 v102, v102
    v_exp_f32 v103, v103
    v_exp_f32 v108, v108
    v_exp_f32 v109, v109
    v_exp_f32 v110, v110
    v_exp_f32 v111, v111
    v_add_f32 v28, v28, v96
    v_add_f32 v28, v28, v97
    v_cvt_pk_bf16_f32 v48, v96, v97
    v_add_f32 v28, v28, v98
    v_add_f32 v28, v28, v99
    v_cvt_pk_bf16_f32 v49, v98, v99
    v_add_f32 v32, v32, v104
    v_add_f32 v32, v32, v105
    v_cvt_pk_bf16_f32 v52, v104, v105
    v_add_f32 v32, v32, v106
    v_add_f32 v32, v32, v107
    v_cvt_pk_bf16_f32 v53, v106, v107
    v_add_f32 v28, v28, v100
    v_add_f32 v28, v28, v101
    v_cvt_pk_bf16_f32 v50, v100, v101
    v_add_f32 v28, v28, v102
    v_add_f32 v28, v28, v103
    v_cvt_pk_bf16_f32 v51, v102, v103
    v_add_f32 v32, v32, v108
    v_add_f32 v32, v32, v109
    v_cvt_pk_bf16_f32 v54, v108, v109
    v_add_f32 v32, v32, v110
    v_add_f32 v32, v32, v111
    v_cvt_pk_bf16_f32 v55, v110, v111
    s_waitcnt lgkmcnt(0)
    s_nop 0
    v_mfma_f32_16x16x32_bf16 v[192:195], v[64:67], v[48:51], v[192:195]
    v_mfma_f32_16x16x32_bf16 v[224:227], v[64:67], v[52:55], v[224:227]
    v_mfma_f32_16x16x32_bf16 v[196:199], v[68:71], v[48:51], v[196:199]
    v_mfma_f32_16x16x32_bf16 v[228:231], v[68:71], v[52:55], v[228:231]
    v_mfma_f32_16x16x32_bf16 v[200:203], v[72:75], v[48:51], v[200:203]
    v_mfma_f32_16x16x32_bf16 v[232:235], v[72:75], v[52:55], v[232:235]
    v_mfma_f32_16x16x32_bf16 v[204:207], v[76:79], v[48:51], v[204:207]
    v_mfma_f32_16x16x32_bf16 v[236:239], v[76:79], v[52:55], v[236:239]
    v_mfma_f32_16x16x32_bf16 v[208:211], v[80:83], v[48:51], v[208:211]
    v_mfma_f32_16x16x32_bf16 v[240:243], v[80:83], v[52:55], v[240:243]
    v_mfma_f32_16x16x32_bf16 v[212:215], v[84:87], v[48:51], v[212:215]
    v_mfma_f32_16x16x32_bf16 v[244:247], v[84:87], v[52:55], v[244:247]
    v_mfma_f32_16x16x32_bf16 v[216:219], v[88:91], v[48:51], v[216:219]
    v_mfma_f32_16x16x32_bf16 v[248:251], v[88:91], v[52:55], v[248:251]
    v_mfma_f32_16x16x32_bf16 v[220:223], v[92:95], v[48:51], v[220:223]
    v_mfma_f32_16x16x32_bf16 v[252:255], v[92:95], v[52:55], v[252:255]
L_recurrent_scan__compressed_kv_cla__moe_arch_mod__prompt_kernel_snext_131:
    v_add_u32 v2, 8192, v2
    s_add_u32 s50, s50, 32
    s_sub_u32 s41, s41, 1
    s_cmp_lg_u32 s41, 0
    s_cbranch_scc1 L_recurrent_scan__compressed_kv_cla__moe_arch_mod__prompt_kernel_sunit_130
    s_sub_u32 s40, s40, 1
    s_cmp_lg_u32 s40, 0
    s_cbranch_scc1 L_recurrent_scan__compressed_kv_cla__moe_arch_mod__prompt_kernel_stile_129
    v_mov_b32 v20, v28
    s_nop 1
    v_permlane16_swap_b32 v28, v20
    s_nop 1
    v_add_f32 v28, v28, v20
    v_mov_b32 v20, v28
    s_nop 1
    v_permlane32_swap_b32 v28, v20
    s_nop 1
    v_add_f32 v28, v28, v20
    v_mov_b32 v20, v32
    s_nop 1
    v_permlane16_swap_b32 v32, v20
    s_nop 1
    v_add_f32 v32, v32, v20
    v_mov_b32 v20, v32
    s_nop 1
    v_permlane32_swap_b32 v32, v20
    s_nop 1
    v_add_f32 v32, v32, v20
    s_mov_b32 s36, 0x5d800000
    v_cmp_nge_f32 vcc, s36, v28
    s_nop 0
    s_or_b64 s[52:53], s[52:53], vcc
    v_cmp_nge_f32 vcc, s36, v32
    s_nop 0
    s_or_b64 s[52:53], s[52:53], vcc
    v_rcp_f32 v20, v28
    v_rcp_f32 v22, v32
    s_lshl_b32 s38, s39, 3
    s_and_b32 s37, s28, 3
    s_lshl_b32 s37, s37, 1
    s_add_u32 s38, s38, s37
    s_lshl_b32 s38, s38, 17
    s_lshl_b32 s37, s29, 12
    s_add_u32 s38, s38, s37
    v_mov_b32 v21, v20
    v_mov_b32 v23, v22
    v_mov_b32 v24, v7
    v_pk_mul_f32 v[192:193], v[192:193], v[20:21]
    v_pk_mul_f32 v[194:195], v[194:195], v[20:21]
    v_pk_mul_f32 v[196:197], v[196:197], v[20:21]
    v_pk_mul_f32 v[198:199], v[198:199], v[20:21]
    v_cvt_pk_bf16_f32 v192, v192, v193
    v_cvt_pk_bf16_f32 v193, v194, v195
    v_cvt_pk_bf16_f32 v194, v196, v197
    v_cvt_pk_bf16_f32 v195, v198, v199
    buffer_store_dwordx4 v[192:195], v24, s[16:19], s38 offen offset:0 sc1
    v_pk_mul_f32 v[200:201], v[200:201], v[20:21]
    v_pk_mul_f32 v[202:203], v[202:203], v[20:21]
    v_pk_mul_f32 v[204:205], v[204:205], v[20:21]
    v_pk_mul_f32 v[206:207], v[206:207], v[20:21]
    v_cvt_pk_bf16_f32 v200, v200, v201
    v_cvt_pk_bf16_f32 v201, v202, v203
    v_cvt_pk_bf16_f32 v202, v204, v205
    v_cvt_pk_bf16_f32 v203, v206, v207
    buffer_store_dwordx4 v[200:203], v24, s[16:19], s38 offen offset:1024 sc1
    v_pk_mul_f32 v[208:209], v[208:209], v[20:21]
    v_pk_mul_f32 v[210:211], v[210:211], v[20:21]
    v_pk_mul_f32 v[212:213], v[212:213], v[20:21]
    v_pk_mul_f32 v[214:215], v[214:215], v[20:21]
    v_cvt_pk_bf16_f32 v208, v208, v209
    v_cvt_pk_bf16_f32 v209, v210, v211
    v_cvt_pk_bf16_f32 v210, v212, v213
    v_cvt_pk_bf16_f32 v211, v214, v215
    buffer_store_dwordx4 v[208:211], v24, s[16:19], s38 offen offset:2048 sc1
    v_pk_mul_f32 v[216:217], v[216:217], v[20:21]
    v_pk_mul_f32 v[218:219], v[218:219], v[20:21]
    v_pk_mul_f32 v[220:221], v[220:221], v[20:21]
    v_pk_mul_f32 v[222:223], v[222:223], v[20:21]
    v_cvt_pk_bf16_f32 v216, v216, v217
    v_cvt_pk_bf16_f32 v217, v218, v219
    v_cvt_pk_bf16_f32 v218, v220, v221
    v_cvt_pk_bf16_f32 v219, v222, v223
    buffer_store_dwordx4 v[216:219], v24, s[16:19], s38 offen offset:3072 sc1
    s_add_u32 s38, s38, 131072
    v_pk_mul_f32 v[224:225], v[224:225], v[22:23]
    v_pk_mul_f32 v[226:227], v[226:227], v[22:23]
    v_pk_mul_f32 v[228:229], v[228:229], v[22:23]
    v_pk_mul_f32 v[230:231], v[230:231], v[22:23]
    v_cvt_pk_bf16_f32 v224, v224, v225
    v_cvt_pk_bf16_f32 v225, v226, v227
    v_cvt_pk_bf16_f32 v226, v228, v229
    v_cvt_pk_bf16_f32 v227, v230, v231
    buffer_store_dwordx4 v[224:227], v24, s[16:19], s38 offen offset:0 sc1
    v_pk_mul_f32 v[232:233], v[232:233], v[22:23]
    v_pk_mul_f32 v[234:235], v[234:235], v[22:23]
    v_pk_mul_f32 v[236:237], v[236:237], v[22:23]
    v_pk_mul_f32 v[238:239], v[238:239], v[22:23]
    v_cvt_pk_bf16_f32 v232, v232, v233
    v_cvt_pk_bf16_f32 v233, v234, v235
    v_cvt_pk_bf16_f32 v234, v236, v237
    v_cvt_pk_bf16_f32 v235, v238, v239
    buffer_store_dwordx4 v[232:235], v24, s[16:19], s38 offen offset:1024 sc1
    v_pk_mul_f32 v[240:241], v[240:241], v[22:23]
    v_pk_mul_f32 v[242:243], v[242:243], v[22:23]
    v_pk_mul_f32 v[244:245], v[244:245], v[22:23]
    v_pk_mul_f32 v[246:247], v[246:247], v[22:23]
    v_cvt_pk_bf16_f32 v240, v240, v241
    v_cvt_pk_bf16_f32 v241, v242, v243
    v_cvt_pk_bf16_f32 v242, v244, v245
    v_cvt_pk_bf16_f32 v243, v246, v247
    buffer_store_dwordx4 v[240:243], v24, s[16:19], s38 offen offset:2048 sc1
    v_pk_mul_f32 v[248:249], v[248:249], v[22:23]
    v_pk_mul_f32 v[250:251], v[250:251], v[22:23]
    v_pk_mul_f32 v[252:253], v[252:253], v[22:23]
    v_pk_mul_f32 v[254:255], v[254:255], v[22:23]
    v_cvt_pk_bf16_f32 v248, v248, v249
    v_cvt_pk_bf16_f32 v249, v250, v251
    v_cvt_pk_bf16_f32 v250, v252, v253
    v_cvt_pk_bf16_f32 v251, v254, v255
    buffer_store_dwordx4 v[248:251], v24, s[16:19], s38 offen offset:3072 sc1
    v_mov_b32 v96, v112
    v_mov_b32 v97, v113
    v_mov_b32 v98, v114
    v_mov_b32 v99, v115
    v_mov_b32 v100, v116
    v_mov_b32 v101, v117
    v_mov_b32 v102, v118
    v_mov_b32 v103, v119
    s_branch L_p3_done
L_recurrent_scan__compressed_kv_cla__moe_arch_mod__prompt_kernel_rare_100:
    s_lshl_b32 s36, s29, 7
    s_cmp_eq_u32 s30, 0
    s_cselect_b32 s37, 4, 0
    s_add_u32 s36, s36, s37
    v_mov_b32 v20, s36
    v_mov_b32 v21, 1
    s_mov_b64 exec, 1
    global_atomic_add v20, v21, s[90:91]
    s_mov_b64 exec, -1
    s_nop 3
    s_branch L_recurrent_scan__compressed_kv_cla__moe_arch_mod__prompt_kernel_back_101
L_recurrent_scan__compressed_kv_cla__moe_arch_mod__prompt_kernel_rare_103:
    s_cmp_lt_i32 s36, 0
    s_cbranch_scc1 L_recurrent_scan__compressed_kv_cla__moe_arch_mod__prompt_kernel_nm_102
    v_mov_b32 v20, 4048155338
    v_subrev_u32 v21, s36, v18
    v_cmp_gt_i32 s[20:21], 0, v21
    v_cmp_gt_i32 s[22:23], 1, v21
    v_cmp_gt_i32 s[62:63], 2, v21
    v_cmp_gt_i32 vcc, 3, v21
    v_cndmask_b32 v96, v96, v20, s[20:21]
    v_cndmask_b32 v97, v97, v20, s[22:23]
    v_cndmask_b32 v98, v98, v20, s[62:63]
    v_cndmask_b32 v99, v99, v20, vcc
    v_cmp_gt_i32 s[20:21], 16, v21
    v_cmp_gt_i32 s[22:23], 17, v21
    v_cmp_gt_i32 s[62:63], 18, v21
    v_cmp_gt_i32 vcc, 19, v21
    v_cndmask_b32 v100, v100, v20, s[20:21]
    v_cndmask_b32 v101, v101, v20, s[22:23]
    v_cndmask_b32 v102, v102, v20, s[62:63]
    v_cndmask_b32 v103, v103, v20, vcc
    v_cmp_gt_i32 s[20:21], -16, v21
    v_cmp_gt_i32 s[22:23], -15, v21
    v_cmp_gt_i32 s[62:63], -14, v21
    v_cmp_gt_i32 vcc, -13, v21
    v_cndmask_b32 v104, v104, v20, s[20:21]
    v_cndmask_b32 v105, v105, v20, s[22:23]
    v_cndmask_b32 v106, v106, v20, s[62:63]
    v_cndmask_b32 v107, v107, v20, vcc
    v_cmp_gt_i32 s[20:21], 0, v21
    v_cmp_gt_i32 s[22:23], 1, v21
    v_cmp_gt_i32 s[62:63], 2, v21
    v_cmp_gt_i32 vcc, 3, v21
    v_cndmask_b32 v108, v108, v20, s[20:21]
    v_cndmask_b32 v109, v109, v20, s[22:23]
    v_cndmask_b32 v110, v110, v20, s[62:63]
    v_cndmask_b32 v111, v111, v20, vcc
L_recurrent_scan__compressed_kv_cla__moe_arch_mod__prompt_kernel_nm_102:
    s_branch L_recurrent_scan__compressed_kv_cla__moe_arch_mod__prompt_kernel_back_104
L_recurrent_scan__compressed_kv_cla__moe_arch_mod__prompt_kernel_rare_110:
    s_add_u32 s36, s40, 1
    s_sub_u32 s36, s36, s51
    s_cmp_lt_u32 s36, 2
    s_cbranch_scc0 L_recurrent_scan__compressed_kv_cla__moe_arch_mod__prompt_kernel_r_106
    s_lshl_b32 s36, s36, 6
    s_add_u32 s36, s36, 32
    s_sub_u32 s36, s36, s50
    s_cmp_lt_i32 s36, 0
    s_cbranch_scc1 L_recurrent_scan__compressed_kv_cla__moe_arch_mod__prompt_kernel_nm_109
    v_mov_b32 v20, 4048155338
    v_subrev_u32 v21, s36, v18
    v_cmp_gt_i32 s[20:21], 0, v21
    v_cmp_gt_i32 s[22:23], 1, v21
    v_cmp_gt_i32 s[62:63], 2, v21
    v_cmp_gt_i32 vcc, 3, v21
    v_cndmask_b32 v112, v112, v20, s[20:21]
    v_cndmask_b32 v113, v113, v20, s[22:23]
    v_cndmask_b32 v114, v114, v20, s[62:63]
    v_cndmask_b32 v115, v115, v20, vcc
    v_cmp_gt_i32 s[20:21], 16, v21
    v_cmp_gt_i32 s[22:23], 17, v21
    v_cmp_gt_i32 s[62:63], 18, v21
    v_cmp_gt_i32 vcc, 19, v21
    v_cndmask_b32 v116, v116, v20, s[20:21]
    v_cndmask_b32 v117, v117, v20, s[22:23]
    v_cndmask_b32 v118, v118, v20, s[62:63]
    v_cndmask_b32 v119, v119, v20, vcc
    v_cmp_gt_i32 s[20:21], -16, v21
    v_cmp_gt_i32 s[22:23], -15, v21
    v_cmp_gt_i32 s[62:63], -14, v21
    v_cmp_gt_i32 vcc, -13, v21
    v_cndmask_b32 v120, v120, v20, s[20:21]
    v_cndmask_b32 v121, v121, v20, s[22:23]
    v_cndmask_b32 v122, v122, v20, s[62:63]
    v_cndmask_b32 v123, v123, v20, vcc
    v_cmp_gt_i32 s[20:21], 0, v21
    v_cmp_gt_i32 s[22:23], 1, v21
    v_cmp_gt_i32 s[62:63], 2, v21
    v_cmp_gt_i32 vcc, 3, v21
    v_cndmask_b32 v124, v124, v20, s[20:21]
    v_cndmask_b32 v125, v125, v20, s[22:23]
    v_cndmask_b32 v126, v126, v20, s[62:63]
    v_cndmask_b32 v127, v127, v20, vcc
L_recurrent_scan__compressed_kv_cla__moe_arch_mod__prompt_kernel_nm_109:
L_recurrent_scan__compressed_kv_cla__moe_arch_mod__prompt_kernel_r_106:
    s_branch L_recurrent_scan__compressed_kv_cla__moe_arch_mod__prompt_kernel_back_111
L_recurrent_scan__compressed_kv_cla__moe_arch_mod__prompt_kernel_rare_113:
    s_add_u32 s36, s40, 2
    s_sub_u32 s36, s36, s51
    s_cmp_eq_u32 s36, 1
    s_cselect_b32 s41, 0x8000, s41
    s_cmp_eq_u32 s40, 15
    s_cbranch_scc0 L_recurrent_scan__compressed_kv_cla__moe_arch_mod__prompt_kernel_r_107
    s_mov_b32 s41, 65536
    s_mov_b32 s49, 0x1ffff
    s_mov_b32 s36, 1
L_recurrent_scan__compressed_kv_cla__moe_arch_mod__prompt_kernel_r_107:
    s_cmp_lt_u32 s36, 2
    s_cbranch_scc0 L_recurrent_scan__compressed_kv_cla__moe_arch_mod__prompt_kernel_r_108
    s_lshl_b32 s36, s36, 6
    s_sub_u32 s36, s36, s50
    s_cmp_lt_i32 s36, 0
    s_cbranch_scc1 L_recurrent_scan__compressed_kv_cla__moe_arch_mod__prompt_kernel_nm_112
    v_mov_b32 v20, 4048155338
    v_subrev_u32 v21, s36, v18
    v_cmp_gt_i32 s[20:21], 0, v21
    v_cmp_gt_i32 s[22:23], 1, v21
    v_cmp_gt_i32 s[62:63], 2, v21
    v_cmp_gt_i32 vcc, 3, v21
    v_cndmask_b32 v96, v96, v20, s[20:21]
    v_cndmask_b32 v97, v97, v20, s[22:23]
    v_cndmask_b32 v98, v98, v20, s[62:63]
    v_cndmask_b32 v99, v99, v20, vcc
    v_cmp_gt_i32 s[20:21], 16, v21
    v_cmp_gt_i32 s[22:23], 17, v21
    v_cmp_gt_i32 s[62:63], 18, v21
    v_cmp_gt_i32 vcc, 19, v21
    v_cndmask_b32 v100, v100, v20, s[20:21]
    v_cndmask_b32 v101, v101, v20, s[22:23]
    v_cndmask_b32 v102, v102, v20, s[62:63]
    v_cndmask_b32 v103, v103, v20, vcc
    v_cmp_gt_i32 s[20:21], -16, v21
    v_cmp_gt_i32 s[22:23], -15, v21
    v_cmp_gt_i32 s[62:63], -14, v21
    v_cmp_gt_i32 vcc, -13, v21
    v_cndmask_b32 v104, v104, v20, s[20:21]
    v_cndmask_b32 v105, v105, v20, s[22:23]
    v_cndmask_b32 v106, v106, v20, s[62:63]
    v_cndmask_b32 v107, v107, v20, vcc
    v_cmp_gt_i32 s[20:21], 0, v21
    v_cmp_gt_i32 s[22:23], 1, v21
    v_cmp_gt_i32 s[62:63], 2, v21
    v_cmp_gt_i32 vcc, 3, v21
    v_cndmask_b32 v108, v108, v20, s[20:21]
    v_cndmask_b32 v109, v109, v20, s[22:23]
    v_cndmask_b32 v110, v110, v20, s[62:63]
    v_cndmask_b32 v111, v111, v20, vcc
L_recurrent_scan__compressed_kv_cla__moe_arch_mod__prompt_kernel_nm_112:
L_recurrent_scan__compressed_kv_cla__moe_arch_mod__prompt_kernel_r_108:
    s_branch L_recurrent_scan__compressed_kv_cla__moe_arch_mod__prompt_kernel_back_114
L_recurrent_scan__compressed_kv_cla__moe_arch_mod__prompt_kernel_rare_116:
    v_mov_b32 v20, 4048155338
    v_subrev_u32 v21, s36, v18
    v_cmp_gt_i32 s[20:21], 0, v21
    v_cmp_gt_i32 s[22:23], 1, v21
    v_cmp_gt_i32 s[62:63], 2, v21
    v_cmp_gt_i32 vcc, 3, v21
    v_cndmask_b32 v112, v112, v20, s[20:21]
    v_cndmask_b32 v113, v113, v20, s[22:23]
    v_cndmask_b32 v114, v114, v20, s[62:63]
    v_cndmask_b32 v115, v115, v20, vcc
    v_cmp_gt_i32 s[20:21], 16, v21
    v_cmp_gt_i32 s[22:23], 17, v21
    v_cmp_gt_i32 s[62:63], 18, v21
    v_cmp_gt_i32 vcc, 19, v21
    v_cndmask_b32 v116, v116, v20, s[20:21]
    v_cndmask_b32 v117, v117, v20, s[22:23]
    v_cndmask_b32 v118, v118, v20, s[62:63]
    v_cndmask_b32 v119, v119, v20, vcc
    v_cmp_gt_i32 s[20:21], -16, v21
    v_cmp_gt_i32 s[22:23], -15, v21
    v_cmp_gt_i32 s[62:63], -14, v21
    v_cmp_gt_i32 vcc, -13, v21
    v_cndmask_b32 v120, v120, v20, s[20:21]
    v_cndmask_b32 v121, v121, v20, s[22:23]
    v_cndmask_b32 v122, v122, v20, s[62:63]
    v_cndmask_b32 v123, v123, v20, vcc
    v_cmp_gt_i32 s[20:21], 0, v21
    v_cmp_gt_i32 s[22:23], 1, v21
    v_cmp_gt_i32 s[62:63], 2, v21
    v_cmp_gt_i32 vcc, 3, v21
    v_cndmask_b32 v124, v124, v20, s[20:21]
    v_cndmask_b32 v125, v125, v20, s[22:23]
    v_cndmask_b32 v126, v126, v20, s[62:63]
    v_cndmask_b32 v127, v127, v20, vcc
    s_branch L_recurrent_scan__compressed_kv_cla__moe_arch_mod__prompt_kernel_back_117
L_recurrent_scan__compressed_kv_cla__moe_arch_mod__prompt_kernel_rare_123:
    s_cmp_eq_u32 s40, 0
    s_cbranch_scc0 L_recurrent_scan__compressed_kv_cla__moe_arch_mod__prompt_kernel_nm_118
    ds_read_b64 v[14:15], v19
    s_waitcnt lgkmcnt(0)
L_recurrent_scan__compressed_kv_cla__moe_arch_mod__prompt_kernel_nm_118:
    s_cmp_eq_u32 s40, 12
    s_cbranch_scc0 L_recurrent_scan__compressed_kv_cla__moe_arch_mod__prompt_kernel_bh_121
    s_getpc_b64 s[36:37]
L_recurrent_scan__compressed_kv_cla__moe_arch_mod__prompt_kernel_pc_122:
    s_sub_u32 s36, s36, L_recurrent_scan__compressed_kv_cla__moe_arch_mod__prompt_kernel_pc_122-L_pc
    s_subb_u32 s37, s37, 0
    s_lshr_b32 s38, s2, 3
    s_lshl_b32 s38, s38, 7
    v_lshl_add_u32 v26, v1, 12, s38
    v_min_u32 v26, L_end-L_pc-4, v26
    v_mov_b32 v27, s37
    v_add_co_u32 v26, vcc, s36, v26
    s_mov_b64 exec, 0xffff
    s_nop 0
    v_addc_co_u32 v27, vcc, 0, v27, vcc
    global_load_dword v0, v[26:27], off
    s_mov_b64 exec, -1
    s_nop 1
L_recurrent_scan__compressed_kv_cla__moe_arch_mod__prompt_kernel_bh_121:
    s_add_u32 s36, s40, 1
    s_cmp_eq_u32 s36, s51
    s_cbranch_scc0 L_recurrent_scan__compressed_kv_cla__moe_arch_mod__prompt_kernel_ns_119
    v_swap_b32 v128, v160
    v_swap_b32 v129, v161
    v_swap_b32 v130, v162
    v_swap_b32 v131, v163
    v_swap_b32 v132, v164
    v_swap_b32 v133, v165
    v_swap_b32 v134, v166
    v_swap_b32 v135, v167
    v_swap_b32 v136, v168
    v_swap_b32 v137, v169
    v_swap_b32 v138, v170
    v_swap_b32 v139, v171
    v_swap_b32 v140, v172
    v_swap_b32 v141, v173
    v_swap_b32 v142, v174
    v_swap_b32 v143, v175
    v_swap_b32 v144, v176
    v_swap_b32 v145, v177
    v_swap_b32 v146, v178
    v_swap_b32 v147, v179
    v_swap_b32 v148, v180
    v_swap_b32 v149, v181
    v_swap_b32 v150, v182
    v_swap_b32 v151, v183
    v_swap_b32 v152, v184
    v_swap_b32 v153, v185
    v_swap_b32 v154, v186
    v_swap_b32 v155, v187
    v_swap_b32 v156, v188
    v_swap_b32 v157, v189
    v_swap_b32 v158, v190
    v_swap_b32 v159, v191
    v_mov_b32 v40, v14
    v_mov_b32 v41, v14
    v_mov_b32 v42, v14
    v_mov_b32 v43, v14
    v_mov_b32 v44, v15
    v_mov_b32 v45, v15
    v_mov_b32 v46, v15
    v_mov_b32 v47, v15
    s_nop 1
L_recurrent_scan__compressed_kv_cla__moe_arch_mod__prompt_kernel_ns_119:
    s_cmp_eq_u32 s40, s51
    s_cbranch_scc0 L_recurrent_scan__compressed_kv_cla__moe_arch_mod__prompt_kernel_ne_120
    s_nop 4
    s_mov_b32 s36, 0x5d800000
    v_cmp_nge_f32 vcc, s36, v28
    s_nop 0
    s_or_b64 s[52:53], s[52:53], vcc
    v_cmp_nge_f32 vcc, s36, v32
    s_nop 0
    s_or_b64 s[52:53], s[52:53], vcc
    v_rcp_f32 v20, v28
    v_rcp_f32 v22, v32
    s_lshl_b32 s38, s30, 3
    s_and_b32 s37, s28, 3
    s_lshl_b32 s37, s37, 1
    s_add_u32 s38, s38, s37
    s_lshl_b32 s38, s38, 17
    s_lshl_b32 s37, s29, 12
    s_add_u32 s38, s38, s37
    v_mov_b32 v21, v20
    v_mov_b32 v23, v22
    v_mov_b32 v24, v7
    v_pk_mul_f32 v[192:193], v[192:193], v[20:21]
    v_pk_mul_f32 v[194:195], v[194:195], v[20:21]
    v_pk_mul_f32 v[196:197], v[196:197], v[20:21]
    v_pk_mul_f32 v[198:199], v[198:199], v[20:21]
    v_cvt_pk_bf16_f32 v192, v192, v193
    v_cvt_pk_bf16_f32 v193, v194, v195
    v_cvt_pk_bf16_f32 v194, v196, v197
    v_cvt_pk_bf16_f32 v195, v198, v199
    buffer_store_dwordx4 v[192:195], v24, s[16:19], s38 offen offset:0 sc1
    v_pk_mul_f32 v[200:201], v[200:201], v[20:21]
    v_pk_mul_f32 v[202:203], v[202:203], v[20:21]
    v_pk_mul_f32 v[204:205], v[204:205], v[20:21]
    v_pk_mul_f32 v[206:207], v[206:207], v[20:21]
    v_cvt_pk_bf16_f32 v200, v200, v201
    v_cvt_pk_bf16_f32 v201, v202, v203
    v_cvt_pk_bf16_f32 v202, v204, v205
    v_cvt_pk_bf16_f32 v203, v206, v207
    buffer_store_dwordx4 v[200:203], v24, s[16:19], s38 offen offset:1024 sc1
    v_pk_mul_f32 v[208:209], v[208:209], v[20:21]
    v_pk_mul_f32 v[210:211], v[210:211], v[20:21]
    v_pk_mul_f32 v[212:213], v[212:213], v[20:21]
    v_pk_mul_f32 v[214:215], v[214:215], v[20:21]
    v_cvt_pk_bf16_f32 v208, v208, v209
    v_cvt_pk_bf16_f32 v209, v210, v211
    v_cvt_pk_bf16_f32 v210, v212, v213
    v_cvt_pk_bf16_f32 v211, v214, v215
    buffer_store_dwordx4 v[208:211], v24, s[16:19], s38 offen offset:2048 sc1
    v_pk_mul_f32 v[216:217], v[216:217], v[20:21]
    v_pk_mul_f32 v[218:219], v[218:219], v[20:21]
    v_pk_mul_f32 v[220:221], v[220:221], v[20:21]
    v_pk_mul_f32 v[222:223], v[222:223], v[20:21]
    v_cvt_pk_bf16_f32 v216, v216, v217
    v_cvt_pk_bf16_f32 v217, v218, v219
    v_cvt_pk_bf16_f32 v218, v220, v221
    v_cvt_pk_bf16_f32 v219, v222, v223
    buffer_store_dwordx4 v[216:219], v24, s[16:19], s38 offen offset:3072 sc1
    s_add_u32 s38, s38, 131072
    v_pk_mul_f32 v[224:225], v[224:225], v[22:23]
    v_pk_mul_f32 v[226:227], v[226:227], v[22:23]
    v_pk_mul_f32 v[228:229], v[228:229], v[22:23]
    v_pk_mul_f32 v[230:231], v[230:231], v[22:23]
    v_cvt_pk_bf16_f32 v224, v224, v225
    v_cvt_pk_bf16_f32 v225, v226, v227
    v_cvt_pk_bf16_f32 v226, v228, v229
    v_cvt_pk_bf16_f32 v227, v230, v231
    buffer_store_dwordx4 v[224:227], v24, s[16:19], s38 offen offset:0 sc1
    v_pk_mul_f32 v[232:233], v[232:233], v[22:23]
    v_pk_mul_f32 v[234:235], v[234:235], v[22:23]
    v_pk_mul_f32 v[236:237], v[236:237], v[22:23]
    v_pk_mul_f32 v[238:239], v[238:239], v[22:23]
    v_cvt_pk_bf16_f32 v232, v232, v233
    v_cvt_pk_bf16_f32 v233, v234, v235
    v_cvt_pk_bf16_f32 v234, v236, v237
    v_cvt_pk_bf16_f32 v235, v238, v239
    buffer_store_dwordx4 v[232:235], v24, s[16:19], s38 offen offset:1024 sc1
    v_pk_mul_f32 v[240:241], v[240:241], v[22:23]
    v_pk_mul_f32 v[242:243], v[242:243], v[22:23]
    v_pk_mul_f32 v[244:245], v[244:245], v[22:23]
    v_pk_mul_f32 v[246:247], v[246:247], v[22:23]
    v_cvt_pk_bf16_f32 v240, v240, v241
    v_cvt_pk_bf16_f32 v241, v242, v243
    v_cvt_pk_bf16_f32 v242, v244, v245
    v_cvt_pk_bf16_f32 v243, v246, v247
    buffer_store_dwordx4 v[240:243], v24, s[16:19], s38 offen offset:2048 sc1
    v_pk_mul_f32 v[248:249], v[248:249], v[22:23]
    v_pk_mul_f32 v[250:251], v[250:251], v[22:23]
    v_pk_mul_f32 v[252:253], v[252:253], v[22:23]
    v_pk_mul_f32 v[254:255], v[254:255], v[22:23]
    v_cvt_pk_bf16_f32 v248, v248, v249
    v_cvt_pk_bf16_f32 v249, v250, v251
    v_cvt_pk_bf16_f32 v250, v252, v253
    v_cvt_pk_bf16_f32 v251, v254, v255
    buffer_store_dwordx4 v[248:251], v24, s[16:19], s38 offen offset:3072 sc1
    v_mov_b64 v[28:29], 0
    v_mov_b64 v[30:31], 0
    v_mov_b64 v[32:33], 0
    v_mov_b64 v[34:35], 0
    v_mov_b64 v[192:193], 0
    v_mov_b64 v[194:195], 0
    v_mov_b64 v[196:197], 0
    v_mov_b64 v[198:199], 0
    v_mov_b64 v[200:201], 0
    v_mov_b64 v[202:203], 0
    v_mov_b64 v[204:205], 0
    v_mov_b64 v[206:207], 0
    v_mov_b64 v[208:209], 0
    v_mov_b64 v[210:211], 0
    v_mov_b64 v[212:213], 0
    v_mov_b64 v[214:215], 0
    v_mov_b64 v[216:217], 0
    v_mov_b64 v[218:219], 0
    v_mov_b64 v[220:221], 0
    v_mov_b64 v[222:223], 0
    v_mov_b64 v[224:225], 0
    v_mov_b64 v[226:227], 0
    v_mov_b64 v[228:229], 0
    v_mov_b64 v[230:231], 0
    v_mov_b64 v[232:233], 0
    v_mov_b64 v[234:235], 0
    v_mov_b64 v[236:237], 0
    v_mov_b64 v[238:239], 0
    v_mov_b64 v[240:241], 0
    v_mov_b64 v[242:243], 0
    v_mov_b64 v[244:245], 0
    v_mov_b64 v[246:247], 0
    v_mov_b64 v[248:249], 0
    v_mov_b64 v[250:251], 0
    v_mov_b64 v[252:253], 0
    v_mov_b64 v[254:255], 0
L_recurrent_scan__compressed_kv_cla__moe_arch_mod__prompt_kernel_ne_120:
    s_branch L_recurrent_scan__compressed_kv_cla__moe_arch_mod__prompt_kernel_back_124
L_recurrent_scan__compressed_kv_cla__moe_arch_mod__prompt_kernel_rare_127:
    s_mov_b32 s61, 0x40000
L_recurrent_scan__compressed_kv_cla__moe_arch_mod__prompt_kernel_spin_125:
    s_sub_u32 s61, s61, 1
    s_cbranch_scc1 L_recurrent_scan__compressed_kv_cla__moe_arch_mod__prompt_kernel_spinx_126
    s_sleep 8
    global_load_dword v11, v12, s[90:91] sc1
    s_waitcnt vmcnt(0)
    v_readfirstlane_b32 s36, v11
    s_nop 0
    s_cmp_lt_u32 s36, 28
    s_cbranch_scc1 L_recurrent_scan__compressed_kv_cla__moe_arch_mod__prompt_kernel_spin_125
L_recurrent_scan__compressed_kv_cla__moe_arch_mod__prompt_kernel_spinx_126:
    s_branch L_recurrent_scan__compressed_kv_cla__moe_arch_mod__prompt_kernel_back_128
L_recurrent_scan__compressed_kv_cla__moe_arch_mod__prompt_kernel_rare_132:
    v_mov_b32 v20, 4048155338
    v_subrev_u32 v21, s50, v18
    v_cmp_gt_i32 s[20:21], 0, v21
    v_cmp_gt_i32 s[22:23], 1, v21
    v_cmp_gt_i32 s[62:63], 2, v21
    v_cmp_gt_i32 vcc, 3, v21
    v_cndmask_b32 v96, v96, v20, s[20:21]
    v_cndmask_b32 v97, v97, v20, s[22:23]
    v_cndmask_b32 v98, v98, v20, s[62:63]
    v_cndmask_b32 v99, v99, v20, vcc
    v_cmp_gt_i32 s[20:21], 16, v21
    v_cmp_gt_i32 s[22:23], 17, v21
    v_cmp_gt_i32 s[62:63], 18, v21
    v_cmp_gt_i32 vcc, 19, v21
    v_cndmask_b32 v100, v100, v20, s[20:21]
    v_cndmask_b32 v101, v101, v20, s[22:23]
    v_cndmask_b32 v102, v102, v20, s[62:63]
    v_cndmask_b32 v103, v103, v20, vcc
    v_cmp_gt_i32 s[20:21], -16, v21
    v_cmp_gt_i32 s[22:23], -15, v21
    v_cmp_gt_i32 s[62:63], -14, v21
    v_cmp_gt_i32 vcc, -13, v21
    v_cndmask_b32 v104, v104, v20, s[20:21]
    v_cndmask_b32 v105, v105, v20, s[22:23]
    v_cndmask_b32 v106, v106, v20, s[62:63]
    v_cndmask_b32 v107, v107, v20, vcc
    v_cmp_gt_i32 s[20:21], 0, v21
    v_cmp_gt_i32 s[22:23], 1, v21
    v_cmp_gt_i32 s[62:63], 2, v21
    v_cmp_gt_i32 vcc, 3, v21
    v_cndmask_b32 v108, v108, v20, s[20:21]
    v_cndmask_b32 v109, v109, v20, s[22:23]
    v_cndmask_b32 v110, v110, v20, s[62:63]
    v_cndmask_b32 v111, v111, v20, vcc
    s_branch L_recurrent_scan__compressed_kv_cla__moe_arch_mod__prompt_kernel_back_133
L_p3_done:
    s_and_b32 s36, s29, 28
    s_sub_u32 s40, 47, s30
    s_lshl_b32 s40, s40, 7
    s_add_u32 s40, s40, s36
    s_add_u32 s41, s30, 32
    s_lshl_b32 s41, s41, 7
    s_add_u32 s41, s41, s36
    s_lshr_b32 s63, s29, 4
    s_lshl_b32 s36, s30, 2
    s_lshr_b32 s30, 0x76534210, s36
    s_and_b32 s30, s30, 7
    s_and_b32 s36, s30, 4
    s_add_u32 s43, s30, s36
    s_lshl_b32 s36, s63, 2
    s_add_u32 s30, s43, s36
    s_and_b32 s29, s29, 15
    s_and_b32 s36, s28, 3
    s_lshl_b32 s37, s29, 2
    s_add_u32 s36, s36, s37
    s_lshl_b32 s36, s36, 18
    s_lshr_b32 s37, s28, 2
    s_lshl_b32 s37, s37, 12
    s_add_u32 s36, s36, s37
    s_lshl_b32 s37, s63, 16
    s_add_u32 s36, s36, s37
    s_lshr_b32 s37, s28, 2
    s_lshl_b32 s37, s37, 17
    s_add_u32 s36, s36, s37
    v_lshl_add_u32 v2, v1, 4, s36
    v_xor_b32 v3, 131072, v2
    v_lshrrev_b32 v19, 4, v1
    s_lshr_b32 s36, s28, 2
    s_lshl_b32 s36, s36, 7
    s_and_b32 s37, s28, 3
    s_lshl_b32 s37, s37, 4
    s_add_u32 s36, s36, s37
    s_lshl_b32 s33, s36, 8
    s_lshl_b32 s37, s63, 11
    s_add_u32 s36, s36, s37
    v_add_u32 v18, s36, v19
    v_lshlrev_b32 v18, 11, v18
    s_lshl_b32 s36, s43, 7
    v_add_u32 v18, s36, v18
    v_lshlrev_b32 v20, 1, v19
    v_and_b32 v21, 7, v1
    v_xor_b32 v20, v20, v21
    v_lshl_add_u32 v18, v20, 4, v18
    v_and_b32 v21, 8, v1
    v_lshl_add_u32 v6, v21, 6, v18
    v_xor_b32 v21, 8, v21
    v_lshl_add_u32 v7, v21, 6, v18
    v_add_u32 v7, 7168, v7
    v_add_u32 v8, 14336, v6
    v_add_u32 v9, 14336, v7
    s_add_u32 s36, s2, 1
    s_mov_b32 s62, 0
    s_lshl_b32 s31, s62, 14
    s_lshl_b32 s32, s62, 20
    s_add_u32 s4, s54, 41943040
    s_addc_u32 s5, s55, 0
    s_and_b32 s5, s5, 0xffff
    s_mov_b32 s6, 117440640
    s_mov_b32 s7, 0x20000
    s_mov_b32 s16, s96
    s_and_b32 s17, s97, 0xffff
    s_mov_b32 s18, 4194304
    s_mov_b32 s19, 0x20000
    s_mov_b32 s20, s98
    s_and_b32 s21, s99, 0xffff
    s_mov_b32 s22, 4194304
    s_mov_b32 s23, 0x20000
    s_lshl_b32 s36, s29, 7
    s_and_b32 s37, s28, 3
    s_lshl_b32 s37, s37, 5
    s_add_u32 s36, s36, s37
    s_lshr_b32 s37, s28, 2
    s_lshl_b32 s37, s37, 4
    s_add_u32 s38, s36, s37
    v_and_b32 v17, 15, v1
    v_add_u32 v14, s38, v17
    v_lshlrev_b32 v16, 3, v14
    v_lshrrev_b32 v15, 3, v1
    v_add_u32 v15, s38, v15
    v_lshlrev_b32 v15, 11, v15
    v_and_b32 v4, 7, v1
    v_lshl_add_u32 v15, v4, 4, v15
    s_lshl_b32 s36, s30, 7
    v_add_u32 v15, s36, v15
    s_lshl_b32 s36, s28, 12
    s_add_u32 s42, s36, 131072
    v_lshl_add_u32 v17, v17, 7, s42
    v_lshl_add_u32 v17, v19, 3, v17
    v_bfe_u32 v20, v1, 2, 2
    v_lshl_add_u32 v18, v19, 2, v20
    v_and_b32 v20, 7, v18
    s_lshl_b32 s36, s63, 2
    s_xor_b32 s36, s36, 4
    v_xor_b32 v20, s36, v20
    v_lshlrev_b32 v18, 8, v18
    s_lshr_b32 s36, s28, 2
    s_lshl_b32 s36, s36, 15
    s_add_u32 s36, s36, 65536
    v_add_u32 v18, s36, v18
    v_and_b32 v21, 3, v1
    v_lshl_add_u32 v18, v21, 3, v18
    v_xor_b32 v21, 0, v20
    v_lshl_add_u32 v50, v21, 5, v18
    v_xor_b32 v21, 1, v20
    v_lshl_add_u32 v51, v21, 5, v18
    v_xor_b32 v21, 2, v20
    v_lshl_add_u32 v52, v21, 5, v18
    v_xor_b32 v21, 3, v20
    v_lshl_add_u32 v53, v21, 5, v18
    v_xor_b32 v21, 4, v20
    v_lshl_add_u32 v54, v21, 5, v18
    v_xor_b32 v21, 5, v20
    v_lshl_add_u32 v55, v21, 5, v18
    v_xor_b32 v21, 6, v20
    v_lshl_add_u32 v56, v21, 5, v18
    v_xor_b32 v21, 7, v20
    v_lshl_add_u32 v57, v21, 5, v18
    v_mov_b64 v[192:193], 0
    v_mov_b64 v[194:195], 0
    v_mov_b64 v[196:197], 0
    v_mov_b64 v[198:199], 0
    v_mov_b64 v[200:201], 0
    v_mov_b64 v[202:203], 0
    v_mov_b64 v[204:205], 0
    v_mov_b64 v[206:207], 0
    v_mov_b64 v[208:209], 0
    v_mov_b64 v[210:211], 0
    v_mov_b64 v[212:213], 0
    v_mov_b64 v[214:215], 0
    v_mov_b64 v[216:217], 0
    v_mov_b64 v[218:219], 0
    v_mov_b64 v[220:221], 0
    v_mov_b64 v[222:223], 0
    v_mov_b64 v[224:225], 0
    v_mov_b64 v[226:227], 0
    v_mov_b64 v[228:229], 0
    v_mov_b64 v[230:231], 0
    v_mov_b64 v[232:233], 0
    v_mov_b64 v[234:235], 0
    v_mov_b64 v[236:237], 0
    v_mov_b64 v[238:239], 0
    v_mov_b64 v[240:241], 0
    v_mov_b64 v[242:243], 0
    v_mov_b64 v[244:245], 0
    v_mov_b64 v[246:247], 0
    v_mov_b64 v[248:249], 0
    v_mov_b64 v[250:251], 0
    v_mov_b64 v[252:253], 0
    v_mov_b64 v[254:255], 0
    s_waitcnt vmcnt(0)
    s_barrier
    s_cmp_eq_u32 s28, 0
    s_cbranch_scc1 L_recurrent_scan__compressed_kv_cla__moe_arch_mod__prompt_kernel_rare_134
L_recurrent_scan__compressed_kv_cla__moe_arch_mod__prompt_kernel_back_135:
    s_bitcmp1_b32 0x70, s28
    s_cbranch_scc1 L_recurrent_scan__compressed_kv_cla__moe_arch_mod__prompt_kernel_f2m_161
L_recurrent_scan__compressed_kv_cla__moe_arch_mod__prompt_kernel_f2a_162:
    s_mov_b32 s34, s33
    s_add_u32 m0, s34, 65536
    s_nop 0
    buffer_load_dwordx4 v6, s[8:11], s32 offen offset:0 lds
    buffer_load_dwordx4 v7, s[8:11], s32 offen offset:1024 lds
    buffer_load_dwordx4 v8, s[8:11], s32 offen offset:2048 lds
    buffer_load_dwordx4 v9, s[8:11], s32 offen offset:3072 lds
    s_add_u32 s32, s32, 131072
    s_add_u32 m0, s34, 81920
    s_nop 0
    buffer_load_dwordx4 v6, s[8:11], s32 offen offset:0 lds
    buffer_load_dwordx4 v7, s[8:11], s32 offen offset:1024 lds
    buffer_load_dwordx4 v8, s[8:11], s32 offen offset:2048 lds
    buffer_load_dwordx4 v9, s[8:11], s32 offen offset:3072 lds
    s_add_u32 s32, s32, 393216
    s_and_b32 s32, s32, 0x3fffff
    s_add_u32 m0, s34, 0
    s_nop 0
    buffer_load_dwordx4 v6, s[8:11], s32 offen offset:0 lds
    buffer_load_dwordx4 v7, s[8:11], s32 offen offset:1024 lds
    buffer_load_dwordx4 v8, s[8:11], s32 offen offset:2048 lds
    buffer_load_dwordx4 v9, s[8:11], s32 offen offset:3072 lds
    s_add_u32 s32, s32, 131072
    s_cmp_lt_u32 s28, 4
    s_cbranch_scc1 L_recurrent_scan__compressed_kv_cla__moe_arch_mod__prompt_kernel_f2m_161
L_recurrent_scan__compressed_kv_cla__moe_arch_mod__prompt_kernel_f2b_163:
    s_mov_b32 s60, 15
    s_cmp_eq_u32 s28, 3
    s_cbranch_scc0 L_recurrent_scan__compressed_kv_cla__moe_arch_mod__prompt_kernel_w7j_164
    v_add_u32 v58, s62, v1
    v_and_b32 v58, 3, v58
    s_add_u32 s36, s29, 32
    s_lshl_b32 s36, s36, 7
    s_lshl_b32 s37, s63, 4
    s_add_u32 s36, s36, s37
    v_lshl_add_u32 v58, v58, 2, s36
    s_mov_b32 s61, 0x40000
L_recurrent_scan__compressed_kv_cla__moe_arch_mod__prompt_kernel_cspin_165:
    s_sub_u32 s61, s61, 1
    s_cbranch_scc1 L_recurrent_scan__compressed_kv_cla__moe_arch_mod__prompt_kernel_cspinx_166
    global_load_dword v59, v58, s[90:91] sc1
    s_waitcnt vmcnt(0)
L_recurrent_scan__compressed_kv_cla__moe_arch_mod__prompt_kernel_cchk_167:
    v_cmp_le_u32 vcc, 4, v59
    s_nop 0
    s_and_b32 s60, vcc_lo, 15
    s_and_b32 s36, s60, 3
    s_cmp_eq_u32 s36, 3
    s_cbranch_scc1 L_recurrent_scan__compressed_kv_cla__moe_arch_mod__prompt_kernel_cspinx_166
    s_sleep 6
    s_branch L_recurrent_scan__compressed_kv_cla__moe_arch_mod__prompt_kernel_cspin_165
L_recurrent_scan__compressed_kv_cla__moe_arch_mod__prompt_kernel_cspinx_166:
L_recurrent_scan__compressed_kv_cla__moe_arch_mod__prompt_kernel_w7j_164:
    s_waitcnt vmcnt(8)
    s_waitcnt lgkmcnt(0)
    s_barrier
    buffer_load_dwordx4 v[128:131], v2, s[4:7], s31 offen offset:0 sc1
    buffer_load_dwordx4 v[132:135], v3, s[4:7], s31 offen offset:0 sc1
    buffer_load_dwordx4 v[136:139], v2, s[4:7], s31 offen offset:1024 sc1
    buffer_load_dwordx4 v[140:143], v3, s[4:7], s31 offen offset:1024 sc1
    buffer_load_dwordx4 v[144:147], v2, s[4:7], s31 offen offset:2048 sc1
    buffer_load_dwordx4 v[148:151], v3, s[4:7], s31 offen offset:2048 sc1
    buffer_load_dwordx4 v[152:155], v2, s[4:7], s31 offen offset:3072 sc1
    buffer_load_dwordx4 v[156:159], v3, s[4:7], s31 offen offset:3072 sc1
    s_add_u32 s31, s31, 8192
    s_and_b32 s31, s31, 0xffff
    s_cmp_lt_u32 s28, 4
    s_cbranch_scc0 L_recurrent_scan__compressed_kv_cla__moe_arch_mod__prompt_kernel_g_136
    s_lshl_b32 s36, s28, 10
    s_add_u32 s36, s36, 131072
    v_lshl_add_u32 v28, v1, 4, s36
    ds_read_b128 v[96:99], v28 offset:0
    ds_read_b128 v[100:103], v28 offset:4096
    ds_read_b128 v[104:107], v28 offset:8192
    ds_read_b128 v[108:111], v28 offset:12288
    ds_read_b128 v[112:115], v28 offset:16384
    ds_read_b128 v[116:119], v28 offset:20480
    ds_read_b128 v[120:123], v28 offset:24576
    s_lshr_b32 s36, s2, 4
    s_lshl_b32 s36, s36, 13
    s_and_b32 s37, s2, 15
    s_lshl_b32 s37, s37, 8
    s_add_u32 s36, s36, s37
    s_lshl_b32 s37, s28, 6
    s_add_u32 s36, s36, s37
    s_add_u32 s36, s36, 59768832
    v_and_b32 v28, 1, v1
    v_lshlrev_b32 v28, 12, v28
    v_lshl_add_u32 v28, v19, 4, v28
    s_waitcnt lgkmcnt(0)
    v_add_f32 v96, v96, v100
    v_add_f32 v97, v97, v101
    v_add_f32 v98, v98, v102
    v_add_f32 v99, v99, v103
    v_add_f32 v96, v96, v104
    v_add_f32 v97, v97, v105
    v_add_f32 v98, v98, v106
    v_add_f32 v99, v99, v107
    v_add_f32 v96, v96, v108
    v_add_f32 v97, v97, v109
    v_add_f32 v98, v98, v110
    v_add_f32 v99, v99, v111
    v_add_f32 v96, v96, v112
    v_add_f32 v97, v97, v113
    v_add_f32 v98, v98, v114
    v_add_f32 v99, v99, v115
    v_add_f32 v96, v96, v116
    v_add_f32 v97, v97, v117
    v_add_f32 v98, v98, v118
    v_add_f32 v99, v99, v119
    v_add_f32 v96, v96, v120
    v_add_f32 v97, v97, v121
    v_add_f32 v98, v98, v122
    v_add_f32 v99, v99, v123
    s_mov_b32 exec_lo, 0x00030003
    s_mov_b32 exec_hi, 0x00030003
    buffer_store_dwordx4 v[96:99], v28, s[24:27], s36 offen sc1
    s_mov_b64 exec, -1
    s_nop 3
L_recurrent_scan__compressed_kv_cla__moe_arch_mod__prompt_kernel_g_136:
    v_lshlrev_b32 v22, 4, v1
    v_mov_b32 v18, v22
    v_add_u32 v20, s42, v22
    v_xor_b32 v21, 16384, v20
    s_lshl_b32 s36, s2, 15
    s_lshl_b32 s37, s28, 12
    s_add_u32 s36, s36, s37
    s_add_u32 s36, s36, 67108864
    s_mov_b32 s41, s36
    s_xor_b32 s39, s36, 131072
    s_add_u32 s40, s2, 128
    s_lshl_b32 s40, s40, 7
    ds_read_b64_tr_b16 v[64:65], v50 offset:0
    ds_read_b64_tr_b16 v[66:67], v50 offset:4096
    ds_read_b64_tr_b16 v[68:69], v51 offset:0
    ds_read_b64_tr_b16 v[70:71], v51 offset:4096
    ds_read_b64_tr_b16 v[72:73], v52 offset:0
    ds_read_b64_tr_b16 v[74:75], v52 offset:4096
    ds_read_b64_tr_b16 v[76:77], v53 offset:0
    ds_read_b64_tr_b16 v[78:79], v53 offset:4096
    ds_read_b64_tr_b16 v[80:81], v54 offset:0
    ds_read_b64_tr_b16 v[82:83], v54 offset:4096
    ds_read_b64_tr_b16 v[84:85], v55 offset:0
    ds_read_b64_tr_b16 v[86:87], v55 offset:4096
    s_mov_b32 s35, 0
    s_waitcnt vmcnt(0)
    buffer_load_dwordx4 v[160:163], v2, s[4:7], s31 offen offset:0 sc1
    buffer_load_dwordx4 v[164:167], v3, s[4:7], s31 offen offset:0 sc1
    buffer_load_dwordx4 v[168:171], v2, s[4:7], s31 offen offset:1024 sc1
    buffer_load_dwordx4 v[172:175], v3, s[4:7], s31 offen offset:1024 sc1
    .p2align 6
L_p4_loop:
    s_cmp_lg_u32 s35, 0
    s_cbranch_scc1 L_recurrent_scan__compressed_kv_cla__moe_arch_mod__prompt_kernel_rare_144
L_recurrent_scan__compressed_kv_cla__moe_arch_mod__prompt_kernel_back_145:
    s_waitcnt lgkmcnt(8)
    v_mfma_f32_16x16x32_bf16 v[192:195], v[64:67], v[128:131], v[192:195]
    ds_read_b64_tr_b16 v[88:89], v56 offset:0
    buffer_load_dwordx4 v[176:179], v2, s[4:7], s31 offen offset:2048 sc1
    v_mfma_f32_16x16x32_bf16 v[224:227], v[64:67], v[132:135], v[224:227]
    ds_read_b64_tr_b16 v[90:91], v56 offset:4096
    v_mfma_f32_16x16x32_bf16 v[196:199], v[68:71], v[128:131], v[196:199]
    ds_read_b64_tr_b16 v[92:93], v57 offset:0
    v_mfma_f32_16x16x32_bf16 v[228:231], v[68:71], v[132:135], v[228:231]
    ds_read_b64_tr_b16 v[94:95], v57 offset:4096
    s_add_u32 m0, s34, 16384
    s_waitcnt lgkmcnt(8)
    v_mfma_f32_16x16x32_bf16 v[200:203], v[72:75], v[128:131], v[200:203]
    ds_read_b64_tr_b16 v[64:65], v50 offset:8192
    buffer_load_dwordx4 v6, s[8:11], s32 offen offset:0 lds
    v_mfma_f32_16x16x32_bf16 v[232:235], v[72:75], v[132:135], v[232:235]
    ds_read_b64_tr_b16 v[66:67], v50 offset:12288
    v_mfma_f32_16x16x32_bf16 v[204:207], v[76:79], v[128:131], v[204:207]
    ds_read_b64_tr_b16 v[68:69], v51 offset:8192
    v_mfma_f32_16x16x32_bf16 v[236:239], v[76:79], v[132:135], v[236:239]
    ds_read_b64_tr_b16 v[70:71], v51 offset:12288
    s_waitcnt lgkmcnt(8)
    v_mfma_f32_16x16x32_bf16 v[208:211], v[80:83], v[128:131], v[208:211]
    ds_read_b64_tr_b16 v[72:73], v52 offset:8192
    buffer_load_dwordx4 v[180:183], v3, s[4:7], s31 offen offset:2048 sc1
    v_mfma_f32_16x16x32_bf16 v[240:243], v[80:83], v[132:135], v[240:243]
    ds_read_b64_tr_b16 v[74:75], v52 offset:12288
    v_mfma_f32_16x16x32_bf16 v[212:215], v[84:87], v[128:131], v[212:215]
    ds_read_b64_tr_b16 v[76:77], v53 offset:8192
    v_mfma_f32_16x16x32_bf16 v[244:247], v[84:87], v[132:135], v[244:247]
    ds_read_b64_tr_b16 v[78:79], v53 offset:12288
    s_waitcnt lgkmcnt(8)
    v_mfma_f32_16x16x32_bf16 v[216:219], v[88:91], v[128:131], v[216:219]
    ds_read_b64_tr_b16 v[80:81], v54 offset:8192
    buffer_load_dwordx4 v7, s[8:11], s32 offen offset:1024 lds
    v_mfma_f32_16x16x32_bf16 v[248:251], v[88:91], v[132:135], v[248:251]
    ds_read_b64_tr_b16 v[82:83], v54 offset:12288
    v_mfma_f32_16x16x32_bf16 v[220:223], v[92:95], v[128:131], v[220:223]
    ds_read_b64_tr_b16 v[84:85], v55 offset:8192
    v_mfma_f32_16x16x32_bf16 v[252:255], v[92:95], v[132:135], v[252:255]
    ds_read_b64_tr_b16 v[86:87], v55 offset:12288
    s_waitcnt lgkmcnt(8)
    v_mfma_f32_16x16x32_bf16 v[192:195], v[64:67], v[136:139], v[192:195]
    ds_read_b64_tr_b16 v[88:89], v56 offset:8192
    buffer_load_dwordx4 v[184:187], v2, s[4:7], s31 offen offset:3072 sc1
    v_mfma_f32_16x16x32_bf16 v[224:227], v[64:67], v[140:143], v[224:227]
    ds_read_b64_tr_b16 v[90:91], v56 offset:12288
    v_mfma_f32_16x16x32_bf16 v[196:199], v[68:71], v[136:139], v[196:199]
    ds_read_b64_tr_b16 v[92:93], v57 offset:8192
    v_mfma_f32_16x16x32_bf16 v[228:231], v[68:71], v[140:143], v[228:231]
    ds_read_b64_tr_b16 v[94:95], v57 offset:12288
    buffer_load_dwordx4 v8, s[8:11], s32 offen offset:2048 lds
    s_waitcnt lgkmcnt(8)
    v_mfma_f32_16x16x32_bf16 v[200:203], v[72:75], v[136:139], v[200:203]
    v_mfma_f32_16x16x32_bf16 v[232:235], v[72:75], v[140:143], v[232:235]
    v_mfma_f32_16x16x32_bf16 v[204:207], v[76:79], v[136:139], v[204:207]
    buffer_load_dwordx4 v[188:191], v3, s[4:7], s31 offen offset:3072 sc1
    s_add_u32 s31, s31, 8192
    s_and_b32 s31, s31, 0xffff
    v_mfma_f32_16x16x32_bf16 v[236:239], v[76:79], v[140:143], v[236:239]
    s_waitcnt lgkmcnt(0)
    s_waitcnt vmcnt(15)
    s_barrier
    v_mfma_f32_16x16x32_bf16 v[208:211], v[80:83], v[136:139], v[208:211]
    ds_read_b64_tr_b16 v[64:65], v50 offset:16384
    ds_read_b64_tr_b16 v[66:67], v50 offset:20480
    v_mfma_f32_16x16x32_bf16 v[240:243], v[80:83], v[140:143], v[240:243]
    ds_read_b64_tr_b16 v[68:69], v51 offset:16384
    ds_read_b64_tr_b16 v[70:71], v51 offset:20480
    v_mfma_f32_16x16x32_bf16 v[212:215], v[84:87], v[136:139], v[212:215]
    ds_read_b64_tr_b16 v[72:73], v52 offset:16384
    ds_read_b64_tr_b16 v[74:75], v52 offset:20480
    v_mfma_f32_16x16x32_bf16 v[244:247], v[84:87], v[140:143], v[244:247]
    ds_read_b64_tr_b16 v[76:77], v53 offset:16384
    ds_read_b64_tr_b16 v[78:79], v53 offset:20480
    v_mfma_f32_16x16x32_bf16 v[216:219], v[88:91], v[136:139], v[216:219]
    ds_read_b64_tr_b16 v[80:81], v54 offset:16384
    ds_read_b64_tr_b16 v[82:83], v54 offset:20480
    buffer_load_dwordx4 v9, s[8:11], s32 offen offset:3072 lds
    v_mfma_f32_16x16x32_bf16 v[248:251], v[88:91], v[140:143], v[248:251]
    s_add_u32 s32, s32, 393216
    s_and_b32 s32, s32, 0x3fffff
    v_mfma_f32_16x16x32_bf16 v[220:223], v[92:95], v[136:139], v[220:223]
    ds_read_b64_tr_b16 v[84:85], v55 offset:16384
    ds_read_b64_tr_b16 v[86:87], v55 offset:20480
    v_mfma_f32_16x16x32_bf16 v[252:255], v[92:95], v[140:143], v[252:255]
    s_waitcnt lgkmcnt(8)
    v_mfma_f32_16x16x32_bf16 v[192:195], v[64:67], v[144:147], v[192:195]
    ds_read_b64_tr_b16 v[88:89], v56 offset:16384
    buffer_load_dwordx4 v[128:131], v2, s[4:7], s31 offen offset:0 sc1
    v_mfma_f32_16x16x32_bf16 v[224:227], v[64:67], v[148:151], v[224:227]
    ds_read_b64_tr_b16 v[90:91], v56 offset:20480
    v_mfma_f32_16x16x32_bf16 v[196:199], v[68:71], v[144:147], v[196:199]
    ds_read_b64_tr_b16 v[92:93], v57 offset:16384
    v_mfma_f32_16x16x32_bf16 v[228:231], v[68:71], v[148:151], v[228:231]
    ds_read_b64_tr_b16 v[94:95], v57 offset:20480
    s_add_u32 m0, s34, 65536
    s_waitcnt lgkmcnt(8)
    v_mfma_f32_16x16x32_bf16 v[200:203], v[72:75], v[144:147], v[200:203]
    ds_read_b64_tr_b16 v[64:65], v50 offset:24576
    buffer_load_dwordx4 v6, s[8:11], s32 offen offset:0 lds
    v_mfma_f32_16x16x32_bf16 v[232:235], v[72:75], v[148:151], v[232:235]
    ds_read_b64_tr_b16 v[66:67], v50 offset:28672
    v_xor_b32 v50, 65536, v50
    v_mfma_f32_16x16x32_bf16 v[204:207], v[76:79], v[144:147], v[204:207]
    ds_read_b64_tr_b16 v[68:69], v51 offset:24576
    v_mfma_f32_16x16x32_bf16 v[236:239], v[76:79], v[148:151], v[236:239]
    ds_read_b64_tr_b16 v[70:71], v51 offset:28672
    v_xor_b32 v51, 65536, v51
    s_waitcnt lgkmcnt(8)
    v_mfma_f32_16x16x32_bf16 v[208:211], v[80:83], v[144:147], v[208:211]
    ds_read_b64_tr_b16 v[72:73], v52 offset:24576
    buffer_load_dwordx4 v[132:135], v3, s[4:7], s31 offen offset:0 sc1
    v_mfma_f32_16x16x32_bf16 v[240:243], v[80:83], v[148:151], v[240:243]
    ds_read_b64_tr_b16 v[74:75], v52 offset:28672
    v_xor_b32 v52, 65536, v52
    v_mfma_f32_16x16x32_bf16 v[212:215], v[84:87], v[144:147], v[212:215]
    ds_read_b64_tr_b16 v[76:77], v53 offset:24576
    v_mfma_f32_16x16x32_bf16 v[244:247], v[84:87], v[148:151], v[244:247]
    ds_read_b64_tr_b16 v[78:79], v53 offset:28672
    v_xor_b32 v53, 65536, v53
    s_waitcnt lgkmcnt(8)
    v_mfma_f32_16x16x32_bf16 v[216:219], v[88:91], v[144:147], v[216:219]
    ds_read_b64_tr_b16 v[80:81], v54 offset:24576
    buffer_load_dwordx4 v7, s[8:11], s32 offen offset:1024 lds
    v_mfma_f32_16x16x32_bf16 v[248:251], v[88:91], v[148:151], v[248:251]
    ds_read_b64_tr_b16 v[82:83], v54 offset:28672
    v_xor_b32 v54, 65536, v54
    v_mfma_f32_16x16x32_bf16 v[220:223], v[92:95], v[144:147], v[220:223]
    ds_read_b64_tr_b16 v[84:85], v55 offset:24576
    v_mfma_f32_16x16x32_bf16 v[252:255], v[92:95], v[148:151], v[252:255]
    ds_read_b64_tr_b16 v[86:87], v55 offset:28672
    v_xor_b32 v55, 65536, v55
    s_waitcnt lgkmcnt(8)
    v_mfma_f32_16x16x32_bf16 v[192:195], v[64:67], v[152:155], v[192:195]
    ds_read_b64_tr_b16 v[88:89], v56 offset:24576
    buffer_load_dwordx4 v[136:139], v2, s[4:7], s31 offen offset:1024 sc1
    v_mfma_f32_16x16x32_bf16 v[224:227], v[64:67], v[156:159], v[224:227]
    ds_read_b64_tr_b16 v[90:91], v56 offset:28672
    v_xor_b32 v56, 65536, v56
    v_mfma_f32_16x16x32_bf16 v[196:199], v[68:71], v[152:155], v[196:199]
    ds_read_b64_tr_b16 v[92:93], v57 offset:24576
    v_mfma_f32_16x16x32_bf16 v[228:231], v[68:71], v[156:159], v[228:231]
    ds_read_b64_tr_b16 v[94:95], v57 offset:28672
    v_xor_b32 v57, 65536, v57
    buffer_load_dwordx4 v8, s[8:11], s32 offen offset:2048 lds
    s_waitcnt lgkmcnt(8)
    v_mfma_f32_16x16x32_bf16 v[200:203], v[72:75], v[152:155], v[200:203]
    v_mfma_f32_16x16x32_bf16 v[232:235], v[72:75], v[156:159], v[232:235]
    v_mfma_f32_16x16x32_bf16 v[204:207], v[76:79], v[152:155], v[204:207]
    buffer_load_dwordx4 v[140:143], v3, s[4:7], s31 offen offset:1024 sc1
    v_mfma_f32_16x16x32_bf16 v[236:239], v[76:79], v[156:159], v[236:239]
    s_waitcnt lgkmcnt(0)
    s_waitcnt vmcnt(15)
    s_barrier
    v_mfma_f32_16x16x32_bf16 v[208:211], v[80:83], v[152:155], v[208:211]
    ds_read_b64_tr_b16 v[64:65], v50 offset:0
    ds_read_b64_tr_b16 v[66:67], v50 offset:4096
    v_mfma_f32_16x16x32_bf16 v[240:243], v[80:83], v[156:159], v[240:243]
    ds_read_b64_tr_b16 v[68:69], v51 offset:0
    ds_read_b64_tr_b16 v[70:71], v51 offset:4096
    v_mfma_f32_16x16x32_bf16 v[212:215], v[84:87], v[152:155], v[212:215]
    ds_read_b64_tr_b16 v[72:73], v52 offset:0
    ds_read_b64_tr_b16 v[74:75], v52 offset:4096
    v_mfma_f32_16x16x32_bf16 v[244:247], v[84:87], v[156:159], v[244:247]
    ds_read_b64_tr_b16 v[76:77], v53 offset:0
    ds_read_b64_tr_b16 v[78:79], v53 offset:4096
    v_mfma_f32_16x16x32_bf16 v[216:219], v[88:91], v[152:155], v[216:219]
    ds_read_b64_tr_b16 v[80:81], v54 offset:0
    ds_read_b64_tr_b16 v[82:83], v54 offset:4096
    buffer_load_dwordx4 v9, s[8:11], s32 offen offset:3072 lds
    v_mfma_f32_16x16x32_bf16 v[248:251], v[88:91], v[156:159], v[248:251]
    s_add_u32 s32, s32, 131072
    v_mfma_f32_16x16x32_bf16 v[220:223], v[92:95], v[152:155], v[220:223]
    ds_read_b64_tr_b16 v[84:85], v55 offset:0
    ds_read_b64_tr_b16 v[86:87], v55 offset:4096
    v_mfma_f32_16x16x32_bf16 v[252:255], v[92:95], v[156:159], v[252:255]
    s_cmp_eq_u32 s35, 2
    s_cbranch_scc1 L_recurrent_scan__compressed_kv_cla__moe_arch_mod__prompt_kernel_rare_147
L_recurrent_scan__compressed_kv_cla__moe_arch_mod__prompt_kernel_back_148:
    s_waitcnt lgkmcnt(8)
    s_waitcnt vmcnt(18)
    v_mfma_f32_16x16x32_bf16 v[192:195], v[64:67], v[160:163], v[192:195]
    ds_read_b64_tr_b16 v[88:89], v56 offset:0
    buffer_load_dwordx4 v[144:147], v2, s[4:7], s31 offen offset:2048 sc1
    v_mfma_f32_16x16x32_bf16 v[224:227], v[64:67], v[164:167], v[224:227]
    ds_read_b64_tr_b16 v[90:91], v56 offset:4096
    v_mfma_f32_16x16x32_bf16 v[196:199], v[68:71], v[160:163], v[196:199]
    ds_read_b64_tr_b16 v[92:93], v57 offset:0
    v_mfma_f32_16x16x32_bf16 v[228:231], v[68:71], v[164:167], v[228:231]
    ds_read_b64_tr_b16 v[94:95], v57 offset:4096
    s_add_u32 m0, s34, 81920
    s_waitcnt lgkmcnt(8)
    v_mfma_f32_16x16x32_bf16 v[200:203], v[72:75], v[160:163], v[200:203]
    ds_read_b64_tr_b16 v[64:65], v50 offset:8192
    buffer_load_dwordx4 v6, s[8:11], s32 offen offset:0 lds
    v_mfma_f32_16x16x32_bf16 v[232:235], v[72:75], v[164:167], v[232:235]
    ds_read_b64_tr_b16 v[66:67], v50 offset:12288
    v_mfma_f32_16x16x32_bf16 v[204:207], v[76:79], v[160:163], v[204:207]
    ds_read_b64_tr_b16 v[68:69], v51 offset:8192
    v_mfma_f32_16x16x32_bf16 v[236:239], v[76:79], v[164:167], v[236:239]
    ds_read_b64_tr_b16 v[70:71], v51 offset:12288
    s_waitcnt lgkmcnt(8)
    v_mfma_f32_16x16x32_bf16 v[208:211], v[80:83], v[160:163], v[208:211]
    ds_read_b64_tr_b16 v[72:73], v52 offset:8192
    buffer_load_dwordx4 v[148:151], v3, s[4:7], s31 offen offset:2048 sc1
    v_mfma_f32_16x16x32_bf16 v[240:243], v[80:83], v[164:167], v[240:243]
    ds_read_b64_tr_b16 v[74:75], v52 offset:12288
    v_mfma_f32_16x16x32_bf16 v[212:215], v[84:87], v[160:163], v[212:215]
    ds_read_b64_tr_b16 v[76:77], v53 offset:8192
    v_mfma_f32_16x16x32_bf16 v[244:247], v[84:87], v[164:167], v[244:247]
    ds_read_b64_tr_b16 v[78:79], v53 offset:12288
    s_waitcnt lgkmcnt(8)
    v_mfma_f32_16x16x32_bf16 v[216:219], v[88:91], v[160:163], v[216:219]
    ds_read_b64_tr_b16 v[80:81], v54 offset:8192
    buffer_load_dwordx4 v7, s[8:11], s32 offen offset:1024 lds
    v_mfma_f32_16x16x32_bf16 v[248:251], v[88:91], v[164:167], v[248:251]
    ds_read_b64_tr_b16 v[82:83], v54 offset:12288
    v_mfma_f32_16x16x32_bf16 v[220:223], v[92:95], v[160:163], v[220:223]
    ds_read_b64_tr_b16 v[84:85], v55 offset:8192
    v_mfma_f32_16x16x32_bf16 v[252:255], v[92:95], v[164:167], v[252:255]
    ds_read_b64_tr_b16 v[86:87], v55 offset:12288
    s_waitcnt lgkmcnt(8)
    s_waitcnt vmcnt(20)
    v_mfma_f32_16x16x32_bf16 v[192:195], v[64:67], v[168:171], v[192:195]
    ds_read_b64_tr_b16 v[88:89], v56 offset:8192
    buffer_load_dwordx4 v[152:155], v2, s[4:7], s31 offen offset:3072 sc1
    v_mfma_f32_16x16x32_bf16 v[224:227], v[64:67], v[172:175], v[224:227]
    ds_read_b64_tr_b16 v[90:91], v56 offset:12288
    v_mfma_f32_16x16x32_bf16 v[196:199], v[68:71], v[168:171], v[196:199]
    ds_read_b64_tr_b16 v[92:93], v57 offset:8192
    v_mfma_f32_16x16x32_bf16 v[228:231], v[68:71], v[172:175], v[228:231]
    ds_read_b64_tr_b16 v[94:95], v57 offset:12288
    buffer_load_dwordx4 v8, s[8:11], s32 offen offset:2048 lds
    s_waitcnt lgkmcnt(8)
    v_mfma_f32_16x16x32_bf16 v[200:203], v[72:75], v[168:171], v[200:203]
    v_mfma_f32_16x16x32_bf16 v[232:235], v[72:75], v[172:175], v[232:235]
    v_mfma_f32_16x16x32_bf16 v[204:207], v[76:79], v[168:171], v[204:207]
    buffer_load_dwordx4 v[156:159], v3, s[4:7], s31 offen offset:3072 sc1
    s_add_u32 s31, s31, 8192
    s_and_b32 s31, s31, 0xffff
    v_mfma_f32_16x16x32_bf16 v[236:239], v[76:79], v[172:175], v[236:239]
    s_cmp_lt_u32 s60, 15
    s_cbranch_scc1 L_recurrent_scan__compressed_kv_cla__moe_arch_mod__prompt_kernel_rare_149
L_recurrent_scan__compressed_kv_cla__moe_arch_mod__prompt_kernel_back_150:
    s_waitcnt lgkmcnt(0)
    s_waitcnt vmcnt(15)
    s_barrier
    v_mfma_f32_16x16x32_bf16 v[208:211], v[80:83], v[168:171], v[208:211]
    ds_read_b64_tr_b16 v[64:65], v50 offset:16384
    ds_read_b64_tr_b16 v[66:67], v50 offset:20480
    v_mfma_f32_16x16x32_bf16 v[240:243], v[80:83], v[172:175], v[240:243]
    ds_read_b64_tr_b16 v[68:69], v51 offset:16384
    ds_read_b64_tr_b16 v[70:71], v51 offset:20480
    v_mfma_f32_16x16x32_bf16 v[212:215], v[84:87], v[168:171], v[212:215]
    ds_read_b64_tr_b16 v[72:73], v52 offset:16384
    ds_read_b64_tr_b16 v[74:75], v52 offset:20480
    v_mfma_f32_16x16x32_bf16 v[244:247], v[84:87], v[172:175], v[244:247]
    ds_read_b64_tr_b16 v[76:77], v53 offset:16384
    ds_read_b64_tr_b16 v[78:79], v53 offset:20480
    v_mfma_f32_16x16x32_bf16 v[216:219], v[88:91], v[168:171], v[216:219]
    ds_read_b64_tr_b16 v[80:81], v54 offset:16384
    ds_read_b64_tr_b16 v[82:83], v54 offset:20480
    buffer_load_dwordx4 v9, s[8:11], s32 offen offset:3072 lds
    v_mfma_f32_16x16x32_bf16 v[248:251], v[88:91], v[172:175], v[248:251]
    s_add_u32 s32, s32, 393216
    s_and_b32 s32, s32, 0x3fffff
    v_mfma_f32_16x16x32_bf16 v[220:223], v[92:95], v[168:171], v[220:223]
    ds_read_b64_tr_b16 v[84:85], v55 offset:16384
    ds_read_b64_tr_b16 v[86:87], v55 offset:20480
    v_mfma_f32_16x16x32_bf16 v[252:255], v[92:95], v[172:175], v[252:255]
    s_waitcnt lgkmcnt(8)
    v_mfma_f32_16x16x32_bf16 v[192:195], v[64:67], v[176:179], v[192:195]
    ds_read_b64_tr_b16 v[88:89], v56 offset:16384
    buffer_load_dwordx4 v[160:163], v2, s[4:7], s31 offen offset:0 sc1
    v_mfma_f32_16x16x32_bf16 v[224:227], v[64:67], v[180:183], v[224:227]
    ds_read_b64_tr_b16 v[90:91], v56 offset:20480
    v_mfma_f32_16x16x32_bf16 v[196:199], v[68:71], v[176:179], v[196:199]
    ds_read_b64_tr_b16 v[92:93], v57 offset:16384
    v_mfma_f32_16x16x32_bf16 v[228:231], v[68:71], v[180:183], v[228:231]
    ds_read_b64_tr_b16 v[94:95], v57 offset:20480
    s_add_u32 m0, s34, 0
    s_waitcnt lgkmcnt(8)
    v_mfma_f32_16x16x32_bf16 v[200:203], v[72:75], v[176:179], v[200:203]
    ds_read_b64_tr_b16 v[64:65], v50 offset:24576
    buffer_load_dwordx4 v6, s[8:11], s32 offen offset:0 lds
    v_mfma_f32_16x16x32_bf16 v[232:235], v[72:75], v[180:183], v[232:235]
    ds_read_b64_tr_b16 v[66:67], v50 offset:28672
    v_xor_b32 v50, 65536, v50
    v_mfma_f32_16x16x32_bf16 v[204:207], v[76:79], v[176:179], v[204:207]
    ds_read_b64_tr_b16 v[68:69], v51 offset:24576
    v_mfma_f32_16x16x32_bf16 v[236:239], v[76:79], v[180:183], v[236:239]
    ds_read_b64_tr_b16 v[70:71], v51 offset:28672
    v_xor_b32 v51, 65536, v51
    s_waitcnt lgkmcnt(8)
    v_mfma_f32_16x16x32_bf16 v[208:211], v[80:83], v[176:179], v[208:211]
    ds_read_b64_tr_b16 v[72:73], v52 offset:24576
    buffer_load_dwordx4 v[164:167], v3, s[4:7], s31 offen offset:0 sc1
    v_mfma_f32_16x16x32_bf16 v[240:243], v[80:83], v[180:183], v[240:243]
    ds_read_b64_tr_b16 v[74:75], v52 offset:28672
    v_xor_b32 v52, 65536, v52
    v_mfma_f32_16x16x32_bf16 v[212:215], v[84:87], v[176:179], v[212:215]
    ds_read_b64_tr_b16 v[76:77], v53 offset:24576
    v_mfma_f32_16x16x32_bf16 v[244:247], v[84:87], v[180:183], v[244:247]
    ds_read_b64_tr_b16 v[78:79], v53 offset:28672
    v_xor_b32 v53, 65536, v53
    s_waitcnt lgkmcnt(8)
    v_mfma_f32_16x16x32_bf16 v[216:219], v[88:91], v[176:179], v[216:219]
    ds_read_b64_tr_b16 v[80:81], v54 offset:24576
    buffer_load_dwordx4 v7, s[8:11], s32 offen offset:1024 lds
    v_mfma_f32_16x16x32_bf16 v[248:251], v[88:91], v[180:183], v[248:251]
    ds_read_b64_tr_b16 v[82:83], v54 offset:28672
    v_xor_b32 v54, 65536, v54
    v_mfma_f32_16x16x32_bf16 v[220:223], v[92:95], v[176:179], v[220:223]
    ds_read_b64_tr_b16 v[84:85], v55 offset:24576
    v_mfma_f32_16x16x32_bf16 v[252:255], v[92:95], v[180:183], v[252:255]
    ds_read_b64_tr_b16 v[86:87], v55 offset:28672
    v_xor_b32 v55, 65536, v55
    s_waitcnt lgkmcnt(8)
    v_mfma_f32_16x16x32_bf16 v[192:195], v[64:67], v[184:187], v[192:195]
    ds_read_b64_tr_b16 v[88:89], v56 offset:24576
    buffer_load_dwordx4 v[168:171], v2, s[4:7], s31 offen offset:1024 sc1
    v_mfma_f32_16x16x32_bf16 v[224:227], v[64:67], v[188:191], v[224:227]
    ds_read_b64_tr_b16 v[90:91], v56 offset:28672
    v_xor_b32 v56, 65536, v56
    v_mfma_f32_16x16x32_bf16 v[196:199], v[68:71], v[184:187], v[196:199]
    ds_read_b64_tr_b16 v[92:93], v57 offset:24576
    v_mfma_f32_16x16x32_bf16 v[228:231], v[68:71], v[188:191], v[228:231]
    ds_read_b64_tr_b16 v[94:95], v57 offset:28672
    v_xor_b32 v57, 65536, v57
    buffer_load_dwordx4 v8, s[8:11], s32 offen offset:2048 lds
    s_waitcnt lgkmcnt(8)
    v_mfma_f32_16x16x32_bf16 v[200:203], v[72:75], v[184:187], v[200:203]
    v_mfma_f32_16x16x32_bf16 v[232:235], v[72:75], v[188:191], v[232:235]
    v_mfma_f32_16x16x32_bf16 v[204:207], v[76:79], v[184:187], v[204:207]
    buffer_load_dwordx4 v[172:175], v3, s[4:7], s31 offen offset:1024 sc1
    v_mfma_f32_16x16x32_bf16 v[236:239], v[76:79], v[188:191], v[236:239]
    s_cmp_lt_u32 s60, 15
    s_cbranch_scc1 L_recurrent_scan__compressed_kv_cla__moe_arch_mod__prompt_kernel_rare_159
L_recurrent_scan__compressed_kv_cla__moe_arch_mod__prompt_kernel_back_160:
    s_waitcnt lgkmcnt(0)
    s_waitcnt vmcnt(15)
    s_barrier
    v_mfma_f32_16x16x32_bf16 v[208:211], v[80:83], v[184:187], v[208:211]
    ds_read_b64_tr_b16 v[64:65], v50 offset:0
    ds_read_b64_tr_b16 v[66:67], v50 offset:4096
    v_mfma_f32_16x16x32_bf16 v[240:243], v[80:83], v[188:191], v[240:243]
    ds_read_b64_tr_b16 v[68:69], v51 offset:0
    ds_read_b64_tr_b16 v[70:71], v51 offset:4096
    v_mfma_f32_16x16x32_bf16 v[212:215], v[84:87], v[184:187], v[212:215]
    ds_read_b64_tr_b16 v[72:73], v52 offset:0
    ds_read_b64_tr_b16 v[74:75], v52 offset:4096
    v_mfma_f32_16x16x32_bf16 v[244:247], v[84:87], v[188:191], v[244:247]
    ds_read_b64_tr_b16 v[76:77], v53 offset:0
    ds_read_b64_tr_b16 v[78:79], v53 offset:4096
    v_mfma_f32_16x16x32_bf16 v[216:219], v[88:91], v[184:187], v[216:219]
    ds_read_b64_tr_b16 v[80:81], v54 offset:0
    ds_read_b64_tr_b16 v[82:83], v54 offset:4096
    buffer_load_dwordx4 v9, s[8:11], s32 offen offset:3072 lds
    v_mfma_f32_16x16x32_bf16 v[248:251], v[88:91], v[188:191], v[248:251]
    s_add_u32 s32, s32, 131072
    v_mfma_f32_16x16x32_bf16 v[220:223], v[92:95], v[184:187], v[220:223]
    ds_read_b64_tr_b16 v[84:85], v55 offset:0
    ds_read_b64_tr_b16 v[86:87], v55 offset:4096
    v_mfma_f32_16x16x32_bf16 v[252:255], v[92:95], v[188:191], v[252:255]
    s_add_u32 s35, s35, 1
    s_cmp_lt_u32 s35, 3
    s_cbranch_scc1 L_p4_loop
    s_sub_u32 s36, s56, s38
    s_sub_u32 s37, s57, s38
    s_min_u32 s36, s36, s37
    s_cmp_lt_u32 s36, 16
    s_cbranch_scc1 L_recurrent_scan__compressed_kv_cla__moe_arch_mod__prompt_kernel_rare_168
L_recurrent_scan__compressed_kv_cla__moe_arch_mod__prompt_kernel_back_169:
    s_xor_b32 s37, s40, 512
    v_mov_b32 v5, s37
    s_waitcnt vmcnt(16)
    ds_read_b64 v[40:41], v17 offset:0
    ds_read_b64 v[42:43], v17 offset:32
    ds_read_b64 v[44:45], v17 offset:64
    ds_read_b64 v[46:47], v17 offset:96
    s_waitcnt lgkmcnt(12)
    v_mfma_f32_16x16x32_bf16 v[192:195], v[64:67], v[128:131], v[192:195]
    ds_read_b64_tr_b16 v[88:89], v56 offset:0
    s_add_u32 m0, s34, 16384
    v_mfma_f32_16x16x32_bf16 v[224:227], v[64:67], v[132:135], v[224:227]
    ds_read_b64_tr_b16 v[90:91], v56 offset:4096
    v_mfma_f32_16x16x32_bf16 v[196:199], v[68:71], v[128:131], v[196:199]
    ds_read_b64_tr_b16 v[92:93], v57 offset:0
    v_mfma_f32_16x16x32_bf16 v[228:231], v[68:71], v[132:135], v[228:231]
    ds_read_b64_tr_b16 v[94:95], v57 offset:4096
    buffer_load_dwordx4 v6, s[8:11], s32 offen offset:0 lds
    s_waitcnt lgkmcnt(12)
    v_mfma_f32_16x16x32_bf16 v[200:203], v[72:75], v[128:131], v[200:203]
    ds_read_b64_tr_b16 v[64:65], v50 offset:8192
    v_mfma_f32_16x16x32_bf16 v[232:235], v[72:75], v[132:135], v[232:235]
    ds_read_b64_tr_b16 v[66:67], v50 offset:12288
    v_mfma_f32_16x16x32_bf16 v[204:207], v[76:79], v[128:131], v[204:207]
    ds_read_b64_tr_b16 v[68:69], v51 offset:8192
    buffer_load_dwordx4 v7, s[8:11], s32 offen offset:1024 lds
    v_mfma_f32_16x16x32_bf16 v[236:239], v[76:79], v[132:135], v[236:239]
    ds_read_b64_tr_b16 v[70:71], v51 offset:12288
    s_waitcnt lgkmcnt(12)
    s_waitcnt lgkmcnt(8)
    v_mfma_f32_16x16x32_bf16 v[208:211], v[80:83], v[128:131], v[208:211]
    ds_read_b64_tr_b16 v[72:73], v52 offset:8192
    v_mfma_f32_16x16x32_bf16 v[240:243], v[80:83], v[132:135], v[240:243]
    ds_read_b64_tr_b16 v[74:75], v52 offset:12288
    buffer_load_dwordx4 v8, s[8:11], s32 offen offset:2048 lds
    v_mfma_f32_16x16x32_bf16 v[212:215], v[84:87], v[128:131], v[212:215]
    ds_read_b64_tr_b16 v[76:77], v53 offset:8192
    v_mfma_f32_16x16x32_bf16 v[244:247], v[84:87], v[132:135], v[244:247]
    ds_read_b64_tr_b16 v[78:79], v53 offset:12288
    s_waitcnt vmcnt(11)
    s_barrier
    s_waitcnt lgkmcnt(8)
    v_mfma_f32_16x16x32_bf16 v[216:219], v[88:91], v[128:131], v[216:219]
    ds_read_b64_tr_b16 v[80:81], v50 offset:16384
    buffer_load_dwordx4 v9, s[8:11], s32 offen offset:3072 lds
    v_mfma_f32_16x16x32_bf16 v[248:251], v[88:91], v[132:135], v[248:251]
    ds_read_b64_tr_b16 v[82:83], v50 offset:20480
    v_mfma_f32_16x16x32_bf16 v[220:223], v[92:95], v[128:131], v[220:223]
    ds_read_b64_tr_b16 v[84:85], v51 offset:16384
    v_mfma_f32_16x16x32_bf16 v[252:255], v[92:95], v[132:135], v[252:255]
    ds_read_b64_tr_b16 v[86:87], v51 offset:20480
    buffer_load_dwordx4 v[176:179], v2, s[4:7], s31 offen offset:2048 sc1
    s_waitcnt lgkmcnt(8)
    v_mfma_f32_16x16x32_bf16 v[192:195], v[64:67], v[136:139], v[192:195]
    ds_read_b64_tr_b16 v[88:89], v52 offset:16384
    v_mfma_f32_16x16x32_bf16 v[224:227], v[64:67], v[140:143], v[224:227]
    ds_read_b64_tr_b16 v[90:91], v52 offset:20480
    v_mfma_f32_16x16x32_bf16 v[196:199], v[68:71], v[136:139], v[196:199]
    ds_read_b64_tr_b16 v[92:93], v53 offset:16384
    buffer_load_dwordx4 v[180:183], v3, s[4:7], s31 offen offset:2048 sc1
    v_mfma_f32_16x16x32_bf16 v[228:231], v[68:71], v[140:143], v[228:231]
    ds_read_b64_tr_b16 v[94:95], v53 offset:20480
    s_waitcnt lgkmcnt(8)
    v_mfma_f32_16x16x32_bf16 v[200:203], v[72:75], v[136:139], v[200:203]
    ds_read_b64_tr_b16 v[64:65], v50 offset:24576
    v_mfma_f32_16x16x32_bf16 v[232:235], v[72:75], v[140:143], v[232:235]
    ds_read_b64_tr_b16 v[66:67], v50 offset:28672
    v_xor_b32 v50, 65536, v50
    buffer_load_dwordx4 v[184:187], v2, s[4:7], s31 offen offset:3072 sc1
    v_mfma_f32_16x16x32_bf16 v[204:207], v[76:79], v[136:139], v[204:207]
    ds_read_b64_tr_b16 v[68:69], v51 offset:24576
    v_mfma_f32_16x16x32_bf16 v[236:239], v[76:79], v[140:143], v[236:239]
    ds_read_b64_tr_b16 v[70:71], v51 offset:28672
    v_xor_b32 v51, 65536, v51
    s_waitcnt lgkmcnt(8)
    v_mfma_f32_16x16x32_bf16 v[192:195], v[80:83], v[144:147], v[192:195]
    ds_read_b64_tr_b16 v[72:73], v52 offset:24576
    buffer_load_dwordx4 v[188:191], v3, s[4:7], s31 offen offset:3072 sc1
    v_mfma_f32_16x16x32_bf16 v[224:227], v[80:83], v[148:151], v[224:227]
    ds_read_b64_tr_b16 v[74:75], v52 offset:28672
    v_xor_b32 v52, 65536, v52
    v_mfma_f32_16x16x32_bf16 v[196:199], v[84:87], v[144:147], v[196:199]
    ds_read_b64_tr_b16 v[76:77], v53 offset:24576
    v_mfma_f32_16x16x32_bf16 v[228:231], v[84:87], v[148:151], v[228:231]
    ds_read_b64_tr_b16 v[78:79], v53 offset:28672
    v_xor_b32 v53, 65536, v53
    s_waitcnt vmcnt(8)
    s_barrier
    s_waitcnt lgkmcnt(8)
    v_mfma_f32_16x16x32_bf16 v[200:203], v[88:91], v[144:147], v[200:203]
    ds_read_b64_tr_b16 v[80:81], v50 offset:0
    v_mfma_f32_16x16x32_bf16 v[232:235], v[88:91], v[148:151], v[232:235]
    ds_read_b64_tr_b16 v[82:83], v50 offset:4096
    v_mfma_f32_16x16x32_bf16 v[204:207], v[92:95], v[144:147], v[204:207]
    ds_read_b64_tr_b16 v[84:85], v51 offset:0
    v_mfma_f32_16x16x32_bf16 v[236:239], v[92:95], v[148:151], v[236:239]
    ds_read_b64_tr_b16 v[86:87], v51 offset:4096
    s_waitcnt lgkmcnt(8)
    v_mfma_f32_16x16x32_bf16 v[192:195], v[64:67], v[152:155], v[192:195]
    ds_read_b64_tr_b16 v[88:89], v52 offset:0
    v_mfma_f32_16x16x32_bf16 v[224:227], v[64:67], v[156:159], v[224:227]
    ds_read_b64_tr_b16 v[90:91], v52 offset:4096
    v_mfma_f32_16x16x32_bf16 v[196:199], v[68:71], v[152:155], v[196:199]
    ds_read_b64_tr_b16 v[92:93], v53 offset:0
    v_mfma_f32_16x16x32_bf16 v[228:231], v[68:71], v[156:159], v[228:231]
    ds_read_b64_tr_b16 v[94:95], v53 offset:4096
    s_waitcnt lgkmcnt(8)
    v_mfma_f32_16x16x32_bf16 v[200:203], v[72:75], v[152:155], v[200:203]
    ds_read_b64_tr_b16 v[64:65], v50 offset:8192
    v_mfma_f32_16x16x32_bf16 v[232:235], v[72:75], v[156:159], v[232:235]
    ds_read_b64_tr_b16 v[66:67], v50 offset:12288
    v_mfma_f32_16x16x32_bf16 v[204:207], v[76:79], v[152:155], v[204:207]
    ds_read_b64_tr_b16 v[68:69], v51 offset:8192
    v_mfma_f32_16x16x32_bf16 v[236:239], v[76:79], v[156:159], v[236:239]
    ds_read_b64_tr_b16 v[70:71], v51 offset:12288
    s_waitcnt lgkmcnt(8)
    v_mfma_f32_16x16x32_bf16 v[192:195], v[80:83], v[160:163], v[192:195]
    ds_read_b64_tr_b16 v[72:73], v52 offset:8192
    v_mfma_f32_16x16x32_bf16 v[224:227], v[80:83], v[164:167], v[224:227]
    ds_read_b64_tr_b16 v[74:75], v52 offset:12288
    v_mfma_f32_16x16x32_bf16 v[196:199], v[84:87], v[160:163], v[196:199]
    ds_read_b64_tr_b16 v[76:77], v53 offset:8192
    v_mfma_f32_16x16x32_bf16 v[228:231], v[84:87], v[164:167], v[228:231]
    ds_read_b64_tr_b16 v[78:79], v53 offset:12288
    s_waitcnt vmcnt(4)
    s_barrier
    s_waitcnt lgkmcnt(8)
    v_mfma_f32_16x16x32_bf16 v[200:203], v[88:91], v[160:163], v[200:203]
    ds_read_b64_tr_b16 v[80:81], v50 offset:16384
    v_mfma_f32_16x16x32_bf16 v[232:235], v[88:91], v[164:167], v[232:235]
    ds_read_b64_tr_b16 v[82:83], v50 offset:20480
    v_mfma_f32_16x16x32_bf16 v[204:207], v[92:95], v[160:163], v[204:207]
    ds_read_b64_tr_b16 v[84:85], v51 offset:16384
    v_mfma_f32_16x16x32_bf16 v[236:239], v[92:95], v[164:167], v[236:239]
    ds_read_b64_tr_b16 v[86:87], v51 offset:20480
    s_waitcnt lgkmcnt(8)
    v_mfma_f32_16x16x32_bf16 v[192:195], v[64:67], v[168:171], v[192:195]
    ds_read_b64_tr_b16 v[88:89], v52 offset:16384
    v_mfma_f32_16x16x32_bf16 v[224:227], v[64:67], v[172:175], v[224:227]
    ds_read_b64_tr_b16 v[90:91], v52 offset:20480
    v_mfma_f32_16x16x32_bf16 v[196:199], v[68:71], v[168:171], v[196:199]
    ds_read_b64_tr_b16 v[92:93], v53 offset:16384
    v_mfma_f32_16x16x32_bf16 v[228:231], v[68:71], v[172:175], v[228:231]
    ds_read_b64_tr_b16 v[94:95], v53 offset:20480
    s_waitcnt lgkmcnt(8)
    v_mfma_f32_16x16x32_bf16 v[200:203], v[72:75], v[168:171], v[200:203]
    ds_read_b64_tr_b16 v[64:65], v50 offset:24576
    v_mfma_f32_16x16x32_bf16 v[232:235], v[72:75], v[172:175], v[232:235]
    ds_read_b64_tr_b16 v[66:67], v50 offset:28672
    v_mfma_f32_16x16x32_bf16 v[204:207], v[76:79], v[168:171], v[204:207]
    ds_read_b64_tr_b16 v[68:69], v51 offset:24576
    v_mfma_f32_16x16x32_bf16 v[236:239], v[76:79], v[172:175], v[236:239]
    ds_read_b64_tr_b16 v[70:71], v51 offset:28672
    s_waitcnt lgkmcnt(8)
    s_waitcnt vmcnt(2)
    v_mfma_f32_16x16x32_bf16 v[192:195], v[80:83], v[176:179], v[192:195]
    ds_read_b64_tr_b16 v[72:73], v52 offset:24576
    v_mfma_f32_16x16x32_bf16 v[224:227], v[80:83], v[180:183], v[224:227]
    ds_read_b64_tr_b16 v[74:75], v52 offset:28672
    v_mfma_f32_16x16x32_bf16 v[196:199], v[84:87], v[176:179], v[196:199]
    ds_read_b64_tr_b16 v[76:77], v53 offset:24576
    v_mfma_f32_16x16x32_bf16 v[228:231], v[84:87], v[180:183], v[228:231]
    ds_read_b64_tr_b16 v[78:79], v53 offset:28672
    s_waitcnt lgkmcnt(8)
    v_mfma_f32_16x16x32_bf16 v[200:203], v[88:91], v[176:179], v[200:203]
    ds_read_b64_tr_b16 v[80:81], v54 offset:8192
    v_mfma_f32_16x16x32_bf16 v[232:235], v[88:91], v[180:183], v[232:235]
    ds_read_b64_tr_b16 v[82:83], v54 offset:12288
    v_mfma_f32_16x16x32_bf16 v[204:207], v[92:95], v[176:179], v[204:207]
    ds_read_b64_tr_b16 v[84:85], v55 offset:8192
    v_mfma_f32_16x16x32_bf16 v[236:239], v[92:95], v[180:183], v[236:239]
    ds_read_b64_tr_b16 v[86:87], v55 offset:12288
    s_waitcnt lgkmcnt(8)
    s_waitcnt vmcnt(0)
    v_mfma_f32_16x16x32_bf16 v[192:195], v[64:67], v[184:187], v[192:195]
    ds_read_b64_tr_b16 v[88:89], v56 offset:8192
    v_mfma_f32_16x16x32_bf16 v[224:227], v[64:67], v[188:191], v[224:227]
    ds_read_b64_tr_b16 v[90:91], v56 offset:12288
    v_mfma_f32_16x16x32_bf16 v[196:199], v[68:71], v[184:187], v[196:199]
    ds_read_b64_tr_b16 v[92:93], v57 offset:8192
    v_mfma_f32_16x16x32_bf16 v[228:231], v[68:71], v[188:191], v[228:231]
    ds_read_b64_tr_b16 v[94:95], v57 offset:12288
    s_waitcnt lgkmcnt(8)
    v_mfma_f32_16x16x32_bf16 v[200:203], v[72:75], v[184:187], v[200:203]
    ds_read_b64_tr_b16 v[64:65], v54 offset:16384
    v_mfma_f32_16x16x32_bf16 v[232:235], v[72:75], v[188:191], v[232:235]
    ds_read_b64_tr_b16 v[66:67], v54 offset:20480
    v_mfma_f32_16x16x32_bf16 v[204:207], v[76:79], v[184:187], v[204:207]
    ds_read_b64_tr_b16 v[68:69], v55 offset:16384
    v_mfma_f32_16x16x32_bf16 v[236:239], v[76:79], v[188:191], v[236:239]
    ds_read_b64_tr_b16 v[70:71], v55 offset:20480
    s_waitcnt lgkmcnt(8)
    v_mfma_f32_16x16x32_bf16 v[208:211], v[80:83], v[136:139], v[208:211]
    ds_read_b64_tr_b16 v[72:73], v56 offset:16384
    v_mfma_f32_16x16x32_bf16 v[240:243], v[80:83], v[140:143], v[240:243]
    ds_read_b64_tr_b16 v[74:75], v56 offset:20480
    v_mfma_f32_16x16x32_bf16 v[212:215], v[84:87], v[136:139], v[212:215]
    ds_read_b64_tr_b16 v[76:77], v57 offset:16384
    ds_write_b128 v20, v[224:227] offset:0
    v_mfma_f32_16x16x32_bf16 v[244:247], v[84:87], v[140:143], v[244:247]
    ds_read_b64_tr_b16 v[78:79], v57 offset:20480
    ds_write_b128 v20, v[228:231] offset:1024
    s_waitcnt lgkmcnt(10)
    v_mfma_f32_16x16x32_bf16 v[216:219], v[88:91], v[136:139], v[216:219]
    ds_read_b64_tr_b16 v[80:81], v54 offset:24576
    ds_write_b128 v20, v[232:235] offset:2048
    v_mfma_f32_16x16x32_bf16 v[248:251], v[88:91], v[140:143], v[248:251]
    ds_read_b64_tr_b16 v[82:83], v54 offset:28672
    v_xor_b32 v54, 65536, v54
    ds_write_b128 v20, v[236:239] offset:3072
    v_mfma_f32_16x16x32_bf16 v[220:223], v[92:95], v[136:139], v[220:223]
    ds_read_b64_tr_b16 v[84:85], v55 offset:24576
    v_mfma_f32_16x16x32_bf16 v[252:255], v[92:95], v[140:143], v[252:255]
    ds_read_b64_tr_b16 v[86:87], v55 offset:28672
    v_xor_b32 v55, 65536, v55
    s_waitcnt lgkmcnt(12)
    v_mfma_f32_16x16x32_bf16 v[208:211], v[64:67], v[144:147], v[208:211]
    ds_read_b64_tr_b16 v[88:89], v56 offset:24576
    v_mfma_f32_16x16x32_bf16 v[240:243], v[64:67], v[148:151], v[240:243]
    ds_read_b64_tr_b16 v[90:91], v56 offset:28672
    v_xor_b32 v56, 65536, v56
    v_mfma_f32_16x16x32_bf16 v[212:215], v[68:71], v[144:147], v[212:215]
    ds_read_b64_tr_b16 v[92:93], v57 offset:24576
    s_waitcnt lgkmcnt(5)
    s_barrier
    v_mfma_f32_16x16x32_bf16 v[244:247], v[68:71], v[148:151], v[244:247]
    ds_read_b64_tr_b16 v[94:95], v57 offset:28672
    v_xor_b32 v57, 65536, v57
    ds_read_b128 v[224:227], v21 offset:0
    ds_read_b128 v[228:231], v21 offset:1024
    v_mfma_f32_16x16x32_bf16 v[216:219], v[72:75], v[144:147], v[216:219]
    ds_read_b64_tr_b16 v[64:65], v54 offset:0
    ds_read_b128 v[232:235], v21 offset:2048
    ds_read_b128 v[236:239], v21 offset:3072
    v_mfma_f32_16x16x32_bf16 v[248:251], v[72:75], v[148:151], v[248:251]
    ds_read_b64_tr_b16 v[66:67], v54 offset:4096
    v_mfma_f32_16x16x32_bf16 v[220:223], v[76:79], v[144:147], v[220:223]
    ds_read_b64_tr_b16 v[68:69], v55 offset:0
    v_mfma_f32_16x16x32_bf16 v[252:255], v[76:79], v[148:151], v[252:255]
    ds_read_b64_tr_b16 v[70:71], v55 offset:4096
    s_waitcnt lgkmcnt(12)
    v_mfma_f32_16x16x32_bf16 v[208:211], v[80:83], v[152:155], v[208:211]
    ds_read_b64_tr_b16 v[72:73], v56 offset:0
    s_waitcnt lgkmcnt(8)
    v_add_f32 v192, v192, v224
    v_add_f32 v193, v193, v225
    v_mfma_f32_16x16x32_bf16 v[240:243], v[80:83], v[156:159], v[240:243]
    ds_read_b64_tr_b16 v[74:75], v56 offset:4096
    v_add_f32 v194, v194, v226
    v_add_f32 v195, v195, v227
    buffer_store_dwordx4 v[192:195], v18, s[24:27], s41 offen offset:0 sc1
    v_mfma_f32_16x16x32_bf16 v[212:215], v[84:87], v[152:155], v[212:215]
    ds_read_b64_tr_b16 v[76:77], v57 offset:0
    s_waitcnt lgkmcnt(9)
    v_add_f32 v196, v196, v228
    v_add_f32 v197, v197, v229
    v_mfma_f32_16x16x32_bf16 v[244:247], v[84:87], v[156:159], v[244:247]
    ds_read_b64_tr_b16 v[78:79], v57 offset:4096
    v_add_f32 v198, v198, v230
    v_add_f32 v199, v199, v231
    buffer_store_dwordx4 v[196:199], v18, s[24:27], s41 offen offset:1024 sc1
    v_mfma_f32_16x16x32_bf16 v[216:219], v[88:91], v[152:155], v[216:219]
    ds_read_b64_tr_b16 v[80:81], v54 offset:8192
    s_waitcnt lgkmcnt(9)
    v_add_f32 v200, v200, v232
    v_add_f32 v201, v201, v233
    v_mfma_f32_16x16x32_bf16 v[248:251], v[88:91], v[156:159], v[248:251]
    ds_read_b64_tr_b16 v[82:83], v54 offset:12288
    v_add_f32 v202, v202, v234
    v_add_f32 v203, v203, v235
    buffer_store_dwordx4 v[200:203], v18, s[24:27], s41 offen offset:2048 sc1
    v_mfma_f32_16x16x32_bf16 v[220:223], v[92:95], v[152:155], v[220:223]
    ds_read_b64_tr_b16 v[84:85], v55 offset:8192
    s_waitcnt lgkmcnt(10)
    v_add_f32 v204, v204, v236
    v_add_f32 v205, v205, v237
    v_mfma_f32_16x16x32_bf16 v[252:255], v[92:95], v[156:159], v[252:255]
    ds_read_b64_tr_b16 v[86:87], v55 offset:12288
    v_add_f32 v206, v206, v238
    v_add_f32 v207, v207, v239
    buffer_store_dwordx4 v[204:207], v18, s[24:27], s41 offen offset:3072 sc1
    s_waitcnt lgkmcnt(8)
    v_mfma_f32_16x16x32_bf16 v[208:211], v[64:67], v[160:163], v[208:211]
    ds_read_b64_tr_b16 v[88:89], v56 offset:8192
    v_mfma_f32_16x16x32_bf16 v[240:243], v[64:67], v[164:167], v[240:243]
    ds_read_b64_tr_b16 v[90:91], v56 offset:12288
    v_mfma_f32_16x16x32_bf16 v[212:215], v[68:71], v[160:163], v[212:215]
    ds_read_b64_tr_b16 v[92:93], v57 offset:8192
    v_mfma_f32_16x16x32_bf16 v[244:247], v[68:71], v[164:167], v[244:247]
    ds_read_b64_tr_b16 v[94:95], v57 offset:12288
    s_waitcnt lgkmcnt(8)
    v_mfma_f32_16x16x32_bf16 v[216:219], v[72:75], v[160:163], v[216:219]
    ds_read_b64_tr_b16 v[64:65], v54 offset:16384
    v_mfma_f32_16x16x32_bf16 v[248:251], v[72:75], v[164:167], v[248:251]
    ds_read_b64_tr_b16 v[66:67], v54 offset:20480
    v_mfma_f32_16x16x32_bf16 v[220:223], v[76:79], v[160:163], v[220:223]
    ds_read_b64_tr_b16 v[68:69], v55 offset:16384
    v_mfma_f32_16x16x32_bf16 v[252:255], v[76:79], v[164:167], v[252:255]
    ds_read_b64_tr_b16 v[70:71], v55 offset:20480
    s_waitcnt lgkmcnt(8)
    v_mfma_f32_16x16x32_bf16 v[208:211], v[80:83], v[168:171], v[208:211]
    ds_read_b64_tr_b16 v[72:73], v56 offset:16384
    v_mfma_f32_16x16x32_bf16 v[240:243], v[80:83], v[172:175], v[240:243]
    ds_read_b64_tr_b16 v[74:75], v56 offset:20480
    v_mfma_f32_16x16x32_bf16 v[212:215], v[84:87], v[168:171], v[212:215]
    ds_read_b64_tr_b16 v[76:77], v57 offset:16384
    v_mfma_f32_16x16x32_bf16 v[244:247], v[84:87], v[172:175], v[244:247]
    ds_read_b64_tr_b16 v[78:79], v57 offset:20480
    s_waitcnt lgkmcnt(8)
    v_mfma_f32_16x16x32_bf16 v[216:219], v[88:91], v[168:171], v[216:219]
    ds_read_b64_tr_b16 v[80:81], v54 offset:24576
    v_mfma_f32_16x16x32_bf16 v[248:251], v[88:91], v[172:175], v[248:251]
    ds_read_b64_tr_b16 v[82:83], v54 offset:28672
    v_mfma_f32_16x16x32_bf16 v[220:223], v[92:95], v[168:171], v[220:223]
    ds_read_b64_tr_b16 v[84:85], v55 offset:24576
    v_mfma_f32_16x16x32_bf16 v[252:255], v[92:95], v[172:175], v[252:255]
    ds_read_b64_tr_b16 v[86:87], v55 offset:28672
    s_waitcnt lgkmcnt(8)
    v_mfma_f32_16x16x32_bf16 v[208:211], v[64:67], v[176:179], v[208:211]
    ds_read_b64_tr_b16 v[88:89], v56 offset:24576
    v_mfma_f32_16x16x32_bf16 v[240:243], v[64:67], v[180:183], v[240:243]
    ds_read_b64_tr_b16 v[90:91], v56 offset:28672
    v_mfma_f32_16x16x32_bf16 v[212:215], v[68:71], v[176:179], v[212:215]
    ds_read_b64_tr_b16 v[92:93], v57 offset:24576
    v_mfma_f32_16x16x32_bf16 v[244:247], v[68:71], v[180:183], v[244:247]
    ds_read_b64_tr_b16 v[94:95], v57 offset:28672
    s_waitcnt lgkmcnt(8)
    v_mfma_f32_16x16x32_bf16 v[216:219], v[72:75], v[176:179], v[216:219]
    v_mfma_f32_16x16x32_bf16 v[248:251], v[72:75], v[180:183], v[248:251]
    v_mfma_f32_16x16x32_bf16 v[220:223], v[76:79], v[176:179], v[220:223]
    v_mfma_f32_16x16x32_bf16 v[252:255], v[76:79], v[180:183], v[252:255]
    s_waitcnt lgkmcnt(4)
    v_mfma_f32_16x16x32_bf16 v[208:211], v[80:83], v[184:187], v[208:211]
    v_mfma_f32_16x16x32_bf16 v[240:243], v[80:83], v[188:191], v[240:243]
    v_mfma_f32_16x16x32_bf16 v[212:215], v[84:87], v[184:187], v[212:215]
    s_lshr_b32 s36, s28, 2
    s_lshl_b32 s36, s36, 15
    s_and_b32 s37, s28, 3
    v_mfma_f32_16x16x32_bf16 v[244:247], v[84:87], v[188:191], v[244:247]
    s_lshl_b32 s37, s37, 12
    s_add_u32 s36, s36, s37
    s_add_u32 s36, s36, 65536
    s_waitcnt lgkmcnt(0)
    v_mfma_f32_16x16x32_bf16 v[216:219], v[88:91], v[184:187], v[216:219]
    v_add_u32 v20, s36, v22
    v_xor_b32 v21, 32768, v20
    v_mfma_f32_16x16x32_bf16 v[248:251], v[88:91], v[188:191], v[248:251]
    v_mfma_f32_16x16x32_bf16 v[220:223], v[92:95], v[184:187], v[220:223]
    v_mfma_f32_16x16x32_bf16 v[252:255], v[92:95], v[188:191], v[252:255]
    s_waitcnt vmcnt(0)
    v_mov_b32 v4, s40
    v_mov_b32 v13, 1
    s_mov_b64 exec, 1
    global_atomic_add v4, v13, s[90:91]
    s_mov_b64 exec, -1
    s_nop 3
    s_nop 4
    ds_write_b128 v20, v[240:243] offset:0
    ds_write_b128 v20, v[244:247] offset:1024
    ds_write_b128 v20, v[248:251] offset:2048
    ds_write_b128 v20, v[252:255] offset:3072
    v_lshlrev_b32 v96, 16, v40
    v_and_b32 v97, 0xffff0000, v40
    v_sub_f32 v112, v96, v48
    v_sub_f32 v113, v97, v48
    v_cvt_pk_bf16_f32 v10, v112, v113
    v_lshlrev_b32 v112, 16, v10
    v_and_b32 v113, 0xffff0000, v10
    v_mul_f32 v112, v112, v49
    v_mul_f32 v113, v113, v49
    v_cvt_pk_bf16_f32 v10, v112, v113
    v_lshlrev_b32 v112, 16, v10
    v_and_b32 v113, 0xffff0000, v10
    v_mul_f32 v11, 0xbfb8aa3b, v112
    v_mul_f32 v12, 0xbfb8aa3b, v113
    v_exp_f32 v11, v11
    v_exp_f32 v12, v12
    s_nop 0
    v_add_f32 v11, 1.0, v11
    v_add_f32 v12, 1.0, v12
    v_rcp_f32 v11, v11
    v_rcp_f32 v12, v12
    s_nop 0
    v_mul_f32 v112, v112, v11
    v_mul_f32 v113, v113, v12
    v_cvt_pk_bf16_f32 v10, v112, v113
    v_lshlrev_b32 v112, 16, v10
    v_and_b32 v113, 0xffff0000, v10
    v_lshlrev_b32 v98, 16, v41
    v_and_b32 v99, 0xffff0000, v41
    v_sub_f32 v114, v98, v48
    v_sub_f32 v115, v99, v48
    v_cvt_pk_bf16_f32 v10, v114, v115
    v_lshlrev_b32 v114, 16, v10
    v_and_b32 v115, 0xffff0000, v10
    v_mul_f32 v114, v114, v49
    v_mul_f32 v115, v115, v49
    v_cvt_pk_bf16_f32 v10, v114, v115
    v_lshlrev_b32 v114, 16, v10
    v_and_b32 v115, 0xffff0000, v10
    v_mul_f32 v11, 0xbfb8aa3b, v114
    v_mul_f32 v12, 0xbfb8aa3b, v115
    v_exp_f32 v11, v11
    v_exp_f32 v12, v12
    s_nop 0
    v_add_f32 v11, 1.0, v11
    v_add_f32 v12, 1.0, v12
    v_rcp_f32 v11, v11
    v_rcp_f32 v12, v12
    s_nop 0
    v_mul_f32 v114, v114, v11
    v_mul_f32 v115, v115, v12
    v_cvt_pk_bf16_f32 v10, v114, v115
    v_lshlrev_b32 v114, 16, v10
    v_and_b32 v115, 0xffff0000, v10
    v_lshlrev_b32 v100, 16, v42
    v_and_b32 v101, 0xffff0000, v42
    v_sub_f32 v116, v100, v48
    v_sub_f32 v117, v101, v48
    v_cvt_pk_bf16_f32 v10, v116, v117
    v_lshlrev_b32 v116, 16, v10
    v_and_b32 v117, 0xffff0000, v10
    v_mul_f32 v116, v116, v49
    v_mul_f32 v117, v117, v49
    v_cvt_pk_bf16_f32 v10, v116, v117
    v_lshlrev_b32 v116, 16, v10
    v_and_b32 v117, 0xffff0000, v10
    v_mul_f32 v11, 0xbfb8aa3b, v116
    v_mul_f32 v12, 0xbfb8aa3b, v117
    v_exp_f32 v11, v11
    v_exp_f32 v12, v12
    s_nop 0
    v_add_f32 v11, 1.0, v11
    v_add_f32 v12, 1.0, v12
    v_rcp_f32 v11, v11
    v_rcp_f32 v12, v12
    s_nop 0
    v_mul_f32 v116, v116, v11
    v_mul_f32 v117, v117, v12
    v_cvt_pk_bf16_f32 v10, v116, v117
    v_lshlrev_b32 v116, 16, v10
    v_and_b32 v117, 0xffff0000, v10
    v_lshlrev_b32 v102, 16, v43
    v_and_b32 v103, 0xffff0000, v43
    v_sub_f32 v118, v102, v48
    v_sub_f32 v119, v103, v48
    v_cvt_pk_bf16_f32 v10, v118, v119
    v_lshlrev_b32 v118, 16, v10
    v_and_b32 v119, 0xffff0000, v10
    v_mul_f32 v118, v118, v49
    v_mul_f32 v119, v119, v49
    v_cvt_pk_bf16_f32 v10, v118, v119
    v_lshlrev_b32 v118, 16, v10
    v_and_b32 v119, 0xffff0000, v10
    v_mul_f32 v11, 0xbfb8aa3b, v118
    v_mul_f32 v12, 0xbfb8aa3b, v119
    v_exp_f32 v11, v11
    v_exp_f32 v12, v12
    s_nop 0
    v_add_f32 v11, 1.0, v11
    v_add_f32 v12, 1.0, v12
    v_rcp_f32 v11, v11
    v_rcp_f32 v12, v12
    s_nop 0
    v_mul_f32 v118, v118, v11
    v_mul_f32 v119, v119, v12
    v_cvt_pk_bf16_f32 v10, v118, v119
    v_lshlrev_b32 v118, 16, v10
    v_and_b32 v119, 0xffff0000, v10
    s_cmp_eq_u32 s28, 3
    s_cbranch_scc1 L_recurrent_scan__compressed_kv_cla__moe_arch_mod__prompt_kernel_rare_172
L_recurrent_scan__compressed_kv_cla__moe_arch_mod__prompt_kernel_back_173:
    s_waitcnt lgkmcnt(0)
    s_barrier
    buffer_load_dwordx4 v[64:67], v18, s[24:27], s39 offen offset:0 sc1
    buffer_load_dwordx4 v[68:71], v18, s[24:27], s39 offen offset:1024 sc1
    buffer_load_dwordx4 v[72:75], v18, s[24:27], s39 offen offset:2048 sc1
    buffer_load_dwordx4 v[76:79], v18, s[24:27], s39 offen offset:3072 sc1
    ds_read_b128 v[128:131], v21 offset:0
    ds_read_b128 v[132:135], v21 offset:1024
    ds_read_b128 v[136:139], v21 offset:2048
    ds_read_b128 v[140:143], v21 offset:3072
    s_waitcnt lgkmcnt(3)
    v_pk_add_f32 v[128:129], v[128:129], v[208:209]
    v_pk_add_f32 v[130:131], v[130:131], v[210:211]
    s_waitcnt lgkmcnt(2)
    v_pk_add_f32 v[132:133], v[132:133], v[212:213]
    v_pk_add_f32 v[134:135], v[134:135], v[214:215]
    s_waitcnt lgkmcnt(1)
    v_pk_add_f32 v[136:137], v[136:137], v[216:217]
    v_pk_add_f32 v[138:139], v[138:139], v[218:219]
    s_waitcnt lgkmcnt(0)
    v_pk_add_f32 v[140:141], v[140:141], v[220:221]
    v_pk_add_f32 v[142:143], v[142:143], v[222:223]
    v_lshlrev_b32 v104, 16, v44
    v_and_b32 v105, 0xffff0000, v44
    v_sub_f32 v120, v104, v48
    v_sub_f32 v121, v105, v48
    v_cvt_pk_bf16_f32 v10, v120, v121
    v_lshlrev_b32 v120, 16, v10
    v_and_b32 v121, 0xffff0000, v10
    v_mul_f32 v120, v120, v49
    v_mul_f32 v121, v121, v49
    v_cvt_pk_bf16_f32 v10, v120, v121
    v_lshlrev_b32 v120, 16, v10
    v_and_b32 v121, 0xffff0000, v10
    v_mul_f32 v11, 0xbfb8aa3b, v120
    v_mul_f32 v12, 0xbfb8aa3b, v121
    v_exp_f32 v11, v11
    v_exp_f32 v12, v12
    s_nop 0
    v_add_f32 v11, 1.0, v11
    v_add_f32 v12, 1.0, v12
    v_rcp_f32 v11, v11
    v_rcp_f32 v12, v12
    s_nop 0
    v_mul_f32 v120, v120, v11
    v_mul_f32 v121, v121, v12
    v_cvt_pk_bf16_f32 v10, v120, v121
    v_lshlrev_b32 v120, 16, v10
    v_and_b32 v121, 0xffff0000, v10
    v_lshlrev_b32 v106, 16, v45
    v_and_b32 v107, 0xffff0000, v45
    v_sub_f32 v122, v106, v48
    v_sub_f32 v123, v107, v48
    v_cvt_pk_bf16_f32 v10, v122, v123
    v_lshlrev_b32 v122, 16, v10
    v_and_b32 v123, 0xffff0000, v10
    v_mul_f32 v122, v122, v49
    v_mul_f32 v123, v123, v49
    v_cvt_pk_bf16_f32 v10, v122, v123
    v_lshlrev_b32 v122, 16, v10
    v_and_b32 v123, 0xffff0000, v10
    v_mul_f32 v11, 0xbfb8aa3b, v122
    v_mul_f32 v12, 0xbfb8aa3b, v123
    v_exp_f32 v11, v11
    v_exp_f32 v12, v12
    s_nop 0
    v_add_f32 v11, 1.0, v11
    v_add_f32 v12, 1.0, v12
    v_rcp_f32 v11, v11
    v_rcp_f32 v12, v12
    s_nop 0
    v_mul_f32 v122, v122, v11
    v_mul_f32 v123, v123, v12
    v_cvt_pk_bf16_f32 v10, v122, v123
    v_lshlrev_b32 v122, 16, v10
    v_and_b32 v123, 0xffff0000, v10
    v_lshlrev_b32 v108, 16, v46
    v_and_b32 v109, 0xffff0000, v46
    v_sub_f32 v124, v108, v48
    v_sub_f32 v125, v109, v48
    v_cvt_pk_bf16_f32 v10, v124, v125
    v_lshlrev_b32 v124, 16, v10
    v_and_b32 v125, 0xffff0000, v10
    v_mul_f32 v124, v124, v49
    v_mul_f32 v125, v125, v49
    v_cvt_pk_bf16_f32 v10, v124, v125
    v_lshlrev_b32 v124, 16, v10
    v_and_b32 v125, 0xffff0000, v10
    v_mul_f32 v11, 0xbfb8aa3b, v124
    v_mul_f32 v12, 0xbfb8aa3b, v125
    v_exp_f32 v11, v11
    v_exp_f32 v12, v12
    s_nop 0
    v_add_f32 v11, 1.0, v11
    v_add_f32 v12, 1.0, v12
    v_rcp_f32 v11, v11
    v_rcp_f32 v12, v12
    s_nop 0
    v_mul_f32 v124, v124, v11
    v_mul_f32 v125, v125, v12
    v_cvt_pk_bf16_f32 v10, v124, v125
    v_lshlrev_b32 v124, 16, v10
    v_and_b32 v125, 0xffff0000, v10
    v_lshlrev_b32 v110, 16, v47
    v_and_b32 v111, 0xffff0000, v47
    v_sub_f32 v126, v110, v48
    v_sub_f32 v127, v111, v48
    v_cvt_pk_bf16_f32 v10, v126, v127
    v_lshlrev_b32 v126, 16, v10
    v_and_b32 v127, 0xffff0000, v10
    v_mul_f32 v126, v126, v49
    v_mul_f32 v127, v127, v49
    v_cvt_pk_bf16_f32 v10, v126, v127
    v_lshlrev_b32 v126, 16, v10
    v_and_b32 v127, 0xffff0000, v10
    v_mul_f32 v11, 0xbfb8aa3b, v126
    v_mul_f32 v12, 0xbfb8aa3b, v127
    v_exp_f32 v11, v11
    v_exp_f32 v12, v12
    s_nop 0
    v_add_f32 v11, 1.0, v11
    v_add_f32 v12, 1.0, v12
    v_rcp_f32 v11, v11
    v_rcp_f32 v12, v12
    s_nop 0
    v_mul_f32 v126, v126, v11
    v_mul_f32 v127, v127, v12
    v_cvt_pk_bf16_f32 v10, v126, v127
    v_lshlrev_b32 v126, 16, v10
    v_and_b32 v127, 0xffff0000, v10
    s_sub_u32 s36, s56, s38
    s_sub_u32 s37, s57, s38
    s_min_u32 s36, s36, s37
    s_cmp_lt_u32 s36, 16
    s_cbranch_scc1 L_recurrent_scan__compressed_kv_cla__moe_arch_mod__prompt_kernel_rare_174
L_recurrent_scan__compressed_kv_cla__moe_arch_mod__prompt_kernel_back_175:
    s_waitcnt vmcnt(3)
    v_pk_add_f32 v[128:129], v[128:129], v[64:65]
    v_cvt_pk_bf16_f32 v23, v128, v129
    v_lshlrev_b32 v128, 16, v23
    v_and_b32 v129, 0xffff0000, v23
    v_pk_mul_f32 v[128:129], v[128:129], v[112:113]
    v_cvt_pk_bf16_f32 v23, v128, v129
    v_lshlrev_b32 v128, 16, v23
    v_and_b32 v129, 0xffff0000, v23
    v_pk_add_f32 v[128:129], v[128:129], v[96:97]
    v_cvt_pk_bf16_f32 v80, v128, v129
    v_pk_add_f32 v[130:131], v[130:131], v[66:67]
    v_cvt_pk_bf16_f32 v23, v130, v131
    v_lshlrev_b32 v130, 16, v23
    v_and_b32 v131, 0xffff0000, v23
    v_pk_mul_f32 v[130:131], v[130:131], v[114:115]
    v_cvt_pk_bf16_f32 v23, v130, v131
    v_lshlrev_b32 v130, 16, v23
    v_and_b32 v131, 0xffff0000, v23
    v_pk_add_f32 v[130:131], v[130:131], v[98:99]
    v_cvt_pk_bf16_f32 v81, v130, v131
    ds_write_b64 v17, v[80:81] offset:0
    s_waitcnt vmcnt(2)
    v_pk_add_f32 v[132:133], v[132:133], v[68:69]
    v_cvt_pk_bf16_f32 v23, v132, v133
    v_lshlrev_b32 v132, 16, v23
    v_and_b32 v133, 0xffff0000, v23
    v_pk_mul_f32 v[132:133], v[132:133], v[116:117]
    v_cvt_pk_bf16_f32 v23, v132, v133
    v_lshlrev_b32 v132, 16, v23
    v_and_b32 v133, 0xffff0000, v23
    v_pk_add_f32 v[132:133], v[132:133], v[100:101]
    v_cvt_pk_bf16_f32 v82, v132, v133
    v_pk_add_f32 v[134:135], v[134:135], v[70:71]
    v_cvt_pk_bf16_f32 v23, v134, v135
    v_lshlrev_b32 v134, 16, v23
    v_and_b32 v135, 0xffff0000, v23
    v_pk_mul_f32 v[134:135], v[134:135], v[118:119]
    v_cvt_pk_bf16_f32 v23, v134, v135
    v_lshlrev_b32 v134, 16, v23
    v_and_b32 v135, 0xffff0000, v23
    v_pk_add_f32 v[134:135], v[134:135], v[102:103]
    v_cvt_pk_bf16_f32 v83, v134, v135
    ds_write_b64 v17, v[82:83] offset:32
    s_waitcnt vmcnt(1)
    v_pk_add_f32 v[136:137], v[136:137], v[72:73]
    v_cvt_pk_bf16_f32 v23, v136, v137
    v_lshlrev_b32 v136, 16, v23
    v_and_b32 v137, 0xffff0000, v23
    v_pk_mul_f32 v[136:137], v[136:137], v[120:121]
    v_cvt_pk_bf16_f32 v23, v136, v137
    v_lshlrev_b32 v136, 16, v23
    v_and_b32 v137, 0xffff0000, v23
    v_pk_add_f32 v[136:137], v[136:137], v[104:105]
    v_cvt_pk_bf16_f32 v84, v136, v137
    v_pk_add_f32 v[138:139], v[138:139], v[74:75]
    v_cvt_pk_bf16_f32 v23, v138, v139
    v_lshlrev_b32 v138, 16, v23
    v_and_b32 v139, 0xffff0000, v23
    v_pk_mul_f32 v[138:139], v[138:139], v[122:123]
    v_cvt_pk_bf16_f32 v23, v138, v139
    v_lshlrev_b32 v138, 16, v23
    v_and_b32 v139, 0xffff0000, v23
    v_pk_add_f32 v[138:139], v[138:139], v[106:107]
    v_cvt_pk_bf16_f32 v85, v138, v139
    ds_write_b64 v17, v[84:85] offset:64
    s_waitcnt vmcnt(0)
    v_pk_add_f32 v[140:141], v[140:141], v[76:77]
    v_cvt_pk_bf16_f32 v23, v140, v141
    v_lshlrev_b32 v140, 16, v23
    v_and_b32 v141, 0xffff0000, v23
    v_pk_mul_f32 v[140:141], v[140:141], v[124:125]
    v_cvt_pk_bf16_f32 v23, v140, v141
    v_lshlrev_b32 v140, 16, v23
    v_and_b32 v141, 0xffff0000, v23
    v_pk_add_f32 v[140:141], v[140:141], v[108:109]
    v_cvt_pk_bf16_f32 v86, v140, v141
    v_pk_add_f32 v[142:143], v[142:143], v[78:79]
    v_cvt_pk_bf16_f32 v23, v142, v143
    v_lshlrev_b32 v142, 16, v23
    v_and_b32 v143, 0xffff0000, v23
    v_pk_mul_f32 v[142:143], v[142:143], v[126:127]
    v_cvt_pk_bf16_f32 v23, v142, v143
    v_lshlrev_b32 v142, 16, v23
    v_and_b32 v143, 0xffff0000, v23
    v_pk_add_f32 v[142:143], v[142:143], v[110:111]
    v_cvt_pk_bf16_f32 v87, v142, v143
    ds_write_b64 v17, v[86:87] offset:96
    v_add_u32 v22, s42, v22
    s_mov_b32 s36, 16384
    s_waitcnt lgkmcnt(0)
    ds_read_b128 v[64:67], v22
    ds_read_b128 v[68:71], v22 offset:1024
    s_waitcnt lgkmcnt(1)
    buffer_store_dwordx4 v[64:67], v15, s[20:23], 0 offen sc1
    s_waitcnt lgkmcnt(0)
    buffer_store_dwordx4 v[68:71], v15, s[20:23], s36 offen sc1
    s_endpgm
L_recurrent_scan__compressed_kv_cla__moe_arch_mod__prompt_kernel_rare_134:
    v_mov_b32 v26, s40
    v_mov_b32 v28, 1
    v_writelane_b32 v26, s41, 1
    s_mov_b64 exec, 3
    global_atomic_add v26, v28, s[90:91]
    s_mov_b64 exec, -1
    s_branch L_recurrent_scan__compressed_kv_cla__moe_arch_mod__prompt_kernel_back_135
L_recurrent_scan__compressed_kv_cla__moe_arch_mod__prompt_kernel_rt1_rare_3:
    s_mov_b32 s61, 0x40000
L_recurrent_scan__compressed_kv_cla__moe_arch_mod__prompt_kernel_rt1_spin_1:
    s_sub_u32 s61, s61, 1
    s_cbranch_scc1 L_recurrent_scan__compressed_kv_cla__moe_arch_mod__prompt_kernel_rt1_spinx_2
    s_sleep 1
    global_load_dword v61, v60, s[90:91] sc1
    s_waitcnt vmcnt(0)
    v_readfirstlane_b32 s36, v61
    s_nop 0
    s_cmp_lt_u32 s36, 16
    s_cbranch_scc1 L_recurrent_scan__compressed_kv_cla__moe_arch_mod__prompt_kernel_rt1_spin_1
L_recurrent_scan__compressed_kv_cla__moe_arch_mod__prompt_kernel_rt1_spinx_2:
    s_branch L_recurrent_scan__compressed_kv_cla__moe_arch_mod__prompt_kernel_rt1_back_4
L_recurrent_scan__compressed_kv_cla__moe_arch_mod__prompt_kernel_rare_144:
    s_cmp_eq_u32 s35, 1
    s_cbranch_scc0 L_recurrent_scan__compressed_kv_cla__moe_arch_mod__prompt_kernel_swn_143
    s_cmp_eq_u32 s28, 0
    s_cbranch_scc0 L_recurrent_scan__compressed_kv_cla__moe_arch_mod__prompt_kernel_g_137
    s_and_b32 s36, s2, 15
    s_add_u32 s36, s36, 96
    s_lshl_b32 s36, s36, 7
    v_mov_b32 v26, s36
    v_mov_b32 v27, 1
    s_mov_b64 exec, 1
    global_atomic_add v26, v27, s[90:91]
    s_mov_b64 exec, -1
    s_nop 3
L_recurrent_scan__compressed_kv_cla__moe_arch_mod__prompt_kernel_g_137:
    s_branch L_recurrent_scan__compressed_kv_cla__moe_arch_mod__prompt_kernel_swend_142
L_recurrent_scan__compressed_kv_cla__moe_arch_mod__prompt_kernel_swn_143:
    s_sub_u32 s36, s56, s38
    s_sub_u32 s37, s57, s38
    s_min_u32 s36, s36, s37
    s_cmp_lt_u32 s36, 16
    s_cbranch_scc0 L_recurrent_scan__compressed_kv_cla__moe_arch_mod__prompt_kernel_nrt_138
    s_add_u32 s36, s30, 96
    s_lshl_b32 s36, s36, 7
    v_mov_b32 v60, s36
    global_load_dword v61, v60, s[90:91] sc1
L_recurrent_scan__compressed_kv_cla__moe_arch_mod__prompt_kernel_nrt_138:
    s_mov_b32 m0, s42
    s_mov_b32 s36, 15360
    buffer_load_dwordx4 v15, s[16:19], 0 offen lds
    buffer_load_dwordx4 v15, s[16:19], s36 offen offset:1024 lds
    s_mov_b32 s36, 4194304
    buffer_load_dwordx2 v[48:49], v16, s[24:27], s36 offen sc1
L_recurrent_scan__compressed_kv_cla__moe_arch_mod__prompt_kernel_swend_142:
    s_branch L_recurrent_scan__compressed_kv_cla__moe_arch_mod__prompt_kernel_back_145
L_recurrent_scan__compressed_kv_cla__moe_arch_mod__prompt_kernel_rare_147:
    s_cmp_eq_u32 s28, 0
    s_cbranch_scc0 L_recurrent_scan__compressed_kv_cla__moe_arch_mod__prompt_kernel_g_141
    s_mov_b32 s43, s38
    s_getpc_b64 s[36:37]
L_recurrent_scan__compressed_kv_cla__moe_arch_mod__prompt_kernel_pc_140:
    s_sub_u32 s36, s36, L_recurrent_scan__compressed_kv_cla__moe_arch_mod__prompt_kernel_pc_140-L_pc
    s_subb_u32 s37, s37, 0
    s_lshr_b32 s38, s2, 3
    s_lshl_b32 s38, s38, 7
    v_lshl_add_u32 v4, v1, 12, s38
    v_min_u32 v4, L_end-L_pc-4, v4
    v_mov_b32 v5, s37
    v_add_co_u32 v4, vcc, s36, v4
    s_mov_b64 exec, 0xffff
    s_nop 0
    v_addc_co_u32 v5, vcc, 0, v5, vcc
    global_load_dword v63, v[4:5], off
    s_mov_b64 exec, -1
    s_nop 1
    s_mov_b32 s38, s43
L_recurrent_scan__compressed_kv_cla__moe_arch_mod__prompt_kernel_g_141:
    s_sub_u32 s36, s56, s38
    s_sub_u32 s37, s57, s38
    s_min_u32 s36, s36, s37
    s_cmp_lt_u32 s36, 16
    s_cbranch_scc0 L_recurrent_scan__compressed_kv_cla__moe_arch_mod__prompt_kernel_nrt_139
    s_waitcnt vmcnt(16)
    v_readfirstlane_b32 s36, v61
    s_nop 0
    s_cmp_lt_u32 s36, 16
    s_cbranch_scc1 L_recurrent_scan__compressed_kv_cla__moe_arch_mod__prompt_kernel_rt1_rare_3
L_recurrent_scan__compressed_kv_cla__moe_arch_mod__prompt_kernel_rt1_back_4:
    s_lshl_b32 s37, s30, 8
    s_add_u32 s36, s37, 59768832
    s_add_u32 s37, s36, 4096
    v_and_b32 v60, 15, v1
    v_lshlrev_b32 v60, 13, v60
    v_lshl_add_u32 v60, v19, 4, v60
    buffer_load_dwordx4 v[96:99], v60, s[24:27], s36 offen offset:0 sc1
    buffer_load_dwordx4 v[100:103], v60, s[24:27], s36 offen offset:64 sc1
    buffer_load_dwordx4 v[104:107], v60, s[24:27], s36 offen offset:128 sc1
    buffer_load_dwordx4 v[108:111], v60, s[24:27], s36 offen offset:192 sc1
    buffer_load_dwordx4 v[112:115], v60, s[24:27], s37 offen offset:0 sc1
    buffer_load_dwordx4 v[116:119], v60, s[24:27], s37 offen offset:64 sc1
    buffer_load_dwordx4 v[120:123], v60, s[24:27], s37 offen offset:128 sc1
    buffer_load_dwordx4 v[124:127], v60, s[24:27], s37 offen offset:192 sc1
L_recurrent_scan__compressed_kv_cla__moe_arch_mod__prompt_kernel_nrt_139:
L_recurrent_scan__compressed_kv_cla__moe_arch_mod__prompt_kernel_swend_146:
    s_branch L_recurrent_scan__compressed_kv_cla__moe_arch_mod__prompt_kernel_back_148
L_recurrent_scan__compressed_kv_cla__moe_arch_mod__prompt_kernel_rare_149:
    global_load_dword v59, v58, s[90:91] sc1
    s_branch L_recurrent_scan__compressed_kv_cla__moe_arch_mod__prompt_kernel_back_150
L_recurrent_scan__compressed_kv_cla__moe_arch_mod__prompt_kernel_rare_159:
    s_cmp_eq_u32 s35, 0
    s_cbranch_scc0 L_recurrent_scan__compressed_kv_cla__moe_arch_mod__prompt_kernel_swn_158
    s_mov_b32 s61, 0x40000
    s_waitcnt vmcnt(7)
    s_branch L_recurrent_scan__compressed_kv_cla__moe_arch_mod__prompt_kernel_cchk_153
L_recurrent_scan__compressed_kv_cla__moe_arch_mod__prompt_kernel_cspin_151:
    s_sub_u32 s61, s61, 1
    s_cbranch_scc1 L_recurrent_scan__compressed_kv_cla__moe_arch_mod__prompt_kernel_cspinx_152
    global_load_dword v59, v58, s[90:91] sc1
    s_waitcnt vmcnt(0)
L_recurrent_scan__compressed_kv_cla__moe_arch_mod__prompt_kernel_cchk_153:
    v_cmp_le_u32 vcc, 4, v59
    s_nop 0
    s_and_b32 s60, vcc_lo, 15
    s_and_b32 s36, s60, 7
    s_cmp_eq_u32 s36, 7
    s_cbranch_scc1 L_recurrent_scan__compressed_kv_cla__moe_arch_mod__prompt_kernel_cspinx_152
    s_sleep 6
    s_branch L_recurrent_scan__compressed_kv_cla__moe_arch_mod__prompt_kernel_cspin_151
L_recurrent_scan__compressed_kv_cla__moe_arch_mod__prompt_kernel_cspinx_152:
    s_branch L_recurrent_scan__compressed_kv_cla__moe_arch_mod__prompt_kernel_swend_157
L_recurrent_scan__compressed_kv_cla__moe_arch_mod__prompt_kernel_swn_158:
    s_mov_b32 s61, 0x40000
    s_waitcnt vmcnt(7)
    s_branch L_recurrent_scan__compressed_kv_cla__moe_arch_mod__prompt_kernel_cchk_156
L_recurrent_scan__compressed_kv_cla__moe_arch_mod__prompt_kernel_cspin_154:
    s_sub_u32 s61, s61, 1
    s_cbranch_scc1 L_recurrent_scan__compressed_kv_cla__moe_arch_mod__prompt_kernel_cspinx_155
    global_load_dword v59, v58, s[90:91] sc1
    s_waitcnt vmcnt(0)
L_recurrent_scan__compressed_kv_cla__moe_arch_mod__prompt_kernel_cchk_156:
    v_cmp_le_u32 vcc, 4, v59
    s_nop 0
    s_and_b32 s60, vcc_lo, 15
    s_and_b32 s36, s60, 15
    s_cmp_eq_u32 s36, 15
    s_cbranch_scc1 L_recurrent_scan__compressed_kv_cla__moe_arch_mod__prompt_kernel_cspinx_155
    s_sleep 6
    s_branch L_recurrent_scan__compressed_kv_cla__moe_arch_mod__prompt_kernel_cspin_154
L_recurrent_scan__compressed_kv_cla__moe_arch_mod__prompt_kernel_cspinx_155:
L_recurrent_scan__compressed_kv_cla__moe_arch_mod__prompt_kernel_swend_157:
    s_branch L_recurrent_scan__compressed_kv_cla__moe_arch_mod__prompt_kernel_back_160
L_recurrent_scan__compressed_kv_cla__moe_arch_mod__prompt_kernel_f2m_161:
    v_lshrrev_b32 v28, 4, v1
    v_bfe_u32 v26, v1, 2, 2
    v_lshl_add_u32 v26, v28, 3, v26
    v_lshlrev_b32 v26, 7, v26
    v_and_b32 v27, 3, v1
    v_lshl_add_u32 v26, v27, 3, v26
    v_bfe_u32 v27, v1, 3, 2
    s_lshl_b32 s36, s28, 12
    s_add_u32 s36, s36, 131072
    v_add_u32 v26, s36, v26
    v_xor_b32 v28, 0, v27
    v_lshl_add_u32 v28, v28, 5, v26
    ds_read_b64_tr_b16 v[112:113], v28 offset:0
    ds_read_b64_tr_b16 v[114:115], v28 offset:512
    v_xor_b32 v28, 1, v27
    v_lshl_add_u32 v28, v28, 5, v26
    ds_read_b64_tr_b16 v[116:117], v28 offset:0
    ds_read_b64_tr_b16 v[118:119], v28 offset:512
    v_xor_b32 v28, 2, v27
    v_lshl_add_u32 v28, v28, 5, v26
    ds_read_b64_tr_b16 v[120:121], v28 offset:0
    ds_read_b64_tr_b16 v[122:123], v28 offset:512
    v_xor_b32 v28, 3, v27
    v_lshl_add_u32 v28, v28, 5, v26
    ds_read_b64_tr_b16 v[124:125], v28 offset:0
    ds_read_b64_tr_b16 v[126:127], v28 offset:512
    v_add_f32_dpp v96, v96, v96 row_ror:4 row_mask:0xf bank_mask:0xf
    v_add_f32_dpp v97, v97, v97 row_ror:4 row_mask:0xf bank_mask:0xf
    v_add_f32_dpp v98, v98, v98 row_ror:4 row_mask:0xf bank_mask:0xf
    v_add_f32_dpp v99, v99, v99 row_ror:4 row_mask:0xf bank_mask:0xf
    v_add_f32_dpp v100, v100, v100 row_ror:4 row_mask:0xf bank_mask:0xf
    v_add_f32_dpp v101, v101, v101 row_ror:4 row_mask:0xf bank_mask:0xf
    v_add_f32_dpp v102, v102, v102 row_ror:4 row_mask:0xf bank_mask:0xf
    v_add_f32_dpp v103, v103, v103 row_ror:4 row_mask:0xf bank_mask:0xf
    v_add_f32_dpp v96, v96, v96 row_ror:8 row_mask:0xf bank_mask:0xf
    v_add_f32_dpp v97, v97, v97 row_ror:8 row_mask:0xf bank_mask:0xf
    v_add_f32_dpp v98, v98, v98 row_ror:8 row_mask:0xf bank_mask:0xf
    v_add_f32_dpp v99, v99, v99 row_ror:8 row_mask:0xf bank_mask:0xf
    v_add_f32_dpp v100, v100, v100 row_ror:8 row_mask:0xf bank_mask:0xf
    v_add_f32_dpp v101, v101, v101 row_ror:8 row_mask:0xf bank_mask:0xf
    v_add_f32_dpp v102, v102, v102 row_ror:8 row_mask:0xf bank_mask:0xf
    v_add_f32_dpp v103, v103, v103 row_ror:8 row_mask:0xf bank_mask:0xf
    v_cvt_pk_bf16_f32 v29, v96, v97
    v_lshlrev_b32 v96, 16, v29
    v_and_b32 v97, 0xffff0000, v29
    v_cvt_pk_bf16_f32 v29, v98, v99
    v_lshlrev_b32 v98, 16, v29
    v_and_b32 v99, 0xffff0000, v29
    v_cvt_pk_bf16_f32 v29, v100, v101
    v_lshlrev_b32 v100, 16, v29
    v_and_b32 v101, 0xffff0000, v29
    v_cvt_pk_bf16_f32 v29, v102, v103
    v_lshlrev_b32 v102, 16, v29
    v_and_b32 v103, 0xffff0000, v29
    v_mul_f32 v104, 0xbfb8aa3b, v96
    v_mul_f32 v105, 0xbfb8aa3b, v97
    v_mul_f32 v106, 0xbfb8aa3b, v98
    v_mul_f32 v107, 0xbfb8aa3b, v99
    v_mul_f32 v108, 0xbfb8aa3b, v100
    v_mul_f32 v109, 0xbfb8aa3b, v101
    v_mul_f32 v110, 0xbfb8aa3b, v102
    v_mul_f32 v111, 0xbfb8aa3b, v103
    v_exp_f32 v104, v104
    v_exp_f32 v105, v105
    v_exp_f32 v106, v106
    v_exp_f32 v107, v107
    v_exp_f32 v108, v108
    v_exp_f32 v109, v109
    v_exp_f32 v110, v110
    v_exp_f32 v111, v111
    v_add_f32 v104, 1.0, v104
    v_add_f32 v105, 1.0, v105
    v_add_f32 v106, 1.0, v106
    v_add_f32 v107, 1.0, v107
    v_add_f32 v108, 1.0, v108
    v_add_f32 v109, 1.0, v109
    v_add_f32 v110, 1.0, v110
    v_add_f32 v111, 1.0, v111
    v_rcp_f32 v104, v104
    v_rcp_f32 v105, v105
    v_rcp_f32 v106, v106
    v_rcp_f32 v107, v107
    v_rcp_f32 v108, v108
    v_rcp_f32 v109, v109
    v_rcp_f32 v110, v110
    v_rcp_f32 v111, v111
    v_mul_f32 v104, v96, v104
    v_mul_f32 v105, v97, v105
    v_mul_f32 v106, v98, v106
    v_mul_f32 v107, v99, v107
    v_mul_f32 v108, v100, v108
    v_mul_f32 v109, v101, v109
    v_mul_f32 v110, v102, v110
    v_mul_f32 v111, v103, v111
    v_cvt_pk_bf16_f32 v29, v104, v105
    v_lshlrev_b32 v104, 16, v29
    v_and_b32 v105, 0xffff0000, v29
    v_cvt_pk_bf16_f32 v29, v106, v107
    v_lshlrev_b32 v106, 16, v29
    v_and_b32 v107, 0xffff0000, v29
    v_cvt_pk_bf16_f32 v29, v108, v109
    v_lshlrev_b32 v108, 16, v29
    v_and_b32 v109, 0xffff0000, v29
    v_cvt_pk_bf16_f32 v29, v110, v111
    v_lshlrev_b32 v110, 16, v29
    v_and_b32 v111, 0xffff0000, v29
    v_mul_f32_dpp v96, v96, v104 quad_perm:[2,3,0,1] row_mask:0xf bank_mask:0xf
    v_mul_f32_dpp v97, v97, v105 quad_perm:[2,3,0,1] row_mask:0xf bank_mask:0xf
    v_mul_f32_dpp v98, v98, v106 quad_perm:[2,3,0,1] row_mask:0xf bank_mask:0xf
    v_mul_f32_dpp v99, v99, v107 quad_perm:[2,3,0,1] row_mask:0xf bank_mask:0xf
    v_mul_f32_dpp v100, v100, v108 quad_perm:[2,3,0,1] row_mask:0xf bank_mask:0xf
    v_mul_f32_dpp v101, v101, v109 quad_perm:[2,3,0,1] row_mask:0xf bank_mask:0xf
    v_mul_f32_dpp v102, v102, v110 quad_perm:[2,3,0,1] row_mask:0xf bank_mask:0xf
    v_mul_f32_dpp v103, v103, v111 quad_perm:[2,3,0,1] row_mask:0xf bank_mask:0xf
    v_cvt_pk_bf16_f32 v36, v96, v97
    v_cvt_pk_bf16_f32 v37, v98, v99
    v_cvt_pk_bf16_f32 v38, v100, v101
    v_cvt_pk_bf16_f32 v39, v102, v103
    s_waitcnt lgkmcnt(0)
    v_lshl_add_u32 v28, v1, 4, s36
    v_mfma_f32_16x16x32_bf16 v[96:99], v[112:115], v[36:39], 0
    v_mfma_f32_16x16x32_bf16 v[100:103], v[116:119], v[36:39], 0
    v_mfma_f32_16x16x32_bf16 v[104:107], v[120:123], v[36:39], 0
    v_mfma_f32_16x16x32_bf16 v[108:111], v[124:127], v[36:39], 0
    s_nop 7
    ds_write_b128 v28, v[96:99] offset:0
    ds_write_b128 v28, v[100:103] offset:1024
    ds_write_b128 v28, v[104:107] offset:2048
    ds_write_b128 v28, v[108:111] offset:3072
    s_cmp_lt_u32 s28, 4
    s_cbranch_scc1 L_recurrent_scan__compressed_kv_cla__moe_arch_mod__prompt_kernel_f2b_163
    s_branch L_recurrent_scan__compressed_kv_cla__moe_arch_mod__prompt_kernel_f2a_162
L_recurrent_scan__compressed_kv_cla__moe_arch_mod__prompt_kernel_rare_168:
    v_mov_b64 v[24:25], 0
    v_mov_b64 v[26:27], 0
    v_mov_b64 v[28:29], 0
    v_mov_b64 v[30:31], 0
    v_mov_b64 v[32:33], 0
    v_mov_b64 v[34:35], 0
    v_mov_b64 v[36:37], 0
    v_mov_b64 v[38:39], 0
    s_waitcnt vmcnt(16)
    s_sub_u32 s36, s56, s38
    s_cmp_lt_u32 s36, 16
    s_cbranch_scc0 L_recurrent_scan__compressed_kv_cla__moe_arch_mod__prompt_kernel_rt2_noy_1
    s_and_b32 s36, s58, 0xffff0000
    s_cmp_lt_i32 s36, 0
    s_cselect_b32 s37, 0x80000000, -1
    s_xor_b32 s36, s36, s37
    s_and_b32 s36, s36, 0xffff0000
    v_mov_b32 v62, s36
    v_mul_f32 v62, 0xbfb8aa3b, v62
    v_exp_f32 v62, v62
    s_nop 0
    v_add_f32 v62, 1.0, v62
    v_rcp_f32 v62, v62
    s_nop 0
    v_cvt_pk_bf16_f32 v62, v62, v62
    v_lshlrev_b32 v62, 16, v62
    v_add_f32_dpp v96, v96, v96 quad_perm:[1,0,3,2] row_mask:0xf bank_mask:0xf
    v_add_f32_dpp v97, v97, v97 quad_perm:[1,0,3,2] row_mask:0xf bank_mask:0xf
    v_add_f32_dpp v98, v98, v98 quad_perm:[1,0,3,2] row_mask:0xf bank_mask:0xf
    v_add_f32_dpp v99, v99, v99 quad_perm:[1,0,3,2] row_mask:0xf bank_mask:0xf
    v_add_f32_dpp v100, v100, v100 quad_perm:[1,0,3,2] row_mask:0xf bank_mask:0xf
    v_add_f32_dpp v101, v101, v101 quad_perm:[1,0,3,2] row_mask:0xf bank_mask:0xf
    v_add_f32_dpp v102, v102, v102 quad_perm:[1,0,3,2] row_mask:0xf bank_mask:0xf
    v_add_f32_dpp v103, v103, v103 quad_perm:[1,0,3,2] row_mask:0xf bank_mask:0xf
    v_add_f32_dpp v104, v104, v104 quad_perm:[1,0,3,2] row_mask:0xf bank_mask:0xf
    v_add_f32_dpp v105, v105, v105 quad_perm:[1,0,3,2] row_mask:0xf bank_mask:0xf
    v_add_f32_dpp v106, v106, v106 quad_perm:[1,0,3,2] row_mask:0xf bank_mask:0xf
    v_add_f32_dpp v107, v107, v107 quad_perm:[1,0,3,2] row_mask:0xf bank_mask:0xf
    v_add_f32_dpp v108, v108, v108 quad_perm:[1,0,3,2] row_mask:0xf bank_mask:0xf
    v_add_f32_dpp v109, v109, v109 quad_perm:[1,0,3,2] row_mask:0xf bank_mask:0xf
    v_add_f32_dpp v110, v110, v110 quad_perm:[1,0,3,2] row_mask:0xf bank_mask:0xf
    v_add_f32_dpp v111, v111, v111 quad_perm:[1,0,3,2] row_mask:0xf bank_mask:0xf
    v_add_f32_dpp v96, v96, v96 quad_perm:[2,3,0,1] row_mask:0xf bank_mask:0xf
    v_add_f32_dpp v97, v97, v97 quad_perm:[2,3,0,1] row_mask:0xf bank_mask:0xf
    v_add_f32_dpp v98, v98, v98 quad_perm:[2,3,0,1] row_mask:0xf bank_mask:0xf
    v_add_f32_dpp v99, v99, v99 quad_perm:[2,3,0,1] row_mask:0xf bank_mask:0xf
    v_add_f32_dpp v100, v100, v100 quad_perm:[2,3,0,1] row_mask:0xf bank_mask:0xf
    v_add_f32_dpp v101, v101, v101 quad_perm:[2,3,0,1] row_mask:0xf bank_mask:0xf
    v_add_f32_dpp v102, v102, v102 quad_perm:[2,3,0,1] row_mask:0xf bank_mask:0xf
    v_add_f32_dpp v103, v103, v103 quad_perm:[2,3,0,1] row_mask:0xf bank_mask:0xf
    v_add_f32_dpp v104, v104, v104 quad_perm:[2,3,0,1] row_mask:0xf bank_mask:0xf
    v_add_f32_dpp v105, v105, v105 quad_perm:[2,3,0,1] row_mask:0xf bank_mask:0xf
    v_add_f32_dpp v106, v106, v106 quad_perm:[2,3,0,1] row_mask:0xf bank_mask:0xf
    v_add_f32_dpp v107, v107, v107 quad_perm:[2,3,0,1] row_mask:0xf bank_mask:0xf
    v_add_f32_dpp v108, v108, v108 quad_perm:[2,3,0,1] row_mask:0xf bank_mask:0xf
    v_add_f32_dpp v109, v109, v109 quad_perm:[2,3,0,1] row_mask:0xf bank_mask:0xf
    v_add_f32_dpp v110, v110, v110 quad_perm:[2,3,0,1] row_mask:0xf bank_mask:0xf
    v_add_f32_dpp v111, v111, v111 quad_perm:[2,3,0,1] row_mask:0xf bank_mask:0xf
    v_add_f32_dpp v96, v96, v96 row_half_mirror row_mask:0xf bank_mask:0xf
    v_add_f32_dpp v97, v97, v97 row_half_mirror row_mask:0xf bank_mask:0xf
    v_add_f32_dpp v98, v98, v98 row_half_mirror row_mask:0xf bank_mask:0xf
    v_add_f32_dpp v99, v99, v99 row_half_mirror row_mask:0xf bank_mask:0xf
    v_add_f32_dpp v100, v100, v100 row_half_mirror row_mask:0xf bank_mask:0xf
    v_add_f32_dpp v101, v101, v101 row_half_mirror row_mask:0xf bank_mask:0xf
    v_add_f32_dpp v102, v102, v102 row_half_mirror row_mask:0xf bank_mask:0xf
    v_add_f32_dpp v103, v103, v103 row_half_mirror row_mask:0xf bank_mask:0xf
    v_add_f32_dpp v104, v104, v104 row_half_mirror row_mask:0xf bank_mask:0xf
    v_add_f32_dpp v105, v105, v105 row_half_mirror row_mask:0xf bank_mask:0xf
    v_add_f32_dpp v106, v106, v106 row_half_mirror row_mask:0xf bank_mask:0xf
    v_add_f32_dpp v107, v107, v107 row_half_mirror row_mask:0xf bank_mask:0xf
    v_add_f32_dpp v108, v108, v108 row_half_mirror row_mask:0xf bank_mask:0xf
    v_add_f32_dpp v109, v109, v109 row_half_mirror row_mask:0xf bank_mask:0xf
    v_add_f32_dpp v110, v110, v110 row_half_mirror row_mask:0xf bank_mask:0xf
    v_add_f32_dpp v111, v111, v111 row_half_mirror row_mask:0xf bank_mask:0xf
    v_add_f32_dpp v96, v96, v96 row_mirror row_mask:0xf bank_mask:0xf
    v_add_f32_dpp v97, v97, v97 row_mirror row_mask:0xf bank_mask:0xf
    v_add_f32_dpp v98, v98, v98 row_mirror row_mask:0xf bank_mask:0xf
    v_add_f32_dpp v99, v99, v99 row_mirror row_mask:0xf bank_mask:0xf
    v_add_f32_dpp v100, v100, v100 row_mirror row_mask:0xf bank_mask:0xf
    v_add_f32_dpp v101, v101, v101 row_mirror row_mask:0xf bank_mask:0xf
    v_add_f32_dpp v102, v102, v102 row_mirror row_mask:0xf bank_mask:0xf
    v_add_f32_dpp v103, v103, v103 row_mirror row_mask:0xf bank_mask:0xf
    v_add_f32_dpp v104, v104, v104 row_mirror row_mask:0xf bank_mask:0xf
    v_add_f32_dpp v105, v105, v105 row_mirror row_mask:0xf bank_mask:0xf
    v_add_f32_dpp v106, v106, v106 row_mirror row_mask:0xf bank_mask:0xf
    v_add_f32_dpp v107, v107, v107 row_mirror row_mask:0xf bank_mask:0xf
    v_add_f32_dpp v108, v108, v108 row_mirror row_mask:0xf bank_mask:0xf
    v_add_f32_dpp v109, v109, v109 row_mirror row_mask:0xf bank_mask:0xf
    v_add_f32_dpp v110, v110, v110 row_mirror row_mask:0xf bank_mask:0xf
    v_add_f32_dpp v111, v111, v111 row_mirror row_mask:0xf bank_mask:0xf
    v_cmp_eq_u32 vcc, s56, v14
    v_cvt_pk_bf16_f32 v63, v96, v97
    v_lshlrev_b32 v96, 16, v63
    v_and_b32 v97, 0xffff0000, v63
    v_mul_f32 v96, v62, v96
    v_mul_f32 v97, v62, v97
    v_cvt_pk_bf16_f32 v63, v96, v97
    v_lshlrev_b32 v96, 16, v63
    v_and_b32 v97, 0xffff0000, v63
    v_cndmask_b32 v24, v24, v96, vcc
    v_cndmask_b32 v25, v25, v97, vcc
    v_cvt_pk_bf16_f32 v63, v98, v99
    v_lshlrev_b32 v98, 16, v63
    v_and_b32 v99, 0xffff0000, v63
    v_mul_f32 v98, v62, v98
    v_mul_f32 v99, v62, v99
    v_cvt_pk_bf16_f32 v63, v98, v99
    v_lshlrev_b32 v98, 16, v63
    v_and_b32 v99, 0xffff0000, v63
    v_cndmask_b32 v26, v26, v98, vcc
    v_cndmask_b32 v27, v27, v99, vcc
    v_cvt_pk_bf16_f32 v63, v100, v101
    v_lshlrev_b32 v100, 16, v63
    v_and_b32 v101, 0xffff0000, v63
    v_mul_f32 v100, v62, v100
    v_mul_f32 v101, v62, v101
    v_cvt_pk_bf16_f32 v63, v100, v101
    v_lshlrev_b32 v100, 16, v63
    v_and_b32 v101, 0xffff0000, v63
    v_cndmask_b32 v28, v28, v100, vcc
    v_cndmask_b32 v29, v29, v101, vcc
    v_cvt_pk_bf16_f32 v63, v102, v103
    v_lshlrev_b32 v102, 16, v63
    v_and_b32 v103, 0xffff0000, v63
    v_mul_f32 v102, v62, v102
    v_mul_f32 v103, v62, v103
    v_cvt_pk_bf16_f32 v63, v102, v103
    v_lshlrev_b32 v102, 16, v63
    v_and_b32 v103, 0xffff0000, v63
    v_cndmask_b32 v30, v30, v102, vcc
    v_cndmask_b32 v31, v31, v103, vcc
    v_cvt_pk_bf16_f32 v63, v104, v105
    v_lshlrev_b32 v104, 16, v63
    v_and_b32 v105, 0xffff0000, v63
    v_mul_f32 v104, v62, v104
    v_mul_f32 v105, v62, v105
    v_cvt_pk_bf16_f32 v63, v104, v105
    v_lshlrev_b32 v104, 16, v63
    v_and_b32 v105, 0xffff0000, v63
    v_cndmask_b32 v32, v32, v104, vcc
    v_cndmask_b32 v33, v33, v105, vcc
    v_cvt_pk_bf16_f32 v63, v106, v107
    v_lshlrev_b32 v106, 16, v63
    v_and_b32 v107, 0xffff0000, v63
    v_mul_f32 v106, v62, v106
    v_mul_f32 v107, v62, v107
    v_cvt_pk_bf16_f32 v63, v106, v107
    v_lshlrev_b32 v106, 16, v63
    v_and_b32 v107, 0xffff0000, v63
    v_cndmask_b32 v34, v34, v106, vcc
    v_cndmask_b32 v35, v35, v107, vcc
    v_cvt_pk_bf16_f32 v63, v108, v109
    v_lshlrev_b32 v108, 16, v63
    v_and_b32 v109, 0xffff0000, v63
    v_mul_f32 v108, v62, v108
    v_mul_f32 v109, v62, v109
    v_cvt_pk_bf16_f32 v63, v108, v109
    v_lshlrev_b32 v108, 16, v63
    v_and_b32 v109, 0xffff0000, v63
    v_cndmask_b32 v36, v36, v108, vcc
    v_cndmask_b32 v37, v37, v109, vcc
    v_cvt_pk_bf16_f32 v63, v110, v111
    v_lshlrev_b32 v110, 16, v63
    v_and_b32 v111, 0xffff0000, v63
    v_mul_f32 v110, v62, v110
    v_mul_f32 v111, v62, v111
    v_cvt_pk_bf16_f32 v63, v110, v111
    v_lshlrev_b32 v110, 16, v63
    v_and_b32 v111, 0xffff0000, v63
    v_cndmask_b32 v38, v38, v110, vcc
    v_cndmask_b32 v39, v39, v111, vcc
L_recurrent_scan__compressed_kv_cla__moe_arch_mod__prompt_kernel_rt2_noy_1:
    s_sub_u32 s36, s57, s38
    s_cmp_lt_u32 s36, 16
    s_cbranch_scc0 L_recurrent_scan__compressed_kv_cla__moe_arch_mod__prompt_kernel_rt2_noy_2
    s_and_b32 s36, s59, 0xffff0000
    s_cmp_lt_i32 s36, 0
    s_cselect_b32 s37, 0x80000000, -1
    s_xor_b32 s36, s36, s37
    s_and_b32 s36, s36, 0xffff0000
    v_mov_b32 v62, s36
    v_mul_f32 v62, 0xbfb8aa3b, v62
    v_exp_f32 v62, v62
    s_nop 0
    v_add_f32 v62, 1.0, v62
    v_rcp_f32 v62, v62
    s_nop 0
    v_cvt_pk_bf16_f32 v62, v62, v62
    v_lshlrev_b32 v62, 16, v62
    v_add_f32_dpp v112, v112, v112 quad_perm:[1,0,3,2] row_mask:0xf bank_mask:0xf
    v_add_f32_dpp v113, v113, v113 quad_perm:[1,0,3,2] row_mask:0xf bank_mask:0xf
    v_add_f32_dpp v114, v114, v114 quad_perm:[1,0,3,2] row_mask:0xf bank_mask:0xf
    v_add_f32_dpp v115, v115, v115 quad_perm:[1,0,3,2] row_mask:0xf bank_mask:0xf
    v_add_f32_dpp v116, v116, v116 quad_perm:[1,0,3,2] row_mask:0xf bank_mask:0xf
    v_add_f32_dpp v117, v117, v117 quad_perm:[1,0,3,2] row_mask:0xf bank_mask:0xf
    v_add_f32_dpp v118, v118, v118 quad_perm:[1,0,3,2] row_mask:0xf bank_mask:0xf
    v_add_f32_dpp v119, v119, v119 quad_perm:[1,0,3,2] row_mask:0xf bank_mask:0xf
    v_add_f32_dpp v120, v120, v120 quad_perm:[1,0,3,2] row_mask:0xf bank_mask:0xf
    v_add_f32_dpp v121, v121, v121 quad_perm:[1,0,3,2] row_mask:0xf bank_mask:0xf
    v_add_f32_dpp v122, v122, v122 quad_perm:[1,0,3,2] row_mask:0xf bank_mask:0xf
    v_add_f32_dpp v123, v123, v123 quad_perm:[1,0,3,2] row_mask:0xf bank_mask:0xf
    v_add_f32_dpp v124, v124, v124 quad_perm:[1,0,3,2] row_mask:0xf bank_mask:0xf
    v_add_f32_dpp v125, v125, v125 quad_perm:[1,0,3,2] row_mask:0xf bank_mask:0xf
    v_add_f32_dpp v126, v126, v126 quad_perm:[1,0,3,2] row_mask:0xf bank_mask:0xf
    v_add_f32_dpp v127, v127, v127 quad_perm:[1,0,3,2] row_mask:0xf bank_mask:0xf
    v_add_f32_dpp v112, v112, v112 quad_perm:[2,3,0,1] row_mask:0xf bank_mask:0xf
    v_add_f32_dpp v113, v113, v113 quad_perm:[2,3,0,1] row_mask:0xf bank_mask:0xf
    v_add_f32_dpp v114, v114, v114 quad_perm:[2,3,0,1] row_mask:0xf bank_mask:0xf
    v_add_f32_dpp v115, v115, v115 quad_perm:[2,3,0,1] row_mask:0xf bank_mask:0xf
    v_add_f32_dpp v116, v116, v116 quad_perm:[2,3,0,1] row_mask:0xf bank_mask:0xf
    v_add_f32_dpp v117, v117, v117 quad_perm:[2,3,0,1] row_mask:0xf bank_mask:0xf
    v_add_f32_dpp v118, v118, v118 quad_perm:[2,3,0,1] row_mask:0xf bank_mask:0xf
    v_add_f32_dpp v119, v119, v119 quad_perm:[2,3,0,1] row_mask:0xf bank_mask:0xf
    v_add_f32_dpp v120, v120, v120 quad_perm:[2,3,0,1] row_mask:0xf bank_mask:0xf
    v_add_f32_dpp v121, v121, v121 quad_perm:[2,3,0,1] row_mask:0xf bank_mask:0xf
    v_add_f32_dpp v122, v122, v122 quad_perm:[2,3,0,1] row_mask:0xf bank_mask:0xf
    v_add_f32_dpp v123, v123, v123 quad_perm:[2,3,0,1] row_mask:0xf bank_mask:0xf
    v_add_f32_dpp v124, v124, v124 quad_perm:[2,3,0,1] row_mask:0xf bank_mask:0xf
    v_add_f32_dpp v125, v125, v125 quad_perm:[2,3,0,1] row_mask:0xf bank_mask:0xf
    v_add_f32_dpp v126, v126, v126 quad_perm:[2,3,0,1] row_mask:0xf bank_mask:0xf
    v_add_f32_dpp v127, v127, v127 quad_perm:[2,3,0,1] row_mask:0xf bank_mask:0xf
    v_add_f32_dpp v112, v112, v112 row_half_mirror row_mask:0xf bank_mask:0xf
    v_add_f32_dpp v113, v113, v113 row_half_mirror row_mask:0xf bank_mask:0xf
    v_add_f32_dpp v114, v114, v114 row_half_mirror row_mask:0xf bank_mask:0xf
    v_add_f32_dpp v115, v115, v115 row_half_mirror row_mask:0xf bank_mask:0xf
    v_add_f32_dpp v116, v116, v116 row_half_mirror row_mask:0xf bank_mask:0xf
    v_add_f32_dpp v117, v117, v117 row_half_mirror row_mask:0xf bank_mask:0xf
    v_add_f32_dpp v118, v118, v118 row_half_mirror row_mask:0xf bank_mask:0xf
    v_add_f32_dpp v119, v119, v119 row_half_mirror row_mask:0xf bank_mask:0xf
    v_add_f32_dpp v120, v120, v120 row_half_mirror row_mask:0xf bank_mask:0xf
    v_add_f32_dpp v121, v121, v121 row_half_mirror row_mask:0xf bank_mask:0xf
    v_add_f32_dpp v122, v122, v122 row_half_mirror row_mask:0xf bank_mask:0xf
    v_add_f32_dpp v123, v123, v123 row_half_mirror row_mask:0xf bank_mask:0xf
    v_add_f32_dpp v124, v124, v124 row_half_mirror row_mask:0xf bank_mask:0xf
    v_add_f32_dpp v125, v125, v125 row_half_mirror row_mask:0xf bank_mask:0xf
    v_add_f32_dpp v126, v126, v126 row_half_mirror row_mask:0xf bank_mask:0xf
    v_add_f32_dpp v127, v127, v127 row_half_mirror row_mask:0xf bank_mask:0xf
    v_add_f32_dpp v112, v112, v112 row_mirror row_mask:0xf bank_mask:0xf
    v_add_f32_dpp v113, v113, v113 row_mirror row_mask:0xf bank_mask:0xf
    v_add_f32_dpp v114, v114, v114 row_mirror row_mask:0xf bank_mask:0xf
    v_add_f32_dpp v115, v115, v115 row_mirror row_mask:0xf bank_mask:0xf
    v_add_f32_dpp v116, v116, v116 row_mirror row_mask:0xf bank_mask:0xf
    v_add_f32_dpp v117, v117, v117 row_mirror row_mask:0xf bank_mask:0xf
    v_add_f32_dpp v118, v118, v118 row_mirror row_mask:0xf bank_mask:0xf
    v_add_f32_dpp v119, v119, v119 row_mirror row_mask:0xf bank_mask:0xf
    v_add_f32_dpp v120, v120, v120 row_mirror row_mask:0xf bank_mask:0xf
    v_add_f32_dpp v121, v121, v121 row_mirror row_mask:0xf bank_mask:0xf
    v_add_f32_dpp v122, v122, v122 row_mirror row_mask:0xf bank_mask:0xf
    v_add_f32_dpp v123, v123, v123 row_mirror row_mask:0xf bank_mask:0xf
    v_add_f32_dpp v124, v124, v124 row_mirror row_mask:0xf bank_mask:0xf
    v_add_f32_dpp v125, v125, v125 row_mirror row_mask:0xf bank_mask:0xf
    v_add_f32_dpp v126, v126, v126 row_mirror row_mask:0xf bank_mask:0xf
    v_add_f32_dpp v127, v127, v127 row_mirror row_mask:0xf bank_mask:0xf
    v_cmp_eq_u32 vcc, s57, v14
    v_cvt_pk_bf16_f32 v63, v112, v113
    v_lshlrev_b32 v112, 16, v63
    v_and_b32 v113, 0xffff0000, v63
    v_mul_f32 v112, v62, v112
    v_mul_f32 v113, v62, v113
    v_cvt_pk_bf16_f32 v63, v112, v113
    v_lshlrev_b32 v112, 16, v63
    v_and_b32 v113, 0xffff0000, v63
    v_cndmask_b32 v24, v24, v112, vcc
    v_cndmask_b32 v25, v25, v113, vcc
    v_cvt_pk_bf16_f32 v63, v114, v115
    v_lshlrev_b32 v114, 16, v63
    v_and_b32 v115, 0xffff0000, v63
    v_mul_f32 v114, v62, v114
    v_mul_f32 v115, v62, v115
    v_cvt_pk_bf16_f32 v63, v114, v115
    v_lshlrev_b32 v114, 16, v63
    v_and_b32 v115, 0xffff0000, v63
    v_cndmask_b32 v26, v26, v114, vcc
    v_cndmask_b32 v27, v27, v115, vcc
    v_cvt_pk_bf16_f32 v63, v116, v117
    v_lshlrev_b32 v116, 16, v63
    v_and_b32 v117, 0xffff0000, v63
    v_mul_f32 v116, v62, v116
    v_mul_f32 v117, v62, v117
    v_cvt_pk_bf16_f32 v63, v116, v117
    v_lshlrev_b32 v116, 16, v63
    v_and_b32 v117, 0xffff0000, v63
    v_cndmask_b32 v28, v28, v116, vcc
    v_cndmask_b32 v29, v29, v117, vcc
    v_cvt_pk_bf16_f32 v63, v118, v119
    v_lshlrev_b32 v118, 16, v63
    v_and_b32 v119, 0xffff0000, v63
    v_mul_f32 v118, v62, v118
    v_mul_f32 v119, v62, v119
    v_cvt_pk_bf16_f32 v63, v118, v119
    v_lshlrev_b32 v118, 16, v63
    v_and_b32 v119, 0xffff0000, v63
    v_cndmask_b32 v30, v30, v118, vcc
    v_cndmask_b32 v31, v31, v119, vcc
    v_cvt_pk_bf16_f32 v63, v120, v121
    v_lshlrev_b32 v120, 16, v63
    v_and_b32 v121, 0xffff0000, v63
    v_mul_f32 v120, v62, v120
    v_mul_f32 v121, v62, v121
    v_cvt_pk_bf16_f32 v63, v120, v121
    v_lshlrev_b32 v120, 16, v63
    v_and_b32 v121, 0xffff0000, v63
    v_cndmask_b32 v32, v32, v120, vcc
    v_cndmask_b32 v33, v33, v121, vcc
    v_cvt_pk_bf16_f32 v63, v122, v123
    v_lshlrev_b32 v122, 16, v63
    v_and_b32 v123, 0xffff0000, v63
    v_mul_f32 v122, v62, v122
    v_mul_f32 v123, v62, v123
    v_cvt_pk_bf16_f32 v63, v122, v123
    v_lshlrev_b32 v122, 16, v63
    v_and_b32 v123, 0xffff0000, v63
    v_cndmask_b32 v34, v34, v122, vcc
    v_cndmask_b32 v35, v35, v123, vcc
    v_cvt_pk_bf16_f32 v63, v124, v125
    v_lshlrev_b32 v124, 16, v63
    v_and_b32 v125, 0xffff0000, v63
    v_mul_f32 v124, v62, v124
    v_mul_f32 v125, v62, v125
    v_cvt_pk_bf16_f32 v63, v124, v125
    v_lshlrev_b32 v124, 16, v63
    v_and_b32 v125, 0xffff0000, v63
    v_cndmask_b32 v36, v36, v124, vcc
    v_cndmask_b32 v37, v37, v125, vcc
    v_cvt_pk_bf16_f32 v63, v126, v127
    v_lshlrev_b32 v126, 16, v63
    v_and_b32 v127, 0xffff0000, v63
    v_mul_f32 v126, v62, v126
    v_mul_f32 v127, v62, v127
    v_cvt_pk_bf16_f32 v63, v126, v127
    v_lshlrev_b32 v126, 16, v63
    v_and_b32 v127, 0xffff0000, v63
    v_cndmask_b32 v38, v38, v126, vcc
    v_cndmask_b32 v39, v39, v127, vcc
L_recurrent_scan__compressed_kv_cla__moe_arch_mod__prompt_kernel_rt2_noy_2:
    s_branch L_recurrent_scan__compressed_kv_cla__moe_arch_mod__prompt_kernel_back_169
L_recurrent_scan__compressed_kv_cla__moe_arch_mod__prompt_kernel_rare_172:
    s_mov_b32 s61, 0x40000
L_recurrent_scan__compressed_kv_cla__moe_arch_mod__prompt_kernel_spin_170:
    s_sub_u32 s61, s61, 1
    s_cbranch_scc1 L_recurrent_scan__compressed_kv_cla__moe_arch_mod__prompt_kernel_spinx_171
    s_sleep 1
    global_load_dword v23, v5, s[90:91] sc1
    s_waitcnt vmcnt(0)
    v_readfirstlane_b32 s36, v23
    s_nop 0
    s_cmp_lt_u32 s36, 8
    s_cbranch_scc1 L_recurrent_scan__compressed_kv_cla__moe_arch_mod__prompt_kernel_spin_170
L_recurrent_scan__compressed_kv_cla__moe_arch_mod__prompt_kernel_spinx_171:
    s_branch L_recurrent_scan__compressed_kv_cla__moe_arch_mod__prompt_kernel_back_173
L_recurrent_scan__compressed_kv_cla__moe_arch_mod__prompt_kernel_rare_174:
    v_lshlrev_b32 v96, 16, v40
    v_and_b32 v97, 0xffff0000, v40
    v_sub_f32 v112, v96, v48
    v_sub_f32 v113, v97, v48
    v_cvt_pk_bf16_f32 v10, v112, v113
    v_lshlrev_b32 v112, 16, v10
    v_and_b32 v113, 0xffff0000, v10
    v_mul_f32 v112, v112, v49
    v_mul_f32 v113, v113, v49
    v_cvt_pk_bf16_f32 v10, v112, v113
    v_lshlrev_b32 v112, 16, v10
    v_and_b32 v113, 0xffff0000, v10
    v_add_f32 v112, v112, v24
    v_add_f32 v113, v113, v25
    v_cvt_pk_bf16_f32 v10, v112, v113
    v_lshlrev_b32 v112, 16, v10
    v_and_b32 v113, 0xffff0000, v10
    v_mul_f32 v11, 0xbfb8aa3b, v112
    v_mul_f32 v12, 0xbfb8aa3b, v113
    v_exp_f32 v11, v11
    v_exp_f32 v12, v12
    s_nop 0
    v_add_f32 v11, 1.0, v11
    v_add_f32 v12, 1.0, v12
    v_rcp_f32 v11, v11
    v_rcp_f32 v12, v12
    s_nop 0
    v_mul_f32 v112, v112, v11
    v_mul_f32 v113, v113, v12
    v_cvt_pk_bf16_f32 v10, v112, v113
    v_lshlrev_b32 v112, 16, v10
    v_and_b32 v113, 0xffff0000, v10
    v_lshlrev_b32 v98, 16, v41
    v_and_b32 v99, 0xffff0000, v41
    v_sub_f32 v114, v98, v48
    v_sub_f32 v115, v99, v48
    v_cvt_pk_bf16_f32 v10, v114, v115
    v_lshlrev_b32 v114, 16, v10
    v_and_b32 v115, 0xffff0000, v10
    v_mul_f32 v114, v114, v49
    v_mul_f32 v115, v115, v49
    v_cvt_pk_bf16_f32 v10, v114, v115
    v_lshlrev_b32 v114, 16, v10
    v_and_b32 v115, 0xffff0000, v10
    v_add_f32 v114, v114, v26
    v_add_f32 v115, v115, v27
    v_cvt_pk_bf16_f32 v10, v114, v115
    v_lshlrev_b32 v114, 16, v10
    v_and_b32 v115, 0xffff0000, v10
    v_mul_f32 v11, 0xbfb8aa3b, v114
    v_mul_f32 v12, 0xbfb8aa3b, v115
    v_exp_f32 v11, v11
    v_exp_f32 v12, v12
    s_nop 0
    v_add_f32 v11, 1.0, v11
    v_add_f32 v12, 1.0, v12
    v_rcp_f32 v11, v11
    v_rcp_f32 v12, v12
    s_nop 0
    v_mul_f32 v114, v114, v11
    v_mul_f32 v115, v115, v12
    v_cvt_pk_bf16_f32 v10, v114, v115
    v_lshlrev_b32 v114, 16, v10
    v_and_b32 v115, 0xffff0000, v10
    v_lshlrev_b32 v100, 16, v42
    v_and_b32 v101, 0xffff0000, v42
    v_sub_f32 v116, v100, v48
    v_sub_f32 v117, v101, v48
    v_cvt_pk_bf16_f32 v10, v116, v117
    v_lshlrev_b32 v116, 16, v10
    v_and_b32 v117, 0xffff0000, v10
    v_mul_f32 v116, v116, v49
    v_mul_f32 v117, v117, v49
    v_cvt_pk_bf16_f32 v10, v116, v117
    v_lshlrev_b32 v116, 16, v10
    v_and_b32 v117, 0xffff0000, v10
    v_add_f32 v116, v116, v28
    v_add_f32 v117, v117, v29
    v_cvt_pk_bf16_f32 v10, v116, v117
    v_lshlrev_b32 v116, 16, v10
    v_and_b32 v117, 0xffff0000, v10
    v_mul_f32 v11, 0xbfb8aa3b, v116
    v_mul_f32 v12, 0xbfb8aa3b, v117
    v_exp_f32 v11, v11
    v_exp_f32 v12, v12
    s_nop 0
    v_add_f32 v11, 1.0, v11
    v_add_f32 v12, 1.0, v12
    v_rcp_f32 v11, v11
    v_rcp_f32 v12, v12
    s_nop 0
    v_mul_f32 v116, v116, v11
    v_mul_f32 v117, v117, v12
    v_cvt_pk_bf16_f32 v10, v116, v117
    v_lshlrev_b32 v116, 16, v10
    v_and_b32 v117, 0xffff0000, v10
    v_lshlrev_b32 v102, 16, v43
    v_and_b32 v103, 0xffff0000, v43
    v_sub_f32 v118, v102, v48
    v_sub_f32 v119, v103, v48
    v_cvt_pk_bf16_f32 v10, v118, v119
    v_lshlrev_b32 v118, 16, v10
    v_and_b32 v119, 0xffff0000, v10
    v_mul_f32 v118, v118, v49
    v_mul_f32 v119, v119, v49
    v_cvt_pk_bf16_f32 v10, v118, v119
    v_lshlrev_b32 v118, 16, v10
    v_and_b32 v119, 0xffff0000, v10
    v_add_f32 v118, v118, v30
    v_add_f32 v119, v119, v31
    v_cvt_pk_bf16_f32 v10, v118, v119
    v_lshlrev_b32 v118, 16, v10
    v_and_b32 v119, 0xffff0000, v10
    v_mul_f32 v11, 0xbfb8aa3b, v118
    v_mul_f32 v12, 0xbfb8aa3b, v119
    v_exp_f32 v11, v11
    v_exp_f32 v12, v12
    s_nop 0
    v_add_f32 v11, 1.0, v11
    v_add_f32 v12, 1.0, v12
    v_rcp_f32 v11, v11
    v_rcp_f32 v12, v12
    s_nop 0
    v_mul_f32 v118, v118, v11
    v_mul_f32 v119, v119, v12
    v_cvt_pk_bf16_f32 v10, v118, v119
    v_lshlrev_b32 v118, 16, v10
    v_and_b32 v119, 0xffff0000, v10
    v_lshlrev_b32 v104, 16, v44
    v_and_b32 v105, 0xffff0000, v44
    v_sub_f32 v120, v104, v48
    v_sub_f32 v121, v105, v48
    v_cvt_pk_bf16_f32 v10, v120, v121
    v_lshlrev_b32 v120, 16, v10
    v_and_b32 v121, 0xffff0000, v10
    v_mul_f32 v120, v120, v49
    v_mul_f32 v121, v121, v49
    v_cvt_pk_bf16_f32 v10, v120, v121
    v_lshlrev_b32 v120, 16, v10
    v_and_b32 v121, 0xffff0000, v10
    v_add_f32 v120, v120, v32
    v_add_f32 v121, v121, v33
    v_cvt_pk_bf16_f32 v10, v120, v121
    v_lshlrev_b32 v120, 16, v10
    v_and_b32 v121, 0xffff0000, v10
    v_mul_f32 v11, 0xbfb8aa3b, v120
    v_mul_f32 v12, 0xbfb8aa3b, v121
    v_exp_f32 v11, v11
    v_exp_f32 v12, v12
    s_nop 0
    v_add_f32 v11, 1.0, v11
    v_add_f32 v12, 1.0, v12
    v_rcp_f32 v11, v11
    v_rcp_f32 v12, v12
    s_nop 0
    v_mul_f32 v120, v120, v11
    v_mul_f32 v121, v121, v12
    v_cvt_pk_bf16_f32 v10, v120, v121
    v_lshlrev_b32 v120, 16, v10
    v_and_b32 v121, 0xffff0000, v10
    v_lshlrev_b32 v106, 16, v45
    v_and_b32 v107, 0xffff0000, v45
    v_sub_f32 v122, v106, v48
    v_sub_f32 v123, v107, v48
    v_cvt_pk_bf16_f32 v10, v122, v123
    v_lshlrev_b32 v122, 16, v10
    v_and_b32 v123, 0xffff0000, v10
    v_mul_f32 v122, v122, v49
    v_mul_f32 v123, v123, v49
    v_cvt_pk_bf16_f32 v10, v122, v123
    v_lshlrev_b32 v122, 16, v10
    v_and_b32 v123, 0xffff0000, v10
    v_add_f32 v122, v122, v34
    v_add_f32 v123, v123, v35
    v_cvt_pk_bf16_f32 v10, v122, v123
    v_lshlrev_b32 v122, 16, v10
    v_and_b32 v123, 0xffff0000, v10
    v_mul_f32 v11, 0xbfb8aa3b, v122
    v_mul_f32 v12, 0xbfb8aa3b, v123
    v_exp_f32 v11, v11
    v_exp_f32 v12, v12
    s_nop 0
    v_add_f32 v11, 1.0, v11
    v_add_f32 v12, 1.0, v12
    v_rcp_f32 v11, v11
    v_rcp_f32 v12, v12
    s_nop 0
    v_mul_f32 v122, v122, v11
    v_mul_f32 v123, v123, v12
    v_cvt_pk_bf16_f32 v10, v122, v123
    v_lshlrev_b32 v122, 16, v10
    v_and_b32 v123, 0xffff0000, v10
    v_lshlrev_b32 v108, 16, v46
    v_and_b32 v109, 0xffff0000, v46
    v_sub_f32 v124, v108, v48
    v_sub_f32 v125, v109, v48
    v_cvt_pk_bf16_f32 v10, v124, v125
    v_lshlrev_b32 v124, 16, v10
    v_and_b32 v125, 0xffff0000, v10
    v_mul_f32 v124, v124, v49
    v_mul_f32 v125, v125, v49
    v_cvt_pk_bf16_f32 v10, v124, v125
    v_lshlrev_b32 v124, 16, v10
    v_and_b32 v125, 0xffff0000, v10
    v_add_f32 v124, v124, v36
    v_add_f32 v125, v125, v37
    v_cvt_pk_bf16_f32 v10, v124, v125
    v_lshlrev_b32 v124, 16, v10
    v_and_b32 v125, 0xffff0000, v10
    v_mul_f32 v11, 0xbfb8aa3b, v124
    v_mul_f32 v12, 0xbfb8aa3b, v125
    v_exp_f32 v11, v11
    v_exp_f32 v12, v12
    s_nop 0
    v_add_f32 v11, 1.0, v11
    v_add_f32 v12, 1.0, v12
    v_rcp_f32 v11, v11
    v_rcp_f32 v12, v12
    s_nop 0
    v_mul_f32 v124, v124, v11
    v_mul_f32 v125, v125, v12
    v_cvt_pk_bf16_f32 v10, v124, v125
    v_lshlrev_b32 v124, 16, v10
    v_and_b32 v125, 0xffff0000, v10
    v_lshlrev_b32 v110, 16, v47
    v_and_b32 v111, 0xffff0000, v47
    v_sub_f32 v126, v110, v48
    v_sub_f32 v127, v111, v48
    v_cvt_pk_bf16_f32 v10, v126, v127
    v_lshlrev_b32 v126, 16, v10
    v_and_b32 v127, 0xffff0000, v10
    v_mul_f32 v126, v126, v49
    v_mul_f32 v127, v127, v49
    v_cvt_pk_bf16_f32 v10, v126, v127
    v_lshlrev_b32 v126, 16, v10
    v_and_b32 v127, 0xffff0000, v10
    v_add_f32 v126, v126, v38
    v_add_f32 v127, v127, v39
    v_cvt_pk_bf16_f32 v10, v126, v127
    v_lshlrev_b32 v126, 16, v10
    v_and_b32 v127, 0xffff0000, v10
    v_mul_f32 v11, 0xbfb8aa3b, v126
    v_mul_f32 v12, 0xbfb8aa3b, v127
    v_exp_f32 v11, v11
    v_exp_f32 v12, v12
    s_nop 0
    v_add_f32 v11, 1.0, v11
    v_add_f32 v12, 1.0, v12
    v_rcp_f32 v11, v11
    v_rcp_f32 v12, v12
    s_nop 0
    v_mul_f32 v126, v126, v11
    v_mul_f32 v127, v127, v12
    v_cvt_pk_bf16_f32 v10, v126, v127
    v_lshlrev_b32 v126, 16, v10
    v_and_b32 v127, 0xffff0000, v10
    s_branch L_recurrent_scan__compressed_kv_cla__moe_arch_mod__prompt_kernel_back_175
L_end:
    s_endpgm
.section .rodata,"a"
.p2align 6
.amdhsa_kernel recurrent_scan__compressed_kv_cla__moe_arch_mod__prompt_kernel
  .amdhsa_next_free_vgpr 256
  .amdhsa_next_free_sgpr 102
  .amdhsa_accum_offset 256
  .amdhsa_group_segment_fixed_size 0
  .amdhsa_kernarg_size 112
  .amdhsa_user_sgpr_count 2
  .amdhsa_user_sgpr_kernarg_segment_ptr 1
  .amdhsa_system_sgpr_workgroup_id_x 1
.end_amdhsa_kernel
```

```asm
; @launch kernel=recurrent_scan__compressed_kv_cla__moe_arch_mod__prompt_kernel grid=(256,1,1) block=(512,1,1) lds=163840
.amdgcn_target "amdgcn-amd-amdhsa--gfx950"
.text
.globl recurrent_scan__compressed_kv_cla__moe_arch_mod__prompt_kernel
.p2align 8
.type recurrent_scan__compressed_kv_cla__moe_arch_mod__prompt_kernel,@function
recurrent_scan__compressed_kv_cla__moe_arch_mod__prompt_kernel:
    s_cmp_ge_u32 s2, 256
    s_cbranch_scc1 L_end
    s_load_dwordx4 s[44:47], s[0:1], 0
    s_load_dwordx2 s[52:53], s[0:1], 56
    s_load_dwordx4 s[48:51], s[0:1], 24
    s_getpc_b64 s[36:37]
L_pc:
    s_lshr_b32 s38, s2, 3
    s_lshl_b32 s38, s38, 7
    v_lshl_add_u32 v16, v0, 12, s38
    v_cmp_gt_u32 vcc, L_end-L_pc-4, v16
    v_mov_b32 v17, s37
    s_and_b64 exec, exec, vcc
    s_cbranch_execz L_nocpf
    v_add_co_u32 v16, vcc, s36, v16
    s_nop 1
    v_addc_co_u32 v17, vcc, 0, v17, vcc
    global_load_dword v119, v[16:17], off
L_nocpf:
    s_mov_b64 exec, -1
    v_lshrrev_b32 v16, 6, v0
    v_and_b32 v1, 63, v0
    v_readfirstlane_b32 s28, v16
    v_lshlrev_b32 v116, 4, v1
    s_lshl_b32 s42, s2, 3
    s_cmp_lt_u32 s28, 4
    s_cbranch_scc1 L_nox
    s_add_u32 s43, s42, s28
    s_sub_u32 s42, s43, 4
    v_lshl_add_u32 v18, s42, 11, v116
    v_add_u32 v19, 8192, v18
    s_waitcnt lgkmcnt(0)
    global_load_dwordx4 v[20:23], v18, s[44:45]
    global_load_dwordx4 v[24:27], v18, s[44:45] offset:1024
    global_load_dwordx4 v[28:31], v19, s[44:45]
    global_load_dwordx4 v[32:35], v19, s[44:45] offset:1024
    global_load_dwordx4 v[36:39], v116, s[52:53]
    global_load_dwordx4 v[40:43], v116, s[52:53] offset:1024
    s_barrier
L_nox:
    s_load_dwordx4 s[88:91], s[0:1], 96
    s_load_dwordx4 s[92:95], s[0:1], 64
    s_load_dwordx2 s[96:97], s[0:1], 16
    s_and_b32 s29, s2, 7
    s_lshl_b32 s29, s29, 2
    s_lshr_b32 s29, 0x75643120, s29
    s_and_b32 s29, s29, 7
    s_lshl_b32 s29, s29, 2
    s_bfe_u32 s36, s2, 0x20003
    s_add_u32 s29, s29, s36
    s_lshr_b32 s30, s2, 5
    v_lshrrev_b32 v16, 3, v1
    s_lshl_b32 s36, s30, 8
    s_lshl_b32 s37, s28, 5
    s_add_u32 s36, s36, s37
    v_add_u32 v16, s36, v16
    v_lshlrev_b32 v16, 10, v16
    v_lshrrev_b32 v18, 4, v1
    v_and_b32 v19, 7, v1
    v_xor_b32 v19, v19, v18
    v_lshl_add_u32 v2, v19, 4, v16
    v_xor_b32 v19, 4, v19
    v_lshl_add_u32 v3, v19, 4, v16
    v_add_u32 v3, 7168, v3
    v_add_u32 v4, 14336, v2
    v_add_u32 v5, 14336, v3
    s_and_b32 s36, s28, 3
    s_lshl_b32 s37, s36, 4
    v_add_u32 v16, s37, v18
    v_lshlrev_b32 v16, 13, v16
    s_lshl_b32 s37, s29, 8
    v_add_u32 v16, s37, v16
    v_and_b32 v19, 15, v1
    v_lshlrev_b32 v18, 1, v18
    v_xor_b32 v19, v19, v18
    v_lshl_add_u32 v6, v19, 4, v16
    v_add_u32 v7, 31744, v6
    v_xor_b32 v19, 8, v19
    v_lshl_add_u32 v8, v19, 4, v16
    v_add_u32 v8, 63488, v8
    v_add_u32 v9, 31744, v8
    s_lshl_b32 s33, s28, 12
    s_add_u32 s34, s33, 65536
    s_mov_b32 s31, 0
    s_mov_b32 s32, 0
    s_mov_b32 s40, 128
    s_mov_b32 s41, 524288
    s_waitcnt lgkmcnt(0)
    s_mov_b32 s4, s46
    s_and_b32 s5, s47, 0xffff
    s_mov_b32 s6, 2097152
    s_mov_b32 s7, 0x20000
    s_mov_b32 s8, s48
    s_and_b32 s9, s49, 0xffff
    s_mov_b32 s10, 4194304
    s_mov_b32 s11, 0x20000
    s_mov_b32 s20, s50
    s_and_b32 s21, s51, 0xffff
    s_mov_b32 s22, 4194304
    s_mov_b32 s23, 0x20000
    s_cmp_lt_u32 s28, 4
    s_cbranch_scc0 L_pro_s
    s_barrier
    s_cmp_eq_u32 s2, 0
    s_cbranch_scc1 L_recurrent_scan__compressed_kv_cla__moe_arch_mod__prompt_kernel_rare_1
L_recurrent_scan__compressed_kv_cla__moe_arch_mod__prompt_kernel_back_2:
    s_add_u32 m0, s33, 0
    s_add_u32 s36, s31, 131072
    buffer_load_dwordx4 v2, s[4:7], s31 offen offset:0 lds
    buffer_load_dwordx4 v3, s[4:7], s31 offen offset:1024 lds
    buffer_load_dwordx4 v4, s[4:7], s31 offen offset:2048 lds
    buffer_load_dwordx4 v5, s[4:7], s31 offen offset:3072 lds
    s_add_u32 m0, s34, 0
    s_nop 0
    buffer_load_dwordx4 v6, s[8:11], s32 offen offset:0 nt lds
    buffer_load_dwordx4 v7, s[8:11], s32 offen offset:1024 nt lds
    buffer_load_dwordx4 v8, s[8:11], s32 offen offset:2048 nt lds
    buffer_load_dwordx4 v9, s[8:11], s32 offen offset:3072 nt lds
    s_add_u32 m0, s33, 16384
    s_nop 0
    buffer_load_dwordx4 v2, s[4:7], s36 offen offset:0 lds
    buffer_load_dwordx4 v3, s[4:7], s36 offen offset:1024 lds
    buffer_load_dwordx4 v4, s[4:7], s36 offen offset:2048 lds
    buffer_load_dwordx4 v5, s[4:7], s36 offen offset:3072 lds
    s_add_u32 m0, s34, 16384
    s_nop 0
    buffer_load_dwordx4 v6, s[20:23], s32 offen offset:0 nt lds
    buffer_load_dwordx4 v7, s[20:23], s32 offen offset:1024 nt lds
    buffer_load_dwordx4 v8, s[20:23], s32 offen offset:2048 nt lds
    buffer_load_dwordx4 v9, s[20:23], s32 offen offset:3072 nt lds
    s_add_u32 s31, s31, s40
    s_add_u32 s32, s32, s41
L_pro_s:
    s_add_u32 s54, s90, 0
    s_addc_u32 s55, s91, 0
    s_add_u32 s12, s54, 8388608
    s_addc_u32 s13, s55, 0
    s_and_b32 s13, s13, 0xffff
    s_mov_b32 s14, 134217856
    s_mov_b32 s15, 0x20000
    s_mov_b32 s24, s54
    s_and_b32 s25, s55, 0xffff
    s_mov_b32 s26, 184549504
    s_mov_b32 s27, 0x20000
    s_add_u32 s90, s54, 61865984
    s_addc_u32 s91, s55, 0
    v_and_b32 v16, 15, v1
    v_lshrrev_b32 v17, 4, v1
    s_bfe_u32 s36, s28, 0x10001
    s_lshl_b32 s36, s36, 14
    v_lshl_add_u32 v18, v16, 7, s36
    v_lshrrev_b32 v19, 1, v16
    v_xor_b32 v19, v19, v17
    v_lshl_add_u32 v10, v19, 4, v18
    v_xor_b32 v19, 4, v19
    v_lshl_add_u32 v11, v19, 4, v18
    v_lshrrev_b32 v16, 2, v16
    v_lshl_add_u32 v18, v17, 3, v16
    v_lshlrev_b32 v18, 8, v18
    s_lshr_b32 s36, s28, 2
    s_lshl_b32 s36, s36, 14
    s_add_u32 s36, s36, 65536
    v_add_u32 v18, s36, v18
    v_and_b32 v19, 3, v1
    v_lshl_add_u32 v18, v19, 3, v18
    v_and_b32 v17, 1, v17
    v_lshl_add_u32 v16, v17, 2, v16
    s_and_b32 s36, s28, 1
    s_lshl_b32 s36, s36, 2
    s_add_u32 s37, s36, 0
    v_xor_b32 v19, s37, v16
    v_lshl_add_u32 v12, v19, 5, v18
    s_add_u32 s37, s36, 1
    v_xor_b32 v19, s37, v16
    v_lshl_add_u32 v13, v19, 5, v18
    s_add_u32 s37, s36, 2
    v_xor_b32 v19, s37, v16
    v_lshl_add_u32 v14, v19, 5, v18
    s_add_u32 s37, s36, 3
    v_xor_b32 v19, s37, v16
    v_lshl_add_u32 v15, v19, 5, v18
    v_mov_b64 v[128:129], 0
    v_mov_b64 v[130:131], 0
    v_mov_b64 v[132:133], 0
    v_mov_b64 v[134:135], 0
    v_mov_b64 v[136:137], 0
    v_mov_b64 v[138:139], 0
    v_mov_b64 v[140:141], 0
    v_mov_b64 v[142:143], 0
    v_mov_b64 v[144:145], 0
    v_mov_b64 v[146:147], 0
    v_mov_b64 v[148:149], 0
    v_mov_b64 v[150:151], 0
    v_mov_b64 v[152:153], 0
    v_mov_b64 v[154:155], 0
    v_mov_b64 v[156:157], 0
    v_mov_b64 v[158:159], 0
    v_mov_b64 v[160:161], 0
    v_mov_b64 v[162:163], 0
    v_mov_b64 v[164:165], 0
    v_mov_b64 v[166:167], 0
    v_mov_b64 v[168:169], 0
    v_mov_b64 v[170:171], 0
    v_mov_b64 v[172:173], 0
    v_mov_b64 v[174:175], 0
    v_mov_b64 v[176:177], 0
    v_mov_b64 v[178:179], 0
    v_mov_b64 v[180:181], 0
    v_mov_b64 v[182:183], 0
    v_mov_b64 v[184:185], 0
    v_mov_b64 v[186:187], 0
    v_mov_b64 v[188:189], 0
    v_mov_b64 v[190:191], 0
    v_mov_b64 v[192:193], 0
    v_mov_b64 v[194:195], 0
    v_mov_b64 v[196:197], 0
    v_mov_b64 v[198:199], 0
    v_mov_b64 v[200:201], 0
    v_mov_b64 v[202:203], 0
    v_mov_b64 v[204:205], 0
    v_mov_b64 v[206:207], 0
    v_mov_b64 v[208:209], 0
    v_mov_b64 v[210:211], 0
    v_mov_b64 v[212:213], 0
    v_mov_b64 v[214:215], 0
    v_mov_b64 v[216:217], 0
    v_mov_b64 v[218:219], 0
    v_mov_b64 v[220:221], 0
    v_mov_b64 v[222:223], 0
    v_mov_b64 v[224:225], 0
    v_mov_b64 v[226:227], 0
    v_mov_b64 v[228:229], 0
    v_mov_b64 v[230:231], 0
    v_mov_b64 v[232:233], 0
    v_mov_b64 v[234:235], 0
    v_mov_b64 v[236:237], 0
    v_mov_b64 v[238:239], 0
    v_mov_b64 v[240:241], 0
    v_mov_b64 v[242:243], 0
    v_mov_b64 v[244:245], 0
    v_mov_b64 v[246:247], 0
    v_mov_b64 v[248:249], 0
    v_mov_b64 v[250:251], 0
    v_mov_b64 v[252:253], 0
    v_mov_b64 v[254:255], 0
    v_mov_b32 v118, 0
    v_mov_b32 v117, 0
    s_lshr_b32 s36, s2, 3
    s_lshl_b32 s36, s36, 5
    s_lshl_b32 s37, s28, 2
    s_add_u32 s36, s36, s37
    v_bfe_u32 v17, v1, 3, 2
    v_add_u32 v17, s36, v17
    v_lshlrev_b32 v17, 13, v17
    v_and_b32 v19, 7, v1
    v_lshl_add_u32 v17, v19, 7, v17
    s_and_b32 s36, s29, 28
    s_lshl_b32 s36, s36, 8
    v_add_u32 v17, s36, v17
    s_mov_b32 s45, 8192
    s_cmp_lt_u32 s28, 4
    s_cbranch_scc0 L_pro_b
    s_add_u32 m0, s33, 32768
    s_add_u32 s36, s31, 131072
    buffer_load_dwordx4 v2, s[4:7], s31 offen offset:0 lds
    buffer_load_dwordx4 v3, s[4:7], s31 offen offset:1024 lds
    buffer_load_dwordx4 v4, s[4:7], s31 offen offset:2048 lds
    buffer_load_dwordx4 v5, s[4:7], s31 offen offset:3072 lds
    s_add_u32 m0, s34, 32768
    s_nop 0
    buffer_load_dwordx4 v6, s[8:11], s32 offen offset:0 nt lds
    buffer_load_dwordx4 v7, s[8:11], s32 offen offset:1024 nt lds
    buffer_load_dwordx4 v8, s[8:11], s32 offen offset:2048 nt lds
    buffer_load_dwordx4 v9, s[8:11], s32 offen offset:3072 nt lds
    s_add_u32 m0, s33, 49152
    s_nop 0
    buffer_load_dwordx4 v2, s[4:7], s36 offen offset:0 lds
    buffer_load_dwordx4 v3, s[4:7], s36 offen offset:1024 lds
    buffer_load_dwordx4 v4, s[4:7], s36 offen offset:2048 lds
    buffer_load_dwordx4 v5, s[4:7], s36 offen offset:3072 lds
    s_add_u32 m0, s34, 49152
    s_nop 0
    buffer_load_dwordx4 v6, s[20:23], s32 offen offset:0 nt lds
    buffer_load_dwordx4 v7, s[20:23], s32 offen offset:1024 nt lds
    buffer_load_dwordx4 v8, s[20:23], s32 offen offset:2048 nt lds
    buffer_load_dwordx4 v9, s[20:23], s32 offen offset:3072 nt lds
    s_add_u32 s31, s31, s40
    s_add_u32 s32, s32, s41
    s_waitcnt vmcnt(16)
    s_branch L_pro_j
L_pro_b:
    s_mov_b64 s[8:9], s[20:21]
    s_mov_b32 s31, 256
    s_mov_b32 s32, 1048576
    s_and_b32 s60, s28, 3
    s_waitcnt vmcnt(0)
    s_mov_b32 s3, 0
L_ln:
    v_lshlrev_b32 v44, 16, v36
    v_and_b32 v45, 0xffff0000, v36
    v_lshlrev_b32 v46, 16, v37
    v_and_b32 v47, 0xffff0000, v37
    v_lshlrev_b32 v48, 16, v38
    v_and_b32 v49, 0xffff0000, v38
    v_lshlrev_b32 v50, 16, v39
    v_and_b32 v51, 0xffff0000, v39
    v_lshlrev_b32 v52, 16, v40
    v_and_b32 v53, 0xffff0000, v40
    v_lshlrev_b32 v54, 16, v41
    v_and_b32 v55, 0xffff0000, v41
    v_lshlrev_b32 v56, 16, v42
    v_and_b32 v57, 0xffff0000, v42
    v_lshlrev_b32 v58, 16, v43
    v_and_b32 v59, 0xffff0000, v43
    v_lshlrev_b32 v60, 16, v20
    v_lshlrev_b32 v76, 16, v28
    v_and_b32 v61, 0xffff0000, v20
    v_and_b32 v77, 0xffff0000, v28
    v_lshlrev_b32 v62, 16, v21
    v_lshlrev_b32 v78, 16, v29
    v_and_b32 v63, 0xffff0000, v21
    v_and_b32 v79, 0xffff0000, v29
    v_lshlrev_b32 v64, 16, v22
    v_lshlrev_b32 v80, 16, v30
    v_and_b32 v65, 0xffff0000, v22
    v_and_b32 v81, 0xffff0000, v30
    v_lshlrev_b32 v66, 16, v23
    v_lshlrev_b32 v82, 16, v31
    v_and_b32 v67, 0xffff0000, v23
    v_and_b32 v83, 0xffff0000, v31
    v_lshlrev_b32 v68, 16, v24
    v_lshlrev_b32 v84, 16, v32
    v_and_b32 v69, 0xffff0000, v24
    v_and_b32 v85, 0xffff0000, v32
    v_lshlrev_b32 v70, 16, v25
    v_lshlrev_b32 v86, 16, v33
    v_and_b32 v71, 0xffff0000, v25
    v_and_b32 v87, 0xffff0000, v33
    v_lshlrev_b32 v72, 16, v26
    v_lshlrev_b32 v88, 16, v34
    v_and_b32 v73, 0xffff0000, v26
    v_and_b32 v89, 0xffff0000, v34
    v_lshlrev_b32 v74, 16, v27
    v_lshlrev_b32 v90, 16, v35
    v_and_b32 v75, 0xffff0000, v27
    v_and_b32 v91, 0xffff0000, v35
    v_pk_add_f32 v[92:93], v[60:61], v[62:63]
    v_pk_add_f32 v[100:101], v[76:77], v[78:79]
    v_pk_add_f32 v[92:93], v[92:93], v[64:65]
    v_pk_add_f32 v[100:101], v[100:101], v[80:81]
    v_pk_add_f32 v[92:93], v[92:93], v[66:67]
    v_pk_add_f32 v[100:101], v[100:101], v[82:83]
    v_pk_add_f32 v[92:93], v[92:93], v[68:69]
    v_pk_add_f32 v[100:101], v[100:101], v[84:85]
    v_pk_add_f32 v[92:93], v[92:93], v[70:71]
    v_pk_add_f32 v[100:101], v[100:101], v[86:87]
    v_pk_add_f32 v[92:93], v[92:93], v[72:73]
    v_pk_add_f32 v[100:101], v[100:101], v[88:89]
    v_pk_add_f32 v[92:93], v[92:93], v[74:75]
    v_pk_add_f32 v[100:101], v[100:101], v[90:91]
    v_add_f32 v92, v92, v93
    v_add_f32 v100, v100, v101
    s_nop 0
    v_add_f32_dpp v92, v92, v92 quad_perm:[1,0,3,2] row_mask:0xf bank_mask:0xf
    v_add_f32_dpp v100, v100, v100 quad_perm:[1,0,3,2] row_mask:0xf bank_mask:0xf
    s_nop 0
    v_add_f32_dpp v92, v92, v92 quad_perm:[2,3,0,1] row_mask:0xf bank_mask:0xf
    v_add_f32_dpp v100, v100, v100 quad_perm:[2,3,0,1] row_mask:0xf bank_mask:0xf
    s_nop 0
    v_add_f32_dpp v92, v92, v92 row_half_mirror row_mask:0xf bank_mask:0xf
    v_add_f32_dpp v100, v100, v100 row_half_mirror row_mask:0xf bank_mask:0xf
    s_nop 0
    v_add_f32_dpp v92, v92, v92 row_mirror row_mask:0xf bank_mask:0xf
    v_add_f32_dpp v100, v100, v100 row_mirror row_mask:0xf bank_mask:0xf
    v_readlane_b32 s36, v92, 0
    v_readlane_b32 s56, v100, 0
    v_readlane_b32 s37, v92, 16
    v_readlane_b32 s57, v100, 16
    v_readlane_b32 s38, v92, 32
    v_readlane_b32 s58, v100, 32
    v_readlane_b32 s39, v92, 48
    v_readlane_b32 s59, v100, 48
    v_mov_b32 v96, s36
    v_mov_b32 v104, s56
    v_add_f32 v96, s37, v96
    v_add_f32 v104, s57, v104
    v_add_f32 v96, s38, v96
    v_add_f32 v104, s58, v104
    v_add_f32 v96, s39, v96
    v_add_f32 v104, s59, v104
    v_mul_f32 v96, 0xba800000, v96
    v_mul_f32 v104, 0xba800000, v104
    v_mov_b32 v97, v96
    v_mov_b32 v105, v104
    v_pk_add_f32 v[94:95], v[60:61], v[96:97]
    v_pk_add_f32 v[102:103], v[76:77], v[104:105]
    v_pk_mul_f32 v[92:93], v[94:95], v[94:95]
    v_pk_mul_f32 v[100:101], v[102:103], v[102:103]
    v_pk_add_f32 v[94:95], v[62:63], v[96:97]
    v_pk_add_f32 v[102:103], v[78:79], v[104:105]
    v_pk_fma_f32 v[92:93], v[94:95], v[94:95], v[92:93]
    v_pk_fma_f32 v[100:101], v[102:103], v[102:103], v[100:101]
    v_pk_add_f32 v[94:95], v[64:65], v[96:97]
    v_pk_add_f32 v[102:103], v[80:81], v[104:105]
    v_pk_fma_f32 v[92:93], v[94:95], v[94:95], v[92:93]
    v_pk_fma_f32 v[100:101], v[102:103], v[102:103], v[100:101]
    v_pk_add_f32 v[94:95], v[66:67], v[96:97]
    v_pk_add_f32 v[102:103], v[82:83], v[104:105]
    v_pk_fma_f32 v[92:93], v[94:95], v[94:95], v[92:93]
    v_pk_fma_f32 v[100:101], v[102:103], v[102:103], v[100:101]
    v_pk_add_f32 v[94:95], v[68:69], v[96:97]
    v_pk_add_f32 v[102:103], v[84:85], v[104:105]
    v_pk_fma_f32 v[92:93], v[94:95], v[94:95], v[92:93]
    v_pk_fma_f32 v[100:101], v[102:103], v[102:103], v[100:101]
    v_pk_add_f32 v[94:95], v[70:71], v[96:97]
    v_pk_add_f32 v[102:103], v[86:87], v[104:105]
    v_pk_fma_f32 v[92:93], v[94:95], v[94:95], v[92:93]
    v_pk_fma_f32 v[100:101], v[102:103], v[102:103], v[100:101]
    v_pk_add_f32 v[94:95], v[72:73], v[96:97]
    v_pk_add_f32 v[102:103], v[88:89], v[104:105]
    v_pk_fma_f32 v[92:93], v[94:95], v[94:95], v[92:93]
    v_pk_fma_f32 v[100:101], v[102:103], v[102:103], v[100:101]
    v_pk_add_f32 v[94:95], v[74:75], v[96:97]
    v_pk_add_f32 v[102:103], v[90:91], v[104:105]
    v_pk_fma_f32 v[92:93], v[94:95], v[94:95], v[92:93]
    v_pk_fma_f32 v[100:101], v[102:103], v[102:103], v[100:101]
    v_add_f32 v92, v92, v93
    v_add_f32 v100, v100, v101
    s_nop 0
    v_add_f32_dpp v92, v92, v92 quad_perm:[1,0,3,2] row_mask:0xf bank_mask:0xf
    v_add_f32_dpp v100, v100, v100 quad_perm:[1,0,3,2] row_mask:0xf bank_mask:0xf
    s_nop 0
    v_add_f32_dpp v92, v92, v92 quad_perm:[2,3,0,1] row_mask:0xf bank_mask:0xf
    v_add_f32_dpp v100, v100, v100 quad_perm:[2,3,0,1] row_mask:0xf bank_mask:0xf
    s_nop 0
    v_add_f32_dpp v92, v92, v92 row_half_mirror row_mask:0xf bank_mask:0xf
    v_add_f32_dpp v100, v100, v100 row_half_mirror row_mask:0xf bank_mask:0xf
    s_nop 0
    v_add_f32_dpp v92, v92, v92 row_mirror row_mask:0xf bank_mask:0xf
    v_add_f32_dpp v100, v100, v100 row_mirror row_mask:0xf bank_mask:0xf
    v_readlane_b32 s36, v92, 0
    v_readlane_b32 s56, v100, 0
    v_readlane_b32 s37, v92, 16
    v_readlane_b32 s57, v100, 16
    v_readlane_b32 s38, v92, 32
    v_readlane_b32 s58, v100, 32
    v_readlane_b32 s39, v92, 48
    v_readlane_b32 s59, v100, 48
    v_mov_b32 v94, s36
    v_mov_b32 v102, s56
    v_add_f32 v94, s37, v94
    v_add_f32 v102, s57, v102
    v_add_f32 v94, s38, v94
    v_add_f32 v102, s58, v102
    v_add_f32 v94, s39, v94
    v_add_f32 v102, s59, v102
    v_mul_f32 v94, 0x3a800000, v94
    v_mul_f32 v102, 0x3a800000, v102
    v_cvt_pk_bf16_f32 v95, v96, v94
    v_cvt_pk_bf16_f32 v103, v104, v102
    v_lshlrev_b32 v96, 16, v95
    v_lshlrev_b32 v104, 16, v103
    v_and_b32 v94, 0xffff0000, v95
    v_and_b32 v102, 0xffff0000, v103
    v_add_f32 v94, 0x3727c5ac, v94
    v_add_f32 v102, 0x3727c5ac, v102
    v_cvt_pk_bf16_f32 v94, v94, v94
    v_cvt_pk_bf16_f32 v102, v102, v102
    v_lshlrev_b32 v94, 16, v94
    v_lshlrev_b32 v102, 16, v102
    v_sqrt_f32 v94, v94
    v_sqrt_f32 v102, v102
    v_mov_b32 v97, v96
    v_mov_b32 v105, v104
    v_cvt_pk_bf16_f32 v94, v94, v94
    v_cvt_pk_bf16_f32 v102, v102, v102
    v_lshlrev_b32 v94, 16, v94
    v_lshlrev_b32 v102, 16, v102
    v_rcp_f32 v99, v94
    v_rcp_f32 v107, v102
    v_fma_f32 v95, -v94, v99, 1.0
    v_fma_f32 v103, -v102, v107, 1.0
    v_fma_f32 v99, v95, v99, v99
    v_fma_f32 v107, v103, v107, v107
    v_mov_b32 v98, v99
    v_mov_b32 v106, v107
    v_pk_add_f32 v[60:61], v[60:61], v[96:97]
    v_pk_add_f32 v[76:77], v[76:77], v[104:105]
    v_cvt_pk_bf16_f32 v94, v60, v61
    v_cvt_pk_bf16_f32 v102, v76, v77
    v_lshlrev_b32 v60, 16, v94
    v_lshlrev_b32 v76, 16, v102
    v_and_b32 v61, 0xffff0000, v94
    v_and_b32 v77, 0xffff0000, v102
    v_pk_mul_f32 v[60:61], v[60:61], v[98:99]
    v_pk_mul_f32 v[76:77], v[76:77], v[106:107]
    v_cvt_pk_bf16_f32 v108, v60, v61
    v_cvt_pk_bf16_f32 v120, v76, v77
    v_lshlrev_b32 v60, 16, v108
    v_lshlrev_b32 v76, 16, v120
    v_and_b32 v61, 0xffff0000, v108
    v_and_b32 v77, 0xffff0000, v120
    v_pk_mul_f32 v[92:93], v[60:61], v[44:45]
    v_pk_mul_f32 v[100:101], v[76:77], v[44:45]
    v_pk_add_f32 v[62:63], v[62:63], v[96:97]
    v_pk_add_f32 v[78:79], v[78:79], v[104:105]
    v_cvt_pk_bf16_f32 v94, v62, v63
    v_cvt_pk_bf16_f32 v102, v78, v79
    v_lshlrev_b32 v62, 16, v94
    v_lshlrev_b32 v78, 16, v102
    v_and_b32 v63, 0xffff0000, v94
    v_and_b32 v79, 0xffff0000, v102
    v_pk_mul_f32 v[62:63], v[62:63], v[98:99]
    v_pk_mul_f32 v[78:79], v[78:79], v[106:107]
    v_cvt_pk_bf16_f32 v109, v62, v63
    v_cvt_pk_bf16_f32 v121, v78, v79
    v_lshlrev_b32 v62, 16, v109
    v_lshlrev_b32 v78, 16, v121
    v_and_b32 v63, 0xffff0000, v109
    v_and_b32 v79, 0xffff0000, v121
    v_pk_fma_f32 v[92:93], v[62:63], v[46:47], v[92:93]
    v_pk_fma_f32 v[100:101], v[78:79], v[46:47], v[100:101]
    v_pk_add_f32 v[64:65], v[64:65], v[96:97]
    v_pk_add_f32 v[80:81], v[80:81], v[104:105]
    v_cvt_pk_bf16_f32 v94, v64, v65
    v_cvt_pk_bf16_f32 v102, v80, v81
    v_lshlrev_b32 v64, 16, v94
    v_lshlrev_b32 v80, 16, v102
    v_and_b32 v65, 0xffff0000, v94
    v_and_b32 v81, 0xffff0000, v102
    v_pk_mul_f32 v[64:65], v[64:65], v[98:99]
    v_pk_mul_f32 v[80:81], v[80:81], v[106:107]
    v_cvt_pk_bf16_f32 v110, v64, v65
    v_cvt_pk_bf16_f32 v122, v80, v81
    v_lshlrev_b32 v64, 16, v110
    v_lshlrev_b32 v80, 16, v122
    v_and_b32 v65, 0xffff0000, v110
    v_and_b32 v81, 0xffff0000, v122
    v_pk_fma_f32 v[92:93], v[64:65], v[48:49], v[92:93]
    v_pk_fma_f32 v[100:101], v[80:81], v[48:49], v[100:101]
    v_pk_add_f32 v[66:67], v[66:67], v[96:97]
    v_pk_add_f32 v[82:83], v[82:83], v[104:105]
    v_cvt_pk_bf16_f32 v94, v66, v67
    v_cvt_pk_bf16_f32 v102, v82, v83
    v_lshlrev_b32 v66, 16, v94
    v_lshlrev_b32 v82, 16, v102
    v_and_b32 v67, 0xffff0000, v94
    v_and_b32 v83, 0xffff0000, v102
    v_pk_mul_f32 v[66:67], v[66:67], v[98:99]
    v_pk_mul_f32 v[82:83], v[82:83], v[106:107]
    v_cvt_pk_bf16_f32 v111, v66, v67
    v_cvt_pk_bf16_f32 v123, v82, v83
    v_lshlrev_b32 v66, 16, v111
    v_lshlrev_b32 v82, 16, v123
    v_and_b32 v67, 0xffff0000, v111
    v_and_b32 v83, 0xffff0000, v123
    v_pk_fma_f32 v[92:93], v[66:67], v[50:51], v[92:93]
    v_pk_fma_f32 v[100:101], v[82:83], v[50:51], v[100:101]
    v_pk_add_f32 v[68:69], v[68:69], v[96:97]
    v_pk_add_f32 v[84:85], v[84:85], v[104:105]
    v_cvt_pk_bf16_f32 v94, v68, v69
    v_cvt_pk_bf16_f32 v102, v84, v85
    v_lshlrev_b32 v68, 16, v94
    v_lshlrev_b32 v84, 16, v102
    v_and_b32 v69, 0xffff0000, v94
    v_and_b32 v85, 0xffff0000, v102
    v_pk_mul_f32 v[68:69], v[68:69], v[98:99]
    v_pk_mul_f32 v[84:85], v[84:85], v[106:107]
    v_cvt_pk_bf16_f32 v112, v68, v69
    v_cvt_pk_bf16_f32 v124, v84, v85
    v_lshlrev_b32 v68, 16, v112
    v_lshlrev_b32 v84, 16, v124
    v_and_b32 v69, 0xffff0000, v112
    v_and_b32 v85, 0xffff0000, v124
    v_pk_fma_f32 v[92:93], v[68:69], v[52:53], v[92:93]
    v_pk_fma_f32 v[100:101], v[84:85], v[52:53], v[100:101]
    v_pk_add_f32 v[70:71], v[70:71], v[96:97]
    v_pk_add_f32 v[86:87], v[86:87], v[104:105]
    v_cvt_pk_bf16_f32 v94, v70, v71
    v_cvt_pk_bf16_f32 v102, v86, v87
    v_lshlrev_b32 v70, 16, v94
    v_lshlrev_b32 v86, 16, v102
    v_and_b32 v71, 0xffff0000, v94
    v_and_b32 v87, 0xffff0000, v102
    v_pk_mul_f32 v[70:71], v[70:71], v[98:99]
    v_pk_mul_f32 v[86:87], v[86:87], v[106:107]
    v_cvt_pk_bf16_f32 v113, v70, v71
    v_cvt_pk_bf16_f32 v125, v86, v87
    v_lshlrev_b32 v70, 16, v113
    v_lshlrev_b32 v86, 16, v125
    v_and_b32 v71, 0xffff0000, v113
    v_and_b32 v87, 0xffff0000, v125
    v_pk_fma_f32 v[92:93], v[70:71], v[54:55], v[92:93]
    v_pk_fma_f32 v[100:101], v[86:87], v[54:55], v[100:101]
    v_pk_add_f32 v[72:73], v[72:73], v[96:97]
    v_pk_add_f32 v[88:89], v[88:89], v[104:105]
    v_cvt_pk_bf16_f32 v94, v72, v73
    v_cvt_pk_bf16_f32 v102, v88, v89
    v_lshlrev_b32 v72, 16, v94
    v_lshlrev_b32 v88, 16, v102
    v_and_b32 v73, 0xffff0000, v94
    v_and_b32 v89, 0xffff0000, v102
    v_pk_mul_f32 v[72:73], v[72:73], v[98:99]
    v_pk_mul_f32 v[88:89], v[88:89], v[106:107]
    v_cvt_pk_bf16_f32 v114, v72, v73
    v_cvt_pk_bf16_f32 v126, v88, v89
    v_lshlrev_b32 v72, 16, v114
    v_lshlrev_b32 v88, 16, v126
    v_and_b32 v73, 0xffff0000, v114
    v_and_b32 v89, 0xffff0000, v126
    v_pk_fma_f32 v[92:93], v[72:73], v[56:57], v[92:93]
    v_pk_fma_f32 v[100:101], v[88:89], v[56:57], v[100:101]
    v_pk_add_f32 v[74:75], v[74:75], v[96:97]
    v_pk_add_f32 v[90:91], v[90:91], v[104:105]
    v_cvt_pk_bf16_f32 v94, v74, v75
    v_cvt_pk_bf16_f32 v102, v90, v91
    v_lshlrev_b32 v74, 16, v94
    v_lshlrev_b32 v90, 16, v102
    v_and_b32 v75, 0xffff0000, v94
    v_and_b32 v91, 0xffff0000, v102
    v_pk_mul_f32 v[74:75], v[74:75], v[98:99]
    v_pk_mul_f32 v[90:91], v[90:91], v[106:107]
    v_cvt_pk_bf16_f32 v115, v74, v75
    v_cvt_pk_bf16_f32 v127, v90, v91
    v_lshlrev_b32 v74, 16, v115
    v_lshlrev_b32 v90, 16, v127
    v_and_b32 v75, 0xffff0000, v115
    v_and_b32 v91, 0xffff0000, v127
    v_pk_fma_f32 v[92:93], v[74:75], v[58:59], v[92:93]
    v_pk_fma_f32 v[100:101], v[90:91], v[58:59], v[100:101]
    v_add_f32 v92, v92, v93
    v_add_f32 v100, v100, v101
    v_xor_b32 v98, 0x80000000, v96
    v_xor_b32 v106, 0x80000000, v104
    s_mul_i32 s36, s60, 2064
    s_mul_i32 s56, s28, 2064
    s_add_u32 s36, s36, 131072
    s_add_u32 s56, s56, 131072
    v_lshl_add_u32 v95, v1, 4, s36
    v_lshl_add_u32 v103, v1, 4, s56
    ds_write_b128 v95, v[108:111]
    ds_write_b128 v103, v[120:123]
    ds_write_b128 v95, v[112:115] offset:1024
    ds_write_b128 v103, v[124:127] offset:1024
    s_nop 0
    v_add_f32_dpp v92, v92, v92 quad_perm:[1,0,3,2] row_mask:0xf bank_mask:0xf
    v_add_f32_dpp v100, v100, v100 quad_perm:[1,0,3,2] row_mask:0xf bank_mask:0xf
    s_nop 0
    v_add_f32_dpp v92, v92, v92 quad_perm:[2,3,0,1] row_mask:0xf bank_mask:0xf
    v_add_f32_dpp v100, v100, v100 quad_perm:[2,3,0,1] row_mask:0xf bank_mask:0xf
    s_nop 0
    v_add_f32_dpp v92, v92, v92 row_half_mirror row_mask:0xf bank_mask:0xf
    v_add_f32_dpp v100, v100, v100 row_half_mirror row_mask:0xf bank_mask:0xf
    s_nop 0
    v_add_f32_dpp v92, v92, v92 row_mirror row_mask:0xf bank_mask:0xf
    v_add_f32_dpp v100, v100, v100 row_mirror row_mask:0xf bank_mask:0xf
    v_readlane_b32 s36, v92, 0
    v_readlane_b32 s56, v100, 0
    v_readlane_b32 s37, v92, 16
    v_readlane_b32 s57, v100, 16
    v_readlane_b32 s38, v92, 32
    v_readlane_b32 s58, v100, 32
    v_readlane_b32 s39, v92, 48
    v_readlane_b32 s59, v100, 48
    v_mov_b32 v93, s36
    v_mov_b32 v101, s56
    v_add_f32 v93, s37, v93
    v_add_f32 v101, s57, v101
    v_add_f32 v93, s38, v93
    v_add_f32 v101, s58, v101
    v_add_f32 v93, s39, v93
    v_add_f32 v101, s59, v101
    v_cvt_pk_bf16_f32 v93, v93, v93
    v_cvt_pk_bf16_f32 v101, v101, v101
    v_lshlrev_b32 v93, 16, v93
    v_lshlrev_b32 v101, 16, v101
    v_ashrrev_i32 v95, 31, v93
    v_ashrrev_i32 v103, 31, v101
    v_or_b32 v95, 0x80000000, v95
    v_or_b32 v103, 0x80000000, v103
    v_xor_b32 v95, v93, v95
    v_xor_b32 v103, v101, v103
    v_and_b32 v95, 0xffff0000, v95
    v_and_b32 v103, 0xffff0000, v103
    s_sub_u32 s36, 0xffff, s42
    s_sub_u32 s56, 0xffff, s43
    v_or_b32 v95, s36, v95
    v_or_b32 v103, s56, v103
    s_lshl_b32 s37, s60, 3
    s_lshl_b32 s57, s28, 3
    s_add_u32 s37, s37, 147712
    s_add_u32 s57, s57, 147712
    v_mov_b32 v94, s37
    v_mov_b32 v102, s57
    ds_write_b64 v94, v[98:99]
    ds_write_b64 v102, v[106:107]
    ds_write_b32 v94, v95 offset:64
    ds_write_b32 v102, v103 offset:64
    s_lshl_b32 s36, s2, 13
    s_lshl_b32 s37, s60, 11
    s_add_u32 s36, s36, s37
    v_lshl_add_u32 v16, v1, 7, s36
    s_cmp_lt_u32 s60, 2
    s_cselect_b64 s[38:39], s[48:49], s[50:51]
    s_lshr_b32 s36, s2, 3
    s_lshl_b32 s36, s36, 1
    s_and_b32 s37, s60, 1
    s_add_u32 s36, s36, s37
    s_lshl_b32 s36, s36, 16
    s_and_b32 s37, s29, 28
    s_lshl_b32 s37, s37, 8
    s_add_u32 s36, s36, s37
    s_sub_u32 s37, 256, s38
    s_and_b32 s37, s37, 0x300
    s_add_u32 s36, s36, s37
    v_lshrrev_b32 v18, 1, v1
    v_lshl_add_u32 v18, v18, 13, s36
    v_and_b32 v19, 1, v1
    v_lshl_add_u32 v18, v19, 7, v18
    s_mov_b64 exec, 0xffff
    global_load_dword v0, v16, s[46:47]
    global_load_dword v0, v18, s[38:39]
    s_mov_b64 exec, -1
    s_waitcnt lgkmcnt(0)
    s_cmp_eq_u32 s3, 0
    s_mov_b32 s3, 0
    s_cbranch_scc0 L_ln
L_pro_j:
    s_barrier
    ds_read_b128 v[20:23], v10 offset:0
    ds_read_b64_tr_b16 v[52:53], v12 offset:0
    ds_read_b64_tr_b16 v[54:55], v12 offset:1024
    ds_read_b64_tr_b16 v[56:57], v13 offset:0
    ds_read_b64_tr_b16 v[58:59], v13 offset:1024
    ds_read_b64_tr_b16 v[60:61], v14 offset:0
    ds_read_b64_tr_b16 v[62:63], v14 offset:1024
    ds_read_b64_tr_b16 v[64:65], v15 offset:0
    ds_read_b64_tr_b16 v[66:67], v15 offset:1024
    ds_read_b128 v[24:27], v10 offset:2048
    ds_read_b128 v[28:31], v10 offset:4096
    ds_read_b128 v[32:35], v10 offset:6144
    ds_read_b128 v[36:39], v10 offset:8192
    ds_read_b128 v[40:43], v10 offset:10240
    ds_read_b128 v[44:47], v10 offset:12288
    ds_read_b128 v[48:51], v10 offset:14336
    s_add_u32 s36, s2, s28
    s_cmp_eq_u32 s36, 0
    s_cbranch_scc1 L_recurrent_scan__compressed_kv_cla__moe_arch_mod__prompt_kernel_rare_3
L_recurrent_scan__compressed_kv_cla__moe_arch_mod__prompt_kernel_back_4:
    s_mov_b32 s35, 0
    s_cmp_eq_u32 s28, 0
    s_cselect_b32 s43, 9, 0
    s_cselect_b32 s44, 2, 1
    s_cmp_lt_u32 s28, 4
    s_cbranch_scc0 L_kv_vloop
    .p2align 6
L_kv_kloop:
    s_waitcnt lgkmcnt(0)
    v_mfma_f32_16x16x32_bf16 v[128:131], v[52:55], v[20:23], v[128:131]
    ds_read_b128 v[68:71], v11 offset:0
    v_mfma_f32_16x16x32_bf16 v[132:135], v[56:59], v[20:23], v[132:135]
    ds_read_b64_tr_b16 v[100:101], v12 offset:8192
    v_mfma_f32_16x16x32_bf16 v[136:139], v[60:63], v[20:23], v[136:139]
    ds_read_b64_tr_b16 v[102:103], v12 offset:9216
    v_mfma_f32_16x16x32_bf16 v[140:143], v[64:67], v[20:23], v[140:143]
    ds_read_b64_tr_b16 v[104:105], v13 offset:8192
    v_mfma_f32_16x16x32_bf16 v[144:147], v[52:55], v[24:27], v[144:147]
    ds_read_b64_tr_b16 v[106:107], v13 offset:9216
    v_mfma_f32_16x16x32_bf16 v[148:151], v[56:59], v[24:27], v[148:151]
    ds_read_b64_tr_b16 v[108:109], v14 offset:8192
    v_mfma_f32_16x16x32_bf16 v[152:155], v[60:63], v[24:27], v[152:155]
    ds_read_b64_tr_b16 v[110:111], v14 offset:9216
    v_mfma_f32_16x16x32_bf16 v[156:159], v[64:67], v[24:27], v[156:159]
    ds_read_b64_tr_b16 v[112:113], v15 offset:8192
    v_mfma_f32_16x16x32_bf16 v[160:163], v[52:55], v[28:31], v[160:163]
    ds_read_b64_tr_b16 v[114:115], v15 offset:9216
    v_mfma_f32_16x16x32_bf16 v[164:167], v[56:59], v[28:31], v[164:167]
    ds_read_b128 v[72:75], v11 offset:2048
    v_mfma_f32_16x16x32_bf16 v[168:171], v[60:63], v[28:31], v[168:171]
    ds_read_b128 v[76:79], v11 offset:4096
    v_mfma_f32_16x16x32_bf16 v[172:175], v[64:67], v[28:31], v[172:175]
    ds_read_b128 v[80:83], v11 offset:6144
    v_mfma_f32_16x16x32_bf16 v[176:179], v[52:55], v[32:35], v[176:179]
    ds_read_b128 v[84:87], v11 offset:8192
    v_mfma_f32_16x16x32_bf16 v[180:183], v[56:59], v[32:35], v[180:183]
    ds_read_b128 v[88:91], v11 offset:10240
    v_mfma_f32_16x16x32_bf16 v[184:187], v[60:63], v[32:35], v[184:187]
    ds_read_b128 v[92:95], v11 offset:12288
    v_mfma_f32_16x16x32_bf16 v[188:191], v[64:67], v[32:35], v[188:191]
    ds_read_b128 v[96:99], v11 offset:14336
    v_mfma_f32_16x16x32_bf16 v[192:195], v[52:55], v[36:39], v[192:195]
    v_mfma_f32_16x16x32_bf16 v[196:199], v[56:59], v[36:39], v[196:199]
    v_mfma_f32_16x16x32_bf16 v[200:203], v[60:63], v[36:39], v[200:203]
    v_mfma_f32_16x16x32_bf16 v[204:207], v[64:67], v[36:39], v[204:207]
    v_mfma_f32_16x16x32_bf16 v[208:211], v[52:55], v[40:43], v[208:211]
    v_mfma_f32_16x16x32_bf16 v[212:215], v[56:59], v[40:43], v[212:215]
    v_mfma_f32_16x16x32_bf16 v[216:219], v[60:63], v[40:43], v[216:219]
    v_mfma_f32_16x16x32_bf16 v[220:223], v[64:67], v[40:43], v[220:223]
    v_mfma_f32_16x16x32_bf16 v[224:227], v[52:55], v[44:47], v[224:227]
    v_mfma_f32_16x16x32_bf16 v[228:231], v[56:59], v[44:47], v[228:231]
    v_mfma_f32_16x16x32_bf16 v[232:235], v[60:63], v[44:47], v[232:235]
    v_mfma_f32_16x16x32_bf16 v[236:239], v[64:67], v[44:47], v[236:239]
    v_mfma_f32_16x16x32_bf16 v[240:243], v[52:55], v[48:51], v[240:243]
    v_mfma_f32_16x16x32_bf16 v[244:247], v[56:59], v[48:51], v[244:247]
    v_mfma_f32_16x16x32_bf16 v[248:251], v[60:63], v[48:51], v[248:251]
    v_mfma_f32_16x16x32_bf16 v[252:255], v[64:67], v[48:51], v[252:255]
    s_cmp_eq_u32 s35, 3
    s_cbranch_scc1 L_recurrent_scan__compressed_kv_cla__moe_arch_mod__prompt_kernel_rare_5
L_recurrent_scan__compressed_kv_cla__moe_arch_mod__prompt_kernel_back_6:
    s_cmp_lt_u32 s35, s44
    s_cbranch_scc1 L_recurrent_scan__compressed_kv_cla__moe_arch_mod__prompt_kernel_w0_7
    s_waitcnt vmcnt(1)
L_recurrent_scan__compressed_kv_cla__moe_arch_mod__prompt_kernel_w0b_8:
    s_waitcnt lgkmcnt(0)
    s_barrier
    v_mfma_f32_16x16x32_bf16 v[128:131], v[100:103], v[68:71], v[128:131]
    ds_read_b128 v[20:23], v10 offset:32768
    s_add_u32 m0, s33, 0
    v_mfma_f32_16x16x32_bf16 v[132:135], v[104:107], v[68:71], v[132:135]
    ds_read_b64_tr_b16 v[52:53], v12 offset:32768
    buffer_load_dwordx4 v2, s[4:7], s31 offen offset:0 lds
    v_mfma_f32_16x16x32_bf16 v[136:139], v[108:111], v[68:71], v[136:139]
    ds_read_b64_tr_b16 v[54:55], v12 offset:33792
    v_mfma_f32_16x16x32_bf16 v[140:143], v[112:115], v[68:71], v[140:143]
    ds_read_b64_tr_b16 v[56:57], v13 offset:32768
    v_mfma_f32_16x16x32_bf16 v[144:147], v[100:103], v[72:75], v[144:147]
    ds_read_b64_tr_b16 v[58:59], v13 offset:33792
    buffer_load_dwordx4 v3, s[4:7], s31 offen offset:1024 lds
    v_mfma_f32_16x16x32_bf16 v[148:151], v[104:107], v[72:75], v[148:151]
    ds_read_b64_tr_b16 v[60:61], v14 offset:32768
    v_mfma_f32_16x16x32_bf16 v[152:155], v[108:111], v[72:75], v[152:155]
    ds_read_b64_tr_b16 v[62:63], v14 offset:33792
    v_mfma_f32_16x16x32_bf16 v[156:159], v[112:115], v[72:75], v[156:159]
    ds_read_b64_tr_b16 v[64:65], v15 offset:32768
    buffer_load_dwordx4 v4, s[4:7], s31 offen offset:2048 lds
    v_mfma_f32_16x16x32_bf16 v[160:163], v[100:103], v[76:79], v[160:163]
    ds_read_b64_tr_b16 v[66:67], v15 offset:33792
    v_mfma_f32_16x16x32_bf16 v[164:167], v[104:107], v[76:79], v[164:167]
    ds_read_b128 v[24:27], v10 offset:34816
    v_mfma_f32_16x16x32_bf16 v[168:171], v[108:111], v[76:79], v[168:171]
    ds_read_b128 v[28:31], v10 offset:36864
    buffer_load_dwordx4 v5, s[4:7], s31 offen offset:3072 lds
    v_mfma_f32_16x16x32_bf16 v[172:175], v[112:115], v[76:79], v[172:175]
    ds_read_b128 v[32:35], v10 offset:38912
    v_mfma_f32_16x16x32_bf16 v[176:179], v[100:103], v[80:83], v[176:179]
    ds_read_b128 v[36:39], v10 offset:40960
    s_add_u32 m0, s34, 0
    v_mfma_f32_16x16x32_bf16 v[180:183], v[104:107], v[80:83], v[180:183]
    ds_read_b128 v[40:43], v10 offset:43008
    buffer_load_dwordx4 v6, s[8:11], s32 offen offset:0 nt lds
    v_mfma_f32_16x16x32_bf16 v[184:187], v[108:111], v[80:83], v[184:187]
    ds_read_b128 v[44:47], v10 offset:45056
    v_mfma_f32_16x16x32_bf16 v[188:191], v[112:115], v[80:83], v[188:191]
    ds_read_b128 v[48:51], v10 offset:47104
    v_mfma_f32_16x16x32_bf16 v[192:195], v[100:103], v[84:87], v[192:195]
    buffer_load_dwordx4 v7, s[8:11], s32 offen offset:1024 nt lds
    v_mfma_f32_16x16x32_bf16 v[196:199], v[104:107], v[84:87], v[196:199]
    v_mfma_f32_16x16x32_bf16 v[200:203], v[108:111], v[84:87], v[200:203]
    v_mfma_f32_16x16x32_bf16 v[204:207], v[112:115], v[84:87], v[204:207]
    buffer_load_dwordx4 v8, s[8:11], s32 offen offset:2048 nt lds
    v_mfma_f32_16x16x32_bf16 v[208:211], v[100:103], v[88:91], v[208:211]
    v_mfma_f32_16x16x32_bf16 v[212:215], v[104:107], v[88:91], v[212:215]
    v_mfma_f32_16x16x32_bf16 v[216:219], v[108:111], v[88:91], v[216:219]
    buffer_load_dwordx4 v9, s[8:11], s32 offen offset:3072 nt lds
    v_mfma_f32_16x16x32_bf16 v[220:223], v[112:115], v[88:91], v[220:223]
    v_mfma_f32_16x16x32_bf16 v[224:227], v[100:103], v[92:95], v[224:227]
    v_mfma_f32_16x16x32_bf16 v[228:231], v[104:107], v[92:95], v[228:231]
    v_mfma_f32_16x16x32_bf16 v[232:235], v[108:111], v[92:95], v[232:235]
    v_mfma_f32_16x16x32_bf16 v[236:239], v[112:115], v[92:95], v[236:239]
    v_mfma_f32_16x16x32_bf16 v[240:243], v[100:103], v[96:99], v[240:243]
    v_mfma_f32_16x16x32_bf16 v[244:247], v[104:107], v[96:99], v[244:247]
    v_mfma_f32_16x16x32_bf16 v[248:251], v[108:111], v[96:99], v[248:251]
    v_mfma_f32_16x16x32_bf16 v[252:255], v[112:115], v[96:99], v[252:255]
    s_bitcmp1_b32 6, s35
    s_cselect_b32 exec_lo, 255, 1
    s_mov_b32 exec_hi, 0
    global_load_dword v0, v17, s[96:97]
    s_mov_b64 exec, -1
    s_cselect_b32 s36, s45, 0
    v_add_u32 v17, s36, v17
    v_min_u32 v17, 8388480, v17
    s_nop 1
    s_add_u32 s31, s31, s40
    s_add_u32 s32, s32, s41
    s_waitcnt lgkmcnt(0)
    v_mfma_f32_16x16x32_bf16 v[128:131], v[52:55], v[20:23], v[128:131]
    ds_read_b128 v[68:71], v11 offset:32768
    v_mfma_f32_16x16x32_bf16 v[132:135], v[56:59], v[20:23], v[132:135]
    ds_read_b64_tr_b16 v[100:101], v12 offset:40960
    v_mfma_f32_16x16x32_bf16 v[136:139], v[60:63], v[20:23], v[136:139]
    ds_read_b64_tr_b16 v[102:103], v12 offset:41984
    v_mfma_f32_16x16x32_bf16 v[140:143], v[64:67], v[20:23], v[140:143]
    ds_read_b64_tr_b16 v[104:105], v13 offset:40960
    v_mfma_f32_16x16x32_bf16 v[144:147], v[52:55], v[24:27], v[144:147]
    ds_read_b64_tr_b16 v[106:107], v13 offset:41984
    v_mfma_f32_16x16x32_bf16 v[148:151], v[56:59], v[24:27], v[148:151]
    ds_read_b64_tr_b16 v[108:109], v14 offset:40960
    v_mfma_f32_16x16x32_bf16 v[152:155], v[60:63], v[24:27], v[152:155]
    ds_read_b64_tr_b16 v[110:111], v14 offset:41984
    v_mfma_f32_16x16x32_bf16 v[156:159], v[64:67], v[24:27], v[156:159]
    ds_read_b64_tr_b16 v[112:113], v15 offset:40960
    v_mfma_f32_16x16x32_bf16 v[160:163], v[52:55], v[28:31], v[160:163]
    ds_read_b64_tr_b16 v[114:115], v15 offset:41984
    v_mfma_f32_16x16x32_bf16 v[164:167], v[56:59], v[28:31], v[164:167]
    ds_read_b128 v[72:75], v11 offset:34816
    v_mfma_f32_16x16x32_bf16 v[168:171], v[60:63], v[28:31], v[168:171]
    ds_read_b128 v[76:79], v11 offset:36864
    v_mfma_f32_16x16x32_bf16 v[172:175], v[64:67], v[28:31], v[172:175]
    ds_read_b128 v[80:83], v11 offset:38912
    v_mfma_f32_16x16x32_bf16 v[176:179], v[52:55], v[32:35], v[176:179]
    ds_read_b128 v[84:87], v11 offset:40960
    v_mfma_f32_16x16x32_bf16 v[180:183], v[56:59], v[32:35], v[180:183]
    ds_read_b128 v[88:91], v11 offset:43008
    v_mfma_f32_16x16x32_bf16 v[184:187], v[60:63], v[32:35], v[184:187]
    ds_read_b128 v[92:95], v11 offset:45056
    v_mfma_f32_16x16x32_bf16 v[188:191], v[64:67], v[32:35], v[188:191]
    ds_read_b128 v[96:99], v11 offset:47104
    v_mfma_f32_16x16x32_bf16 v[192:195], v[52:55], v[36:39], v[192:195]
    v_mfma_f32_16x16x32_bf16 v[196:199], v[56:59], v[36:39], v[196:199]
    v_mfma_f32_16x16x32_bf16 v[200:203], v[60:63], v[36:39], v[200:203]
    v_mfma_f32_16x16x32_bf16 v[204:207], v[64:67], v[36:39], v[204:207]
    v_mfma_f32_16x16x32_bf16 v[208:211], v[52:55], v[40:43], v[208:211]
    s_bitcmp1_b32 s43, s35
    s_cbranch_scc1 L_recurrent_scan__compressed_kv_cla__moe_arch_mod__prompt_kernel_rare_13
L_recurrent_scan__compressed_kv_cla__moe_arch_mod__prompt_kernel_back_14:
    v_mfma_f32_16x16x32_bf16 v[212:215], v[56:59], v[40:43], v[212:215]
    v_mfma_f32_16x16x32_bf16 v[216:219], v[60:63], v[40:43], v[216:219]
    v_mfma_f32_16x16x32_bf16 v[220:223], v[64:67], v[40:43], v[220:223]
    v_mfma_f32_16x16x32_bf16 v[224:227], v[52:55], v[44:47], v[224:227]
    v_mfma_f32_16x16x32_bf16 v[228:231], v[56:59], v[44:47], v[228:231]
    v_mfma_f32_16x16x32_bf16 v[232:235], v[60:63], v[44:47], v[232:235]
    v_mfma_f32_16x16x32_bf16 v[236:239], v[64:67], v[44:47], v[236:239]
    v_mfma_f32_16x16x32_bf16 v[240:243], v[52:55], v[48:51], v[240:243]
    v_mfma_f32_16x16x32_bf16 v[244:247], v[56:59], v[48:51], v[244:247]
    v_mfma_f32_16x16x32_bf16 v[248:251], v[60:63], v[48:51], v[248:251]
    v_mfma_f32_16x16x32_bf16 v[252:255], v[64:67], v[48:51], v[252:255]
    s_bitcmp1_b32 s43, s35
    s_cbranch_scc1 L_recurrent_scan__compressed_kv_cla__moe_arch_mod__prompt_kernel_w0_15
    s_waitcnt vmcnt(1)
L_recurrent_scan__compressed_kv_cla__moe_arch_mod__prompt_kernel_w0b_16:
    s_waitcnt lgkmcnt(0)
    s_cmp_eq_u32 s35, 3
    s_barrier
    s_cbranch_scc1 L_p1_fin0
    v_mfma_f32_16x16x32_bf16 v[128:131], v[100:103], v[68:71], v[128:131]
    ds_read_b128 v[20:23], v10 offset:0
    s_add_u32 m0, s33, 32768
    v_mfma_f32_16x16x32_bf16 v[132:135], v[104:107], v[68:71], v[132:135]
    ds_read_b64_tr_b16 v[52:53], v12 offset:0
    buffer_load_dwordx4 v2, s[4:7], s31 offen offset:0 lds
    v_mfma_f32_16x16x32_bf16 v[136:139], v[108:111], v[68:71], v[136:139]
    ds_read_b64_tr_b16 v[54:55], v12 offset:1024
    v_mfma_f32_16x16x32_bf16 v[140:143], v[112:115], v[68:71], v[140:143]
    ds_read_b64_tr_b16 v[56:57], v13 offset:0
    v_mfma_f32_16x16x32_bf16 v[144:147], v[100:103], v[72:75], v[144:147]
    ds_read_b64_tr_b16 v[58:59], v13 offset:1024
    buffer_load_dwordx4 v3, s[4:7], s31 offen offset:1024 lds
    v_mfma_f32_16x16x32_bf16 v[148:151], v[104:107], v[72:75], v[148:151]
    ds_read_b64_tr_b16 v[60:61], v14 offset:0
    v_mfma_f32_16x16x32_bf16 v[152:155], v[108:111], v[72:75], v[152:155]
    ds_read_b64_tr_b16 v[62:63], v14 offset:1024
    v_mfma_f32_16x16x32_bf16 v[156:159], v[112:115], v[72:75], v[156:159]
    ds_read_b64_tr_b16 v[64:65], v15 offset:0
    buffer_load_dwordx4 v4, s[4:7], s31 offen offset:2048 lds
    v_mfma_f32_16x16x32_bf16 v[160:163], v[100:103], v[76:79], v[160:163]
    ds_read_b64_tr_b16 v[66:67], v15 offset:1024
    v_mfma_f32_16x16x32_bf16 v[164:167], v[104:107], v[76:79], v[164:167]
    ds_read_b128 v[24:27], v10 offset:2048
    v_mfma_f32_16x16x32_bf16 v[168:171], v[108:111], v[76:79], v[168:171]
    ds_read_b128 v[28:31], v10 offset:4096
    buffer_load_dwordx4 v5, s[4:7], s31 offen offset:3072 lds
    v_mfma_f32_16x16x32_bf16 v[172:175], v[112:115], v[76:79], v[172:175]
    ds_read_b128 v[32:35], v10 offset:6144
    v_mfma_f32_16x16x32_bf16 v[176:179], v[100:103], v[80:83], v[176:179]
    ds_read_b128 v[36:39], v10 offset:8192
    s_add_u32 m0, s34, 32768
    v_mfma_f32_16x16x32_bf16 v[180:183], v[104:107], v[80:83], v[180:183]
    ds_read_b128 v[40:43], v10 offset:10240
    buffer_load_dwordx4 v6, s[8:11], s32 offen offset:0 nt lds
    v_mfma_f32_16x16x32_bf16 v[184:187], v[108:111], v[80:83], v[184:187]
    ds_read_b128 v[44:47], v10 offset:12288
    v_mfma_f32_16x16x32_bf16 v[188:191], v[112:115], v[80:83], v[188:191]
    ds_read_b128 v[48:51], v10 offset:14336
    v_mfma_f32_16x16x32_bf16 v[192:195], v[100:103], v[84:87], v[192:195]
    buffer_load_dwordx4 v7, s[8:11], s32 offen offset:1024 nt lds
    v_mfma_f32_16x16x32_bf16 v[196:199], v[104:107], v[84:87], v[196:199]
    v_mfma_f32_16x16x32_bf16 v[200:203], v[108:111], v[84:87], v[200:203]
    v_mfma_f32_16x16x32_bf16 v[204:207], v[112:115], v[84:87], v[204:207]
    buffer_load_dwordx4 v8, s[8:11], s32 offen offset:2048 nt lds
    v_mfma_f32_16x16x32_bf16 v[208:211], v[100:103], v[88:91], v[208:211]
    v_mfma_f32_16x16x32_bf16 v[212:215], v[104:107], v[88:91], v[212:215]
    v_mfma_f32_16x16x32_bf16 v[216:219], v[108:111], v[88:91], v[216:219]
    buffer_load_dwordx4 v9, s[8:11], s32 offen offset:3072 nt lds
    v_mfma_f32_16x16x32_bf16 v[220:223], v[112:115], v[88:91], v[220:223]
    v_mfma_f32_16x16x32_bf16 v[224:227], v[100:103], v[92:95], v[224:227]
    v_mfma_f32_16x16x32_bf16 v[228:231], v[104:107], v[92:95], v[228:231]
    v_mfma_f32_16x16x32_bf16 v[232:235], v[108:111], v[92:95], v[232:235]
    v_mfma_f32_16x16x32_bf16 v[236:239], v[112:115], v[92:95], v[236:239]
    v_mfma_f32_16x16x32_bf16 v[240:243], v[100:103], v[96:99], v[240:243]
    v_mfma_f32_16x16x32_bf16 v[244:247], v[104:107], v[96:99], v[244:247]
    v_mfma_f32_16x16x32_bf16 v[248:251], v[108:111], v[96:99], v[248:251]
    s_add_u32 s36, s35, s28
    s_cmp_eq_u32 s36, 0
    s_cbranch_scc1 L_recurrent_scan__compressed_kv_cla__moe_arch_mod__prompt_kernel_rare_25
L_recurrent_scan__compressed_kv_cla__moe_arch_mod__prompt_kernel_back_26:
    v_mfma_f32_16x16x32_bf16 v[252:255], v[112:115], v[96:99], v[252:255]
    s_bitcmp1_b32 3, s35
    s_cselect_b32 exec_lo, 255, 1
    s_mov_b32 exec_hi, 0
    global_load_dword v0, v17, s[96:97]
    s_mov_b64 exec, -1
    s_cselect_b32 s36, s45, 0
    v_add_u32 v17, s36, v17
    v_min_u32 v17, 8388480, v17
    s_nop 1
    s_add_u32 s31, s31, s40
    s_add_u32 s32, s32, s41
    s_add_u32 s35, s35, 1
    s_branch L_kv_kloop
L_p1_fin0:
    v_mfma_f32_16x16x32_bf16 v[128:131], v[100:103], v[68:71], v[128:131]
    s_and_b32 s36, s28, 3
    s_sub_u32 s37, 15, s30
    s_cmp_lt_u32 s28, 4
    s_cselect_b32 s37, s37, s30
    s_lshl_b32 s37, s37, 2
    s_add_u32 s37, s37, s36
    s_lshl_b32 s37, s37, 16
    v_lshl_add_u32 v6, v1, 4, s37
    v_add_u32 v7, 32768, v6
    s_mov_b32 s32, 0
    s_mov_b32 s8, s54
    s_and_b32 s9, s55, 0xffff
    s_mov_b32 s10, 104857728
    s_mov_b32 s11, 0x20000
    v_mfma_f32_16x16x32_bf16 v[132:135], v[104:107], v[68:71], v[132:135]
    buffer_load_dwordx4 v[24:27], v6, s[8:11], s32 offen offset:0 sc1
    v_mfma_f32_16x16x32_bf16 v[136:139], v[108:111], v[68:71], v[136:139]
    v_lshrrev_b32 v18, 4, v1
    v_mfma_f32_16x16x32_bf16 v[140:143], v[112:115], v[68:71], v[140:143]
    v_bfe_u32 v20, v1, 2, 2
    v_mfma_f32_16x16x32_bf16 v[144:147], v[100:103], v[72:75], v[144:147]
    v_lshl_add_u32 v19, v18, 3, v20
    v_mfma_f32_16x16x32_bf16 v[148:151], v[104:107], v[72:75], v[148:151]
    buffer_load_dwordx4 v[28:31], v7, s[8:11], s32 offen offset:0 sc1
    v_lshlrev_b32 v19, 8, v19
    v_mfma_f32_16x16x32_bf16 v[152:155], v[108:111], v[72:75], v[152:155]
    v_and_b32 v21, 3, v1
    v_mfma_f32_16x16x32_bf16 v[156:159], v[112:115], v[72:75], v[156:159]
    v_lshl_add_u32 v19, v21, 3, v19
    v_mfma_f32_16x16x32_bf16 v[160:163], v[100:103], v[76:79], v[160:163]
    v_and_b32 v21, 1, v18
    v_mfma_f32_16x16x32_bf16 v[164:167], v[104:107], v[76:79], v[164:167]
    buffer_load_dwordx4 v[32:35], v6, s[8:11], s32 offen offset:1024 sc1
    v_lshl_add_u32 v20, v21, 2, v20
    v_mfma_f32_16x16x32_bf16 v[168:171], v[108:111], v[76:79], v[168:171]
    v_xor_b32 v21, 0, v20
    v_mfma_f32_16x16x32_bf16 v[172:175], v[112:115], v[76:79], v[172:175]
    v_lshl_add_u32 v10, v21, 5, v19
    v_mfma_f32_16x16x32_bf16 v[176:179], v[100:103], v[80:83], v[176:179]
    v_xor_b32 v21, 1, v20
    v_mfma_f32_16x16x32_bf16 v[180:183], v[104:107], v[80:83], v[180:183]
    buffer_load_dwordx4 v[36:39], v7, s[8:11], s32 offen offset:1024 sc1
    v_lshl_add_u32 v11, v21, 5, v19
    v_mfma_f32_16x16x32_bf16 v[184:187], v[108:111], v[80:83], v[184:187]
    v_xor_b32 v21, 2, v20
    v_mfma_f32_16x16x32_bf16 v[188:191], v[112:115], v[80:83], v[188:191]
    v_lshl_add_u32 v12, v21, 5, v19
    v_mfma_f32_16x16x32_bf16 v[192:195], v[100:103], v[84:87], v[192:195]
    v_xor_b32 v21, 3, v20
    v_mfma_f32_16x16x32_bf16 v[196:199], v[104:107], v[84:87], v[196:199]
    buffer_load_dwordx4 v[40:43], v6, s[8:11], s32 offen offset:2048 sc1
    v_lshl_add_u32 v13, v21, 5, v19
    v_mfma_f32_16x16x32_bf16 v[200:203], v[108:111], v[84:87], v[200:203]
    v_xor_b32 v21, 4, v20
    v_mfma_f32_16x16x32_bf16 v[204:207], v[112:115], v[84:87], v[204:207]
    v_lshl_add_u32 v14, v21, 5, v19
    v_mfma_f32_16x16x32_bf16 v[208:211], v[100:103], v[88:91], v[208:211]
    v_xor_b32 v21, 5, v20
    v_mfma_f32_16x16x32_bf16 v[212:215], v[104:107], v[88:91], v[212:215]
    buffer_load_dwordx4 v[44:47], v7, s[8:11], s32 offen offset:2048 sc1
    v_lshl_add_u32 v15, v21, 5, v19
    v_mfma_f32_16x16x32_bf16 v[216:219], v[108:111], v[88:91], v[216:219]
    v_xor_b32 v21, 6, v20
    v_mfma_f32_16x16x32_bf16 v[220:223], v[112:115], v[88:91], v[220:223]
    v_lshl_add_u32 v16, v21, 5, v19
    v_mfma_f32_16x16x32_bf16 v[224:227], v[100:103], v[92:95], v[224:227]
    v_xor_b32 v21, 7, v20
    v_mfma_f32_16x16x32_bf16 v[228:231], v[104:107], v[92:95], v[228:231]
    buffer_load_dwordx4 v[48:51], v6, s[8:11], s32 offen offset:3072 sc1
    v_lshl_add_u32 v17, v21, 5, v19
    v_mfma_f32_16x16x32_bf16 v[232:235], v[108:111], v[92:95], v[232:235]
    s_lshl_b32 s45, s29, 20
    v_mfma_f32_16x16x32_bf16 v[236:239], v[112:115], v[92:95], v[236:239]
    v_mfma_f32_16x16x32_bf16 v[240:243], v[100:103], v[96:99], v[240:243]
    v_mfma_f32_16x16x32_bf16 v[244:247], v[104:107], v[96:99], v[244:247]
    buffer_load_dwordx4 v[52:55], v7, s[8:11], s32 offen offset:3072 sc1
    v_mfma_f32_16x16x32_bf16 v[248:251], v[108:111], v[96:99], v[248:251]
    v_mfma_f32_16x16x32_bf16 v[252:255], v[112:115], v[96:99], v[252:255]
    s_branch L_p1_done
    .p2align 6
L_kv_vloop:
    s_waitcnt lgkmcnt(0)
    v_mfma_f32_16x16x32_bf16 v[128:131], v[20:23], v[52:55], v[128:131]
    ds_read_b128 v[68:71], v11 offset:0
    v_mfma_f32_16x16x32_bf16 v[160:163], v[20:23], v[56:59], v[160:163]
    ds_read_b64_tr_b16 v[100:101], v12 offset:8192
    v_mfma_f32_16x16x32_bf16 v[192:195], v[20:23], v[60:63], v[192:195]
    ds_read_b64_tr_b16 v[102:103], v12 offset:9216
    v_mfma_f32_16x16x32_bf16 v[224:227], v[20:23], v[64:67], v[224:227]
    ds_read_b64_tr_b16 v[104:105], v13 offset:8192
    v_mfma_f32_16x16x32_bf16 v[132:135], v[24:27], v[52:55], v[132:135]
    ds_read_b64_tr_b16 v[106:107], v13 offset:9216
    v_mfma_f32_16x16x32_bf16 v[164:167], v[24:27], v[56:59], v[164:167]
    ds_read_b64_tr_b16 v[108:109], v14 offset:8192
    v_mfma_f32_16x16x32_bf16 v[196:199], v[24:27], v[60:63], v[196:199]
    ds_read_b64_tr_b16 v[110:111], v14 offset:9216
    v_mfma_f32_16x16x32_bf16 v[228:231], v[24:27], v[64:67], v[228:231]
    ds_read_b64_tr_b16 v[112:113], v15 offset:8192
    v_mfma_f32_16x16x32_bf16 v[136:139], v[28:31], v[52:55], v[136:139]
    ds_read_b64_tr_b16 v[114:115], v15 offset:9216
    v_mfma_f32_16x16x32_bf16 v[168:171], v[28:31], v[56:59], v[168:171]
    ds_read_b128 v[72:75], v11 offset:2048
    v_mfma_f32_16x16x32_bf16 v[200:203], v[28:31], v[60:63], v[200:203]
    ds_read_b128 v[76:79], v11 offset:4096
    v_mfma_f32_16x16x32_bf16 v[232:235], v[28:31], v[64:67], v[232:235]
    ds_read_b128 v[80:83], v11 offset:6144
    v_mfma_f32_16x16x32_bf16 v[140:143], v[32:35], v[52:55], v[140:143]
    ds_read_b128 v[84:87], v11 offset:8192
    v_mfma_f32_16x16x32_bf16 v[172:175], v[32:35], v[56:59], v[172:175]
    ds_read_b128 v[88:91], v11 offset:10240
    v_mfma_f32_16x16x32_bf16 v[204:207], v[32:35], v[60:63], v[204:207]
    ds_read_b128 v[92:95], v11 offset:12288
    v_mfma_f32_16x16x32_bf16 v[236:239], v[32:35], v[64:67], v[236:239]
    ds_read_b128 v[96:99], v11 offset:14336
    v_mfma_f32_16x16x32_bf16 v[144:147], v[36:39], v[52:55], v[144:147]
    v_mfma_f32_16x16x32_bf16 v[176:179], v[36:39], v[56:59], v[176:179]
    v_mfma_f32_16x16x32_bf16 v[208:211], v[36:39], v[60:63], v[208:211]
    v_mfma_f32_16x16x32_bf16 v[240:243], v[36:39], v[64:67], v[240:243]
    v_mfma_f32_16x16x32_bf16 v[148:151], v[40:43], v[52:55], v[148:151]
    v_mfma_f32_16x16x32_bf16 v[180:183], v[40:43], v[56:59], v[180:183]
    v_mfma_f32_16x16x32_bf16 v[212:215], v[40:43], v[60:63], v[212:215]
    v_mfma_f32_16x16x32_bf16 v[244:247], v[40:43], v[64:67], v[244:247]
    v_mfma_f32_16x16x32_bf16 v[152:155], v[44:47], v[52:55], v[152:155]
    v_mfma_f32_16x16x32_bf16 v[184:187], v[44:47], v[56:59], v[184:187]
    v_mfma_f32_16x16x32_bf16 v[216:219], v[44:47], v[60:63], v[216:219]
    v_mfma_f32_16x16x32_bf16 v[248:251], v[44:47], v[64:67], v[248:251]
    v_mfma_f32_16x16x32_bf16 v[156:159], v[48:51], v[52:55], v[156:159]
    v_mfma_f32_16x16x32_bf16 v[188:191], v[48:51], v[56:59], v[188:191]
    v_mfma_f32_16x16x32_bf16 v[220:223], v[48:51], v[60:63], v[220:223]
    v_mfma_f32_16x16x32_bf16 v[252:255], v[48:51], v[64:67], v[252:255]
    s_cmp_lt_u32 s35, s44
    s_cbranch_scc1 L_recurrent_scan__compressed_kv_cla__moe_arch_mod__prompt_kernel_w0_27
    s_waitcnt vmcnt(1)
L_recurrent_scan__compressed_kv_cla__moe_arch_mod__prompt_kernel_w0b_28:
    s_waitcnt lgkmcnt(0)
    s_barrier
    s_add_u32 m0, s33, 0
    s_nop 0
    buffer_load_dwordx4 v2, s[4:7], s31 offen offset:0 lds
    buffer_load_dwordx4 v3, s[4:7], s31 offen offset:1024 lds
    buffer_load_dwordx4 v4, s[4:7], s31 offen offset:2048 lds
    buffer_load_dwordx4 v5, s[4:7], s31 offen offset:3072 lds
    s_add_u32 m0, s34, 0
    s_nop 0
    buffer_load_dwordx4 v6, s[8:11], s32 offen offset:0 nt lds
    buffer_load_dwordx4 v7, s[8:11], s32 offen offset:1024 nt lds
    buffer_load_dwordx4 v8, s[8:11], s32 offen offset:2048 nt lds
    buffer_load_dwordx4 v9, s[8:11], s32 offen offset:3072 nt lds
    s_add_u32 s31, s31, s40
    s_add_u32 s32, s32, s41
    s_cmp_eq_u32 s35, 0
    s_cbranch_scc1 L_recurrent_scan__compressed_kv_cla__moe_arch_mod__prompt_kernel_rare_32
L_recurrent_scan__compressed_kv_cla__moe_arch_mod__prompt_kernel_back_33:
    v_mfma_f32_16x16x32_bf16 v[128:131], v[68:71], v[100:103], v[128:131]
    ds_read_b128 v[20:23], v10 offset:32768
    v_mfma_f32_16x16x32_bf16 v[160:163], v[68:71], v[104:107], v[160:163]
    ds_read_b64_tr_b16 v[52:53], v12 offset:32768
    v_mfma_f32_16x16x32_bf16 v[192:195], v[68:71], v[108:111], v[192:195]
    ds_read_b64_tr_b16 v[54:55], v12 offset:33792
    v_mfma_f32_16x16x32_bf16 v[224:227], v[68:71], v[112:115], v[224:227]
    ds_read_b64_tr_b16 v[56:57], v13 offset:32768
    v_mfma_f32_16x16x32_bf16 v[132:135], v[72:75], v[100:103], v[132:135]
    ds_read_b64_tr_b16 v[58:59], v13 offset:33792
    v_mfma_f32_16x16x32_bf16 v[164:167], v[72:75], v[104:107], v[164:167]
    ds_read_b64_tr_b16 v[60:61], v14 offset:32768
    v_mfma_f32_16x16x32_bf16 v[196:199], v[72:75], v[108:111], v[196:199]
    ds_read_b64_tr_b16 v[62:63], v14 offset:33792
    v_mfma_f32_16x16x32_bf16 v[228:231], v[72:75], v[112:115], v[228:231]
    ds_read_b64_tr_b16 v[64:65], v15 offset:32768
    v_mfma_f32_16x16x32_bf16 v[136:139], v[76:79], v[100:103], v[136:139]
    ds_read_b64_tr_b16 v[66:67], v15 offset:33792
    v_mfma_f32_16x16x32_bf16 v[168:171], v[76:79], v[104:107], v[168:171]
    ds_read_b128 v[24:27], v10 offset:34816
    v_mfma_f32_16x16x32_bf16 v[200:203], v[76:79], v[108:111], v[200:203]
    ds_read_b128 v[28:31], v10 offset:36864
    v_mfma_f32_16x16x32_bf16 v[232:235], v[76:79], v[112:115], v[232:235]
    ds_read_b128 v[32:35], v10 offset:38912
    v_mfma_f32_16x16x32_bf16 v[140:143], v[80:83], v[100:103], v[140:143]
    ds_read_b128 v[36:39], v10 offset:40960
    v_mfma_f32_16x16x32_bf16 v[172:175], v[80:83], v[104:107], v[172:175]
    ds_read_b128 v[40:43], v10 offset:43008
    v_mfma_f32_16x16x32_bf16 v[204:207], v[80:83], v[108:111], v[204:207]
    ds_read_b128 v[44:47], v10 offset:45056
    v_mfma_f32_16x16x32_bf16 v[236:239], v[80:83], v[112:115], v[236:239]
    ds_read_b128 v[48:51], v10 offset:47104
    v_mfma_f32_16x16x32_bf16 v[144:147], v[84:87], v[100:103], v[144:147]
    v_mfma_f32_16x16x32_bf16 v[176:179], v[84:87], v[104:107], v[176:179]
    v_mfma_f32_16x16x32_bf16 v[208:211], v[84:87], v[108:111], v[208:211]
    v_mfma_f32_16x16x32_bf16 v[240:243], v[84:87], v[112:115], v[240:243]
    v_mfma_f32_16x16x32_bf16 v[148:151], v[88:91], v[100:103], v[148:151]
    v_mfma_f32_16x16x32_bf16 v[180:183], v[88:91], v[104:107], v[180:183]
    v_mfma_f32_16x16x32_bf16 v[212:215], v[88:91], v[108:111], v[212:215]
    v_mfma_f32_16x16x32_bf16 v[244:247], v[88:91], v[112:115], v[244:247]
    v_mfma_f32_16x16x32_bf16 v[152:155], v[92:95], v[100:103], v[152:155]
    v_mfma_f32_16x16x32_bf16 v[184:187], v[92:95], v[104:107], v[184:187]
    v_mfma_f32_16x16x32_bf16 v[216:219], v[92:95], v[108:111], v[216:219]
    v_mfma_f32_16x16x32_bf16 v[248:251], v[92:95], v[112:115], v[248:251]
    v_mfma_f32_16x16x32_bf16 v[156:159], v[96:99], v[100:103], v[156:159]
    v_mfma_f32_16x16x32_bf16 v[188:191], v[96:99], v[104:107], v[188:191]
    v_mfma_f32_16x16x32_bf16 v[220:223], v[96:99], v[108:111], v[220:223]
    v_mfma_f32_16x16x32_bf16 v[252:255], v[96:99], v[112:115], v[252:255]
    s_bitcmp1_b32 6, s35
    s_cselect_b32 exec_lo, 255, 1
    s_mov_b32 exec_hi, 0
    global_load_dword v0, v17, s[96:97]
    s_mov_b64 exec, -1
    s_cselect_b32 s36, s45, 0
    v_add_u32 v17, s36, v17
    v_min_u32 v17, 8388480, v17
    s_nop 1
    s_waitcnt lgkmcnt(0)
    v_mfma_f32_16x16x32_bf16 v[128:131], v[20:23], v[52:55], v[128:131]
    ds_read_b128 v[68:71], v11 offset:32768
    v_mfma_f32_16x16x32_bf16 v[160:163], v[20:23], v[56:59], v[160:163]
    ds_read_b64_tr_b16 v[100:101], v12 offset:40960
    v_mfma_f32_16x16x32_bf16 v[192:195], v[20:23], v[60:63], v[192:195]
    ds_read_b64_tr_b16 v[102:103], v12 offset:41984
    v_mfma_f32_16x16x32_bf16 v[224:227], v[20:23], v[64:67], v[224:227]
    ds_read_b64_tr_b16 v[104:105], v13 offset:40960
    v_mfma_f32_16x16x32_bf16 v[132:135], v[24:27], v[52:55], v[132:135]
    ds_read_b64_tr_b16 v[106:107], v13 offset:41984
    v_mfma_f32_16x16x32_bf16 v[164:167], v[24:27], v[56:59], v[164:167]
    ds_read_b64_tr_b16 v[108:109], v14 offset:40960
    v_mfma_f32_16x16x32_bf16 v[196:199], v[24:27], v[60:63], v[196:199]
    ds_read_b64_tr_b16 v[110:111], v14 offset:41984
    v_mfma_f32_16x16x32_bf16 v[228:231], v[24:27], v[64:67], v[228:231]
    ds_read_b64_tr_b16 v[112:113], v15 offset:40960
    v_mfma_f32_16x16x32_bf16 v[136:139], v[28:31], v[52:55], v[136:139]
    ds_read_b64_tr_b16 v[114:115], v15 offset:41984
    v_mfma_f32_16x16x32_bf16 v[168:171], v[28:31], v[56:59], v[168:171]
    ds_read_b128 v[72:75], v11 offset:34816
    v_mfma_f32_16x16x32_bf16 v[200:203], v[28:31], v[60:63], v[200:203]
    ds_read_b128 v[76:79], v11 offset:36864
    v_mfma_f32_16x16x32_bf16 v[232:235], v[28:31], v[64:67], v[232:235]
    ds_read_b128 v[80:83], v11 offset:38912
    v_mfma_f32_16x16x32_bf16 v[140:143], v[32:35], v[52:55], v[140:143]
    ds_read_b128 v[84:87], v11 offset:40960
    v_mfma_f32_16x16x32_bf16 v[172:175], v[32:35], v[56:59], v[172:175]
    ds_read_b128 v[88:91], v11 offset:43008
    v_mfma_f32_16x16x32_bf16 v[204:207], v[32:35], v[60:63], v[204:207]
    ds_read_b128 v[92:95], v11 offset:45056
    v_mfma_f32_16x16x32_bf16 v[236:239], v[32:35], v[64:67], v[236:239]
    ds_read_b128 v[96:99], v11 offset:47104
    v_mfma_f32_16x16x32_bf16 v[144:147], v[36:39], v[52:55], v[144:147]
    v_mfma_f32_16x16x32_bf16 v[176:179], v[36:39], v[56:59], v[176:179]
    v_mfma_f32_16x16x32_bf16 v[208:211], v[36:39], v[60:63], v[208:211]
    v_mfma_f32_16x16x32_bf16 v[240:243], v[36:39], v[64:67], v[240:243]
    v_mfma_f32_16x16x32_bf16 v[148:151], v[40:43], v[52:55], v[148:151]
    v_mfma_f32_16x16x32_bf16 v[180:183], v[40:43], v[56:59], v[180:183]
    v_mfma_f32_16x16x32_bf16 v[212:215], v[40:43], v[60:63], v[212:215]
    v_mfma_f32_16x16x32_bf16 v[244:247], v[40:43], v[64:67], v[244:247]
    v_mfma_f32_16x16x32_bf16 v[152:155], v[44:47], v[52:55], v[152:155]
    v_mfma_f32_16x16x32_bf16 v[184:187], v[44:47], v[56:59], v[184:187]
    v_mfma_f32_16x16x32_bf16 v[216:219], v[44:47], v[60:63], v[216:219]
    v_mfma_f32_16x16x32_bf16 v[248:251], v[44:47], v[64:67], v[248:251]
    v_mfma_f32_16x16x32_bf16 v[156:159], v[48:51], v[52:55], v[156:159]
    v_mfma_f32_16x16x32_bf16 v[188:191], v[48:51], v[56:59], v[188:191]
    v_mfma_f32_16x16x32_bf16 v[220:223], v[48:51], v[60:63], v[220:223]
    v_mfma_f32_16x16x32_bf16 v[252:255], v[48:51], v[64:67], v[252:255]
    s_waitcnt vmcnt(1) lgkmcnt(0)
    s_cmp_eq_u32 s35, 3
    s_barrier
    s_cbranch_scc1 L_p1_fin1
    s_add_u32 m0, s33, 32768
    s_nop 0
    buffer_load_dwordx4 v2, s[4:7], s31 offen offset:0 lds
    buffer_load_dwordx4 v3, s[4:7], s31 offen offset:1024 lds
    buffer_load_dwordx4 v4, s[4:7], s31 offen offset:2048 lds
    buffer_load_dwordx4 v5, s[4:7], s31 offen offset:3072 lds
    s_add_u32 m0, s34, 32768
    s_nop 0
    buffer_load_dwordx4 v6, s[8:11], s32 offen offset:0 nt lds
    buffer_load_dwordx4 v7, s[8:11], s32 offen offset:1024 nt lds
    buffer_load_dwordx4 v8, s[8:11], s32 offen offset:2048 nt lds
    buffer_load_dwordx4 v9, s[8:11], s32 offen offset:3072 nt lds
    s_add_u32 s31, s31, s40
    s_add_u32 s32, s32, s41
    s_cmp_eq_u32 s35, 2
    s_cbranch_scc1 L_recurrent_scan__compressed_kv_cla__moe_arch_mod__prompt_kernel_rare_36
L_recurrent_scan__compressed_kv_cla__moe_arch_mod__prompt_kernel_back_37:
    v_mfma_f32_16x16x32_bf16 v[128:131], v[68:71], v[100:103], v[128:131]
    ds_read_b128 v[20:23], v10 offset:0
    v_mfma_f32_16x16x32_bf16 v[160:163], v[68:71], v[104:107], v[160:163]
    ds_read_b64_tr_b16 v[52:53], v12 offset:0
    v_mfma_f32_16x16x32_bf16 v[192:195], v[68:71], v[108:111], v[192:195]
    ds_read_b64_tr_b16 v[54:55], v12 offset:1024
    v_mfma_f32_16x16x32_bf16 v[224:227], v[68:71], v[112:115], v[224:227]
    ds_read_b64_tr_b16 v[56:57], v13 offset:0
    v_mfma_f32_16x16x32_bf16 v[132:135], v[72:75], v[100:103], v[132:135]
    ds_read_b64_tr_b16 v[58:59], v13 offset:1024
    v_mfma_f32_16x16x32_bf16 v[164:167], v[72:75], v[104:107], v[164:167]
    ds_read_b64_tr_b16 v[60:61], v14 offset:0
    v_mfma_f32_16x16x32_bf16 v[196:199], v[72:75], v[108:111], v[196:199]
    ds_read_b64_tr_b16 v[62:63], v14 offset:1024
    v_mfma_f32_16x16x32_bf16 v[228:231], v[72:75], v[112:115], v[228:231]
    ds_read_b64_tr_b16 v[64:65], v15 offset:0
    v_mfma_f32_16x16x32_bf16 v[136:139], v[76:79], v[100:103], v[136:139]
    ds_read_b64_tr_b16 v[66:67], v15 offset:1024
    v_mfma_f32_16x16x32_bf16 v[168:171], v[76:79], v[104:107], v[168:171]
    ds_read_b128 v[24:27], v10 offset:2048
    v_mfma_f32_16x16x32_bf16 v[200:203], v[76:79], v[108:111], v[200:203]
    ds_read_b128 v[28:31], v10 offset:4096
    v_mfma_f32_16x16x32_bf16 v[232:235], v[76:79], v[112:115], v[232:235]
    ds_read_b128 v[32:35], v10 offset:6144
    v_mfma_f32_16x16x32_bf16 v[140:143], v[80:83], v[100:103], v[140:143]
    ds_read_b128 v[36:39], v10 offset:8192
    v_mfma_f32_16x16x32_bf16 v[172:175], v[80:83], v[104:107], v[172:175]
    ds_read_b128 v[40:43], v10 offset:10240
    v_mfma_f32_16x16x32_bf16 v[204:207], v[80:83], v[108:111], v[204:207]
    ds_read_b128 v[44:47], v10 offset:12288
    v_mfma_f32_16x16x32_bf16 v[236:239], v[80:83], v[112:115], v[236:239]
    ds_read_b128 v[48:51], v10 offset:14336
    v_mfma_f32_16x16x32_bf16 v[144:147], v[84:87], v[100:103], v[144:147]
    v_mfma_f32_16x16x32_bf16 v[176:179], v[84:87], v[104:107], v[176:179]
    v_mfma_f32_16x16x32_bf16 v[208:211], v[84:87], v[108:111], v[208:211]
    v_mfma_f32_16x16x32_bf16 v[240:243], v[84:87], v[112:115], v[240:243]
    v_mfma_f32_16x16x32_bf16 v[148:151], v[88:91], v[100:103], v[148:151]
    v_mfma_f32_16x16x32_bf16 v[180:183], v[88:91], v[104:107], v[180:183]
    v_mfma_f32_16x16x32_bf16 v[212:215], v[88:91], v[108:111], v[212:215]
    v_mfma_f32_16x16x32_bf16 v[244:247], v[88:91], v[112:115], v[244:247]
    v_mfma_f32_16x16x32_bf16 v[152:155], v[92:95], v[100:103], v[152:155]
    v_mfma_f32_16x16x32_bf16 v[184:187], v[92:95], v[104:107], v[184:187]
    v_mfma_f32_16x16x32_bf16 v[216:219], v[92:95], v[108:111], v[216:219]
    v_mfma_f32_16x16x32_bf16 v[248:251], v[92:95], v[112:115], v[248:251]
    v_mfma_f32_16x16x32_bf16 v[156:159], v[96:99], v[100:103], v[156:159]
    v_mfma_f32_16x16x32_bf16 v[188:191], v[96:99], v[104:107], v[188:191]
    v_mfma_f32_16x16x32_bf16 v[220:223], v[96:99], v[108:111], v[220:223]
    v_mfma_f32_16x16x32_bf16 v[252:255], v[96:99], v[112:115], v[252:255]
    s_bitcmp1_b32 3, s35
    s_cselect_b32 exec_lo, 255, 1
    s_mov_b32 exec_hi, 0
    global_load_dword v0, v17, s[96:97]
    s_mov_b64 exec, -1
    s_cselect_b32 s36, s45, 0
    v_add_u32 v17, s36, v17
    v_min_u32 v17, 8388480, v17
    s_nop 1
    s_add_u32 s35, s35, 1
    s_branch L_kv_vloop
L_p1_fin1:
    s_and_b32 s36, s28, 3
    s_sub_u32 s37, 15, s30
    s_cmp_lt_u32 s28, 4
    s_cselect_b32 s37, s37, s30
    s_lshl_b32 s37, s37, 2
    s_add_u32 s37, s37, s36
    s_lshl_b32 s37, s37, 16
    v_lshl_add_u32 v6, v1, 4, s37
    v_add_u32 v7, 32768, v6
    s_mov_b32 s32, 0
    s_mov_b32 s8, s54
    s_and_b32 s9, s55, 0xffff
    s_mov_b32 s10, 104857728
    s_mov_b32 s11, 0x20000
    v_mfma_f32_16x16x32_bf16 v[128:131], v[68:71], v[100:103], v[128:131]
    v_mfma_f32_16x16x32_bf16 v[160:163], v[68:71], v[104:107], v[160:163]
    buffer_load_dwordx4 v[24:27], v6, s[8:11], s32 offen offset:0 sc1
    v_mfma_f32_16x16x32_bf16 v[192:195], v[68:71], v[108:111], v[192:195]
    v_lshrrev_b32 v18, 4, v1
    v_mfma_f32_16x16x32_bf16 v[224:227], v[68:71], v[112:115], v[224:227]
    v_bfe_u32 v20, v1, 2, 2
    v_mfma_f32_16x16x32_bf16 v[132:135], v[72:75], v[100:103], v[132:135]
    v_lshl_add_u32 v19, v18, 3, v20
    v_mfma_f32_16x16x32_bf16 v[164:167], v[72:75], v[104:107], v[164:167]
    buffer_load_dwordx4 v[28:31], v7, s[8:11], s32 offen offset:0 sc1
    v_lshlrev_b32 v19, 8, v19
    v_mfma_f32_16x16x32_bf16 v[196:199], v[72:75], v[108:111], v[196:199]
    v_and_b32 v21, 3, v1
    v_mfma_f32_16x16x32_bf16 v[228:231], v[72:75], v[112:115], v[228:231]
    v_lshl_add_u32 v19, v21, 3, v19
    v_mfma_f32_16x16x32_bf16 v[136:139], v[76:79], v[100:103], v[136:139]
    v_and_b32 v21, 1, v18
    v_mfma_f32_16x16x32_bf16 v[168:171], v[76:79], v[104:107], v[168:171]
    buffer_load_dwordx4 v[32:35], v6, s[8:11], s32 offen offset:1024 sc1
    v_lshl_add_u32 v20, v21, 2, v20
    v_mfma_f32_16x16x32_bf16 v[200:203], v[76:79], v[108:111], v[200:203]
    v_xor_b32 v21, 0, v20
    v_mfma_f32_16x16x32_bf16 v[232:235], v[76:79], v[112:115], v[232:235]
    v_lshl_add_u32 v10, v21, 5, v19
    v_mfma_f32_16x16x32_bf16 v[140:143], v[80:83], v[100:103], v[140:143]
    v_xor_b32 v21, 1, v20
    v_mfma_f32_16x16x32_bf16 v[172:175], v[80:83], v[104:107], v[172:175]
    buffer_load_dwordx4 v[36:39], v7, s[8:11], s32 offen offset:1024 sc1
    v_lshl_add_u32 v11, v21, 5, v19
    v_mfma_f32_16x16x32_bf16 v[204:207], v[80:83], v[108:111], v[204:207]
    v_xor_b32 v21, 2, v20
    v_mfma_f32_16x16x32_bf16 v[236:239], v[80:83], v[112:115], v[236:239]
    v_lshl_add_u32 v12, v21, 5, v19
    v_mfma_f32_16x16x32_bf16 v[144:147], v[84:87], v[100:103], v[144:147]
    v_xor_b32 v21, 3, v20
    v_mfma_f32_16x16x32_bf16 v[176:179], v[84:87], v[104:107], v[176:179]
    buffer_load_dwordx4 v[40:43], v6, s[8:11], s32 offen offset:2048 sc1
    v_lshl_add_u32 v13, v21, 5, v19
    v_mfma_f32_16x16x32_bf16 v[208:211], v[84:87], v[108:111], v[208:211]
    v_xor_b32 v21, 4, v20
    v_mfma_f32_16x16x32_bf16 v[240:243], v[84:87], v[112:115], v[240:243]
    v_lshl_add_u32 v14, v21, 5, v19
    v_mfma_f32_16x16x32_bf16 v[148:151], v[88:91], v[100:103], v[148:151]
    v_xor_b32 v21, 5, v20
    v_mfma_f32_16x16x32_bf16 v[180:183], v[88:91], v[104:107], v[180:183]
    buffer_load_dwordx4 v[44:47], v7, s[8:11], s32 offen offset:2048 sc1
    v_lshl_add_u32 v15, v21, 5, v19
    v_mfma_f32_16x16x32_bf16 v[212:215], v[88:91], v[108:111], v[212:215]
    v_xor_b32 v21, 6, v20
    v_mfma_f32_16x16x32_bf16 v[244:247], v[88:91], v[112:115], v[244:247]
    v_lshl_add_u32 v16, v21, 5, v19
    v_mfma_f32_16x16x32_bf16 v[152:155], v[92:95], v[100:103], v[152:155]
    v_xor_b32 v21, 7, v20
    v_mfma_f32_16x16x32_bf16 v[184:187], v[92:95], v[104:107], v[184:187]
    buffer_load_dwordx4 v[48:51], v6, s[8:11], s32 offen offset:3072 sc1
    v_lshl_add_u32 v17, v21, 5, v19
    v_mfma_f32_16x16x32_bf16 v[216:219], v[92:95], v[108:111], v[216:219]
    s_lshl_b32 s45, s29, 20
    v_mfma_f32_16x16x32_bf16 v[248:251], v[92:95], v[112:115], v[248:251]
    v_mfma_f32_16x16x32_bf16 v[156:159], v[96:99], v[100:103], v[156:159]
    v_mfma_f32_16x16x32_bf16 v[188:191], v[96:99], v[104:107], v[188:191]
    buffer_load_dwordx4 v[52:55], v7, s[8:11], s32 offen offset:3072 sc1
    v_mfma_f32_16x16x32_bf16 v[220:223], v[96:99], v[108:111], v[220:223]
    v_mfma_f32_16x16x32_bf16 v[252:255], v[96:99], v[112:115], v[252:255]
L_p1_done:
    s_waitcnt vmcnt(8)
    ds_read_b64_tr_b16 v[64:65], v10 offset:0
    ds_read_b64_tr_b16 v[66:67], v10 offset:1024
    ds_read_b64_tr_b16 v[68:69], v11 offset:0
    ds_read_b64_tr_b16 v[70:71], v11 offset:1024
    ds_read_b64_tr_b16 v[72:73], v12 offset:0
    ds_read_b64_tr_b16 v[74:75], v12 offset:1024
    ds_read_b64_tr_b16 v[76:77], v13 offset:0
    ds_read_b64_tr_b16 v[78:79], v13 offset:1024
    ds_read_b64_tr_b16 v[80:81], v14 offset:0
    ds_read_b64_tr_b16 v[82:83], v14 offset:1024
    ds_read_b64_tr_b16 v[84:85], v15 offset:0
    ds_read_b64_tr_b16 v[86:87], v15 offset:1024
    s_add_u32 m0, s33, 32768
    s_add_u32 s32, s32, 4096
    v_cvt_pk_bf16_f32 v128, v128, v129
    v_cvt_pk_bf16_f32 v129, v130, v131
    v_cvt_pk_bf16_f32 v130, v132, v133
    v_cvt_pk_bf16_f32 v131, v134, v135
    v_cvt_pk_bf16_f32 v132, v136, v137
    v_cvt_pk_bf16_f32 v133, v138, v139
    buffer_load_dwordx4 v2, s[4:7], s31 offen offset:0 lds
    v_cvt_pk_bf16_f32 v134, v140, v141
    v_cvt_pk_bf16_f32 v135, v142, v143
    v_cvt_pk_bf16_f32 v136, v144, v145
    v_cvt_pk_bf16_f32 v137, v146, v147
    v_cvt_pk_bf16_f32 v138, v148, v149
    v_cvt_pk_bf16_f32 v139, v150, v151
    buffer_load_dwordx4 v3, s[4:7], s31 offen offset:1024 lds
    v_cvt_pk_bf16_f32 v140, v152, v153
    v_cvt_pk_bf16_f32 v141, v154, v155
    v_cvt_pk_bf16_f32 v142, v156, v157
    v_cvt_pk_bf16_f32 v143, v158, v159
    v_cvt_pk_bf16_f32 v144, v160, v161
    v_cvt_pk_bf16_f32 v145, v162, v163
    buffer_load_dwordx4 v4, s[4:7], s31 offen offset:2048 lds
    v_cvt_pk_bf16_f32 v146, v164, v165
    v_cvt_pk_bf16_f32 v147, v166, v167
    v_cvt_pk_bf16_f32 v148, v168, v169
    v_cvt_pk_bf16_f32 v149, v170, v171
    v_cvt_pk_bf16_f32 v150, v172, v173
    v_cvt_pk_bf16_f32 v151, v174, v175
    buffer_load_dwordx4 v5, s[4:7], s31 offen offset:3072 lds
    v_cvt_pk_bf16_f32 v152, v176, v177
    v_cvt_pk_bf16_f32 v153, v178, v179
    v_cvt_pk_bf16_f32 v154, v180, v181
    v_cvt_pk_bf16_f32 v155, v182, v183
    v_cvt_pk_bf16_f32 v156, v184, v185
    v_cvt_pk_bf16_f32 v157, v186, v187
    s_mov_b32 s31, 3145728
    s_add_u32 s34, s33, 98304
    v_cvt_pk_bf16_f32 v158, v188, v189
    v_cvt_pk_bf16_f32 v159, v190, v191
    v_cvt_pk_bf16_f32 v160, v192, v193
    v_cvt_pk_bf16_f32 v161, v194, v195
    v_cvt_pk_bf16_f32 v162, v196, v197
    v_cvt_pk_bf16_f32 v163, v198, v199
    buffer_load_dwordx4 v[96:99], v6, s[8:11], s32 offen offset:0 sc1
    v_cvt_pk_bf16_f32 v164, v200, v201
    v_cvt_pk_bf16_f32 v165, v202, v203
    v_cvt_pk_bf16_f32 v166, v204, v205
    v_cvt_pk_bf16_f32 v167, v206, v207
    v_cvt_pk_bf16_f32 v168, v208, v209
    v_cvt_pk_bf16_f32 v169, v210, v211
    buffer_load_dwordx4 v[100:103], v7, s[8:11], s32 offen offset:0 sc1
    v_cvt_pk_bf16_f32 v170, v212, v213
    v_cvt_pk_bf16_f32 v171, v214, v215
    v_cvt_pk_bf16_f32 v172, v216, v217
    v_cvt_pk_bf16_f32 v173, v218, v219
    v_cvt_pk_bf16_f32 v174, v220, v221
    v_cvt_pk_bf16_f32 v175, v222, v223
    buffer_load_dwordx4 v[104:107], v6, s[8:11], s32 offen offset:1024 sc1
    v_cvt_pk_bf16_f32 v176, v224, v225
    v_cvt_pk_bf16_f32 v177, v226, v227
    v_cvt_pk_bf16_f32 v178, v228, v229
    v_cvt_pk_bf16_f32 v179, v230, v231
    v_cvt_pk_bf16_f32 v180, v232, v233
    v_cvt_pk_bf16_f32 v181, v234, v235
    buffer_load_dwordx4 v[108:111], v7, s[8:11], s32 offen offset:1024 sc1
    v_cvt_pk_bf16_f32 v182, v236, v237
    v_cvt_pk_bf16_f32 v183, v238, v239
    v_cvt_pk_bf16_f32 v184, v240, v241
    v_cvt_pk_bf16_f32 v185, v242, v243
    v_cvt_pk_bf16_f32 v186, v244, v245
    v_cvt_pk_bf16_f32 v187, v246, v247
    buffer_load_dwordx4 v[112:115], v6, s[8:11], s32 offen offset:2048 sc1
    v_cvt_pk_bf16_f32 v188, v248, v249
    v_cvt_pk_bf16_f32 v189, v250, v251
    v_cvt_pk_bf16_f32 v190, v252, v253
    v_cvt_pk_bf16_f32 v191, v254, v255
    s_lshl_b32 s38, s29, 20
    s_lshl_b32 s37, s30, 17
    s_add_u32 s38, s38, s37
    s_bfe_u32 s37, s28, 0x10001
    s_lshl_b32 s37, s37, 16
    s_add_u32 s38, s38, s37
    s_lshr_b32 s36, s28, 2
    s_lshl_b32 s37, s36, 15
    s_add_u32 s38, s38, s37
    s_and_b32 s37, s28, 1
    s_add_u32 s36, s36, 11
    s_lshl_b32 s37, s37, s36
    s_add_u32 s38, s38, s37
    s_cmp_lt_u32 s28, 4
    s_cselect_b32 s36, 4, 32
    s_cselect_b32 s37, 16, 64
    s_cselect_b32 s39, 32, 4
    s_lshl_b32 s36, s36, 8
    s_lshl_b32 s37, s37, 8
    s_lshl_b32 s39, s39, 8
    s_mov_b64 s[16:17], s[12:13]
    s_mov_b64 s[18:19], s[14:15]
    s_cmp_eq_u32 s30, 0
    s_cselect_b32 s52, 2, 4
    v_lshlrev_b32 v58, 4, v1
    v_add_u32 v59, s36, v58
    v_add_u32 v60, s37, v58
    v_add_u32 v61, s36, v60
    v_mov_b64 v[192:193], 0
    v_mov_b64 v[194:195], 0
    v_mov_b64 v[196:197], 0
    v_mov_b64 v[198:199], 0
    v_mov_b64 v[200:201], 0
    v_mov_b64 v[202:203], 0
    v_mov_b64 v[204:205], 0
    v_mov_b64 v[206:207], 0
    v_mov_b64 v[208:209], 0
    v_mov_b64 v[210:211], 0
    v_mov_b64 v[212:213], 0
    v_mov_b64 v[214:215], 0
    v_mov_b64 v[216:217], 0
    v_mov_b64 v[218:219], 0
    v_mov_b64 v[220:221], 0
    v_mov_b64 v[222:223], 0
    v_mov_b64 v[224:225], 0
    v_mov_b64 v[226:227], 0
    v_mov_b64 v[228:229], 0
    v_mov_b64 v[230:231], 0
    v_mov_b64 v[232:233], 0
    v_mov_b64 v[234:235], 0
    v_mov_b64 v[236:237], 0
    v_mov_b64 v[238:239], 0
    v_mov_b64 v[240:241], 0
    v_mov_b64 v[242:243], 0
    v_mov_b64 v[244:245], 0
    v_mov_b64 v[246:247], 0
    v_mov_b64 v[248:249], 0
    v_mov_b64 v[250:251], 0
    v_mov_b64 v[252:253], 0
    v_mov_b64 v[254:255], 0
    buffer_load_dwordx4 v[116:119], v7, s[8:11], s32 offen offset:2048 sc1
    s_mov_b32 s35, 0
    s_mov_b32 s41, 0x1ffff
    s_waitcnt vmcnt(10)
    s_cmp_eq_u32 s30, 0
    s_cbranch_scc1 L_recurrent_scan__compressed_kv_cla__moe_arch_mod__prompt_kernel_rare_55
L_recurrent_scan__compressed_kv_cla__moe_arch_mod__prompt_kernel_back_56:
    .p2align 6
L_p2_loop:
    s_cmp_eq_u32 s35, 3
    s_cbranch_scc1 L_recurrent_scan__compressed_kv_cla__moe_arch_mod__prompt_kernel_rare_47
L_recurrent_scan__compressed_kv_cla__moe_arch_mod__prompt_kernel_back_48:
    s_waitcnt lgkmcnt(8)
    s_waitcnt vmcnt(22)
    v_mfma_f32_16x16x32_bf16 v[192:195], v[64:67], v[24:27], v[192:195]
    ds_read_b64_tr_b16 v[88:89], v16 offset:0
    v_mfma_f32_16x16x32_bf16 v[224:227], v[64:67], v[28:31], v[224:227]
    ds_read_b64_tr_b16 v[90:91], v16 offset:1024
    v_mfma_f32_16x16x32_bf16 v[196:199], v[68:71], v[24:27], v[196:199]
    ds_read_b64_tr_b16 v[92:93], v17 offset:0
    buffer_load_dwordx4 v[120:123], v6, s[8:11], s32 offen offset:3072 sc1
    v_mfma_f32_16x16x32_bf16 v[228:231], v[68:71], v[28:31], v[228:231]
    ds_read_b64_tr_b16 v[94:95], v17 offset:1024
    s_waitcnt lgkmcnt(8)
    v_mfma_f32_16x16x32_bf16 v[200:203], v[72:75], v[24:27], v[200:203]
    ds_read_b64_tr_b16 v[64:65], v10 offset:8192
    v_mfma_f32_16x16x32_bf16 v[232:235], v[72:75], v[28:31], v[232:235]
    ds_read_b64_tr_b16 v[66:67], v10 offset:9216
    v_mfma_f32_16x16x32_bf16 v[204:207], v[76:79], v[24:27], v[204:207]
    ds_read_b64_tr_b16 v[68:69], v11 offset:8192
    buffer_load_dwordx4 v[124:127], v7, s[8:11], s32 offen offset:3072 sc1
    v_mfma_f32_16x16x32_bf16 v[236:239], v[76:79], v[28:31], v[236:239]
    ds_read_b64_tr_b16 v[70:71], v11 offset:9216
    s_add_u32 s32, s32, 4096
    s_cmp_lt_u32 s35, s52
    s_cselect_b32 s18, s18, 0
    s_waitcnt lgkmcnt(8)
    v_mfma_f32_16x16x32_bf16 v[208:211], v[80:83], v[24:27], v[208:211]
    ds_read_b64_tr_b16 v[72:73], v12 offset:8192
    s_cmp_lt_u32 s35, 3
    s_cselect_b32 s10, s10, 0
    v_mfma_f32_16x16x32_bf16 v[240:243], v[80:83], v[28:31], v[240:243]
    ds_read_b64_tr_b16 v[74:75], v12 offset:9216
    v_mfma_f32_16x16x32_bf16 v[212:215], v[84:87], v[24:27], v[212:215]
    ds_read_b64_tr_b16 v[76:77], v13 offset:8192
    buffer_store_dwordx4 v[128:131], v58, s[16:19], s38 offen sc1
    v_mfma_f32_16x16x32_bf16 v[244:247], v[84:87], v[28:31], v[244:247]
    ds_read_b64_tr_b16 v[78:79], v13 offset:9216
    s_mov_b32 m0, s34
    s_waitcnt lgkmcnt(8)
    v_mfma_f32_16x16x32_bf16 v[216:219], v[88:91], v[24:27], v[216:219]
    ds_read_b64_tr_b16 v[80:81], v14 offset:8192
    v_mov_b64 v[128:129], v[144:145]
    buffer_load_dwordx4 v2, s[4:7], s31 offen offset:0 sc1 lds
    v_mfma_f32_16x16x32_bf16 v[248:251], v[88:91], v[28:31], v[248:251]
    ds_read_b64_tr_b16 v[82:83], v14 offset:9216
    v_mfma_f32_16x16x32_bf16 v[220:223], v[92:95], v[24:27], v[220:223]
    ds_read_b64_tr_b16 v[84:85], v15 offset:8192
    v_mov_b64 v[130:131], v[146:147]
    v_mfma_f32_16x16x32_bf16 v[252:255], v[92:95], v[28:31], v[252:255]
    ds_read_b64_tr_b16 v[86:87], v15 offset:9216
    s_waitcnt lgkmcnt(8)
    s_waitcnt vmcnt(22)
    v_mfma_f32_16x16x32_bf16 v[192:195], v[64:67], v[32:35], v[192:195]
    ds_read_b64_tr_b16 v[88:89], v16 offset:8192
    v_mov_b64 v[144:145], v[160:161]
    v_mfma_f32_16x16x32_bf16 v[224:227], v[64:67], v[36:39], v[224:227]
    ds_read_b64_tr_b16 v[90:91], v16 offset:9216
    v_mfma_f32_16x16x32_bf16 v[196:199], v[68:71], v[32:35], v[196:199]
    ds_read_b64_tr_b16 v[92:93], v17 offset:8192
    buffer_load_dwordx4 v[24:27], v6, s[8:11], s32 offen offset:0 sc1
    v_mov_b64 v[146:147], v[162:163]
    v_mfma_f32_16x16x32_bf16 v[228:231], v[68:71], v[36:39], v[228:231]
    ds_read_b64_tr_b16 v[94:95], v17 offset:9216
    s_waitcnt lgkmcnt(8)
    v_mfma_f32_16x16x32_bf16 v[200:203], v[72:75], v[32:35], v[200:203]
    ds_read_b64_tr_b16 v[64:65], v10 offset:16384
    v_mov_b64 v[160:161], v[176:177]
    v_mfma_f32_16x16x32_bf16 v[232:235], v[72:75], v[36:39], v[232:235]
    ds_read_b64_tr_b16 v[66:67], v10 offset:17408
    v_mfma_f32_16x16x32_bf16 v[204:207], v[76:79], v[32:35], v[204:207]
    ds_read_b64_tr_b16 v[68:69], v11 offset:16384
    buffer_load_dwordx4 v[28:31], v7, s[8:11], s32 offen offset:0 sc1
    v_mov_b64 v[162:163], v[178:179]
    v_mfma_f32_16x16x32_bf16 v[236:239], v[76:79], v[36:39], v[236:239]
    ds_read_b64_tr_b16 v[70:71], v11 offset:17408
    s_waitcnt lgkmcnt(8)
    v_mfma_f32_16x16x32_bf16 v[208:211], v[80:83], v[32:35], v[208:211]
    ds_read_b64_tr_b16 v[72:73], v12 offset:16384
    v_mfma_f32_16x16x32_bf16 v[240:243], v[80:83], v[36:39], v[240:243]
    ds_read_b64_tr_b16 v[74:75], v12 offset:17408
    v_mfma_f32_16x16x32_bf16 v[212:215], v[84:87], v[32:35], v[212:215]
    ds_read_b64_tr_b16 v[76:77], v13 offset:16384
    v_mfma_f32_16x16x32_bf16 v[244:247], v[84:87], v[36:39], v[244:247]
    ds_read_b64_tr_b16 v[78:79], v13 offset:17408
    s_waitcnt lgkmcnt(8)
    v_mfma_f32_16x16x32_bf16 v[216:219], v[88:91], v[32:35], v[216:219]
    ds_read_b64_tr_b16 v[80:81], v14 offset:16384
    buffer_load_dwordx4 v3, s[4:7], s31 offen offset:1024 sc1 lds
    v_mfma_f32_16x16x32_bf16 v[248:251], v[88:91], v[36:39], v[248:251]
    ds_read_b64_tr_b16 v[82:83], v14 offset:17408
    v_mfma_f32_16x16x32_bf16 v[220:223], v[92:95], v[32:35], v[220:223]
    ds_read_b64_tr_b16 v[84:85], v15 offset:16384
    buffer_store_dwordx4 v[132:135], v59, s[16:19], s38 offen sc1
    v_mfma_f32_16x16x32_bf16 v[252:255], v[92:95], v[36:39], v[252:255]
    ds_read_b64_tr_b16 v[86:87], v15 offset:17408
    s_waitcnt lgkmcnt(8)
    s_waitcnt vmcnt(23)
    v_mfma_f32_16x16x32_bf16 v[192:195], v[64:67], v[40:43], v[192:195]
    ds_read_b64_tr_b16 v[88:89], v16 offset:16384
    v_mov_b64 v[132:133], v[148:149]
    v_mfma_f32_16x16x32_bf16 v[224:227], v[64:67], v[44:47], v[224:227]
    ds_read_b64_tr_b16 v[90:91], v16 offset:17408
    v_mfma_f32_16x16x32_bf16 v[196:199], v[68:71], v[40:43], v[196:199]
    ds_read_b64_tr_b16 v[92:93], v17 offset:16384
    buffer_load_dwordx4 v[32:35], v6, s[8:11], s32 offen offset:1024 sc1
    v_mov_b64 v[134:135], v[150:151]
    v_mfma_f32_16x16x32_bf16 v[228:231], v[68:71], v[44:47], v[228:231]
    ds_read_b64_tr_b16 v[94:95], v17 offset:17408
    s_waitcnt lgkmcnt(8)
    v_mfma_f32_16x16x32_bf16 v[200:203], v[72:75], v[40:43], v[200:203]
    ds_read_b64_tr_b16 v[64:65], v10 offset:24576
    v_mov_b64 v[148:149], v[164:165]
    v_mfma_f32_16x16x32_bf16 v[232:235], v[72:75], v[44:47], v[232:235]
    ds_read_b64_tr_b16 v[66:67], v10 offset:25600
    v_mfma_f32_16x16x32_bf16 v[204:207], v[76:79], v[40:43], v[204:207]
    ds_read_b64_tr_b16 v[68:69], v11 offset:24576
    buffer_load_dwordx4 v[36:39], v7, s[8:11], s32 offen offset:1024 sc1
    v_mov_b64 v[150:151], v[166:167]
    v_mfma_f32_16x16x32_bf16 v[236:239], v[76:79], v[44:47], v[236:239]
    ds_read_b64_tr_b16 v[70:71], v11 offset:25600
    s_waitcnt lgkmcnt(8)
    v_mfma_f32_16x16x32_bf16 v[208:211], v[80:83], v[40:43], v[208:211]
    ds_read_b64_tr_b16 v[72:73], v12 offset:24576
    v_mov_b64 v[164:165], v[180:181]
    v_mfma_f32_16x16x32_bf16 v[240:243], v[80:83], v[44:47], v[240:243]
    ds_read_b64_tr_b16 v[74:75], v12 offset:25600
    v_mfma_f32_16x16x32_bf16 v[212:215], v[84:87], v[40:43], v[212:215]
    ds_read_b64_tr_b16 v[76:77], v13 offset:24576
    v_mov_b64 v[166:167], v[182:183]
    v_mfma_f32_16x16x32_bf16 v[244:247], v[84:87], v[44:47], v[244:247]
    ds_read_b64_tr_b16 v[78:79], v13 offset:25600
    s_waitcnt lgkmcnt(8)
    v_mfma_f32_16x16x32_bf16 v[216:219], v[88:91], v[40:43], v[216:219]
    ds_read_b64_tr_b16 v[80:81], v14 offset:24576
    buffer_load_dwordx4 v4, s[4:7], s31 offen offset:2048 sc1 lds
    v_mfma_f32_16x16x32_bf16 v[248:251], v[88:91], v[44:47], v[248:251]
    ds_read_b64_tr_b16 v[82:83], v14 offset:25600
    v_mfma_f32_16x16x32_bf16 v[220:223], v[92:95], v[40:43], v[220:223]
    ds_read_b64_tr_b16 v[84:85], v15 offset:24576
    v_mfma_f32_16x16x32_bf16 v[252:255], v[92:95], v[44:47], v[252:255]
    ds_read_b64_tr_b16 v[86:87], v15 offset:25600
    s_waitcnt lgkmcnt(8)
    s_waitcnt vmcnt(23)
    v_mfma_f32_16x16x32_bf16 v[192:195], v[64:67], v[48:51], v[192:195]
    ds_read_b64_tr_b16 v[88:89], v16 offset:24576
    v_mfma_f32_16x16x32_bf16 v[224:227], v[64:67], v[52:55], v[224:227]
    ds_read_b64_tr_b16 v[90:91], v16 offset:25600
    v_mfma_f32_16x16x32_bf16 v[196:199], v[68:71], v[48:51], v[196:199]
    ds_read_b64_tr_b16 v[92:93], v17 offset:24576
    buffer_load_dwordx4 v[40:43], v6, s[8:11], s32 offen offset:2048 sc1
    v_mfma_f32_16x16x32_bf16 v[228:231], v[68:71], v[52:55], v[228:231]
    ds_read_b64_tr_b16 v[94:95], v17 offset:25600
    s_waitcnt lgkmcnt(8)
    v_mfma_f32_16x16x32_bf16 v[200:203], v[72:75], v[48:51], v[200:203]
    v_mfma_f32_16x16x32_bf16 v[232:235], v[72:75], v[52:55], v[232:235]
    v_mfma_f32_16x16x32_bf16 v[204:207], v[76:79], v[48:51], v[204:207]
    buffer_load_dwordx4 v[44:47], v7, s[8:11], s32 offen offset:2048 sc1
    v_mfma_f32_16x16x32_bf16 v[236:239], v[76:79], v[52:55], v[236:239]
    s_cmp_eq_u32 s35, 3
    s_cbranch_scc1 L_recurrent_scan__compressed_kv_cla__moe_arch_mod__prompt_kernel_rare_45
L_recurrent_scan__compressed_kv_cla__moe_arch_mod__prompt_kernel_back_46:
    s_waitcnt lgkmcnt(0)
    s_waitcnt vmcnt(19)
    s_cmp_eq_u32 s35, s52
    s_cbranch_scc1 L_recurrent_scan__compressed_kv_cla__moe_arch_mod__prompt_kernel_rare_53
L_recurrent_scan__compressed_kv_cla__moe_arch_mod__prompt_kernel_back_54:
    s_barrier
    v_mfma_f32_16x16x32_bf16 v[208:211], v[80:83], v[48:51], v[208:211]
    ds_read_b64_tr_b16 v[64:65], v10 offset:32768
    ds_read_b64_tr_b16 v[66:67], v10 offset:33792
    v_mfma_f32_16x16x32_bf16 v[240:243], v[80:83], v[52:55], v[240:243]
    ds_read_b64_tr_b16 v[68:69], v11 offset:32768
    ds_read_b64_tr_b16 v[70:71], v11 offset:33792
    v_mfma_f32_16x16x32_bf16 v[212:215], v[84:87], v[48:51], v[212:215]
    ds_read_b64_tr_b16 v[72:73], v12 offset:32768
    ds_read_b64_tr_b16 v[74:75], v12 offset:33792
    v_mfma_f32_16x16x32_bf16 v[244:247], v[84:87], v[52:55], v[244:247]
    ds_read_b64_tr_b16 v[76:77], v13 offset:32768
    ds_read_b64_tr_b16 v[78:79], v13 offset:33792
    v_mfma_f32_16x16x32_bf16 v[216:219], v[88:91], v[48:51], v[216:219]
    ds_read_b64_tr_b16 v[80:81], v14 offset:32768
    ds_read_b64_tr_b16 v[82:83], v14 offset:33792
    buffer_load_dwordx4 v5, s[4:7], s31 offen offset:3072 sc1 lds
    v_mfma_f32_16x16x32_bf16 v[248:251], v[88:91], v[52:55], v[248:251]
    s_add_u32 s31, s31, s40
    s_add_u32 s34, s34, 32768
    s_and_b32 s34, s34, s41
    v_mfma_f32_16x16x32_bf16 v[220:223], v[92:95], v[48:51], v[220:223]
    ds_read_b64_tr_b16 v[84:85], v15 offset:32768
    ds_read_b64_tr_b16 v[86:87], v15 offset:33792
    v_mfma_f32_16x16x32_bf16 v[252:255], v[92:95], v[52:55], v[252:255]
    s_cmp_ge_u32 s35, 2
    s_cbranch_scc1 L_recurrent_scan__compressed_kv_cla__moe_arch_mod__prompt_kernel_rare_51
L_recurrent_scan__compressed_kv_cla__moe_arch_mod__prompt_kernel_back_52:
    s_waitcnt lgkmcnt(8)
    s_waitcnt vmcnt(18)
    v_mfma_f32_16x16x32_bf16 v[192:195], v[64:67], v[96:99], v[192:195]
    ds_read_b64_tr_b16 v[88:89], v16 offset:32768
    v_mfma_f32_16x16x32_bf16 v[224:227], v[64:67], v[100:103], v[224:227]
    ds_read_b64_tr_b16 v[90:91], v16 offset:33792
    v_mfma_f32_16x16x32_bf16 v[196:199], v[68:71], v[96:99], v[196:199]
    ds_read_b64_tr_b16 v[92:93], v17 offset:32768
    buffer_load_dwordx4 v[48:51], v6, s[8:11], s32 offen offset:3072 sc1
    v_mfma_f32_16x16x32_bf16 v[228:231], v[68:71], v[100:103], v[228:231]
    ds_read_b64_tr_b16 v[94:95], v17 offset:33792
    s_waitcnt lgkmcnt(8)
    v_mfma_f32_16x16x32_bf16 v[200:203], v[72:75], v[96:99], v[200:203]
    ds_read_b64_tr_b16 v[64:65], v10 offset:40960
    v_mfma_f32_16x16x32_bf16 v[232:235], v[72:75], v[100:103], v[232:235]
    ds_read_b64_tr_b16 v[66:67], v10 offset:41984
    v_mfma_f32_16x16x32_bf16 v[204:207], v[76:79], v[96:99], v[204:207]
    ds_read_b64_tr_b16 v[68:69], v11 offset:40960
    buffer_load_dwordx4 v[52:55], v7, s[8:11], s32 offen offset:3072 sc1
    v_mfma_f32_16x16x32_bf16 v[236:239], v[76:79], v[100:103], v[236:239]
    ds_read_b64_tr_b16 v[70:71], v11 offset:41984
    s_add_u32 s32, s32, 4096
    s_waitcnt lgkmcnt(8)
    v_mfma_f32_16x16x32_bf16 v[208:211], v[80:83], v[96:99], v[208:211]
    ds_read_b64_tr_b16 v[72:73], v12 offset:40960
    v_mfma_f32_16x16x32_bf16 v[240:243], v[80:83], v[100:103], v[240:243]
    ds_read_b64_tr_b16 v[74:75], v12 offset:41984
    v_mfma_f32_16x16x32_bf16 v[212:215], v[84:87], v[96:99], v[212:215]
    ds_read_b64_tr_b16 v[76:77], v13 offset:40960
    buffer_store_dwordx4 v[136:139], v60, s[16:19], s38 offen sc1
    v_mfma_f32_16x16x32_bf16 v[244:247], v[84:87], v[100:103], v[244:247]
    ds_read_b64_tr_b16 v[78:79], v13 offset:41984
    s_mov_b32 m0, s34
    s_waitcnt lgkmcnt(8)
    v_mfma_f32_16x16x32_bf16 v[216:219], v[88:91], v[96:99], v[216:219]
    ds_read_b64_tr_b16 v[80:81], v14 offset:40960
    v_mov_b64 v[136:137], v[152:153]
    buffer_load_dwordx4 v2, s[4:7], s31 offen offset:0 sc1 lds
    v_mfma_f32_16x16x32_bf16 v[248:251], v[88:91], v[100:103], v[248:251]
    ds_read_b64_tr_b16 v[82:83], v14 offset:41984
    v_mfma_f32_16x16x32_bf16 v[220:223], v[92:95], v[96:99], v[220:223]
    ds_read_b64_tr_b16 v[84:85], v15 offset:40960
    v_mov_b64 v[138:139], v[154:155]
    v_mfma_f32_16x16x32_bf16 v[252:255], v[92:95], v[100:103], v[252:255]
    ds_read_b64_tr_b16 v[86:87], v15 offset:41984
    s_waitcnt lgkmcnt(8)
    s_waitcnt vmcnt(20)
    v_mfma_f32_16x16x32_bf16 v[192:195], v[64:67], v[104:107], v[192:195]
    ds_read_b64_tr_b16 v[88:89], v16 offset:40960
    v_mov_b64 v[152:153], v[168:169]
    v_mfma_f32_16x16x32_bf16 v[224:227], v[64:67], v[108:111], v[224:227]
    ds_read_b64_tr_b16 v[90:91], v16 offset:41984
    v_mfma_f32_16x16x32_bf16 v[196:199], v[68:71], v[104:107], v[196:199]
    ds_read_b64_tr_b16 v[92:93], v17 offset:40960
    buffer_load_dwordx4 v[96:99], v6, s[8:11], s32 offen offset:0 sc1
    v_mov_b64 v[154:155], v[170:171]
    v_mfma_f32_16x16x32_bf16 v[228:231], v[68:71], v[108:111], v[228:231]
    ds_read_b64_tr_b16 v[94:95], v17 offset:41984
    s_waitcnt lgkmcnt(8)
    v_mfma_f32_16x16x32_bf16 v[200:203], v[72:75], v[104:107], v[200:203]
    ds_read_b64_tr_b16 v[64:65], v10 offset:49152
    v_mov_b64 v[168:169], v[184:185]
    v_mfma_f32_16x16x32_bf16 v[232:235], v[72:75], v[108:111], v[232:235]
    ds_read_b64_tr_b16 v[66:67], v10 offset:50176
    v_mfma_f32_16x16x32_bf16 v[204:207], v[76:79], v[104:107], v[204:207]
    ds_read_b64_tr_b16 v[68:69], v11 offset:49152
    buffer_load_dwordx4 v[100:103], v7, s[8:11], s32 offen offset:0 sc1
    v_mov_b64 v[170:171], v[186:187]
    v_mfma_f32_16x16x32_bf16 v[236:239], v[76:79], v[108:111], v[236:239]
    ds_read_b64_tr_b16 v[70:71], v11 offset:50176
    s_waitcnt lgkmcnt(8)
    v_mfma_f32_16x16x32_bf16 v[208:211], v[80:83], v[104:107], v[208:211]
    ds_read_b64_tr_b16 v[72:73], v12 offset:49152
    v_mfma_f32_16x16x32_bf16 v[240:243], v[80:83], v[108:111], v[240:243]
    ds_read_b64_tr_b16 v[74:75], v12 offset:50176
    v_mfma_f32_16x16x32_bf16 v[212:215], v[84:87], v[104:107], v[212:215]
    ds_read_b64_tr_b16 v[76:77], v13 offset:49152
    v_mfma_f32_16x16x32_bf16 v[244:247], v[84:87], v[108:111], v[244:247]
    ds_read_b64_tr_b16 v[78:79], v13 offset:50176
    s_waitcnt lgkmcnt(8)
    v_mfma_f32_16x16x32_bf16 v[216:219], v[88:91], v[104:107], v[216:219]
    ds_read_b64_tr_b16 v[80:81], v14 offset:49152
    buffer_load_dwordx4 v3, s[4:7], s31 offen offset:1024 sc1 lds
    v_mfma_f32_16x16x32_bf16 v[248:251], v[88:91], v[108:111], v[248:251]
    ds_read_b64_tr_b16 v[82:83], v14 offset:50176
    v_mfma_f32_16x16x32_bf16 v[220:223], v[92:95], v[104:107], v[220:223]
    ds_read_b64_tr_b16 v[84:85], v15 offset:49152
    buffer_store_dwordx4 v[140:143], v61, s[16:19], s38 offen sc1
    v_mfma_f32_16x16x32_bf16 v[252:255], v[92:95], v[108:111], v[252:255]
    ds_read_b64_tr_b16 v[86:87], v15 offset:50176
    s_add_u32 s38, s38, s39
    s_waitcnt lgkmcnt(8)
    s_waitcnt vmcnt(22)
    v_mfma_f32_16x16x32_bf16 v[192:195], v[64:67], v[112:115], v[192:195]
    ds_read_b64_tr_b16 v[88:89], v16 offset:49152
    v_mov_b64 v[140:141], v[156:157]
    v_mfma_f32_16x16x32_bf16 v[224:227], v[64:67], v[116:119], v[224:227]
    ds_read_b64_tr_b16 v[90:91], v16 offset:50176
    v_mfma_f32_16x16x32_bf16 v[196:199], v[68:71], v[112:115], v[196:199]
    ds_read_b64_tr_b16 v[92:93], v17 offset:49152
    buffer_load_dwordx4 v[104:107], v6, s[8:11], s32 offen offset:1024 sc1
    v_mov_b64 v[142:143], v[158:159]
    v_mfma_f32_16x16x32_bf16 v[228:231], v[68:71], v[116:119], v[228:231]
    ds_read_b64_tr_b16 v[94:95], v17 offset:50176
    s_waitcnt lgkmcnt(8)
    v_mfma_f32_16x16x32_bf16 v[200:203], v[72:75], v[112:115], v[200:203]
    ds_read_b64_tr_b16 v[64:65], v10 offset:57344
    v_mov_b64 v[156:157], v[172:173]
    v_mfma_f32_16x16x32_bf16 v[232:235], v[72:75], v[116:119], v[232:235]
    ds_read_b64_tr_b16 v[66:67], v10 offset:58368
    v_xor_b32 v10, 65536, v10
    v_mfma_f32_16x16x32_bf16 v[204:207], v[76:79], v[112:115], v[204:207]
    ds_read_b64_tr_b16 v[68:69], v11 offset:57344
    buffer_load_dwordx4 v[108:111], v7, s[8:11], s32 offen offset:1024 sc1
    v_mov_b64 v[158:159], v[174:175]
    v_mfma_f32_16x16x32_bf16 v[236:239], v[76:79], v[116:119], v[236:239]
    ds_read_b64_tr_b16 v[70:71], v11 offset:58368
    v_xor_b32 v11, 65536, v11
    s_waitcnt lgkmcnt(8)
    v_mfma_f32_16x16x32_bf16 v[208:211], v[80:83], v[112:115], v[208:211]
    ds_read_b64_tr_b16 v[72:73], v12 offset:57344
    v_mov_b64 v[172:173], v[188:189]
    v_mfma_f32_16x16x32_bf16 v[240:243], v[80:83], v[116:119], v[240:243]
    ds_read_b64_tr_b16 v[74:75], v12 offset:58368
    v_xor_b32 v12, 65536, v12
    v_mfma_f32_16x16x32_bf16 v[212:215], v[84:87], v[112:115], v[212:215]
    ds_read_b64_tr_b16 v[76:77], v13 offset:57344
    v_mov_b64 v[174:175], v[190:191]
    v_mfma_f32_16x16x32_bf16 v[244:247], v[84:87], v[116:119], v[244:247]
    ds_read_b64_tr_b16 v[78:79], v13 offset:58368
    v_xor_b32 v13, 65536, v13
    s_waitcnt lgkmcnt(8)
    v_mfma_f32_16x16x32_bf16 v[216:219], v[88:91], v[112:115], v[216:219]
    ds_read_b64_tr_b16 v[80:81], v14 offset:57344
    buffer_load_dwordx4 v4, s[4:7], s31 offen offset:2048 sc1 lds
    v_mfma_f32_16x16x32_bf16 v[248:251], v[88:91], v[116:119], v[248:251]
    ds_read_b64_tr_b16 v[82:83], v14 offset:58368
    v_xor_b32 v14, 65536, v14
    v_mfma_f32_16x16x32_bf16 v[220:223], v[92:95], v[112:115], v[220:223]
    ds_read_b64_tr_b16 v[84:85], v15 offset:57344
    v_mfma_f32_16x16x32_bf16 v[252:255], v[92:95], v[116:119], v[252:255]
    ds_read_b64_tr_b16 v[86:87], v15 offset:58368
    v_xor_b32 v15, 65536, v15
    s_waitcnt lgkmcnt(8)
    s_waitcnt vmcnt(23)
    v_mfma_f32_16x16x32_bf16 v[192:195], v[64:67], v[120:123], v[192:195]
    ds_read_b64_tr_b16 v[88:89], v16 offset:57344
    v_mfma_f32_16x16x32_bf16 v[224:227], v[64:67], v[124:127], v[224:227]
    ds_read_b64_tr_b16 v[90:91], v16 offset:58368
    v_xor_b32 v16, 65536, v16
    v_mfma_f32_16x16x32_bf16 v[196:199], v[68:71], v[120:123], v[196:199]
    ds_read_b64_tr_b16 v[92:93], v17 offset:57344
    buffer_load_dwordx4 v[112:115], v6, s[8:11], s32 offen offset:2048 sc1
    v_mfma_f32_16x16x32_bf16 v[228:231], v[68:71], v[124:127], v[228:231]
    ds_read_b64_tr_b16 v[94:95], v17 offset:58368
    v_xor_b32 v17, 65536, v17
    s_waitcnt lgkmcnt(8)
    v_mfma_f32_16x16x32_bf16 v[200:203], v[72:75], v[120:123], v[200:203]
    v_mfma_f32_16x16x32_bf16 v[232:235], v[72:75], v[124:127], v[232:235]
    v_mfma_f32_16x16x32_bf16 v[204:207], v[76:79], v[120:123], v[204:207]
    buffer_load_dwordx4 v[116:119], v7, s[8:11], s32 offen offset:2048 sc1
    v_mfma_f32_16x16x32_bf16 v[236:239], v[76:79], v[124:127], v[236:239]
    s_waitcnt lgkmcnt(0)
    s_barrier
    v_mfma_f32_16x16x32_bf16 v[208:211], v[80:83], v[120:123], v[208:211]
    ds_read_b64_tr_b16 v[64:65], v10 offset:0
    ds_read_b64_tr_b16 v[66:67], v10 offset:1024
    v_mfma_f32_16x16x32_bf16 v[240:243], v[80:83], v[124:127], v[240:243]
    ds_read_b64_tr_b16 v[68:69], v11 offset:0
    ds_read_b64_tr_b16 v[70:71], v11 offset:1024
    v_mfma_f32_16x16x32_bf16 v[212:215], v[84:87], v[120:123], v[212:215]
    ds_read_b64_tr_b16 v[72:73], v12 offset:0
    ds_read_b64_tr_b16 v[74:75], v12 offset:1024
    v_mfma_f32_16x16x32_bf16 v[244:247], v[84:87], v[124:127], v[244:247]
    ds_read_b64_tr_b16 v[76:77], v13 offset:0
    ds_read_b64_tr_b16 v[78:79], v13 offset:1024
    v_mfma_f32_16x16x32_bf16 v[216:219], v[88:91], v[120:123], v[216:219]
    ds_read_b64_tr_b16 v[80:81], v14 offset:0
    ds_read_b64_tr_b16 v[82:83], v14 offset:1024
    buffer_load_dwordx4 v5, s[4:7], s31 offen offset:3072 sc1 lds
    v_mfma_f32_16x16x32_bf16 v[248:251], v[88:91], v[124:127], v[248:251]
    s_add_u32 s31, s31, s40
    s_add_u32 s34, s34, 32768
    s_and_b32 s34, s34, s41
    v_mfma_f32_16x16x32_bf16 v[220:223], v[92:95], v[120:123], v[220:223]
    ds_read_b64_tr_b16 v[84:85], v15 offset:0
    ds_read_b64_tr_b16 v[86:87], v15 offset:1024
    v_mfma_f32_16x16x32_bf16 v[252:255], v[92:95], v[124:127], v[252:255]
    s_add_u32 s35, s35, 1
    s_cmp_lt_u32 s35, 4
    s_cbranch_scc1 L_p2_loop
    s_add_u32 m0, s33, 65536
    s_nop 0
    buffer_load_dwordx4 v2, s[4:7], s31 offen offset:0 sc1 lds
    buffer_load_dwordx4 v2, s[4:7], s31 offen offset:1024 sc1 lds
    buffer_load_dwordx4 v2, s[4:7], s31 offen offset:2048 sc1 lds
    buffer_load_dwordx4 v2, s[4:7], s31 offen offset:3072 sc1 lds
    s_load_dwordx2 s[32:33], s[0:1], 40
    s_load_dwordx2 s[34:35], s[0:1], 80
    s_load_dwordx2 s[96:97], s[0:1], 0
    s_load_dwordx2 s[98:99], s[0:1], 88
    s_cmp_lt_u32 s28, 4
    s_cbranch_scc0 L_grp1
    v_mov_b32 v20, 1040356334
    v_mov_b32 v21, v20
    s_and_b32 s37, s28, 3
    s_lshl_b32 s37, s37, 13
    v_lshlrev_b32 v7, 4, v1
    v_add_u32 v4, s37, v7
    v_add_u32 v19, 131072, v4
    v_add_u32 v6, 4096, v4
    s_add_u32 s43, s37, 32768
    s_add_u32 s44, s37, 98304
    v_pk_mul_f32 v[192:193], v[192:193], v[20:21]
    v_pk_mul_f32 v[194:195], v[194:195], v[20:21]
    v_pk_mul_f32 v[196:197], v[196:197], v[20:21]
    v_pk_mul_f32 v[198:199], v[198:199], v[20:21]
    v_cvt_pk_bf16_f32 v128, v192, v193
    v_cvt_pk_bf16_f32 v129, v194, v195
    v_cvt_pk_bf16_f32 v130, v196, v197
    v_cvt_pk_bf16_f32 v131, v198, v199
    ds_write_b128 v19, v[128:131] offset:0
    v_pk_mul_f32 v[200:201], v[200:201], v[20:21]
    v_pk_mul_f32 v[202:203], v[202:203], v[20:21]
    v_pk_mul_f32 v[204:205], v[204:205], v[20:21]
    v_pk_mul_f32 v[206:207], v[206:207], v[20:21]
    v_cvt_pk_bf16_f32 v132, v200, v201
    v_cvt_pk_bf16_f32 v133, v202, v203
    v_cvt_pk_bf16_f32 v134, v204, v205
    v_cvt_pk_bf16_f32 v135, v206, v207
    ds_write_b128 v19, v[132:135] offset:1024
    v_pk_mul_f32 v[208:209], v[208:209], v[20:21]
    v_pk_mul_f32 v[210:211], v[210:211], v[20:21]
    v_pk_mul_f32 v[212:213], v[212:213], v[20:21]
    v_pk_mul_f32 v[214:215], v[214:215], v[20:21]
    v_cvt_pk_bf16_f32 v136, v208, v209
    v_cvt_pk_bf16_f32 v137, v210, v211
    v_cvt_pk_bf16_f32 v138, v212, v213
    v_cvt_pk_bf16_f32 v139, v214, v215
    ds_write_b128 v19, v[136:139] offset:2048
    v_pk_mul_f32 v[216:217], v[216:217], v[20:21]
    v_pk_mul_f32 v[218:219], v[218:219], v[20:21]
    v_pk_mul_f32 v[220:221], v[220:221], v[20:21]
    v_pk_mul_f32 v[222:223], v[222:223], v[20:21]
    v_cvt_pk_bf16_f32 v140, v216, v217
    v_cvt_pk_bf16_f32 v141, v218, v219
    v_cvt_pk_bf16_f32 v142, v220, v221
    v_cvt_pk_bf16_f32 v143, v222, v223
    ds_write_b128 v19, v[140:143] offset:3072
    v_pk_mul_f32 v[224:225], v[224:225], v[20:21]
    v_pk_mul_f32 v[226:227], v[226:227], v[20:21]
    v_pk_mul_f32 v[228:229], v[228:229], v[20:21]
    v_pk_mul_f32 v[230:231], v[230:231], v[20:21]
    v_cvt_pk_bf16_f32 v144, v224, v225
    v_cvt_pk_bf16_f32 v145, v226, v227
    v_cvt_pk_bf16_f32 v146, v228, v229
    v_cvt_pk_bf16_f32 v147, v230, v231
    ds_write_b128 v19, v[144:147] offset:4096
    v_pk_mul_f32 v[232:233], v[232:233], v[20:21]
    v_pk_mul_f32 v[234:235], v[234:235], v[20:21]
    v_pk_mul_f32 v[236:237], v[236:237], v[20:21]
    v_pk_mul_f32 v[238:239], v[238:239], v[20:21]
    v_cvt_pk_bf16_f32 v148, v232, v233
    v_cvt_pk_bf16_f32 v149, v234, v235
    v_cvt_pk_bf16_f32 v150, v236, v237
    v_cvt_pk_bf16_f32 v151, v238, v239
    ds_write_b128 v19, v[148:151] offset:5120
    v_pk_mul_f32 v[240:241], v[240:241], v[20:21]
    v_pk_mul_f32 v[242:243], v[242:243], v[20:21]
    v_pk_mul_f32 v[244:245], v[244:245], v[20:21]
    v_pk_mul_f32 v[246:247], v[246:247], v[20:21]
    v_cvt_pk_bf16_f32 v152, v240, v241
    v_cvt_pk_bf16_f32 v153, v242, v243
    v_cvt_pk_bf16_f32 v154, v244, v245
    v_cvt_pk_bf16_f32 v155, v246, v247
    ds_write_b128 v19, v[152:155] offset:6144
    v_pk_mul_f32 v[248:249], v[248:249], v[20:21]
    v_pk_mul_f32 v[250:251], v[250:251], v[20:21]
    v_pk_mul_f32 v[252:253], v[252:253], v[20:21]
    v_pk_mul_f32 v[254:255], v[254:255], v[20:21]
    v_cvt_pk_bf16_f32 v156, v248, v249
    v_cvt_pk_bf16_f32 v157, v250, v251
    v_cvt_pk_bf16_f32 v158, v252, v253
    v_cvt_pk_bf16_f32 v159, v254, v255
    ds_write_b128 v19, v[156:159] offset:7168
    v_mov_b32 v2, v7
    v_and_b32 v21, 15, v1
    v_lshrrev_b32 v22, 4, v1
    v_lshlrev_b32 v22, 2, v22
    v_sub_u32 v18, v21, v22
    s_mov_b32 s40, 0
    s_mov_b32 s41, 16384
    s_mov_b32 s49, 0xffff
    s_lshl_b32 s51, s30, 1
    s_add_u32 s51, s51, 1
    s_and_b32 s50, s28, 3
    s_lshl_b32 s50, s50, 5
    s_lshl_b32 s31, 1, s51
    s_or_b32 s31, s31, 0x8000
    s_add_u32 s36, s51, 1
    s_lshl_b32 s36, -1, s36
    s_or_b32 s48, s36, 0xaaaaaaab
    s_and_b32 s48, s48, 0x7fff
    s_or_b32 s39, s36, 0x55555555
    s_and_b32 s39, s39, 0xffff
    s_add_u32 s46, s45, 65536
    s_add_u32 s47, s45, 98304
    s_mov_b64 s[52:53], 0
    s_waitcnt vmcnt(4) lgkmcnt(0)
    s_barrier
    ds_read_b128 v[64:67], v2 offset:0
    ds_read_b128 v[68:71], v2 offset:1024
    ds_read_b128 v[72:75], v2 offset:2048
    ds_read_b128 v[76:79], v2 offset:3072
    ds_read_b128 v[80:83], v2 offset:4096
    ds_read_b128 v[84:87], v2 offset:5120
    ds_read_b128 v[88:91], v2 offset:6144
    ds_read_b128 v[92:95], v2 offset:7168
    v_mov_b32 v36, 0x3f803f80
    v_mov_b32 v37, 0x3f803f80
    v_mov_b32 v38, 0x3f803f80
    v_mov_b32 v39, 0x3f803f80
    s_add_u32 s16, s54, 41943040
    s_addc_u32 s17, s55, 0
    s_and_b32 s17, s17, 0xffff
    s_mov_b32 s18, 117440640
    s_mov_b32 s19, 0x20000
    s_mov_b32 s4, s92
    s_and_b32 s5, s93, 0xffff
    s_mov_b32 s6, 7340032
    s_mov_b32 s7, 0x20000
    s_mov_b32 s8, s94
    s_and_b32 s9, s95, 0xffff
    s_mov_b32 s10, 7340032
    s_mov_b32 s11, 0x20000
    s_and_b32 s60, s29, 3
    s_add_u32 s60, s60, 4
    s_sub_u32 s3, s2, 32
    s_cmp_eq_u32 s28, 0
    s_cselect_b32 s36, 0xad, 0x2d
    s_cselect_b32 s42, 14, 12
    s_cmp_lt_u32 s3, 224
    s_cselect_b32 s36, s36, 0
    s_lshl_b32 s36, s36, s60
    s_or_b32 s42, s42, s36
    s_waitcnt lgkmcnt(7)
    v_mfma_f32_16x16x32_bf16 v[96:99], v[64:67], v[128:131], 0
    v_mov_b64 v[192:193], 0
    v_mov_b64 v[194:195], 0
    v_mfma_f32_16x16x32_bf16 v[104:107], v[64:67], v[144:147], 0
    ds_read_b128 v[64:67], v2 offset:8192
    v_mov_b64 v[196:197], 0
    v_mov_b64 v[198:199], 0
    s_waitcnt lgkmcnt(7)
    v_mfma_f32_16x16x32_bf16 v[96:99], v[68:71], v[132:135], v[96:99]
    v_mov_b64 v[200:201], 0
    v_mov_b64 v[202:203], 0
    v_mfma_f32_16x16x32_bf16 v[104:107], v[68:71], v[148:151], v[104:107]
    ds_read_b128 v[68:71], v2 offset:9216
    v_mov_b64 v[204:205], 0
    v_mov_b64 v[206:207], 0
    s_waitcnt lgkmcnt(7)
    v_mfma_f32_16x16x32_bf16 v[96:99], v[72:75], v[136:139], v[96:99]
    v_mov_b64 v[208:209], 0
    v_mfma_f32_16x16x32_bf16 v[104:107], v[72:75], v[152:155], v[104:107]
    ds_read_b128 v[72:75], v2 offset:10240
    v_mov_b64 v[210:211], 0
    v_mov_b64 v[212:213], 0
    s_waitcnt lgkmcnt(7)
    v_mfma_f32_16x16x32_bf16 v[96:99], v[76:79], v[140:143], v[96:99]
    v_mov_b64 v[214:215], 0
    v_mov_b64 v[216:217], 0
    v_mfma_f32_16x16x32_bf16 v[104:107], v[76:79], v[156:159], v[104:107]
    ds_read_b128 v[76:79], v2 offset:11264
    v_mov_b64 v[218:219], 0
    v_mov_b64 v[220:221], 0
    s_waitcnt lgkmcnt(7)
    v_mfma_f32_16x16x32_bf16 v[100:103], v[80:83], v[128:131], 0
    v_mov_b64 v[222:223], 0
    v_mov_b64 v[224:225], 0
    v_mfma_f32_16x16x32_bf16 v[108:111], v[80:83], v[144:147], 0
    ds_read_b128 v[80:83], v2 offset:12288
    v_mov_b64 v[226:227], 0
    s_waitcnt lgkmcnt(7)
    v_mfma_f32_16x16x32_bf16 v[100:103], v[84:87], v[132:135], v[100:103]
    v_mov_b64 v[228:229], 0
    v_mov_b64 v[230:231], 0
    v_mfma_f32_16x16x32_bf16 v[108:111], v[84:87], v[148:151], v[108:111]
    ds_read_b128 v[84:87], v2 offset:13312
    v_mov_b64 v[232:233], 0
    v_mov_b64 v[234:235], 0
    s_waitcnt lgkmcnt(7)
    v_mfma_f32_16x16x32_bf16 v[100:103], v[88:91], v[136:139], v[100:103]
    v_mov_b64 v[236:237], 0
    v_mov_b64 v[238:239], 0
    v_mfma_f32_16x16x32_bf16 v[108:111], v[88:91], v[152:155], v[108:111]
    ds_read_b128 v[88:91], v2 offset:14336
    v_mov_b64 v[240:241], 0
    v_mov_b64 v[242:243], 0
    s_waitcnt lgkmcnt(7)
    v_mfma_f32_16x16x32_bf16 v[100:103], v[92:95], v[140:143], v[100:103]
    v_mov_b64 v[244:245], 0
    v_mfma_f32_16x16x32_bf16 v[108:111], v[92:95], v[156:159], v[108:111]
    ds_read_b128 v[92:95], v2 offset:15360
    v_mov_b64 v[246:247], 0
    v_mov_b64 v[248:249], 0
    s_waitcnt lgkmcnt(7)
    v_mfma_f32_16x16x32_bf16 v[112:115], v[64:67], v[128:131], 0
    v_mov_b64 v[250:251], 0
    v_mov_b64 v[252:253], 0
    v_mfma_f32_16x16x32_bf16 v[120:123], v[64:67], v[144:147], 0
    v_mov_b64 v[254:255], 0
    v_mov_b64 v[28:29], 0
    s_waitcnt lgkmcnt(6)
    v_mfma_f32_16x16x32_bf16 v[112:115], v[68:71], v[132:135], v[112:115]
    v_mov_b64 v[30:31], 0
    v_mov_b64 v[32:33], 0
    v_mfma_f32_16x16x32_bf16 v[120:123], v[68:71], v[148:151], v[120:123]
    v_mov_b64 v[34:35], 0
    s_waitcnt lgkmcnt(5)
    v_mfma_f32_16x16x32_bf16 v[112:115], v[72:75], v[136:139], v[112:115]
    v_mfma_f32_16x16x32_bf16 v[120:123], v[72:75], v[152:155], v[120:123]
    v_max3_f32 v22, v96, v97, v98
    v_max3_f32 v23, v104, v105, v106
    s_waitcnt lgkmcnt(4)
    v_mfma_f32_16x16x32_bf16 v[112:115], v[76:79], v[140:143], v[112:115]
    v_max3_f32 v22, v22, v99, v100
    v_max3_f32 v23, v23, v107, v108
    v_mfma_f32_16x16x32_bf16 v[120:123], v[76:79], v[156:159], v[120:123]
    v_max3_f32 v22, v22, v101, v102
    v_max3_f32 v23, v23, v109, v110
    s_waitcnt lgkmcnt(3)
    v_mfma_f32_16x16x32_bf16 v[116:119], v[80:83], v[128:131], 0
    v_max_f32 v22, v22, v103
    v_max_f32 v23, v23, v111
    v_mfma_f32_16x16x32_bf16 v[124:127], v[80:83], v[144:147], 0
    v_mov_b32 v24, v22
    v_mov_b32 v25, v23
    s_waitcnt lgkmcnt(2)
    v_mfma_f32_16x16x32_bf16 v[116:119], v[84:87], v[132:135], v[116:119]
    v_permlane16_swap_b32 v22, v24
    v_permlane16_swap_b32 v23, v25
    v_mfma_f32_16x16x32_bf16 v[124:127], v[84:87], v[148:151], v[124:127]
    v_max_f32 v22, v22, v24
    v_max_f32 v23, v23, v25
    s_waitcnt lgkmcnt(1)
    v_mfma_f32_16x16x32_bf16 v[116:119], v[88:91], v[136:139], v[116:119]
    v_mov_b32 v24, v22
    v_mov_b32 v25, v23
    v_mfma_f32_16x16x32_bf16 v[124:127], v[88:91], v[152:155], v[124:127]
    v_permlane32_swap_b32 v22, v24
    v_permlane32_swap_b32 v23, v25
    s_waitcnt lgkmcnt(0)
    v_mfma_f32_16x16x32_bf16 v[116:119], v[92:95], v[140:143], v[116:119]
    v_max_f32 v22, v22, v24
    v_max_f32 v23, v23, v25
    v_mfma_f32_16x16x32_bf16 v[124:127], v[92:95], v[156:159], v[124:127]
    v_sub_f32 v40, 0, v22
    v_sub_f32 v41, 0, v22
    v_sub_f32 v42, 0, v22
    v_sub_f32 v43, 0, v22
    v_sub_f32 v44, 0, v23
    v_sub_f32 v45, 0, v23
    v_sub_f32 v46, 0, v23
    v_sub_f32 v47, 0, v23
    v_add_u32 v3, 65536, v2
    v_add_u32 v2, s41, v2
    v_and_b32 v2, s49, v2
    s_waitcnt vmcnt(0)
    s_barrier
    s_cmp_eq_u32 s28, 0
    s_cbranch_scc1 L_recurrent_scan__compressed_kv_cla__moe_arch_mod__prompt_kernel_rare_57
L_recurrent_scan__compressed_kv_cla__moe_arch_mod__prompt_kernel_back_58:
    ds_read_b128 v[64:67], v2 offset:0
    ds_read_b128 v[68:71], v2 offset:1024
    ds_read_b128 v[72:75], v2 offset:2048
    ds_read_b128 v[76:79], v2 offset:3072
    ds_read_b128 v[80:83], v2 offset:4096
    ds_read_b128 v[84:87], v2 offset:5120
    ds_read_b128 v[88:91], v2 offset:6144
    ds_write_b32 v19, v40
    ds_write_b32 v19, v44 offset:4
    v_pk_add_f32 v[96:97], v[96:97], v[40:41]
    v_pk_add_f32 v[98:99], v[98:99], v[40:41]
    v_pk_add_f32 v[100:101], v[100:101], v[40:41]
    v_pk_add_f32 v[102:103], v[102:103], v[40:41]
    v_pk_add_f32 v[104:105], v[104:105], v[44:45]
    v_pk_add_f32 v[106:107], v[106:107], v[44:45]
    v_pk_add_f32 v[108:109], v[108:109], v[44:45]
    v_pk_add_f32 v[110:111], v[110:111], v[44:45]
    v_pk_add_f32 v[112:113], v[112:113], v[40:41]
    v_pk_add_f32 v[114:115], v[114:115], v[40:41]
    v_pk_add_f32 v[116:117], v[116:117], v[40:41]
    v_pk_add_f32 v[118:119], v[118:119], v[40:41]
    v_pk_add_f32 v[120:121], v[120:121], v[44:45]
    v_pk_add_f32 v[122:123], v[122:123], v[44:45]
    v_pk_add_f32 v[124:125], v[124:125], v[44:45]
    v_pk_add_f32 v[126:127], v[126:127], v[44:45]
    v_exp_f32 v96, v96
    v_exp_f32 v97, v97
    v_exp_f32 v98, v98
    v_exp_f32 v99, v99
    v_exp_f32 v104, v104
    v_exp_f32 v105, v105
    v_exp_f32 v106, v106
    v_exp_f32 v107, v107
    v_exp_f32 v100, v100
    v_exp_f32 v101, v101
    v_exp_f32 v102, v102
    v_exp_f32 v103, v103
    v_exp_f32 v108, v108
    v_exp_f32 v109, v109
    v_exp_f32 v110, v110
    v_exp_f32 v111, v111
    v_cvt_pk_bf16_f32 v48, v96, v97
    v_cvt_pk_bf16_f32 v49, v98, v99
    v_cvt_pk_bf16_f32 v52, v104, v105
    v_cvt_pk_bf16_f32 v53, v106, v107
    v_cvt_pk_bf16_f32 v50, v100, v101
    v_cvt_pk_bf16_f32 v51, v102, v103
    v_cvt_pk_bf16_f32 v54, v108, v109
    v_cvt_pk_bf16_f32 v55, v110, v111
    .p2align 6
L_body00:
    s_waitcnt lgkmcnt(5)
    v_mfma_f32_16x16x32_bf16 v[96:99], v[64:67], v[128:131], v[40:43]
    v_exp_f32 v112, v112
    v_mfma_f32_16x16x32_bf16 v[104:107], v[64:67], v[144:147], v[44:47]
    ds_read_b128 v[92:95], v2 offset:7168
    s_bitcmp1_b32 s48, s40
    s_cbranch_scc0 L_recurrent_scan__compressed_kv_cla__moe_arch_mod__prompt_kernel_nodma_83
    s_add_u32 m0, s43, 0
    s_nop 0
    buffer_load_dwordx4 v4, s[12:15], s46 offen offset:0 sc1 lds
    buffer_load_dwordx4 v4, s[12:15], s46 offen offset:1024 sc1 lds
L_recurrent_scan__compressed_kv_cla__moe_arch_mod__prompt_kernel_nodma_83:
    v_mfma_f32_16x16x32_bf16 v[96:99], v[68:71], v[132:135], v[96:99]
    v_exp_f32 v113, v113
    v_mfma_f32_16x16x32_bf16 v[104:107], v[68:71], v[148:151], v[104:107]
    ds_read_b128 v[64:67], v3 offset:0
    s_waitcnt lgkmcnt(5)
    v_mfma_f32_16x16x32_bf16 v[96:99], v[72:75], v[136:139], v[96:99]
    v_exp_f32 v114, v114
    v_mfma_f32_16x16x32_bf16 v[104:107], v[72:75], v[152:155], v[104:107]
    ds_read_b128 v[68:71], v3 offset:1024
    v_cvt_pk_bf16_f32 v56, v112, v113
    s_bitcmp1_b32 s48, s40
    s_cbranch_scc0 L_recurrent_scan__compressed_kv_cla__moe_arch_mod__prompt_kernel_nodma_84
    s_add_u32 m0, s43, 0
    s_nop 0
    buffer_load_dwordx4 v4, s[12:15], s46 offen offset:2048 sc1 lds
    buffer_load_dwordx4 v4, s[12:15], s46 offen offset:3072 sc1 lds
L_recurrent_scan__compressed_kv_cla__moe_arch_mod__prompt_kernel_nodma_84:
    v_mfma_f32_16x16x32_bf16 v[96:99], v[76:79], v[140:143], v[96:99]
    v_exp_f32 v115, v115
    v_mfma_f32_16x16x32_bf16 v[104:107], v[76:79], v[156:159], v[104:107]
    ds_read_b128 v[72:75], v3 offset:2048
    s_waitcnt lgkmcnt(5)
    v_mfma_f32_16x16x32_bf16 v[100:103], v[80:83], v[128:131], v[40:43]
    v_exp_f32 v120, v120
    v_mfma_f32_16x16x32_bf16 v[108:111], v[80:83], v[144:147], v[44:47]
    ds_read_b128 v[76:79], v3 offset:3072
    v_cvt_pk_bf16_f32 v57, v114, v115
    v_mfma_f32_16x16x32_bf16 v[100:103], v[84:87], v[132:135], v[100:103]
    v_exp_f32 v121, v121
    v_mfma_f32_16x16x32_bf16 v[108:111], v[84:87], v[148:151], v[108:111]
    ds_read_b128 v[80:83], v3 offset:4096
    s_bitcmp1_b32 s48, s40
    s_cbranch_scc0 L_recurrent_scan__compressed_kv_cla__moe_arch_mod__prompt_kernel_nodma_85
    s_add_u32 m0, s43, 4096
    s_nop 0
    buffer_load_dwordx4 v6, s[12:15], s46 offen offset:0 sc1 lds
    buffer_load_dwordx4 v6, s[12:15], s46 offen offset:1024 sc1 lds
L_recurrent_scan__compressed_kv_cla__moe_arch_mod__prompt_kernel_nodma_85:
    s_waitcnt lgkmcnt(5)
    v_mfma_f32_16x16x32_bf16 v[100:103], v[88:91], v[136:139], v[100:103]
    v_exp_f32 v122, v122
    v_mfma_f32_16x16x32_bf16 v[108:111], v[88:91], v[152:155], v[108:111]
    ds_read_b128 v[84:87], v3 offset:5120
    v_cvt_pk_bf16_f32 v60, v120, v121
    v_mfma_f32_16x16x32_bf16 v[100:103], v[92:95], v[140:143], v[100:103]
    v_exp_f32 v123, v123
    v_mfma_f32_16x16x32_bf16 v[108:111], v[92:95], v[156:159], v[108:111]
    ds_read_b128 v[88:91], v3 offset:6144
    s_bitcmp1_b32 s48, s40
    s_cbranch_scc0 L_recurrent_scan__compressed_kv_cla__moe_arch_mod__prompt_kernel_nodma_86
    s_add_u32 m0, s43, 4096
    s_nop 0
    buffer_load_dwordx4 v6, s[12:15], s46 offen offset:2048 sc1 lds
    buffer_load_dwordx4 v6, s[12:15], s46 offen offset:3072 sc1 lds
    s_add_u32 s46, s46, 65536
    s_xor_b32 s43, s43, 32768
L_recurrent_scan__compressed_kv_cla__moe_arch_mod__prompt_kernel_nodma_86:
    s_waitcnt lgkmcnt(5)
    v_mfma_f32_16x16x32_bf16 v[192:195], v[64:67], v[48:51], v[192:195]
    v_exp_f32 v116, v116
    v_mfma_f32_16x16x32_bf16 v[224:227], v[64:67], v[52:55], v[224:227]
    ds_read_b128 v[92:95], v3 offset:7168
    v_cvt_pk_bf16_f32 v61, v122, v123
    v_mfma_f32_16x16x32_bf16 v[196:199], v[68:71], v[48:51], v[196:199]
    v_exp_f32 v117, v117
    v_mfma_f32_16x16x32_bf16 v[228:231], v[68:71], v[52:55], v[228:231]
    ds_read_b128 v[64:67], v2 offset:8192
    s_waitcnt lgkmcnt(5)
    v_mfma_f32_16x16x32_bf16 v[200:203], v[72:75], v[48:51], v[200:203]
    v_exp_f32 v118, v118
    v_mfma_f32_16x16x32_bf16 v[232:235], v[72:75], v[52:55], v[232:235]
    v_mfma_f32_16x16x32_bf16 v[28:31], v[36:39], v[48:51], v[28:31]
    ds_read_b128 v[68:71], v2 offset:9216
    v_cvt_pk_bf16_f32 v58, v116, v117
    s_bitcmp1_b32 s39, s40
    s_cbranch_scc0 L_recurrent_scan__compressed_kv_cla__moe_arch_mod__prompt_kernel_nodma_87
    s_add_u32 m0, s44, 0
    s_nop 0
    buffer_load_dwordx4 v4, s[12:15], s47 offen offset:0 sc1 lds
    buffer_load_dwordx4 v4, s[12:15], s47 offen offset:1024 sc1 lds
L_recurrent_scan__compressed_kv_cla__moe_arch_mod__prompt_kernel_nodma_87:
    v_mfma_f32_16x16x32_bf16 v[204:207], v[76:79], v[48:51], v[204:207]
    v_exp_f32 v119, v119
    v_mfma_f32_16x16x32_bf16 v[236:239], v[76:79], v[52:55], v[236:239]
    ds_read_b128 v[72:75], v2 offset:10240
    s_waitcnt lgkmcnt(5)
    v_mfma_f32_16x16x32_bf16 v[208:211], v[80:83], v[48:51], v[208:211]
    v_exp_f32 v124, v124
    v_mfma_f32_16x16x32_bf16 v[240:243], v[80:83], v[52:55], v[240:243]
    ds_read_b128 v[76:79], v2 offset:11264
    v_cvt_pk_bf16_f32 v59, v118, v119
    s_bitcmp1_b32 s39, s40
    s_cbranch_scc0 L_recurrent_scan__compressed_kv_cla__moe_arch_mod__prompt_kernel_nodma_88
    s_add_u32 m0, s44, 0
    s_nop 0
    buffer_load_dwordx4 v4, s[12:15], s47 offen offset:2048 sc1 lds
    buffer_load_dwordx4 v4, s[12:15], s47 offen offset:3072 sc1 lds
L_recurrent_scan__compressed_kv_cla__moe_arch_mod__prompt_kernel_nodma_88:
    v_mfma_f32_16x16x32_bf16 v[212:215], v[84:87], v[48:51], v[212:215]
    v_exp_f32 v125, v125
    v_mfma_f32_16x16x32_bf16 v[244:247], v[84:87], v[52:55], v[244:247]
    ds_read_b128 v[80:83], v2 offset:12288
    s_waitcnt lgkmcnt(5)
    v_mfma_f32_16x16x32_bf16 v[216:219], v[88:91], v[48:51], v[216:219]
    v_exp_f32 v126, v126
    v_mfma_f32_16x16x32_bf16 v[248:251], v[88:91], v[52:55], v[248:251]
    v_mfma_f32_16x16x32_bf16 v[32:35], v[36:39], v[52:55], v[32:35]
    ds_read_b128 v[84:87], v2 offset:13312
    v_cvt_pk_bf16_f32 v62, v124, v125
    v_mfma_f32_16x16x32_bf16 v[220:223], v[92:95], v[48:51], v[220:223]
    v_exp_f32 v127, v127
    v_mfma_f32_16x16x32_bf16 v[252:255], v[92:95], v[52:55], v[252:255]
    ds_read_b128 v[88:91], v2 offset:14336
    v_cvt_pk_bf16_f32 v63, v126, v127
    s_bitcmp1_b32 s39, s40
    s_cbranch_scc0 L_recurrent_scan__compressed_kv_cla__moe_arch_mod__prompt_kernel_nodma_89
    s_add_u32 m0, s44, 4096
    s_nop 0
    buffer_load_dwordx4 v6, s[12:15], s47 offen offset:0 sc1 lds
    buffer_load_dwordx4 v6, s[12:15], s47 offen offset:1024 sc1 lds
L_recurrent_scan__compressed_kv_cla__moe_arch_mod__prompt_kernel_nodma_89:
    s_bitcmp1_b32 s31, s40
    s_cbranch_scc1 L_recurrent_scan__compressed_kv_cla__moe_arch_mod__prompt_kernel_rare_65
L_recurrent_scan__compressed_kv_cla__moe_arch_mod__prompt_kernel_back_66:
    s_waitcnt lgkmcnt(5)
    v_mfma_f32_16x16x32_bf16 v[112:115], v[64:67], v[128:131], v[40:43]
    v_exp_f32 v96, v96
    v_mfma_f32_16x16x32_bf16 v[120:123], v[64:67], v[144:147], v[44:47]
    ds_read_b128 v[92:95], v2 offset:15360
    v_mfma_f32_16x16x32_bf16 v[112:115], v[68:71], v[132:135], v[112:115]
    v_exp_f32 v97, v97
    v_mfma_f32_16x16x32_bf16 v[120:123], v[68:71], v[148:151], v[120:123]
    ds_read_b128 v[64:67], v3 offset:8192
    s_bitcmp1_b32 s39, s40
    s_cbranch_scc0 L_recurrent_scan__compressed_kv_cla__moe_arch_mod__prompt_kernel_nodma_90
    s_add_u32 m0, s44, 4096
    s_nop 0
    buffer_load_dwordx4 v6, s[12:15], s47 offen offset:2048 sc1 lds
    buffer_load_dwordx4 v6, s[12:15], s47 offen offset:3072 sc1 lds
    s_add_u32 s47, s47, 65536
    s_xor_b32 s44, s44, 32768
L_recurrent_scan__compressed_kv_cla__moe_arch_mod__prompt_kernel_nodma_90:
    s_waitcnt lgkmcnt(5)
    v_mfma_f32_16x16x32_bf16 v[112:115], v[72:75], v[136:139], v[112:115]
    v_exp_f32 v98, v98
    v_mfma_f32_16x16x32_bf16 v[120:123], v[72:75], v[152:155], v[120:123]
    ds_read_b128 v[68:71], v3 offset:9216
    v_cvt_pk_bf16_f32 v48, v96, v97
    v_mfma_f32_16x16x32_bf16 v[112:115], v[76:79], v[140:143], v[112:115]
    v_exp_f32 v99, v99
    v_mfma_f32_16x16x32_bf16 v[120:123], v[76:79], v[156:159], v[120:123]
    ds_read_b128 v[72:75], v3 offset:10240
    s_waitcnt lgkmcnt(5)
    v_mfma_f32_16x16x32_bf16 v[116:119], v[80:83], v[128:131], v[40:43]
    v_exp_f32 v104, v104
    v_mfma_f32_16x16x32_bf16 v[124:127], v[80:83], v[144:147], v[44:47]
    ds_read_b128 v[76:79], v3 offset:11264
    v_cvt_pk_bf16_f32 v49, v98, v99
    v_mfma_f32_16x16x32_bf16 v[116:119], v[84:87], v[132:135], v[116:119]
    v_exp_f32 v105, v105
    v_mfma_f32_16x16x32_bf16 v[124:127], v[84:87], v[148:151], v[124:127]
    ds_read_b128 v[80:83], v3 offset:12288
    s_waitcnt lgkmcnt(5)
    v_mfma_f32_16x16x32_bf16 v[116:119], v[88:91], v[136:139], v[116:119]
    v_exp_f32 v106, v106
    v_mfma_f32_16x16x32_bf16 v[124:127], v[88:91], v[152:155], v[124:127]
    ds_read_b128 v[84:87], v3 offset:13312
    v_cvt_pk_bf16_f32 v52, v104, v105
    v_mfma_f32_16x16x32_bf16 v[116:119], v[92:95], v[140:143], v[116:119]
    v_exp_f32 v107, v107
    v_mfma_f32_16x16x32_bf16 v[124:127], v[92:95], v[156:159], v[124:127]
    ds_read_b128 v[88:91], v3 offset:14336
    s_waitcnt lgkmcnt(5)
    v_mfma_f32_16x16x32_bf16 v[192:195], v[64:67], v[56:59], v[192:195]
    v_exp_f32 v100, v100
    v_mfma_f32_16x16x32_bf16 v[224:227], v[64:67], v[60:63], v[224:227]
    ds_read_b128 v[92:95], v3 offset:15360
    v_cvt_pk_bf16_f32 v53, v106, v107
    v_mfma_f32_16x16x32_bf16 v[196:199], v[68:71], v[56:59], v[196:199]
    v_exp_f32 v101, v101
    v_mfma_f32_16x16x32_bf16 v[228:231], v[68:71], v[60:63], v[228:231]
    v_add_u32 v3, 65536, v2
    v_add_u32 v2, s41, v2
    s_waitcnt lgkmcnt(4)
    v_mfma_f32_16x16x32_bf16 v[200:203], v[72:75], v[56:59], v[200:203]
    v_exp_f32 v102, v102
    s_add_u32 s40, s40, 1
    v_and_b32 v2, s49, v2
    v_mfma_f32_16x16x32_bf16 v[232:235], v[72:75], v[60:63], v[232:235]
    v_mfma_f32_16x16x32_bf16 v[28:31], v[36:39], v[56:59], v[28:31]
    v_cvt_pk_bf16_f32 v50, v100, v101
    s_waitcnt vmcnt(8) lgkmcnt(0)
    s_cmp_le_u32 s40, s51
    s_cbranch_scc1 L_recurrent_scan__compressed_kv_cla__moe_arch_mod__prompt_kernel_rlx_67
    s_waitcnt vmcnt(0)
L_recurrent_scan__compressed_kv_cla__moe_arch_mod__prompt_kernel_rlx_67:
    s_bitcmp1_b32 s42, s40
    s_cbranch_scc1 L_recurrent_scan__compressed_kv_cla__moe_arch_mod__prompt_kernel_rare_81
L_recurrent_scan__compressed_kv_cla__moe_arch_mod__prompt_kernel_back_82:
    s_barrier
    v_mfma_f32_16x16x32_bf16 v[204:207], v[76:79], v[56:59], v[204:207]
    v_exp_f32 v103, v103
    v_mfma_f32_16x16x32_bf16 v[236:239], v[76:79], v[60:63], v[236:239]
    ds_read_b128 v[68:71], v2 offset:1024
    ds_read_b128 v[64:67], v2 offset:0
    v_mfma_f32_16x16x32_bf16 v[208:211], v[80:83], v[56:59], v[208:211]
    v_exp_f32 v108, v108
    v_mfma_f32_16x16x32_bf16 v[240:243], v[80:83], v[60:63], v[240:243]
    ds_read_b128 v[76:79], v2 offset:3072
    ds_read_b128 v[72:75], v2 offset:2048
    v_cvt_pk_bf16_f32 v51, v102, v103
    v_mfma_f32_16x16x32_bf16 v[212:215], v[84:87], v[56:59], v[212:215]
    v_exp_f32 v109, v109
    v_mfma_f32_16x16x32_bf16 v[244:247], v[84:87], v[60:63], v[244:247]
    ds_read_b128 v[80:83], v2 offset:4096
    v_mfma_f32_16x16x32_bf16 v[216:219], v[88:91], v[56:59], v[216:219]
    v_exp_f32 v110, v110
    v_mfma_f32_16x16x32_bf16 v[248:251], v[88:91], v[60:63], v[248:251]
    v_mfma_f32_16x16x32_bf16 v[32:35], v[36:39], v[60:63], v[32:35]
    ds_read_b128 v[84:87], v2 offset:5120
    v_cvt_pk_bf16_f32 v54, v108, v109
    v_mfma_f32_16x16x32_bf16 v[220:223], v[92:95], v[56:59], v[220:223]
    v_exp_f32 v111, v111
    v_mfma_f32_16x16x32_bf16 v[252:255], v[92:95], v[60:63], v[252:255]
    ds_read_b128 v[88:91], v2 offset:6144
    v_cvt_pk_bf16_f32 v55, v110, v111
    s_cmp_lg_u32 s40, 16
    s_cbranch_scc1 L_body00
    s_lshr_b32 s36, s2, 5
    s_add_u32 s36, s36, 48
    s_lshl_b32 s36, s36, 7
    v_mov_b32 v12, s36
    global_load_dword v11, v12, s[90:91] sc1
    s_sub_u32 s36, 32, s50
    s_cmp_lt_i32 s36, 0
    s_cbranch_scc0 L_recurrent_scan__compressed_kv_cla__moe_arch_mod__prompt_kernel_rare_93
L_recurrent_scan__compressed_kv_cla__moe_arch_mod__prompt_kernel_back_94:
    s_lshl_b32 s37, s28, 13
    v_add_u32 v5, s37, v7
    s_waitcnt lgkmcnt(5)
    v_mfma_f32_16x16x32_bf16 v[192:195], v[64:67], v[48:51], v[192:195]
    v_exp_f32 v112, v112
    v_mfma_f32_16x16x32_bf16 v[224:227], v[64:67], v[52:55], v[224:227]
    ds_read_b128 v[92:95], v3 offset:7168
    v_exp_f32 v113, v113
    v_mfma_f32_16x16x32_bf16 v[196:199], v[68:71], v[48:51], v[196:199]
    v_cvt_pk_bf16_f32 v56, v112, v113
    v_exp_f32 v114, v114
    v_mfma_f32_16x16x32_bf16 v[228:231], v[68:71], v[52:55], v[228:231]
    ds_read_b128 v[64:67], v3 offset:8192
    v_exp_f32 v115, v115
    s_waitcnt lgkmcnt(5)
    v_mfma_f32_16x16x32_bf16 v[200:203], v[72:75], v[48:51], v[200:203]
    v_cvt_pk_bf16_f32 v57, v114, v115
    v_exp_f32 v120, v120
    v_mfma_f32_16x16x32_bf16 v[232:235], v[72:75], v[52:55], v[232:235]
    v_mfma_f32_16x16x32_bf16 v[28:31], v[36:39], v[48:51], v[28:31]
    ds_read_b128 v[68:71], v3 offset:9216
    v_exp_f32 v121, v121
    v_mfma_f32_16x16x32_bf16 v[204:207], v[76:79], v[48:51], v[204:207]
    v_cvt_pk_bf16_f32 v60, v120, v121
    v_exp_f32 v122, v122
    v_mfma_f32_16x16x32_bf16 v[236:239], v[76:79], v[52:55], v[236:239]
    ds_read_b128 v[72:75], v3 offset:10240
    v_exp_f32 v123, v123
    s_waitcnt lgkmcnt(6)
    v_mfma_f32_16x16x32_bf16 v[208:211], v[80:83], v[48:51], v[208:211]
    v_cvt_pk_bf16_f32 v61, v122, v123
    v_exp_f32 v116, v116
    v_mfma_f32_16x16x32_bf16 v[240:243], v[80:83], v[52:55], v[240:243]
    ds_read_b128 v[76:79], v3 offset:11264
    v_exp_f32 v117, v117
    s_waitcnt lgkmcnt(6)
    v_mfma_f32_16x16x32_bf16 v[212:215], v[84:87], v[48:51], v[212:215]
    v_cvt_pk_bf16_f32 v58, v116, v117
    v_exp_f32 v118, v118
    v_mfma_f32_16x16x32_bf16 v[244:247], v[84:87], v[52:55], v[244:247]
    ds_read_b128 v[80:83], v3 offset:12288
    v_exp_f32 v119, v119
    s_waitcnt lgkmcnt(6)
    v_mfma_f32_16x16x32_bf16 v[216:219], v[88:91], v[48:51], v[216:219]
    v_cvt_pk_bf16_f32 v59, v118, v119
    v_exp_f32 v124, v124
    v_mfma_f32_16x16x32_bf16 v[248:251], v[88:91], v[52:55], v[248:251]
    v_mfma_f32_16x16x32_bf16 v[32:35], v[36:39], v[52:55], v[32:35]
    ds_read_b128 v[84:87], v3 offset:13312
    v_exp_f32 v125, v125
    s_waitcnt lgkmcnt(6)
    v_mfma_f32_16x16x32_bf16 v[220:223], v[92:95], v[48:51], v[220:223]
    v_cvt_pk_bf16_f32 v62, v124, v125
    v_exp_f32 v126, v126
    v_mfma_f32_16x16x32_bf16 v[252:255], v[92:95], v[52:55], v[252:255]
    ds_read_b128 v[88:91], v3 offset:14336
    v_exp_f32 v127, v127
    s_nop 0
    v_cvt_pk_bf16_f32 v63, v126, v127
    s_nop 1
    s_waitcnt lgkmcnt(6)
    v_mfma_f32_16x16x32_bf16 v[192:195], v[64:67], v[56:59], v[192:195]
    s_mov_b32 s4, s34
    s_and_b32 s5, s35, 0xffff
    s_mov_b32 s6, 7340032
    s_mov_b32 s7, 0x20000
    s_mov_b32 s8, s32
    v_mfma_f32_16x16x32_bf16 v[224:227], v[64:67], v[60:63], v[224:227]
    ds_read_b128 v[92:95], v3 offset:15360
    s_and_b32 s9, s33, 0xffff
    s_mov_b32 s10, 8388608
    s_mov_b32 s11, 0x20000
    s_lshr_b32 s38, s2, 4
    s_waitcnt lgkmcnt(6)
    v_mfma_f32_16x16x32_bf16 v[196:199], v[68:71], v[56:59], v[196:199]
    s_mul_i32 s38, s38, 224
    s_and_b32 s39, s2, 15
    s_lshl_b32 s39, s39, 7
    v_lshrrev_b32 v25, 3, v1
    s_lshl_b32 s36, s28, 5
    v_mfma_f32_16x16x32_bf16 v[228:231], v[68:71], v[60:63], v[228:231]
    s_add_u32 s36, s36, s38
    v_add_u32 v25, s36, v25
    v_mul_u32_u24 v25, 2048, v25
    v_add_u32 v25, s39, v25
    s_waitcnt lgkmcnt(5)
    v_mfma_f32_16x16x32_bf16 v[200:203], v[72:75], v[56:59], v[200:203]
    v_bfe_u32 v26, v1, 4, 1
    v_lshlrev_b32 v26, 1, v26
    v_and_b32 v27, 7, v1
    v_xor_b32 v26, v26, v27
    v_mfma_f32_16x16x32_bf16 v[232:235], v[72:75], v[60:63], v[232:235]
    v_mfma_f32_16x16x32_bf16 v[28:31], v[36:39], v[56:59], v[28:31]
    v_lshl_add_u32 v24, v26, 4, v25
    v_xor_b32 v26, 4, v26
    v_lshl_add_u32 v25, v26, 4, v25
    v_add_u32 v25, 15360, v25
    v_add_u32 v26, 30720, v24
    s_waitcnt lgkmcnt(4)
    v_mfma_f32_16x16x32_bf16 v[204:207], v[76:79], v[56:59], v[204:207]
    v_add_u32 v27, 30720, v25
    s_lshl_b32 s36, s28, 12
    s_add_u32 s36, s36, 131072
    s_cmp_lt_u32 s28, 7
    s_cselect_b32 m0, s36, 0x30000
    s_cselect_b32 s6, 7340032, 0
    v_mfma_f32_16x16x32_bf16 v[236:239], v[76:79], v[60:63], v[236:239]
    buffer_load_dwordx4 v24, s[4:7], 0 offen offset:0 lds
    buffer_load_dwordx4 v25, s[4:7], 0 offen offset:1024 lds
    buffer_load_dwordx4 v26, s[4:7], 0 offen offset:2048 lds
    buffer_load_dwordx4 v27, s[4:7], 0 offen offset:3072 lds
    s_waitcnt lgkmcnt(3)
    v_mfma_f32_16x16x32_bf16 v[208:211], v[80:83], v[56:59], v[208:211]
    v_mfma_f32_16x16x32_bf16 v[240:243], v[80:83], v[60:63], v[240:243]
    ds_write_b128 v5, v[224:227] offset:0
    s_waitcnt lgkmcnt(3)
    v_mfma_f32_16x16x32_bf16 v[212:215], v[84:87], v[56:59], v[212:215]
    v_mfma_f32_16x16x32_bf16 v[244:247], v[84:87], v[60:63], v[244:247]
    ds_write_b128 v5, v[228:231] offset:1024
    s_waitcnt lgkmcnt(3)
    v_mfma_f32_16x16x32_bf16 v[216:219], v[88:91], v[56:59], v[216:219]
    v_mfma_f32_16x16x32_bf16 v[248:251], v[88:91], v[60:63], v[248:251]
    v_mfma_f32_16x16x32_bf16 v[32:35], v[36:39], v[60:63], v[32:35]
    ds_write_b128 v5, v[232:235] offset:2048
    s_waitcnt lgkmcnt(3)
    v_mfma_f32_16x16x32_bf16 v[220:223], v[92:95], v[56:59], v[220:223]
    v_mfma_f32_16x16x32_bf16 v[252:255], v[92:95], v[60:63], v[252:255]
    ds_write_b128 v5, v[236:239] offset:3072
    ds_write_b128 v5, v[240:243] offset:4096
    ds_write_b128 v5, v[244:247] offset:5120
    v_xor_b32 v106, 32768, v5
    s_lshl_b32 s37, s28, 8
    s_add_u32 s37, s37, 159744
    v_lshl_add_u32 v107, v1, 2, s37
    v_xor_b32 v108, 1024, v107
    ds_write_b128 v5, v[248:251] offset:6144
    ds_write_b128 v5, v[252:255] offset:7168
    ds_write_b32 v107, v32
    s_mov_b32 s36, 0x5d800000
    v_cmp_nge_f32 vcc, s36, v28
    s_nop 0
    s_or_b64 s[52:53], s[52:53], vcc
    v_cmp_nge_f32 vcc, s36, v32
    s_nop 0
    s_or_b64 s[52:53], s[52:53], vcc
    s_or_b32 s36, s52, s53
    v_mov_b32 v110, s36
    s_lshl_b32 s37, s28, 2
    s_add_u32 s37, s37, 161792
    v_mov_b32 v111, s37
    ds_write_b32 v111, v110
    v_mov_b32 v112, 161856
    v_mov_b32 v114, s56
    v_mov_b32 v115, s57
    v_mov_b32 v116, s58
    v_mov_b32 v117, s59
    ds_write_b128 v112, v[114:117]
    v_and_b32 v111, 7, v1
    v_lshlrev_b32 v111, 2, v111
    v_add_u32 v111, 161792, v111
    v_mov_b32 v113, v7
    s_sub_u32 s36, 15, s30
    s_lshl_b32 s38, s36, 3
    s_and_b32 s37, s28, 3
    s_lshl_b32 s37, s37, 1
    s_add_u32 s38, s38, s37
    s_lshl_b32 s38, s38, 17
    s_lshl_b32 s37, s29, 12
    s_add_u32 s38, s38, s37
    s_waitcnt vmcnt(4)
    v_readfirstlane_b32 s36, v11
    s_nop 0
    s_cmp_lt_u32 s36, 28
    s_cbranch_scc1 L_recurrent_scan__compressed_kv_cla__moe_arch_mod__prompt_kernel_rare_97
L_recurrent_scan__compressed_kv_cla__moe_arch_mod__prompt_kernel_back_98:
    s_lshr_b32 s36, s2, 4
    s_mul_i32 s36, s36, 7
    s_min_u32 s37, s28, 6
    s_add_u32 s36, s36, s37
    s_lshl_b32 s36, s36, 11
    s_add_u32 s36, s36, 58720256
    v_and_b32 v11, 15, v1
    v_lshlrev_b32 v11, 4, v11
    v_lshrrev_b32 v12, 4, v1
    v_lshl_add_u32 v11, v12, 9, v11
    buffer_load_dwordx4 v[96:99], v11, s[24:27], s36 offen offset:0 sc1
    buffer_load_dwordx4 v[100:103], v11, s[24:27], s36 offen offset:256 sc1
    s_waitcnt lgkmcnt(0)
    s_barrier
    ds_read_b32 v110, v111
    ds_read_b32 v109, v108
    ds_read_b128 v[64:67], v106 offset:0
    ds_read_b128 v[68:71], v106 offset:1024
    ds_read_b128 v[72:75], v106 offset:2048
    ds_read_b128 v[76:79], v106 offset:3072
    ds_read_b128 v[80:83], v106 offset:4096
    ds_read_b128 v[84:87], v106 offset:5120
    ds_read_b128 v[88:91], v106 offset:6144
    ds_read_b128 v[92:95], v106 offset:7168
    s_waitcnt lgkmcnt(8)
    v_add_f32 v109, v109, v28
    v_cmp_ne_u32 s[52:53], 0, v110
    v_rcp_f32 v109, v109
    s_nop 0
    v_mov_b32 v108, v109
    s_waitcnt lgkmcnt(6)
    v_pk_add_f32 v[192:193], v[192:193], v[64:65]
    v_pk_add_f32 v[194:195], v[194:195], v[66:67]
    v_pk_add_f32 v[196:197], v[196:197], v[68:69]
    v_pk_add_f32 v[198:199], v[198:199], v[70:71]
    v_pk_mul_f32 v[192:193], v[192:193], v[108:109]
    v_pk_mul_f32 v[194:195], v[194:195], v[108:109]
    v_pk_mul_f32 v[196:197], v[196:197], v[108:109]
    v_pk_mul_f32 v[198:199], v[198:199], v[108:109]
    v_cvt_pk_bf16_f32 v48, v192, v193
    v_cvt_pk_bf16_f32 v49, v194, v195
    v_cvt_pk_bf16_f32 v50, v196, v197
    v_cvt_pk_bf16_f32 v51, v198, v199
    buffer_store_dwordx4 v[48:51], v113, s[16:19], s38 offen offset:0 sc1
    s_waitcnt lgkmcnt(4)
    v_pk_add_f32 v[200:201], v[200:201], v[72:73]
    v_pk_add_f32 v[202:203], v[202:203], v[74:75]
    v_pk_add_f32 v[204:205], v[204:205], v[76:77]
    v_pk_add_f32 v[206:207], v[206:207], v[78:79]
    v_pk_mul_f32 v[200:201], v[200:201], v[108:109]
    v_pk_mul_f32 v[202:203], v[202:203], v[108:109]
    v_pk_mul_f32 v[204:205], v[204:205], v[108:109]
    v_pk_mul_f32 v[206:207], v[206:207], v[108:109]
    v_cvt_pk_bf16_f32 v52, v200, v201
    v_cvt_pk_bf16_f32 v53, v202, v203
    v_cvt_pk_bf16_f32 v54, v204, v205
    v_cvt_pk_bf16_f32 v55, v206, v207
    buffer_store_dwordx4 v[52:55], v113, s[16:19], s38 offen offset:1024 sc1
    s_waitcnt lgkmcnt(2)
    v_pk_add_f32 v[208:209], v[208:209], v[80:81]
    v_pk_add_f32 v[210:211], v[210:211], v[82:83]
    v_pk_add_f32 v[212:213], v[212:213], v[84:85]
    v_pk_add_f32 v[214:215], v[214:215], v[86:87]
    v_pk_mul_f32 v[208:209], v[208:209], v[108:109]
    v_pk_mul_f32 v[210:211], v[210:211], v[108:109]
    v_pk_mul_f32 v[212:213], v[212:213], v[108:109]
    v_pk_mul_f32 v[214:215], v[214:215], v[108:109]
    v_cvt_pk_bf16_f32 v56, v208, v209
    v_cvt_pk_bf16_f32 v57, v210, v211
    v_cvt_pk_bf16_f32 v58, v212, v213
    v_cvt_pk_bf16_f32 v59, v214, v215
    buffer_store_dwordx4 v[56:59], v113, s[16:19], s38 offen offset:2048 sc1
    s_waitcnt lgkmcnt(0)
    v_pk_add_f32 v[216:217], v[216:217], v[88:89]
    v_pk_add_f32 v[218:219], v[218:219], v[90:91]
    v_pk_add_f32 v[220:221], v[220:221], v[92:93]
    v_pk_add_f32 v[222:223], v[222:223], v[94:95]
    v_pk_mul_f32 v[216:217], v[216:217], v[108:109]
    v_pk_mul_f32 v[218:219], v[218:219], v[108:109]
    v_pk_mul_f32 v[220:221], v[220:221], v[108:109]
    v_pk_mul_f32 v[222:223], v[222:223], v[108:109]
    v_cvt_pk_bf16_f32 v60, v216, v217
    v_cvt_pk_bf16_f32 v61, v218, v219
    v_cvt_pk_bf16_f32 v62, v220, v221
    v_cvt_pk_bf16_f32 v63, v222, v223
    buffer_store_dwordx4 v[60:63], v113, s[16:19], s38 offen offset:3072 sc1
    s_cmp_eq_u64 s[52:53], 0
    s_cbranch_scc1 L_p3_done
    s_waitcnt vmcnt(0)
    v_mov_b32 v112, v96
    v_mov_b32 v113, v97
    v_mov_b32 v114, v98
    v_mov_b32 v115, v99
    v_mov_b32 v116, v100
    v_mov_b32 v117, v101
    v_mov_b32 v118, v102
    v_mov_b32 v119, v103
    v_mov_b32 v192, 0
    v_mov_b32 v193, 0
    v_mov_b32 v194, 0
    v_mov_b32 v195, 0
    v_mov_b32 v196, 0
    v_mov_b32 v197, 0
    v_mov_b32 v198, 0
    v_mov_b32 v199, 0
    v_mov_b32 v200, 0
    v_mov_b32 v201, 0
    v_mov_b32 v202, 0
    v_mov_b32 v203, 0
    v_mov_b32 v204, 0
    v_mov_b32 v205, 0
    v_mov_b32 v206, 0
    v_mov_b32 v207, 0
    v_mov_b32 v208, 0
    v_mov_b32 v209, 0
    v_mov_b32 v210, 0
    v_mov_b32 v211, 0
    v_mov_b32 v212, 0
    v_mov_b32 v213, 0
    v_mov_b32 v214, 0
    v_mov_b32 v215, 0
    v_mov_b32 v216, 0
    v_mov_b32 v217, 0
    v_mov_b32 v218, 0
    v_mov_b32 v219, 0
    v_mov_b32 v220, 0
    v_mov_b32 v221, 0
    v_mov_b32 v222, 0
    v_mov_b32 v223, 0
    v_mov_b32 v224, 0
    v_mov_b32 v225, 0
    v_mov_b32 v226, 0
    v_mov_b32 v227, 0
    v_mov_b32 v228, 0
    v_mov_b32 v229, 0
    v_mov_b32 v230, 0
    v_mov_b32 v231, 0
    v_mov_b32 v232, 0
    v_mov_b32 v233, 0
    v_mov_b32 v234, 0
    v_mov_b32 v235, 0
    v_mov_b32 v236, 0
    v_mov_b32 v237, 0
    v_mov_b32 v238, 0
    v_mov_b32 v239, 0
    v_mov_b32 v240, 0
    v_mov_b32 v241, 0
    v_mov_b32 v242, 0
    v_mov_b32 v243, 0
    v_mov_b32 v244, 0
    v_mov_b32 v245, 0
    v_mov_b32 v246, 0
    v_mov_b32 v247, 0
    v_mov_b32 v248, 0
    v_mov_b32 v249, 0
    v_mov_b32 v250, 0
    v_mov_b32 v251, 0
    v_mov_b32 v252, 0
    v_mov_b32 v253, 0
    v_mov_b32 v254, 0
    v_mov_b32 v255, 0
    v_mov_b32 v28, 0
    v_mov_b32 v40, 4048155338
    v_mov_b32 v32, 0
    v_mov_b32 v41, 4048155338
    s_lshl_b32 s43, s28, 12
    v_add_u32 v4, s43, v7
    s_mov_b32 s46, s45
    s_sub_u32 s40, 16, s30
    s_sub_u32 s39, 15, s30
    s_lshl_b32 s37, s39, 7
    s_and_b32 s36, s28, 3
    s_lshl_b32 s36, s36, 5
    s_add_u32 s36, s36, s37
    s_sub_u32 s50, 0, s36
L_recurrent_scan__compressed_kv_cla__moe_arch_mod__prompt_kernel_stile_99:
    s_waitcnt vmcnt(0) lgkmcnt(0)
    s_barrier
    s_mov_b32 m0, s43
    s_add_u32 s47, s46, 32768
    buffer_load_dwordx4 v4, s[12:15], s46 offen offset:0 sc1 lds
    buffer_load_dwordx4 v4, s[12:15], s46 offen offset:1024 sc1 lds
    buffer_load_dwordx4 v4, s[12:15], s46 offen offset:2048 sc1 lds
    buffer_load_dwordx4 v4, s[12:15], s46 offen offset:3072 sc1 lds
    s_add_u32 m0, s43, 32768
    s_add_u32 s46, s46, 65536
    buffer_load_dwordx4 v4, s[12:15], s47 offen offset:0 sc1 lds
    buffer_load_dwordx4 v4, s[12:15], s47 offen offset:1024 sc1 lds
    buffer_load_dwordx4 v4, s[12:15], s47 offen offset:2048 sc1 lds
    buffer_load_dwordx4 v4, s[12:15], s47 offen offset:3072 sc1 lds
    v_mov_b32 v2, v7
    s_mov_b32 s41, 4
    s_waitcnt vmcnt(0)
    s_barrier
L_recurrent_scan__compressed_kv_cla__moe_arch_mod__prompt_kernel_sunit_100:
    s_cmp_gt_i32 s50, 0
    s_cbranch_scc1 L_recurrent_scan__compressed_kv_cla__moe_arch_mod__prompt_kernel_snext_101
    ds_read_b128 v[64:67], v2 offset:0
    ds_read_b128 v[68:71], v2 offset:1024
    ds_read_b128 v[72:75], v2 offset:2048
    ds_read_b128 v[76:79], v2 offset:3072
    ds_read_b128 v[80:83], v2 offset:4096
    ds_read_b128 v[84:87], v2 offset:5120
    ds_read_b128 v[88:91], v2 offset:6144
    ds_read_b128 v[92:95], v2 offset:7168
    s_waitcnt lgkmcnt(0)
    v_mfma_f32_16x16x32_bf16 v[96:99], v[64:67], v[128:131], 0
    v_mfma_f32_16x16x32_bf16 v[104:107], v[64:67], v[144:147], 0
    v_mfma_f32_16x16x32_bf16 v[96:99], v[68:71], v[132:135], v[96:99]
    v_mfma_f32_16x16x32_bf16 v[104:107], v[68:71], v[148:151], v[104:107]
    v_mfma_f32_16x16x32_bf16 v[96:99], v[72:75], v[136:139], v[96:99]
    v_mfma_f32_16x16x32_bf16 v[104:107], v[72:75], v[152:155], v[104:107]
    v_mfma_f32_16x16x32_bf16 v[96:99], v[76:79], v[140:143], v[96:99]
    v_mfma_f32_16x16x32_bf16 v[104:107], v[76:79], v[156:159], v[104:107]
    v_mfma_f32_16x16x32_bf16 v[100:103], v[80:83], v[128:131], 0
    v_mfma_f32_16x16x32_bf16 v[108:111], v[80:83], v[144:147], 0
    v_mfma_f32_16x16x32_bf16 v[100:103], v[84:87], v[132:135], v[100:103]
    v_mfma_f32_16x16x32_bf16 v[108:111], v[84:87], v[148:151], v[108:111]
    v_mfma_f32_16x16x32_bf16 v[100:103], v[88:91], v[136:139], v[100:103]
    v_mfma_f32_16x16x32_bf16 v[108:111], v[88:91], v[152:155], v[108:111]
    v_mfma_f32_16x16x32_bf16 v[100:103], v[92:95], v[140:143], v[100:103]
    v_mfma_f32_16x16x32_bf16 v[108:111], v[92:95], v[156:159], v[108:111]
    ds_read_b128 v[64:67], v2 offset:32768
    ds_read_b128 v[68:71], v2 offset:33792
    ds_read_b128 v[72:75], v2 offset:34816
    ds_read_b128 v[76:79], v2 offset:35840
    ds_read_b128 v[80:83], v2 offset:36864
    ds_read_b128 v[84:87], v2 offset:37888
    ds_read_b128 v[88:91], v2 offset:38912
    ds_read_b128 v[92:95], v2 offset:39936
    s_nop 1
    s_cmp_lt_i32 s50, 0
    s_cbranch_scc0 L_recurrent_scan__compressed_kv_cla__moe_arch_mod__prompt_kernel_rare_104
L_recurrent_scan__compressed_kv_cla__moe_arch_mod__prompt_kernel_back_105:
    v_max3_f32 v22, v96, v97, v98
    v_max3_f32 v22, v22, v99, v100
    v_max3_f32 v22, v22, v101, v102
    v_max3_f32 v22, v22, v103, v40
    v_mov_b32 v24, v22
    s_nop 1
    v_permlane16_swap_b32 v22, v24
    s_nop 1
    v_max_f32 v22, v22, v24
    v_mov_b32 v24, v22
    s_nop 1
    v_permlane32_swap_b32 v22, v24
    s_nop 1
    v_max_f32 v22, v22, v24
    v_sub_f32 v25, v40, v22
    v_exp_f32 v25, v25
    v_mov_b32 v40, v22
    v_mul_f32 v28, v28, v25
    v_mul_f32 v192, v192, v25
    v_mul_f32 v193, v193, v25
    v_mul_f32 v194, v194, v25
    v_mul_f32 v195, v195, v25
    v_mul_f32 v196, v196, v25
    v_mul_f32 v197, v197, v25
    v_mul_f32 v198, v198, v25
    v_mul_f32 v199, v199, v25
    v_mul_f32 v200, v200, v25
    v_mul_f32 v201, v201, v25
    v_mul_f32 v202, v202, v25
    v_mul_f32 v203, v203, v25
    v_mul_f32 v204, v204, v25
    v_mul_f32 v205, v205, v25
    v_mul_f32 v206, v206, v25
    v_mul_f32 v207, v207, v25
    v_mul_f32 v208, v208, v25
    v_mul_f32 v209, v209, v25
    v_mul_f32 v210, v210, v25
    v_mul_f32 v211, v211, v25
    v_mul_f32 v212, v212, v25
    v_mul_f32 v213, v213, v25
    v_mul_f32 v214, v214, v25
    v_mul_f32 v215, v215, v25
    v_mul_f32 v216, v216, v25
    v_mul_f32 v217, v217, v25
    v_mul_f32 v218, v218, v25
    v_mul_f32 v219, v219, v25
    v_mul_f32 v220, v220, v25
    v_mul_f32 v221, v221, v25
    v_mul_f32 v222, v222, v25
    v_mul_f32 v223, v223, v25
    v_sub_f32 v96, v96, v22
    v_sub_f32 v97, v97, v22
    v_sub_f32 v98, v98, v22
    v_sub_f32 v99, v99, v22
    v_sub_f32 v100, v100, v22
    v_sub_f32 v101, v101, v22
    v_sub_f32 v102, v102, v22
    v_sub_f32 v103, v103, v22
    v_max3_f32 v23, v104, v105, v106
    v_max3_f32 v23, v23, v107, v108
    v_max3_f32 v23, v23, v109, v110
    v_max3_f32 v23, v23, v111, v41
    v_mov_b32 v24, v23
    s_nop 1
    v_permlane16_swap_b32 v23, v24
    s_nop 1
    v_max_f32 v23, v23, v24
    v_mov_b32 v24, v23
    s_nop 1
    v_permlane32_swap_b32 v23, v24
    s_nop 1
    v_max_f32 v23, v23, v24
    v_sub_f32 v25, v41, v23
    v_exp_f32 v25, v25
    v_mov_b32 v41, v23
    v_mul_f32 v32, v32, v25
    v_mul_f32 v224, v224, v25
    v_mul_f32 v225, v225, v25
    v_mul_f32 v226, v226, v25
    v_mul_f32 v227, v227, v25
    v_mul_f32 v228, v228, v25
    v_mul_f32 v229, v229, v25
    v_mul_f32 v230, v230, v25
    v_mul_f32 v231, v231, v25
    v_mul_f32 v232, v232, v25
    v_mul_f32 v233, v233, v25
    v_mul_f32 v234, v234, v25
    v_mul_f32 v235, v235, v25
    v_mul_f32 v236, v236, v25
    v_mul_f32 v237, v237, v25
    v_mul_f32 v238, v238, v25
    v_mul_f32 v239, v239, v25
    v_mul_f32 v240, v240, v25
    v_mul_f32 v241, v241, v25
    v_mul_f32 v242, v242, v25
    v_mul_f32 v243, v243, v25
    v_mul_f32 v244, v244, v25
    v_mul_f32 v245, v245, v25
    v_mul_f32 v246, v246, v25
    v_mul_f32 v247, v247, v25
    v_mul_f32 v248, v248, v25
    v_mul_f32 v249, v249, v25
    v_mul_f32 v250, v250, v25
    v_mul_f32 v251, v251, v25
    v_mul_f32 v252, v252, v25
    v_mul_f32 v253, v253, v25
    v_mul_f32 v254, v254, v25
    v_mul_f32 v255, v255, v25
    v_sub_f32 v104, v104, v23
    v_sub_f32 v105, v105, v23
    v_sub_f32 v106, v106, v23
    v_sub_f32 v107, v107, v23
    v_sub_f32 v108, v108, v23
    v_sub_f32 v109, v109, v23
    v_sub_f32 v110, v110, v23
    v_sub_f32 v111, v111, v23
    v_exp_f32 v96, v96
    v_exp_f32 v97, v97
    v_exp_f32 v98, v98
    v_exp_f32 v99, v99
    v_exp_f32 v104, v104
    v_exp_f32 v105, v105
    v_exp_f32 v106, v106
    v_exp_f32 v107, v107
    v_exp_f32 v100, v100
    v_exp_f32 v101, v101
    v_exp_f32 v102, v102
    v_exp_f32 v103, v103
    v_exp_f32 v108, v108
    v_exp_f32 v109, v109
    v_exp_f32 v110, v110
    v_exp_f32 v111, v111
    v_add_f32 v28, v28, v96
    v_add_f32 v28, v28, v97
    v_cvt_pk_bf16_f32 v48, v96, v97
    v_add_f32 v28, v28, v98
    v_add_f32 v28, v28, v99
    v_cvt_pk_bf16_f32 v49, v98, v99
    v_add_f32 v32, v32, v104
    v_add_f32 v32, v32, v105
    v_cvt_pk_bf16_f32 v52, v104, v105
    v_add_f32 v32, v32, v106
    v_add_f32 v32, v32, v107
    v_cvt_pk_bf16_f32 v53, v106, v107
    v_add_f32 v28, v28, v100
    v_add_f32 v28, v28, v101
    v_cvt_pk_bf16_f32 v50, v100, v101
    v_add_f32 v28, v28, v102
    v_add_f32 v28, v28, v103
    v_cvt_pk_bf16_f32 v51, v102, v103
    v_add_f32 v32, v32, v108
    v_add_f32 v32, v32, v109
    v_cvt_pk_bf16_f32 v54, v108, v109
    v_add_f32 v32, v32, v110
    v_add_f32 v32, v32, v111
    v_cvt_pk_bf16_f32 v55, v110, v111
    s_waitcnt lgkmcnt(0)
    s_nop 0
    v_mfma_f32_16x16x32_bf16 v[192:195], v[64:67], v[48:51], v[192:195]
    v_mfma_f32_16x16x32_bf16 v[224:227], v[64:67], v[52:55], v[224:227]
    v_mfma_f32_16x16x32_bf16 v[196:199], v[68:71], v[48:51], v[196:199]
    v_mfma_f32_16x16x32_bf16 v[228:231], v[68:71], v[52:55], v[228:231]
    v_mfma_f32_16x16x32_bf16 v[200:203], v[72:75], v[48:51], v[200:203]
    v_mfma_f32_16x16x32_bf16 v[232:235], v[72:75], v[52:55], v[232:235]
    v_mfma_f32_16x16x32_bf16 v[204:207], v[76:79], v[48:51], v[204:207]
    v_mfma_f32_16x16x32_bf16 v[236:239], v[76:79], v[52:55], v[236:239]
    v_mfma_f32_16x16x32_bf16 v[208:211], v[80:83], v[48:51], v[208:211]
    v_mfma_f32_16x16x32_bf16 v[240:243], v[80:83], v[52:55], v[240:243]
    v_mfma_f32_16x16x32_bf16 v[212:215], v[84:87], v[48:51], v[212:215]
    v_mfma_f32_16x16x32_bf16 v[244:247], v[84:87], v[52:55], v[244:247]
    v_mfma_f32_16x16x32_bf16 v[216:219], v[88:91], v[48:51], v[216:219]
    v_mfma_f32_16x16x32_bf16 v[248:251], v[88:91], v[52:55], v[248:251]
    v_mfma_f32_16x16x32_bf16 v[220:223], v[92:95], v[48:51], v[220:223]
    v_mfma_f32_16x16x32_bf16 v[252:255], v[92:95], v[52:55], v[252:255]
L_recurrent_scan__compressed_kv_cla__moe_arch_mod__prompt_kernel_snext_101:
    v_add_u32 v2, 8192, v2
    s_add_u32 s50, s50, 32
    s_sub_u32 s41, s41, 1
    s_cmp_lg_u32 s41, 0
    s_cbranch_scc1 L_recurrent_scan__compressed_kv_cla__moe_arch_mod__prompt_kernel_sunit_100
    s_sub_u32 s40, s40, 1
    s_cmp_lg_u32 s40, 0
    s_cbranch_scc1 L_recurrent_scan__compressed_kv_cla__moe_arch_mod__prompt_kernel_stile_99
    v_mov_b32 v20, v28
    s_nop 1
    v_permlane16_swap_b32 v28, v20
    s_nop 1
    v_add_f32 v28, v28, v20
    v_mov_b32 v20, v28
    s_nop 1
    v_permlane32_swap_b32 v28, v20
    s_nop 1
    v_add_f32 v28, v28, v20
    v_mov_b32 v20, v32
    s_nop 1
    v_permlane16_swap_b32 v32, v20
    s_nop 1
    v_add_f32 v32, v32, v20
    v_mov_b32 v20, v32
    s_nop 1
    v_permlane32_swap_b32 v32, v20
    s_nop 1
    v_add_f32 v32, v32, v20
    s_mov_b32 s36, 0x5d800000
    v_cmp_nge_f32 vcc, s36, v28
    s_nop 0
    s_or_b64 s[52:53], s[52:53], vcc
    v_cmp_nge_f32 vcc, s36, v32
    s_nop 0
    s_or_b64 s[52:53], s[52:53], vcc
    v_rcp_f32 v20, v28
    v_rcp_f32 v22, v32
    s_lshl_b32 s38, s39, 3
    s_and_b32 s37, s28, 3
    s_lshl_b32 s37, s37, 1
    s_add_u32 s38, s38, s37
    s_lshl_b32 s38, s38, 17
    s_lshl_b32 s37, s29, 12
    s_add_u32 s38, s38, s37
    v_mov_b32 v21, v20
    v_mov_b32 v23, v22
    v_mov_b32 v24, v7
    v_pk_mul_f32 v[192:193], v[192:193], v[20:21]
    v_pk_mul_f32 v[194:195], v[194:195], v[20:21]
    v_pk_mul_f32 v[196:197], v[196:197], v[20:21]
    v_pk_mul_f32 v[198:199], v[198:199], v[20:21]
    v_cvt_pk_bf16_f32 v192, v192, v193
    v_cvt_pk_bf16_f32 v193, v194, v195
    v_cvt_pk_bf16_f32 v194, v196, v197
    v_cvt_pk_bf16_f32 v195, v198, v199
    buffer_store_dwordx4 v[192:195], v24, s[16:19], s38 offen offset:0 sc1
    v_pk_mul_f32 v[200:201], v[200:201], v[20:21]
    v_pk_mul_f32 v[202:203], v[202:203], v[20:21]
    v_pk_mul_f32 v[204:205], v[204:205], v[20:21]
    v_pk_mul_f32 v[206:207], v[206:207], v[20:21]
    v_cvt_pk_bf16_f32 v200, v200, v201
    v_cvt_pk_bf16_f32 v201, v202, v203
    v_cvt_pk_bf16_f32 v202, v204, v205
    v_cvt_pk_bf16_f32 v203, v206, v207
    buffer_store_dwordx4 v[200:203], v24, s[16:19], s38 offen offset:1024 sc1
    v_pk_mul_f32 v[208:209], v[208:209], v[20:21]
    v_pk_mul_f32 v[210:211], v[210:211], v[20:21]
    v_pk_mul_f32 v[212:213], v[212:213], v[20:21]
    v_pk_mul_f32 v[214:215], v[214:215], v[20:21]
    v_cvt_pk_bf16_f32 v208, v208, v209
    v_cvt_pk_bf16_f32 v209, v210, v211
    v_cvt_pk_bf16_f32 v210, v212, v213
    v_cvt_pk_bf16_f32 v211, v214, v215
    buffer_store_dwordx4 v[208:211], v24, s[16:19], s38 offen offset:2048 sc1
    v_pk_mul_f32 v[216:217], v[216:217], v[20:21]
    v_pk_mul_f32 v[218:219], v[218:219], v[20:21]
    v_pk_mul_f32 v[220:221], v[220:221], v[20:21]
    v_pk_mul_f32 v[222:223], v[222:223], v[20:21]
    v_cvt_pk_bf16_f32 v216, v216, v217
    v_cvt_pk_bf16_f32 v217, v218, v219
    v_cvt_pk_bf16_f32 v218, v220, v221
    v_cvt_pk_bf16_f32 v219, v222, v223
    buffer_store_dwordx4 v[216:219], v24, s[16:19], s38 offen offset:3072 sc1
    s_add_u32 s38, s38, 131072
    v_pk_mul_f32 v[224:225], v[224:225], v[22:23]
    v_pk_mul_f32 v[226:227], v[226:227], v[22:23]
    v_pk_mul_f32 v[228:229], v[228:229], v[22:23]
    v_pk_mul_f32 v[230:231], v[230:231], v[22:23]
    v_cvt_pk_bf16_f32 v224, v224, v225
    v_cvt_pk_bf16_f32 v225, v226, v227
    v_cvt_pk_bf16_f32 v226, v228, v229
    v_cvt_pk_bf16_f32 v227, v230, v231
    buffer_store_dwordx4 v[224:227], v24, s[16:19], s38 offen offset:0 sc1
    v_pk_mul_f32 v[232:233], v[232:233], v[22:23]
    v_pk_mul_f32 v[234:235], v[234:235], v[22:23]
    v_pk_mul_f32 v[236:237], v[236:237], v[22:23]
    v_pk_mul_f32 v[238:239], v[238:239], v[22:23]
    v_cvt_pk_bf16_f32 v232, v232, v233
    v_cvt_pk_bf16_f32 v233, v234, v235
    v_cvt_pk_bf16_f32 v234, v236, v237
    v_cvt_pk_bf16_f32 v235, v238, v239
    buffer_store_dwordx4 v[232:235], v24, s[16:19], s38 offen offset:1024 sc1
    v_pk_mul_f32 v[240:241], v[240:241], v[22:23]
    v_pk_mul_f32 v[242:243], v[242:243], v[22:23]
    v_pk_mul_f32 v[244:245], v[244:245], v[22:23]
    v_pk_mul_f32 v[246:247], v[246:247], v[22:23]
    v_cvt_pk_bf16_f32 v240, v240, v241
    v_cvt_pk_bf16_f32 v241, v242, v243
    v_cvt_pk_bf16_f32 v242, v244, v245
    v_cvt_pk_bf16_f32 v243, v246, v247
    buffer_store_dwordx4 v[240:243], v24, s[16:19], s38 offen offset:2048 sc1
    v_pk_mul_f32 v[248:249], v[248:249], v[22:23]
    v_pk_mul_f32 v[250:251], v[250:251], v[22:23]
    v_pk_mul_f32 v[252:253], v[252:253], v[22:23]
    v_pk_mul_f32 v[254:255], v[254:255], v[22:23]
    v_cvt_pk_bf16_f32 v248, v248, v249
    v_cvt_pk_bf16_f32 v249, v250, v251
    v_cvt_pk_bf16_f32 v250, v252, v253
    v_cvt_pk_bf16_f32 v251, v254, v255
    buffer_store_dwordx4 v[248:251], v24, s[16:19], s38 offen offset:3072 sc1
    v_mov_b32 v96, v112
    v_mov_b32 v97, v113
    v_mov_b32 v98, v114
    v_mov_b32 v99, v115
    v_mov_b32 v100, v116
    v_mov_b32 v101, v117
    v_mov_b32 v102, v118
    v_mov_b32 v103, v119
    s_branch L_p3_done
L_recurrent_scan__compressed_kv_cla__moe_arch_mod__prompt_kernel_rare_1:
    s_mul_i32 s36, s28, 12288
    s_add_u32 s36, s36, 61865984
    v_lshl_add_u32 v16, v1, 4, s36
    v_mov_b32 v108, 0
    v_mov_b32 v109, 0
    v_mov_b32 v110, 0
    v_mov_b32 v111, 0
    global_store_dwordx4 v16, v[108:111], s[90:91] sc1
    v_add_u32 v16, 1024, v16
    global_store_dwordx4 v16, v[108:111], s[90:91] sc1
    v_add_u32 v16, 1024, v16
    global_store_dwordx4 v16, v[108:111], s[90:91] sc1
    v_add_u32 v16, 1024, v16
    global_store_dwordx4 v16, v[108:111], s[90:91] sc1
    v_add_u32 v16, 1024, v16
    global_store_dwordx4 v16, v[108:111], s[90:91] sc1
    v_add_u32 v16, 1024, v16
    global_store_dwordx4 v16, v[108:111], s[90:91] sc1
    v_add_u32 v16, 1024, v16
    global_store_dwordx4 v16, v[108:111], s[90:91] sc1
    v_add_u32 v16, 1024, v16
    global_store_dwordx4 v16, v[108:111], s[90:91] sc1
    v_add_u32 v16, 1024, v16
    global_store_dwordx4 v16, v[108:111], s[90:91] sc1
    v_add_u32 v16, 1024, v16
    global_store_dwordx4 v16, v[108:111], s[90:91] sc1
    v_add_u32 v16, 1024, v16
    global_store_dwordx4 v16, v[108:111], s[90:91] sc1
    v_add_u32 v16, 1024, v16
    global_store_dwordx4 v16, v[108:111], s[90:91] sc1
    v_add_u32 v16, 1024, v16
    s_branch L_recurrent_scan__compressed_kv_cla__moe_arch_mod__prompt_kernel_back_2
L_recurrent_scan__compressed_kv_cla__moe_arch_mod__prompt_kernel_rare_3:
    v_mov_b32 v19, 1
    s_mov_b64 exec, 1
    global_store_dword v118, v19, s[88:89] sc1
    s_mov_b64 exec, -1
    s_branch L_recurrent_scan__compressed_kv_cla__moe_arch_mod__prompt_kernel_back_4
L_recurrent_scan__compressed_kv_cla__moe_arch_mod__prompt_kernel_rare_5:
    v_lshrrev_b32 v3, 4, v1
    s_lshl_b32 s37, s28, 4
    v_add_u32 v19, s37, v3
    v_lshlrev_b32 v19, 13, v19
    s_lshl_b32 s37, s29, 8
    v_add_u32 v19, s37, v19
    v_and_b32 v16, 15, v1
    v_lshlrev_b32 v3, 1, v3
    v_xor_b32 v16, v16, v3
    v_lshl_add_u32 v2, v16, 4, v19
    v_add_u32 v3, 31744, v2
    v_xor_b32 v16, 8, v16
    v_lshl_add_u32 v4, v16, 4, v19
    v_add_u32 v4, 63488, v4
    v_add_u32 v5, 31744, v4
    s_mov_b32 s4, s96
    s_and_b32 s5, s97, 0xffff
    s_mov_b32 s6, 8388608
    s_mov_b32 s7, 0x20000
    s_mov_b32 s31, 0
    s_mov_b32 s40, 1048576
    s_mov_b64 s[8:9], s[4:5]
    s_mov_b32 s10, s6
    s_mov_b32 s32, 2097152
    v_mov_b32 v6, v2
    v_mov_b32 v7, v3
    v_mov_b32 v8, v4
    v_mov_b32 v9, v5
    s_branch L_recurrent_scan__compressed_kv_cla__moe_arch_mod__prompt_kernel_back_6
L_recurrent_scan__compressed_kv_cla__moe_arch_mod__prompt_kernel_w0_7:
    s_cmp_eq_u32 s35, 0
    s_cbranch_scc0 L_recurrent_scan__compressed_kv_cla__moe_arch_mod__prompt_kernel_swn_10
    v_and_b32 v16, 7, v1
    v_lshrrev_b32 v18, 3, v1
    v_mul_u32_u24 v19, 2064, v16
    v_lshl_add_u32 v19, v18, 4, v19
    s_lshl_b32 s36, s28, 8
    s_add_u32 s36, s36, 131072
    v_add_u32 v19, s36, v19
    ds_read_b128 v[120:123], v19
    ds_read_b128 v[124:127], v19 offset:128
    v_lshlrev_b32 v16, 4, v16
    v_lshl_add_u32 v16, v18, 8, v16
    s_lshr_b32 s36, s2, 1
    s_lshl_b32 s36, s36, 15
    s_and_b32 s37, s2, 1
    s_lshl_b32 s37, s37, 7
    s_add_u32 s36, s36, s37
    s_lshl_b32 s37, s28, 12
    s_add_u32 s36, s36, s37
    s_waitcnt lgkmcnt(0)
    buffer_store_dwordx4 v[120:123], v16, s[24:27], s36 offen sc1
    buffer_store_dwordx4 v[124:127], v16, s[24:27], s36 offen offset:2048 sc1
    s_waitcnt vmcnt(2)
    s_branch L_recurrent_scan__compressed_kv_cla__moe_arch_mod__prompt_kernel_swend_9
L_recurrent_scan__compressed_kv_cla__moe_arch_mod__prompt_kernel_swn_10:
    s_waitcnt vmcnt(2)
L_recurrent_scan__compressed_kv_cla__moe_arch_mod__prompt_kernel_swend_9:
    s_branch L_recurrent_scan__compressed_kv_cla__moe_arch_mod__prompt_kernel_w0b_8
L_recurrent_scan__compressed_kv_cla__moe_arch_mod__prompt_kernel_rare_13:
    s_cmp_eq_u32 s35, 0
    s_cbranch_scc0 L_recurrent_scan__compressed_kv_cla__moe_arch_mod__prompt_kernel_swn_12
    global_load_dword v116, v118, s[88:89] sc1
    s_branch L_recurrent_scan__compressed_kv_cla__moe_arch_mod__prompt_kernel_swend_11
L_recurrent_scan__compressed_kv_cla__moe_arch_mod__prompt_kernel_swn_12:
    v_and_b32 v117, 15, v1
    v_add_u32 v117, 112, v117
    v_lshlrev_b32 v117, 7, v117
    global_load_dword v116, v117, s[90:91] sc1
L_recurrent_scan__compressed_kv_cla__moe_arch_mod__prompt_kernel_swend_11:
    s_branch L_recurrent_scan__compressed_kv_cla__moe_arch_mod__prompt_kernel_back_14
L_recurrent_scan__compressed_kv_cla__moe_arch_mod__prompt_kernel_rare_19:
    s_mov_b32 s61, 0x40000
L_recurrent_scan__compressed_kv_cla__moe_arch_mod__prompt_kernel_spin_17:
    s_sub_u32 s61, s61, 1
    s_cbranch_scc1 L_recurrent_scan__compressed_kv_cla__moe_arch_mod__prompt_kernel_spinx_18
    s_sleep 8
    global_load_dword v116, v118, s[88:89] sc1
    s_waitcnt vmcnt(0)
    v_readfirstlane_b32 s36, v116
    s_nop 0
    s_cmp_lt_u32 s36, 1
    s_cbranch_scc1 L_recurrent_scan__compressed_kv_cla__moe_arch_mod__prompt_kernel_spin_17
L_recurrent_scan__compressed_kv_cla__moe_arch_mod__prompt_kernel_spinx_18:
    s_branch L_recurrent_scan__compressed_kv_cla__moe_arch_mod__prompt_kernel_back_20
L_recurrent_scan__compressed_kv_cla__moe_arch_mod__prompt_kernel_w0_15:
    s_waitcnt vmcnt(0)
    s_cmp_eq_u32 s35, 0
    s_cbranch_scc0 L_recurrent_scan__compressed_kv_cla__moe_arch_mod__prompt_kernel_swn_24
    v_readfirstlane_b32 s36, v116
    s_nop 0
    s_cmp_lt_u32 s36, 1
    s_cbranch_scc1 L_recurrent_scan__compressed_kv_cla__moe_arch_mod__prompt_kernel_rare_19
L_recurrent_scan__compressed_kv_cla__moe_arch_mod__prompt_kernel_back_20:
    s_branch L_recurrent_scan__compressed_kv_cla__moe_arch_mod__prompt_kernel_swend_23
L_recurrent_scan__compressed_kv_cla__moe_arch_mod__prompt_kernel_swn_24:
    s_mov_b32 s61, 0x40000
L_recurrent_scan__compressed_kv_cla__moe_arch_mod__prompt_kernel_lspin_21:
    v_cmp_gt_u32 vcc, 16, v116
    s_nop 0
    s_cmp_eq_u64 vcc, 0
    s_cbranch_scc1 L_recurrent_scan__compressed_kv_cla__moe_arch_mod__prompt_kernel_lspinx_22
    s_sub_u32 s61, s61, 1
    s_cbranch_scc1 L_recurrent_scan__compressed_kv_cla__moe_arch_mod__prompt_kernel_lspinx_22
    s_sleep 8
    global_load_dword v116, v117, s[90:91] sc1
    s_waitcnt vmcnt(0)
    s_branch L_recurrent_scan__compressed_kv_cla__moe_arch_mod__prompt_kernel_lspin_21
L_recurrent_scan__compressed_kv_cla__moe_arch_mod__prompt_kernel_lspinx_22:
L_recurrent_scan__compressed_kv_cla__moe_arch_mod__prompt_kernel_swend_23:
    s_branch L_recurrent_scan__compressed_kv_cla__moe_arch_mod__prompt_kernel_w0b_16
L_recurrent_scan__compressed_kv_cla__moe_arch_mod__prompt_kernel_rare_25:
    s_lshr_b32 s36, s2, 4
    s_add_u32 s36, s36, 112
    s_lshl_b32 s36, s36, 7
    v_mov_b32 v16, s36
    v_mov_b32 v19, 1
    s_mov_b64 exec, 1
    global_atomic_add v16, v19, s[90:91]
    s_mov_b64 exec, -1
    s_nop 3
    s_branch L_recurrent_scan__compressed_kv_cla__moe_arch_mod__prompt_kernel_back_26
L_recurrent_scan__compressed_kv_cla__moe_arch_mod__prompt_kernel_w0_27:
    s_cmp_eq_u32 s35, 0
    s_cbranch_scc0 L_recurrent_scan__compressed_kv_cla__moe_arch_mod__prompt_kernel_swn_30
    s_waitcnt vmcnt(2)
    s_branch L_recurrent_scan__compressed_kv_cla__moe_arch_mod__prompt_kernel_swend_29
L_recurrent_scan__compressed_kv_cla__moe_arch_mod__prompt_kernel_swn_30:
    s_waitcnt vmcnt(2)
L_recurrent_scan__compressed_kv_cla__moe_arch_mod__prompt_kernel_swend_29:
    s_branch L_recurrent_scan__compressed_kv_cla__moe_arch_mod__prompt_kernel_w0b_28
L_recurrent_scan__compressed_kv_cla__moe_arch_mod__prompt_kernel_rare_32:
    v_and_b32 v16, 7, v1
    v_lshrrev_b32 v18, 3, v1
    v_mul_u32_u24 v19, 2064, v16
    v_lshl_add_u32 v19, v18, 4, v19
    s_lshl_b32 s36, s28, 8
    s_add_u32 s36, s36, 131072
    v_add_u32 v19, s36, v19
    ds_read_b128 v[120:123], v19
    ds_read_b128 v[124:127], v19 offset:128
    v_lshlrev_b32 v16, 4, v16
    v_lshl_add_u32 v16, v18, 8, v16
    s_lshr_b32 s36, s2, 1
    s_lshl_b32 s36, s36, 15
    s_and_b32 s37, s2, 1
    s_lshl_b32 s37, s37, 7
    s_add_u32 s36, s36, s37
    s_lshl_b32 s37, s28, 12
    s_add_u32 s36, s36, s37
    s_waitcnt lgkmcnt(0)
    buffer_store_dwordx4 v[120:123], v16, s[24:27], s36 offen sc1
    buffer_store_dwordx4 v[124:127], v16, s[24:27], s36 offen offset:2048 sc1
    s_cmp_eq_u32 s28, 7
    s_cbranch_scc0 L_recurrent_scan__compressed_kv_cla__moe_arch_mod__prompt_kernel_l7_31
    v_and_b32 v120, 7, v1
    v_lshlrev_b32 v120, 3, v120
    v_add_u32 v121, 147712, v120
    ds_read_b64 v[122:123], v121
    ds_read_b32 v124, v121 offset:64
    s_lshl_b32 s36, s2, 6
    s_add_u32 s36, s36, 4194304
    s_lshl_b32 s37, s2, 3
    s_add_u32 s37, s37, 4276224
    s_waitcnt lgkmcnt(0)
    v_mov_b32 v126, v124
    s_nop 1
    v_max_u32_dpp v126, v126, v126 quad_perm:[1,0,3,2] row_mask:0xf bank_mask:0xf
    s_nop 1
    v_max_u32_dpp v126, v126, v126 quad_perm:[2,3,0,1] row_mask:0xf bank_mask:0xf
    s_nop 1
    v_max_u32_dpp v126, v126, v126 row_half_mirror row_mask:0xf bank_mask:0xf
    v_cmp_eq_u32 vcc, v126, v124
    s_nop 1
    v_cndmask_b32 v127, v124, v118, vcc
    s_nop 1
    v_max_u32_dpp v127, v127, v127 quad_perm:[1,0,3,2] row_mask:0xf bank_mask:0xf
    s_nop 1
    v_max_u32_dpp v127, v127, v127 quad_perm:[2,3,0,1] row_mask:0xf bank_mask:0xf
    s_nop 1
    v_max_u32_dpp v127, v127, v127 row_half_mirror row_mask:0xf bank_mask:0xf
    s_mov_b64 exec, 0xff
    buffer_store_dwordx2 v[122:123], v120, s[24:27], s36 offen sc1
    s_mov_b64 exec, 1
    buffer_store_dwordx2 v[126:127], v120, s[24:27], s37 offen sc1
    s_mov_b64 exec, -1
    s_nop 3
L_recurrent_scan__compressed_kv_cla__moe_arch_mod__prompt_kernel_l7_31:
    s_branch L_recurrent_scan__compressed_kv_cla__moe_arch_mod__prompt_kernel_back_33
L_recurrent_scan__compressed_kv_cla__moe_arch_mod__prompt_kernel_rare_36:
    v_lshrrev_b32 v3, 4, v1
    s_lshl_b32 s37, s28, 4
    v_add_u32 v19, s37, v3
    v_lshlrev_b32 v19, 13, v19
    s_lshl_b32 s37, s29, 8
    v_add_u32 v19, s37, v19
    v_and_b32 v16, 15, v1
    v_lshlrev_b32 v3, 1, v3
    v_xor_b32 v16, v16, v3
    v_lshl_add_u32 v2, v16, 4, v19
    v_add_u32 v3, 31744, v2
    v_xor_b32 v16, 8, v16
    v_lshl_add_u32 v4, v16, 4, v19
    v_add_u32 v4, 63488, v4
    v_add_u32 v5, 31744, v4
    s_mov_b32 s4, s96
    s_and_b32 s5, s97, 0xffff
    s_mov_b32 s6, 8388608
    s_mov_b32 s7, 0x20000
    s_mov_b32 s31, 0
    s_mov_b32 s40, 1048576
    s_mov_b64 s[8:9], s[4:5]
    s_mov_b32 s10, s6
    s_mov_b32 s32, 2097152
    v_mov_b32 v6, v2
    v_mov_b32 v7, v3
    v_mov_b32 v8, v4
    v_mov_b32 v9, v5
    s_branch L_recurrent_scan__compressed_kv_cla__moe_arch_mod__prompt_kernel_back_37
L_recurrent_scan__compressed_kv_cla__moe_arch_mod__prompt_kernel_rare_42:
    s_mov_b32 s61, 0x40000
L_recurrent_scan__compressed_kv_cla__moe_arch_mod__prompt_kernel_spin_40:
    s_sub_u32 s61, s61, 1
    s_cbranch_scc1 L_recurrent_scan__compressed_kv_cla__moe_arch_mod__prompt_kernel_spinx_41
    s_sleep 8
    global_load_dword v56, v57, s[90:91] sc1
    s_waitcnt vmcnt(0)
    v_readfirstlane_b32 s36, v56
    s_nop 0
    s_cmp_lt_u32 s36, 1
    s_cbranch_scc1 L_recurrent_scan__compressed_kv_cla__moe_arch_mod__prompt_kernel_spin_40
L_recurrent_scan__compressed_kv_cla__moe_arch_mod__prompt_kernel_spinx_41:
    s_branch L_recurrent_scan__compressed_kv_cla__moe_arch_mod__prompt_kernel_back_43
L_recurrent_scan__compressed_kv_cla__moe_arch_mod__prompt_kernel_rare_45:
    s_cmp_eq_u32 s28, 0
    s_cbranch_scc0 L_recurrent_scan__compressed_kv_cla__moe_arch_mod__prompt_kernel_g_44
    s_waitcnt vmcnt(13)
    v_readfirstlane_b32 s36, v56
    s_nop 0
    s_cmp_lt_u32 s36, 1
    s_cbranch_scc1 L_recurrent_scan__compressed_kv_cla__moe_arch_mod__prompt_kernel_rare_42
L_recurrent_scan__compressed_kv_cla__moe_arch_mod__prompt_kernel_back_43:
L_recurrent_scan__compressed_kv_cla__moe_arch_mod__prompt_kernel_g_44:
    s_branch L_recurrent_scan__compressed_kv_cla__moe_arch_mod__prompt_kernel_back_46
L_recurrent_scan__compressed_kv_cla__moe_arch_mod__prompt_kernel_rare_47:
    s_cmp_eq_u32 s28, 0
    s_cbranch_scc0 L_recurrent_scan__compressed_kv_cla__moe_arch_mod__prompt_kernel_g_39
    s_add_u32 s36, s29, 64
    s_lshl_b32 s36, s36, 7
    v_mov_b32 v57, s36
    global_load_dword v56, v57, s[90:91] sc1
L_recurrent_scan__compressed_kv_cla__moe_arch_mod__prompt_kernel_g_39:
    s_branch L_recurrent_scan__compressed_kv_cla__moe_arch_mod__prompt_kernel_back_48
L_recurrent_scan__compressed_kv_cla__moe_arch_mod__prompt_kernel_rare_51:
    s_cmp_eq_u32 s35, 2
    s_cbranch_scc0 L_recurrent_scan__compressed_kv_cla__moe_arch_mod__prompt_kernel_swn_50
    s_mov_b32 s6, 0
    s_mov_b32 s34, 0x30000
    s_mov_b32 s41, 0x37fff
    s_lshl_b32 s36, s30, 3
    s_add_u32 s36, s28, s36
    s_cmp_eq_u32 s36, 4
    s_cbranch_scc0 L_recurrent_scan__compressed_kv_cla__moe_arch_mod__prompt_kernel_g_38
    s_add_u32 s36, s29, 64
    s_lshl_b32 s36, s36, 7
    v_mov_b32 v62, s36
    v_mov_b32 v63, 1
    s_mov_b64 exec, 1
    global_atomic_add v62, v63, s[90:91]
    s_mov_b64 exec, -1
    s_nop 3
L_recurrent_scan__compressed_kv_cla__moe_arch_mod__prompt_kernel_g_38:
    s_branch L_recurrent_scan__compressed_kv_cla__moe_arch_mod__prompt_kernel_swend_49
L_recurrent_scan__compressed_kv_cla__moe_arch_mod__prompt_kernel_swn_50:
    s_mov_b64 s[4:5], s[12:13]
    s_mov_b32 s6, s14
    s_mov_b32 s31, s45
    s_mov_b32 s40, 32768
    s_mov_b32 s34, s33
    v_add_u32 v2, s33, v58
    v_mov_b32 v3, v2
    v_mov_b32 v4, v2
    v_mov_b32 v5, v2
L_recurrent_scan__compressed_kv_cla__moe_arch_mod__prompt_kernel_swend_49:
    s_branch L_recurrent_scan__compressed_kv_cla__moe_arch_mod__prompt_kernel_back_52
L_recurrent_scan__compressed_kv_cla__moe_arch_mod__prompt_kernel_rare_53:
    s_branch L_recurrent_scan__compressed_kv_cla__moe_arch_mod__prompt_kernel_back_54
L_recurrent_scan__compressed_kv_cla__moe_arch_mod__prompt_kernel_rare_55:
    s_lshl_b32 s36, s39, 1
    s_add_u32 s36, s36, s38
    s_add_u32 s37, s36, s39
    buffer_store_dwordx4 v[160:163], v58, s[16:19], s36 offen sc1
    buffer_store_dwordx4 v[164:167], v59, s[16:19], s36 offen sc1
    buffer_store_dwordx4 v[168:171], v60, s[16:19], s36 offen sc1
    buffer_store_dwordx4 v[172:175], v61, s[16:19], s36 offen sc1
    buffer_store_dwordx4 v[176:179], v58, s[16:19], s37 offen sc1
    buffer_store_dwordx4 v[180:183], v59, s[16:19], s37 offen sc1
    buffer_store_dwordx4 v[184:187], v60, s[16:19], s37 offen sc1
    buffer_store_dwordx4 v[188:191], v61, s[16:19], s37 offen sc1
    s_branch L_recurrent_scan__compressed_kv_cla__moe_arch_mod__prompt_kernel_back_56
L_recurrent_scan__compressed_kv_cla__moe_arch_mod__prompt_kernel_rare_57:
    s_lshl_b32 s36, s29, 7
    v_mov_b32 v13, s36
    global_load_dword v14, v13, s[90:91] sc1
    s_branch L_recurrent_scan__compressed_kv_cla__moe_arch_mod__prompt_kernel_back_58
L_recurrent_scan__compressed_kv_cla__moe_arch_mod__prompt_kernel_rare_65:
    s_mov_b32 s41, 32768
    s_cmp_eq_u32 s40, 15
    s_cbranch_scc0 L_recurrent_scan__compressed_kv_cla__moe_arch_mod__prompt_kernel_r_59
    s_mov_b32 s41, 65536
    s_mov_b32 s49, 0x1ffff
    s_sub_u32 s36, 0, s50
    s_cmp_lt_i32 s36, 0
    s_cbranch_scc1 L_recurrent_scan__compressed_kv_cla__moe_arch_mod__prompt_kernel_nm_64
    v_mov_b32 v20, 4048155338
    s_cmp_gt_i32 s36, 0
    s_cbranch_scc1 L_recurrent_scan__compressed_kv_cla__moe_arch_mod__prompt_kernel_mf_62
    v_cmp_gt_i32 s[20:21], 0, v18
    v_cmp_gt_i32 s[22:23], 1, v18
    v_cmp_gt_i32 s[62:63], 2, v18
    v_cmp_gt_i32 vcc, 3, v18
    v_mov_b32 v100, v20
    v_mov_b32 v101, v20
    v_mov_b32 v102, v20
    v_mov_b32 v103, v20
    v_cndmask_b32 v96, v96, v20, s[20:21]
    v_cndmask_b32 v97, v97, v20, s[22:23]
    v_cndmask_b32 v98, v98, v20, s[62:63]
    v_cndmask_b32 v99, v99, v20, vcc
    v_cndmask_b32 v108, v108, v20, s[20:21]
    v_cndmask_b32 v109, v109, v20, s[22:23]
    v_cndmask_b32 v110, v110, v20, s[62:63]
    v_cndmask_b32 v111, v111, v20, vcc
    s_branch L_recurrent_scan__compressed_kv_cla__moe_arch_mod__prompt_kernel_me_63
L_recurrent_scan__compressed_kv_cla__moe_arch_mod__prompt_kernel_mf_62:
    v_mov_b32 v96, v20
    v_mov_b32 v97, v20
    v_mov_b32 v98, v20
    v_mov_b32 v99, v20
    v_mov_b32 v100, v20
    v_mov_b32 v101, v20
    v_mov_b32 v102, v20
    v_mov_b32 v103, v20
    v_mov_b32 v104, v20
    v_mov_b32 v105, v20
    v_mov_b32 v106, v20
    v_mov_b32 v107, v20
    v_mov_b32 v108, v20
    v_mov_b32 v109, v20
    v_mov_b32 v110, v20
    v_mov_b32 v111, v20
L_recurrent_scan__compressed_kv_cla__moe_arch_mod__prompt_kernel_me_63:
L_recurrent_scan__compressed_kv_cla__moe_arch_mod__prompt_kernel_nm_64:
L_recurrent_scan__compressed_kv_cla__moe_arch_mod__prompt_kernel_r_59:
    s_branch L_recurrent_scan__compressed_kv_cla__moe_arch_mod__prompt_kernel_back_66
L_recurrent_scan__compressed_kv_cla__moe_arch_mod__prompt_kernel_rare_75:
    s_mov_b32 s61, 0x40000
L_recurrent_scan__compressed_kv_cla__moe_arch_mod__prompt_kernel_spin_73:
    s_sub_u32 s61, s61, 1
    s_cbranch_scc1 L_recurrent_scan__compressed_kv_cla__moe_arch_mod__prompt_kernel_spinx_74
    s_sleep 8
    global_load_dword v14, v13, s[90:91] sc1
    s_waitcnt vmcnt(0)
    v_readfirstlane_b32 s36, v14
    s_nop 0
    s_cmp_lt_u32 s36, 7
    s_cbranch_scc1 L_recurrent_scan__compressed_kv_cla__moe_arch_mod__prompt_kernel_spin_73
L_recurrent_scan__compressed_kv_cla__moe_arch_mod__prompt_kernel_spinx_74:
    s_branch L_recurrent_scan__compressed_kv_cla__moe_arch_mod__prompt_kernel_back_76
L_recurrent_scan__compressed_kv_cla__moe_arch_mod__prompt_kernel_rare_81:
    s_cmp_eq_u32 s40, 1
    s_cbranch_scc0 L_recurrent_scan__compressed_kv_cla__moe_arch_mod__prompt_kernel_swn_78
    v_readfirstlane_b32 s36, v14
    s_nop 0
    s_cmp_lt_u32 s36, 7
    s_cbranch_scc1 L_recurrent_scan__compressed_kv_cla__moe_arch_mod__prompt_kernel_rare_75
L_recurrent_scan__compressed_kv_cla__moe_arch_mod__prompt_kernel_back_76:
    s_branch L_recurrent_scan__compressed_kv_cla__moe_arch_mod__prompt_kernel_swend_77
L_recurrent_scan__compressed_kv_cla__moe_arch_mod__prompt_kernel_swn_78:
    s_cmp_eq_u32 s40, 2
    s_cbranch_scc0 L_recurrent_scan__compressed_kv_cla__moe_arch_mod__prompt_kernel_swn_79
    s_mov_b32 s36, 4276224
    buffer_load_dwordx4 v[160:163], v7, s[24:27], s36 offen offset:0 sc1
    buffer_load_dwordx4 v[164:167], v7, s[24:27], s36 offen offset:1024 sc1
    s_branch L_recurrent_scan__compressed_kv_cla__moe_arch_mod__prompt_kernel_swend_77
L_recurrent_scan__compressed_kv_cla__moe_arch_mod__prompt_kernel_swn_79:
    s_cmp_eq_u32 s40, 3
    s_cbranch_scc0 L_recurrent_scan__compressed_kv_cla__moe_arch_mod__prompt_kernel_swn_80
    v_max_u32 v24, v160, v161
    v_min_u32 v25, v160, v161
    v_med3_u32 v25, v24, v25, v162
    v_max_u32 v24, v24, v162
    v_med3_u32 v25, v24, v25, v163
    v_max_u32 v24, v24, v163
    v_med3_u32 v25, v24, v25, v164
    v_max_u32 v24, v24, v164
    v_med3_u32 v25, v24, v25, v165
    v_max_u32 v24, v24, v165
    v_med3_u32 v25, v24, v25, v166
    v_max_u32 v24, v24, v166
    v_med3_u32 v25, v24, v25, v167
    v_max_u32 v24, v24, v167
    v_mov_b32 v26, v24
    s_nop 1
    v_max_u32_dpp v26, v26, v26 quad_perm:[1,0,3,2] row_mask:0xf bank_mask:0xf
    s_nop 1
    v_max_u32_dpp v26, v26, v26 quad_perm:[2,3,0,1] row_mask:0xf bank_mask:0xf
    s_nop 1
    v_max_u32_dpp v26, v26, v26 row_half_mirror row_mask:0xf bank_mask:0xf
    s_nop 1
    v_max_u32_dpp v26, v26, v26 row_mirror row_mask:0xf bank_mask:0xf
    s_nop 0
    v_readlane_b32 s20, v26, 0
    v_readlane_b32 s21, v26, 16
    v_readlane_b32 s22, v26, 32
    v_readlane_b32 s23, v26, 48
    s_max_u32 s20, s20, s21
    s_max_u32 s22, s22, s23
    s_max_u32 s20, s20, s22
    s_mov_b32 s58, s20
    v_cmp_eq_u32 vcc, s58, v24
    s_nop 1
    v_cndmask_b32 v26, v24, v25, vcc
    s_nop 1
    v_max_u32_dpp v26, v26, v26 quad_perm:[1,0,3,2] row_mask:0xf bank_mask:0xf
    s_nop 1
    v_max_u32_dpp v26, v26, v26 quad_perm:[2,3,0,1] row_mask:0xf bank_mask:0xf
    s_nop 1
    v_max_u32_dpp v26, v26, v26 row_half_mirror row_mask:0xf bank_mask:0xf
    s_nop 1
    v_max_u32_dpp v26, v26, v26 row_mirror row_mask:0xf bank_mask:0xf
    s_nop 0
    v_readlane_b32 s20, v26, 0
    v_readlane_b32 s21, v26, 16
    v_readlane_b32 s22, v26, 32
    v_readlane_b32 s23, v26, 48
    s_max_u32 s20, s20, s21
    s_max_u32 s22, s22, s23
    s_max_u32 s20, s20, s22
    s_mov_b32 s59, s20
    s_and_b32 s36, s58, 0xffff
    s_sub_u32 s56, 0xffff, s36
    s_and_b32 s36, s59, 0xffff
    s_sub_u32 s57, 0xffff, s36
    v_and_b32 v24, 1, v1
    v_mov_b32 v25, s56
    v_mov_b32 v26, s57
    v_cmp_eq_u32 vcc, 1, v24
    s_nop 1
    v_cndmask_b32 v25, v25, v26, vcc
    v_lshrrev_b32 v26, 4, v25
    v_lshlrev_b32 v26, 15, v26
    v_and_b32 v25, 15, v25
    v_lshl_add_u32 v26, v25, 4, v26
    v_lshrrev_b32 v27, 4, v1
    v_lshl_add_u32 v26, v27, 8, v26
    s_and_b32 s36, s3, 3
    s_lshl_b32 s36, s36, 13
    s_add_u32 s37, s36, 4096
    s_mov_b32 exec_lo, 0x00030003
    s_mov_b32 exec_hi, 0x00030003
    buffer_load_dwordx4 v[160:163], v26, s[24:27], s36 offen offset:0 sc1
    buffer_load_dwordx4 v[164:167], v26, s[24:27], s36 offen offset:1024 sc1
    buffer_load_dwordx4 v[168:171], v26, s[24:27], s36 offen offset:2048 sc1
    buffer_load_dwordx4 v[172:175], v26, s[24:27], s36 offen offset:3072 sc1
    buffer_load_dwordx4 v[176:179], v26, s[24:27], s37 offen offset:0 sc1
    buffer_load_dwordx4 v[180:183], v26, s[24:27], s37 offen offset:1024 sc1
    buffer_load_dwordx4 v[184:187], v26, s[24:27], s37 offen offset:2048 sc1
    buffer_load_dwordx4 v[188:191], v26, s[24:27], s37 offen offset:3072 sc1
    s_mov_b64 exec, -1
    s_branch L_recurrent_scan__compressed_kv_cla__moe_arch_mod__prompt_kernel_swend_77
L_recurrent_scan__compressed_kv_cla__moe_arch_mod__prompt_kernel_swn_80:
    s_sub_u32 s38, s40, s60
    s_cmp_eq_u32 s38, 0
    s_cbranch_scc0 L_recurrent_scan__compressed_kv_cla__moe_arch_mod__prompt_kernel_swn_69
    s_and_b32 s20, s3, 3
    s_lshl_b32 s20, s20, 8
    s_lshl_b32 s21, s28, 5
    s_add_u32 s20, s20, s21
    s_lshr_b32 s21, s3, 2
    s_lshl_b32 s21, s21, 7
    v_lshrrev_b32 v25, 3, v1
    s_lshl_b32 s36, s28, 5
    s_add_u32 s36, s36, s20
    v_add_u32 v25, s36, v25
    v_mul_u32_u24 v25, 7168, v25
    v_add_u32 v25, s21, v25
    v_bfe_u32 v26, v1, 4, 1
    v_lshlrev_b32 v26, 1, v26
    v_and_b32 v27, 7, v1
    v_xor_b32 v26, v26, v27
    v_lshl_add_u32 v24, v26, 4, v25
    v_xor_b32 v26, 4, v26
    v_lshl_add_u32 v25, v26, 4, v25
    v_add_u32 v25, 56320, v25
    v_add_u32 v26, 112640, v24
    v_add_u32 v27, 112640, v25
    s_lshl_b32 s36, s28, 13
    s_add_u32 m0, s36, 131072
    s_mov_b32 s37, 229376
    buffer_load_dwordx4 v24, s[4:7], 0 offen offset:0 nt lds
    buffer_load_dwordx4 v25, s[4:7], 0 offen offset:1024 nt lds
    buffer_load_dwordx4 v26, s[4:7], 0 offen offset:2048 nt lds
    buffer_load_dwordx4 v27, s[4:7], 0 offen offset:3072 nt lds
    s_add_u32 m0, s36, 135168
    s_nop 0
    buffer_load_dwordx4 v24, s[4:7], s37 offen offset:0 nt lds
    buffer_load_dwordx4 v25, s[4:7], s37 offen offset:1024 nt lds
    buffer_load_dwordx4 v26, s[4:7], s37 offen offset:2048 nt lds
    buffer_load_dwordx4 v27, s[4:7], s37 offen offset:3072 nt lds
    s_branch L_recurrent_scan__compressed_kv_cla__moe_arch_mod__prompt_kernel_swend_68
L_recurrent_scan__compressed_kv_cla__moe_arch_mod__prompt_kernel_swn_69:
    s_cmp_eq_u32 s38, 2
    s_cbranch_scc0 L_recurrent_scan__compressed_kv_cla__moe_arch_mod__prompt_kernel_swn_70
    v_lshrrev_b32 v8, 4, v1
    v_bfe_u32 v5, v1, 2, 2
    v_lshl_add_u32 v5, v8, 3, v5
    v_lshlrev_b32 v5, 7, v5
    v_and_b32 v9, 3, v1
    v_lshl_add_u32 v5, v9, 3, v5
    v_bfe_u32 v9, v1, 3, 2
    v_xor_b32 v9, s28, v9
    v_lshl_add_u32 v5, v9, 5, v5
    v_add_u32 v5, 131072, v5
    ds_read_b64_tr_b16 v[14:15], v5 offset:0
    ds_read_b64_tr_b16 v[16:17], v5 offset:512
    ds_read_b64_tr_b16 v[20:21], v5 offset:4096
    ds_read_b64_tr_b16 v[22:23], v5 offset:4608
    ds_read_b64_tr_b16 v[24:25], v5 offset:8192
    ds_read_b64_tr_b16 v[26:27], v5 offset:8704
    s_and_b32 s36, s3, 3
    s_lshl_b32 s36, s36, 6
    s_lshr_b32 s37, s3, 2
    s_lshl_b32 s37, s37, 12
    s_add_u32 s36, s36, s37
    s_lshl_b32 s37, s28, 10
    s_add_u32 s36, s36, s37
    s_add_u32 s36, s36, 58720256
    v_and_b32 v9, 1, v1
    v_lshlrev_b32 v9, 4, v9
    v_lshl_add_u32 v9, v8, 8, v9
    s_waitcnt lgkmcnt(4)
    v_mfma_f32_16x16x32_bf16 v[10:13], v[14:17], v[160:163], 0
    ds_read_b64_tr_b16 v[14:15], v5 offset:12288
    ds_read_b64_tr_b16 v[16:17], v5 offset:12800
    s_waitcnt lgkmcnt(4)
    v_mfma_f32_16x16x32_bf16 v[10:13], v[20:23], v[164:167], v[10:13]
    ds_read_b64_tr_b16 v[20:21], v5 offset:16384
    ds_read_b64_tr_b16 v[22:23], v5 offset:16896
    s_waitcnt lgkmcnt(4)
    v_mfma_f32_16x16x32_bf16 v[10:13], v[24:27], v[168:171], v[10:13]
    ds_read_b64_tr_b16 v[24:25], v5 offset:20480
    ds_read_b64_tr_b16 v[26:27], v5 offset:20992
    s_waitcnt lgkmcnt(4)
    v_mfma_f32_16x16x32_bf16 v[10:13], v[14:17], v[172:175], v[10:13]
    ds_read_b64_tr_b16 v[14:15], v5 offset:24576
    ds_read_b64_tr_b16 v[16:17], v5 offset:25088
    s_waitcnt lgkmcnt(4)
    v_mfma_f32_16x16x32_bf16 v[10:13], v[20:23], v[176:179], v[10:13]
    ds_read_b64_tr_b16 v[20:21], v5 offset:28672
    ds_read_b64_tr_b16 v[22:23], v5 offset:29184
    s_waitcnt lgkmcnt(4)
    v_mfma_f32_16x16x32_bf16 v[10:13], v[24:27], v[180:183], v[10:13]
    s_waitcnt lgkmcnt(2)
    v_mfma_f32_16x16x32_bf16 v[10:13], v[14:17], v[184:187], v[10:13]
    s_waitcnt lgkmcnt(0)
    v_mfma_f32_16x16x32_bf16 v[10:13], v[20:23], v[188:191], v[10:13]
    s_nop 5
    s_mov_b32 exec_lo, 0x00030003
    s_mov_b32 exec_hi, 0x00030003
    buffer_store_dwordx4 v[10:13], v9, s[24:27], s36 offen sc1
    s_mov_b64 exec, -1
    s_nop 1
    s_branch L_recurrent_scan__compressed_kv_cla__moe_arch_mod__prompt_kernel_swend_68
L_recurrent_scan__compressed_kv_cla__moe_arch_mod__prompt_kernel_swn_70:
    s_cmp_eq_u32 s38, 3
    s_cbranch_scc0 L_recurrent_scan__compressed_kv_cla__moe_arch_mod__prompt_kernel_swn_71
    s_and_b32 s20, s3, 3
    s_lshl_b32 s20, s20, 8
    s_lshl_b32 s21, s28, 5
    s_add_u32 s20, s20, s21
    s_lshr_b32 s21, s3, 2
    s_lshl_b32 s21, s21, 7
    v_lshrrev_b32 v25, 3, v1
    s_lshl_b32 s36, s28, 5
    s_add_u32 s36, s36, s20
    v_add_u32 v25, s36, v25
    v_mul_u32_u24 v25, 7168, v25
    v_add_u32 v25, s21, v25
    v_bfe_u32 v26, v1, 4, 1
    v_lshlrev_b32 v26, 1, v26
    v_and_b32 v27, 7, v1
    v_xor_b32 v26, v26, v27
    v_lshl_add_u32 v24, v26, 4, v25
    v_xor_b32 v26, 4, v26
    v_lshl_add_u32 v25, v26, 4, v25
    v_add_u32 v25, 56320, v25
    v_add_u32 v26, 112640, v24
    v_add_u32 v27, 112640, v25
    s_lshl_b32 s36, s28, 13
    s_add_u32 m0, s36, 131072
    s_mov_b32 s37, 229376
    buffer_load_dwordx4 v24, s[8:11], 0 offen offset:0 nt lds
    buffer_load_dwordx4 v25, s[8:11], 0 offen offset:1024 nt lds
    buffer_load_dwordx4 v26, s[8:11], 0 offen offset:2048 nt lds
    buffer_load_dwordx4 v27, s[8:11], 0 offen offset:3072 nt lds
    s_add_u32 m0, s36, 135168
    s_nop 0
    buffer_load_dwordx4 v24, s[8:11], s37 offen offset:0 nt lds
    buffer_load_dwordx4 v25, s[8:11], s37 offen offset:1024 nt lds
    buffer_load_dwordx4 v26, s[8:11], s37 offen offset:2048 nt lds
    buffer_load_dwordx4 v27, s[8:11], s37 offen offset:3072 nt lds
    s_branch L_recurrent_scan__compressed_kv_cla__moe_arch_mod__prompt_kernel_swend_68
L_recurrent_scan__compressed_kv_cla__moe_arch_mod__prompt_kernel_swn_71:
    s_cmp_eq_u32 s38, 5
    s_cbranch_scc0 L_recurrent_scan__compressed_kv_cla__moe_arch_mod__prompt_kernel_swn_72
    v_lshrrev_b32 v8, 4, v1
    v_bfe_u32 v5, v1, 2, 2
    v_lshl_add_u32 v5, v8, 3, v5
    v_lshlrev_b32 v5, 7, v5
    v_and_b32 v9, 3, v1
    v_lshl_add_u32 v5, v9, 3, v5
    v_bfe_u32 v9, v1, 3, 2
    v_xor_b32 v9, s28, v9
    v_lshl_add_u32 v5, v9, 5, v5
    v_add_u32 v5, 131072, v5
    ds_read_b64_tr_b16 v[14:15], v5 offset:0
    ds_read_b64_tr_b16 v[16:17], v5 offset:512
    ds_read_b64_tr_b16 v[20:21], v5 offset:4096
    ds_read_b64_tr_b16 v[22:23], v5 offset:4608
    ds_read_b64_tr_b16 v[24:25], v5 offset:8192
    ds_read_b64_tr_b16 v[26:27], v5 offset:8704
    s_and_b32 s36, s3, 3
    s_lshl_b32 s36, s36, 6
    s_lshr_b32 s37, s3, 2
    s_lshl_b32 s37, s37, 12
    s_add_u32 s36, s36, s37
    s_lshl_b32 s37, s28, 10
    s_add_u32 s36, s36, s37
    s_add_u32 s36, s36, 58720288
    v_and_b32 v9, 1, v1
    v_lshlrev_b32 v9, 4, v9
    v_lshl_add_u32 v9, v8, 8, v9
    s_waitcnt lgkmcnt(4)
    v_mfma_f32_16x16x32_bf16 v[10:13], v[14:17], v[160:163], 0
    ds_read_b64_tr_b16 v[14:15], v5 offset:12288
    ds_read_b64_tr_b16 v[16:17], v5 offset:12800
    s_waitcnt lgkmcnt(4)
    v_mfma_f32_16x16x32_bf16 v[10:13], v[20:23], v[164:167], v[10:13]
    ds_read_b64_tr_b16 v[20:21], v5 offset:16384
    ds_read_b64_tr_b16 v[22:23], v5 offset:16896
    s_waitcnt lgkmcnt(4)
    v_mfma_f32_16x16x32_bf16 v[10:13], v[24:27], v[168:171], v[10:13]
    ds_read_b64_tr_b16 v[24:25], v5 offset:20480
    ds_read_b64_tr_b16 v[26:27], v5 offset:20992
    s_waitcnt lgkmcnt(4)
    v_mfma_f32_16x16x32_bf16 v[10:13], v[14:17], v[172:175], v[10:13]
    ds_read_b64_tr_b16 v[14:15], v5 offset:24576
    ds_read_b64_tr_b16 v[16:17], v5 offset:25088
    s_waitcnt lgkmcnt(4)
    v_mfma_f32_16x16x32_bf16 v[10:13], v[20:23], v[176:179], v[10:13]
    ds_read_b64_tr_b16 v[20:21], v5 offset:28672
    ds_read_b64_tr_b16 v[22:23], v5 offset:29184
    s_waitcnt lgkmcnt(4)
    v_mfma_f32_16x16x32_bf16 v[10:13], v[24:27], v[180:183], v[10:13]
    s_waitcnt lgkmcnt(2)
    v_mfma_f32_16x16x32_bf16 v[10:13], v[14:17], v[184:187], v[10:13]
    s_waitcnt lgkmcnt(0)
    v_mfma_f32_16x16x32_bf16 v[10:13], v[20:23], v[188:191], v[10:13]
    s_nop 5
    s_mov_b32 exec_lo, 0x00030003
    s_mov_b32 exec_hi, 0x00030003
    buffer_store_dwordx4 v[10:13], v9, s[24:27], s36 offen sc1
    s_mov_b64 exec, -1
    s_nop 1
    s_branch L_recurrent_scan__compressed_kv_cla__moe_arch_mod__prompt_kernel_swend_68
L_recurrent_scan__compressed_kv_cla__moe_arch_mod__prompt_kernel_swn_72:
    s_mul_i32 s36, s3, 2341
    s_lshr_b32 s36, s36, 16
    s_add_u32 s36, s36, 48
    s_lshl_b32 s36, s36, 7
    v_mov_b32 v20, s36
    v_mov_b32 v21, 1
    s_mov_b64 exec, 1
    global_atomic_add v20, v21, s[90:91]
    s_mov_b64 exec, -1
    s_nop 3
L_recurrent_scan__compressed_kv_cla__moe_arch_mod__prompt_kernel_swend_68:
L_recurrent_scan__compressed_kv_cla__moe_arch_mod__prompt_kernel_swend_77:
    s_branch L_recurrent_scan__compressed_kv_cla__moe_arch_mod__prompt_kernel_back_82
L_recurrent_scan__compressed_kv_cla__moe_arch_mod__prompt_kernel_rare_93:
    v_mov_b32 v20, 4048155338
    s_cmp_gt_i32 s36, 0
    s_cbranch_scc1 L_recurrent_scan__compressed_kv_cla__moe_arch_mod__prompt_kernel_mf_91
    v_cmp_gt_i32 s[20:21], 0, v18
    v_cmp_gt_i32 s[22:23], 1, v18
    v_cmp_gt_i32 s[62:63], 2, v18
    v_cmp_gt_i32 vcc, 3, v18
    v_mov_b32 v116, v20
    v_mov_b32 v117, v20
    v_mov_b32 v118, v20
    v_mov_b32 v119, v20
    v_cndmask_b32 v112, v112, v20, s[20:21]
    v_cndmask_b32 v113, v113, v20, s[22:23]
    v_cndmask_b32 v114, v114, v20, s[62:63]
    v_cndmask_b32 v115, v115, v20, vcc
    v_cndmask_b32 v124, v124, v20, s[20:21]
    v_cndmask_b32 v125, v125, v20, s[22:23]
    v_cndmask_b32 v126, v126, v20, s[62:63]
    v_cndmask_b32 v127, v127, v20, vcc
    s_branch L_recurrent_scan__compressed_kv_cla__moe_arch_mod__prompt_kernel_me_92
L_recurrent_scan__compressed_kv_cla__moe_arch_mod__prompt_kernel_mf_91:
    v_mov_b32 v112, v20
    v_mov_b32 v113, v20
    v_mov_b32 v114, v20
    v_mov_b32 v115, v20
    v_mov_b32 v116, v20
    v_mov_b32 v117, v20
    v_mov_b32 v118, v20
    v_mov_b32 v119, v20
    v_mov_b32 v120, v20
    v_mov_b32 v121, v20
    v_mov_b32 v122, v20
    v_mov_b32 v123, v20
    v_mov_b32 v124, v20
    v_mov_b32 v125, v20
    v_mov_b32 v126, v20
    v_mov_b32 v127, v20
L_recurrent_scan__compressed_kv_cla__moe_arch_mod__prompt_kernel_me_92:
    s_branch L_recurrent_scan__compressed_kv_cla__moe_arch_mod__prompt_kernel_back_94
L_recurrent_scan__compressed_kv_cla__moe_arch_mod__prompt_kernel_rare_97:
    s_mov_b32 s61, 0x40000
L_recurrent_scan__compressed_kv_cla__moe_arch_mod__prompt_kernel_spin_95:
    s_sub_u32 s61, s61, 1
    s_cbranch_scc1 L_recurrent_scan__compressed_kv_cla__moe_arch_mod__prompt_kernel_spinx_96
    s_sleep 8
    global_load_dword v11, v12, s[90:91] sc1
    s_waitcnt vmcnt(0)
    v_readfirstlane_b32 s36, v11
    s_nop 0
    s_cmp_lt_u32 s36, 28
    s_cbranch_scc1 L_recurrent_scan__compressed_kv_cla__moe_arch_mod__prompt_kernel_spin_95
L_recurrent_scan__compressed_kv_cla__moe_arch_mod__prompt_kernel_spinx_96:
    s_branch L_recurrent_scan__compressed_kv_cla__moe_arch_mod__prompt_kernel_back_98
L_recurrent_scan__compressed_kv_cla__moe_arch_mod__prompt_kernel_rare_104:
    v_mov_b32 v20, 4048155338
    s_cmp_gt_i32 s50, 0
    s_cbranch_scc1 L_recurrent_scan__compressed_kv_cla__moe_arch_mod__prompt_kernel_mf_102
    v_cmp_gt_i32 s[20:21], 0, v18
    v_cmp_gt_i32 s[22:23], 1, v18
    v_cmp_gt_i32 s[62:63], 2, v18
    v_cmp_gt_i32 vcc, 3, v18
    v_mov_b32 v100, v20
    v_mov_b32 v101, v20
    v_mov_b32 v102, v20
    v_mov_b32 v103, v20
    v_cndmask_b32 v96, v96, v20, s[20:21]
    v_cndmask_b32 v97, v97, v20, s[22:23]
    v_cndmask_b32 v98, v98, v20, s[62:63]
    v_cndmask_b32 v99, v99, v20, vcc
    v_cndmask_b32 v108, v108, v20, s[20:21]
    v_cndmask_b32 v109, v109, v20, s[22:23]
    v_cndmask_b32 v110, v110, v20, s[62:63]
    v_cndmask_b32 v111, v111, v20, vcc
    s_branch L_recurrent_scan__compressed_kv_cla__moe_arch_mod__prompt_kernel_me_103
L_recurrent_scan__compressed_kv_cla__moe_arch_mod__prompt_kernel_mf_102:
    v_mov_b32 v96, v20
    v_mov_b32 v97, v20
    v_mov_b32 v98, v20
    v_mov_b32 v99, v20
    v_mov_b32 v100, v20
    v_mov_b32 v101, v20
    v_mov_b32 v102, v20
    v_mov_b32 v103, v20
    v_mov_b32 v104, v20
    v_mov_b32 v105, v20
    v_mov_b32 v106, v20
    v_mov_b32 v107, v20
    v_mov_b32 v108, v20
    v_mov_b32 v109, v20
    v_mov_b32 v110, v20
    v_mov_b32 v111, v20
L_recurrent_scan__compressed_kv_cla__moe_arch_mod__prompt_kernel_me_103:
    s_branch L_recurrent_scan__compressed_kv_cla__moe_arch_mod__prompt_kernel_back_105
L_grp1:
    v_mov_b32 v20, 1040356334
    v_mov_b32 v21, v20
    s_and_b32 s37, s28, 3
    s_lshl_b32 s37, s37, 13
    v_lshlrev_b32 v7, 4, v1
    v_add_u32 v4, s37, v7
    v_add_u32 v19, 131072, v4
    v_add_u32 v6, 4096, v4
    s_add_u32 s43, s37, 32768
    s_add_u32 s44, s37, 98304
    v_pk_mul_f32 v[192:193], v[192:193], v[20:21]
    v_pk_mul_f32 v[194:195], v[194:195], v[20:21]
    v_pk_mul_f32 v[196:197], v[196:197], v[20:21]
    v_pk_mul_f32 v[198:199], v[198:199], v[20:21]
    v_cvt_pk_bf16_f32 v128, v192, v193
    v_cvt_pk_bf16_f32 v129, v194, v195
    v_cvt_pk_bf16_f32 v130, v196, v197
    v_cvt_pk_bf16_f32 v131, v198, v199
    v_pk_mul_f32 v[200:201], v[200:201], v[20:21]
    v_pk_mul_f32 v[202:203], v[202:203], v[20:21]
    v_pk_mul_f32 v[204:205], v[204:205], v[20:21]
    v_pk_mul_f32 v[206:207], v[206:207], v[20:21]
    v_cvt_pk_bf16_f32 v132, v200, v201
    v_cvt_pk_bf16_f32 v133, v202, v203
    v_cvt_pk_bf16_f32 v134, v204, v205
    v_cvt_pk_bf16_f32 v135, v206, v207
    v_pk_mul_f32 v[208:209], v[208:209], v[20:21]
    v_pk_mul_f32 v[210:211], v[210:211], v[20:21]
    v_pk_mul_f32 v[212:213], v[212:213], v[20:21]
    v_pk_mul_f32 v[214:215], v[214:215], v[20:21]
    v_cvt_pk_bf16_f32 v136, v208, v209
    v_cvt_pk_bf16_f32 v137, v210, v211
    v_cvt_pk_bf16_f32 v138, v212, v213
    v_cvt_pk_bf16_f32 v139, v214, v215
    v_pk_mul_f32 v[216:217], v[216:217], v[20:21]
    v_pk_mul_f32 v[218:219], v[218:219], v[20:21]
    v_pk_mul_f32 v[220:221], v[220:221], v[20:21]
    v_pk_mul_f32 v[222:223], v[222:223], v[20:21]
    v_cvt_pk_bf16_f32 v140, v216, v217
    v_cvt_pk_bf16_f32 v141, v218, v219
    v_cvt_pk_bf16_f32 v142, v220, v221
    v_cvt_pk_bf16_f32 v143, v222, v223
    v_pk_mul_f32 v[224:225], v[224:225], v[20:21]
    v_pk_mul_f32 v[226:227], v[226:227], v[20:21]
    v_pk_mul_f32 v[228:229], v[228:229], v[20:21]
    v_pk_mul_f32 v[230:231], v[230:231], v[20:21]
    v_cvt_pk_bf16_f32 v144, v224, v225
    v_cvt_pk_bf16_f32 v145, v226, v227
    v_cvt_pk_bf16_f32 v146, v228, v229
    v_cvt_pk_bf16_f32 v147, v230, v231
    v_pk_mul_f32 v[232:233], v[232:233], v[20:21]
    v_pk_mul_f32 v[234:235], v[234:235], v[20:21]
    v_pk_mul_f32 v[236:237], v[236:237], v[20:21]
    v_pk_mul_f32 v[238:239], v[238:239], v[20:21]
    v_cvt_pk_bf16_f32 v148, v232, v233
    v_cvt_pk_bf16_f32 v149, v234, v235
    v_cvt_pk_bf16_f32 v150, v236, v237
    v_cvt_pk_bf16_f32 v151, v238, v239
    v_pk_mul_f32 v[240:241], v[240:241], v[20:21]
    v_pk_mul_f32 v[242:243], v[242:243], v[20:21]
    v_pk_mul_f32 v[244:245], v[244:245], v[20:21]
    v_pk_mul_f32 v[246:247], v[246:247], v[20:21]
    v_cvt_pk_bf16_f32 v152, v240, v241
    v_cvt_pk_bf16_f32 v153, v242, v243
    v_cvt_pk_bf16_f32 v154, v244, v245
    v_cvt_pk_bf16_f32 v155, v246, v247
    v_pk_mul_f32 v[248:249], v[248:249], v[20:21]
    v_pk_mul_f32 v[250:251], v[250:251], v[20:21]
    v_pk_mul_f32 v[252:253], v[252:253], v[20:21]
    v_pk_mul_f32 v[254:255], v[254:255], v[20:21]
    v_cvt_pk_bf16_f32 v156, v248, v249
    v_cvt_pk_bf16_f32 v157, v250, v251
    v_cvt_pk_bf16_f32 v158, v252, v253
    v_cvt_pk_bf16_f32 v159, v254, v255
    v_mov_b32 v2, v7
    v_and_b32 v21, 15, v1
    v_lshrrev_b32 v22, 4, v1
    v_lshlrev_b32 v22, 2, v22
    v_sub_u32 v18, v21, v22
    s_mov_b32 s40, 0
    s_mov_b32 s41, 16384
    s_mov_b32 s49, 0xffff
    s_lshl_b32 s51, s30, 1
    s_add_u32 s51, s51, 1
    s_and_b32 s50, s28, 3
    s_lshl_b32 s50, s50, 5
    s_lshl_b32 s42, 7, s51
    s_lshr_b32 s42, s42, 2
    s_or_b32 s42, s42, 0x8001
    s_mov_b64 s[52:53], 0
    s_waitcnt vmcnt(4) lgkmcnt(0)
    s_barrier
    ds_read_b128 v[64:67], v2 offset:0
    ds_read_b128 v[68:71], v2 offset:1024
    ds_read_b128 v[72:75], v2 offset:2048
    ds_read_b128 v[76:79], v2 offset:3072
    ds_read_b128 v[80:83], v2 offset:4096
    ds_read_b128 v[84:87], v2 offset:5120
    ds_read_b128 v[88:91], v2 offset:6144
    ds_read_b128 v[92:95], v2 offset:7168
    ds_read_b128 v[160:163], v19 offset:0
    ds_read_b128 v[164:167], v19 offset:1024
    ds_read_b128 v[168:171], v19 offset:2048
    ds_read_b128 v[172:175], v19 offset:3072
    ds_read_b128 v[176:179], v19 offset:4096
    ds_read_b128 v[180:183], v19 offset:5120
    ds_read_b128 v[184:187], v19 offset:6144
    ds_read_b128 v[188:191], v19 offset:7168
    v_mov_b32 v36, 0x3f803f80
    v_mov_b32 v37, 0x3f803f80
    v_mov_b32 v38, 0x3f803f80
    v_mov_b32 v39, 0x3f803f80
    s_add_u32 s16, s54, 41943040
    s_addc_u32 s17, s55, 0
    s_and_b32 s17, s17, 0xffff
    s_mov_b32 s18, 117440640
    s_mov_b32 s19, 0x20000
    s_cmp_eq_u32 s28, 4
    s_cbranch_scc1 L_recurrent_scan__compressed_kv_cla__moe_arch_mod__prompt_kernel_rare_144
L_recurrent_scan__compressed_kv_cla__moe_arch_mod__prompt_kernel_back_145:
    s_sub_u32 s36, s2, 160
    s_lshl_b32 s36, s36, 1
    s_and_b32 s37, s28, 1
    s_add_u32 s36, s36, s37
    s_min_u32 s36, s36, 1024
    s_mul_i32 s36, s36, 43776
    s_cmp_lt_u32 s28, 6
    s_cselect_b64 s[4:5], s[32:33], s[34:35]
    s_cselect_b32 s37, 32, 28
    s_lshl_b32 s37, s37, 18
    s_min_u32 s36, s36, s37
    s_sub_u32 s6, s37, s36
    s_min_u32 s6, s6, 43776
    s_add_u32 s4, s4, s36
    s_addc_u32 s5, s5, 0
    s_and_b32 s5, s5, 0xffff
    s_mov_b32 s7, 0x20000
    v_cmp_gt_u32 vcc, 32, v1
    v_lshlrev_b32 v13, 7, v1
    v_mov_b32 v12, 0x100000
    v_cndmask_b32 v13, v12, v13, vcc
    s_mov_b32 s48, 0
    s_cmp_eq_u32 s28, 5
    s_cselect_b32 s36, 0x1000, 0
    s_or_b32 s42, s42, s36
    s_waitcnt lgkmcnt(15)
    v_mfma_f32_16x16x32_bf16 v[96:99], v[64:67], v[128:131], 0
    v_mov_b64 v[192:193], 0
    v_mov_b64 v[194:195], 0
    v_mfma_f32_16x16x32_bf16 v[104:107], v[64:67], v[144:147], 0
    ds_read_b128 v[64:67], v2 offset:8192
    v_mov_b64 v[196:197], 0
    v_mov_b64 v[198:199], 0
    s_waitcnt lgkmcnt(15)
    v_mfma_f32_16x16x32_bf16 v[96:99], v[68:71], v[132:135], v[96:99]
    v_mov_b64 v[200:201], 0
    v_mov_b64 v[202:203], 0
    v_mfma_f32_16x16x32_bf16 v[104:107], v[68:71], v[148:151], v[104:107]
    ds_read_b128 v[68:71], v2 offset:9216
    v_mov_b64 v[204:205], 0
    v_mov_b64 v[206:207], 0
    s_waitcnt lgkmcnt(15)
    v_mfma_f32_16x16x32_bf16 v[96:99], v[72:75], v[136:139], v[96:99]
    v_mov_b64 v[208:209], 0
    v_mfma_f32_16x16x32_bf16 v[104:107], v[72:75], v[152:155], v[104:107]
    ds_read_b128 v[72:75], v2 offset:10240
    v_mov_b64 v[210:211], 0
    v_mov_b64 v[212:213], 0
    s_waitcnt lgkmcnt(15)
    v_mfma_f32_16x16x32_bf16 v[96:99], v[76:79], v[140:143], v[96:99]
    v_mov_b64 v[214:215], 0
    v_mov_b64 v[216:217], 0
    v_mfma_f32_16x16x32_bf16 v[104:107], v[76:79], v[156:159], v[104:107]
    ds_read_b128 v[76:79], v2 offset:11264
    v_mov_b64 v[218:219], 0
    v_mov_b64 v[220:221], 0
    s_waitcnt lgkmcnt(15)
    v_mfma_f32_16x16x32_bf16 v[100:103], v[80:83], v[128:131], 0
    v_mov_b64 v[222:223], 0
    v_mov_b64 v[224:225], 0
    v_mfma_f32_16x16x32_bf16 v[108:111], v[80:83], v[144:147], 0
    ds_read_b128 v[80:83], v2 offset:12288
    v_mov_b64 v[226:227], 0
    s_waitcnt lgkmcnt(15)
    v_mfma_f32_16x16x32_bf16 v[100:103], v[84:87], v[132:135], v[100:103]
    v_mov_b64 v[228:229], 0
    v_mov_b64 v[230:231], 0
    v_mfma_f32_16x16x32_bf16 v[108:111], v[84:87], v[148:151], v[108:111]
    ds_read_b128 v[84:87], v2 offset:13312
    v_mov_b64 v[232:233], 0
    v_mov_b64 v[234:235], 0
    s_waitcnt lgkmcnt(15)
    v_mfma_f32_16x16x32_bf16 v[100:103], v[88:91], v[136:139], v[100:103]
    v_mov_b64 v[236:237], 0
    v_mov_b64 v[238:239], 0
    v_mfma_f32_16x16x32_bf16 v[108:111], v[88:91], v[152:155], v[108:111]
    ds_read_b128 v[88:91], v2 offset:14336
    v_mov_b64 v[240:241], 0
    v_mov_b64 v[242:243], 0
    s_waitcnt lgkmcnt(15)
    v_mfma_f32_16x16x32_bf16 v[100:103], v[92:95], v[140:143], v[100:103]
    v_mov_b64 v[244:245], 0
    v_mfma_f32_16x16x32_bf16 v[108:111], v[92:95], v[156:159], v[108:111]
    ds_read_b128 v[92:95], v2 offset:15360
    v_mov_b64 v[246:247], 0
    v_mov_b64 v[248:249], 0
    s_waitcnt lgkmcnt(7)
    v_mfma_f32_16x16x32_bf16 v[112:115], v[64:67], v[128:131], 0
    v_mov_b64 v[250:251], 0
    v_mov_b64 v[252:253], 0
    v_mfma_f32_16x16x32_bf16 v[120:123], v[64:67], v[144:147], 0
    v_mov_b64 v[254:255], 0
    v_mov_b64 v[28:29], 0
    s_waitcnt lgkmcnt(6)
    v_mfma_f32_16x16x32_bf16 v[112:115], v[68:71], v[132:135], v[112:115]
    v_mov_b64 v[30:31], 0
    v_mov_b64 v[32:33], 0
    v_mfma_f32_16x16x32_bf16 v[120:123], v[68:71], v[148:151], v[120:123]
    v_mov_b64 v[34:35], 0
    s_waitcnt lgkmcnt(5)
    v_mfma_f32_16x16x32_bf16 v[112:115], v[72:75], v[136:139], v[112:115]
    s_add_u32 s36, s30, s50
    s_cmp_eq_u32 s36, 0
    s_cbranch_scc1 L_recurrent_scan__compressed_kv_cla__moe_arch_mod__prompt_kernel_rare_109
L_recurrent_scan__compressed_kv_cla__moe_arch_mod__prompt_kernel_back_110:
    v_mfma_f32_16x16x32_bf16 v[120:123], v[72:75], v[152:155], v[120:123]
    v_max3_f32 v22, v96, v97, v98
    v_max3_f32 v23, v104, v105, v106
    s_waitcnt lgkmcnt(4)
    v_mfma_f32_16x16x32_bf16 v[112:115], v[76:79], v[140:143], v[112:115]
    v_max3_f32 v22, v22, v99, v100
    v_max3_f32 v23, v23, v107, v108
    v_mfma_f32_16x16x32_bf16 v[120:123], v[76:79], v[156:159], v[120:123]
    v_max3_f32 v22, v22, v101, v102
    v_max3_f32 v23, v23, v109, v110
    s_waitcnt lgkmcnt(3)
    v_mfma_f32_16x16x32_bf16 v[116:119], v[80:83], v[128:131], 0
    v_max_f32 v22, v22, v103
    v_max_f32 v23, v23, v111
    v_mfma_f32_16x16x32_bf16 v[124:127], v[80:83], v[144:147], 0
    v_mov_b32 v24, v22
    v_mov_b32 v25, v23
    s_waitcnt lgkmcnt(2)
    v_mfma_f32_16x16x32_bf16 v[116:119], v[84:87], v[132:135], v[116:119]
    v_permlane16_swap_b32 v22, v24
    v_permlane16_swap_b32 v23, v25
    v_mfma_f32_16x16x32_bf16 v[124:127], v[84:87], v[148:151], v[124:127]
    v_max_f32 v22, v22, v24
    v_max_f32 v23, v23, v25
    s_waitcnt lgkmcnt(1)
    v_mfma_f32_16x16x32_bf16 v[116:119], v[88:91], v[136:139], v[116:119]
    v_mov_b32 v24, v22
    v_mov_b32 v25, v23
    v_mfma_f32_16x16x32_bf16 v[124:127], v[88:91], v[152:155], v[124:127]
    v_permlane32_swap_b32 v22, v24
    v_permlane32_swap_b32 v23, v25
    s_waitcnt lgkmcnt(0)
    v_mfma_f32_16x16x32_bf16 v[116:119], v[92:95], v[140:143], v[116:119]
    v_max_f32 v22, v22, v24
    v_max_f32 v23, v23, v25
    v_mfma_f32_16x16x32_bf16 v[124:127], v[92:95], v[156:159], v[124:127]
    v_sub_f32 v40, 0, v22
    v_sub_f32 v41, 0, v22
    v_sub_f32 v42, 0, v22
    v_sub_f32 v43, 0, v22
    v_sub_f32 v44, 0, v23
    v_sub_f32 v45, 0, v23
    v_sub_f32 v46, 0, v23
    v_sub_f32 v47, 0, v23
    v_add_u32 v3, 65536, v2
    v_add_u32 v2, s41, v2
    v_and_b32 v2, s49, v2
    s_waitcnt vmcnt(1)
    s_cmp_eq_u32 s28, 4
    s_cbranch_scc1 L_recurrent_scan__compressed_kv_cla__moe_arch_mod__prompt_kernel_pw_111
    s_waitcnt vmcnt(0)
L_recurrent_scan__compressed_kv_cla__moe_arch_mod__prompt_kernel_pw_111:
    s_barrier
    ds_read_b128 v[64:67], v2 offset:0
    ds_read_b128 v[68:71], v2 offset:1024
    ds_read_b128 v[72:75], v2 offset:2048
    ds_read_b128 v[76:79], v2 offset:3072
    ds_read_b128 v[80:83], v2 offset:4096
    ds_read_b128 v[84:87], v2 offset:5120
    ds_read_b128 v[88:91], v2 offset:6144
    v_pk_add_f32 v[96:97], v[96:97], v[40:41]
    v_pk_add_f32 v[98:99], v[98:99], v[40:41]
    v_pk_add_f32 v[100:101], v[100:101], v[40:41]
    v_pk_add_f32 v[102:103], v[102:103], v[40:41]
    v_pk_add_f32 v[104:105], v[104:105], v[44:45]
    v_pk_add_f32 v[106:107], v[106:107], v[44:45]
    v_pk_add_f32 v[108:109], v[108:109], v[44:45]
    v_pk_add_f32 v[110:111], v[110:111], v[44:45]
    v_pk_add_f32 v[112:113], v[112:113], v[40:41]
    v_pk_add_f32 v[114:115], v[114:115], v[40:41]
    v_pk_add_f32 v[116:117], v[116:117], v[40:41]
    v_pk_add_f32 v[118:119], v[118:119], v[40:41]
    v_pk_add_f32 v[120:121], v[120:121], v[44:45]
    v_pk_add_f32 v[122:123], v[122:123], v[44:45]
    v_pk_add_f32 v[124:125], v[124:125], v[44:45]
    v_pk_add_f32 v[126:127], v[126:127], v[44:45]
    v_exp_f32 v96, v96
    v_exp_f32 v97, v97
    v_exp_f32 v98, v98
    v_exp_f32 v99, v99
    v_exp_f32 v104, v104
    v_exp_f32 v105, v105
    v_exp_f32 v106, v106
    v_exp_f32 v107, v107
    v_exp_f32 v100, v100
    v_exp_f32 v101, v101
    v_exp_f32 v102, v102
    v_exp_f32 v103, v103
    v_exp_f32 v108, v108
    v_exp_f32 v109, v109
    v_exp_f32 v110, v110
    v_exp_f32 v111, v111
    v_cvt_pk_bf16_f32 v48, v96, v97
    v_cvt_pk_bf16_f32 v49, v98, v99
    v_cvt_pk_bf16_f32 v52, v104, v105
    v_cvt_pk_bf16_f32 v53, v106, v107
    v_cvt_pk_bf16_f32 v50, v100, v101
    v_cvt_pk_bf16_f32 v51, v102, v103
    v_cvt_pk_bf16_f32 v54, v108, v109
    v_cvt_pk_bf16_f32 v55, v110, v111
    .p2align 6
L_body10:
    s_bitcmp1_b32 s42, s40
    s_cbranch_scc1 L_recurrent_scan__compressed_kv_cla__moe_arch_mod__prompt_kernel_rare_118
L_recurrent_scan__compressed_kv_cla__moe_arch_mod__prompt_kernel_back_119:
    s_waitcnt lgkmcnt(5)
    v_mfma_f32_16x16x32_bf16 v[96:99], v[64:67], v[128:131], v[40:43]
    v_exp_f32 v112, v112
    v_mfma_f32_16x16x32_bf16 v[104:107], v[64:67], v[144:147], v[44:47]
    ds_read_b128 v[92:95], v2 offset:7168
    v_mfma_f32_16x16x32_bf16 v[96:99], v[68:71], v[132:135], v[96:99]
    v_exp_f32 v113, v113
    v_mfma_f32_16x16x32_bf16 v[104:107], v[68:71], v[148:151], v[104:107]
    ds_read_b128 v[64:67], v3 offset:0
    s_waitcnt lgkmcnt(5)
    v_mfma_f32_16x16x32_bf16 v[96:99], v[72:75], v[136:139], v[96:99]
    v_exp_f32 v114, v114
    v_mfma_f32_16x16x32_bf16 v[104:107], v[72:75], v[152:155], v[104:107]
    ds_read_b128 v[68:71], v3 offset:1024
    v_cvt_pk_bf16_f32 v56, v112, v113
    v_mfma_f32_16x16x32_bf16 v[96:99], v[76:79], v[140:143], v[96:99]
    v_exp_f32 v115, v115
    v_mfma_f32_16x16x32_bf16 v[104:107], v[76:79], v[156:159], v[104:107]
    ds_read_b128 v[72:75], v3 offset:2048
    s_waitcnt lgkmcnt(5)
    v_mfma_f32_16x16x32_bf16 v[100:103], v[80:83], v[128:131], v[40:43]
    v_exp_f32 v120, v120
    v_mfma_f32_16x16x32_bf16 v[108:111], v[80:83], v[144:147], v[44:47]
    ds_read_b128 v[76:79], v3 offset:3072
    v_cvt_pk_bf16_f32 v57, v114, v115
    v_mfma_f32_16x16x32_bf16 v[100:103], v[84:87], v[132:135], v[100:103]
    v_exp_f32 v121, v121
    v_mfma_f32_16x16x32_bf16 v[108:111], v[84:87], v[148:151], v[108:111]
    ds_read_b128 v[80:83], v3 offset:4096
    s_waitcnt lgkmcnt(5)
    v_mfma_f32_16x16x32_bf16 v[100:103], v[88:91], v[136:139], v[100:103]
    v_exp_f32 v122, v122
    v_mfma_f32_16x16x32_bf16 v[108:111], v[88:91], v[152:155], v[108:111]
    ds_read_b128 v[84:87], v3 offset:5120
    v_cvt_pk_bf16_f32 v60, v120, v121
    v_mfma_f32_16x16x32_bf16 v[100:103], v[92:95], v[140:143], v[100:103]
    v_exp_f32 v123, v123
    v_mfma_f32_16x16x32_bf16 v[108:111], v[92:95], v[156:159], v[108:111]
    ds_read_b128 v[88:91], v3 offset:6144
    s_waitcnt lgkmcnt(5)
    v_mfma_f32_16x16x32_bf16 v[192:195], v[64:67], v[48:51], v[192:195]
    v_exp_f32 v116, v116
    v_mfma_f32_16x16x32_bf16 v[224:227], v[64:67], v[52:55], v[224:227]
    ds_read_b128 v[92:95], v3 offset:7168
    v_cvt_pk_bf16_f32 v61, v122, v123
    v_mfma_f32_16x16x32_bf16 v[196:199], v[68:71], v[48:51], v[196:199]
    v_exp_f32 v117, v117
    v_mfma_f32_16x16x32_bf16 v[228:231], v[68:71], v[52:55], v[228:231]
    ds_read_b128 v[64:67], v2 offset:8192
    s_waitcnt lgkmcnt(5)
    v_mfma_f32_16x16x32_bf16 v[200:203], v[72:75], v[48:51], v[200:203]
    v_exp_f32 v118, v118
    v_mfma_f32_16x16x32_bf16 v[232:235], v[72:75], v[52:55], v[232:235]
    v_mfma_f32_16x16x32_bf16 v[28:31], v[36:39], v[48:51], v[28:31]
    ds_read_b128 v[68:71], v2 offset:9216
    v_cvt_pk_bf16_f32 v58, v116, v117
    v_mfma_f32_16x16x32_bf16 v[204:207], v[76:79], v[48:51], v[204:207]
    v_exp_f32 v119, v119
    v_mfma_f32_16x16x32_bf16 v[236:239], v[76:79], v[52:55], v[236:239]
    ds_read_b128 v[72:75], v2 offset:10240
    s_waitcnt lgkmcnt(5)
    v_mfma_f32_16x16x32_bf16 v[208:211], v[80:83], v[48:51], v[208:211]
    v_exp_f32 v124, v124
    buffer_load_dword v0, v13, s[4:7], s48 offen
    s_add_u32 s48, s48, 4096
    v_mfma_f32_16x16x32_bf16 v[240:243], v[80:83], v[52:55], v[240:243]
    ds_read_b128 v[76:79], v2 offset:11264
    v_cvt_pk_bf16_f32 v59, v118, v119
    v_mfma_f32_16x16x32_bf16 v[212:215], v[84:87], v[48:51], v[212:215]
    v_exp_f32 v125, v125
    v_mfma_f32_16x16x32_bf16 v[244:247], v[84:87], v[52:55], v[244:247]
    ds_read_b128 v[80:83], v2 offset:12288
    s_waitcnt lgkmcnt(5)
    v_mfma_f32_16x16x32_bf16 v[216:219], v[88:91], v[48:51], v[216:219]
    v_exp_f32 v126, v126
    v_mfma_f32_16x16x32_bf16 v[248:251], v[88:91], v[52:55], v[248:251]
    v_mfma_f32_16x16x32_bf16 v[32:35], v[36:39], v[52:55], v[32:35]
    ds_read_b128 v[84:87], v2 offset:13312
    v_cvt_pk_bf16_f32 v62, v124, v125
    v_mfma_f32_16x16x32_bf16 v[220:223], v[92:95], v[48:51], v[220:223]
    v_exp_f32 v127, v127
    v_mfma_f32_16x16x32_bf16 v[252:255], v[92:95], v[52:55], v[252:255]
    ds_read_b128 v[88:91], v2 offset:14336
    v_cvt_pk_bf16_f32 v63, v126, v127
    s_bitcmp1_b32 s42, s40
    s_cbranch_scc1 L_recurrent_scan__compressed_kv_cla__moe_arch_mod__prompt_kernel_rare_123
L_recurrent_scan__compressed_kv_cla__moe_arch_mod__prompt_kernel_back_124:
    s_waitcnt lgkmcnt(5)
    v_mfma_f32_16x16x32_bf16 v[112:115], v[64:67], v[128:131], v[40:43]
    v_exp_f32 v96, v96
    v_mfma_f32_16x16x32_bf16 v[120:123], v[64:67], v[144:147], v[44:47]
    ds_read_b128 v[92:95], v2 offset:15360
    v_mfma_f32_16x16x32_bf16 v[112:115], v[68:71], v[132:135], v[112:115]
    v_exp_f32 v97, v97
    v_mfma_f32_16x16x32_bf16 v[120:123], v[68:71], v[148:151], v[120:123]
    ds_read_b128 v[64:67], v3 offset:8192
    s_waitcnt lgkmcnt(5)
    v_mfma_f32_16x16x32_bf16 v[112:115], v[72:75], v[136:139], v[112:115]
    v_exp_f32 v98, v98
    v_mfma_f32_16x16x32_bf16 v[120:123], v[72:75], v[152:155], v[120:123]
    ds_read_b128 v[68:71], v3 offset:9216
    v_cvt_pk_bf16_f32 v48, v96, v97
    v_mfma_f32_16x16x32_bf16 v[112:115], v[76:79], v[140:143], v[112:115]
    v_exp_f32 v99, v99
    v_mfma_f32_16x16x32_bf16 v[120:123], v[76:79], v[156:159], v[120:123]
    ds_read_b128 v[72:75], v3 offset:10240
    s_waitcnt lgkmcnt(5)
    v_mfma_f32_16x16x32_bf16 v[116:119], v[80:83], v[128:131], v[40:43]
    v_exp_f32 v104, v104
    v_mfma_f32_16x16x32_bf16 v[124:127], v[80:83], v[144:147], v[44:47]
    ds_read_b128 v[76:79], v3 offset:11264
    v_cvt_pk_bf16_f32 v49, v98, v99
    v_mfma_f32_16x16x32_bf16 v[116:119], v[84:87], v[132:135], v[116:119]
    v_exp_f32 v105, v105
    v_mfma_f32_16x16x32_bf16 v[124:127], v[84:87], v[148:151], v[124:127]
    ds_read_b128 v[80:83], v3 offset:12288
    s_waitcnt lgkmcnt(5)
    v_mfma_f32_16x16x32_bf16 v[116:119], v[88:91], v[136:139], v[116:119]
    v_exp_f32 v106, v106
    v_mfma_f32_16x16x32_bf16 v[124:127], v[88:91], v[152:155], v[124:127]
    ds_read_b128 v[84:87], v3 offset:13312
    v_cvt_pk_bf16_f32 v52, v104, v105
    v_mfma_f32_16x16x32_bf16 v[116:119], v[92:95], v[140:143], v[116:119]
    v_exp_f32 v107, v107
    v_mfma_f32_16x16x32_bf16 v[124:127], v[92:95], v[156:159], v[124:127]
    ds_read_b128 v[88:91], v3 offset:14336
    s_waitcnt lgkmcnt(5)
    v_mfma_f32_16x16x32_bf16 v[192:195], v[64:67], v[56:59], v[192:195]
    v_exp_f32 v100, v100
    v_mfma_f32_16x16x32_bf16 v[224:227], v[64:67], v[60:63], v[224:227]
    ds_read_b128 v[92:95], v3 offset:15360
    v_cvt_pk_bf16_f32 v53, v106, v107
    v_mfma_f32_16x16x32_bf16 v[196:199], v[68:71], v[56:59], v[196:199]
    v_exp_f32 v101, v101
    v_mfma_f32_16x16x32_bf16 v[228:231], v[68:71], v[60:63], v[228:231]
    v_add_u32 v3, 65536, v2
    v_add_u32 v2, s41, v2
    s_waitcnt lgkmcnt(4)
    v_mfma_f32_16x16x32_bf16 v[200:203], v[72:75], v[56:59], v[200:203]
    v_exp_f32 v102, v102
    v_and_b32 v2, s49, v2
    v_mfma_f32_16x16x32_bf16 v[232:235], v[72:75], v[60:63], v[232:235]
    v_mfma_f32_16x16x32_bf16 v[28:31], v[36:39], v[56:59], v[28:31]
    v_cvt_pk_bf16_f32 v50, v100, v101
    s_waitcnt lgkmcnt(0)
    s_barrier
    v_mfma_f32_16x16x32_bf16 v[204:207], v[76:79], v[56:59], v[204:207]
    v_exp_f32 v103, v103
    v_mfma_f32_16x16x32_bf16 v[236:239], v[76:79], v[60:63], v[236:239]
    ds_read_b128 v[68:71], v2 offset:1024
    ds_read_b128 v[64:67], v2 offset:0
    v_mfma_f32_16x16x32_bf16 v[208:211], v[80:83], v[56:59], v[208:211]
    v_exp_f32 v108, v108
    v_mfma_f32_16x16x32_bf16 v[240:243], v[80:83], v[60:63], v[240:243]
    ds_read_b128 v[76:79], v2 offset:3072
    ds_read_b128 v[72:75], v2 offset:2048
    v_cvt_pk_bf16_f32 v51, v102, v103
    v_mfma_f32_16x16x32_bf16 v[212:215], v[84:87], v[56:59], v[212:215]
    v_exp_f32 v109, v109
    v_mfma_f32_16x16x32_bf16 v[244:247], v[84:87], v[60:63], v[244:247]
    ds_read_b128 v[80:83], v2 offset:4096
    v_mfma_f32_16x16x32_bf16 v[216:219], v[88:91], v[56:59], v[216:219]
    v_exp_f32 v110, v110
    v_mfma_f32_16x16x32_bf16 v[248:251], v[88:91], v[60:63], v[248:251]
    v_mfma_f32_16x16x32_bf16 v[32:35], v[36:39], v[60:63], v[32:35]
    ds_read_b128 v[84:87], v2 offset:5120
    v_cvt_pk_bf16_f32 v54, v108, v109
    v_mfma_f32_16x16x32_bf16 v[220:223], v[92:95], v[56:59], v[220:223]
    v_exp_f32 v111, v111
    v_mfma_f32_16x16x32_bf16 v[252:255], v[92:95], v[60:63], v[252:255]
    ds_read_b128 v[88:91], v2 offset:6144
    v_cvt_pk_bf16_f32 v55, v110, v111
    s_bitcmp1_b32 s42, s40
    s_cbranch_scc1 L_recurrent_scan__compressed_kv_cla__moe_arch_mod__prompt_kernel_rare_151
L_recurrent_scan__compressed_kv_cla__moe_arch_mod__prompt_kernel_back_152:
    s_add_u32 s40, s40, 1
    s_cmp_lg_u32 s40, s51
    s_cbranch_scc1 L_body10
    v_mov_b32 v40, v14
    v_mov_b32 v41, v14
    v_mov_b32 v42, v14
    v_mov_b32 v43, v14
    v_mov_b32 v44, v15
    v_mov_b32 v45, v15
    v_mov_b32 v46, v15
    v_mov_b32 v47, v15
    s_nop 1
    .p2align 6
L_body11:
    s_bitcmp1_b32 s42, s40
    s_cbranch_scc1 L_recurrent_scan__compressed_kv_cla__moe_arch_mod__prompt_kernel_rare_136
L_recurrent_scan__compressed_kv_cla__moe_arch_mod__prompt_kernel_back_137:
    s_waitcnt lgkmcnt(5)
    v_mfma_f32_16x16x32_bf16 v[96:99], v[64:67], v[160:163], v[40:43]
    v_exp_f32 v112, v112
    v_mfma_f32_16x16x32_bf16 v[104:107], v[64:67], v[176:179], v[44:47]
    ds_read_b128 v[92:95], v2 offset:7168
    v_mfma_f32_16x16x32_bf16 v[96:99], v[68:71], v[164:167], v[96:99]
    v_exp_f32 v113, v113
    v_mfma_f32_16x16x32_bf16 v[104:107], v[68:71], v[180:183], v[104:107]
    ds_read_b128 v[64:67], v3 offset:0
    s_waitcnt lgkmcnt(5)
    v_mfma_f32_16x16x32_bf16 v[96:99], v[72:75], v[168:171], v[96:99]
    v_exp_f32 v114, v114
    v_mfma_f32_16x16x32_bf16 v[104:107], v[72:75], v[184:187], v[104:107]
    ds_read_b128 v[68:71], v3 offset:1024
    v_cvt_pk_bf16_f32 v56, v112, v113
    v_mfma_f32_16x16x32_bf16 v[96:99], v[76:79], v[172:175], v[96:99]
    v_exp_f32 v115, v115
    v_mfma_f32_16x16x32_bf16 v[104:107], v[76:79], v[188:191], v[104:107]
    ds_read_b128 v[72:75], v3 offset:2048
    s_waitcnt lgkmcnt(5)
    v_mfma_f32_16x16x32_bf16 v[100:103], v[80:83], v[160:163], v[40:43]
    v_exp_f32 v120, v120
    v_mfma_f32_16x16x32_bf16 v[108:111], v[80:83], v[176:179], v[44:47]
    ds_read_b128 v[76:79], v3 offset:3072
    v_cvt_pk_bf16_f32 v57, v114, v115
    v_mfma_f32_16x16x32_bf16 v[100:103], v[84:87], v[164:167], v[100:103]
    v_exp_f32 v121, v121
    v_mfma_f32_16x16x32_bf16 v[108:111], v[84:87], v[180:183], v[108:111]
    ds_read_b128 v[80:83], v3 offset:4096
    s_waitcnt lgkmcnt(5)
    v_mfma_f32_16x16x32_bf16 v[100:103], v[88:91], v[168:171], v[100:103]
    v_exp_f32 v122, v122
    v_mfma_f32_16x16x32_bf16 v[108:111], v[88:91], v[184:187], v[108:111]
    ds_read_b128 v[84:87], v3 offset:5120
    v_cvt_pk_bf16_f32 v60, v120, v121
    v_mfma_f32_16x16x32_bf16 v[100:103], v[92:95], v[172:175], v[100:103]
    v_exp_f32 v123, v123
    v_mfma_f32_16x16x32_bf16 v[108:111], v[92:95], v[188:191], v[108:111]
    ds_read_b128 v[88:91], v3 offset:6144
    s_waitcnt lgkmcnt(5)
    v_mfma_f32_16x16x32_bf16 v[192:195], v[64:67], v[48:51], v[192:195]
    v_exp_f32 v116, v116
    v_mfma_f32_16x16x32_bf16 v[224:227], v[64:67], v[52:55], v[224:227]
    ds_read_b128 v[92:95], v3 offset:7168
    v_cvt_pk_bf16_f32 v61, v122, v123
    v_mfma_f32_16x16x32_bf16 v[196:199], v[68:71], v[48:51], v[196:199]
    v_exp_f32 v117, v117
    v_mfma_f32_16x16x32_bf16 v[228:231], v[68:71], v[52:55], v[228:231]
    ds_read_b128 v[64:67], v2 offset:8192
    s_waitcnt lgkmcnt(5)
    v_mfma_f32_16x16x32_bf16 v[200:203], v[72:75], v[48:51], v[200:203]
    v_exp_f32 v118, v118
    v_mfma_f32_16x16x32_bf16 v[232:235], v[72:75], v[52:55], v[232:235]
    v_mfma_f32_16x16x32_bf16 v[28:31], v[36:39], v[48:51], v[28:31]
    ds_read_b128 v[68:71], v2 offset:9216
    v_cvt_pk_bf16_f32 v58, v116, v117
    v_mfma_f32_16x16x32_bf16 v[204:207], v[76:79], v[48:51], v[204:207]
    v_exp_f32 v119, v119
    v_mfma_f32_16x16x32_bf16 v[236:239], v[76:79], v[52:55], v[236:239]
    ds_read_b128 v[72:75], v2 offset:10240
    s_waitcnt lgkmcnt(5)
    v_mfma_f32_16x16x32_bf16 v[208:211], v[80:83], v[48:51], v[208:211]
    v_exp_f32 v124, v124
    buffer_load_dword v0, v13, s[4:7], s48 offen
    s_add_u32 s48, s48, 4096
    v_mfma_f32_16x16x32_bf16 v[240:243], v[80:83], v[52:55], v[240:243]
    ds_read_b128 v[76:79], v2 offset:11264
    v_cvt_pk_bf16_f32 v59, v118, v119
    v_mfma_f32_16x16x32_bf16 v[212:215], v[84:87], v[48:51], v[212:215]
    v_exp_f32 v125, v125
    v_mfma_f32_16x16x32_bf16 v[244:247], v[84:87], v[52:55], v[244:247]
    ds_read_b128 v[80:83], v2 offset:12288
    s_waitcnt lgkmcnt(5)
    v_mfma_f32_16x16x32_bf16 v[216:219], v[88:91], v[48:51], v[216:219]
    v_exp_f32 v126, v126
    v_mfma_f32_16x16x32_bf16 v[248:251], v[88:91], v[52:55], v[248:251]
    v_mfma_f32_16x16x32_bf16 v[32:35], v[36:39], v[52:55], v[32:35]
    ds_read_b128 v[84:87], v2 offset:13312
    v_cvt_pk_bf16_f32 v62, v124, v125
    v_mfma_f32_16x16x32_bf16 v[220:223], v[92:95], v[48:51], v[220:223]
    v_exp_f32 v127, v127
    v_mfma_f32_16x16x32_bf16 v[252:255], v[92:95], v[52:55], v[252:255]
    ds_read_b128 v[88:91], v2 offset:14336
    v_cvt_pk_bf16_f32 v63, v126, v127
    s_bitcmp1_b32 s42, s40
    s_cbranch_scc1 L_recurrent_scan__compressed_kv_cla__moe_arch_mod__prompt_kernel_rare_141
L_recurrent_scan__compressed_kv_cla__moe_arch_mod__prompt_kernel_back_142:
    s_waitcnt lgkmcnt(5)
    v_mfma_f32_16x16x32_bf16 v[112:115], v[64:67], v[160:163], v[40:43]
    v_exp_f32 v96, v96
    v_mfma_f32_16x16x32_bf16 v[120:123], v[64:67], v[176:179], v[44:47]
    ds_read_b128 v[92:95], v2 offset:15360
    v_mfma_f32_16x16x32_bf16 v[112:115], v[68:71], v[164:167], v[112:115]
    v_exp_f32 v97, v97
    v_mfma_f32_16x16x32_bf16 v[120:123], v[68:71], v[180:183], v[120:123]
    ds_read_b128 v[64:67], v3 offset:8192
    s_waitcnt lgkmcnt(5)
    v_mfma_f32_16x16x32_bf16 v[112:115], v[72:75], v[168:171], v[112:115]
    v_exp_f32 v98, v98
    v_mfma_f32_16x16x32_bf16 v[120:123], v[72:75], v[184:187], v[120:123]
    ds_read_b128 v[68:71], v3 offset:9216
    v_cvt_pk_bf16_f32 v48, v96, v97
    v_mfma_f32_16x16x32_bf16 v[112:115], v[76:79], v[172:175], v[112:115]
    v_exp_f32 v99, v99
    v_mfma_f32_16x16x32_bf16 v[120:123], v[76:79], v[188:191], v[120:123]
    ds_read_b128 v[72:75], v3 offset:10240
    s_waitcnt lgkmcnt(5)
    v_mfma_f32_16x16x32_bf16 v[116:119], v[80:83], v[160:163], v[40:43]
    v_exp_f32 v104, v104
    v_mfma_f32_16x16x32_bf16 v[124:127], v[80:83], v[176:179], v[44:47]
    ds_read_b128 v[76:79], v3 offset:11264
    v_cvt_pk_bf16_f32 v49, v98, v99
    v_mfma_f32_16x16x32_bf16 v[116:119], v[84:87], v[164:167], v[116:119]
    v_exp_f32 v105, v105
    v_mfma_f32_16x16x32_bf16 v[124:127], v[84:87], v[180:183], v[124:127]
    ds_read_b128 v[80:83], v3 offset:12288
    s_waitcnt lgkmcnt(5)
    v_mfma_f32_16x16x32_bf16 v[116:119], v[88:91], v[168:171], v[116:119]
    v_exp_f32 v106, v106
    v_mfma_f32_16x16x32_bf16 v[124:127], v[88:91], v[184:187], v[124:127]
    ds_read_b128 v[84:87], v3 offset:13312
    v_cvt_pk_bf16_f32 v52, v104, v105
    v_mfma_f32_16x16x32_bf16 v[116:119], v[92:95], v[172:175], v[116:119]
    v_exp_f32 v107, v107
    v_mfma_f32_16x16x32_bf16 v[124:127], v[92:95], v[188:191], v[124:127]
    ds_read_b128 v[88:91], v3 offset:14336
    s_waitcnt lgkmcnt(5)
    v_mfma_f32_16x16x32_bf16 v[192:195], v[64:67], v[56:59], v[192:195]
    v_exp_f32 v100, v100
    v_mfma_f32_16x16x32_bf16 v[224:227], v[64:67], v[60:63], v[224:227]
    ds_read_b128 v[92:95], v3 offset:15360
    v_cvt_pk_bf16_f32 v53, v106, v107
    v_mfma_f32_16x16x32_bf16 v[196:199], v[68:71], v[56:59], v[196:199]
    v_exp_f32 v101, v101
    v_mfma_f32_16x16x32_bf16 v[228:231], v[68:71], v[60:63], v[228:231]
    v_add_u32 v3, 65536, v2
    v_add_u32 v2, s41, v2
    s_waitcnt lgkmcnt(4)
    v_mfma_f32_16x16x32_bf16 v[200:203], v[72:75], v[56:59], v[200:203]
    v_exp_f32 v102, v102
    v_and_b32 v2, s49, v2
    v_mfma_f32_16x16x32_bf16 v[232:235], v[72:75], v[60:63], v[232:235]
    v_mfma_f32_16x16x32_bf16 v[28:31], v[36:39], v[56:59], v[28:31]
    v_cvt_pk_bf16_f32 v50, v100, v101
    s_waitcnt lgkmcnt(0)
    s_barrier
    v_mfma_f32_16x16x32_bf16 v[204:207], v[76:79], v[56:59], v[204:207]
    v_exp_f32 v103, v103
    v_mfma_f32_16x16x32_bf16 v[236:239], v[76:79], v[60:63], v[236:239]
    ds_read_b128 v[68:71], v2 offset:1024
    ds_read_b128 v[64:67], v2 offset:0
    v_mfma_f32_16x16x32_bf16 v[208:211], v[80:83], v[56:59], v[208:211]
    v_exp_f32 v108, v108
    v_mfma_f32_16x16x32_bf16 v[240:243], v[80:83], v[60:63], v[240:243]
    ds_read_b128 v[76:79], v2 offset:3072
    ds_read_b128 v[72:75], v2 offset:2048
    v_cvt_pk_bf16_f32 v51, v102, v103
    v_mfma_f32_16x16x32_bf16 v[212:215], v[84:87], v[56:59], v[212:215]
    v_exp_f32 v109, v109
    v_mfma_f32_16x16x32_bf16 v[244:247], v[84:87], v[60:63], v[244:247]
    ds_read_b128 v[80:83], v2 offset:4096
    v_mfma_f32_16x16x32_bf16 v[216:219], v[88:91], v[56:59], v[216:219]
    v_exp_f32 v110, v110
    v_mfma_f32_16x16x32_bf16 v[248:251], v[88:91], v[60:63], v[248:251]
    v_mfma_f32_16x16x32_bf16 v[32:35], v[36:39], v[60:63], v[32:35]
    ds_read_b128 v[84:87], v2 offset:5120
    v_cvt_pk_bf16_f32 v54, v108, v109
    v_mfma_f32_16x16x32_bf16 v[220:223], v[92:95], v[56:59], v[220:223]
    v_exp_f32 v111, v111
    v_mfma_f32_16x16x32_bf16 v[252:255], v[92:95], v[60:63], v[252:255]
    ds_read_b128 v[88:91], v2 offset:6144
    v_cvt_pk_bf16_f32 v55, v110, v111
    s_bitcmp1_b32 s42, s40
    s_cbranch_scc1 L_recurrent_scan__compressed_kv_cla__moe_arch_mod__prompt_kernel_rare_158
L_recurrent_scan__compressed_kv_cla__moe_arch_mod__prompt_kernel_back_159:
    s_add_u32 s40, s40, 1
    s_cmp_lg_u32 s40, 16
    s_cbranch_scc1 L_body11
    s_lshr_b32 s36, s2, 5
    s_add_u32 s36, s36, 48
    s_lshl_b32 s36, s36, 7
    v_mov_b32 v12, s36
    global_load_dword v11, v12, s[90:91] sc1
    s_sub_u32 s36, 96, s50
    s_cmp_lt_i32 s36, 0
    s_cbranch_scc0 L_recurrent_scan__compressed_kv_cla__moe_arch_mod__prompt_kernel_rare_128
L_recurrent_scan__compressed_kv_cla__moe_arch_mod__prompt_kernel_back_129:
    s_lshl_b32 s37, s28, 13
    v_add_u32 v5, s37, v7
    s_waitcnt lgkmcnt(5)
    v_mfma_f32_16x16x32_bf16 v[192:195], v[64:67], v[48:51], v[192:195]
    v_exp_f32 v112, v112
    v_mfma_f32_16x16x32_bf16 v[224:227], v[64:67], v[52:55], v[224:227]
    ds_read_b128 v[92:95], v3 offset:7168
    v_exp_f32 v113, v113
    v_mfma_f32_16x16x32_bf16 v[196:199], v[68:71], v[48:51], v[196:199]
    v_cvt_pk_bf16_f32 v56, v112, v113
    v_exp_f32 v114, v114
    v_mfma_f32_16x16x32_bf16 v[228:231], v[68:71], v[52:55], v[228:231]
    ds_read_b128 v[64:67], v3 offset:8192
    v_exp_f32 v115, v115
    s_waitcnt lgkmcnt(5)
    v_mfma_f32_16x16x32_bf16 v[200:203], v[72:75], v[48:51], v[200:203]
    v_cvt_pk_bf16_f32 v57, v114, v115
    v_exp_f32 v120, v120
    v_mfma_f32_16x16x32_bf16 v[232:235], v[72:75], v[52:55], v[232:235]
    v_mfma_f32_16x16x32_bf16 v[28:31], v[36:39], v[48:51], v[28:31]
    ds_read_b128 v[68:71], v3 offset:9216
    v_exp_f32 v121, v121
    v_mfma_f32_16x16x32_bf16 v[204:207], v[76:79], v[48:51], v[204:207]
    v_cvt_pk_bf16_f32 v60, v120, v121
    v_exp_f32 v122, v122
    v_mfma_f32_16x16x32_bf16 v[236:239], v[76:79], v[52:55], v[236:239]
    ds_read_b128 v[72:75], v3 offset:10240
    v_exp_f32 v123, v123
    s_waitcnt lgkmcnt(6)
    v_mfma_f32_16x16x32_bf16 v[208:211], v[80:83], v[48:51], v[208:211]
    v_cvt_pk_bf16_f32 v61, v122, v123
    v_exp_f32 v116, v116
    v_mfma_f32_16x16x32_bf16 v[240:243], v[80:83], v[52:55], v[240:243]
    ds_read_b128 v[76:79], v3 offset:11264
    v_exp_f32 v117, v117
    s_waitcnt lgkmcnt(6)
    v_mfma_f32_16x16x32_bf16 v[212:215], v[84:87], v[48:51], v[212:215]
    v_cvt_pk_bf16_f32 v58, v116, v117
    v_exp_f32 v118, v118
    v_mfma_f32_16x16x32_bf16 v[244:247], v[84:87], v[52:55], v[244:247]
    ds_read_b128 v[80:83], v3 offset:12288
    v_exp_f32 v119, v119
    s_waitcnt lgkmcnt(6)
    v_mfma_f32_16x16x32_bf16 v[216:219], v[88:91], v[48:51], v[216:219]
    v_cvt_pk_bf16_f32 v59, v118, v119
    v_exp_f32 v124, v124
    v_mfma_f32_16x16x32_bf16 v[248:251], v[88:91], v[52:55], v[248:251]
    v_mfma_f32_16x16x32_bf16 v[32:35], v[36:39], v[52:55], v[32:35]
    ds_read_b128 v[84:87], v3 offset:13312
    v_exp_f32 v125, v125
    s_waitcnt lgkmcnt(6)
    v_mfma_f32_16x16x32_bf16 v[220:223], v[92:95], v[48:51], v[220:223]
    v_cvt_pk_bf16_f32 v62, v124, v125
    v_exp_f32 v126, v126
    v_mfma_f32_16x16x32_bf16 v[252:255], v[92:95], v[52:55], v[252:255]
    ds_read_b128 v[88:91], v3 offset:14336
    v_exp_f32 v127, v127
    s_nop 0
    v_cvt_pk_bf16_f32 v63, v126, v127
    s_nop 1
    s_waitcnt lgkmcnt(6)
    v_mfma_f32_16x16x32_bf16 v[192:195], v[64:67], v[56:59], v[192:195]
    s_mov_b32 s4, s34
    s_and_b32 s5, s35, 0xffff
    s_mov_b32 s6, 7340032
    s_mov_b32 s7, 0x20000
    s_mov_b32 s8, s32
    v_mfma_f32_16x16x32_bf16 v[224:227], v[64:67], v[60:63], v[224:227]
    ds_read_b128 v[92:95], v3 offset:15360
    s_and_b32 s9, s33, 0xffff
    s_mov_b32 s10, 8388608
    s_mov_b32 s11, 0x20000
    s_lshr_b32 s38, s2, 4
    s_waitcnt lgkmcnt(6)
    v_mfma_f32_16x16x32_bf16 v[196:199], v[68:71], v[56:59], v[196:199]
    s_mul_i32 s38, s38, 224
    s_and_b32 s39, s2, 15
    s_lshl_b32 s39, s39, 7
    v_lshrrev_b32 v25, 3, v1
    s_lshl_b32 s36, s28, 5
    v_mfma_f32_16x16x32_bf16 v[228:231], v[68:71], v[60:63], v[228:231]
    s_add_u32 s36, s36, s38
    v_add_u32 v25, s36, v25
    v_mul_u32_u24 v25, 2048, v25
    v_add_u32 v25, s39, v25
    s_waitcnt lgkmcnt(5)
    v_mfma_f32_16x16x32_bf16 v[200:203], v[72:75], v[56:59], v[200:203]
    v_bfe_u32 v26, v1, 4, 1
    v_lshlrev_b32 v26, 1, v26
    v_and_b32 v27, 7, v1
    v_xor_b32 v26, v26, v27
    v_mfma_f32_16x16x32_bf16 v[232:235], v[72:75], v[60:63], v[232:235]
    v_mfma_f32_16x16x32_bf16 v[28:31], v[36:39], v[56:59], v[28:31]
    v_lshl_add_u32 v24, v26, 4, v25
    v_xor_b32 v26, 4, v26
    v_lshl_add_u32 v25, v26, 4, v25
    v_add_u32 v25, 15360, v25
    v_add_u32 v26, 30720, v24
    s_waitcnt lgkmcnt(4)
    v_mfma_f32_16x16x32_bf16 v[204:207], v[76:79], v[56:59], v[204:207]
    v_add_u32 v27, 30720, v25
    s_lshl_b32 s36, s28, 12
    s_add_u32 s36, s36, 131072
    s_cmp_lt_u32 s28, 7
    s_cselect_b32 m0, s36, 0x30000
    s_cselect_b32 s6, 7340032, 0
    v_mfma_f32_16x16x32_bf16 v[236:239], v[76:79], v[60:63], v[236:239]
    buffer_load_dwordx4 v24, s[4:7], 0 offen offset:0 lds
    buffer_load_dwordx4 v25, s[4:7], 0 offen offset:1024 lds
    buffer_load_dwordx4 v26, s[4:7], 0 offen offset:2048 lds
    buffer_load_dwordx4 v27, s[4:7], 0 offen offset:3072 lds
    s_waitcnt lgkmcnt(3)
    v_mfma_f32_16x16x32_bf16 v[208:211], v[80:83], v[56:59], v[208:211]
    v_mfma_f32_16x16x32_bf16 v[240:243], v[80:83], v[60:63], v[240:243]
    ds_write_b128 v5, v[192:195] offset:0
    s_waitcnt lgkmcnt(3)
    v_mfma_f32_16x16x32_bf16 v[212:215], v[84:87], v[56:59], v[212:215]
    v_mfma_f32_16x16x32_bf16 v[244:247], v[84:87], v[60:63], v[244:247]
    ds_write_b128 v5, v[196:199] offset:1024
    s_waitcnt lgkmcnt(3)
    v_mfma_f32_16x16x32_bf16 v[216:219], v[88:91], v[56:59], v[216:219]
    v_mfma_f32_16x16x32_bf16 v[248:251], v[88:91], v[60:63], v[248:251]
    v_mfma_f32_16x16x32_bf16 v[32:35], v[36:39], v[60:63], v[32:35]
    ds_write_b128 v5, v[200:203] offset:2048
    s_waitcnt lgkmcnt(3)
    v_mfma_f32_16x16x32_bf16 v[220:223], v[92:95], v[56:59], v[220:223]
    v_mfma_f32_16x16x32_bf16 v[252:255], v[92:95], v[60:63], v[252:255]
    ds_write_b128 v5, v[204:207] offset:3072
    ds_write_b128 v5, v[208:211] offset:4096
    ds_write_b128 v5, v[212:215] offset:5120
    v_xor_b32 v106, 32768, v5
    s_lshl_b32 s37, s28, 8
    s_add_u32 s37, s37, 159744
    v_lshl_add_u32 v107, v1, 2, s37
    v_xor_b32 v108, 1024, v107
    ds_write_b128 v5, v[216:219] offset:6144
    ds_write_b128 v5, v[220:223] offset:7168
    ds_write_b32 v107, v28
    s_mov_b32 s36, 0x5d800000
    v_cmp_nge_f32 vcc, s36, v28
    s_nop 0
    s_or_b64 s[52:53], s[52:53], vcc
    v_cmp_nge_f32 vcc, s36, v32
    s_nop 0
    s_or_b64 s[52:53], s[52:53], vcc
    s_or_b32 s36, s52, s53
    v_mov_b32 v110, s36
    s_lshl_b32 s37, s28, 2
    s_add_u32 s37, s37, 161792
    v_mov_b32 v111, s37
    ds_write_b32 v111, v110
    v_mov_b32 v112, 161856
    v_and_b32 v111, 7, v1
    v_lshlrev_b32 v111, 2, v111
    v_add_u32 v111, 161792, v111
    v_mov_b32 v113, v7
    s_sub_u32 s36, 15, s30
    s_lshl_b32 s38, s36, 3
    s_and_b32 s37, s28, 3
    s_lshl_b32 s37, s37, 1
    s_add_u32 s38, s38, s37
    s_add_u32 s38, s38, 1
    s_lshl_b32 s38, s38, 17
    s_lshl_b32 s37, s29, 12
    s_add_u32 s38, s38, s37
    s_waitcnt vmcnt(4)
    v_readfirstlane_b32 s36, v11
    s_nop 0
    s_cmp_lt_u32 s36, 28
    s_cbranch_scc1 L_recurrent_scan__compressed_kv_cla__moe_arch_mod__prompt_kernel_rare_162
L_recurrent_scan__compressed_kv_cla__moe_arch_mod__prompt_kernel_back_163:
    s_lshr_b32 s36, s2, 4
    s_mul_i32 s36, s36, 7
    s_min_u32 s37, s28, 6
    s_add_u32 s36, s36, s37
    s_lshl_b32 s36, s36, 11
    s_add_u32 s36, s36, 58720256
    v_and_b32 v11, 15, v1
    v_lshlrev_b32 v11, 4, v11
    v_lshrrev_b32 v12, 4, v1
    v_lshl_add_u32 v11, v12, 9, v11
    buffer_load_dwordx4 v[96:99], v11, s[24:27], s36 offen offset:0 sc1
    buffer_load_dwordx4 v[100:103], v11, s[24:27], s36 offen offset:256 sc1
    s_waitcnt lgkmcnt(0)
    s_barrier
    ds_read_b128 v[114:117], v112
    ds_read_b32 v110, v111
    ds_read_b32 v109, v108
    ds_read_b128 v[64:67], v106 offset:0
    ds_read_b128 v[68:71], v106 offset:1024
    ds_read_b128 v[72:75], v106 offset:2048
    ds_read_b128 v[76:79], v106 offset:3072
    ds_read_b128 v[80:83], v106 offset:4096
    ds_read_b128 v[84:87], v106 offset:5120
    ds_read_b128 v[88:91], v106 offset:6144
    ds_read_b128 v[92:95], v106 offset:7168
    s_waitcnt lgkmcnt(8)
    v_add_f32 v109, v109, v32
    v_cmp_ne_u32 s[52:53], 0, v110
    v_readfirstlane_b32 s56, v114
    v_readfirstlane_b32 s57, v115
    v_readfirstlane_b32 s58, v116
    v_readfirstlane_b32 s59, v117
    v_rcp_f32 v109, v109
    s_nop 0
    v_mov_b32 v108, v109
    s_waitcnt lgkmcnt(6)
    v_pk_add_f32 v[224:225], v[224:225], v[64:65]
    v_pk_add_f32 v[226:227], v[226:227], v[66:67]
    v_pk_add_f32 v[228:229], v[228:229], v[68:69]
    v_pk_add_f32 v[230:231], v[230:231], v[70:71]
    v_pk_mul_f32 v[224:225], v[224:225], v[108:109]
    v_pk_mul_f32 v[226:227], v[226:227], v[108:109]
    v_pk_mul_f32 v[228:229], v[228:229], v[108:109]
    v_pk_mul_f32 v[230:231], v[230:231], v[108:109]
    v_cvt_pk_bf16_f32 v48, v224, v225
    v_cvt_pk_bf16_f32 v49, v226, v227
    v_cvt_pk_bf16_f32 v50, v228, v229
    v_cvt_pk_bf16_f32 v51, v230, v231
    buffer_store_dwordx4 v[48:51], v113, s[16:19], s38 offen offset:0 sc1
    s_waitcnt lgkmcnt(4)
    v_pk_add_f32 v[232:233], v[232:233], v[72:73]
    v_pk_add_f32 v[234:235], v[234:235], v[74:75]
    v_pk_add_f32 v[236:237], v[236:237], v[76:77]
    v_pk_add_f32 v[238:239], v[238:239], v[78:79]
    v_pk_mul_f32 v[232:233], v[232:233], v[108:109]
    v_pk_mul_f32 v[234:235], v[234:235], v[108:109]
    v_pk_mul_f32 v[236:237], v[236:237], v[108:109]
    v_pk_mul_f32 v[238:239], v[238:239], v[108:109]
    v_cvt_pk_bf16_f32 v52, v232, v233
    v_cvt_pk_bf16_f32 v53, v234, v235
    v_cvt_pk_bf16_f32 v54, v236, v237
    v_cvt_pk_bf16_f32 v55, v238, v239
    buffer_store_dwordx4 v[52:55], v113, s[16:19], s38 offen offset:1024 sc1
    s_waitcnt lgkmcnt(2)
    v_pk_add_f32 v[240:241], v[240:241], v[80:81]
    v_pk_add_f32 v[242:243], v[242:243], v[82:83]
    v_pk_add_f32 v[244:245], v[244:245], v[84:85]
    v_pk_add_f32 v[246:247], v[246:247], v[86:87]
    v_pk_mul_f32 v[240:241], v[240:241], v[108:109]
    v_pk_mul_f32 v[242:243], v[242:243], v[108:109]
    v_pk_mul_f32 v[244:245], v[244:245], v[108:109]
    v_pk_mul_f32 v[246:247], v[246:247], v[108:109]
    v_cvt_pk_bf16_f32 v56, v240, v241
    v_cvt_pk_bf16_f32 v57, v242, v243
    v_cvt_pk_bf16_f32 v58, v244, v245
    v_cvt_pk_bf16_f32 v59, v246, v247
    buffer_store_dwordx4 v[56:59], v113, s[16:19], s38 offen offset:2048 sc1
    s_waitcnt lgkmcnt(0)
    v_pk_add_f32 v[248:249], v[248:249], v[88:89]
    v_pk_add_f32 v[250:251], v[250:251], v[90:91]
    v_pk_add_f32 v[252:253], v[252:253], v[92:93]
    v_pk_add_f32 v[254:255], v[254:255], v[94:95]
    v_pk_mul_f32 v[248:249], v[248:249], v[108:109]
    v_pk_mul_f32 v[250:251], v[250:251], v[108:109]
    v_pk_mul_f32 v[252:253], v[252:253], v[108:109]
    v_pk_mul_f32 v[254:255], v[254:255], v[108:109]
    v_cvt_pk_bf16_f32 v60, v248, v249
    v_cvt_pk_bf16_f32 v61, v250, v251
    v_cvt_pk_bf16_f32 v62, v252, v253
    v_cvt_pk_bf16_f32 v63, v254, v255
    buffer_store_dwordx4 v[60:63], v113, s[16:19], s38 offen offset:3072 sc1
    s_cmp_eq_u64 s[52:53], 0
    s_cbranch_scc1 L_p3_done
    s_waitcnt vmcnt(0)
    v_mov_b32 v112, v96
    v_mov_b32 v113, v97
    v_mov_b32 v114, v98
    v_mov_b32 v115, v99
    v_mov_b32 v116, v100
    v_mov_b32 v117, v101
    v_mov_b32 v118, v102
    v_mov_b32 v119, v103
    v_mov_b32 v192, 0
    v_mov_b32 v193, 0
    v_mov_b32 v194, 0
    v_mov_b32 v195, 0
    v_mov_b32 v196, 0
    v_mov_b32 v197, 0
    v_mov_b32 v198, 0
    v_mov_b32 v199, 0
    v_mov_b32 v200, 0
    v_mov_b32 v201, 0
    v_mov_b32 v202, 0
    v_mov_b32 v203, 0
    v_mov_b32 v204, 0
    v_mov_b32 v205, 0
    v_mov_b32 v206, 0
    v_mov_b32 v207, 0
    v_mov_b32 v208, 0
    v_mov_b32 v209, 0
    v_mov_b32 v210, 0
    v_mov_b32 v211, 0
    v_mov_b32 v212, 0
    v_mov_b32 v213, 0
    v_mov_b32 v214, 0
    v_mov_b32 v215, 0
    v_mov_b32 v216, 0
    v_mov_b32 v217, 0
    v_mov_b32 v218, 0
    v_mov_b32 v219, 0
    v_mov_b32 v220, 0
    v_mov_b32 v221, 0
    v_mov_b32 v222, 0
    v_mov_b32 v223, 0
    v_mov_b32 v224, 0
    v_mov_b32 v225, 0
    v_mov_b32 v226, 0
    v_mov_b32 v227, 0
    v_mov_b32 v228, 0
    v_mov_b32 v229, 0
    v_mov_b32 v230, 0
    v_mov_b32 v231, 0
    v_mov_b32 v232, 0
    v_mov_b32 v233, 0
    v_mov_b32 v234, 0
    v_mov_b32 v235, 0
    v_mov_b32 v236, 0
    v_mov_b32 v237, 0
    v_mov_b32 v238, 0
    v_mov_b32 v239, 0
    v_mov_b32 v240, 0
    v_mov_b32 v241, 0
    v_mov_b32 v242, 0
    v_mov_b32 v243, 0
    v_mov_b32 v244, 0
    v_mov_b32 v245, 0
    v_mov_b32 v246, 0
    v_mov_b32 v247, 0
    v_mov_b32 v248, 0
    v_mov_b32 v249, 0
    v_mov_b32 v250, 0
    v_mov_b32 v251, 0
    v_mov_b32 v252, 0
    v_mov_b32 v253, 0
    v_mov_b32 v254, 0
    v_mov_b32 v255, 0
    v_mov_b32 v28, 0
    v_mov_b32 v40, 4048155338
    v_mov_b32 v32, 0
    v_mov_b32 v41, 4048155338
    s_lshl_b32 s43, s28, 12
    v_add_u32 v4, s43, v7
    s_mov_b32 s46, s45
    s_sub_u32 s40, 16, s30
    s_mov_b32 s39, s30
    s_lshl_b32 s37, s39, 7
    s_and_b32 s36, s28, 3
    s_lshl_b32 s36, s36, 5
    s_add_u32 s36, s36, s37
    s_sub_u32 s50, 0, s36
L_recurrent_scan__compressed_kv_cla__moe_arch_mod__prompt_kernel_stile_164:
    s_waitcnt vmcnt(0) lgkmcnt(0)
    s_barrier
    s_mov_b32 m0, s43
    s_add_u32 s47, s46, 32768
    buffer_load_dwordx4 v4, s[12:15], s46 offen offset:0 sc1 lds
    buffer_load_dwordx4 v4, s[12:15], s46 offen offset:1024 sc1 lds
    buffer_load_dwordx4 v4, s[12:15], s46 offen offset:2048 sc1 lds
    buffer_load_dwordx4 v4, s[12:15], s46 offen offset:3072 sc1 lds
    s_add_u32 m0, s43, 32768
    s_add_u32 s46, s46, 65536
    buffer_load_dwordx4 v4, s[12:15], s47 offen offset:0 sc1 lds
    buffer_load_dwordx4 v4, s[12:15], s47 offen offset:1024 sc1 lds
    buffer_load_dwordx4 v4, s[12:15], s47 offen offset:2048 sc1 lds
    buffer_load_dwordx4 v4, s[12:15], s47 offen offset:3072 sc1 lds
    v_mov_b32 v2, v7
    s_mov_b32 s41, 4
    s_waitcnt vmcnt(0)
    s_barrier
L_recurrent_scan__compressed_kv_cla__moe_arch_mod__prompt_kernel_sunit_165:
    s_cmp_gt_i32 s50, 0
    s_cbranch_scc1 L_recurrent_scan__compressed_kv_cla__moe_arch_mod__prompt_kernel_snext_166
    ds_read_b128 v[64:67], v2 offset:0
    ds_read_b128 v[68:71], v2 offset:1024
    ds_read_b128 v[72:75], v2 offset:2048
    ds_read_b128 v[76:79], v2 offset:3072
    ds_read_b128 v[80:83], v2 offset:4096
    ds_read_b128 v[84:87], v2 offset:5120
    ds_read_b128 v[88:91], v2 offset:6144
    ds_read_b128 v[92:95], v2 offset:7168
    s_waitcnt lgkmcnt(0)
    v_mfma_f32_16x16x32_bf16 v[96:99], v[64:67], v[128:131], 0
    v_mfma_f32_16x16x32_bf16 v[104:107], v[64:67], v[144:147], 0
    v_mfma_f32_16x16x32_bf16 v[96:99], v[68:71], v[132:135], v[96:99]
    v_mfma_f32_16x16x32_bf16 v[104:107], v[68:71], v[148:151], v[104:107]
    v_mfma_f32_16x16x32_bf16 v[96:99], v[72:75], v[136:139], v[96:99]
    v_mfma_f32_16x16x32_bf16 v[104:107], v[72:75], v[152:155], v[104:107]
    v_mfma_f32_16x16x32_bf16 v[96:99], v[76:79], v[140:143], v[96:99]
    v_mfma_f32_16x16x32_bf16 v[104:107], v[76:79], v[156:159], v[104:107]
    v_mfma_f32_16x16x32_bf16 v[100:103], v[80:83], v[128:131], 0
    v_mfma_f32_16x16x32_bf16 v[108:111], v[80:83], v[144:147], 0
    v_mfma_f32_16x16x32_bf16 v[100:103], v[84:87], v[132:135], v[100:103]
    v_mfma_f32_16x16x32_bf16 v[108:111], v[84:87], v[148:151], v[108:111]
    v_mfma_f32_16x16x32_bf16 v[100:103], v[88:91], v[136:139], v[100:103]
    v_mfma_f32_16x16x32_bf16 v[108:111], v[88:91], v[152:155], v[108:111]
    v_mfma_f32_16x16x32_bf16 v[100:103], v[92:95], v[140:143], v[100:103]
    v_mfma_f32_16x16x32_bf16 v[108:111], v[92:95], v[156:159], v[108:111]
    ds_read_b128 v[64:67], v2 offset:32768
    ds_read_b128 v[68:71], v2 offset:33792
    ds_read_b128 v[72:75], v2 offset:34816
    ds_read_b128 v[76:79], v2 offset:35840
    ds_read_b128 v[80:83], v2 offset:36864
    ds_read_b128 v[84:87], v2 offset:37888
    ds_read_b128 v[88:91], v2 offset:38912
    ds_read_b128 v[92:95], v2 offset:39936
    s_nop 1
    s_cmp_lt_i32 s50, 0
    s_cbranch_scc0 L_recurrent_scan__compressed_kv_cla__moe_arch_mod__prompt_kernel_rare_169
L_recurrent_scan__compressed_kv_cla__moe_arch_mod__prompt_kernel_back_170:
    v_max3_f32 v22, v96, v97, v98
    v_max3_f32 v22, v22, v99, v100
    v_max3_f32 v22, v22, v101, v102
    v_max3_f32 v22, v22, v103, v40
    v_mov_b32 v24, v22
    s_nop 1
    v_permlane16_swap_b32 v22, v24
    s_nop 1
    v_max_f32 v22, v22, v24
    v_mov_b32 v24, v22
    s_nop 1
    v_permlane32_swap_b32 v22, v24
    s_nop 1
    v_max_f32 v22, v22, v24
    v_sub_f32 v25, v40, v22
    v_exp_f32 v25, v25
    v_mov_b32 v40, v22
    v_mul_f32 v28, v28, v25
    v_mul_f32 v192, v192, v25
    v_mul_f32 v193, v193, v25
    v_mul_f32 v194, v194, v25
    v_mul_f32 v195, v195, v25
    v_mul_f32 v196, v196, v25
    v_mul_f32 v197, v197, v25
    v_mul_f32 v198, v198, v25
    v_mul_f32 v199, v199, v25
    v_mul_f32 v200, v200, v25
    v_mul_f32 v201, v201, v25
    v_mul_f32 v202, v202, v25
    v_mul_f32 v203, v203, v25
    v_mul_f32 v204, v204, v25
    v_mul_f32 v205, v205, v25
    v_mul_f32 v206, v206, v25
    v_mul_f32 v207, v207, v25
    v_mul_f32 v208, v208, v25
    v_mul_f32 v209, v209, v25
    v_mul_f32 v210, v210, v25
    v_mul_f32 v211, v211, v25
    v_mul_f32 v212, v212, v25
    v_mul_f32 v213, v213, v25
    v_mul_f32 v214, v214, v25
    v_mul_f32 v215, v215, v25
    v_mul_f32 v216, v216, v25
    v_mul_f32 v217, v217, v25
    v_mul_f32 v218, v218, v25
    v_mul_f32 v219, v219, v25
    v_mul_f32 v220, v220, v25
    v_mul_f32 v221, v221, v25
    v_mul_f32 v222, v222, v25
    v_mul_f32 v223, v223, v25
    v_sub_f32 v96, v96, v22
    v_sub_f32 v97, v97, v22
    v_sub_f32 v98, v98, v22
    v_sub_f32 v99, v99, v22
    v_sub_f32 v100, v100, v22
    v_sub_f32 v101, v101, v22
    v_sub_f32 v102, v102, v22
    v_sub_f32 v103, v103, v22
    v_max3_f32 v23, v104, v105, v106
    v_max3_f32 v23, v23, v107, v108
    v_max3_f32 v23, v23, v109, v110
    v_max3_f32 v23, v23, v111, v41
    v_mov_b32 v24, v23
    s_nop 1
    v_permlane16_swap_b32 v23, v24
    s_nop 1
    v_max_f32 v23, v23, v24
    v_mov_b32 v24, v23
    s_nop 1
    v_permlane32_swap_b32 v23, v24
    s_nop 1
    v_max_f32 v23, v23, v24
    v_sub_f32 v25, v41, v23
    v_exp_f32 v25, v25
    v_mov_b32 v41, v23
    v_mul_f32 v32, v32, v25
    v_mul_f32 v224, v224, v25
    v_mul_f32 v225, v225, v25
    v_mul_f32 v226, v226, v25
    v_mul_f32 v227, v227, v25
    v_mul_f32 v228, v228, v25
    v_mul_f32 v229, v229, v25
    v_mul_f32 v230, v230, v25
    v_mul_f32 v231, v231, v25
    v_mul_f32 v232, v232, v25
    v_mul_f32 v233, v233, v25
    v_mul_f32 v234, v234, v25
    v_mul_f32 v235, v235, v25
    v_mul_f32 v236, v236, v25
    v_mul_f32 v237, v237, v25
    v_mul_f32 v238, v238, v25
    v_mul_f32 v239, v239, v25
    v_mul_f32 v240, v240, v25
    v_mul_f32 v241, v241, v25
    v_mul_f32 v242, v242, v25
    v_mul_f32 v243, v243, v25
    v_mul_f32 v244, v244, v25
    v_mul_f32 v245, v245, v25
    v_mul_f32 v246, v246, v25
    v_mul_f32 v247, v247, v25
    v_mul_f32 v248, v248, v25
    v_mul_f32 v249, v249, v25
    v_mul_f32 v250, v250, v25
    v_mul_f32 v251, v251, v25
    v_mul_f32 v252, v252, v25
    v_mul_f32 v253, v253, v25
    v_mul_f32 v254, v254, v25
    v_mul_f32 v255, v255, v25
    v_sub_f32 v104, v104, v23
    v_sub_f32 v105, v105, v23
    v_sub_f32 v106, v106, v23
    v_sub_f32 v107, v107, v23
    v_sub_f32 v108, v108, v23
    v_sub_f32 v109, v109, v23
    v_sub_f32 v110, v110, v23
    v_sub_f32 v111, v111, v23
    v_exp_f32 v96, v96
    v_exp_f32 v97, v97
    v_exp_f32 v98, v98
    v_exp_f32 v99, v99
    v_exp_f32 v104, v104
    v_exp_f32 v105, v105
    v_exp_f32 v106, v106
    v_exp_f32 v107, v107
    v_exp_f32 v100, v100
    v_exp_f32 v101, v101
    v_exp_f32 v102, v102
    v_exp_f32 v103, v103
    v_exp_f32 v108, v108
    v_exp_f32 v109, v109
    v_exp_f32 v110, v110
    v_exp_f32 v111, v111
    v_add_f32 v28, v28, v96
    v_add_f32 v28, v28, v97
    v_cvt_pk_bf16_f32 v48, v96, v97
    v_add_f32 v28, v28, v98
    v_add_f32 v28, v28, v99
    v_cvt_pk_bf16_f32 v49, v98, v99
    v_add_f32 v32, v32, v104
    v_add_f32 v32, v32, v105
    v_cvt_pk_bf16_f32 v52, v104, v105
    v_add_f32 v32, v32, v106
    v_add_f32 v32, v32, v107
    v_cvt_pk_bf16_f32 v53, v106, v107
    v_add_f32 v28, v28, v100
    v_add_f32 v28, v28, v101
    v_cvt_pk_bf16_f32 v50, v100, v101
    v_add_f32 v28, v28, v102
    v_add_f32 v28, v28, v103
    v_cvt_pk_bf16_f32 v51, v102, v103
    v_add_f32 v32, v32, v108
    v_add_f32 v32, v32, v109
    v_cvt_pk_bf16_f32 v54, v108, v109
    v_add_f32 v32, v32, v110
    v_add_f32 v32, v32, v111
    v_cvt_pk_bf16_f32 v55, v110, v111
    s_waitcnt lgkmcnt(0)
    s_nop 0
    v_mfma_f32_16x16x32_bf16 v[192:195], v[64:67], v[48:51], v[192:195]
    v_mfma_f32_16x16x32_bf16 v[224:227], v[64:67], v[52:55], v[224:227]
    v_mfma_f32_16x16x32_bf16 v[196:199], v[68:71], v[48:51], v[196:199]
    v_mfma_f32_16x16x32_bf16 v[228:231], v[68:71], v[52:55], v[228:231]
    v_mfma_f32_16x16x32_bf16 v[200:203], v[72:75], v[48:51], v[200:203]
    v_mfma_f32_16x16x32_bf16 v[232:235], v[72:75], v[52:55], v[232:235]
    v_mfma_f32_16x16x32_bf16 v[204:207], v[76:79], v[48:51], v[204:207]
    v_mfma_f32_16x16x32_bf16 v[236:239], v[76:79], v[52:55], v[236:239]
    v_mfma_f32_16x16x32_bf16 v[208:211], v[80:83], v[48:51], v[208:211]
    v_mfma_f32_16x16x32_bf16 v[240:243], v[80:83], v[52:55], v[240:243]
    v_mfma_f32_16x16x32_bf16 v[212:215], v[84:87], v[48:51], v[212:215]
    v_mfma_f32_16x16x32_bf16 v[244:247], v[84:87], v[52:55], v[244:247]
    v_mfma_f32_16x16x32_bf16 v[216:219], v[88:91], v[48:51], v[216:219]
    v_mfma_f32_16x16x32_bf16 v[248:251], v[88:91], v[52:55], v[248:251]
    v_mfma_f32_16x16x32_bf16 v[220:223], v[92:95], v[48:51], v[220:223]
    v_mfma_f32_16x16x32_bf16 v[252:255], v[92:95], v[52:55], v[252:255]
L_recurrent_scan__compressed_kv_cla__moe_arch_mod__prompt_kernel_snext_166:
    v_add_u32 v2, 8192, v2
    s_add_u32 s50, s50, 32
    s_sub_u32 s41, s41, 1
    s_cmp_lg_u32 s41, 0
    s_cbranch_scc1 L_recurrent_scan__compressed_kv_cla__moe_arch_mod__prompt_kernel_sunit_165
    s_sub_u32 s40, s40, 1
    s_cmp_lg_u32 s40, 0
    s_cbranch_scc1 L_recurrent_scan__compressed_kv_cla__moe_arch_mod__prompt_kernel_stile_164
    v_mov_b32 v20, v28
    s_nop 1
    v_permlane16_swap_b32 v28, v20
    s_nop 1
    v_add_f32 v28, v28, v20
    v_mov_b32 v20, v28
    s_nop 1
    v_permlane32_swap_b32 v28, v20
    s_nop 1
    v_add_f32 v28, v28, v20
    v_mov_b32 v20, v32
    s_nop 1
    v_permlane16_swap_b32 v32, v20
    s_nop 1
    v_add_f32 v32, v32, v20
    v_mov_b32 v20, v32
    s_nop 1
    v_permlane32_swap_b32 v32, v20
    s_nop 1
    v_add_f32 v32, v32, v20
    s_mov_b32 s36, 0x5d800000
    v_cmp_nge_f32 vcc, s36, v28
    s_nop 0
    s_or_b64 s[52:53], s[52:53], vcc
    v_cmp_nge_f32 vcc, s36, v32
    s_nop 0
    s_or_b64 s[52:53], s[52:53], vcc
    v_rcp_f32 v20, v28
    v_rcp_f32 v22, v32
    s_lshl_b32 s38, s39, 3
    s_and_b32 s37, s28, 3
    s_lshl_b32 s37, s37, 1
    s_add_u32 s38, s38, s37
    s_lshl_b32 s38, s38, 17
    s_lshl_b32 s37, s29, 12
    s_add_u32 s38, s38, s37
    v_mov_b32 v21, v20
    v_mov_b32 v23, v22
    v_mov_b32 v24, v7
    v_pk_mul_f32 v[192:193], v[192:193], v[20:21]
    v_pk_mul_f32 v[194:195], v[194:195], v[20:21]
    v_pk_mul_f32 v[196:197], v[196:197], v[20:21]
    v_pk_mul_f32 v[198:199], v[198:199], v[20:21]
    v_cvt_pk_bf16_f32 v192, v192, v193
    v_cvt_pk_bf16_f32 v193, v194, v195
    v_cvt_pk_bf16_f32 v194, v196, v197
    v_cvt_pk_bf16_f32 v195, v198, v199
    buffer_store_dwordx4 v[192:195], v24, s[16:19], s38 offen offset:0 sc1
    v_pk_mul_f32 v[200:201], v[200:201], v[20:21]
    v_pk_mul_f32 v[202:203], v[202:203], v[20:21]
    v_pk_mul_f32 v[204:205], v[204:205], v[20:21]
    v_pk_mul_f32 v[206:207], v[206:207], v[20:21]
    v_cvt_pk_bf16_f32 v200, v200, v201
    v_cvt_pk_bf16_f32 v201, v202, v203
    v_cvt_pk_bf16_f32 v202, v204, v205
    v_cvt_pk_bf16_f32 v203, v206, v207
    buffer_store_dwordx4 v[200:203], v24, s[16:19], s38 offen offset:1024 sc1
    v_pk_mul_f32 v[208:209], v[208:209], v[20:21]
    v_pk_mul_f32 v[210:211], v[210:211], v[20:21]
    v_pk_mul_f32 v[212:213], v[212:213], v[20:21]
    v_pk_mul_f32 v[214:215], v[214:215], v[20:21]
    v_cvt_pk_bf16_f32 v208, v208, v209
    v_cvt_pk_bf16_f32 v209, v210, v211
    v_cvt_pk_bf16_f32 v210, v212, v213
    v_cvt_pk_bf16_f32 v211, v214, v215
    buffer_store_dwordx4 v[208:211], v24, s[16:19], s38 offen offset:2048 sc1
    v_pk_mul_f32 v[216:217], v[216:217], v[20:21]
    v_pk_mul_f32 v[218:219], v[218:219], v[20:21]
    v_pk_mul_f32 v[220:221], v[220:221], v[20:21]
    v_pk_mul_f32 v[222:223], v[222:223], v[20:21]
    v_cvt_pk_bf16_f32 v216, v216, v217
    v_cvt_pk_bf16_f32 v217, v218, v219
    v_cvt_pk_bf16_f32 v218, v220, v221
    v_cvt_pk_bf16_f32 v219, v222, v223
    buffer_store_dwordx4 v[216:219], v24, s[16:19], s38 offen offset:3072 sc1
    s_add_u32 s38, s38, 131072
    v_pk_mul_f32 v[224:225], v[224:225], v[22:23]
    v_pk_mul_f32 v[226:227], v[226:227], v[22:23]
    v_pk_mul_f32 v[228:229], v[228:229], v[22:23]
    v_pk_mul_f32 v[230:231], v[230:231], v[22:23]
    v_cvt_pk_bf16_f32 v224, v224, v225
    v_cvt_pk_bf16_f32 v225, v226, v227
    v_cvt_pk_bf16_f32 v226, v228, v229
    v_cvt_pk_bf16_f32 v227, v230, v231
    buffer_store_dwordx4 v[224:227], v24, s[16:19], s38 offen offset:0 sc1
    v_pk_mul_f32 v[232:233], v[232:233], v[22:23]
    v_pk_mul_f32 v[234:235], v[234:235], v[22:23]
    v_pk_mul_f32 v[236:237], v[236:237], v[22:23]
    v_pk_mul_f32 v[238:239], v[238:239], v[22:23]
    v_cvt_pk_bf16_f32 v232, v232, v233
    v_cvt_pk_bf16_f32 v233, v234, v235
    v_cvt_pk_bf16_f32 v234, v236, v237
    v_cvt_pk_bf16_f32 v235, v238, v239
    buffer_store_dwordx4 v[232:235], v24, s[16:19], s38 offen offset:1024 sc1
    v_pk_mul_f32 v[240:241], v[240:241], v[22:23]
    v_pk_mul_f32 v[242:243], v[242:243], v[22:23]
    v_pk_mul_f32 v[244:245], v[244:245], v[22:23]
    v_pk_mul_f32 v[246:247], v[246:247], v[22:23]
    v_cvt_pk_bf16_f32 v240, v240, v241
    v_cvt_pk_bf16_f32 v241, v242, v243
    v_cvt_pk_bf16_f32 v242, v244, v245
    v_cvt_pk_bf16_f32 v243, v246, v247
    buffer_store_dwordx4 v[240:243], v24, s[16:19], s38 offen offset:2048 sc1
    v_pk_mul_f32 v[248:249], v[248:249], v[22:23]
    v_pk_mul_f32 v[250:251], v[250:251], v[22:23]
    v_pk_mul_f32 v[252:253], v[252:253], v[22:23]
    v_pk_mul_f32 v[254:255], v[254:255], v[22:23]
    v_cvt_pk_bf16_f32 v248, v248, v249
    v_cvt_pk_bf16_f32 v249, v250, v251
    v_cvt_pk_bf16_f32 v250, v252, v253
    v_cvt_pk_bf16_f32 v251, v254, v255
    buffer_store_dwordx4 v[248:251], v24, s[16:19], s38 offen offset:3072 sc1
    v_mov_b32 v96, v112
    v_mov_b32 v97, v113
    v_mov_b32 v98, v114
    v_mov_b32 v99, v115
    v_mov_b32 v100, v116
    v_mov_b32 v101, v117
    v_mov_b32 v102, v118
    v_mov_b32 v103, v119
    s_branch L_p3_done
L_recurrent_scan__compressed_kv_cla__moe_arch_mod__prompt_kernel_rare_109:
    s_cmp_lt_i32 s36, 0
    s_cbranch_scc1 L_recurrent_scan__compressed_kv_cla__moe_arch_mod__prompt_kernel_nm_108
    v_mov_b32 v20, 4048155338
    s_cmp_gt_i32 s36, 0
    s_cbranch_scc1 L_recurrent_scan__compressed_kv_cla__moe_arch_mod__prompt_kernel_mf_106
    v_cmp_gt_i32 s[20:21], 0, v18
    v_cmp_gt_i32 s[22:23], 1, v18
    v_cmp_gt_i32 s[62:63], 2, v18
    v_cmp_gt_i32 vcc, 3, v18
    v_mov_b32 v100, v20
    v_mov_b32 v101, v20
    v_mov_b32 v102, v20
    v_mov_b32 v103, v20
    v_cndmask_b32 v96, v96, v20, s[20:21]
    v_cndmask_b32 v97, v97, v20, s[22:23]
    v_cndmask_b32 v98, v98, v20, s[62:63]
    v_cndmask_b32 v99, v99, v20, vcc
    v_cndmask_b32 v108, v108, v20, s[20:21]
    v_cndmask_b32 v109, v109, v20, s[22:23]
    v_cndmask_b32 v110, v110, v20, s[62:63]
    v_cndmask_b32 v111, v111, v20, vcc
    s_branch L_recurrent_scan__compressed_kv_cla__moe_arch_mod__prompt_kernel_me_107
L_recurrent_scan__compressed_kv_cla__moe_arch_mod__prompt_kernel_mf_106:
    v_mov_b32 v96, v20
    v_mov_b32 v97, v20
    v_mov_b32 v98, v20
    v_mov_b32 v99, v20
    v_mov_b32 v100, v20
    v_mov_b32 v101, v20
    v_mov_b32 v102, v20
    v_mov_b32 v103, v20
    v_mov_b32 v104, v20
    v_mov_b32 v105, v20
    v_mov_b32 v106, v20
    v_mov_b32 v107, v20
    v_mov_b32 v108, v20
    v_mov_b32 v109, v20
    v_mov_b32 v110, v20
    v_mov_b32 v111, v20
L_recurrent_scan__compressed_kv_cla__moe_arch_mod__prompt_kernel_me_107:
L_recurrent_scan__compressed_kv_cla__moe_arch_mod__prompt_kernel_nm_108:
    s_branch L_recurrent_scan__compressed_kv_cla__moe_arch_mod__prompt_kernel_back_110
L_recurrent_scan__compressed_kv_cla__moe_arch_mod__prompt_kernel_rare_118:
    s_add_u32 s36, s40, 1
    s_sub_u32 s36, s36, s51
    s_cmp_lt_u32 s36, 2
    s_cbranch_scc0 L_recurrent_scan__compressed_kv_cla__moe_arch_mod__prompt_kernel_r_112
    s_lshl_b32 s36, s36, 6
    s_add_u32 s36, s36, 32
    s_sub_u32 s36, s36, s50
    s_cmp_lt_i32 s36, 0
    s_cbranch_scc1 L_recurrent_scan__compressed_kv_cla__moe_arch_mod__prompt_kernel_nm_117
    v_mov_b32 v20, 4048155338
    s_cmp_gt_i32 s36, 0
    s_cbranch_scc1 L_recurrent_scan__compressed_kv_cla__moe_arch_mod__prompt_kernel_mf_115
    v_cmp_gt_i32 s[20:21], 0, v18
    v_cmp_gt_i32 s[22:23], 1, v18
    v_cmp_gt_i32 s[62:63], 2, v18
    v_cmp_gt_i32 vcc, 3, v18
    v_mov_b32 v116, v20
    v_mov_b32 v117, v20
    v_mov_b32 v118, v20
    v_mov_b32 v119, v20
    v_cndmask_b32 v112, v112, v20, s[20:21]
    v_cndmask_b32 v113, v113, v20, s[22:23]
    v_cndmask_b32 v114, v114, v20, s[62:63]
    v_cndmask_b32 v115, v115, v20, vcc
    v_cndmask_b32 v124, v124, v20, s[20:21]
    v_cndmask_b32 v125, v125, v20, s[22:23]
    v_cndmask_b32 v126, v126, v20, s[62:63]
    v_cndmask_b32 v127, v127, v20, vcc
    s_branch L_recurrent_scan__compressed_kv_cla__moe_arch_mod__prompt_kernel_me_116
L_recurrent_scan__compressed_kv_cla__moe_arch_mod__prompt_kernel_mf_115:
    v_mov_b32 v112, v20
    v_mov_b32 v113, v20
    v_mov_b32 v114, v20
    v_mov_b32 v115, v20
    v_mov_b32 v116, v20
    v_mov_b32 v117, v20
    v_mov_b32 v118, v20
    v_mov_b32 v119, v20
    v_mov_b32 v120, v20
    v_mov_b32 v121, v20
    v_mov_b32 v122, v20
    v_mov_b32 v123, v20
    v_mov_b32 v124, v20
    v_mov_b32 v125, v20
    v_mov_b32 v126, v20
    v_mov_b32 v127, v20
L_recurrent_scan__compressed_kv_cla__moe_arch_mod__prompt_kernel_me_116:
L_recurrent_scan__compressed_kv_cla__moe_arch_mod__prompt_kernel_nm_117:
L_recurrent_scan__compressed_kv_cla__moe_arch_mod__prompt_kernel_r_112:
    s_branch L_recurrent_scan__compressed_kv_cla__moe_arch_mod__prompt_kernel_back_119
L_recurrent_scan__compressed_kv_cla__moe_arch_mod__prompt_kernel_rare_123:
    s_add_u32 s36, s40, 2
    s_sub_u32 s36, s36, s51
    s_cmp_eq_u32 s36, 1
    s_cselect_b32 s41, 0x8000, s41
    s_cmp_eq_u32 s40, 15
    s_cbranch_scc0 L_recurrent_scan__compressed_kv_cla__moe_arch_mod__prompt_kernel_r_113
    s_mov_b32 s41, 65536
    s_mov_b32 s49, 0x1ffff
    s_mov_b32 s36, 1
L_recurrent_scan__compressed_kv_cla__moe_arch_mod__prompt_kernel_r_113:
    s_cmp_lt_u32 s36, 2
    s_cbranch_scc0 L_recurrent_scan__compressed_kv_cla__moe_arch_mod__prompt_kernel_r_114
    s_lshl_b32 s36, s36, 6
    s_sub_u32 s36, s36, s50
    s_cmp_lt_i32 s36, 0
    s_cbranch_scc1 L_recurrent_scan__compressed_kv_cla__moe_arch_mod__prompt_kernel_nm_122
    v_mov_b32 v20, 4048155338
    s_cmp_gt_i32 s36, 0
    s_cbranch_scc1 L_recurrent_scan__compressed_kv_cla__moe_arch_mod__prompt_kernel_mf_120
    v_cmp_gt_i32 s[20:21], 0, v18
    v_cmp_gt_i32 s[22:23], 1, v18
    v_cmp_gt_i32 s[62:63], 2, v18
    v_cmp_gt_i32 vcc, 3, v18
    v_mov_b32 v100, v20
    v_mov_b32 v101, v20
    v_mov_b32 v102, v20
    v_mov_b32 v103, v20
    v_cndmask_b32 v96, v96, v20, s[20:21]
    v_cndmask_b32 v97, v97, v20, s[22:23]
    v_cndmask_b32 v98, v98, v20, s[62:63]
    v_cndmask_b32 v99, v99, v20, vcc
    v_cndmask_b32 v108, v108, v20, s[20:21]
    v_cndmask_b32 v109, v109, v20, s[22:23]
    v_cndmask_b32 v110, v110, v20, s[62:63]
    v_cndmask_b32 v111, v111, v20, vcc
    s_branch L_recurrent_scan__compressed_kv_cla__moe_arch_mod__prompt_kernel_me_121
L_recurrent_scan__compressed_kv_cla__moe_arch_mod__prompt_kernel_mf_120:
    v_mov_b32 v96, v20
    v_mov_b32 v97, v20
    v_mov_b32 v98, v20
    v_mov_b32 v99, v20
    v_mov_b32 v100, v20
    v_mov_b32 v101, v20
    v_mov_b32 v102, v20
    v_mov_b32 v103, v20
    v_mov_b32 v104, v20
    v_mov_b32 v105, v20
    v_mov_b32 v106, v20
    v_mov_b32 v107, v20
    v_mov_b32 v108, v20
    v_mov_b32 v109, v20
    v_mov_b32 v110, v20
    v_mov_b32 v111, v20
L_recurrent_scan__compressed_kv_cla__moe_arch_mod__prompt_kernel_me_121:
L_recurrent_scan__compressed_kv_cla__moe_arch_mod__prompt_kernel_nm_122:
L_recurrent_scan__compressed_kv_cla__moe_arch_mod__prompt_kernel_r_114:
    s_branch L_recurrent_scan__compressed_kv_cla__moe_arch_mod__prompt_kernel_back_124
L_recurrent_scan__compressed_kv_cla__moe_arch_mod__prompt_kernel_rare_128:
    v_mov_b32 v20, 4048155338
    s_cmp_gt_i32 s36, 0
    s_cbranch_scc1 L_recurrent_scan__compressed_kv_cla__moe_arch_mod__prompt_kernel_mf_126
    v_cmp_gt_i32 s[20:21], 0, v18
    v_cmp_gt_i32 s[22:23], 1, v18
    v_cmp_gt_i32 s[62:63], 2, v18
    v_cmp_gt_i32 vcc, 3, v18
    v_mov_b32 v116, v20
    v_mov_b32 v117, v20
    v_mov_b32 v118, v20
    v_mov_b32 v119, v20
    v_cndmask_b32 v112, v112, v20, s[20:21]
    v_cndmask_b32 v113, v113, v20, s[22:23]
    v_cndmask_b32 v114, v114, v20, s[62:63]
    v_cndmask_b32 v115, v115, v20, vcc
    v_cndmask_b32 v124, v124, v20, s[20:21]
    v_cndmask_b32 v125, v125, v20, s[22:23]
    v_cndmask_b32 v126, v126, v20, s[62:63]
    v_cndmask_b32 v127, v127, v20, vcc
    s_branch L_recurrent_scan__compressed_kv_cla__moe_arch_mod__prompt_kernel_me_127
L_recurrent_scan__compressed_kv_cla__moe_arch_mod__prompt_kernel_mf_126:
    v_mov_b32 v112, v20
    v_mov_b32 v113, v20
    v_mov_b32 v114, v20
    v_mov_b32 v115, v20
    v_mov_b32 v116, v20
    v_mov_b32 v117, v20
    v_mov_b32 v118, v20
    v_mov_b32 v119, v20
    v_mov_b32 v120, v20
    v_mov_b32 v121, v20
    v_mov_b32 v122, v20
    v_mov_b32 v123, v20
    v_mov_b32 v124, v20
    v_mov_b32 v125, v20
    v_mov_b32 v126, v20
    v_mov_b32 v127, v20
L_recurrent_scan__compressed_kv_cla__moe_arch_mod__prompt_kernel_me_127:
    s_branch L_recurrent_scan__compressed_kv_cla__moe_arch_mod__prompt_kernel_back_129
L_recurrent_scan__compressed_kv_cla__moe_arch_mod__prompt_kernel_rare_136:
    s_add_u32 s36, s40, 1
    s_sub_u32 s36, s36, s51
    s_cmp_lt_u32 s36, 2
    s_cbranch_scc0 L_recurrent_scan__compressed_kv_cla__moe_arch_mod__prompt_kernel_r_130
    s_lshl_b32 s36, s36, 6
    s_add_u32 s36, s36, 32
    s_sub_u32 s36, s36, s50
    s_cmp_lt_i32 s36, 0
    s_cbranch_scc1 L_recurrent_scan__compressed_kv_cla__moe_arch_mod__prompt_kernel_nm_135
    v_mov_b32 v20, 4048155338
    s_cmp_gt_i32 s36, 0
    s_cbranch_scc1 L_recurrent_scan__compressed_kv_cla__moe_arch_mod__prompt_kernel_mf_133
    v_cmp_gt_i32 s[20:21], 0, v18
    v_cmp_gt_i32 s[22:23], 1, v18
    v_cmp_gt_i32 s[62:63], 2, v18
    v_cmp_gt_i32 vcc, 3, v18
    v_mov_b32 v116, v20
    v_mov_b32 v117, v20
    v_mov_b32 v118, v20
    v_mov_b32 v119, v20
    v_cndmask_b32 v112, v112, v20, s[20:21]
    v_cndmask_b32 v113, v113, v20, s[22:23]
    v_cndmask_b32 v114, v114, v20, s[62:63]
    v_cndmask_b32 v115, v115, v20, vcc
    v_cndmask_b32 v124, v124, v20, s[20:21]
    v_cndmask_b32 v125, v125, v20, s[22:23]
    v_cndmask_b32 v126, v126, v20, s[62:63]
    v_cndmask_b32 v127, v127, v20, vcc
    s_branch L_recurrent_scan__compressed_kv_cla__moe_arch_mod__prompt_kernel_me_134
L_recurrent_scan__compressed_kv_cla__moe_arch_mod__prompt_kernel_mf_133:
    v_mov_b32 v112, v20
    v_mov_b32 v113, v20
    v_mov_b32 v114, v20
    v_mov_b32 v115, v20
    v_mov_b32 v116, v20
    v_mov_b32 v117, v20
    v_mov_b32 v118, v20
    v_mov_b32 v119, v20
    v_mov_b32 v120, v20
    v_mov_b32 v121, v20
    v_mov_b32 v122, v20
    v_mov_b32 v123, v20
    v_mov_b32 v124, v20
    v_mov_b32 v125, v20
    v_mov_b32 v126, v20
    v_mov_b32 v127, v20
L_recurrent_scan__compressed_kv_cla__moe_arch_mod__prompt_kernel_me_134:
L_recurrent_scan__compressed_kv_cla__moe_arch_mod__prompt_kernel_nm_135:
L_recurrent_scan__compressed_kv_cla__moe_arch_mod__prompt_kernel_r_130:
    s_branch L_recurrent_scan__compressed_kv_cla__moe_arch_mod__prompt_kernel_back_137
L_recurrent_scan__compressed_kv_cla__moe_arch_mod__prompt_kernel_rare_141:
    s_add_u32 s36, s40, 2
    s_sub_u32 s36, s36, s51
    s_cmp_eq_u32 s36, 1
    s_cselect_b32 s41, 0x8000, s41
    s_cmp_eq_u32 s40, 15
    s_cbranch_scc0 L_recurrent_scan__compressed_kv_cla__moe_arch_mod__prompt_kernel_r_131
    s_mov_b32 s41, 65536
    s_mov_b32 s49, 0x1ffff
    s_mov_b32 s36, 1
L_recurrent_scan__compressed_kv_cla__moe_arch_mod__prompt_kernel_r_131:
    s_cmp_lt_u32 s36, 2
    s_cbranch_scc0 L_recurrent_scan__compressed_kv_cla__moe_arch_mod__prompt_kernel_r_132
    s_lshl_b32 s36, s36, 6
    s_sub_u32 s36, s36, s50
    s_cmp_lt_i32 s36, 0
    s_cbranch_scc1 L_recurrent_scan__compressed_kv_cla__moe_arch_mod__prompt_kernel_nm_140
    v_mov_b32 v20, 4048155338
    s_cmp_gt_i32 s36, 0
    s_cbranch_scc1 L_recurrent_scan__compressed_kv_cla__moe_arch_mod__prompt_kernel_mf_138
    v_cmp_gt_i32 s[20:21], 0, v18
    v_cmp_gt_i32 s[22:23], 1, v18
    v_cmp_gt_i32 s[62:63], 2, v18
    v_cmp_gt_i32 vcc, 3, v18
    v_mov_b32 v100, v20
    v_mov_b32 v101, v20
    v_mov_b32 v102, v20
    v_mov_b32 v103, v20
    v_cndmask_b32 v96, v96, v20, s[20:21]
    v_cndmask_b32 v97, v97, v20, s[22:23]
    v_cndmask_b32 v98, v98, v20, s[62:63]
    v_cndmask_b32 v99, v99, v20, vcc
    v_cndmask_b32 v108, v108, v20, s[20:21]
    v_cndmask_b32 v109, v109, v20, s[22:23]
    v_cndmask_b32 v110, v110, v20, s[62:63]
    v_cndmask_b32 v111, v111, v20, vcc
    s_branch L_recurrent_scan__compressed_kv_cla__moe_arch_mod__prompt_kernel_me_139
L_recurrent_scan__compressed_kv_cla__moe_arch_mod__prompt_kernel_mf_138:
    v_mov_b32 v96, v20
    v_mov_b32 v97, v20
    v_mov_b32 v98, v20
    v_mov_b32 v99, v20
    v_mov_b32 v100, v20
    v_mov_b32 v101, v20
    v_mov_b32 v102, v20
    v_mov_b32 v103, v20
    v_mov_b32 v104, v20
    v_mov_b32 v105, v20
    v_mov_b32 v106, v20
    v_mov_b32 v107, v20
    v_mov_b32 v108, v20
    v_mov_b32 v109, v20
    v_mov_b32 v110, v20
    v_mov_b32 v111, v20
L_recurrent_scan__compressed_kv_cla__moe_arch_mod__prompt_kernel_me_139:
L_recurrent_scan__compressed_kv_cla__moe_arch_mod__prompt_kernel_nm_140:
L_recurrent_scan__compressed_kv_cla__moe_arch_mod__prompt_kernel_r_132:
    s_branch L_recurrent_scan__compressed_kv_cla__moe_arch_mod__prompt_kernel_back_142
L_recurrent_scan__compressed_kv_cla__moe_arch_mod__prompt_kernel_rare_144:
    s_lshl_b32 s36, s29, 7
    s_cmp_eq_u32 s30, 0
    s_cselect_b32 s37, 4, 0
    s_add_u32 s36, s36, s37
    v_mov_b32 v20, s36
    v_mov_b32 v21, 1
    s_mov_b64 exec, 1
    global_atomic_add v20, v21, s[90:91]
    s_mov_b64 exec, -1
    s_nop 3
    s_branch L_recurrent_scan__compressed_kv_cla__moe_arch_mod__prompt_kernel_back_145
L_recurrent_scan__compressed_kv_cla__moe_arch_mod__prompt_kernel_rare_151:
    s_cmp_eq_u32 s40, 12
    s_cbranch_scc0 L_recurrent_scan__compressed_kv_cla__moe_arch_mod__prompt_kernel_bh_149
    s_getpc_b64 s[36:37]
L_recurrent_scan__compressed_kv_cla__moe_arch_mod__prompt_kernel_pc_150:
    s_sub_u32 s36, s36, L_recurrent_scan__compressed_kv_cla__moe_arch_mod__prompt_kernel_pc_150-L_pc
    s_subb_u32 s37, s37, 0
    s_lshr_b32 s38, s2, 3
    s_lshl_b32 s38, s38, 7
    v_lshl_add_u32 v26, v1, 12, s38
    v_min_u32 v26, L_end-L_pc-4, v26
    v_mov_b32 v27, s37
    v_add_co_u32 v26, vcc, s36, v26
    s_mov_b64 exec, 0xffff
    s_nop 0
    v_addc_co_u32 v27, vcc, 0, v27, vcc
    global_load_dword v0, v[26:27], off
    s_mov_b64 exec, -1
    s_nop 1
L_recurrent_scan__compressed_kv_cla__moe_arch_mod__prompt_kernel_bh_149:
    s_cmp_eq_u32 s40, 0
    s_cbranch_scc0 L_recurrent_scan__compressed_kv_cla__moe_arch_mod__prompt_kernel_nm_146
    ds_read_b64 v[14:15], v19
    s_waitcnt lgkmcnt(0)
L_recurrent_scan__compressed_kv_cla__moe_arch_mod__prompt_kernel_nm_146:
    s_branch L_recurrent_scan__compressed_kv_cla__moe_arch_mod__prompt_kernel_back_152
L_recurrent_scan__compressed_kv_cla__moe_arch_mod__prompt_kernel_rare_158:
    s_cmp_eq_u32 s40, 12
    s_cbranch_scc0 L_recurrent_scan__compressed_kv_cla__moe_arch_mod__prompt_kernel_bh_156
    s_getpc_b64 s[36:37]
L_recurrent_scan__compressed_kv_cla__moe_arch_mod__prompt_kernel_pc_157:
    s_sub_u32 s36, s36, L_recurrent_scan__compressed_kv_cla__moe_arch_mod__prompt_kernel_pc_157-L_pc
    s_subb_u32 s37, s37, 0
    s_lshr_b32 s38, s2, 3
    s_lshl_b32 s38, s38, 7
    v_lshl_add_u32 v26, v1, 12, s38
    v_min_u32 v26, L_end-L_pc-4, v26
    v_mov_b32 v27, s37
    v_add_co_u32 v26, vcc, s36, v26
    s_mov_b64 exec, 0xffff
    s_nop 0
    v_addc_co_u32 v27, vcc, 0, v27, vcc
    global_load_dword v0, v[26:27], off
    s_mov_b64 exec, -1
    s_nop 1
L_recurrent_scan__compressed_kv_cla__moe_arch_mod__prompt_kernel_bh_156:
    s_cmp_eq_u32 s40, s51
    s_cbranch_scc0 L_recurrent_scan__compressed_kv_cla__moe_arch_mod__prompt_kernel_ne_155
    s_nop 4
    s_mov_b32 s36, 0x5d800000
    v_cmp_nge_f32 vcc, s36, v28
    s_nop 0
    s_or_b64 s[52:53], s[52:53], vcc
    v_cmp_nge_f32 vcc, s36, v32
    s_nop 0
    s_or_b64 s[52:53], s[52:53], vcc
    v_rcp_f32 v20, v28
    v_rcp_f32 v22, v32
    s_lshl_b32 s38, s30, 3
    s_and_b32 s37, s28, 3
    s_lshl_b32 s37, s37, 1
    s_add_u32 s38, s38, s37
    s_lshl_b32 s38, s38, 17
    s_lshl_b32 s37, s29, 12
    s_add_u32 s38, s38, s37
    v_mov_b32 v21, v20
    v_mov_b32 v23, v22
    v_mov_b32 v24, v7
    v_pk_mul_f32 v[192:193], v[192:193], v[20:21]
    v_pk_mul_f32 v[194:195], v[194:195], v[20:21]
    v_pk_mul_f32 v[196:197], v[196:197], v[20:21]
    v_pk_mul_f32 v[198:199], v[198:199], v[20:21]
    v_cvt_pk_bf16_f32 v192, v192, v193
    v_cvt_pk_bf16_f32 v193, v194, v195
    v_cvt_pk_bf16_f32 v194, v196, v197
    v_cvt_pk_bf16_f32 v195, v198, v199
    buffer_store_dwordx4 v[192:195], v24, s[16:19], s38 offen offset:0 sc1
    v_pk_mul_f32 v[200:201], v[200:201], v[20:21]
    v_pk_mul_f32 v[202:203], v[202:203], v[20:21]
    v_pk_mul_f32 v[204:205], v[204:205], v[20:21]
    v_pk_mul_f32 v[206:207], v[206:207], v[20:21]
    v_cvt_pk_bf16_f32 v200, v200, v201
    v_cvt_pk_bf16_f32 v201, v202, v203
    v_cvt_pk_bf16_f32 v202, v204, v205
    v_cvt_pk_bf16_f32 v203, v206, v207
    buffer_store_dwordx4 v[200:203], v24, s[16:19], s38 offen offset:1024 sc1
    v_pk_mul_f32 v[208:209], v[208:209], v[20:21]
    v_pk_mul_f32 v[210:211], v[210:211], v[20:21]
    v_pk_mul_f32 v[212:213], v[212:213], v[20:21]
    v_pk_mul_f32 v[214:215], v[214:215], v[20:21]
    v_cvt_pk_bf16_f32 v208, v208, v209
    v_cvt_pk_bf16_f32 v209, v210, v211
    v_cvt_pk_bf16_f32 v210, v212, v213
    v_cvt_pk_bf16_f32 v211, v214, v215
    buffer_store_dwordx4 v[208:211], v24, s[16:19], s38 offen offset:2048 sc1
    v_pk_mul_f32 v[216:217], v[216:217], v[20:21]
    v_pk_mul_f32 v[218:219], v[218:219], v[20:21]
    v_pk_mul_f32 v[220:221], v[220:221], v[20:21]
    v_pk_mul_f32 v[222:223], v[222:223], v[20:21]
    v_cvt_pk_bf16_f32 v216, v216, v217
    v_cvt_pk_bf16_f32 v217, v218, v219
    v_cvt_pk_bf16_f32 v218, v220, v221
    v_cvt_pk_bf16_f32 v219, v222, v223
    buffer_store_dwordx4 v[216:219], v24, s[16:19], s38 offen offset:3072 sc1
    s_add_u32 s38, s38, 131072
    v_pk_mul_f32 v[224:225], v[224:225], v[22:23]
    v_pk_mul_f32 v[226:227], v[226:227], v[22:23]
    v_pk_mul_f32 v[228:229], v[228:229], v[22:23]
    v_pk_mul_f32 v[230:231], v[230:231], v[22:23]
    v_cvt_pk_bf16_f32 v224, v224, v225
    v_cvt_pk_bf16_f32 v225, v226, v227
    v_cvt_pk_bf16_f32 v226, v228, v229
    v_cvt_pk_bf16_f32 v227, v230, v231
    buffer_store_dwordx4 v[224:227], v24, s[16:19], s38 offen offset:0 sc1
    v_pk_mul_f32 v[232:233], v[232:233], v[22:23]
    v_pk_mul_f32 v[234:235], v[234:235], v[22:23]
    v_pk_mul_f32 v[236:237], v[236:237], v[22:23]
    v_pk_mul_f32 v[238:239], v[238:239], v[22:23]
    v_cvt_pk_bf16_f32 v232, v232, v233
    v_cvt_pk_bf16_f32 v233, v234, v235
    v_cvt_pk_bf16_f32 v234, v236, v237
    v_cvt_pk_bf16_f32 v235, v238, v239
    buffer_store_dwordx4 v[232:235], v24, s[16:19], s38 offen offset:1024 sc1
    v_pk_mul_f32 v[240:241], v[240:241], v[22:23]
    v_pk_mul_f32 v[242:243], v[242:243], v[22:23]
    v_pk_mul_f32 v[244:245], v[244:245], v[22:23]
    v_pk_mul_f32 v[246:247], v[246:247], v[22:23]
    v_cvt_pk_bf16_f32 v240, v240, v241
    v_cvt_pk_bf16_f32 v241, v242, v243
    v_cvt_pk_bf16_f32 v242, v244, v245
    v_cvt_pk_bf16_f32 v243, v246, v247
    buffer_store_dwordx4 v[240:243], v24, s[16:19], s38 offen offset:2048 sc1
    v_pk_mul_f32 v[248:249], v[248:249], v[22:23]
    v_pk_mul_f32 v[250:251], v[250:251], v[22:23]
    v_pk_mul_f32 v[252:253], v[252:253], v[22:23]
    v_pk_mul_f32 v[254:255], v[254:255], v[22:23]
    v_cvt_pk_bf16_f32 v248, v248, v249
    v_cvt_pk_bf16_f32 v249, v250, v251
    v_cvt_pk_bf16_f32 v250, v252, v253
    v_cvt_pk_bf16_f32 v251, v254, v255
    buffer_store_dwordx4 v[248:251], v24, s[16:19], s38 offen offset:3072 sc1
    v_mov_b64 v[28:29], 0
    v_mov_b64 v[30:31], 0
    v_mov_b64 v[32:33], 0
    v_mov_b64 v[34:35], 0
    v_mov_b64 v[192:193], 0
    v_mov_b64 v[194:195], 0
    v_mov_b64 v[196:197], 0
    v_mov_b64 v[198:199], 0
    v_mov_b64 v[200:201], 0
    v_mov_b64 v[202:203], 0
    v_mov_b64 v[204:205], 0
    v_mov_b64 v[206:207], 0
    v_mov_b64 v[208:209], 0
    v_mov_b64 v[210:211], 0
    v_mov_b64 v[212:213], 0
    v_mov_b64 v[214:215], 0
    v_mov_b64 v[216:217], 0
    v_mov_b64 v[218:219], 0
    v_mov_b64 v[220:221], 0
    v_mov_b64 v[222:223], 0
    v_mov_b64 v[224:225], 0
    v_mov_b64 v[226:227], 0
    v_mov_b64 v[228:229], 0
    v_mov_b64 v[230:231], 0
    v_mov_b64 v[232:233], 0
    v_mov_b64 v[234:235], 0
    v_mov_b64 v[236:237], 0
    v_mov_b64 v[238:239], 0
    v_mov_b64 v[240:241], 0
    v_mov_b64 v[242:243], 0
    v_mov_b64 v[244:245], 0
    v_mov_b64 v[246:247], 0
    v_mov_b64 v[248:249], 0
    v_mov_b64 v[250:251], 0
    v_mov_b64 v[252:253], 0
    v_mov_b64 v[254:255], 0
L_recurrent_scan__compressed_kv_cla__moe_arch_mod__prompt_kernel_ne_155:
    s_branch L_recurrent_scan__compressed_kv_cla__moe_arch_mod__prompt_kernel_back_159
L_recurrent_scan__compressed_kv_cla__moe_arch_mod__prompt_kernel_rare_162:
    s_mov_b32 s61, 0x40000
L_recurrent_scan__compressed_kv_cla__moe_arch_mod__prompt_kernel_spin_160:
    s_sub_u32 s61, s61, 1
    s_cbranch_scc1 L_recurrent_scan__compressed_kv_cla__moe_arch_mod__prompt_kernel_spinx_161
    s_sleep 8
    global_load_dword v11, v12, s[90:91] sc1
    s_waitcnt vmcnt(0)
    v_readfirstlane_b32 s36, v11
    s_nop 0
    s_cmp_lt_u32 s36, 28
    s_cbranch_scc1 L_recurrent_scan__compressed_kv_cla__moe_arch_mod__prompt_kernel_spin_160
L_recurrent_scan__compressed_kv_cla__moe_arch_mod__prompt_kernel_spinx_161:
    s_branch L_recurrent_scan__compressed_kv_cla__moe_arch_mod__prompt_kernel_back_163
L_recurrent_scan__compressed_kv_cla__moe_arch_mod__prompt_kernel_rare_169:
    v_mov_b32 v20, 4048155338
    s_cmp_gt_i32 s50, 0
    s_cbranch_scc1 L_recurrent_scan__compressed_kv_cla__moe_arch_mod__prompt_kernel_mf_167
    v_cmp_gt_i32 s[20:21], 0, v18
    v_cmp_gt_i32 s[22:23], 1, v18
    v_cmp_gt_i32 s[62:63], 2, v18
    v_cmp_gt_i32 vcc, 3, v18
    v_mov_b32 v100, v20
    v_mov_b32 v101, v20
    v_mov_b32 v102, v20
    v_mov_b32 v103, v20
    v_cndmask_b32 v96, v96, v20, s[20:21]
    v_cndmask_b32 v97, v97, v20, s[22:23]
    v_cndmask_b32 v98, v98, v20, s[62:63]
    v_cndmask_b32 v99, v99, v20, vcc
    v_cndmask_b32 v108, v108, v20, s[20:21]
    v_cndmask_b32 v109, v109, v20, s[22:23]
    v_cndmask_b32 v110, v110, v20, s[62:63]
    v_cndmask_b32 v111, v111, v20, vcc
    s_branch L_recurrent_scan__compressed_kv_cla__moe_arch_mod__prompt_kernel_me_168
L_recurrent_scan__compressed_kv_cla__moe_arch_mod__prompt_kernel_mf_167:
    v_mov_b32 v96, v20
    v_mov_b32 v97, v20
    v_mov_b32 v98, v20
    v_mov_b32 v99, v20
    v_mov_b32 v100, v20
    v_mov_b32 v101, v20
    v_mov_b32 v102, v20
    v_mov_b32 v103, v20
    v_mov_b32 v104, v20
    v_mov_b32 v105, v20
    v_mov_b32 v106, v20
    v_mov_b32 v107, v20
    v_mov_b32 v108, v20
    v_mov_b32 v109, v20
    v_mov_b32 v110, v20
    v_mov_b32 v111, v20
L_recurrent_scan__compressed_kv_cla__moe_arch_mod__prompt_kernel_me_168:
    s_branch L_recurrent_scan__compressed_kv_cla__moe_arch_mod__prompt_kernel_back_170
L_p3_done:
    s_and_b32 s36, s29, 28
    s_sub_u32 s40, 47, s30
    s_lshl_b32 s40, s40, 7
    s_add_u32 s40, s40, s36
    s_add_u32 s41, s30, 32
    s_lshl_b32 s41, s41, 7
    s_add_u32 s41, s41, s36
    s_lshr_b32 s63, s29, 4
    s_lshl_b32 s36, s30, 2
    s_lshr_b32 s30, 0x76534210, s36
    s_and_b32 s30, s30, 7
    s_and_b32 s36, s30, 4
    s_add_u32 s43, s30, s36
    s_lshl_b32 s36, s63, 2
    s_add_u32 s30, s43, s36
    s_and_b32 s29, s29, 15
    s_and_b32 s36, s28, 3
    s_lshl_b32 s37, s29, 2
    s_add_u32 s36, s36, s37
    s_lshl_b32 s36, s36, 18
    s_lshr_b32 s37, s28, 2
    s_lshl_b32 s37, s37, 12
    s_add_u32 s36, s36, s37
    s_lshl_b32 s37, s63, 16
    s_add_u32 s36, s36, s37
    s_lshr_b32 s37, s28, 2
    s_lshl_b32 s37, s37, 17
    s_add_u32 s36, s36, s37
    v_lshl_add_u32 v2, v1, 4, s36
    v_xor_b32 v3, 131072, v2
    v_lshrrev_b32 v19, 4, v1
    s_lshr_b32 s36, s28, 2
    s_lshl_b32 s36, s36, 7
    s_and_b32 s37, s28, 3
    s_lshl_b32 s37, s37, 4
    s_add_u32 s36, s36, s37
    s_lshl_b32 s33, s36, 8
    s_lshl_b32 s37, s63, 11
    s_add_u32 s36, s36, s37
    v_add_u32 v18, s36, v19
    v_lshlrev_b32 v18, 11, v18
    s_lshl_b32 s36, s43, 7
    v_add_u32 v18, s36, v18
    v_lshlrev_b32 v20, 1, v19
    v_and_b32 v21, 7, v1
    v_xor_b32 v20, v20, v21
    v_lshl_add_u32 v18, v20, 4, v18
    v_and_b32 v21, 8, v1
    v_lshl_add_u32 v6, v21, 6, v18
    v_xor_b32 v21, 8, v21
    v_lshl_add_u32 v7, v21, 6, v18
    v_add_u32 v7, 7168, v7
    v_add_u32 v8, 14336, v6
    v_add_u32 v9, 14336, v7
    s_add_u32 s36, s2, 1
    s_mov_b32 s62, 0
    s_mov_b32 s31, 0
    s_mov_b32 s32, 0
    s_add_u32 s4, s54, 41943040
    s_addc_u32 s5, s55, 0
    s_and_b32 s5, s5, 0xffff
    s_mov_b32 s6, 117440640
    s_mov_b32 s7, 0x20000
    s_mov_b32 s16, s96
    s_and_b32 s17, s97, 0xffff
    s_mov_b32 s18, 4194304
    s_mov_b32 s19, 0x20000
    s_mov_b32 s20, s98
    s_and_b32 s21, s99, 0xffff
    s_mov_b32 s22, 4194304
    s_mov_b32 s23, 0x20000
    s_lshl_b32 s36, s29, 7
    s_and_b32 s37, s28, 3
    s_lshl_b32 s37, s37, 5
    s_add_u32 s36, s36, s37
    s_lshr_b32 s37, s28, 2
    s_lshl_b32 s37, s37, 4
    s_add_u32 s38, s36, s37
    v_and_b32 v63, 15, v1
    v_add_u32 v14, s38, v63
    v_lshlrev_b32 v16, 3, v14
    v_lshrrev_b32 v15, 3, v1
    v_add_u32 v15, s38, v15
    v_lshlrev_b32 v15, 11, v15
    v_and_b32 v4, 7, v1
    v_lshl_add_u32 v15, v4, 4, v15
    s_lshl_b32 s36, s30, 7
    v_add_u32 v15, s36, v15
    s_lshl_b32 s36, s28, 12
    s_add_u32 s42, s36, 131072
    v_lshl_add_u32 v63, v63, 7, s42
    v_lshl_add_u32 v63, v19, 3, v63
    v_bfe_u32 v20, v1, 2, 2
    v_lshl_add_u32 v18, v19, 2, v20
    v_and_b32 v20, 7, v18
    s_lshl_b32 s36, s63, 2
    s_xor_b32 s36, s36, 4
    v_xor_b32 v20, s36, v20
    v_lshlrev_b32 v18, 8, v18
    s_lshr_b32 s36, s28, 2
    s_lshl_b32 s36, s36, 15
    s_add_u32 s36, s36, 65536
    v_add_u32 v18, s36, v18
    v_and_b32 v21, 3, v1
    v_lshl_add_u32 v18, v21, 3, v18
    v_xor_b32 v21, 0, v20
    v_lshl_add_u32 v50, v21, 5, v18
    v_xor_b32 v21, 1, v20
    v_lshl_add_u32 v51, v21, 5, v18
    v_xor_b32 v21, 2, v20
    v_lshl_add_u32 v52, v21, 5, v18
    v_xor_b32 v21, 3, v20
    v_lshl_add_u32 v53, v21, 5, v18
    v_xor_b32 v21, 4, v20
    v_lshl_add_u32 v54, v21, 5, v18
    v_xor_b32 v21, 5, v20
    v_lshl_add_u32 v55, v21, 5, v18
    v_xor_b32 v21, 6, v20
    v_lshl_add_u32 v56, v21, 5, v18
    v_xor_b32 v21, 7, v20
    v_lshl_add_u32 v57, v21, 5, v18
    v_mov_b64 v[192:193], 0
    v_mov_b64 v[194:195], 0
    v_mov_b64 v[196:197], 0
    v_mov_b64 v[198:199], 0
    v_mov_b64 v[200:201], 0
    v_mov_b64 v[202:203], 0
    v_mov_b64 v[204:205], 0
    v_mov_b64 v[206:207], 0
    v_mov_b64 v[208:209], 0
    v_mov_b64 v[210:211], 0
    v_mov_b64 v[212:213], 0
    v_mov_b64 v[214:215], 0
    v_mov_b64 v[216:217], 0
    v_mov_b64 v[218:219], 0
    v_mov_b64 v[220:221], 0
    v_mov_b64 v[222:223], 0
    v_mov_b64 v[224:225], 0
    v_mov_b64 v[226:227], 0
    v_mov_b64 v[228:229], 0
    v_mov_b64 v[230:231], 0
    v_mov_b64 v[232:233], 0
    v_mov_b64 v[234:235], 0
    v_mov_b64 v[236:237], 0
    v_mov_b64 v[238:239], 0
    v_mov_b64 v[240:241], 0
    v_mov_b64 v[242:243], 0
    v_mov_b64 v[244:245], 0
    v_mov_b64 v[246:247], 0
    v_mov_b64 v[248:249], 0
    v_mov_b64 v[250:251], 0
    v_mov_b64 v[252:253], 0
    v_mov_b64 v[254:255], 0
    s_waitcnt vmcnt(0)
    s_barrier
    s_cmp_eq_u32 s28, 0
    s_cbranch_scc1 L_recurrent_scan__compressed_kv_cla__moe_arch_mod__prompt_kernel_rare_171
L_recurrent_scan__compressed_kv_cla__moe_arch_mod__prompt_kernel_back_172:
    s_bitcmp1_b32 0x70, s28
    s_cbranch_scc1 L_recurrent_scan__compressed_kv_cla__moe_arch_mod__prompt_kernel_f2m_193
L_recurrent_scan__compressed_kv_cla__moe_arch_mod__prompt_kernel_f2a_194:
    s_mov_b32 s34, s33
    s_add_u32 m0, s34, 65536
    s_nop 0
    buffer_load_dwordx4 v6, s[8:11], s32 offen offset:0 lds
    buffer_load_dwordx4 v7, s[8:11], s32 offen offset:1024 lds
    buffer_load_dwordx4 v8, s[8:11], s32 offen offset:2048 lds
    buffer_load_dwordx4 v9, s[8:11], s32 offen offset:3072 lds
    s_add_u32 s32, s32, 131072
    s_add_u32 m0, s34, 81920
    s_nop 0
    buffer_load_dwordx4 v6, s[8:11], s32 offen offset:0 lds
    buffer_load_dwordx4 v7, s[8:11], s32 offen offset:1024 lds
    buffer_load_dwordx4 v8, s[8:11], s32 offen offset:2048 lds
    buffer_load_dwordx4 v9, s[8:11], s32 offen offset:3072 lds
    s_add_u32 s32, s32, 393216
    s_add_u32 m0, s34, 0
    s_nop 0
    buffer_load_dwordx4 v6, s[8:11], s32 offen offset:0 lds
    buffer_load_dwordx4 v7, s[8:11], s32 offen offset:1024 lds
    buffer_load_dwordx4 v8, s[8:11], s32 offen offset:2048 lds
    buffer_load_dwordx4 v9, s[8:11], s32 offen offset:3072 lds
    s_add_u32 s32, s32, 131072
    s_cmp_lt_u32 s28, 4
    s_cbranch_scc1 L_recurrent_scan__compressed_kv_cla__moe_arch_mod__prompt_kernel_f2m_193
L_recurrent_scan__compressed_kv_cla__moe_arch_mod__prompt_kernel_f2b_195:
    s_mov_b32 s60, 31
    s_cmp_eq_u32 s28, 3
    s_cbranch_scc0 L_recurrent_scan__compressed_kv_cla__moe_arch_mod__prompt_kernel_w7j_196
    v_min_u32 v58, 3, v1
    s_lshl_b32 s36, s63, 2
    v_add_u32 v58, s36, v58
    s_add_u32 s36, s29, 32
    s_lshl_b32 s36, s36, 7
    v_lshl_add_u32 v58, v58, 2, s36
    s_mov_b32 s44, 3
    s_mov_b32 s61, 0x40000
L_recurrent_scan__compressed_kv_cla__moe_arch_mod__prompt_kernel_cspin_197:
    s_sub_u32 s61, s61, 1
    s_cbranch_scc1 L_recurrent_scan__compressed_kv_cla__moe_arch_mod__prompt_kernel_cspinx_198
    global_load_dword v59, v58, s[90:91] sc1
    s_waitcnt vmcnt(0)
L_recurrent_scan__compressed_kv_cla__moe_arch_mod__prompt_kernel_cchk_199:
    v_cmp_le_u32 vcc, 4, v59
    s_nop 0
    s_and_b32 s60, vcc_lo, 31
    s_and_b32 s36, s60, s44
    s_cmp_eq_u32 s36, s44
    s_cbranch_scc1 L_recurrent_scan__compressed_kv_cla__moe_arch_mod__prompt_kernel_cspinx_198
    s_sleep 6
    s_branch L_recurrent_scan__compressed_kv_cla__moe_arch_mod__prompt_kernel_cspin_197
L_recurrent_scan__compressed_kv_cla__moe_arch_mod__prompt_kernel_cspinx_198:
    s_lshl_b32 s44, s44, 1
    s_or_b32 s44, s44, 1
    s_and_b32 s44, s44, 31
L_recurrent_scan__compressed_kv_cla__moe_arch_mod__prompt_kernel_w7j_196:
    s_waitcnt vmcnt(8)
    s_waitcnt lgkmcnt(0)
    s_barrier
    buffer_load_dwordx4 v[128:131], v2, s[4:7], s31 offen offset:0 sc1
    buffer_load_dwordx4 v[132:135], v3, s[4:7], s31 offen offset:0 sc1
    buffer_load_dwordx4 v[136:139], v2, s[4:7], s31 offen offset:1024 sc1
    buffer_load_dwordx4 v[140:143], v3, s[4:7], s31 offen offset:1024 sc1
    buffer_load_dwordx4 v[144:147], v2, s[4:7], s31 offen offset:2048 sc1
    buffer_load_dwordx4 v[148:151], v3, s[4:7], s31 offen offset:2048 sc1
    buffer_load_dwordx4 v[152:155], v2, s[4:7], s31 offen offset:3072 sc1
    buffer_load_dwordx4 v[156:159], v3, s[4:7], s31 offen offset:3072 sc1
    s_add_u32 s31, s31, 8192
    s_cmp_lt_u32 s28, 4
    s_cbranch_scc0 L_recurrent_scan__compressed_kv_cla__moe_arch_mod__prompt_kernel_g_173
    s_lshl_b32 s36, s28, 10
    s_add_u32 s36, s36, 131072
    v_lshl_add_u32 v28, v1, 4, s36
    ds_read_b128 v[96:99], v28 offset:0
    ds_read_b128 v[100:103], v28 offset:4096
    ds_read_b128 v[104:107], v28 offset:8192
    ds_read_b128 v[108:111], v28 offset:12288
    ds_read_b128 v[112:115], v28 offset:16384
    ds_read_b128 v[116:119], v28 offset:20480
    ds_read_b128 v[120:123], v28 offset:24576
    s_lshr_b32 s36, s2, 4
    s_lshl_b32 s36, s36, 13
    s_and_b32 s37, s2, 15
    s_lshl_b32 s37, s37, 8
    s_add_u32 s36, s36, s37
    s_lshl_b32 s37, s28, 6
    s_add_u32 s36, s36, s37
    s_add_u32 s36, s36, 59768832
    v_and_b32 v28, 1, v1
    v_lshlrev_b32 v28, 12, v28
    v_lshl_add_u32 v28, v19, 4, v28
    s_waitcnt lgkmcnt(0)
    v_add_f32 v96, v96, v100
    v_add_f32 v97, v97, v101
    v_add_f32 v98, v98, v102
    v_add_f32 v99, v99, v103
    v_add_f32 v96, v96, v104
    v_add_f32 v97, v97, v105
    v_add_f32 v98, v98, v106
    v_add_f32 v99, v99, v107
    v_add_f32 v96, v96, v108
    v_add_f32 v97, v97, v109
    v_add_f32 v98, v98, v110
    v_add_f32 v99, v99, v111
    v_add_f32 v96, v96, v112
    v_add_f32 v97, v97, v113
    v_add_f32 v98, v98, v114
    v_add_f32 v99, v99, v115
    v_add_f32 v96, v96, v116
    v_add_f32 v97, v97, v117
    v_add_f32 v98, v98, v118
    v_add_f32 v99, v99, v119
    v_add_f32 v96, v96, v120
    v_add_f32 v97, v97, v121
    v_add_f32 v98, v98, v122
    v_add_f32 v99, v99, v123
    s_mov_b32 exec_lo, 0x00030003
    s_mov_b32 exec_hi, 0x00030003
    buffer_store_dwordx4 v[96:99], v28, s[24:27], s36 offen sc1
    s_mov_b64 exec, -1
    s_nop 3
L_recurrent_scan__compressed_kv_cla__moe_arch_mod__prompt_kernel_g_173:
    v_lshlrev_b32 v22, 4, v1
    v_mov_b32 v18, v22
    v_add_u32 v20, s42, v22
    v_xor_b32 v21, 16384, v20
    s_lshl_b32 s36, s2, 15
    s_lshl_b32 s37, s28, 12
    s_add_u32 s36, s36, s37
    s_add_u32 s36, s36, 67108864
    s_mov_b32 s41, s36
    s_xor_b32 s39, s36, 131072
    s_add_u32 s40, s2, 128
    s_lshl_b32 s40, s40, 7
    ds_read_b64_tr_b16 v[64:65], v50 offset:0
    ds_read_b64_tr_b16 v[66:67], v50 offset:4096
    ds_read_b64_tr_b16 v[68:69], v51 offset:0
    ds_read_b64_tr_b16 v[70:71], v51 offset:4096
    ds_read_b64_tr_b16 v[72:73], v52 offset:0
    ds_read_b64_tr_b16 v[74:75], v52 offset:4096
    ds_read_b64_tr_b16 v[76:77], v53 offset:0
    ds_read_b64_tr_b16 v[78:79], v53 offset:4096
    ds_read_b64_tr_b16 v[80:81], v54 offset:0
    ds_read_b64_tr_b16 v[82:83], v54 offset:4096
    ds_read_b64_tr_b16 v[84:85], v55 offset:0
    ds_read_b64_tr_b16 v[86:87], v55 offset:4096
    s_mov_b32 s35, 1
    s_waitcnt vmcnt(0)
    buffer_load_dwordx4 v[160:163], v2, s[4:7], s31 offen offset:0 sc1
    buffer_load_dwordx4 v[164:167], v3, s[4:7], s31 offen offset:0 sc1
    buffer_load_dwordx4 v[168:171], v2, s[4:7], s31 offen offset:1024 sc1
    buffer_load_dwordx4 v[172:175], v3, s[4:7], s31 offen offset:1024 sc1
    .p2align 6
L_p4_loop:
    s_cmp_ge_u32 s35, 2
    s_cbranch_scc1 L_recurrent_scan__compressed_kv_cla__moe_arch_mod__prompt_kernel_rare_181
L_recurrent_scan__compressed_kv_cla__moe_arch_mod__prompt_kernel_back_182:
    s_waitcnt lgkmcnt(8)
    v_mfma_f32_16x16x32_bf16 v[192:195], v[64:67], v[128:131], v[192:195]
    ds_read_b64_tr_b16 v[88:89], v56 offset:0
    buffer_load_dwordx4 v[176:179], v2, s[4:7], s31 offen offset:2048 sc1
    v_mfma_f32_16x16x32_bf16 v[224:227], v[64:67], v[132:135], v[224:227]
    ds_read_b64_tr_b16 v[90:91], v56 offset:4096
    v_mfma_f32_16x16x32_bf16 v[196:199], v[68:71], v[128:131], v[196:199]
    ds_read_b64_tr_b16 v[92:93], v57 offset:0
    v_mfma_f32_16x16x32_bf16 v[228:231], v[68:71], v[132:135], v[228:231]
    ds_read_b64_tr_b16 v[94:95], v57 offset:4096
    s_add_u32 m0, s34, 16384
    s_waitcnt lgkmcnt(8)
    v_mfma_f32_16x16x32_bf16 v[200:203], v[72:75], v[128:131], v[200:203]
    ds_read_b64_tr_b16 v[64:65], v50 offset:8192
    buffer_load_dwordx4 v6, s[8:11], s32 offen offset:0 lds
    v_mfma_f32_16x16x32_bf16 v[232:235], v[72:75], v[132:135], v[232:235]
    ds_read_b64_tr_b16 v[66:67], v50 offset:12288
    v_mfma_f32_16x16x32_bf16 v[204:207], v[76:79], v[128:131], v[204:207]
    ds_read_b64_tr_b16 v[68:69], v51 offset:8192
    v_mfma_f32_16x16x32_bf16 v[236:239], v[76:79], v[132:135], v[236:239]
    ds_read_b64_tr_b16 v[70:71], v51 offset:12288
    s_waitcnt lgkmcnt(8)
    v_mfma_f32_16x16x32_bf16 v[208:211], v[80:83], v[128:131], v[208:211]
    ds_read_b64_tr_b16 v[72:73], v52 offset:8192
    buffer_load_dwordx4 v[180:183], v3, s[4:7], s31 offen offset:2048 sc1
    v_mfma_f32_16x16x32_bf16 v[240:243], v[80:83], v[132:135], v[240:243]
    ds_read_b64_tr_b16 v[74:75], v52 offset:12288
    v_mfma_f32_16x16x32_bf16 v[212:215], v[84:87], v[128:131], v[212:215]
    ds_read_b64_tr_b16 v[76:77], v53 offset:8192
    v_mfma_f32_16x16x32_bf16 v[244:247], v[84:87], v[132:135], v[244:247]
    ds_read_b64_tr_b16 v[78:79], v53 offset:12288
    s_waitcnt lgkmcnt(8)
    v_mfma_f32_16x16x32_bf16 v[216:219], v[88:91], v[128:131], v[216:219]
    ds_read_b64_tr_b16 v[80:81], v54 offset:8192
    buffer_load_dwordx4 v7, s[8:11], s32 offen offset:1024 lds
    v_mfma_f32_16x16x32_bf16 v[248:251], v[88:91], v[132:135], v[248:251]
    ds_read_b64_tr_b16 v[82:83], v54 offset:12288
    v_mfma_f32_16x16x32_bf16 v[220:223], v[92:95], v[128:131], v[220:223]
    ds_read_b64_tr_b16 v[84:85], v55 offset:8192
    v_mfma_f32_16x16x32_bf16 v[252:255], v[92:95], v[132:135], v[252:255]
    ds_read_b64_tr_b16 v[86:87], v55 offset:12288
    s_waitcnt lgkmcnt(8)
    v_mfma_f32_16x16x32_bf16 v[192:195], v[64:67], v[136:139], v[192:195]
    ds_read_b64_tr_b16 v[88:89], v56 offset:8192
    buffer_load_dwordx4 v[184:187], v2, s[4:7], s31 offen offset:3072 sc1
    v_mfma_f32_16x16x32_bf16 v[224:227], v[64:67], v[140:143], v[224:227]
    ds_read_b64_tr_b16 v[90:91], v56 offset:12288
    v_mfma_f32_16x16x32_bf16 v[196:199], v[68:71], v[136:139], v[196:199]
    ds_read_b64_tr_b16 v[92:93], v57 offset:8192
    v_mfma_f32_16x16x32_bf16 v[228:231], v[68:71], v[140:143], v[228:231]
    ds_read_b64_tr_b16 v[94:95], v57 offset:12288
    buffer_load_dwordx4 v8, s[8:11], s32 offen offset:2048 lds
    s_waitcnt lgkmcnt(8)
    v_mfma_f32_16x16x32_bf16 v[200:203], v[72:75], v[136:139], v[200:203]
    v_mfma_f32_16x16x32_bf16 v[232:235], v[72:75], v[140:143], v[232:235]
    v_mfma_f32_16x16x32_bf16 v[204:207], v[76:79], v[136:139], v[204:207]
    buffer_load_dwordx4 v[188:191], v3, s[4:7], s31 offen offset:3072 sc1
    s_add_u32 s31, s31, 8192
    v_mfma_f32_16x16x32_bf16 v[236:239], v[76:79], v[140:143], v[236:239]
    s_waitcnt lgkmcnt(0)
    s_waitcnt vmcnt(15)
    s_barrier
    v_mfma_f32_16x16x32_bf16 v[208:211], v[80:83], v[136:139], v[208:211]
    ds_read_b64_tr_b16 v[64:65], v50 offset:16384
    ds_read_b64_tr_b16 v[66:67], v50 offset:20480
    v_mfma_f32_16x16x32_bf16 v[240:243], v[80:83], v[140:143], v[240:243]
    ds_read_b64_tr_b16 v[68:69], v51 offset:16384
    ds_read_b64_tr_b16 v[70:71], v51 offset:20480
    v_mfma_f32_16x16x32_bf16 v[212:215], v[84:87], v[136:139], v[212:215]
    ds_read_b64_tr_b16 v[72:73], v52 offset:16384
    ds_read_b64_tr_b16 v[74:75], v52 offset:20480
    v_mfma_f32_16x16x32_bf16 v[244:247], v[84:87], v[140:143], v[244:247]
    ds_read_b64_tr_b16 v[76:77], v53 offset:16384
    ds_read_b64_tr_b16 v[78:79], v53 offset:20480
    v_mfma_f32_16x16x32_bf16 v[216:219], v[88:91], v[136:139], v[216:219]
    ds_read_b64_tr_b16 v[80:81], v54 offset:16384
    ds_read_b64_tr_b16 v[82:83], v54 offset:20480
    buffer_load_dwordx4 v9, s[8:11], s32 offen offset:3072 lds
    v_mfma_f32_16x16x32_bf16 v[248:251], v[88:91], v[140:143], v[248:251]
    s_add_u32 s32, s32, 393216
    v_mfma_f32_16x16x32_bf16 v[220:223], v[92:95], v[136:139], v[220:223]
    ds_read_b64_tr_b16 v[84:85], v55 offset:16384
    ds_read_b64_tr_b16 v[86:87], v55 offset:20480
    v_mfma_f32_16x16x32_bf16 v[252:255], v[92:95], v[140:143], v[252:255]
    s_waitcnt lgkmcnt(8)
    v_mfma_f32_16x16x32_bf16 v[192:195], v[64:67], v[144:147], v[192:195]
    ds_read_b64_tr_b16 v[88:89], v56 offset:16384
    buffer_load_dwordx4 v[128:131], v2, s[4:7], s31 offen offset:0 sc1
    v_mfma_f32_16x16x32_bf16 v[224:227], v[64:67], v[148:151], v[224:227]
    ds_read_b64_tr_b16 v[90:91], v56 offset:20480
    v_mfma_f32_16x16x32_bf16 v[196:199], v[68:71], v[144:147], v[196:199]
    ds_read_b64_tr_b16 v[92:93], v57 offset:16384
    v_mfma_f32_16x16x32_bf16 v[228:231], v[68:71], v[148:151], v[228:231]
    ds_read_b64_tr_b16 v[94:95], v57 offset:20480
    s_add_u32 m0, s34, 65536
    s_waitcnt lgkmcnt(8)
    v_mfma_f32_16x16x32_bf16 v[200:203], v[72:75], v[144:147], v[200:203]
    ds_read_b64_tr_b16 v[64:65], v50 offset:24576
    buffer_load_dwordx4 v6, s[8:11], s32 offen offset:0 lds
    v_mfma_f32_16x16x32_bf16 v[232:235], v[72:75], v[148:151], v[232:235]
    ds_read_b64_tr_b16 v[66:67], v50 offset:28672
    v_xor_b32 v50, 65536, v50
    v_mfma_f32_16x16x32_bf16 v[204:207], v[76:79], v[144:147], v[204:207]
    ds_read_b64_tr_b16 v[68:69], v51 offset:24576
    v_mfma_f32_16x16x32_bf16 v[236:239], v[76:79], v[148:151], v[236:239]
    ds_read_b64_tr_b16 v[70:71], v51 offset:28672
    v_xor_b32 v51, 65536, v51
    s_waitcnt lgkmcnt(8)
    v_mfma_f32_16x16x32_bf16 v[208:211], v[80:83], v[144:147], v[208:211]
    ds_read_b64_tr_b16 v[72:73], v52 offset:24576
    buffer_load_dwordx4 v[132:135], v3, s[4:7], s31 offen offset:0 sc1
    v_mfma_f32_16x16x32_bf16 v[240:243], v[80:83], v[148:151], v[240:243]
    ds_read_b64_tr_b16 v[74:75], v52 offset:28672
    v_xor_b32 v52, 65536, v52
    v_mfma_f32_16x16x32_bf16 v[212:215], v[84:87], v[144:147], v[212:215]
    ds_read_b64_tr_b16 v[76:77], v53 offset:24576
    v_mfma_f32_16x16x32_bf16 v[244:247], v[84:87], v[148:151], v[244:247]
    ds_read_b64_tr_b16 v[78:79], v53 offset:28672
    v_xor_b32 v53, 65536, v53
    s_waitcnt lgkmcnt(8)
    v_mfma_f32_16x16x32_bf16 v[216:219], v[88:91], v[144:147], v[216:219]
    ds_read_b64_tr_b16 v[80:81], v54 offset:24576
    buffer_load_dwordx4 v7, s[8:11], s32 offen offset:1024 lds
    v_mfma_f32_16x16x32_bf16 v[248:251], v[88:91], v[148:151], v[248:251]
    ds_read_b64_tr_b16 v[82:83], v54 offset:28672
    v_xor_b32 v54, 65536, v54
    v_mfma_f32_16x16x32_bf16 v[220:223], v[92:95], v[144:147], v[220:223]
    ds_read_b64_tr_b16 v[84:85], v55 offset:24576
    v_mfma_f32_16x16x32_bf16 v[252:255], v[92:95], v[148:151], v[252:255]
    ds_read_b64_tr_b16 v[86:87], v55 offset:28672
    v_xor_b32 v55, 65536, v55
    s_waitcnt lgkmcnt(8)
    v_mfma_f32_16x16x32_bf16 v[192:195], v[64:67], v[152:155], v[192:195]
    ds_read_b64_tr_b16 v[88:89], v56 offset:24576
    buffer_load_dwordx4 v[136:139], v2, s[4:7], s31 offen offset:1024 sc1
    v_mfma_f32_16x16x32_bf16 v[224:227], v[64:67], v[156:159], v[224:227]
    ds_read_b64_tr_b16 v[90:91], v56 offset:28672
    v_xor_b32 v56, 65536, v56
    v_mfma_f32_16x16x32_bf16 v[196:199], v[68:71], v[152:155], v[196:199]
    ds_read_b64_tr_b16 v[92:93], v57 offset:24576
    v_mfma_f32_16x16x32_bf16 v[228:231], v[68:71], v[156:159], v[228:231]
    ds_read_b64_tr_b16 v[94:95], v57 offset:28672
    v_xor_b32 v57, 65536, v57
    buffer_load_dwordx4 v8, s[8:11], s32 offen offset:2048 lds
    s_waitcnt lgkmcnt(8)
    v_mfma_f32_16x16x32_bf16 v[200:203], v[72:75], v[152:155], v[200:203]
    v_mfma_f32_16x16x32_bf16 v[232:235], v[72:75], v[156:159], v[232:235]
    v_mfma_f32_16x16x32_bf16 v[204:207], v[76:79], v[152:155], v[204:207]
    buffer_load_dwordx4 v[140:143], v3, s[4:7], s31 offen offset:1024 sc1
    v_mfma_f32_16x16x32_bf16 v[236:239], v[76:79], v[156:159], v[236:239]
    s_waitcnt lgkmcnt(0)
    s_waitcnt vmcnt(15)
    s_barrier
    v_mfma_f32_16x16x32_bf16 v[208:211], v[80:83], v[152:155], v[208:211]
    ds_read_b64_tr_b16 v[64:65], v50 offset:0
    ds_read_b64_tr_b16 v[66:67], v50 offset:4096
    v_mfma_f32_16x16x32_bf16 v[240:243], v[80:83], v[156:159], v[240:243]
    ds_read_b64_tr_b16 v[68:69], v51 offset:0
    ds_read_b64_tr_b16 v[70:71], v51 offset:4096
    v_mfma_f32_16x16x32_bf16 v[212:215], v[84:87], v[152:155], v[212:215]
    ds_read_b64_tr_b16 v[72:73], v52 offset:0
    ds_read_b64_tr_b16 v[74:75], v52 offset:4096
    v_mfma_f32_16x16x32_bf16 v[244:247], v[84:87], v[156:159], v[244:247]
    ds_read_b64_tr_b16 v[76:77], v53 offset:0
    ds_read_b64_tr_b16 v[78:79], v53 offset:4096
    v_mfma_f32_16x16x32_bf16 v[216:219], v[88:91], v[152:155], v[216:219]
    ds_read_b64_tr_b16 v[80:81], v54 offset:0
    ds_read_b64_tr_b16 v[82:83], v54 offset:4096
    buffer_load_dwordx4 v9, s[8:11], s32 offen offset:3072 lds
    v_mfma_f32_16x16x32_bf16 v[248:251], v[88:91], v[156:159], v[248:251]
    s_add_u32 s32, s32, 131072
    v_mfma_f32_16x16x32_bf16 v[220:223], v[92:95], v[152:155], v[220:223]
    ds_read_b64_tr_b16 v[84:85], v55 offset:0
    ds_read_b64_tr_b16 v[86:87], v55 offset:4096
    v_mfma_f32_16x16x32_bf16 v[252:255], v[92:95], v[156:159], v[252:255]
L_p4_mid:
    s_cmp_eq_u32 s35, 3
    s_cbranch_scc1 L_recurrent_scan__compressed_kv_cla__moe_arch_mod__prompt_kernel_rare_184
L_recurrent_scan__compressed_kv_cla__moe_arch_mod__prompt_kernel_back_185:
    s_waitcnt lgkmcnt(8)
    s_waitcnt vmcnt(18)
    v_mfma_f32_16x16x32_bf16 v[192:195], v[64:67], v[160:163], v[192:195]
    ds_read_b64_tr_b16 v[88:89], v56 offset:0
    buffer_load_dwordx4 v[144:147], v2, s[4:7], s31 offen offset:2048 sc1
    v_mfma_f32_16x16x32_bf16 v[224:227], v[64:67], v[164:167], v[224:227]
    ds_read_b64_tr_b16 v[90:91], v56 offset:4096
    v_mfma_f32_16x16x32_bf16 v[196:199], v[68:71], v[160:163], v[196:199]
    ds_read_b64_tr_b16 v[92:93], v57 offset:0
    v_mfma_f32_16x16x32_bf16 v[228:231], v[68:71], v[164:167], v[228:231]
    ds_read_b64_tr_b16 v[94:95], v57 offset:4096
    s_add_u32 m0, s34, 81920
    s_waitcnt lgkmcnt(8)
    v_mfma_f32_16x16x32_bf16 v[200:203], v[72:75], v[160:163], v[200:203]
    ds_read_b64_tr_b16 v[64:65], v50 offset:8192
    buffer_load_dwordx4 v6, s[8:11], s32 offen offset:0 lds
    v_mfma_f32_16x16x32_bf16 v[232:235], v[72:75], v[164:167], v[232:235]
    ds_read_b64_tr_b16 v[66:67], v50 offset:12288
    v_mfma_f32_16x16x32_bf16 v[204:207], v[76:79], v[160:163], v[204:207]
    ds_read_b64_tr_b16 v[68:69], v51 offset:8192
    v_mfma_f32_16x16x32_bf16 v[236:239], v[76:79], v[164:167], v[236:239]
    ds_read_b64_tr_b16 v[70:71], v51 offset:12288
    s_waitcnt lgkmcnt(8)
    v_mfma_f32_16x16x32_bf16 v[208:211], v[80:83], v[160:163], v[208:211]
    ds_read_b64_tr_b16 v[72:73], v52 offset:8192
    buffer_load_dwordx4 v[148:151], v3, s[4:7], s31 offen offset:2048 sc1
    v_mfma_f32_16x16x32_bf16 v[240:243], v[80:83], v[164:167], v[240:243]
    ds_read_b64_tr_b16 v[74:75], v52 offset:12288
    v_mfma_f32_16x16x32_bf16 v[212:215], v[84:87], v[160:163], v[212:215]
    ds_read_b64_tr_b16 v[76:77], v53 offset:8192
    v_mfma_f32_16x16x32_bf16 v[244:247], v[84:87], v[164:167], v[244:247]
    ds_read_b64_tr_b16 v[78:79], v53 offset:12288
    s_waitcnt lgkmcnt(8)
    v_mfma_f32_16x16x32_bf16 v[216:219], v[88:91], v[160:163], v[216:219]
    ds_read_b64_tr_b16 v[80:81], v54 offset:8192
    buffer_load_dwordx4 v7, s[8:11], s32 offen offset:1024 lds
    v_mfma_f32_16x16x32_bf16 v[248:251], v[88:91], v[164:167], v[248:251]
    ds_read_b64_tr_b16 v[82:83], v54 offset:12288
    v_mfma_f32_16x16x32_bf16 v[220:223], v[92:95], v[160:163], v[220:223]
    ds_read_b64_tr_b16 v[84:85], v55 offset:8192
    v_mfma_f32_16x16x32_bf16 v[252:255], v[92:95], v[164:167], v[252:255]
    ds_read_b64_tr_b16 v[86:87], v55 offset:12288
    s_waitcnt lgkmcnt(8)
    s_waitcnt vmcnt(20)
    v_mfma_f32_16x16x32_bf16 v[192:195], v[64:67], v[168:171], v[192:195]
    ds_read_b64_tr_b16 v[88:89], v56 offset:8192
    buffer_load_dwordx4 v[152:155], v2, s[4:7], s31 offen offset:3072 sc1
    v_mfma_f32_16x16x32_bf16 v[224:227], v[64:67], v[172:175], v[224:227]
    ds_read_b64_tr_b16 v[90:91], v56 offset:12288
    v_mfma_f32_16x16x32_bf16 v[196:199], v[68:71], v[168:171], v[196:199]
    ds_read_b64_tr_b16 v[92:93], v57 offset:8192
    v_mfma_f32_16x16x32_bf16 v[228:231], v[68:71], v[172:175], v[228:231]
    ds_read_b64_tr_b16 v[94:95], v57 offset:12288
    buffer_load_dwordx4 v8, s[8:11], s32 offen offset:2048 lds
    s_waitcnt lgkmcnt(8)
    v_mfma_f32_16x16x32_bf16 v[200:203], v[72:75], v[168:171], v[200:203]
    v_mfma_f32_16x16x32_bf16 v[232:235], v[72:75], v[172:175], v[232:235]
    v_mfma_f32_16x16x32_bf16 v[204:207], v[76:79], v[168:171], v[204:207]
    buffer_load_dwordx4 v[156:159], v3, s[4:7], s31 offen offset:3072 sc1
    s_add_u32 s31, s31, 8192
    v_mfma_f32_16x16x32_bf16 v[236:239], v[76:79], v[172:175], v[236:239]
    s_cmp_lt_u32 s60, 31
    s_cbranch_scc1 L_recurrent_scan__compressed_kv_cla__moe_arch_mod__prompt_kernel_rare_186
L_recurrent_scan__compressed_kv_cla__moe_arch_mod__prompt_kernel_back_187:
    s_waitcnt lgkmcnt(0)
    s_waitcnt vmcnt(15)
    s_barrier
    v_mfma_f32_16x16x32_bf16 v[208:211], v[80:83], v[168:171], v[208:211]
    ds_read_b64_tr_b16 v[64:65], v50 offset:16384
    ds_read_b64_tr_b16 v[66:67], v50 offset:20480
    v_mfma_f32_16x16x32_bf16 v[240:243], v[80:83], v[172:175], v[240:243]
    ds_read_b64_tr_b16 v[68:69], v51 offset:16384
    ds_read_b64_tr_b16 v[70:71], v51 offset:20480
    v_mfma_f32_16x16x32_bf16 v[212:215], v[84:87], v[168:171], v[212:215]
    ds_read_b64_tr_b16 v[72:73], v52 offset:16384
    ds_read_b64_tr_b16 v[74:75], v52 offset:20480
    v_mfma_f32_16x16x32_bf16 v[244:247], v[84:87], v[172:175], v[244:247]
    ds_read_b64_tr_b16 v[76:77], v53 offset:16384
    ds_read_b64_tr_b16 v[78:79], v53 offset:20480
    v_mfma_f32_16x16x32_bf16 v[216:219], v[88:91], v[168:171], v[216:219]
    ds_read_b64_tr_b16 v[80:81], v54 offset:16384
    ds_read_b64_tr_b16 v[82:83], v54 offset:20480
    buffer_load_dwordx4 v9, s[8:11], s32 offen offset:3072 lds
    v_mfma_f32_16x16x32_bf16 v[248:251], v[88:91], v[172:175], v[248:251]
    s_add_u32 s32, s32, 393216
    v_mfma_f32_16x16x32_bf16 v[220:223], v[92:95], v[168:171], v[220:223]
    ds_read_b64_tr_b16 v[84:85], v55 offset:16384
    ds_read_b64_tr_b16 v[86:87], v55 offset:20480
    v_mfma_f32_16x16x32_bf16 v[252:255], v[92:95], v[172:175], v[252:255]
    s_waitcnt lgkmcnt(8)
    v_mfma_f32_16x16x32_bf16 v[192:195], v[64:67], v[176:179], v[192:195]
    ds_read_b64_tr_b16 v[88:89], v56 offset:16384
    buffer_load_dwordx4 v[160:163], v2, s[4:7], s31 offen offset:0 sc1
    v_mfma_f32_16x16x32_bf16 v[224:227], v[64:67], v[180:183], v[224:227]
    ds_read_b64_tr_b16 v[90:91], v56 offset:20480
    v_mfma_f32_16x16x32_bf16 v[196:199], v[68:71], v[176:179], v[196:199]
    ds_read_b64_tr_b16 v[92:93], v57 offset:16384
    v_mfma_f32_16x16x32_bf16 v[228:231], v[68:71], v[180:183], v[228:231]
    ds_read_b64_tr_b16 v[94:95], v57 offset:20480
    s_add_u32 m0, s34, 0
    s_waitcnt lgkmcnt(8)
    v_mfma_f32_16x16x32_bf16 v[200:203], v[72:75], v[176:179], v[200:203]
    ds_read_b64_tr_b16 v[64:65], v50 offset:24576
    buffer_load_dwordx4 v6, s[8:11], s32 offen offset:0 lds
    v_mfma_f32_16x16x32_bf16 v[232:235], v[72:75], v[180:183], v[232:235]
    ds_read_b64_tr_b16 v[66:67], v50 offset:28672
    v_xor_b32 v50, 65536, v50
    v_mfma_f32_16x16x32_bf16 v[204:207], v[76:79], v[176:179], v[204:207]
    ds_read_b64_tr_b16 v[68:69], v51 offset:24576
    v_mfma_f32_16x16x32_bf16 v[236:239], v[76:79], v[180:183], v[236:239]
    ds_read_b64_tr_b16 v[70:71], v51 offset:28672
    v_xor_b32 v51, 65536, v51
    s_waitcnt lgkmcnt(8)
    v_mfma_f32_16x16x32_bf16 v[208:211], v[80:83], v[176:179], v[208:211]
    ds_read_b64_tr_b16 v[72:73], v52 offset:24576
    buffer_load_dwordx4 v[164:167], v3, s[4:7], s31 offen offset:0 sc1
    v_mfma_f32_16x16x32_bf16 v[240:243], v[80:83], v[180:183], v[240:243]
    ds_read_b64_tr_b16 v[74:75], v52 offset:28672
    v_xor_b32 v52, 65536, v52
    v_mfma_f32_16x16x32_bf16 v[212:215], v[84:87], v[176:179], v[212:215]
    ds_read_b64_tr_b16 v[76:77], v53 offset:24576
    v_mfma_f32_16x16x32_bf16 v[244:247], v[84:87], v[180:183], v[244:247]
    ds_read_b64_tr_b16 v[78:79], v53 offset:28672
    v_xor_b32 v53, 65536, v53
    s_waitcnt lgkmcnt(8)
    v_mfma_f32_16x16x32_bf16 v[216:219], v[88:91], v[176:179], v[216:219]
    ds_read_b64_tr_b16 v[80:81], v54 offset:24576
    buffer_load_dwordx4 v7, s[8:11], s32 offen offset:1024 lds
    v_mfma_f32_16x16x32_bf16 v[248:251], v[88:91], v[180:183], v[248:251]
    ds_read_b64_tr_b16 v[82:83], v54 offset:28672
    v_xor_b32 v54, 65536, v54
    v_mfma_f32_16x16x32_bf16 v[220:223], v[92:95], v[176:179], v[220:223]
    ds_read_b64_tr_b16 v[84:85], v55 offset:24576
    v_mfma_f32_16x16x32_bf16 v[252:255], v[92:95], v[180:183], v[252:255]
    ds_read_b64_tr_b16 v[86:87], v55 offset:28672
    v_xor_b32 v55, 65536, v55
    s_waitcnt lgkmcnt(8)
    v_mfma_f32_16x16x32_bf16 v[192:195], v[64:67], v[184:187], v[192:195]
    ds_read_b64_tr_b16 v[88:89], v56 offset:24576
    buffer_load_dwordx4 v[168:171], v2, s[4:7], s31 offen offset:1024 sc1
    v_mfma_f32_16x16x32_bf16 v[224:227], v[64:67], v[188:191], v[224:227]
    ds_read_b64_tr_b16 v[90:91], v56 offset:28672
    v_xor_b32 v56, 65536, v56
    v_mfma_f32_16x16x32_bf16 v[196:199], v[68:71], v[184:187], v[196:199]
    ds_read_b64_tr_b16 v[92:93], v57 offset:24576
    v_mfma_f32_16x16x32_bf16 v[228:231], v[68:71], v[188:191], v[228:231]
    ds_read_b64_tr_b16 v[94:95], v57 offset:28672
    v_xor_b32 v57, 65536, v57
    buffer_load_dwordx4 v8, s[8:11], s32 offen offset:2048 lds
    s_waitcnt lgkmcnt(8)
    v_mfma_f32_16x16x32_bf16 v[200:203], v[72:75], v[184:187], v[200:203]
    v_mfma_f32_16x16x32_bf16 v[232:235], v[72:75], v[188:191], v[232:235]
    v_mfma_f32_16x16x32_bf16 v[204:207], v[76:79], v[184:187], v[204:207]
    buffer_load_dwordx4 v[172:175], v3, s[4:7], s31 offen offset:1024 sc1
    v_mfma_f32_16x16x32_bf16 v[236:239], v[76:79], v[188:191], v[236:239]
    s_cmp_lt_u32 s60, 31
    s_cbranch_scc1 L_recurrent_scan__compressed_kv_cla__moe_arch_mod__prompt_kernel_rare_191
L_recurrent_scan__compressed_kv_cla__moe_arch_mod__prompt_kernel_back_192:
    s_waitcnt lgkmcnt(0)
    s_waitcnt vmcnt(15)
    s_barrier
    v_mfma_f32_16x16x32_bf16 v[208:211], v[80:83], v[184:187], v[208:211]
    ds_read_b64_tr_b16 v[64:65], v50 offset:0
    ds_read_b64_tr_b16 v[66:67], v50 offset:4096
    v_mfma_f32_16x16x32_bf16 v[240:243], v[80:83], v[188:191], v[240:243]
    ds_read_b64_tr_b16 v[68:69], v51 offset:0
    ds_read_b64_tr_b16 v[70:71], v51 offset:4096
    v_mfma_f32_16x16x32_bf16 v[212:215], v[84:87], v[184:187], v[212:215]
    ds_read_b64_tr_b16 v[72:73], v52 offset:0
    ds_read_b64_tr_b16 v[74:75], v52 offset:4096
    v_mfma_f32_16x16x32_bf16 v[244:247], v[84:87], v[188:191], v[244:247]
    ds_read_b64_tr_b16 v[76:77], v53 offset:0
    ds_read_b64_tr_b16 v[78:79], v53 offset:4096
    v_mfma_f32_16x16x32_bf16 v[216:219], v[88:91], v[184:187], v[216:219]
    ds_read_b64_tr_b16 v[80:81], v54 offset:0
    ds_read_b64_tr_b16 v[82:83], v54 offset:4096
    buffer_load_dwordx4 v9, s[8:11], s32 offen offset:3072 lds
    v_mfma_f32_16x16x32_bf16 v[248:251], v[88:91], v[188:191], v[248:251]
    s_add_u32 s32, s32, 131072
    v_mfma_f32_16x16x32_bf16 v[220:223], v[92:95], v[184:187], v[220:223]
    ds_read_b64_tr_b16 v[84:85], v55 offset:0
    ds_read_b64_tr_b16 v[86:87], v55 offset:4096
    v_mfma_f32_16x16x32_bf16 v[252:255], v[92:95], v[188:191], v[252:255]
    s_add_u32 s35, s35, 1
    s_cmp_lt_u32 s35, 4
    s_cbranch_scc1 L_p4_loop
    s_sub_u32 s36, s56, s38
    s_sub_u32 s37, s57, s38
    s_min_u32 s36, s36, s37
    s_cmp_lt_u32 s36, 16
    s_cbranch_scc1 L_recurrent_scan__compressed_kv_cla__moe_arch_mod__prompt_kernel_rare_200
L_recurrent_scan__compressed_kv_cla__moe_arch_mod__prompt_kernel_back_201:
    s_xor_b32 s37, s40, 512
    v_mov_b32 v5, s37
    s_waitcnt vmcnt(16)
    ds_read_b64 v[40:41], v63 offset:0
    ds_read_b64 v[42:43], v63 offset:32
    ds_read_b64 v[44:45], v63 offset:64
    ds_read_b64 v[46:47], v63 offset:96
    s_waitcnt lgkmcnt(12)
    v_mfma_f32_16x16x32_bf16 v[192:195], v[64:67], v[128:131], v[192:195]
    ds_read_b64_tr_b16 v[88:89], v56 offset:0
    s_add_u32 m0, s34, 16384
    v_mfma_f32_16x16x32_bf16 v[224:227], v[64:67], v[132:135], v[224:227]
    ds_read_b64_tr_b16 v[90:91], v56 offset:4096
    v_mfma_f32_16x16x32_bf16 v[196:199], v[68:71], v[128:131], v[196:199]
    ds_read_b64_tr_b16 v[92:93], v57 offset:0
    v_mfma_f32_16x16x32_bf16 v[228:231], v[68:71], v[132:135], v[228:231]
    ds_read_b64_tr_b16 v[94:95], v57 offset:4096
    buffer_load_dwordx4 v6, s[8:11], s32 offen offset:0 lds
    s_waitcnt lgkmcnt(12)
    v_mfma_f32_16x16x32_bf16 v[200:203], v[72:75], v[128:131], v[200:203]
    ds_read_b64_tr_b16 v[64:65], v50 offset:8192
    v_mfma_f32_16x16x32_bf16 v[232:235], v[72:75], v[132:135], v[232:235]
    ds_read_b64_tr_b16 v[66:67], v50 offset:12288
    v_mfma_f32_16x16x32_bf16 v[204:207], v[76:79], v[128:131], v[204:207]
    ds_read_b64_tr_b16 v[68:69], v51 offset:8192
    buffer_load_dwordx4 v7, s[8:11], s32 offen offset:1024 lds
    v_mfma_f32_16x16x32_bf16 v[236:239], v[76:79], v[132:135], v[236:239]
    ds_read_b64_tr_b16 v[70:71], v51 offset:12288
    s_waitcnt lgkmcnt(12)
    s_waitcnt lgkmcnt(8)
    v_mfma_f32_16x16x32_bf16 v[208:211], v[80:83], v[128:131], v[208:211]
    ds_read_b64_tr_b16 v[72:73], v52 offset:8192
    v_mfma_f32_16x16x32_bf16 v[240:243], v[80:83], v[132:135], v[240:243]
    ds_read_b64_tr_b16 v[74:75], v52 offset:12288
    buffer_load_dwordx4 v8, s[8:11], s32 offen offset:2048 lds
    v_mfma_f32_16x16x32_bf16 v[212:215], v[84:87], v[128:131], v[212:215]
    ds_read_b64_tr_b16 v[76:77], v53 offset:8192
    v_mfma_f32_16x16x32_bf16 v[244:247], v[84:87], v[132:135], v[244:247]
    ds_read_b64_tr_b16 v[78:79], v53 offset:12288
    s_waitcnt vmcnt(11)
    s_barrier
    s_waitcnt lgkmcnt(8)
    v_mfma_f32_16x16x32_bf16 v[216:219], v[88:91], v[128:131], v[216:219]
    ds_read_b64_tr_b16 v[80:81], v50 offset:16384
    buffer_load_dwordx4 v9, s[8:11], s32 offen offset:3072 lds
    v_mfma_f32_16x16x32_bf16 v[248:251], v[88:91], v[132:135], v[248:251]
    ds_read_b64_tr_b16 v[82:83], v50 offset:20480
    v_mfma_f32_16x16x32_bf16 v[220:223], v[92:95], v[128:131], v[220:223]
    ds_read_b64_tr_b16 v[84:85], v51 offset:16384
    v_mfma_f32_16x16x32_bf16 v[252:255], v[92:95], v[132:135], v[252:255]
    ds_read_b64_tr_b16 v[86:87], v51 offset:20480
    buffer_load_dwordx4 v[176:179], v2, s[4:7], s31 offen offset:2048 sc1
    s_waitcnt lgkmcnt(8)
    v_mfma_f32_16x16x32_bf16 v[192:195], v[64:67], v[136:139], v[192:195]
    ds_read_b64_tr_b16 v[88:89], v52 offset:16384
    v_mfma_f32_16x16x32_bf16 v[224:227], v[64:67], v[140:143], v[224:227]
    ds_read_b64_tr_b16 v[90:91], v52 offset:20480
    v_mfma_f32_16x16x32_bf16 v[196:199], v[68:71], v[136:139], v[196:199]
    ds_read_b64_tr_b16 v[92:93], v53 offset:16384
    buffer_load_dwordx4 v[180:183], v3, s[4:7], s31 offen offset:2048 sc1
    v_mfma_f32_16x16x32_bf16 v[228:231], v[68:71], v[140:143], v[228:231]
    ds_read_b64_tr_b16 v[94:95], v53 offset:20480
    s_waitcnt lgkmcnt(8)
    v_mfma_f32_16x16x32_bf16 v[200:203], v[72:75], v[136:139], v[200:203]
    ds_read_b64_tr_b16 v[64:65], v50 offset:24576
    v_mfma_f32_16x16x32_bf16 v[232:235], v[72:75], v[140:143], v[232:235]
    ds_read_b64_tr_b16 v[66:67], v50 offset:28672
    v_xor_b32 v50, 65536, v50
    buffer_load_dwordx4 v[184:187], v2, s[4:7], s31 offen offset:3072 sc1
    v_mfma_f32_16x16x32_bf16 v[204:207], v[76:79], v[136:139], v[204:207]
    ds_read_b64_tr_b16 v[68:69], v51 offset:24576
    v_mfma_f32_16x16x32_bf16 v[236:239], v[76:79], v[140:143], v[236:239]
    ds_read_b64_tr_b16 v[70:71], v51 offset:28672
    v_xor_b32 v51, 65536, v51
    s_waitcnt lgkmcnt(8)
    v_mfma_f32_16x16x32_bf16 v[192:195], v[80:83], v[144:147], v[192:195]
    ds_read_b64_tr_b16 v[72:73], v52 offset:24576
    buffer_load_dwordx4 v[188:191], v3, s[4:7], s31 offen offset:3072 sc1
    v_mfma_f32_16x16x32_bf16 v[224:227], v[80:83], v[148:151], v[224:227]
    ds_read_b64_tr_b16 v[74:75], v52 offset:28672
    v_xor_b32 v52, 65536, v52
    v_mfma_f32_16x16x32_bf16 v[196:199], v[84:87], v[144:147], v[196:199]
    ds_read_b64_tr_b16 v[76:77], v53 offset:24576
    v_mfma_f32_16x16x32_bf16 v[228:231], v[84:87], v[148:151], v[228:231]
    ds_read_b64_tr_b16 v[78:79], v53 offset:28672
    v_xor_b32 v53, 65536, v53
    s_waitcnt vmcnt(8)
    s_barrier
    s_waitcnt lgkmcnt(8)
    v_mfma_f32_16x16x32_bf16 v[200:203], v[88:91], v[144:147], v[200:203]
    ds_read_b64_tr_b16 v[80:81], v50 offset:0
    v_mfma_f32_16x16x32_bf16 v[232:235], v[88:91], v[148:151], v[232:235]
    ds_read_b64_tr_b16 v[82:83], v50 offset:4096
    v_mfma_f32_16x16x32_bf16 v[204:207], v[92:95], v[144:147], v[204:207]
    ds_read_b64_tr_b16 v[84:85], v51 offset:0
    v_mfma_f32_16x16x32_bf16 v[236:239], v[92:95], v[148:151], v[236:239]
    ds_read_b64_tr_b16 v[86:87], v51 offset:4096
    s_waitcnt lgkmcnt(8)
    v_mfma_f32_16x16x32_bf16 v[192:195], v[64:67], v[152:155], v[192:195]
    ds_read_b64_tr_b16 v[88:89], v52 offset:0
    v_mfma_f32_16x16x32_bf16 v[224:227], v[64:67], v[156:159], v[224:227]
    ds_read_b64_tr_b16 v[90:91], v52 offset:4096
    v_mfma_f32_16x16x32_bf16 v[196:199], v[68:71], v[152:155], v[196:199]
    ds_read_b64_tr_b16 v[92:93], v53 offset:0
    v_mfma_f32_16x16x32_bf16 v[228:231], v[68:71], v[156:159], v[228:231]
    ds_read_b64_tr_b16 v[94:95], v53 offset:4096
    s_waitcnt lgkmcnt(8)
    v_mfma_f32_16x16x32_bf16 v[200:203], v[72:75], v[152:155], v[200:203]
    ds_read_b64_tr_b16 v[64:65], v50 offset:8192
    v_mfma_f32_16x16x32_bf16 v[232:235], v[72:75], v[156:159], v[232:235]
    ds_read_b64_tr_b16 v[66:67], v50 offset:12288
    v_mfma_f32_16x16x32_bf16 v[204:207], v[76:79], v[152:155], v[204:207]
    ds_read_b64_tr_b16 v[68:69], v51 offset:8192
    v_mfma_f32_16x16x32_bf16 v[236:239], v[76:79], v[156:159], v[236:239]
    ds_read_b64_tr_b16 v[70:71], v51 offset:12288
    s_waitcnt lgkmcnt(8)
    v_mfma_f32_16x16x32_bf16 v[192:195], v[80:83], v[160:163], v[192:195]
    ds_read_b64_tr_b16 v[72:73], v52 offset:8192
    v_mfma_f32_16x16x32_bf16 v[224:227], v[80:83], v[164:167], v[224:227]
    ds_read_b64_tr_b16 v[74:75], v52 offset:12288
    v_mfma_f32_16x16x32_bf16 v[196:199], v[84:87], v[160:163], v[196:199]
    ds_read_b64_tr_b16 v[76:77], v53 offset:8192
    v_mfma_f32_16x16x32_bf16 v[228:231], v[84:87], v[164:167], v[228:231]
    ds_read_b64_tr_b16 v[78:79], v53 offset:12288
    s_waitcnt vmcnt(4)
    s_barrier
    s_waitcnt lgkmcnt(8)
    v_mfma_f32_16x16x32_bf16 v[200:203], v[88:91], v[160:163], v[200:203]
    ds_read_b64_tr_b16 v[80:81], v50 offset:16384
    v_mfma_f32_16x16x32_bf16 v[232:235], v[88:91], v[164:167], v[232:235]
    ds_read_b64_tr_b16 v[82:83], v50 offset:20480
    v_mfma_f32_16x16x32_bf16 v[204:207], v[92:95], v[160:163], v[204:207]
    ds_read_b64_tr_b16 v[84:85], v51 offset:16384
    v_mfma_f32_16x16x32_bf16 v[236:239], v[92:95], v[164:167], v[236:239]
    ds_read_b64_tr_b16 v[86:87], v51 offset:20480
    s_waitcnt lgkmcnt(8)
    v_mfma_f32_16x16x32_bf16 v[192:195], v[64:67], v[168:171], v[192:195]
    ds_read_b64_tr_b16 v[88:89], v52 offset:16384
    v_mfma_f32_16x16x32_bf16 v[224:227], v[64:67], v[172:175], v[224:227]
    ds_read_b64_tr_b16 v[90:91], v52 offset:20480
    v_mfma_f32_16x16x32_bf16 v[196:199], v[68:71], v[168:171], v[196:199]
    ds_read_b64_tr_b16 v[92:93], v53 offset:16384
    v_mfma_f32_16x16x32_bf16 v[228:231], v[68:71], v[172:175], v[228:231]
    ds_read_b64_tr_b16 v[94:95], v53 offset:20480
    s_waitcnt lgkmcnt(8)
    v_mfma_f32_16x16x32_bf16 v[200:203], v[72:75], v[168:171], v[200:203]
    ds_read_b64_tr_b16 v[64:65], v50 offset:24576
    v_mfma_f32_16x16x32_bf16 v[232:235], v[72:75], v[172:175], v[232:235]
    ds_read_b64_tr_b16 v[66:67], v50 offset:28672
    v_mfma_f32_16x16x32_bf16 v[204:207], v[76:79], v[168:171], v[204:207]
    ds_read_b64_tr_b16 v[68:69], v51 offset:24576
    v_mfma_f32_16x16x32_bf16 v[236:239], v[76:79], v[172:175], v[236:239]
    ds_read_b64_tr_b16 v[70:71], v51 offset:28672
    s_waitcnt lgkmcnt(8)
    s_waitcnt vmcnt(2)
    v_mfma_f32_16x16x32_bf16 v[192:195], v[80:83], v[176:179], v[192:195]
    ds_read_b64_tr_b16 v[72:73], v52 offset:24576
    v_mfma_f32_16x16x32_bf16 v[224:227], v[80:83], v[180:183], v[224:227]
    ds_read_b64_tr_b16 v[74:75], v52 offset:28672
    v_mfma_f32_16x16x32_bf16 v[196:199], v[84:87], v[176:179], v[196:199]
    ds_read_b64_tr_b16 v[76:77], v53 offset:24576
    v_mfma_f32_16x16x32_bf16 v[228:231], v[84:87], v[180:183], v[228:231]
    ds_read_b64_tr_b16 v[78:79], v53 offset:28672
    s_waitcnt lgkmcnt(8)
    v_mfma_f32_16x16x32_bf16 v[200:203], v[88:91], v[176:179], v[200:203]
    ds_read_b64_tr_b16 v[80:81], v54 offset:8192
    v_mfma_f32_16x16x32_bf16 v[232:235], v[88:91], v[180:183], v[232:235]
    ds_read_b64_tr_b16 v[82:83], v54 offset:12288
    v_mfma_f32_16x16x32_bf16 v[204:207], v[92:95], v[176:179], v[204:207]
    ds_read_b64_tr_b16 v[84:85], v55 offset:8192
    v_mfma_f32_16x16x32_bf16 v[236:239], v[92:95], v[180:183], v[236:239]
    ds_read_b64_tr_b16 v[86:87], v55 offset:12288
    s_waitcnt lgkmcnt(8)
    s_waitcnt vmcnt(0)
    v_mfma_f32_16x16x32_bf16 v[192:195], v[64:67], v[184:187], v[192:195]
    ds_read_b64_tr_b16 v[88:89], v56 offset:8192
    v_mfma_f32_16x16x32_bf16 v[224:227], v[64:67], v[188:191], v[224:227]
    ds_read_b64_tr_b16 v[90:91], v56 offset:12288
    v_mfma_f32_16x16x32_bf16 v[196:199], v[68:71], v[184:187], v[196:199]
    ds_read_b64_tr_b16 v[92:93], v57 offset:8192
    v_mfma_f32_16x16x32_bf16 v[228:231], v[68:71], v[188:191], v[228:231]
    ds_read_b64_tr_b16 v[94:95], v57 offset:12288
    s_waitcnt lgkmcnt(8)
    v_mfma_f32_16x16x32_bf16 v[200:203], v[72:75], v[184:187], v[200:203]
    ds_read_b64_tr_b16 v[64:65], v54 offset:16384
    v_mfma_f32_16x16x32_bf16 v[232:235], v[72:75], v[188:191], v[232:235]
    ds_read_b64_tr_b16 v[66:67], v54 offset:20480
    v_mfma_f32_16x16x32_bf16 v[204:207], v[76:79], v[184:187], v[204:207]
    ds_read_b64_tr_b16 v[68:69], v55 offset:16384
    v_mfma_f32_16x16x32_bf16 v[236:239], v[76:79], v[188:191], v[236:239]
    ds_read_b64_tr_b16 v[70:71], v55 offset:20480
    s_waitcnt lgkmcnt(8)
    v_mfma_f32_16x16x32_bf16 v[208:211], v[80:83], v[136:139], v[208:211]
    ds_read_b64_tr_b16 v[72:73], v56 offset:16384
    v_mfma_f32_16x16x32_bf16 v[240:243], v[80:83], v[140:143], v[240:243]
    ds_read_b64_tr_b16 v[74:75], v56 offset:20480
    v_mfma_f32_16x16x32_bf16 v[212:215], v[84:87], v[136:139], v[212:215]
    ds_read_b64_tr_b16 v[76:77], v57 offset:16384
    ds_write_b128 v20, v[224:227] offset:0
    v_mfma_f32_16x16x32_bf16 v[244:247], v[84:87], v[140:143], v[244:247]
    ds_read_b64_tr_b16 v[78:79], v57 offset:20480
    ds_write_b128 v20, v[228:231] offset:1024
    s_waitcnt lgkmcnt(10)
    v_mfma_f32_16x16x32_bf16 v[216:219], v[88:91], v[136:139], v[216:219]
    ds_read_b64_tr_b16 v[80:81], v54 offset:24576
    ds_write_b128 v20, v[232:235] offset:2048
    v_mfma_f32_16x16x32_bf16 v[248:251], v[88:91], v[140:143], v[248:251]
    ds_read_b64_tr_b16 v[82:83], v54 offset:28672
    v_xor_b32 v54, 65536, v54
    ds_write_b128 v20, v[236:239] offset:3072
    v_mfma_f32_16x16x32_bf16 v[220:223], v[92:95], v[136:139], v[220:223]
    ds_read_b64_tr_b16 v[84:85], v55 offset:24576
    v_mfma_f32_16x16x32_bf16 v[252:255], v[92:95], v[140:143], v[252:255]
    ds_read_b64_tr_b16 v[86:87], v55 offset:28672
    v_xor_b32 v55, 65536, v55
    s_waitcnt lgkmcnt(12)
    v_mfma_f32_16x16x32_bf16 v[208:211], v[64:67], v[144:147], v[208:211]
    ds_read_b64_tr_b16 v[88:89], v56 offset:24576
    v_mfma_f32_16x16x32_bf16 v[240:243], v[64:67], v[148:151], v[240:243]
    ds_read_b64_tr_b16 v[90:91], v56 offset:28672
    v_xor_b32 v56, 65536, v56
    v_mfma_f32_16x16x32_bf16 v[212:215], v[68:71], v[144:147], v[212:215]
    ds_read_b64_tr_b16 v[92:93], v57 offset:24576
    s_waitcnt lgkmcnt(5)
    s_barrier
    v_mfma_f32_16x16x32_bf16 v[244:247], v[68:71], v[148:151], v[244:247]
    ds_read_b64_tr_b16 v[94:95], v57 offset:28672
    v_xor_b32 v57, 65536, v57
    ds_read_b128 v[224:227], v21 offset:0
    ds_read_b128 v[228:231], v21 offset:1024
    v_mfma_f32_16x16x32_bf16 v[216:219], v[72:75], v[144:147], v[216:219]
    ds_read_b64_tr_b16 v[64:65], v54 offset:0
    ds_read_b128 v[232:235], v21 offset:2048
    ds_read_b128 v[236:239], v21 offset:3072
    v_mfma_f32_16x16x32_bf16 v[248:251], v[72:75], v[148:151], v[248:251]
    ds_read_b64_tr_b16 v[66:67], v54 offset:4096
    v_mfma_f32_16x16x32_bf16 v[220:223], v[76:79], v[144:147], v[220:223]
    ds_read_b64_tr_b16 v[68:69], v55 offset:0
    v_mfma_f32_16x16x32_bf16 v[252:255], v[76:79], v[148:151], v[252:255]
    ds_read_b64_tr_b16 v[70:71], v55 offset:4096
    s_waitcnt lgkmcnt(12)
    v_mfma_f32_16x16x32_bf16 v[208:211], v[80:83], v[152:155], v[208:211]
    ds_read_b64_tr_b16 v[72:73], v56 offset:0
    s_waitcnt lgkmcnt(8)
    v_add_f32 v192, v192, v224
    v_add_f32 v193, v193, v225
    v_mfma_f32_16x16x32_bf16 v[240:243], v[80:83], v[156:159], v[240:243]
    ds_read_b64_tr_b16 v[74:75], v56 offset:4096
    v_add_f32 v194, v194, v226
    v_add_f32 v195, v195, v227
    buffer_store_dwordx4 v[192:195], v18, s[24:27], s41 offen offset:0 sc1
    v_mfma_f32_16x16x32_bf16 v[212:215], v[84:87], v[152:155], v[212:215]
    ds_read_b64_tr_b16 v[76:77], v57 offset:0
    s_waitcnt lgkmcnt(9)
    v_add_f32 v196, v196, v228
    v_add_f32 v197, v197, v229
    v_mfma_f32_16x16x32_bf16 v[244:247], v[84:87], v[156:159], v[244:247]
    ds_read_b64_tr_b16 v[78:79], v57 offset:4096
    v_add_f32 v198, v198, v230
    v_add_f32 v199, v199, v231
    buffer_store_dwordx4 v[196:199], v18, s[24:27], s41 offen offset:1024 sc1
    v_mfma_f32_16x16x32_bf16 v[216:219], v[88:91], v[152:155], v[216:219]
    ds_read_b64_tr_b16 v[80:81], v54 offset:8192
    s_waitcnt lgkmcnt(9)
    v_add_f32 v200, v200, v232
    v_add_f32 v201, v201, v233
    v_mfma_f32_16x16x32_bf16 v[248:251], v[88:91], v[156:159], v[248:251]
    ds_read_b64_tr_b16 v[82:83], v54 offset:12288
    v_add_f32 v202, v202, v234
    v_add_f32 v203, v203, v235
    buffer_store_dwordx4 v[200:203], v18, s[24:27], s41 offen offset:2048 sc1
    v_mfma_f32_16x16x32_bf16 v[220:223], v[92:95], v[152:155], v[220:223]
    ds_read_b64_tr_b16 v[84:85], v55 offset:8192
    s_waitcnt lgkmcnt(10)
    v_add_f32 v204, v204, v236
    v_add_f32 v205, v205, v237
    v_mfma_f32_16x16x32_bf16 v[252:255], v[92:95], v[156:159], v[252:255]
    ds_read_b64_tr_b16 v[86:87], v55 offset:12288
    v_add_f32 v206, v206, v238
    v_add_f32 v207, v207, v239
    buffer_store_dwordx4 v[204:207], v18, s[24:27], s41 offen offset:3072 sc1
    s_waitcnt lgkmcnt(8)
    v_mfma_f32_16x16x32_bf16 v[208:211], v[64:67], v[160:163], v[208:211]
    ds_read_b64_tr_b16 v[88:89], v56 offset:8192
    v_mfma_f32_16x16x32_bf16 v[240:243], v[64:67], v[164:167], v[240:243]
    ds_read_b64_tr_b16 v[90:91], v56 offset:12288
    v_mfma_f32_16x16x32_bf16 v[212:215], v[68:71], v[160:163], v[212:215]
    ds_read_b64_tr_b16 v[92:93], v57 offset:8192
    v_mfma_f32_16x16x32_bf16 v[244:247], v[68:71], v[164:167], v[244:247]
    ds_read_b64_tr_b16 v[94:95], v57 offset:12288
    s_waitcnt lgkmcnt(8)
    v_mfma_f32_16x16x32_bf16 v[216:219], v[72:75], v[160:163], v[216:219]
    ds_read_b64_tr_b16 v[64:65], v54 offset:16384
    v_mfma_f32_16x16x32_bf16 v[248:251], v[72:75], v[164:167], v[248:251]
    ds_read_b64_tr_b16 v[66:67], v54 offset:20480
    v_mfma_f32_16x16x32_bf16 v[220:223], v[76:79], v[160:163], v[220:223]
    ds_read_b64_tr_b16 v[68:69], v55 offset:16384
    v_mfma_f32_16x16x32_bf16 v[252:255], v[76:79], v[164:167], v[252:255]
    ds_read_b64_tr_b16 v[70:71], v55 offset:20480
    s_waitcnt lgkmcnt(8)
    v_mfma_f32_16x16x32_bf16 v[208:211], v[80:83], v[168:171], v[208:211]
    ds_read_b64_tr_b16 v[72:73], v56 offset:16384
    v_mfma_f32_16x16x32_bf16 v[240:243], v[80:83], v[172:175], v[240:243]
    ds_read_b64_tr_b16 v[74:75], v56 offset:20480
    v_mfma_f32_16x16x32_bf16 v[212:215], v[84:87], v[168:171], v[212:215]
    ds_read_b64_tr_b16 v[76:77], v57 offset:16384
    v_mfma_f32_16x16x32_bf16 v[244:247], v[84:87], v[172:175], v[244:247]
    ds_read_b64_tr_b16 v[78:79], v57 offset:20480
    s_waitcnt lgkmcnt(8)
    v_mfma_f32_16x16x32_bf16 v[216:219], v[88:91], v[168:171], v[216:219]
    ds_read_b64_tr_b16 v[80:81], v54 offset:24576
    v_mfma_f32_16x16x32_bf16 v[248:251], v[88:91], v[172:175], v[248:251]
    ds_read_b64_tr_b16 v[82:83], v54 offset:28672
    v_mfma_f32_16x16x32_bf16 v[220:223], v[92:95], v[168:171], v[220:223]
    ds_read_b64_tr_b16 v[84:85], v55 offset:24576
    v_mfma_f32_16x16x32_bf16 v[252:255], v[92:95], v[172:175], v[252:255]
    ds_read_b64_tr_b16 v[86:87], v55 offset:28672
    s_waitcnt lgkmcnt(8)
    v_mfma_f32_16x16x32_bf16 v[208:211], v[64:67], v[176:179], v[208:211]
    ds_read_b64_tr_b16 v[88:89], v56 offset:24576
    v_mfma_f32_16x16x32_bf16 v[240:243], v[64:67], v[180:183], v[240:243]
    ds_read_b64_tr_b16 v[90:91], v56 offset:28672
    v_mfma_f32_16x16x32_bf16 v[212:215], v[68:71], v[176:179], v[212:215]
    ds_read_b64_tr_b16 v[92:93], v57 offset:24576
    v_mfma_f32_16x16x32_bf16 v[244:247], v[68:71], v[180:183], v[244:247]
    ds_read_b64_tr_b16 v[94:95], v57 offset:28672
    s_waitcnt lgkmcnt(8)
    v_mfma_f32_16x16x32_bf16 v[216:219], v[72:75], v[176:179], v[216:219]
    v_mfma_f32_16x16x32_bf16 v[248:251], v[72:75], v[180:183], v[248:251]
    v_mfma_f32_16x16x32_bf16 v[220:223], v[76:79], v[176:179], v[220:223]
    v_mfma_f32_16x16x32_bf16 v[252:255], v[76:79], v[180:183], v[252:255]
    s_waitcnt lgkmcnt(4)
    v_mfma_f32_16x16x32_bf16 v[208:211], v[80:83], v[184:187], v[208:211]
    v_mfma_f32_16x16x32_bf16 v[240:243], v[80:83], v[188:191], v[240:243]
    v_mfma_f32_16x16x32_bf16 v[212:215], v[84:87], v[184:187], v[212:215]
    s_lshr_b32 s36, s28, 2
    s_lshl_b32 s36, s36, 15
    s_and_b32 s37, s28, 3
    v_mfma_f32_16x16x32_bf16 v[244:247], v[84:87], v[188:191], v[244:247]
    s_lshl_b32 s37, s37, 12
    s_add_u32 s36, s36, s37
    s_add_u32 s36, s36, 65536
    s_waitcnt lgkmcnt(0)
    v_mfma_f32_16x16x32_bf16 v[216:219], v[88:91], v[184:187], v[216:219]
    v_add_u32 v20, s36, v22
    v_xor_b32 v21, 32768, v20
    v_mfma_f32_16x16x32_bf16 v[248:251], v[88:91], v[188:191], v[248:251]
    v_mfma_f32_16x16x32_bf16 v[220:223], v[92:95], v[184:187], v[220:223]
    v_mfma_f32_16x16x32_bf16 v[252:255], v[92:95], v[188:191], v[252:255]
    s_waitcnt vmcnt(0)
    v_mov_b32 v4, s40
    v_mov_b32 v13, 1
    s_mov_b64 exec, 1
    global_atomic_add v4, v13, s[90:91]
    s_mov_b64 exec, -1
    s_nop 3
    s_nop 4
    ds_write_b128 v20, v[240:243] offset:0
    ds_write_b128 v20, v[244:247] offset:1024
    ds_write_b128 v20, v[248:251] offset:2048
    ds_write_b128 v20, v[252:255] offset:3072
    v_lshlrev_b32 v96, 16, v40
    v_and_b32 v97, 0xffff0000, v40
    v_sub_f32 v112, v96, v48
    v_sub_f32 v113, v97, v48
    v_cvt_pk_bf16_f32 v10, v112, v113
    v_lshlrev_b32 v112, 16, v10
    v_and_b32 v113, 0xffff0000, v10
    v_mul_f32 v112, v112, v49
    v_mul_f32 v113, v113, v49
    v_cvt_pk_bf16_f32 v10, v112, v113
    v_lshlrev_b32 v112, 16, v10
    v_and_b32 v113, 0xffff0000, v10
    v_mul_f32 v11, 0xbfb8aa3b, v112
    v_mul_f32 v12, 0xbfb8aa3b, v113
    v_exp_f32 v11, v11
    v_exp_f32 v12, v12
    s_nop 0
    v_add_f32 v11, 1.0, v11
    v_add_f32 v12, 1.0, v12
    v_rcp_f32 v11, v11
    v_rcp_f32 v12, v12
    s_nop 0
    v_mul_f32 v112, v112, v11
    v_mul_f32 v113, v113, v12
    v_cvt_pk_bf16_f32 v10, v112, v113
    v_lshlrev_b32 v112, 16, v10
    v_and_b32 v113, 0xffff0000, v10
    v_lshlrev_b32 v98, 16, v41
    v_and_b32 v99, 0xffff0000, v41
    v_sub_f32 v114, v98, v48
    v_sub_f32 v115, v99, v48
    v_cvt_pk_bf16_f32 v10, v114, v115
    v_lshlrev_b32 v114, 16, v10
    v_and_b32 v115, 0xffff0000, v10
    v_mul_f32 v114, v114, v49
    v_mul_f32 v115, v115, v49
    v_cvt_pk_bf16_f32 v10, v114, v115
    v_lshlrev_b32 v114, 16, v10
    v_and_b32 v115, 0xffff0000, v10
    v_mul_f32 v11, 0xbfb8aa3b, v114
    v_mul_f32 v12, 0xbfb8aa3b, v115
    v_exp_f32 v11, v11
    v_exp_f32 v12, v12
    s_nop 0
    v_add_f32 v11, 1.0, v11
    v_add_f32 v12, 1.0, v12
    v_rcp_f32 v11, v11
    v_rcp_f32 v12, v12
    s_nop 0
    v_mul_f32 v114, v114, v11
    v_mul_f32 v115, v115, v12
    v_cvt_pk_bf16_f32 v10, v114, v115
    v_lshlrev_b32 v114, 16, v10
    v_and_b32 v115, 0xffff0000, v10
    v_lshlrev_b32 v100, 16, v42
    v_and_b32 v101, 0xffff0000, v42
    v_sub_f32 v116, v100, v48
    v_sub_f32 v117, v101, v48
    v_cvt_pk_bf16_f32 v10, v116, v117
    v_lshlrev_b32 v116, 16, v10
    v_and_b32 v117, 0xffff0000, v10
    v_mul_f32 v116, v116, v49
    v_mul_f32 v117, v117, v49
    v_cvt_pk_bf16_f32 v10, v116, v117
    v_lshlrev_b32 v116, 16, v10
    v_and_b32 v117, 0xffff0000, v10
    v_mul_f32 v11, 0xbfb8aa3b, v116
    v_mul_f32 v12, 0xbfb8aa3b, v117
    v_exp_f32 v11, v11
    v_exp_f32 v12, v12
    s_nop 0
    v_add_f32 v11, 1.0, v11
    v_add_f32 v12, 1.0, v12
    v_rcp_f32 v11, v11
    v_rcp_f32 v12, v12
    s_nop 0
    v_mul_f32 v116, v116, v11
    v_mul_f32 v117, v117, v12
    v_cvt_pk_bf16_f32 v10, v116, v117
    v_lshlrev_b32 v116, 16, v10
    v_and_b32 v117, 0xffff0000, v10
    v_lshlrev_b32 v102, 16, v43
    v_and_b32 v103, 0xffff0000, v43
    v_sub_f32 v118, v102, v48
    v_sub_f32 v119, v103, v48
    v_cvt_pk_bf16_f32 v10, v118, v119
    v_lshlrev_b32 v118, 16, v10
    v_and_b32 v119, 0xffff0000, v10
    v_mul_f32 v118, v118, v49
    v_mul_f32 v119, v119, v49
    v_cvt_pk_bf16_f32 v10, v118, v119
    v_lshlrev_b32 v118, 16, v10
    v_and_b32 v119, 0xffff0000, v10
    v_mul_f32 v11, 0xbfb8aa3b, v118
    v_mul_f32 v12, 0xbfb8aa3b, v119
    v_exp_f32 v11, v11
    v_exp_f32 v12, v12
    s_nop 0
    v_add_f32 v11, 1.0, v11
    v_add_f32 v12, 1.0, v12
    v_rcp_f32 v11, v11
    v_rcp_f32 v12, v12
    s_nop 0
    v_mul_f32 v118, v118, v11
    v_mul_f32 v119, v119, v12
    v_cvt_pk_bf16_f32 v10, v118, v119
    v_lshlrev_b32 v118, 16, v10
    v_and_b32 v119, 0xffff0000, v10
    s_cmp_eq_u32 s28, 3
    s_cbranch_scc1 L_recurrent_scan__compressed_kv_cla__moe_arch_mod__prompt_kernel_rare_204
L_recurrent_scan__compressed_kv_cla__moe_arch_mod__prompt_kernel_back_205:
    s_waitcnt lgkmcnt(0)
    s_barrier
    buffer_load_dwordx4 v[64:67], v18, s[24:27], s39 offen offset:0 sc1
    buffer_load_dwordx4 v[68:71], v18, s[24:27], s39 offen offset:1024 sc1
    buffer_load_dwordx4 v[72:75], v18, s[24:27], s39 offen offset:2048 sc1
    buffer_load_dwordx4 v[76:79], v18, s[24:27], s39 offen offset:3072 sc1
    ds_read_b128 v[128:131], v21 offset:0
    ds_read_b128 v[132:135], v21 offset:1024
    ds_read_b128 v[136:139], v21 offset:2048
    ds_read_b128 v[140:143], v21 offset:3072
    s_waitcnt lgkmcnt(3)
    v_pk_add_f32 v[128:129], v[128:129], v[208:209]
    v_pk_add_f32 v[130:131], v[130:131], v[210:211]
    s_waitcnt lgkmcnt(2)
    v_pk_add_f32 v[132:133], v[132:133], v[212:213]
    v_pk_add_f32 v[134:135], v[134:135], v[214:215]
    s_waitcnt lgkmcnt(1)
    v_pk_add_f32 v[136:137], v[136:137], v[216:217]
    v_pk_add_f32 v[138:139], v[138:139], v[218:219]
    s_waitcnt lgkmcnt(0)
    v_pk_add_f32 v[140:141], v[140:141], v[220:221]
    v_pk_add_f32 v[142:143], v[142:143], v[222:223]
    v_lshlrev_b32 v104, 16, v44
    v_and_b32 v105, 0xffff0000, v44
    v_sub_f32 v120, v104, v48
    v_sub_f32 v121, v105, v48
    v_cvt_pk_bf16_f32 v10, v120, v121
    v_lshlrev_b32 v120, 16, v10
    v_and_b32 v121, 0xffff0000, v10
    v_mul_f32 v120, v120, v49
    v_mul_f32 v121, v121, v49
    v_cvt_pk_bf16_f32 v10, v120, v121
    v_lshlrev_b32 v120, 16, v10
    v_and_b32 v121, 0xffff0000, v10
    v_mul_f32 v11, 0xbfb8aa3b, v120
    v_mul_f32 v12, 0xbfb8aa3b, v121
    v_exp_f32 v11, v11
    v_exp_f32 v12, v12
    s_nop 0
    v_add_f32 v11, 1.0, v11
    v_add_f32 v12, 1.0, v12
    v_rcp_f32 v11, v11
    v_rcp_f32 v12, v12
    s_nop 0
    v_mul_f32 v120, v120, v11
    v_mul_f32 v121, v121, v12
    v_cvt_pk_bf16_f32 v10, v120, v121
    v_lshlrev_b32 v120, 16, v10
    v_and_b32 v121, 0xffff0000, v10
    v_lshlrev_b32 v106, 16, v45
    v_and_b32 v107, 0xffff0000, v45
    v_sub_f32 v122, v106, v48
    v_sub_f32 v123, v107, v48
    v_cvt_pk_bf16_f32 v10, v122, v123
    v_lshlrev_b32 v122, 16, v10
    v_and_b32 v123, 0xffff0000, v10
    v_mul_f32 v122, v122, v49
    v_mul_f32 v123, v123, v49
    v_cvt_pk_bf16_f32 v10, v122, v123
    v_lshlrev_b32 v122, 16, v10
    v_and_b32 v123, 0xffff0000, v10
    v_mul_f32 v11, 0xbfb8aa3b, v122
    v_mul_f32 v12, 0xbfb8aa3b, v123
    v_exp_f32 v11, v11
    v_exp_f32 v12, v12
    s_nop 0
    v_add_f32 v11, 1.0, v11
    v_add_f32 v12, 1.0, v12
    v_rcp_f32 v11, v11
    v_rcp_f32 v12, v12
    s_nop 0
    v_mul_f32 v122, v122, v11
    v_mul_f32 v123, v123, v12
    v_cvt_pk_bf16_f32 v10, v122, v123
    v_lshlrev_b32 v122, 16, v10
    v_and_b32 v123, 0xffff0000, v10
    v_lshlrev_b32 v108, 16, v46
    v_and_b32 v109, 0xffff0000, v46
    v_sub_f32 v124, v108, v48
    v_sub_f32 v125, v109, v48
    v_cvt_pk_bf16_f32 v10, v124, v125
    v_lshlrev_b32 v124, 16, v10
    v_and_b32 v125, 0xffff0000, v10
    v_mul_f32 v124, v124, v49
    v_mul_f32 v125, v125, v49
    v_cvt_pk_bf16_f32 v10, v124, v125
    v_lshlrev_b32 v124, 16, v10
    v_and_b32 v125, 0xffff0000, v10
    v_mul_f32 v11, 0xbfb8aa3b, v124
    v_mul_f32 v12, 0xbfb8aa3b, v125
    v_exp_f32 v11, v11
    v_exp_f32 v12, v12
    s_nop 0
    v_add_f32 v11, 1.0, v11
    v_add_f32 v12, 1.0, v12
    v_rcp_f32 v11, v11
    v_rcp_f32 v12, v12
    s_nop 0
    v_mul_f32 v124, v124, v11
    v_mul_f32 v125, v125, v12
    v_cvt_pk_bf16_f32 v10, v124, v125
    v_lshlrev_b32 v124, 16, v10
    v_and_b32 v125, 0xffff0000, v10
    v_lshlrev_b32 v110, 16, v47
    v_and_b32 v111, 0xffff0000, v47
    v_sub_f32 v126, v110, v48
    v_sub_f32 v127, v111, v48
    v_cvt_pk_bf16_f32 v10, v126, v127
    v_lshlrev_b32 v126, 16, v10
    v_and_b32 v127, 0xffff0000, v10
    v_mul_f32 v126, v126, v49
    v_mul_f32 v127, v127, v49
    v_cvt_pk_bf16_f32 v10, v126, v127
    v_lshlrev_b32 v126, 16, v10
    v_and_b32 v127, 0xffff0000, v10
    v_mul_f32 v11, 0xbfb8aa3b, v126
    v_mul_f32 v12, 0xbfb8aa3b, v127
    v_exp_f32 v11, v11
    v_exp_f32 v12, v12
    s_nop 0
    v_add_f32 v11, 1.0, v11
    v_add_f32 v12, 1.0, v12
    v_rcp_f32 v11, v11
    v_rcp_f32 v12, v12
    s_nop 0
    v_mul_f32 v126, v126, v11
    v_mul_f32 v127, v127, v12
    v_cvt_pk_bf16_f32 v10, v126, v127
    v_lshlrev_b32 v126, 16, v10
    v_and_b32 v127, 0xffff0000, v10
    s_sub_u32 s36, s56, s38
    s_sub_u32 s37, s57, s38
    s_min_u32 s36, s36, s37
    s_cmp_lt_u32 s36, 16
    s_cbranch_scc1 L_recurrent_scan__compressed_kv_cla__moe_arch_mod__prompt_kernel_rare_206
L_recurrent_scan__compressed_kv_cla__moe_arch_mod__prompt_kernel_back_207:
    s_waitcnt vmcnt(3)
    v_pk_add_f32 v[128:129], v[128:129], v[64:65]
    v_cvt_pk_bf16_f32 v23, v128, v129
    v_lshlrev_b32 v128, 16, v23
    v_and_b32 v129, 0xffff0000, v23
    v_pk_mul_f32 v[128:129], v[128:129], v[112:113]
    v_cvt_pk_bf16_f32 v23, v128, v129
    v_lshlrev_b32 v128, 16, v23
    v_and_b32 v129, 0xffff0000, v23
    v_pk_add_f32 v[128:129], v[128:129], v[96:97]
    v_cvt_pk_bf16_f32 v80, v128, v129
    v_pk_add_f32 v[130:131], v[130:131], v[66:67]
    v_cvt_pk_bf16_f32 v23, v130, v131
    v_lshlrev_b32 v130, 16, v23
    v_and_b32 v131, 0xffff0000, v23
    v_pk_mul_f32 v[130:131], v[130:131], v[114:115]
    v_cvt_pk_bf16_f32 v23, v130, v131
    v_lshlrev_b32 v130, 16, v23
    v_and_b32 v131, 0xffff0000, v23
    v_pk_add_f32 v[130:131], v[130:131], v[98:99]
    v_cvt_pk_bf16_f32 v81, v130, v131
    ds_write_b64 v63, v[80:81] offset:0
    s_waitcnt vmcnt(2)
    v_pk_add_f32 v[132:133], v[132:133], v[68:69]
    v_cvt_pk_bf16_f32 v23, v132, v133
    v_lshlrev_b32 v132, 16, v23
    v_and_b32 v133, 0xffff0000, v23
    v_pk_mul_f32 v[132:133], v[132:133], v[116:117]
    v_cvt_pk_bf16_f32 v23, v132, v133
    v_lshlrev_b32 v132, 16, v23
    v_and_b32 v133, 0xffff0000, v23
    v_pk_add_f32 v[132:133], v[132:133], v[100:101]
    v_cvt_pk_bf16_f32 v82, v132, v133
    v_pk_add_f32 v[134:135], v[134:135], v[70:71]
    v_cvt_pk_bf16_f32 v23, v134, v135
    v_lshlrev_b32 v134, 16, v23
    v_and_b32 v135, 0xffff0000, v23
    v_pk_mul_f32 v[134:135], v[134:135], v[118:119]
    v_cvt_pk_bf16_f32 v23, v134, v135
    v_lshlrev_b32 v134, 16, v23
    v_and_b32 v135, 0xffff0000, v23
    v_pk_add_f32 v[134:135], v[134:135], v[102:103]
    v_cvt_pk_bf16_f32 v83, v134, v135
    ds_write_b64 v63, v[82:83] offset:32
    s_waitcnt vmcnt(1)
    v_pk_add_f32 v[136:137], v[136:137], v[72:73]
    v_cvt_pk_bf16_f32 v23, v136, v137
    v_lshlrev_b32 v136, 16, v23
    v_and_b32 v137, 0xffff0000, v23
    v_pk_mul_f32 v[136:137], v[136:137], v[120:121]
    v_cvt_pk_bf16_f32 v23, v136, v137
    v_lshlrev_b32 v136, 16, v23
    v_and_b32 v137, 0xffff0000, v23
    v_pk_add_f32 v[136:137], v[136:137], v[104:105]
    v_cvt_pk_bf16_f32 v84, v136, v137
    v_pk_add_f32 v[138:139], v[138:139], v[74:75]
    v_cvt_pk_bf16_f32 v23, v138, v139
    v_lshlrev_b32 v138, 16, v23
    v_and_b32 v139, 0xffff0000, v23
    v_pk_mul_f32 v[138:139], v[138:139], v[122:123]
    v_cvt_pk_bf16_f32 v23, v138, v139
    v_lshlrev_b32 v138, 16, v23
    v_and_b32 v139, 0xffff0000, v23
    v_pk_add_f32 v[138:139], v[138:139], v[106:107]
    v_cvt_pk_bf16_f32 v85, v138, v139
    ds_write_b64 v63, v[84:85] offset:64
    s_waitcnt vmcnt(0)
    v_pk_add_f32 v[140:141], v[140:141], v[76:77]
    v_cvt_pk_bf16_f32 v23, v140, v141
    v_lshlrev_b32 v140, 16, v23
    v_and_b32 v141, 0xffff0000, v23
    v_pk_mul_f32 v[140:141], v[140:141], v[124:125]
    v_cvt_pk_bf16_f32 v23, v140, v141
    v_lshlrev_b32 v140, 16, v23
    v_and_b32 v141, 0xffff0000, v23
    v_pk_add_f32 v[140:141], v[140:141], v[108:109]
    v_cvt_pk_bf16_f32 v86, v140, v141
    v_pk_add_f32 v[142:143], v[142:143], v[78:79]
    v_cvt_pk_bf16_f32 v23, v142, v143
    v_lshlrev_b32 v142, 16, v23
    v_and_b32 v143, 0xffff0000, v23
    v_pk_mul_f32 v[142:143], v[142:143], v[126:127]
    v_cvt_pk_bf16_f32 v23, v142, v143
    v_lshlrev_b32 v142, 16, v23
    v_and_b32 v143, 0xffff0000, v23
    v_pk_add_f32 v[142:143], v[142:143], v[110:111]
    v_cvt_pk_bf16_f32 v87, v142, v143
    ds_write_b64 v63, v[86:87] offset:96
    v_add_u32 v22, s42, v22
    s_mov_b32 s36, 16384
    s_waitcnt lgkmcnt(0)
    ds_read_b128 v[64:67], v22
    ds_read_b128 v[68:71], v22 offset:1024
    s_waitcnt lgkmcnt(1)
    buffer_store_dwordx4 v[64:67], v15, s[20:23], 0 offen sc1
    s_waitcnt lgkmcnt(0)
    buffer_store_dwordx4 v[68:71], v15, s[20:23], s36 offen sc1
    s_endpgm
L_recurrent_scan__compressed_kv_cla__moe_arch_mod__prompt_kernel_rare_171:
    v_mov_b32 v26, s40
    v_mov_b32 v28, 1
    v_writelane_b32 v26, s41, 1
    s_mov_b64 exec, 3
    global_atomic_add v26, v28, s[90:91]
    s_mov_b64 exec, -1
    s_branch L_recurrent_scan__compressed_kv_cla__moe_arch_mod__prompt_kernel_back_172
L_recurrent_scan__compressed_kv_cla__moe_arch_mod__prompt_kernel_rt1_rare_3:
    s_mov_b32 s61, 0x40000
L_recurrent_scan__compressed_kv_cla__moe_arch_mod__prompt_kernel_rt1_spin_1:
    s_sub_u32 s61, s61, 1
    s_cbranch_scc1 L_recurrent_scan__compressed_kv_cla__moe_arch_mod__prompt_kernel_rt1_spinx_2
    s_sleep 1
    global_load_dword v61, v60, s[90:91] sc1
    s_waitcnt vmcnt(0)
    v_readfirstlane_b32 s36, v61
    s_nop 0
    s_cmp_lt_u32 s36, 16
    s_cbranch_scc1 L_recurrent_scan__compressed_kv_cla__moe_arch_mod__prompt_kernel_rt1_spin_1
L_recurrent_scan__compressed_kv_cla__moe_arch_mod__prompt_kernel_rt1_spinx_2:
    s_branch L_recurrent_scan__compressed_kv_cla__moe_arch_mod__prompt_kernel_rt1_back_4
L_recurrent_scan__compressed_kv_cla__moe_arch_mod__prompt_kernel_rare_181:
    s_cmp_eq_u32 s35, 2
    s_cbranch_scc0 L_recurrent_scan__compressed_kv_cla__moe_arch_mod__prompt_kernel_swn_180
    s_cmp_eq_u32 s28, 0
    s_cbranch_scc0 L_recurrent_scan__compressed_kv_cla__moe_arch_mod__prompt_kernel_g_174
    s_and_b32 s36, s2, 15
    s_add_u32 s36, s36, 96
    s_lshl_b32 s36, s36, 7
    v_mov_b32 v26, s36
    v_mov_b32 v27, 1
    s_mov_b64 exec, 1
    global_atomic_add v26, v27, s[90:91]
    s_mov_b64 exec, -1
    s_nop 3
L_recurrent_scan__compressed_kv_cla__moe_arch_mod__prompt_kernel_g_174:
    s_branch L_recurrent_scan__compressed_kv_cla__moe_arch_mod__prompt_kernel_swend_179
L_recurrent_scan__compressed_kv_cla__moe_arch_mod__prompt_kernel_swn_180:
    s_sub_u32 s36, s56, s38
    s_sub_u32 s37, s57, s38
    s_min_u32 s36, s36, s37
    s_cmp_lt_u32 s36, 16
    s_cbranch_scc0 L_recurrent_scan__compressed_kv_cla__moe_arch_mod__prompt_kernel_nrt_175
    s_add_u32 s36, s30, 96
    s_lshl_b32 s36, s36, 7
    v_mov_b32 v60, s36
    global_load_dword v61, v60, s[90:91] sc1
L_recurrent_scan__compressed_kv_cla__moe_arch_mod__prompt_kernel_nrt_175:
    s_mov_b32 m0, s42
    s_mov_b32 s36, 15360
    buffer_load_dwordx4 v15, s[16:19], 0 offen lds
    buffer_load_dwordx4 v15, s[16:19], s36 offen offset:1024 lds
    s_mov_b32 s36, 4194304
    buffer_load_dwordx2 v[48:49], v16, s[24:27], s36 offen sc1
L_recurrent_scan__compressed_kv_cla__moe_arch_mod__prompt_kernel_swend_179:
    s_branch L_recurrent_scan__compressed_kv_cla__moe_arch_mod__prompt_kernel_back_182
L_recurrent_scan__compressed_kv_cla__moe_arch_mod__prompt_kernel_rare_184:
    s_cmp_eq_u32 s28, 0
    s_cbranch_scc0 L_recurrent_scan__compressed_kv_cla__moe_arch_mod__prompt_kernel_g_178
    s_mov_b32 s43, s38
    s_getpc_b64 s[36:37]
L_recurrent_scan__compressed_kv_cla__moe_arch_mod__prompt_kernel_pc_177:
    s_sub_u32 s36, s36, L_recurrent_scan__compressed_kv_cla__moe_arch_mod__prompt_kernel_pc_177-L_pc
    s_subb_u32 s37, s37, 0
    s_lshr_b32 s38, s2, 3
    s_lshl_b32 s38, s38, 7
    v_lshl_add_u32 v4, v1, 12, s38
    v_min_u32 v4, L_end-L_pc-4, v4
    v_mov_b32 v5, s37
    v_add_co_u32 v4, vcc, s36, v4
    s_mov_b64 exec, 0xffff
    s_nop 0
    v_addc_co_u32 v5, vcc, 0, v5, vcc
    global_load_dword v0, v[4:5], off
    s_mov_b64 exec, -1
    s_nop 1
    s_mov_b32 s38, s43
L_recurrent_scan__compressed_kv_cla__moe_arch_mod__prompt_kernel_g_178:
    s_sub_u32 s36, s56, s38
    s_sub_u32 s37, s57, s38
    s_min_u32 s36, s36, s37
    s_cmp_lt_u32 s36, 16
    s_cbranch_scc0 L_recurrent_scan__compressed_kv_cla__moe_arch_mod__prompt_kernel_nrt_176
    s_waitcnt vmcnt(16)
    v_readfirstlane_b32 s36, v61
    s_nop 0
    s_cmp_lt_u32 s36, 16
    s_cbranch_scc1 L_recurrent_scan__compressed_kv_cla__moe_arch_mod__prompt_kernel_rt1_rare_3
L_recurrent_scan__compressed_kv_cla__moe_arch_mod__prompt_kernel_rt1_back_4:
    s_lshl_b32 s37, s30, 8
    s_add_u32 s36, s37, 59768832
    s_add_u32 s37, s36, 4096
    v_and_b32 v60, 15, v1
    v_lshlrev_b32 v60, 13, v60
    v_lshl_add_u32 v60, v19, 4, v60
    buffer_load_dwordx4 v[96:99], v60, s[24:27], s36 offen offset:0 sc1
    buffer_load_dwordx4 v[100:103], v60, s[24:27], s36 offen offset:64 sc1
    buffer_load_dwordx4 v[104:107], v60, s[24:27], s36 offen offset:128 sc1
    buffer_load_dwordx4 v[108:111], v60, s[24:27], s36 offen offset:192 sc1
    buffer_load_dwordx4 v[112:115], v60, s[24:27], s37 offen offset:0 sc1
    buffer_load_dwordx4 v[116:119], v60, s[24:27], s37 offen offset:64 sc1
    buffer_load_dwordx4 v[120:123], v60, s[24:27], s37 offen offset:128 sc1
    buffer_load_dwordx4 v[124:127], v60, s[24:27], s37 offen offset:192 sc1
L_recurrent_scan__compressed_kv_cla__moe_arch_mod__prompt_kernel_nrt_176:
L_recurrent_scan__compressed_kv_cla__moe_arch_mod__prompt_kernel_swend_183:
    s_branch L_recurrent_scan__compressed_kv_cla__moe_arch_mod__prompt_kernel_back_185
L_recurrent_scan__compressed_kv_cla__moe_arch_mod__prompt_kernel_rare_186:
    global_load_dword v59, v58, s[90:91] sc1
    s_branch L_recurrent_scan__compressed_kv_cla__moe_arch_mod__prompt_kernel_back_187
L_recurrent_scan__compressed_kv_cla__moe_arch_mod__prompt_kernel_rare_191:
    s_mov_b32 s61, 0x40000
    s_waitcnt vmcnt(7)
    s_branch L_recurrent_scan__compressed_kv_cla__moe_arch_mod__prompt_kernel_cchk_190
L_recurrent_scan__compressed_kv_cla__moe_arch_mod__prompt_kernel_cspin_188:
    s_sub_u32 s61, s61, 1
    s_cbranch_scc1 L_recurrent_scan__compressed_kv_cla__moe_arch_mod__prompt_kernel_cspinx_189
    global_load_dword v59, v58, s[90:91] sc1
    s_waitcnt vmcnt(0)
L_recurrent_scan__compressed_kv_cla__moe_arch_mod__prompt_kernel_cchk_190:
    v_cmp_le_u32 vcc, 4, v59
    s_nop 0
    s_and_b32 s60, vcc_lo, 31
    s_and_b32 s36, s60, s44
    s_cmp_eq_u32 s36, s44
    s_cbranch_scc1 L_recurrent_scan__compressed_kv_cla__moe_arch_mod__prompt_kernel_cspinx_189
    s_sleep 6
    s_branch L_recurrent_scan__compressed_kv_cla__moe_arch_mod__prompt_kernel_cspin_188
L_recurrent_scan__compressed_kv_cla__moe_arch_mod__prompt_kernel_cspinx_189:
    s_lshl_b32 s44, s44, 1
    s_or_b32 s44, s44, 1
    s_and_b32 s44, s44, 31
    s_branch L_recurrent_scan__compressed_kv_cla__moe_arch_mod__prompt_kernel_back_192
L_recurrent_scan__compressed_kv_cla__moe_arch_mod__prompt_kernel_f2m_193:
    v_lshrrev_b32 v28, 4, v1
    v_bfe_u32 v26, v1, 2, 2
    v_lshl_add_u32 v26, v28, 3, v26
    v_lshlrev_b32 v26, 7, v26
    v_and_b32 v27, 3, v1
    v_lshl_add_u32 v26, v27, 3, v26
    v_bfe_u32 v27, v1, 3, 2
    s_lshl_b32 s36, s28, 12
    s_add_u32 s36, s36, 131072
    v_add_u32 v26, s36, v26
    v_xor_b32 v28, 0, v27
    v_lshl_add_u32 v28, v28, 5, v26
    ds_read_b64_tr_b16 v[112:113], v28 offset:0
    ds_read_b64_tr_b16 v[114:115], v28 offset:512
    v_xor_b32 v28, 1, v27
    v_lshl_add_u32 v28, v28, 5, v26
    ds_read_b64_tr_b16 v[116:117], v28 offset:0
    ds_read_b64_tr_b16 v[118:119], v28 offset:512
    v_xor_b32 v28, 2, v27
    v_lshl_add_u32 v28, v28, 5, v26
    ds_read_b64_tr_b16 v[120:121], v28 offset:0
    ds_read_b64_tr_b16 v[122:123], v28 offset:512
    v_xor_b32 v28, 3, v27
    v_lshl_add_u32 v28, v28, 5, v26
    ds_read_b64_tr_b16 v[124:125], v28 offset:0
    ds_read_b64_tr_b16 v[126:127], v28 offset:512
    v_add_f32_dpp v96, v96, v96 row_ror:4 row_mask:0xf bank_mask:0xf
    v_add_f32_dpp v97, v97, v97 row_ror:4 row_mask:0xf bank_mask:0xf
    v_add_f32_dpp v98, v98, v98 row_ror:4 row_mask:0xf bank_mask:0xf
    v_add_f32_dpp v99, v99, v99 row_ror:4 row_mask:0xf bank_mask:0xf
    v_add_f32_dpp v100, v100, v100 row_ror:4 row_mask:0xf bank_mask:0xf
    v_add_f32_dpp v101, v101, v101 row_ror:4 row_mask:0xf bank_mask:0xf
    v_add_f32_dpp v102, v102, v102 row_ror:4 row_mask:0xf bank_mask:0xf
    v_add_f32_dpp v103, v103, v103 row_ror:4 row_mask:0xf bank_mask:0xf
    v_add_f32_dpp v96, v96, v96 row_ror:8 row_mask:0xf bank_mask:0xf
    v_add_f32_dpp v97, v97, v97 row_ror:8 row_mask:0xf bank_mask:0xf
    v_add_f32_dpp v98, v98, v98 row_ror:8 row_mask:0xf bank_mask:0xf
    v_add_f32_dpp v99, v99, v99 row_ror:8 row_mask:0xf bank_mask:0xf
    v_add_f32_dpp v100, v100, v100 row_ror:8 row_mask:0xf bank_mask:0xf
    v_add_f32_dpp v101, v101, v101 row_ror:8 row_mask:0xf bank_mask:0xf
    v_add_f32_dpp v102, v102, v102 row_ror:8 row_mask:0xf bank_mask:0xf
    v_add_f32_dpp v103, v103, v103 row_ror:8 row_mask:0xf bank_mask:0xf
    v_cvt_pk_bf16_f32 v29, v96, v97
    v_lshlrev_b32 v96, 16, v29
    v_and_b32 v97, 0xffff0000, v29
    v_cvt_pk_bf16_f32 v29, v98, v99
    v_lshlrev_b32 v98, 16, v29
    v_and_b32 v99, 0xffff0000, v29
    v_cvt_pk_bf16_f32 v29, v100, v101
    v_lshlrev_b32 v100, 16, v29
    v_and_b32 v101, 0xffff0000, v29
    v_cvt_pk_bf16_f32 v29, v102, v103
    v_lshlrev_b32 v102, 16, v29
    v_and_b32 v103, 0xffff0000, v29
    v_mul_f32 v104, 0xbfb8aa3b, v96
    v_mul_f32 v105, 0xbfb8aa3b, v97
    v_mul_f32 v106, 0xbfb8aa3b, v98
    v_mul_f32 v107, 0xbfb8aa3b, v99
    v_mul_f32 v108, 0xbfb8aa3b, v100
    v_mul_f32 v109, 0xbfb8aa3b, v101
    v_mul_f32 v110, 0xbfb8aa3b, v102
    v_mul_f32 v111, 0xbfb8aa3b, v103
    v_exp_f32 v104, v104
    v_exp_f32 v105, v105
    v_exp_f32 v106, v106
    v_exp_f32 v107, v107
    v_exp_f32 v108, v108
    v_exp_f32 v109, v109
    v_exp_f32 v110, v110
    v_exp_f32 v111, v111
    v_add_f32 v104, 1.0, v104
    v_add_f32 v105, 1.0, v105
    v_add_f32 v106, 1.0, v106
    v_add_f32 v107, 1.0, v107
    v_add_f32 v108, 1.0, v108
    v_add_f32 v109, 1.0, v109
    v_add_f32 v110, 1.0, v110
    v_add_f32 v111, 1.0, v111
    v_rcp_f32 v104, v104
    v_rcp_f32 v105, v105
    v_rcp_f32 v106, v106
    v_rcp_f32 v107, v107
    v_rcp_f32 v108, v108
    v_rcp_f32 v109, v109
    v_rcp_f32 v110, v110
    v_rcp_f32 v111, v111
    v_mul_f32 v104, v96, v104
    v_mul_f32 v105, v97, v105
    v_mul_f32 v106, v98, v106
    v_mul_f32 v107, v99, v107
    v_mul_f32 v108, v100, v108
    v_mul_f32 v109, v101, v109
    v_mul_f32 v110, v102, v110
    v_mul_f32 v111, v103, v111
    v_cvt_pk_bf16_f32 v29, v104, v105
    v_lshlrev_b32 v104, 16, v29
    v_and_b32 v105, 0xffff0000, v29
    v_cvt_pk_bf16_f32 v29, v106, v107
    v_lshlrev_b32 v106, 16, v29
    v_and_b32 v107, 0xffff0000, v29
    v_cvt_pk_bf16_f32 v29, v108, v109
    v_lshlrev_b32 v108, 16, v29
    v_and_b32 v109, 0xffff0000, v29
    v_cvt_pk_bf16_f32 v29, v110, v111
    v_lshlrev_b32 v110, 16, v29
    v_and_b32 v111, 0xffff0000, v29
    v_mul_f32_dpp v96, v96, v104 quad_perm:[2,3,0,1] row_mask:0xf bank_mask:0xf
    v_mul_f32_dpp v97, v97, v105 quad_perm:[2,3,0,1] row_mask:0xf bank_mask:0xf
    v_mul_f32_dpp v98, v98, v106 quad_perm:[2,3,0,1] row_mask:0xf bank_mask:0xf
    v_mul_f32_dpp v99, v99, v107 quad_perm:[2,3,0,1] row_mask:0xf bank_mask:0xf
    v_mul_f32_dpp v100, v100, v108 quad_perm:[2,3,0,1] row_mask:0xf bank_mask:0xf
    v_mul_f32_dpp v101, v101, v109 quad_perm:[2,3,0,1] row_mask:0xf bank_mask:0xf
    v_mul_f32_dpp v102, v102, v110 quad_perm:[2,3,0,1] row_mask:0xf bank_mask:0xf
    v_mul_f32_dpp v103, v103, v111 quad_perm:[2,3,0,1] row_mask:0xf bank_mask:0xf
    v_cvt_pk_bf16_f32 v36, v96, v97
    v_cvt_pk_bf16_f32 v37, v98, v99
    v_cvt_pk_bf16_f32 v38, v100, v101
    v_cvt_pk_bf16_f32 v39, v102, v103
    s_waitcnt lgkmcnt(0)
    v_lshl_add_u32 v28, v1, 4, s36
    v_mfma_f32_16x16x32_bf16 v[96:99], v[112:115], v[36:39], 0
    v_mfma_f32_16x16x32_bf16 v[100:103], v[116:119], v[36:39], 0
    v_mfma_f32_16x16x32_bf16 v[104:107], v[120:123], v[36:39], 0
    v_mfma_f32_16x16x32_bf16 v[108:111], v[124:127], v[36:39], 0
    s_nop 7
    ds_write_b128 v28, v[96:99] offset:0
    ds_write_b128 v28, v[100:103] offset:1024
    ds_write_b128 v28, v[104:107] offset:2048
    ds_write_b128 v28, v[108:111] offset:3072
    s_cmp_lt_u32 s28, 4
    s_cbranch_scc1 L_recurrent_scan__compressed_kv_cla__moe_arch_mod__prompt_kernel_f2b_195
    s_branch L_recurrent_scan__compressed_kv_cla__moe_arch_mod__prompt_kernel_f2a_194
L_recurrent_scan__compressed_kv_cla__moe_arch_mod__prompt_kernel_rare_200:
    v_mov_b64 v[24:25], 0
    v_mov_b64 v[26:27], 0
    v_mov_b64 v[28:29], 0
    v_mov_b64 v[30:31], 0
    v_mov_b64 v[32:33], 0
    v_mov_b64 v[34:35], 0
    v_mov_b64 v[36:37], 0
    v_mov_b64 v[38:39], 0
    s_waitcnt vmcnt(16)
    s_sub_u32 s36, s56, s38
    s_cmp_lt_u32 s36, 16
    s_cbranch_scc0 L_recurrent_scan__compressed_kv_cla__moe_arch_mod__prompt_kernel_rt2_noy_1
    s_and_b32 s36, s58, 0xffff0000
    s_cmp_lt_i32 s36, 0
    s_cselect_b32 s37, 0x80000000, -1
    s_xor_b32 s36, s36, s37
    s_and_b32 s36, s36, 0xffff0000
    v_mov_b32 v62, s36
    v_mul_f32 v62, 0xbfb8aa3b, v62
    v_exp_f32 v62, v62
    s_nop 0
    v_add_f32 v62, 1.0, v62
    v_rcp_f32 v62, v62
    s_nop 0
    v_cvt_pk_bf16_f32 v62, v62, v62
    v_lshlrev_b32 v62, 16, v62
    v_add_f32_dpp v96, v96, v96 quad_perm:[1,0,3,2] row_mask:0xf bank_mask:0xf
    v_add_f32_dpp v97, v97, v97 quad_perm:[1,0,3,2] row_mask:0xf bank_mask:0xf
    v_add_f32_dpp v98, v98, v98 quad_perm:[1,0,3,2] row_mask:0xf bank_mask:0xf
    v_add_f32_dpp v99, v99, v99 quad_perm:[1,0,3,2] row_mask:0xf bank_mask:0xf
    v_add_f32_dpp v100, v100, v100 quad_perm:[1,0,3,2] row_mask:0xf bank_mask:0xf
    v_add_f32_dpp v101, v101, v101 quad_perm:[1,0,3,2] row_mask:0xf bank_mask:0xf
    v_add_f32_dpp v102, v102, v102 quad_perm:[1,0,3,2] row_mask:0xf bank_mask:0xf
    v_add_f32_dpp v103, v103, v103 quad_perm:[1,0,3,2] row_mask:0xf bank_mask:0xf
    v_add_f32_dpp v104, v104, v104 quad_perm:[1,0,3,2] row_mask:0xf bank_mask:0xf
    v_add_f32_dpp v105, v105, v105 quad_perm:[1,0,3,2] row_mask:0xf bank_mask:0xf
    v_add_f32_dpp v106, v106, v106 quad_perm:[1,0,3,2] row_mask:0xf bank_mask:0xf
    v_add_f32_dpp v107, v107, v107 quad_perm:[1,0,3,2] row_mask:0xf bank_mask:0xf
    v_add_f32_dpp v108, v108, v108 quad_perm:[1,0,3,2] row_mask:0xf bank_mask:0xf
    v_add_f32_dpp v109, v109, v109 quad_perm:[1,0,3,2] row_mask:0xf bank_mask:0xf
    v_add_f32_dpp v110, v110, v110 quad_perm:[1,0,3,2] row_mask:0xf bank_mask:0xf
    v_add_f32_dpp v111, v111, v111 quad_perm:[1,0,3,2] row_mask:0xf bank_mask:0xf
    v_add_f32_dpp v96, v96, v96 quad_perm:[2,3,0,1] row_mask:0xf bank_mask:0xf
    v_add_f32_dpp v97, v97, v97 quad_perm:[2,3,0,1] row_mask:0xf bank_mask:0xf
    v_add_f32_dpp v98, v98, v98 quad_perm:[2,3,0,1] row_mask:0xf bank_mask:0xf
    v_add_f32_dpp v99, v99, v99 quad_perm:[2,3,0,1] row_mask:0xf bank_mask:0xf
    v_add_f32_dpp v100, v100, v100 quad_perm:[2,3,0,1] row_mask:0xf bank_mask:0xf
    v_add_f32_dpp v101, v101, v101 quad_perm:[2,3,0,1] row_mask:0xf bank_mask:0xf
    v_add_f32_dpp v102, v102, v102 quad_perm:[2,3,0,1] row_mask:0xf bank_mask:0xf
    v_add_f32_dpp v103, v103, v103 quad_perm:[2,3,0,1] row_mask:0xf bank_mask:0xf
    v_add_f32_dpp v104, v104, v104 quad_perm:[2,3,0,1] row_mask:0xf bank_mask:0xf
    v_add_f32_dpp v105, v105, v105 quad_perm:[2,3,0,1] row_mask:0xf bank_mask:0xf
    v_add_f32_dpp v106, v106, v106 quad_perm:[2,3,0,1] row_mask:0xf bank_mask:0xf
    v_add_f32_dpp v107, v107, v107 quad_perm:[2,3,0,1] row_mask:0xf bank_mask:0xf
    v_add_f32_dpp v108, v108, v108 quad_perm:[2,3,0,1] row_mask:0xf bank_mask:0xf
    v_add_f32_dpp v109, v109, v109 quad_perm:[2,3,0,1] row_mask:0xf bank_mask:0xf
    v_add_f32_dpp v110, v110, v110 quad_perm:[2,3,0,1] row_mask:0xf bank_mask:0xf
    v_add_f32_dpp v111, v111, v111 quad_perm:[2,3,0,1] row_mask:0xf bank_mask:0xf
    v_add_f32_dpp v96, v96, v96 row_half_mirror row_mask:0xf bank_mask:0xf
    v_add_f32_dpp v97, v97, v97 row_half_mirror row_mask:0xf bank_mask:0xf
    v_add_f32_dpp v98, v98, v98 row_half_mirror row_mask:0xf bank_mask:0xf
    v_add_f32_dpp v99, v99, v99 row_half_mirror row_mask:0xf bank_mask:0xf
    v_add_f32_dpp v100, v100, v100 row_half_mirror row_mask:0xf bank_mask:0xf
    v_add_f32_dpp v101, v101, v101 row_half_mirror row_mask:0xf bank_mask:0xf
    v_add_f32_dpp v102, v102, v102 row_half_mirror row_mask:0xf bank_mask:0xf
    v_add_f32_dpp v103, v103, v103 row_half_mirror row_mask:0xf bank_mask:0xf
    v_add_f32_dpp v104, v104, v104 row_half_mirror row_mask:0xf bank_mask:0xf
    v_add_f32_dpp v105, v105, v105 row_half_mirror row_mask:0xf bank_mask:0xf
    v_add_f32_dpp v106, v106, v106 row_half_mirror row_mask:0xf bank_mask:0xf
    v_add_f32_dpp v107, v107, v107 row_half_mirror row_mask:0xf bank_mask:0xf
    v_add_f32_dpp v108, v108, v108 row_half_mirror row_mask:0xf bank_mask:0xf
    v_add_f32_dpp v109, v109, v109 row_half_mirror row_mask:0xf bank_mask:0xf
    v_add_f32_dpp v110, v110, v110 row_half_mirror row_mask:0xf bank_mask:0xf
    v_add_f32_dpp v111, v111, v111 row_half_mirror row_mask:0xf bank_mask:0xf
    v_add_f32_dpp v96, v96, v96 row_mirror row_mask:0xf bank_mask:0xf
    v_add_f32_dpp v97, v97, v97 row_mirror row_mask:0xf bank_mask:0xf
    v_add_f32_dpp v98, v98, v98 row_mirror row_mask:0xf bank_mask:0xf
    v_add_f32_dpp v99, v99, v99 row_mirror row_mask:0xf bank_mask:0xf
    v_add_f32_dpp v100, v100, v100 row_mirror row_mask:0xf bank_mask:0xf
    v_add_f32_dpp v101, v101, v101 row_mirror row_mask:0xf bank_mask:0xf
    v_add_f32_dpp v102, v102, v102 row_mirror row_mask:0xf bank_mask:0xf
    v_add_f32_dpp v103, v103, v103 row_mirror row_mask:0xf bank_mask:0xf
    v_add_f32_dpp v104, v104, v104 row_mirror row_mask:0xf bank_mask:0xf
    v_add_f32_dpp v105, v105, v105 row_mirror row_mask:0xf bank_mask:0xf
    v_add_f32_dpp v106, v106, v106 row_mirror row_mask:0xf bank_mask:0xf
    v_add_f32_dpp v107, v107, v107 row_mirror row_mask:0xf bank_mask:0xf
    v_add_f32_dpp v108, v108, v108 row_mirror row_mask:0xf bank_mask:0xf
    v_add_f32_dpp v109, v109, v109 row_mirror row_mask:0xf bank_mask:0xf
    v_add_f32_dpp v110, v110, v110 row_mirror row_mask:0xf bank_mask:0xf
    v_add_f32_dpp v111, v111, v111 row_mirror row_mask:0xf bank_mask:0xf
    v_cmp_eq_u32 vcc, s56, v14
    v_cvt_pk_bf16_f32 v61, v96, v97
    v_lshlrev_b32 v96, 16, v61
    v_and_b32 v97, 0xffff0000, v61
    v_mul_f32 v96, v62, v96
    v_mul_f32 v97, v62, v97
    v_cvt_pk_bf16_f32 v61, v96, v97
    v_lshlrev_b32 v96, 16, v61
    v_and_b32 v97, 0xffff0000, v61
    v_cndmask_b32 v24, v24, v96, vcc
    v_cndmask_b32 v25, v25, v97, vcc
    v_cvt_pk_bf16_f32 v61, v98, v99
    v_lshlrev_b32 v98, 16, v61
    v_and_b32 v99, 0xffff0000, v61
    v_mul_f32 v98, v62, v98
    v_mul_f32 v99, v62, v99
    v_cvt_pk_bf16_f32 v61, v98, v99
    v_lshlrev_b32 v98, 16, v61
    v_and_b32 v99, 0xffff0000, v61
    v_cndmask_b32 v26, v26, v98, vcc
    v_cndmask_b32 v27, v27, v99, vcc
    v_cvt_pk_bf16_f32 v61, v100, v101
    v_lshlrev_b32 v100, 16, v61
    v_and_b32 v101, 0xffff0000, v61
    v_mul_f32 v100, v62, v100
    v_mul_f32 v101, v62, v101
    v_cvt_pk_bf16_f32 v61, v100, v101
    v_lshlrev_b32 v100, 16, v61
    v_and_b32 v101, 0xffff0000, v61
    v_cndmask_b32 v28, v28, v100, vcc
    v_cndmask_b32 v29, v29, v101, vcc
    v_cvt_pk_bf16_f32 v61, v102, v103
    v_lshlrev_b32 v102, 16, v61
    v_and_b32 v103, 0xffff0000, v61
    v_mul_f32 v102, v62, v102
    v_mul_f32 v103, v62, v103
    v_cvt_pk_bf16_f32 v61, v102, v103
    v_lshlrev_b32 v102, 16, v61
    v_and_b32 v103, 0xffff0000, v61
    v_cndmask_b32 v30, v30, v102, vcc
    v_cndmask_b32 v31, v31, v103, vcc
    v_cvt_pk_bf16_f32 v61, v104, v105
    v_lshlrev_b32 v104, 16, v61
    v_and_b32 v105, 0xffff0000, v61
    v_mul_f32 v104, v62, v104
    v_mul_f32 v105, v62, v105
    v_cvt_pk_bf16_f32 v61, v104, v105
    v_lshlrev_b32 v104, 16, v61
    v_and_b32 v105, 0xffff0000, v61
    v_cndmask_b32 v32, v32, v104, vcc
    v_cndmask_b32 v33, v33, v105, vcc
    v_cvt_pk_bf16_f32 v61, v106, v107
    v_lshlrev_b32 v106, 16, v61
    v_and_b32 v107, 0xffff0000, v61
    v_mul_f32 v106, v62, v106
    v_mul_f32 v107, v62, v107
    v_cvt_pk_bf16_f32 v61, v106, v107
    v_lshlrev_b32 v106, 16, v61
    v_and_b32 v107, 0xffff0000, v61
    v_cndmask_b32 v34, v34, v106, vcc
    v_cndmask_b32 v35, v35, v107, vcc
    v_cvt_pk_bf16_f32 v61, v108, v109
    v_lshlrev_b32 v108, 16, v61
    v_and_b32 v109, 0xffff0000, v61
    v_mul_f32 v108, v62, v108
    v_mul_f32 v109, v62, v109
    v_cvt_pk_bf16_f32 v61, v108, v109
    v_lshlrev_b32 v108, 16, v61
    v_and_b32 v109, 0xffff0000, v61
    v_cndmask_b32 v36, v36, v108, vcc
    v_cndmask_b32 v37, v37, v109, vcc
    v_cvt_pk_bf16_f32 v61, v110, v111
    v_lshlrev_b32 v110, 16, v61
    v_and_b32 v111, 0xffff0000, v61
    v_mul_f32 v110, v62, v110
    v_mul_f32 v111, v62, v111
    v_cvt_pk_bf16_f32 v61, v110, v111
    v_lshlrev_b32 v110, 16, v61
    v_and_b32 v111, 0xffff0000, v61
    v_cndmask_b32 v38, v38, v110, vcc
    v_cndmask_b32 v39, v39, v111, vcc
L_recurrent_scan__compressed_kv_cla__moe_arch_mod__prompt_kernel_rt2_noy_1:
    s_sub_u32 s36, s57, s38
    s_cmp_lt_u32 s36, 16
    s_cbranch_scc0 L_recurrent_scan__compressed_kv_cla__moe_arch_mod__prompt_kernel_rt2_noy_2
    s_and_b32 s36, s59, 0xffff0000
    s_cmp_lt_i32 s36, 0
    s_cselect_b32 s37, 0x80000000, -1
    s_xor_b32 s36, s36, s37
    s_and_b32 s36, s36, 0xffff0000
    v_mov_b32 v62, s36
    v_mul_f32 v62, 0xbfb8aa3b, v62
    v_exp_f32 v62, v62
    s_nop 0
    v_add_f32 v62, 1.0, v62
    v_rcp_f32 v62, v62
    s_nop 0
    v_cvt_pk_bf16_f32 v62, v62, v62
    v_lshlrev_b32 v62, 16, v62
    v_add_f32_dpp v112, v112, v112 quad_perm:[1,0,3,2] row_mask:0xf bank_mask:0xf
    v_add_f32_dpp v113, v113, v113 quad_perm:[1,0,3,2] row_mask:0xf bank_mask:0xf
    v_add_f32_dpp v114, v114, v114 quad_perm:[1,0,3,2] row_mask:0xf bank_mask:0xf
    v_add_f32_dpp v115, v115, v115 quad_perm:[1,0,3,2] row_mask:0xf bank_mask:0xf
    v_add_f32_dpp v116, v116, v116 quad_perm:[1,0,3,2] row_mask:0xf bank_mask:0xf
    v_add_f32_dpp v117, v117, v117 quad_perm:[1,0,3,2] row_mask:0xf bank_mask:0xf
    v_add_f32_dpp v118, v118, v118 quad_perm:[1,0,3,2] row_mask:0xf bank_mask:0xf
    v_add_f32_dpp v119, v119, v119 quad_perm:[1,0,3,2] row_mask:0xf bank_mask:0xf
    v_add_f32_dpp v120, v120, v120 quad_perm:[1,0,3,2] row_mask:0xf bank_mask:0xf
    v_add_f32_dpp v121, v121, v121 quad_perm:[1,0,3,2] row_mask:0xf bank_mask:0xf
    v_add_f32_dpp v122, v122, v122 quad_perm:[1,0,3,2] row_mask:0xf bank_mask:0xf
    v_add_f32_dpp v123, v123, v123 quad_perm:[1,0,3,2] row_mask:0xf bank_mask:0xf
    v_add_f32_dpp v124, v124, v124 quad_perm:[1,0,3,2] row_mask:0xf bank_mask:0xf
    v_add_f32_dpp v125, v125, v125 quad_perm:[1,0,3,2] row_mask:0xf bank_mask:0xf
    v_add_f32_dpp v126, v126, v126 quad_perm:[1,0,3,2] row_mask:0xf bank_mask:0xf
    v_add_f32_dpp v127, v127, v127 quad_perm:[1,0,3,2] row_mask:0xf bank_mask:0xf
    v_add_f32_dpp v112, v112, v112 quad_perm:[2,3,0,1] row_mask:0xf bank_mask:0xf
    v_add_f32_dpp v113, v113, v113 quad_perm:[2,3,0,1] row_mask:0xf bank_mask:0xf
    v_add_f32_dpp v114, v114, v114 quad_perm:[2,3,0,1] row_mask:0xf bank_mask:0xf
    v_add_f32_dpp v115, v115, v115 quad_perm:[2,3,0,1] row_mask:0xf bank_mask:0xf
    v_add_f32_dpp v116, v116, v116 quad_perm:[2,3,0,1] row_mask:0xf bank_mask:0xf
    v_add_f32_dpp v117, v117, v117 quad_perm:[2,3,0,1] row_mask:0xf bank_mask:0xf
    v_add_f32_dpp v118, v118, v118 quad_perm:[2,3,0,1] row_mask:0xf bank_mask:0xf
    v_add_f32_dpp v119, v119, v119 quad_perm:[2,3,0,1] row_mask:0xf bank_mask:0xf
    v_add_f32_dpp v120, v120, v120 quad_perm:[2,3,0,1] row_mask:0xf bank_mask:0xf
    v_add_f32_dpp v121, v121, v121 quad_perm:[2,3,0,1] row_mask:0xf bank_mask:0xf
    v_add_f32_dpp v122, v122, v122 quad_perm:[2,3,0,1] row_mask:0xf bank_mask:0xf
    v_add_f32_dpp v123, v123, v123 quad_perm:[2,3,0,1] row_mask:0xf bank_mask:0xf
    v_add_f32_dpp v124, v124, v124 quad_perm:[2,3,0,1] row_mask:0xf bank_mask:0xf
    v_add_f32_dpp v125, v125, v125 quad_perm:[2,3,0,1] row_mask:0xf bank_mask:0xf
    v_add_f32_dpp v126, v126, v126 quad_perm:[2,3,0,1] row_mask:0xf bank_mask:0xf
    v_add_f32_dpp v127, v127, v127 quad_perm:[2,3,0,1] row_mask:0xf bank_mask:0xf
    v_add_f32_dpp v112, v112, v112 row_half_mirror row_mask:0xf bank_mask:0xf
    v_add_f32_dpp v113, v113, v113 row_half_mirror row_mask:0xf bank_mask:0xf
    v_add_f32_dpp v114, v114, v114 row_half_mirror row_mask:0xf bank_mask:0xf
    v_add_f32_dpp v115, v115, v115 row_half_mirror row_mask:0xf bank_mask:0xf
    v_add_f32_dpp v116, v116, v116 row_half_mirror row_mask:0xf bank_mask:0xf
    v_add_f32_dpp v117, v117, v117 row_half_mirror row_mask:0xf bank_mask:0xf
    v_add_f32_dpp v118, v118, v118 row_half_mirror row_mask:0xf bank_mask:0xf
    v_add_f32_dpp v119, v119, v119 row_half_mirror row_mask:0xf bank_mask:0xf
    v_add_f32_dpp v120, v120, v120 row_half_mirror row_mask:0xf bank_mask:0xf
    v_add_f32_dpp v121, v121, v121 row_half_mirror row_mask:0xf bank_mask:0xf
    v_add_f32_dpp v122, v122, v122 row_half_mirror row_mask:0xf bank_mask:0xf
    v_add_f32_dpp v123, v123, v123 row_half_mirror row_mask:0xf bank_mask:0xf
    v_add_f32_dpp v124, v124, v124 row_half_mirror row_mask:0xf bank_mask:0xf
    v_add_f32_dpp v125, v125, v125 row_half_mirror row_mask:0xf bank_mask:0xf
    v_add_f32_dpp v126, v126, v126 row_half_mirror row_mask:0xf bank_mask:0xf
    v_add_f32_dpp v127, v127, v127 row_half_mirror row_mask:0xf bank_mask:0xf
    v_add_f32_dpp v112, v112, v112 row_mirror row_mask:0xf bank_mask:0xf
    v_add_f32_dpp v113, v113, v113 row_mirror row_mask:0xf bank_mask:0xf
    v_add_f32_dpp v114, v114, v114 row_mirror row_mask:0xf bank_mask:0xf
    v_add_f32_dpp v115, v115, v115 row_mirror row_mask:0xf bank_mask:0xf
    v_add_f32_dpp v116, v116, v116 row_mirror row_mask:0xf bank_mask:0xf
    v_add_f32_dpp v117, v117, v117 row_mirror row_mask:0xf bank_mask:0xf
    v_add_f32_dpp v118, v118, v118 row_mirror row_mask:0xf bank_mask:0xf
    v_add_f32_dpp v119, v119, v119 row_mirror row_mask:0xf bank_mask:0xf
    v_add_f32_dpp v120, v120, v120 row_mirror row_mask:0xf bank_mask:0xf
    v_add_f32_dpp v121, v121, v121 row_mirror row_mask:0xf bank_mask:0xf
    v_add_f32_dpp v122, v122, v122 row_mirror row_mask:0xf bank_mask:0xf
    v_add_f32_dpp v123, v123, v123 row_mirror row_mask:0xf bank_mask:0xf
    v_add_f32_dpp v124, v124, v124 row_mirror row_mask:0xf bank_mask:0xf
    v_add_f32_dpp v125, v125, v125 row_mirror row_mask:0xf bank_mask:0xf
    v_add_f32_dpp v126, v126, v126 row_mirror row_mask:0xf bank_mask:0xf
    v_add_f32_dpp v127, v127, v127 row_mirror row_mask:0xf bank_mask:0xf
    v_cmp_eq_u32 vcc, s57, v14
    v_cvt_pk_bf16_f32 v61, v112, v113
    v_lshlrev_b32 v112, 16, v61
    v_and_b32 v113, 0xffff0000, v61
    v_mul_f32 v112, v62, v112
    v_mul_f32 v113, v62, v113
    v_cvt_pk_bf16_f32 v61, v112, v113
    v_lshlrev_b32 v112, 16, v61
    v_and_b32 v113, 0xffff0000, v61
    v_cndmask_b32 v24, v24, v112, vcc
    v_cndmask_b32 v25, v25, v113, vcc
    v_cvt_pk_bf16_f32 v61, v114, v115
    v_lshlrev_b32 v114, 16, v61
    v_and_b32 v115, 0xffff0000, v61
    v_mul_f32 v114, v62, v114
    v_mul_f32 v115, v62, v115
    v_cvt_pk_bf16_f32 v61, v114, v115
    v_lshlrev_b32 v114, 16, v61
    v_and_b32 v115, 0xffff0000, v61
    v_cndmask_b32 v26, v26, v114, vcc
    v_cndmask_b32 v27, v27, v115, vcc
    v_cvt_pk_bf16_f32 v61, v116, v117
    v_lshlrev_b32 v116, 16, v61
    v_and_b32 v117, 0xffff0000, v61
    v_mul_f32 v116, v62, v116
    v_mul_f32 v117, v62, v117
    v_cvt_pk_bf16_f32 v61, v116, v117
    v_lshlrev_b32 v116, 16, v61
    v_and_b32 v117, 0xffff0000, v61
    v_cndmask_b32 v28, v28, v116, vcc
    v_cndmask_b32 v29, v29, v117, vcc
    v_cvt_pk_bf16_f32 v61, v118, v119
    v_lshlrev_b32 v118, 16, v61
    v_and_b32 v119, 0xffff0000, v61
    v_mul_f32 v118, v62, v118
    v_mul_f32 v119, v62, v119
    v_cvt_pk_bf16_f32 v61, v118, v119
    v_lshlrev_b32 v118, 16, v61
    v_and_b32 v119, 0xffff0000, v61
    v_cndmask_b32 v30, v30, v118, vcc
    v_cndmask_b32 v31, v31, v119, vcc
    v_cvt_pk_bf16_f32 v61, v120, v121
    v_lshlrev_b32 v120, 16, v61
    v_and_b32 v121, 0xffff0000, v61
    v_mul_f32 v120, v62, v120
    v_mul_f32 v121, v62, v121
    v_cvt_pk_bf16_f32 v61, v120, v121
    v_lshlrev_b32 v120, 16, v61
    v_and_b32 v121, 0xffff0000, v61
    v_cndmask_b32 v32, v32, v120, vcc
    v_cndmask_b32 v33, v33, v121, vcc
    v_cvt_pk_bf16_f32 v61, v122, v123
    v_lshlrev_b32 v122, 16, v61
    v_and_b32 v123, 0xffff0000, v61
    v_mul_f32 v122, v62, v122
    v_mul_f32 v123, v62, v123
    v_cvt_pk_bf16_f32 v61, v122, v123
    v_lshlrev_b32 v122, 16, v61
    v_and_b32 v123, 0xffff0000, v61
    v_cndmask_b32 v34, v34, v122, vcc
    v_cndmask_b32 v35, v35, v123, vcc
    v_cvt_pk_bf16_f32 v61, v124, v125
    v_lshlrev_b32 v124, 16, v61
    v_and_b32 v125, 0xffff0000, v61
    v_mul_f32 v124, v62, v124
    v_mul_f32 v125, v62, v125
    v_cvt_pk_bf16_f32 v61, v124, v125
    v_lshlrev_b32 v124, 16, v61
    v_and_b32 v125, 0xffff0000, v61
    v_cndmask_b32 v36, v36, v124, vcc
    v_cndmask_b32 v37, v37, v125, vcc
    v_cvt_pk_bf16_f32 v61, v126, v127
    v_lshlrev_b32 v126, 16, v61
    v_and_b32 v127, 0xffff0000, v61
    v_mul_f32 v126, v62, v126
    v_mul_f32 v127, v62, v127
    v_cvt_pk_bf16_f32 v61, v126, v127
    v_lshlrev_b32 v126, 16, v61
    v_and_b32 v127, 0xffff0000, v61
    v_cndmask_b32 v38, v38, v126, vcc
    v_cndmask_b32 v39, v39, v127, vcc
L_recurrent_scan__compressed_kv_cla__moe_arch_mod__prompt_kernel_rt2_noy_2:
    s_branch L_recurrent_scan__compressed_kv_cla__moe_arch_mod__prompt_kernel_back_201
L_recurrent_scan__compressed_kv_cla__moe_arch_mod__prompt_kernel_rare_204:
    s_mov_b32 s61, 0x40000
L_recurrent_scan__compressed_kv_cla__moe_arch_mod__prompt_kernel_spin_202:
    s_sub_u32 s61, s61, 1
    s_cbranch_scc1 L_recurrent_scan__compressed_kv_cla__moe_arch_mod__prompt_kernel_spinx_203
    s_sleep 1
    global_load_dword v23, v5, s[90:91] sc1
    s_waitcnt vmcnt(0)
    v_readfirstlane_b32 s36, v23
    s_nop 0
    s_cmp_lt_u32 s36, 8
    s_cbranch_scc1 L_recurrent_scan__compressed_kv_cla__moe_arch_mod__prompt_kernel_spin_202
L_recurrent_scan__compressed_kv_cla__moe_arch_mod__prompt_kernel_spinx_203:
    s_branch L_recurrent_scan__compressed_kv_cla__moe_arch_mod__prompt_kernel_back_205
L_recurrent_scan__compressed_kv_cla__moe_arch_mod__prompt_kernel_rare_206:
    v_lshlrev_b32 v96, 16, v40
    v_and_b32 v97, 0xffff0000, v40
    v_sub_f32 v112, v96, v48
    v_sub_f32 v113, v97, v48
    v_cvt_pk_bf16_f32 v10, v112, v113
    v_lshlrev_b32 v112, 16, v10
    v_and_b32 v113, 0xffff0000, v10
    v_mul_f32 v112, v112, v49
    v_mul_f32 v113, v113, v49
    v_cvt_pk_bf16_f32 v10, v112, v113
    v_lshlrev_b32 v112, 16, v10
    v_and_b32 v113, 0xffff0000, v10
    v_add_f32 v112, v112, v24
    v_add_f32 v113, v113, v25
    v_cvt_pk_bf16_f32 v10, v112, v113
    v_lshlrev_b32 v112, 16, v10
    v_and_b32 v113, 0xffff0000, v10
    v_mul_f32 v11, 0xbfb8aa3b, v112
    v_mul_f32 v12, 0xbfb8aa3b, v113
    v_exp_f32 v11, v11
    v_exp_f32 v12, v12
    s_nop 0
    v_add_f32 v11, 1.0, v11
    v_add_f32 v12, 1.0, v12
    v_rcp_f32 v11, v11
    v_rcp_f32 v12, v12
    s_nop 0
    v_mul_f32 v112, v112, v11
    v_mul_f32 v113, v113, v12
    v_cvt_pk_bf16_f32 v10, v112, v113
    v_lshlrev_b32 v112, 16, v10
    v_and_b32 v113, 0xffff0000, v10
    v_lshlrev_b32 v98, 16, v41
    v_and_b32 v99, 0xffff0000, v41
    v_sub_f32 v114, v98, v48
    v_sub_f32 v115, v99, v48
    v_cvt_pk_bf16_f32 v10, v114, v115
    v_lshlrev_b32 v114, 16, v10
    v_and_b32 v115, 0xffff0000, v10
    v_mul_f32 v114, v114, v49
    v_mul_f32 v115, v115, v49
    v_cvt_pk_bf16_f32 v10, v114, v115
    v_lshlrev_b32 v114, 16, v10
    v_and_b32 v115, 0xffff0000, v10
    v_add_f32 v114, v114, v26
    v_add_f32 v115, v115, v27
    v_cvt_pk_bf16_f32 v10, v114, v115
    v_lshlrev_b32 v114, 16, v10
    v_and_b32 v115, 0xffff0000, v10
    v_mul_f32 v11, 0xbfb8aa3b, v114
    v_mul_f32 v12, 0xbfb8aa3b, v115
    v_exp_f32 v11, v11
    v_exp_f32 v12, v12
    s_nop 0
    v_add_f32 v11, 1.0, v11
    v_add_f32 v12, 1.0, v12
    v_rcp_f32 v11, v11
    v_rcp_f32 v12, v12
    s_nop 0
    v_mul_f32 v114, v114, v11
    v_mul_f32 v115, v115, v12
    v_cvt_pk_bf16_f32 v10, v114, v115
    v_lshlrev_b32 v114, 16, v10
    v_and_b32 v115, 0xffff0000, v10
    v_lshlrev_b32 v100, 16, v42
    v_and_b32 v101, 0xffff0000, v42
    v_sub_f32 v116, v100, v48
    v_sub_f32 v117, v101, v48
    v_cvt_pk_bf16_f32 v10, v116, v117
    v_lshlrev_b32 v116, 16, v10
    v_and_b32 v117, 0xffff0000, v10
    v_mul_f32 v116, v116, v49
    v_mul_f32 v117, v117, v49
    v_cvt_pk_bf16_f32 v10, v116, v117
    v_lshlrev_b32 v116, 16, v10
    v_and_b32 v117, 0xffff0000, v10
    v_add_f32 v116, v116, v28
    v_add_f32 v117, v117, v29
    v_cvt_pk_bf16_f32 v10, v116, v117
    v_lshlrev_b32 v116, 16, v10
    v_and_b32 v117, 0xffff0000, v10
    v_mul_f32 v11, 0xbfb8aa3b, v116
    v_mul_f32 v12, 0xbfb8aa3b, v117
    v_exp_f32 v11, v11
    v_exp_f32 v12, v12
    s_nop 0
    v_add_f32 v11, 1.0, v11
    v_add_f32 v12, 1.0, v12
    v_rcp_f32 v11, v11
    v_rcp_f32 v12, v12
    s_nop 0
    v_mul_f32 v116, v116, v11
    v_mul_f32 v117, v117, v12
    v_cvt_pk_bf16_f32 v10, v116, v117
    v_lshlrev_b32 v116, 16, v10
    v_and_b32 v117, 0xffff0000, v10
    v_lshlrev_b32 v102, 16, v43
    v_and_b32 v103, 0xffff0000, v43
    v_sub_f32 v118, v102, v48
    v_sub_f32 v119, v103, v48
    v_cvt_pk_bf16_f32 v10, v118, v119
    v_lshlrev_b32 v118, 16, v10
    v_and_b32 v119, 0xffff0000, v10
    v_mul_f32 v118, v118, v49
    v_mul_f32 v119, v119, v49
    v_cvt_pk_bf16_f32 v10, v118, v119
    v_lshlrev_b32 v118, 16, v10
    v_and_b32 v119, 0xffff0000, v10
    v_add_f32 v118, v118, v30
    v_add_f32 v119, v119, v31
    v_cvt_pk_bf16_f32 v10, v118, v119
    v_lshlrev_b32 v118, 16, v10
    v_and_b32 v119, 0xffff0000, v10
    v_mul_f32 v11, 0xbfb8aa3b, v118
    v_mul_f32 v12, 0xbfb8aa3b, v119
    v_exp_f32 v11, v11
    v_exp_f32 v12, v12
    s_nop 0
    v_add_f32 v11, 1.0, v11
    v_add_f32 v12, 1.0, v12
    v_rcp_f32 v11, v11
    v_rcp_f32 v12, v12
    s_nop 0
    v_mul_f32 v118, v118, v11
    v_mul_f32 v119, v119, v12
    v_cvt_pk_bf16_f32 v10, v118, v119
    v_lshlrev_b32 v118, 16, v10
    v_and_b32 v119, 0xffff0000, v10
    v_lshlrev_b32 v104, 16, v44
    v_and_b32 v105, 0xffff0000, v44
    v_sub_f32 v120, v104, v48
    v_sub_f32 v121, v105, v48
    v_cvt_pk_bf16_f32 v10, v120, v121
    v_lshlrev_b32 v120, 16, v10
    v_and_b32 v121, 0xffff0000, v10
    v_mul_f32 v120, v120, v49
    v_mul_f32 v121, v121, v49
    v_cvt_pk_bf16_f32 v10, v120, v121
    v_lshlrev_b32 v120, 16, v10
    v_and_b32 v121, 0xffff0000, v10
    v_add_f32 v120, v120, v32
    v_add_f32 v121, v121, v33
    v_cvt_pk_bf16_f32 v10, v120, v121
    v_lshlrev_b32 v120, 16, v10
    v_and_b32 v121, 0xffff0000, v10
    v_mul_f32 v11, 0xbfb8aa3b, v120
    v_mul_f32 v12, 0xbfb8aa3b, v121
    v_exp_f32 v11, v11
    v_exp_f32 v12, v12
    s_nop 0
    v_add_f32 v11, 1.0, v11
    v_add_f32 v12, 1.0, v12
    v_rcp_f32 v11, v11
    v_rcp_f32 v12, v12
    s_nop 0
    v_mul_f32 v120, v120, v11
    v_mul_f32 v121, v121, v12
    v_cvt_pk_bf16_f32 v10, v120, v121
    v_lshlrev_b32 v120, 16, v10
    v_and_b32 v121, 0xffff0000, v10
    v_lshlrev_b32 v106, 16, v45
    v_and_b32 v107, 0xffff0000, v45
    v_sub_f32 v122, v106, v48
    v_sub_f32 v123, v107, v48
    v_cvt_pk_bf16_f32 v10, v122, v123
    v_lshlrev_b32 v122, 16, v10
    v_and_b32 v123, 0xffff0000, v10
    v_mul_f32 v122, v122, v49
    v_mul_f32 v123, v123, v49
    v_cvt_pk_bf16_f32 v10, v122, v123
    v_lshlrev_b32 v122, 16, v10
    v_and_b32 v123, 0xffff0000, v10
    v_add_f32 v122, v122, v34
    v_add_f32 v123, v123, v35
    v_cvt_pk_bf16_f32 v10, v122, v123
    v_lshlrev_b32 v122, 16, v10
    v_and_b32 v123, 0xffff0000, v10
    v_mul_f32 v11, 0xbfb8aa3b, v122
    v_mul_f32 v12, 0xbfb8aa3b, v123
    v_exp_f32 v11, v11
    v_exp_f32 v12, v12
    s_nop 0
    v_add_f32 v11, 1.0, v11
    v_add_f32 v12, 1.0, v12
    v_rcp_f32 v11, v11
    v_rcp_f32 v12, v12
    s_nop 0
    v_mul_f32 v122, v122, v11
    v_mul_f32 v123, v123, v12
    v_cvt_pk_bf16_f32 v10, v122, v123
    v_lshlrev_b32 v122, 16, v10
    v_and_b32 v123, 0xffff0000, v10
    v_lshlrev_b32 v108, 16, v46
    v_and_b32 v109, 0xffff0000, v46
    v_sub_f32 v124, v108, v48
    v_sub_f32 v125, v109, v48
    v_cvt_pk_bf16_f32 v10, v124, v125
    v_lshlrev_b32 v124, 16, v10
    v_and_b32 v125, 0xffff0000, v10
    v_mul_f32 v124, v124, v49
    v_mul_f32 v125, v125, v49
    v_cvt_pk_bf16_f32 v10, v124, v125
    v_lshlrev_b32 v124, 16, v10
    v_and_b32 v125, 0xffff0000, v10
    v_add_f32 v124, v124, v36
    v_add_f32 v125, v125, v37
    v_cvt_pk_bf16_f32 v10, v124, v125
    v_lshlrev_b32 v124, 16, v10
    v_and_b32 v125, 0xffff0000, v10
    v_mul_f32 v11, 0xbfb8aa3b, v124
    v_mul_f32 v12, 0xbfb8aa3b, v125
    v_exp_f32 v11, v11
    v_exp_f32 v12, v12
    s_nop 0
    v_add_f32 v11, 1.0, v11
    v_add_f32 v12, 1.0, v12
    v_rcp_f32 v11, v11
    v_rcp_f32 v12, v12
    s_nop 0
    v_mul_f32 v124, v124, v11
    v_mul_f32 v125, v125, v12
    v_cvt_pk_bf16_f32 v10, v124, v125
    v_lshlrev_b32 v124, 16, v10
    v_and_b32 v125, 0xffff0000, v10
    v_lshlrev_b32 v110, 16, v47
    v_and_b32 v111, 0xffff0000, v47
    v_sub_f32 v126, v110, v48
    v_sub_f32 v127, v111, v48
    v_cvt_pk_bf16_f32 v10, v126, v127
    v_lshlrev_b32 v126, 16, v10
    v_and_b32 v127, 0xffff0000, v10
    v_mul_f32 v126, v126, v49
    v_mul_f32 v127, v127, v49
    v_cvt_pk_bf16_f32 v10, v126, v127
    v_lshlrev_b32 v126, 16, v10
    v_and_b32 v127, 0xffff0000, v10
    v_add_f32 v126, v126, v38
    v_add_f32 v127, v127, v39
    v_cvt_pk_bf16_f32 v10, v126, v127
    v_lshlrev_b32 v126, 16, v10
    v_and_b32 v127, 0xffff0000, v10
    v_mul_f32 v11, 0xbfb8aa3b, v126
    v_mul_f32 v12, 0xbfb8aa3b, v127
    v_exp_f32 v11, v11
    v_exp_f32 v12, v12
    s_nop 0
    v_add_f32 v11, 1.0, v11
    v_add_f32 v12, 1.0, v12
    v_rcp_f32 v11, v11
    v_rcp_f32 v12, v12
    s_nop 0
    v_mul_f32 v126, v126, v11
    v_mul_f32 v127, v127, v12
    v_cvt_pk_bf16_f32 v10, v126, v127
    v_lshlrev_b32 v126, 16, v10
    v_and_b32 v127, 0xffff0000, v10
    s_branch L_recurrent_scan__compressed_kv_cla__moe_arch_mod__prompt_kernel_back_207
L_end:
    s_endpgm
.section .rodata,"a"
.p2align 6
.amdhsa_kernel recurrent_scan__compressed_kv_cla__moe_arch_mod__prompt_kernel
  .amdhsa_next_free_vgpr 256
  .amdhsa_next_free_sgpr 102
  .amdhsa_accum_offset 256
  .amdhsa_group_segment_fixed_size 0
  .amdhsa_kernarg_size 112
  .amdhsa_user_sgpr_count 2
  .amdhsa_user_sgpr_kernarg_segment_ptr 1
  .amdhsa_system_sgpr_workgroup_id_x 1
.end_amdhsa_kernel
```

```asm
; @launch kernel=recurrent_scan__compressed_kv_cla__moe_arch_mod__prompt_kernel grid=(256,1,1) block=(512,1,1) lds=163840
.amdgcn_target "amdgcn-amd-amdhsa--gfx950"
.text
.globl recurrent_scan__compressed_kv_cla__moe_arch_mod__prompt_kernel
.p2align 8
.type recurrent_scan__compressed_kv_cla__moe_arch_mod__prompt_kernel,@function
recurrent_scan__compressed_kv_cla__moe_arch_mod__prompt_kernel:
    s_cmp_ge_u32 s2, 256
    s_cbranch_scc1 L_end
    s_load_dwordx4 s[44:47], s[0:1], 0
    s_load_dwordx2 s[52:53], s[0:1], 56
    s_load_dwordx4 s[48:51], s[0:1], 24
    s_getpc_b64 s[36:37]
L_pc:
    s_lshr_b32 s38, s2, 3
    s_lshl_b32 s38, s38, 7
    v_lshl_add_u32 v16, v0, 12, s38
    v_cmp_gt_u32 vcc, L_end-L_pc-4, v16
    v_mov_b32 v17, s37
    s_and_b64 exec, exec, vcc
    s_cbranch_execz L_nocpf
    v_add_co_u32 v16, vcc, s36, v16
    s_nop 1
    v_addc_co_u32 v17, vcc, 0, v17, vcc
    global_load_dword v119, v[16:17], off
L_nocpf:
    s_mov_b64 exec, -1
    v_lshrrev_b32 v16, 6, v0
    v_and_b32 v1, 63, v0
    v_readfirstlane_b32 s28, v16
    v_lshlrev_b32 v116, 4, v1
    s_lshl_b32 s42, s2, 3
    s_cmp_lt_u32 s28, 4
    s_cbranch_scc1 L_nox
    s_add_u32 s43, s42, s28
    s_sub_u32 s42, s43, 4
    v_lshl_add_u32 v18, s42, 11, v116
    v_add_u32 v19, 8192, v18
    s_waitcnt lgkmcnt(0)
    global_load_dwordx4 v[20:23], v18, s[44:45]
    global_load_dwordx4 v[24:27], v18, s[44:45] offset:1024
    global_load_dwordx4 v[28:31], v19, s[44:45]
    global_load_dwordx4 v[32:35], v19, s[44:45] offset:1024
    global_load_dwordx4 v[36:39], v116, s[52:53]
    global_load_dwordx4 v[40:43], v116, s[52:53] offset:1024
    s_barrier
L_nox:
    s_load_dwordx4 s[88:91], s[0:1], 96
    s_load_dwordx4 s[92:95], s[0:1], 64
    s_load_dwordx2 s[96:97], s[0:1], 16
    s_and_b32 s29, s2, 7
    s_lshl_b32 s29, s29, 2
    s_lshr_b32 s29, 0x75643120, s29
    s_and_b32 s29, s29, 7
    s_lshl_b32 s29, s29, 2
    s_bfe_u32 s36, s2, 0x20003
    s_add_u32 s29, s29, s36
    s_lshr_b32 s30, s2, 5
    v_lshrrev_b32 v16, 3, v1
    s_lshl_b32 s36, s30, 8
    s_lshl_b32 s37, s28, 5
    s_add_u32 s36, s36, s37
    v_add_u32 v16, s36, v16
    v_lshlrev_b32 v16, 10, v16
    v_lshrrev_b32 v18, 4, v1
    v_and_b32 v19, 7, v1
    v_xor_b32 v19, v19, v18
    v_lshl_add_u32 v2, v19, 4, v16
    v_xor_b32 v19, 4, v19
    v_lshl_add_u32 v3, v19, 4, v16
    v_add_u32 v3, 7168, v3
    v_add_u32 v4, 14336, v2
    v_add_u32 v5, 14336, v3
    s_and_b32 s36, s28, 3
    s_lshl_b32 s37, s36, 4
    v_add_u32 v16, s37, v18
    v_lshlrev_b32 v16, 13, v16
    s_lshl_b32 s37, s29, 8
    v_add_u32 v16, s37, v16
    v_and_b32 v19, 15, v1
    v_lshlrev_b32 v18, 1, v18
    v_xor_b32 v19, v19, v18
    v_lshl_add_u32 v6, v19, 4, v16
    v_add_u32 v7, 31744, v6
    v_xor_b32 v19, 8, v19
    v_lshl_add_u32 v8, v19, 4, v16
    v_add_u32 v8, 63488, v8
    v_add_u32 v9, 31744, v8
    s_lshl_b32 s33, s28, 12
    s_add_u32 s34, s33, 65536
    s_mov_b32 s31, 0
    s_mov_b32 s32, 0
    s_mov_b32 s40, 128
    s_mov_b32 s41, 524288
    s_waitcnt lgkmcnt(0)
    s_mov_b32 s4, s46
    s_and_b32 s5, s47, 0xffff
    s_mov_b32 s6, 2097152
    s_mov_b32 s7, 0x20000
    s_mov_b32 s8, s48
    s_and_b32 s9, s49, 0xffff
    s_mov_b32 s10, 4194304
    s_mov_b32 s11, 0x20000
    s_mov_b32 s20, s50
    s_and_b32 s21, s51, 0xffff
    s_mov_b32 s22, 4194304
    s_mov_b32 s23, 0x20000
    s_cmp_lt_u32 s28, 4
    s_cbranch_scc0 L_pro_s
    s_barrier
    s_cmp_eq_u32 s2, 0
    s_cbranch_scc1 L_recurrent_scan__compressed_kv_cla__moe_arch_mod__prompt_kernel_rare_1
L_recurrent_scan__compressed_kv_cla__moe_arch_mod__prompt_kernel_back_2:
    s_add_u32 m0, s33, 0
    s_add_u32 s36, s31, 131072
    buffer_load_dwordx4 v2, s[4:7], s31 offen offset:0 lds
    buffer_load_dwordx4 v3, s[4:7], s31 offen offset:1024 lds
    buffer_load_dwordx4 v4, s[4:7], s31 offen offset:2048 lds
    buffer_load_dwordx4 v5, s[4:7], s31 offen offset:3072 lds
    s_add_u32 m0, s34, 0
    s_nop 0
    buffer_load_dwordx4 v6, s[8:11], s32 offen offset:0 nt lds
    buffer_load_dwordx4 v7, s[8:11], s32 offen offset:1024 nt lds
    buffer_load_dwordx4 v8, s[8:11], s32 offen offset:2048 nt lds
    buffer_load_dwordx4 v9, s[8:11], s32 offen offset:3072 nt lds
    s_add_u32 m0, s33, 16384
    s_nop 0
    buffer_load_dwordx4 v2, s[4:7], s36 offen offset:0 lds
    buffer_load_dwordx4 v3, s[4:7], s36 offen offset:1024 lds
    buffer_load_dwordx4 v4, s[4:7], s36 offen offset:2048 lds
    buffer_load_dwordx4 v5, s[4:7], s36 offen offset:3072 lds
    s_add_u32 m0, s34, 16384
    s_nop 0
    buffer_load_dwordx4 v6, s[20:23], s32 offen offset:0 nt lds
    buffer_load_dwordx4 v7, s[20:23], s32 offen offset:1024 nt lds
    buffer_load_dwordx4 v8, s[20:23], s32 offen offset:2048 nt lds
    buffer_load_dwordx4 v9, s[20:23], s32 offen offset:3072 nt lds
    s_add_u32 s31, s31, s40
    s_add_u32 s32, s32, s41
L_pro_s:
    s_add_u32 s54, s90, 0
    s_addc_u32 s55, s91, 0
    s_add_u32 s12, s54, 8388608
    s_addc_u32 s13, s55, 0
    s_and_b32 s13, s13, 0xffff
    s_mov_b32 s14, 134217856
    s_mov_b32 s15, 0x20000
    s_mov_b32 s24, s54
    s_and_b32 s25, s55, 0xffff
    s_mov_b32 s26, 184549504
    s_mov_b32 s27, 0x20000
    s_add_u32 s90, s54, 61865984
    s_addc_u32 s91, s55, 0
    v_and_b32 v16, 15, v1
    v_lshrrev_b32 v17, 4, v1
    s_bfe_u32 s36, s28, 0x10001
    s_lshl_b32 s36, s36, 14
    v_lshl_add_u32 v18, v16, 7, s36
    v_lshrrev_b32 v19, 1, v16
    v_xor_b32 v19, v19, v17
    v_lshl_add_u32 v10, v19, 4, v18
    v_xor_b32 v19, 4, v19
    v_lshl_add_u32 v11, v19, 4, v18
    v_lshrrev_b32 v16, 2, v16
    v_lshl_add_u32 v18, v17, 3, v16
    v_lshlrev_b32 v18, 8, v18
    s_lshr_b32 s36, s28, 2
    s_lshl_b32 s36, s36, 14
    s_add_u32 s36, s36, 65536
    v_add_u32 v18, s36, v18
    v_and_b32 v19, 3, v1
    v_lshl_add_u32 v18, v19, 3, v18
    v_and_b32 v17, 1, v17
    v_lshl_add_u32 v16, v17, 2, v16
    s_and_b32 s36, s28, 1
    s_lshl_b32 s36, s36, 2
    s_add_u32 s37, s36, 0
    v_xor_b32 v19, s37, v16
    v_lshl_add_u32 v12, v19, 5, v18
    s_add_u32 s37, s36, 1
    v_xor_b32 v19, s37, v16
    v_lshl_add_u32 v13, v19, 5, v18
    s_add_u32 s37, s36, 2
    v_xor_b32 v19, s37, v16
    v_lshl_add_u32 v14, v19, 5, v18
    s_add_u32 s37, s36, 3
    v_xor_b32 v19, s37, v16
    v_lshl_add_u32 v15, v19, 5, v18
    v_mov_b64 v[128:129], 0
    v_mov_b64 v[130:131], 0
    v_mov_b64 v[132:133], 0
    v_mov_b64 v[134:135], 0
    v_mov_b64 v[136:137], 0
    v_mov_b64 v[138:139], 0
    v_mov_b64 v[140:141], 0
    v_mov_b64 v[142:143], 0
    v_mov_b64 v[144:145], 0
    v_mov_b64 v[146:147], 0
    v_mov_b64 v[148:149], 0
    v_mov_b64 v[150:151], 0
    v_mov_b64 v[152:153], 0
    v_mov_b64 v[154:155], 0
    v_mov_b64 v[156:157], 0
    v_mov_b64 v[158:159], 0
    v_mov_b64 v[160:161], 0
    v_mov_b64 v[162:163], 0
    v_mov_b64 v[164:165], 0
    v_mov_b64 v[166:167], 0
    v_mov_b64 v[168:169], 0
    v_mov_b64 v[170:171], 0
    v_mov_b64 v[172:173], 0
    v_mov_b64 v[174:175], 0
    v_mov_b64 v[176:177], 0
    v_mov_b64 v[178:179], 0
    v_mov_b64 v[180:181], 0
    v_mov_b64 v[182:183], 0
    v_mov_b64 v[184:185], 0
    v_mov_b64 v[186:187], 0
    v_mov_b64 v[188:189], 0
    v_mov_b64 v[190:191], 0
    v_mov_b64 v[192:193], 0
    v_mov_b64 v[194:195], 0
    v_mov_b64 v[196:197], 0
    v_mov_b64 v[198:199], 0
    v_mov_b64 v[200:201], 0
    v_mov_b64 v[202:203], 0
    v_mov_b64 v[204:205], 0
    v_mov_b64 v[206:207], 0
    v_mov_b64 v[208:209], 0
    v_mov_b64 v[210:211], 0
    v_mov_b64 v[212:213], 0
    v_mov_b64 v[214:215], 0
    v_mov_b64 v[216:217], 0
    v_mov_b64 v[218:219], 0
    v_mov_b64 v[220:221], 0
    v_mov_b64 v[222:223], 0
    v_mov_b64 v[224:225], 0
    v_mov_b64 v[226:227], 0
    v_mov_b64 v[228:229], 0
    v_mov_b64 v[230:231], 0
    v_mov_b64 v[232:233], 0
    v_mov_b64 v[234:235], 0
    v_mov_b64 v[236:237], 0
    v_mov_b64 v[238:239], 0
    v_mov_b64 v[240:241], 0
    v_mov_b64 v[242:243], 0
    v_mov_b64 v[244:245], 0
    v_mov_b64 v[246:247], 0
    v_mov_b64 v[248:249], 0
    v_mov_b64 v[250:251], 0
    v_mov_b64 v[252:253], 0
    v_mov_b64 v[254:255], 0
    v_mov_b32 v118, 0
    v_mov_b32 v117, 0
    s_lshr_b32 s36, s2, 3
    s_lshl_b32 s36, s36, 5
    s_lshl_b32 s37, s28, 2
    s_add_u32 s36, s36, s37
    s_lshl_b32 s36, s36, 13
    s_and_b32 s37, s29, 28
    s_lshl_b32 s37, s37, 8
    s_add_u32 s36, s36, s37
    s_add_u32 s16, s96, s36
    s_addc_u32 s17, s97, 0
    s_and_b32 s17, s17, 0xffff
    s_mov_b32 s18, 25600
    s_mov_b32 s19, 0x20000
    v_cmp_gt_u32 vcc, 8, v1
    v_lshlrev_b32 v17, 7, v1
    v_mov_b32 v19, 0x100000
    v_cndmask_b32 v17, v19, v17, vcc
    s_mov_b32 s45, 0
    s_cmp_lt_u32 s28, 4
    s_cbranch_scc0 L_pro_b
    s_add_u32 m0, s33, 32768
    s_add_u32 s36, s31, 131072
    buffer_load_dwordx4 v2, s[4:7], s31 offen offset:0 lds
    buffer_load_dwordx4 v3, s[4:7], s31 offen offset:1024 lds
    buffer_load_dwordx4 v4, s[4:7], s31 offen offset:2048 lds
    buffer_load_dwordx4 v5, s[4:7], s31 offen offset:3072 lds
    s_add_u32 m0, s34, 32768
    s_nop 0
    buffer_load_dwordx4 v6, s[8:11], s32 offen offset:0 nt lds
    buffer_load_dwordx4 v7, s[8:11], s32 offen offset:1024 nt lds
    buffer_load_dwordx4 v8, s[8:11], s32 offen offset:2048 nt lds
    buffer_load_dwordx4 v9, s[8:11], s32 offen offset:3072 nt lds
    s_add_u32 m0, s33, 49152
    s_nop 0
    buffer_load_dwordx4 v2, s[4:7], s36 offen offset:0 lds
    buffer_load_dwordx4 v3, s[4:7], s36 offen offset:1024 lds
    buffer_load_dwordx4 v4, s[4:7], s36 offen offset:2048 lds
    buffer_load_dwordx4 v5, s[4:7], s36 offen offset:3072 lds
    s_add_u32 m0, s34, 49152
    s_nop 0
    buffer_load_dwordx4 v6, s[20:23], s32 offen offset:0 nt lds
    buffer_load_dwordx4 v7, s[20:23], s32 offen offset:1024 nt lds
    buffer_load_dwordx4 v8, s[20:23], s32 offen offset:2048 nt lds
    buffer_load_dwordx4 v9, s[20:23], s32 offen offset:3072 nt lds
    s_add_u32 s31, s31, s40
    s_add_u32 s32, s32, s41
    s_waitcnt vmcnt(16)
    s_branch L_pro_j
L_pro_b:
    s_mov_b64 s[8:9], s[20:21]
    s_mov_b32 s31, 256
    s_mov_b32 s32, 1048576
    s_and_b32 s60, s28, 3
    s_waitcnt vmcnt(0)
    s_mov_b32 s3, 0
L_ln:
    v_lshlrev_b32 v44, 16, v36
    v_and_b32 v45, 0xffff0000, v36
    v_lshlrev_b32 v46, 16, v37
    v_and_b32 v47, 0xffff0000, v37
    v_lshlrev_b32 v48, 16, v38
    v_and_b32 v49, 0xffff0000, v38
    v_lshlrev_b32 v50, 16, v39
    v_and_b32 v51, 0xffff0000, v39
    v_lshlrev_b32 v52, 16, v40
    v_and_b32 v53, 0xffff0000, v40
    v_lshlrev_b32 v54, 16, v41
    v_and_b32 v55, 0xffff0000, v41
    v_lshlrev_b32 v56, 16, v42
    v_and_b32 v57, 0xffff0000, v42
    v_lshlrev_b32 v58, 16, v43
    v_and_b32 v59, 0xffff0000, v43
    v_lshlrev_b32 v60, 16, v20
    v_lshlrev_b32 v76, 16, v28
    v_and_b32 v61, 0xffff0000, v20
    v_and_b32 v77, 0xffff0000, v28
    v_lshlrev_b32 v62, 16, v21
    v_lshlrev_b32 v78, 16, v29
    v_and_b32 v63, 0xffff0000, v21
    v_and_b32 v79, 0xffff0000, v29
    v_lshlrev_b32 v64, 16, v22
    v_lshlrev_b32 v80, 16, v30
    v_and_b32 v65, 0xffff0000, v22
    v_and_b32 v81, 0xffff0000, v30
    v_lshlrev_b32 v66, 16, v23
    v_lshlrev_b32 v82, 16, v31
    v_and_b32 v67, 0xffff0000, v23
    v_and_b32 v83, 0xffff0000, v31
    v_lshlrev_b32 v68, 16, v24
    v_lshlrev_b32 v84, 16, v32
    v_and_b32 v69, 0xffff0000, v24
    v_and_b32 v85, 0xffff0000, v32
    v_lshlrev_b32 v70, 16, v25
    v_lshlrev_b32 v86, 16, v33
    v_and_b32 v71, 0xffff0000, v25
    v_and_b32 v87, 0xffff0000, v33
    v_lshlrev_b32 v72, 16, v26
    v_lshlrev_b32 v88, 16, v34
    v_and_b32 v73, 0xffff0000, v26
    v_and_b32 v89, 0xffff0000, v34
    v_lshlrev_b32 v74, 16, v27
    v_lshlrev_b32 v90, 16, v35
    v_and_b32 v75, 0xffff0000, v27
    v_and_b32 v91, 0xffff0000, v35
    v_pk_add_f32 v[92:93], v[60:61], v[62:63]
    v_pk_add_f32 v[100:101], v[76:77], v[78:79]
    v_pk_add_f32 v[92:93], v[92:93], v[64:65]
    v_pk_add_f32 v[100:101], v[100:101], v[80:81]
    v_pk_add_f32 v[92:93], v[92:93], v[66:67]
    v_pk_add_f32 v[100:101], v[100:101], v[82:83]
    v_pk_add_f32 v[92:93], v[92:93], v[68:69]
    v_pk_add_f32 v[100:101], v[100:101], v[84:85]
    v_pk_add_f32 v[92:93], v[92:93], v[70:71]
    v_pk_add_f32 v[100:101], v[100:101], v[86:87]
    v_pk_add_f32 v[92:93], v[92:93], v[72:73]
    v_pk_add_f32 v[100:101], v[100:101], v[88:89]
    v_pk_add_f32 v[92:93], v[92:93], v[74:75]
    v_pk_add_f32 v[100:101], v[100:101], v[90:91]
    v_add_f32 v92, v92, v93
    v_add_f32 v100, v100, v101
    s_nop 0
    v_add_f32_dpp v92, v92, v92 quad_perm:[1,0,3,2] row_mask:0xf bank_mask:0xf
    v_add_f32_dpp v100, v100, v100 quad_perm:[1,0,3,2] row_mask:0xf bank_mask:0xf
    s_nop 0
    v_add_f32_dpp v92, v92, v92 quad_perm:[2,3,0,1] row_mask:0xf bank_mask:0xf
    v_add_f32_dpp v100, v100, v100 quad_perm:[2,3,0,1] row_mask:0xf bank_mask:0xf
    s_nop 0
    v_add_f32_dpp v92, v92, v92 row_half_mirror row_mask:0xf bank_mask:0xf
    v_add_f32_dpp v100, v100, v100 row_half_mirror row_mask:0xf bank_mask:0xf
    s_nop 0
    v_add_f32_dpp v92, v92, v92 row_mirror row_mask:0xf bank_mask:0xf
    v_add_f32_dpp v100, v100, v100 row_mirror row_mask:0xf bank_mask:0xf
    v_readlane_b32 s36, v92, 0
    v_readlane_b32 s56, v100, 0
    v_readlane_b32 s37, v92, 16
    v_readlane_b32 s57, v100, 16
    v_readlane_b32 s38, v92, 32
    v_readlane_b32 s58, v100, 32
    v_readlane_b32 s39, v92, 48
    v_readlane_b32 s59, v100, 48
    v_mov_b32 v96, s36
    v_mov_b32 v104, s56
    v_add_f32 v96, s37, v96
    v_add_f32 v104, s57, v104
    v_add_f32 v96, s38, v96
    v_add_f32 v104, s58, v104
    v_add_f32 v96, s39, v96
    v_add_f32 v104, s59, v104
    v_mul_f32 v96, 0xba800000, v96
    v_mul_f32 v104, 0xba800000, v104
    v_mov_b32 v97, v96
    v_mov_b32 v105, v104
    v_pk_add_f32 v[94:95], v[60:61], v[96:97]
    v_pk_add_f32 v[102:103], v[76:77], v[104:105]
    v_pk_mul_f32 v[92:93], v[94:95], v[94:95]
    v_pk_mul_f32 v[100:101], v[102:103], v[102:103]
    v_pk_add_f32 v[94:95], v[62:63], v[96:97]
    v_pk_add_f32 v[102:103], v[78:79], v[104:105]
    v_pk_fma_f32 v[92:93], v[94:95], v[94:95], v[92:93]
    v_pk_fma_f32 v[100:101], v[102:103], v[102:103], v[100:101]
    v_pk_add_f32 v[94:95], v[64:65], v[96:97]
    v_pk_add_f32 v[102:103], v[80:81], v[104:105]
    v_pk_fma_f32 v[92:93], v[94:95], v[94:95], v[92:93]
    v_pk_fma_f32 v[100:101], v[102:103], v[102:103], v[100:101]
    v_pk_add_f32 v[94:95], v[66:67], v[96:97]
    v_pk_add_f32 v[102:103], v[82:83], v[104:105]
    v_pk_fma_f32 v[92:93], v[94:95], v[94:95], v[92:93]
    v_pk_fma_f32 v[100:101], v[102:103], v[102:103], v[100:101]
    v_pk_add_f32 v[94:95], v[68:69], v[96:97]
    v_pk_add_f32 v[102:103], v[84:85], v[104:105]
    v_pk_fma_f32 v[92:93], v[94:95], v[94:95], v[92:93]
    v_pk_fma_f32 v[100:101], v[102:103], v[102:103], v[100:101]
    v_pk_add_f32 v[94:95], v[70:71], v[96:97]
    v_pk_add_f32 v[102:103], v[86:87], v[104:105]
    v_pk_fma_f32 v[92:93], v[94:95], v[94:95], v[92:93]
    v_pk_fma_f32 v[100:101], v[102:103], v[102:103], v[100:101]
    v_pk_add_f32 v[94:95], v[72:73], v[96:97]
    v_pk_add_f32 v[102:103], v[88:89], v[104:105]
    v_pk_fma_f32 v[92:93], v[94:95], v[94:95], v[92:93]
    v_pk_fma_f32 v[100:101], v[102:103], v[102:103], v[100:101]
    v_pk_add_f32 v[94:95], v[74:75], v[96:97]
    v_pk_add_f32 v[102:103], v[90:91], v[104:105]
    v_pk_fma_f32 v[92:93], v[94:95], v[94:95], v[92:93]
    v_pk_fma_f32 v[100:101], v[102:103], v[102:103], v[100:101]
    v_add_f32 v92, v92, v93
    v_add_f32 v100, v100, v101
    s_nop 0
    v_add_f32_dpp v92, v92, v92 quad_perm:[1,0,3,2] row_mask:0xf bank_mask:0xf
    v_add_f32_dpp v100, v100, v100 quad_perm:[1,0,3,2] row_mask:0xf bank_mask:0xf
    s_nop 0
    v_add_f32_dpp v92, v92, v92 quad_perm:[2,3,0,1] row_mask:0xf bank_mask:0xf
    v_add_f32_dpp v100, v100, v100 quad_perm:[2,3,0,1] row_mask:0xf bank_mask:0xf
    s_nop 0
    v_add_f32_dpp v92, v92, v92 row_half_mirror row_mask:0xf bank_mask:0xf
    v_add_f32_dpp v100, v100, v100 row_half_mirror row_mask:0xf bank_mask:0xf
    s_nop 0
    v_add_f32_dpp v92, v92, v92 row_mirror row_mask:0xf bank_mask:0xf
    v_add_f32_dpp v100, v100, v100 row_mirror row_mask:0xf bank_mask:0xf
    v_readlane_b32 s36, v92, 0
    v_readlane_b32 s56, v100, 0
    v_readlane_b32 s37, v92, 16
    v_readlane_b32 s57, v100, 16
    v_readlane_b32 s38, v92, 32
    v_readlane_b32 s58, v100, 32
    v_readlane_b32 s39, v92, 48
    v_readlane_b32 s59, v100, 48
    v_mov_b32 v94, s36
    v_mov_b32 v102, s56
    v_add_f32 v94, s37, v94
    v_add_f32 v102, s57, v102
    v_add_f32 v94, s38, v94
    v_add_f32 v102, s58, v102
    v_add_f32 v94, s39, v94
    v_add_f32 v102, s59, v102
    v_mul_f32 v94, 0x3a800000, v94
    v_mul_f32 v102, 0x3a800000, v102
    v_cvt_pk_bf16_f32 v95, v96, v94
    v_cvt_pk_bf16_f32 v103, v104, v102
    v_lshlrev_b32 v96, 16, v95
    v_lshlrev_b32 v104, 16, v103
    v_and_b32 v94, 0xffff0000, v95
    v_and_b32 v102, 0xffff0000, v103
    v_add_f32 v94, 0x3727c5ac, v94
    v_add_f32 v102, 0x3727c5ac, v102
    v_cvt_pk_bf16_f32 v94, v94, v94
    v_cvt_pk_bf16_f32 v102, v102, v102
    v_lshlrev_b32 v94, 16, v94
    v_lshlrev_b32 v102, 16, v102
    v_sqrt_f32 v94, v94
    v_sqrt_f32 v102, v102
    v_mov_b32 v97, v96
    v_mov_b32 v105, v104
    v_cvt_pk_bf16_f32 v94, v94, v94
    v_cvt_pk_bf16_f32 v102, v102, v102
    v_lshlrev_b32 v94, 16, v94
    v_lshlrev_b32 v102, 16, v102
    v_rcp_f32 v99, v94
    v_rcp_f32 v107, v102
    v_fma_f32 v95, -v94, v99, 1.0
    v_fma_f32 v103, -v102, v107, 1.0
    v_fma_f32 v99, v95, v99, v99
    v_fma_f32 v107, v103, v107, v107
    v_mov_b32 v98, v99
    v_mov_b32 v106, v107
    v_pk_add_f32 v[60:61], v[60:61], v[96:97]
    v_pk_add_f32 v[76:77], v[76:77], v[104:105]
    v_cvt_pk_bf16_f32 v94, v60, v61
    v_cvt_pk_bf16_f32 v102, v76, v77
    v_lshlrev_b32 v60, 16, v94
    v_lshlrev_b32 v76, 16, v102
    v_and_b32 v61, 0xffff0000, v94
    v_and_b32 v77, 0xffff0000, v102
    v_pk_mul_f32 v[60:61], v[60:61], v[98:99]
    v_pk_mul_f32 v[76:77], v[76:77], v[106:107]
    v_cvt_pk_bf16_f32 v108, v60, v61
    v_cvt_pk_bf16_f32 v120, v76, v77
    v_lshlrev_b32 v60, 16, v108
    v_lshlrev_b32 v76, 16, v120
    v_and_b32 v61, 0xffff0000, v108
    v_and_b32 v77, 0xffff0000, v120
    v_pk_mul_f32 v[92:93], v[60:61], v[44:45]
    v_pk_mul_f32 v[100:101], v[76:77], v[44:45]
    v_pk_add_f32 v[62:63], v[62:63], v[96:97]
    v_pk_add_f32 v[78:79], v[78:79], v[104:105]
    v_cvt_pk_bf16_f32 v94, v62, v63
    v_cvt_pk_bf16_f32 v102, v78, v79
    v_lshlrev_b32 v62, 16, v94
    v_lshlrev_b32 v78, 16, v102
    v_and_b32 v63, 0xffff0000, v94
    v_and_b32 v79, 0xffff0000, v102
    v_pk_mul_f32 v[62:63], v[62:63], v[98:99]
    v_pk_mul_f32 v[78:79], v[78:79], v[106:107]
    v_cvt_pk_bf16_f32 v109, v62, v63
    v_cvt_pk_bf16_f32 v121, v78, v79
    v_lshlrev_b32 v62, 16, v109
    v_lshlrev_b32 v78, 16, v121
    v_and_b32 v63, 0xffff0000, v109
    v_and_b32 v79, 0xffff0000, v121
    v_pk_fma_f32 v[92:93], v[62:63], v[46:47], v[92:93]
    v_pk_fma_f32 v[100:101], v[78:79], v[46:47], v[100:101]
    v_pk_add_f32 v[64:65], v[64:65], v[96:97]
    v_pk_add_f32 v[80:81], v[80:81], v[104:105]
    v_cvt_pk_bf16_f32 v94, v64, v65
    v_cvt_pk_bf16_f32 v102, v80, v81
    v_lshlrev_b32 v64, 16, v94
    v_lshlrev_b32 v80, 16, v102
    v_and_b32 v65, 0xffff0000, v94
    v_and_b32 v81, 0xffff0000, v102
    v_pk_mul_f32 v[64:65], v[64:65], v[98:99]
    v_pk_mul_f32 v[80:81], v[80:81], v[106:107]
    v_cvt_pk_bf16_f32 v110, v64, v65
    v_cvt_pk_bf16_f32 v122, v80, v81
    v_lshlrev_b32 v64, 16, v110
    v_lshlrev_b32 v80, 16, v122
    v_and_b32 v65, 0xffff0000, v110
    v_and_b32 v81, 0xffff0000, v122
    v_pk_fma_f32 v[92:93], v[64:65], v[48:49], v[92:93]
    v_pk_fma_f32 v[100:101], v[80:81], v[48:49], v[100:101]
    v_pk_add_f32 v[66:67], v[66:67], v[96:97]
    v_pk_add_f32 v[82:83], v[82:83], v[104:105]
    v_cvt_pk_bf16_f32 v94, v66, v67
    v_cvt_pk_bf16_f32 v102, v82, v83
    v_lshlrev_b32 v66, 16, v94
    v_lshlrev_b32 v82, 16, v102
    v_and_b32 v67, 0xffff0000, v94
    v_and_b32 v83, 0xffff0000, v102
    v_pk_mul_f32 v[66:67], v[66:67], v[98:99]
    v_pk_mul_f32 v[82:83], v[82:83], v[106:107]
    v_cvt_pk_bf16_f32 v111, v66, v67
    v_cvt_pk_bf16_f32 v123, v82, v83
    v_lshlrev_b32 v66, 16, v111
    v_lshlrev_b32 v82, 16, v123
    v_and_b32 v67, 0xffff0000, v111
    v_and_b32 v83, 0xffff0000, v123
    v_pk_fma_f32 v[92:93], v[66:67], v[50:51], v[92:93]
    v_pk_fma_f32 v[100:101], v[82:83], v[50:51], v[100:101]
    v_pk_add_f32 v[68:69], v[68:69], v[96:97]
    v_pk_add_f32 v[84:85], v[84:85], v[104:105]
    v_cvt_pk_bf16_f32 v94, v68, v69
    v_cvt_pk_bf16_f32 v102, v84, v85
    v_lshlrev_b32 v68, 16, v94
    v_lshlrev_b32 v84, 16, v102
    v_and_b32 v69, 0xffff0000, v94
    v_and_b32 v85, 0xffff0000, v102
    v_pk_mul_f32 v[68:69], v[68:69], v[98:99]
    v_pk_mul_f32 v[84:85], v[84:85], v[106:107]
    v_cvt_pk_bf16_f32 v112, v68, v69
    v_cvt_pk_bf16_f32 v124, v84, v85
    v_lshlrev_b32 v68, 16, v112
    v_lshlrev_b32 v84, 16, v124
    v_and_b32 v69, 0xffff0000, v112
    v_and_b32 v85, 0xffff0000, v124
    v_pk_fma_f32 v[92:93], v[68:69], v[52:53], v[92:93]
    v_pk_fma_f32 v[100:101], v[84:85], v[52:53], v[100:101]
    v_pk_add_f32 v[70:71], v[70:71], v[96:97]
    v_pk_add_f32 v[86:87], v[86:87], v[104:105]
    v_cvt_pk_bf16_f32 v94, v70, v71
    v_cvt_pk_bf16_f32 v102, v86, v87
    v_lshlrev_b32 v70, 16, v94
    v_lshlrev_b32 v86, 16, v102
    v_and_b32 v71, 0xffff0000, v94
    v_and_b32 v87, 0xffff0000, v102
    v_pk_mul_f32 v[70:71], v[70:71], v[98:99]
    v_pk_mul_f32 v[86:87], v[86:87], v[106:107]
    v_cvt_pk_bf16_f32 v113, v70, v71
    v_cvt_pk_bf16_f32 v125, v86, v87
    v_lshlrev_b32 v70, 16, v113
    v_lshlrev_b32 v86, 16, v125
    v_and_b32 v71, 0xffff0000, v113
    v_and_b32 v87, 0xffff0000, v125
    v_pk_fma_f32 v[92:93], v[70:71], v[54:55], v[92:93]
    v_pk_fma_f32 v[100:101], v[86:87], v[54:55], v[100:101]
    v_pk_add_f32 v[72:73], v[72:73], v[96:97]
    v_pk_add_f32 v[88:89], v[88:89], v[104:105]
    v_cvt_pk_bf16_f32 v94, v72, v73
    v_cvt_pk_bf16_f32 v102, v88, v89
    v_lshlrev_b32 v72, 16, v94
    v_lshlrev_b32 v88, 16, v102
    v_and_b32 v73, 0xffff0000, v94
    v_and_b32 v89, 0xffff0000, v102
    v_pk_mul_f32 v[72:73], v[72:73], v[98:99]
    v_pk_mul_f32 v[88:89], v[88:89], v[106:107]
    v_cvt_pk_bf16_f32 v114, v72, v73
    v_cvt_pk_bf16_f32 v126, v88, v89
    v_lshlrev_b32 v72, 16, v114
    v_lshlrev_b32 v88, 16, v126
    v_and_b32 v73, 0xffff0000, v114
    v_and_b32 v89, 0xffff0000, v126
    v_pk_fma_f32 v[92:93], v[72:73], v[56:57], v[92:93]
    v_pk_fma_f32 v[100:101], v[88:89], v[56:57], v[100:101]
    v_pk_add_f32 v[74:75], v[74:75], v[96:97]
    v_pk_add_f32 v[90:91], v[90:91], v[104:105]
    v_cvt_pk_bf16_f32 v94, v74, v75
    v_cvt_pk_bf16_f32 v102, v90, v91
    v_lshlrev_b32 v74, 16, v94
    v_lshlrev_b32 v90, 16, v102
    v_and_b32 v75, 0xffff0000, v94
    v_and_b32 v91, 0xffff0000, v102
    v_pk_mul_f32 v[74:75], v[74:75], v[98:99]
    v_pk_mul_f32 v[90:91], v[90:91], v[106:107]
    v_cvt_pk_bf16_f32 v115, v74, v75
    v_cvt_pk_bf16_f32 v127, v90, v91
    v_lshlrev_b32 v74, 16, v115
    v_lshlrev_b32 v90, 16, v127
    v_and_b32 v75, 0xffff0000, v115
    v_and_b32 v91, 0xffff0000, v127
    v_pk_fma_f32 v[92:93], v[74:75], v[58:59], v[92:93]
    v_pk_fma_f32 v[100:101], v[90:91], v[58:59], v[100:101]
    v_add_f32 v92, v92, v93
    v_add_f32 v100, v100, v101
    v_xor_b32 v98, 0x80000000, v96
    v_xor_b32 v106, 0x80000000, v104
    s_mul_i32 s36, s60, 2064
    s_mul_i32 s56, s28, 2064
    s_add_u32 s36, s36, 131072
    s_add_u32 s56, s56, 131072
    v_lshl_add_u32 v95, v1, 4, s36
    v_lshl_add_u32 v103, v1, 4, s56
    ds_write_b128 v95, v[108:111]
    ds_write_b128 v103, v[120:123]
    ds_write_b128 v95, v[112:115] offset:1024
    ds_write_b128 v103, v[124:127] offset:1024
    s_nop 0
    v_add_f32_dpp v92, v92, v92 quad_perm:[1,0,3,2] row_mask:0xf bank_mask:0xf
    v_add_f32_dpp v100, v100, v100 quad_perm:[1,0,3,2] row_mask:0xf bank_mask:0xf
    s_nop 0
    v_add_f32_dpp v92, v92, v92 quad_perm:[2,3,0,1] row_mask:0xf bank_mask:0xf
    v_add_f32_dpp v100, v100, v100 quad_perm:[2,3,0,1] row_mask:0xf bank_mask:0xf
    s_nop 0
    v_add_f32_dpp v92, v92, v92 row_half_mirror row_mask:0xf bank_mask:0xf
    v_add_f32_dpp v100, v100, v100 row_half_mirror row_mask:0xf bank_mask:0xf
    s_nop 0
    v_add_f32_dpp v92, v92, v92 row_mirror row_mask:0xf bank_mask:0xf
    v_add_f32_dpp v100, v100, v100 row_mirror row_mask:0xf bank_mask:0xf
    v_readlane_b32 s36, v92, 0
    v_readlane_b32 s56, v100, 0
    v_readlane_b32 s37, v92, 16
    v_readlane_b32 s57, v100, 16
    v_readlane_b32 s38, v92, 32
    v_readlane_b32 s58, v100, 32
    v_readlane_b32 s39, v92, 48
    v_readlane_b32 s59, v100, 48
    v_mov_b32 v93, s36
    v_mov_b32 v101, s56
    v_add_f32 v93, s37, v93
    v_add_f32 v101, s57, v101
    v_add_f32 v93, s38, v93
    v_add_f32 v101, s58, v101
    v_add_f32 v93, s39, v93
    v_add_f32 v101, s59, v101
    v_cvt_pk_bf16_f32 v93, v93, v93
    v_cvt_pk_bf16_f32 v101, v101, v101
    v_lshlrev_b32 v93, 16, v93
    v_lshlrev_b32 v101, 16, v101
    v_ashrrev_i32 v95, 31, v93
    v_ashrrev_i32 v103, 31, v101
    v_or_b32 v95, 0x80000000, v95
    v_or_b32 v103, 0x80000000, v103
    v_xor_b32 v95, v93, v95
    v_xor_b32 v103, v101, v103
    v_and_b32 v95, 0xffff0000, v95
    v_and_b32 v103, 0xffff0000, v103
    s_sub_u32 s36, 0xffff, s42
    s_sub_u32 s56, 0xffff, s43
    v_or_b32 v95, s36, v95
    v_or_b32 v103, s56, v103
    s_lshl_b32 s37, s60, 3
    s_lshl_b32 s57, s28, 3
    s_add_u32 s37, s37, 147712
    s_add_u32 s57, s57, 147712
    v_mov_b32 v94, s37
    v_mov_b32 v102, s57
    ds_write_b64 v94, v[98:99]
    ds_write_b64 v102, v[106:107]
    ds_write_b32 v94, v95 offset:64
    ds_write_b32 v102, v103 offset:64
    s_lshl_b32 s36, s2, 13
    s_lshl_b32 s37, s60, 11
    s_add_u32 s36, s36, s37
    v_lshl_add_u32 v16, v1, 7, s36
    s_cmp_lt_u32 s60, 2
    s_cselect_b64 s[38:39], s[48:49], s[50:51]
    s_lshr_b32 s36, s2, 3
    s_lshl_b32 s36, s36, 1
    s_and_b32 s37, s60, 1
    s_add_u32 s36, s36, s37
    s_lshl_b32 s36, s36, 16
    s_and_b32 s37, s29, 28
    s_lshl_b32 s37, s37, 8
    s_add_u32 s36, s36, s37
    s_sub_u32 s37, 256, s38
    s_and_b32 s37, s37, 0x300
    s_add_u32 s36, s36, s37
    v_lshrrev_b32 v18, 1, v1
    v_lshl_add_u32 v18, v18, 13, s36
    v_and_b32 v19, 1, v1
    v_lshl_add_u32 v18, v19, 7, v18
    s_mov_b64 exec, 0xffff
    global_load_dword v0, v16, s[46:47]
    global_load_dword v0, v18, s[38:39]
    s_mov_b64 exec, -1
    s_waitcnt lgkmcnt(0)
    s_cmp_eq_u32 s3, 0
    s_mov_b32 s3, 0
    s_cbranch_scc0 L_ln
L_pro_j:
    s_barrier
    ds_read_b128 v[20:23], v10 offset:0
    ds_read_b64_tr_b16 v[52:53], v12 offset:0
    ds_read_b64_tr_b16 v[54:55], v12 offset:1024
    ds_read_b64_tr_b16 v[56:57], v13 offset:0
    ds_read_b64_tr_b16 v[58:59], v13 offset:1024
    ds_read_b64_tr_b16 v[60:61], v14 offset:0
    ds_read_b64_tr_b16 v[62:63], v14 offset:1024
    ds_read_b64_tr_b16 v[64:65], v15 offset:0
    ds_read_b64_tr_b16 v[66:67], v15 offset:1024
    ds_read_b128 v[24:27], v10 offset:2048
    ds_read_b128 v[28:31], v10 offset:4096
    ds_read_b128 v[32:35], v10 offset:6144
    ds_read_b128 v[36:39], v10 offset:8192
    ds_read_b128 v[40:43], v10 offset:10240
    ds_read_b128 v[44:47], v10 offset:12288
    ds_read_b128 v[48:51], v10 offset:14336
    s_add_u32 s36, s2, s28
    s_cmp_eq_u32 s36, 0
    s_cbranch_scc1 L_recurrent_scan__compressed_kv_cla__moe_arch_mod__prompt_kernel_rare_3
L_recurrent_scan__compressed_kv_cla__moe_arch_mod__prompt_kernel_back_4:
    s_mov_b32 s35, 0
    s_cmp_eq_u32 s28, 0
    s_cselect_b32 s43, 9, 0
    s_cselect_b32 s44, 2, 1
    s_cmp_lt_u32 s28, 4
    s_cbranch_scc0 L_kv_vloop
    .p2align 6
L_kv_kloop:
    s_waitcnt lgkmcnt(0)
    v_mfma_f32_16x16x32_bf16 v[128:131], v[52:55], v[20:23], v[128:131]
    ds_read_b128 v[68:71], v11 offset:0
    v_mfma_f32_16x16x32_bf16 v[132:135], v[56:59], v[20:23], v[132:135]
    ds_read_b64_tr_b16 v[100:101], v12 offset:8192
    v_mfma_f32_16x16x32_bf16 v[136:139], v[60:63], v[20:23], v[136:139]
    ds_read_b64_tr_b16 v[102:103], v12 offset:9216
    v_mfma_f32_16x16x32_bf16 v[140:143], v[64:67], v[20:23], v[140:143]
    ds_read_b64_tr_b16 v[104:105], v13 offset:8192
    v_mfma_f32_16x16x32_bf16 v[144:147], v[52:55], v[24:27], v[144:147]
    ds_read_b64_tr_b16 v[106:107], v13 offset:9216
    v_mfma_f32_16x16x32_bf16 v[148:151], v[56:59], v[24:27], v[148:151]
    ds_read_b64_tr_b16 v[108:109], v14 offset:8192
    v_mfma_f32_16x16x32_bf16 v[152:155], v[60:63], v[24:27], v[152:155]
    ds_read_b64_tr_b16 v[110:111], v14 offset:9216
    v_mfma_f32_16x16x32_bf16 v[156:159], v[64:67], v[24:27], v[156:159]
    ds_read_b64_tr_b16 v[112:113], v15 offset:8192
    v_mfma_f32_16x16x32_bf16 v[160:163], v[52:55], v[28:31], v[160:163]
    ds_read_b64_tr_b16 v[114:115], v15 offset:9216
    v_mfma_f32_16x16x32_bf16 v[164:167], v[56:59], v[28:31], v[164:167]
    ds_read_b128 v[72:75], v11 offset:2048
    v_mfma_f32_16x16x32_bf16 v[168:171], v[60:63], v[28:31], v[168:171]
    ds_read_b128 v[76:79], v11 offset:4096
    v_mfma_f32_16x16x32_bf16 v[172:175], v[64:67], v[28:31], v[172:175]
    ds_read_b128 v[80:83], v11 offset:6144
    v_mfma_f32_16x16x32_bf16 v[176:179], v[52:55], v[32:35], v[176:179]
    ds_read_b128 v[84:87], v11 offset:8192
    v_mfma_f32_16x16x32_bf16 v[180:183], v[56:59], v[32:35], v[180:183]
    ds_read_b128 v[88:91], v11 offset:10240
    v_mfma_f32_16x16x32_bf16 v[184:187], v[60:63], v[32:35], v[184:187]
    ds_read_b128 v[92:95], v11 offset:12288
    v_mfma_f32_16x16x32_bf16 v[188:191], v[64:67], v[32:35], v[188:191]
    ds_read_b128 v[96:99], v11 offset:14336
    v_mfma_f32_16x16x32_bf16 v[192:195], v[52:55], v[36:39], v[192:195]
    v_mfma_f32_16x16x32_bf16 v[196:199], v[56:59], v[36:39], v[196:199]
    v_mfma_f32_16x16x32_bf16 v[200:203], v[60:63], v[36:39], v[200:203]
    v_mfma_f32_16x16x32_bf16 v[204:207], v[64:67], v[36:39], v[204:207]
    v_mfma_f32_16x16x32_bf16 v[208:211], v[52:55], v[40:43], v[208:211]
    v_mfma_f32_16x16x32_bf16 v[212:215], v[56:59], v[40:43], v[212:215]
    v_mfma_f32_16x16x32_bf16 v[216:219], v[60:63], v[40:43], v[216:219]
    v_mfma_f32_16x16x32_bf16 v[220:223], v[64:67], v[40:43], v[220:223]
    v_mfma_f32_16x16x32_bf16 v[224:227], v[52:55], v[44:47], v[224:227]
    v_mfma_f32_16x16x32_bf16 v[228:231], v[56:59], v[44:47], v[228:231]
    v_mfma_f32_16x16x32_bf16 v[232:235], v[60:63], v[44:47], v[232:235]
    v_mfma_f32_16x16x32_bf16 v[236:239], v[64:67], v[44:47], v[236:239]
    v_mfma_f32_16x16x32_bf16 v[240:243], v[52:55], v[48:51], v[240:243]
    v_mfma_f32_16x16x32_bf16 v[244:247], v[56:59], v[48:51], v[244:247]
    v_mfma_f32_16x16x32_bf16 v[248:251], v[60:63], v[48:51], v[248:251]
    v_mfma_f32_16x16x32_bf16 v[252:255], v[64:67], v[48:51], v[252:255]
    s_cmp_eq_u32 s35, 3
    s_cbranch_scc1 L_recurrent_scan__compressed_kv_cla__moe_arch_mod__prompt_kernel_rare_5
L_recurrent_scan__compressed_kv_cla__moe_arch_mod__prompt_kernel_back_6:
    s_cmp_lt_u32 s35, s44
    s_cbranch_scc1 L_recurrent_scan__compressed_kv_cla__moe_arch_mod__prompt_kernel_w0_7
    s_waitcnt vmcnt(1)
L_recurrent_scan__compressed_kv_cla__moe_arch_mod__prompt_kernel_w0b_8:
    s_waitcnt lgkmcnt(0)
    s_barrier
    v_mfma_f32_16x16x32_bf16 v[128:131], v[100:103], v[68:71], v[128:131]
    ds_read_b128 v[20:23], v10 offset:32768
    s_add_u32 m0, s33, 0
    v_mfma_f32_16x16x32_bf16 v[132:135], v[104:107], v[68:71], v[132:135]
    ds_read_b64_tr_b16 v[52:53], v12 offset:32768
    buffer_load_dwordx4 v2, s[4:7], s31 offen offset:0 lds
    v_mfma_f32_16x16x32_bf16 v[136:139], v[108:111], v[68:71], v[136:139]
    ds_read_b64_tr_b16 v[54:55], v12 offset:33792
    v_mfma_f32_16x16x32_bf16 v[140:143], v[112:115], v[68:71], v[140:143]
    ds_read_b64_tr_b16 v[56:57], v13 offset:32768
    v_mfma_f32_16x16x32_bf16 v[144:147], v[100:103], v[72:75], v[144:147]
    ds_read_b64_tr_b16 v[58:59], v13 offset:33792
    buffer_load_dwordx4 v3, s[4:7], s31 offen offset:1024 lds
    v_mfma_f32_16x16x32_bf16 v[148:151], v[104:107], v[72:75], v[148:151]
    ds_read_b64_tr_b16 v[60:61], v14 offset:32768
    v_mfma_f32_16x16x32_bf16 v[152:155], v[108:111], v[72:75], v[152:155]
    ds_read_b64_tr_b16 v[62:63], v14 offset:33792
    v_mfma_f32_16x16x32_bf16 v[156:159], v[112:115], v[72:75], v[156:159]
    ds_read_b64_tr_b16 v[64:65], v15 offset:32768
    buffer_load_dwordx4 v4, s[4:7], s31 offen offset:2048 lds
    v_mfma_f32_16x16x32_bf16 v[160:163], v[100:103], v[76:79], v[160:163]
    ds_read_b64_tr_b16 v[66:67], v15 offset:33792
    v_mfma_f32_16x16x32_bf16 v[164:167], v[104:107], v[76:79], v[164:167]
    ds_read_b128 v[24:27], v10 offset:34816
    v_mfma_f32_16x16x32_bf16 v[168:171], v[108:111], v[76:79], v[168:171]
    ds_read_b128 v[28:31], v10 offset:36864
    buffer_load_dwordx4 v5, s[4:7], s31 offen offset:3072 lds
    v_mfma_f32_16x16x32_bf16 v[172:175], v[112:115], v[76:79], v[172:175]
    ds_read_b128 v[32:35], v10 offset:38912
    v_mfma_f32_16x16x32_bf16 v[176:179], v[100:103], v[80:83], v[176:179]
    ds_read_b128 v[36:39], v10 offset:40960
    s_add_u32 m0, s34, 0
    v_mfma_f32_16x16x32_bf16 v[180:183], v[104:107], v[80:83], v[180:183]
    ds_read_b128 v[40:43], v10 offset:43008
    buffer_load_dwordx4 v6, s[8:11], s32 offen offset:0 nt lds
    v_mfma_f32_16x16x32_bf16 v[184:187], v[108:111], v[80:83], v[184:187]
    ds_read_b128 v[44:47], v10 offset:45056
    v_mfma_f32_16x16x32_bf16 v[188:191], v[112:115], v[80:83], v[188:191]
    ds_read_b128 v[48:51], v10 offset:47104
    v_mfma_f32_16x16x32_bf16 v[192:195], v[100:103], v[84:87], v[192:195]
    buffer_load_dwordx4 v7, s[8:11], s32 offen offset:1024 nt lds
    v_mfma_f32_16x16x32_bf16 v[196:199], v[104:107], v[84:87], v[196:199]
    v_mfma_f32_16x16x32_bf16 v[200:203], v[108:111], v[84:87], v[200:203]
    v_mfma_f32_16x16x32_bf16 v[204:207], v[112:115], v[84:87], v[204:207]
    buffer_load_dwordx4 v8, s[8:11], s32 offen offset:2048 nt lds
    v_mfma_f32_16x16x32_bf16 v[208:211], v[100:103], v[88:91], v[208:211]
    v_mfma_f32_16x16x32_bf16 v[212:215], v[104:107], v[88:91], v[212:215]
    v_mfma_f32_16x16x32_bf16 v[216:219], v[108:111], v[88:91], v[216:219]
    buffer_load_dwordx4 v9, s[8:11], s32 offen offset:3072 nt lds
    v_mfma_f32_16x16x32_bf16 v[220:223], v[112:115], v[88:91], v[220:223]
    v_mfma_f32_16x16x32_bf16 v[224:227], v[100:103], v[92:95], v[224:227]
    v_mfma_f32_16x16x32_bf16 v[228:231], v[104:107], v[92:95], v[228:231]
    v_mfma_f32_16x16x32_bf16 v[232:235], v[108:111], v[92:95], v[232:235]
    s_cmp_eq_u32 s35, 3
    s_cbranch_scc1 L_recurrent_scan__compressed_kv_cla__moe_arch_mod__prompt_kernel_rare_11
L_recurrent_scan__compressed_kv_cla__moe_arch_mod__prompt_kernel_back_12:
    v_mfma_f32_16x16x32_bf16 v[236:239], v[112:115], v[92:95], v[236:239]
    v_mfma_f32_16x16x32_bf16 v[240:243], v[100:103], v[96:99], v[240:243]
    v_mfma_f32_16x16x32_bf16 v[244:247], v[104:107], v[96:99], v[244:247]
    v_mfma_f32_16x16x32_bf16 v[248:251], v[108:111], v[96:99], v[248:251]
    v_mfma_f32_16x16x32_bf16 v[252:255], v[112:115], v[96:99], v[252:255]
    buffer_load_dword v0, v17, s[16:19], s45 offen
    s_add_u32 s45, s45, 8192
    s_add_u32 s31, s31, s40
    s_add_u32 s32, s32, s41
    s_waitcnt lgkmcnt(0)
    v_mfma_f32_16x16x32_bf16 v[128:131], v[52:55], v[20:23], v[128:131]
    ds_read_b128 v[68:71], v11 offset:32768
    v_mfma_f32_16x16x32_bf16 v[132:135], v[56:59], v[20:23], v[132:135]
    ds_read_b64_tr_b16 v[100:101], v12 offset:40960
    v_mfma_f32_16x16x32_bf16 v[136:139], v[60:63], v[20:23], v[136:139]
    ds_read_b64_tr_b16 v[102:103], v12 offset:41984
    v_mfma_f32_16x16x32_bf16 v[140:143], v[64:67], v[20:23], v[140:143]
    ds_read_b64_tr_b16 v[104:105], v13 offset:40960
    v_mfma_f32_16x16x32_bf16 v[144:147], v[52:55], v[24:27], v[144:147]
    ds_read_b64_tr_b16 v[106:107], v13 offset:41984
    v_mfma_f32_16x16x32_bf16 v[148:151], v[56:59], v[24:27], v[148:151]
    ds_read_b64_tr_b16 v[108:109], v14 offset:40960
    v_mfma_f32_16x16x32_bf16 v[152:155], v[60:63], v[24:27], v[152:155]
    ds_read_b64_tr_b16 v[110:111], v14 offset:41984
    v_mfma_f32_16x16x32_bf16 v[156:159], v[64:67], v[24:27], v[156:159]
    ds_read_b64_tr_b16 v[112:113], v15 offset:40960
    v_mfma_f32_16x16x32_bf16 v[160:163], v[52:55], v[28:31], v[160:163]
    ds_read_b64_tr_b16 v[114:115], v15 offset:41984
    v_mfma_f32_16x16x32_bf16 v[164:167], v[56:59], v[28:31], v[164:167]
    ds_read_b128 v[72:75], v11 offset:34816
    v_mfma_f32_16x16x32_bf16 v[168:171], v[60:63], v[28:31], v[168:171]
    ds_read_b128 v[76:79], v11 offset:36864
    v_mfma_f32_16x16x32_bf16 v[172:175], v[64:67], v[28:31], v[172:175]
    ds_read_b128 v[80:83], v11 offset:38912
    v_mfma_f32_16x16x32_bf16 v[176:179], v[52:55], v[32:35], v[176:179]
    ds_read_b128 v[84:87], v11 offset:40960
    v_mfma_f32_16x16x32_bf16 v[180:183], v[56:59], v[32:35], v[180:183]
    ds_read_b128 v[88:91], v11 offset:43008
    v_mfma_f32_16x16x32_bf16 v[184:187], v[60:63], v[32:35], v[184:187]
    ds_read_b128 v[92:95], v11 offset:45056
    v_mfma_f32_16x16x32_bf16 v[188:191], v[64:67], v[32:35], v[188:191]
    ds_read_b128 v[96:99], v11 offset:47104
    v_mfma_f32_16x16x32_bf16 v[192:195], v[52:55], v[36:39], v[192:195]
    v_mfma_f32_16x16x32_bf16 v[196:199], v[56:59], v[36:39], v[196:199]
    v_mfma_f32_16x16x32_bf16 v[200:203], v[60:63], v[36:39], v[200:203]
    v_mfma_f32_16x16x32_bf16 v[204:207], v[64:67], v[36:39], v[204:207]
    v_mfma_f32_16x16x32_bf16 v[208:211], v[52:55], v[40:43], v[208:211]
    s_bitcmp1_b32 s43, s35
    s_cbranch_scc1 L_recurrent_scan__compressed_kv_cla__moe_arch_mod__prompt_kernel_rare_15
L_recurrent_scan__compressed_kv_cla__moe_arch_mod__prompt_kernel_back_16:
    v_mfma_f32_16x16x32_bf16 v[212:215], v[56:59], v[40:43], v[212:215]
    v_mfma_f32_16x16x32_bf16 v[216:219], v[60:63], v[40:43], v[216:219]
    v_mfma_f32_16x16x32_bf16 v[220:223], v[64:67], v[40:43], v[220:223]
    v_mfma_f32_16x16x32_bf16 v[224:227], v[52:55], v[44:47], v[224:227]
    v_mfma_f32_16x16x32_bf16 v[228:231], v[56:59], v[44:47], v[228:231]
    v_mfma_f32_16x16x32_bf16 v[232:235], v[60:63], v[44:47], v[232:235]
    v_mfma_f32_16x16x32_bf16 v[236:239], v[64:67], v[44:47], v[236:239]
    v_mfma_f32_16x16x32_bf16 v[240:243], v[52:55], v[48:51], v[240:243]
    v_mfma_f32_16x16x32_bf16 v[244:247], v[56:59], v[48:51], v[244:247]
    v_mfma_f32_16x16x32_bf16 v[248:251], v[60:63], v[48:51], v[248:251]
    v_mfma_f32_16x16x32_bf16 v[252:255], v[64:67], v[48:51], v[252:255]
    s_bitcmp1_b32 s43, s35
    s_cbranch_scc1 L_recurrent_scan__compressed_kv_cla__moe_arch_mod__prompt_kernel_w0_17
    s_waitcnt vmcnt(1)
L_recurrent_scan__compressed_kv_cla__moe_arch_mod__prompt_kernel_w0b_18:
    s_waitcnt lgkmcnt(0)
    s_cmp_eq_u32 s35, 3
    s_barrier
    s_cbranch_scc1 L_p1_fin0
    v_mfma_f32_16x16x32_bf16 v[128:131], v[100:103], v[68:71], v[128:131]
    ds_read_b128 v[20:23], v10 offset:0
    s_add_u32 m0, s33, 32768
    v_mfma_f32_16x16x32_bf16 v[132:135], v[104:107], v[68:71], v[132:135]
    ds_read_b64_tr_b16 v[52:53], v12 offset:0
    buffer_load_dwordx4 v2, s[4:7], s31 offen offset:0 lds
    v_mfma_f32_16x16x32_bf16 v[136:139], v[108:111], v[68:71], v[136:139]
    ds_read_b64_tr_b16 v[54:55], v12 offset:1024
    v_mfma_f32_16x16x32_bf16 v[140:143], v[112:115], v[68:71], v[140:143]
    ds_read_b64_tr_b16 v[56:57], v13 offset:0
    v_mfma_f32_16x16x32_bf16 v[144:147], v[100:103], v[72:75], v[144:147]
    ds_read_b64_tr_b16 v[58:59], v13 offset:1024
    buffer_load_dwordx4 v3, s[4:7], s31 offen offset:1024 lds
    v_mfma_f32_16x16x32_bf16 v[148:151], v[104:107], v[72:75], v[148:151]
    ds_read_b64_tr_b16 v[60:61], v14 offset:0
    v_mfma_f32_16x16x32_bf16 v[152:155], v[108:111], v[72:75], v[152:155]
    ds_read_b64_tr_b16 v[62:63], v14 offset:1024
    v_mfma_f32_16x16x32_bf16 v[156:159], v[112:115], v[72:75], v[156:159]
    ds_read_b64_tr_b16 v[64:65], v15 offset:0
    buffer_load_dwordx4 v4, s[4:7], s31 offen offset:2048 lds
    v_mfma_f32_16x16x32_bf16 v[160:163], v[100:103], v[76:79], v[160:163]
    ds_read_b64_tr_b16 v[66:67], v15 offset:1024
    v_mfma_f32_16x16x32_bf16 v[164:167], v[104:107], v[76:79], v[164:167]
    ds_read_b128 v[24:27], v10 offset:2048
    v_mfma_f32_16x16x32_bf16 v[168:171], v[108:111], v[76:79], v[168:171]
    ds_read_b128 v[28:31], v10 offset:4096
    buffer_load_dwordx4 v5, s[4:7], s31 offen offset:3072 lds
    v_mfma_f32_16x16x32_bf16 v[172:175], v[112:115], v[76:79], v[172:175]
    ds_read_b128 v[32:35], v10 offset:6144
    v_mfma_f32_16x16x32_bf16 v[176:179], v[100:103], v[80:83], v[176:179]
    ds_read_b128 v[36:39], v10 offset:8192
    s_add_u32 m0, s34, 32768
    v_mfma_f32_16x16x32_bf16 v[180:183], v[104:107], v[80:83], v[180:183]
    ds_read_b128 v[40:43], v10 offset:10240
    buffer_load_dwordx4 v6, s[8:11], s32 offen offset:0 nt lds
    v_mfma_f32_16x16x32_bf16 v[184:187], v[108:111], v[80:83], v[184:187]
    ds_read_b128 v[44:47], v10 offset:12288
    v_mfma_f32_16x16x32_bf16 v[188:191], v[112:115], v[80:83], v[188:191]
    ds_read_b128 v[48:51], v10 offset:14336
    v_mfma_f32_16x16x32_bf16 v[192:195], v[100:103], v[84:87], v[192:195]
    buffer_load_dwordx4 v7, s[8:11], s32 offen offset:1024 nt lds
    v_mfma_f32_16x16x32_bf16 v[196:199], v[104:107], v[84:87], v[196:199]
    v_mfma_f32_16x16x32_bf16 v[200:203], v[108:111], v[84:87], v[200:203]
    v_mfma_f32_16x16x32_bf16 v[204:207], v[112:115], v[84:87], v[204:207]
    buffer_load_dwordx4 v8, s[8:11], s32 offen offset:2048 nt lds
    v_mfma_f32_16x16x32_bf16 v[208:211], v[100:103], v[88:91], v[208:211]
    v_mfma_f32_16x16x32_bf16 v[212:215], v[104:107], v[88:91], v[212:215]
    v_mfma_f32_16x16x32_bf16 v[216:219], v[108:111], v[88:91], v[216:219]
    buffer_load_dwordx4 v9, s[8:11], s32 offen offset:3072 nt lds
    v_mfma_f32_16x16x32_bf16 v[220:223], v[112:115], v[88:91], v[220:223]
    v_mfma_f32_16x16x32_bf16 v[224:227], v[100:103], v[92:95], v[224:227]
    v_mfma_f32_16x16x32_bf16 v[228:231], v[104:107], v[92:95], v[228:231]
    v_mfma_f32_16x16x32_bf16 v[232:235], v[108:111], v[92:95], v[232:235]
    v_mfma_f32_16x16x32_bf16 v[236:239], v[112:115], v[92:95], v[236:239]
    v_mfma_f32_16x16x32_bf16 v[240:243], v[100:103], v[96:99], v[240:243]
    v_mfma_f32_16x16x32_bf16 v[244:247], v[104:107], v[96:99], v[244:247]
    v_mfma_f32_16x16x32_bf16 v[248:251], v[108:111], v[96:99], v[248:251]
    s_add_u32 s36, s35, s28
    s_cmp_eq_u32 s36, 0
    s_cbranch_scc1 L_recurrent_scan__compressed_kv_cla__moe_arch_mod__prompt_kernel_rare_27
L_recurrent_scan__compressed_kv_cla__moe_arch_mod__prompt_kernel_back_28:
    v_mfma_f32_16x16x32_bf16 v[252:255], v[112:115], v[96:99], v[252:255]
    buffer_load_dword v0, v17, s[16:19], s45 offen
    s_add_u32 s45, s45, 8192
    s_add_u32 s31, s31, s40
    s_add_u32 s32, s32, s41
    s_add_u32 s35, s35, 1
    s_branch L_kv_kloop
L_p1_fin0:
    v_mfma_f32_16x16x32_bf16 v[128:131], v[100:103], v[68:71], v[128:131]
    s_and_b32 s36, s28, 3
    s_sub_u32 s37, 15, s30
    s_cmp_lt_u32 s28, 4
    s_cselect_b32 s37, s37, s30
    s_lshl_b32 s37, s37, 2
    s_add_u32 s37, s37, s36
    s_lshl_b32 s37, s37, 16
    v_lshl_add_u32 v6, v1, 4, s37
    v_add_u32 v7, 32768, v6
    s_mov_b32 s32, 0
    s_mov_b32 s8, s54
    s_and_b32 s9, s55, 0xffff
    s_mov_b32 s10, 104857728
    s_mov_b32 s11, 0x20000
    v_mfma_f32_16x16x32_bf16 v[132:135], v[104:107], v[68:71], v[132:135]
    buffer_load_dwordx4 v[24:27], v6, s[8:11], s32 offen offset:0 sc1
    v_mfma_f32_16x16x32_bf16 v[136:139], v[108:111], v[68:71], v[136:139]
    v_lshrrev_b32 v18, 4, v1
    v_mfma_f32_16x16x32_bf16 v[140:143], v[112:115], v[68:71], v[140:143]
    v_bfe_u32 v20, v1, 2, 2
    v_mfma_f32_16x16x32_bf16 v[144:147], v[100:103], v[72:75], v[144:147]
    buffer_load_dwordx4 v[28:31], v7, s[8:11], s32 offen offset:0 sc1
    v_lshl_add_u32 v19, v18, 3, v20
    v_mfma_f32_16x16x32_bf16 v[148:151], v[104:107], v[72:75], v[148:151]
    v_lshlrev_b32 v19, 8, v19
    v_mfma_f32_16x16x32_bf16 v[152:155], v[108:111], v[72:75], v[152:155]
    v_and_b32 v21, 3, v1
    v_mfma_f32_16x16x32_bf16 v[156:159], v[112:115], v[72:75], v[156:159]
    buffer_load_dwordx4 v[32:35], v6, s[8:11], s32 offen offset:1024 sc1
    v_lshl_add_u32 v19, v21, 3, v19
    v_mfma_f32_16x16x32_bf16 v[160:163], v[100:103], v[76:79], v[160:163]
    v_and_b32 v21, 1, v18
    v_mfma_f32_16x16x32_bf16 v[164:167], v[104:107], v[76:79], v[164:167]
    v_lshl_add_u32 v20, v21, 2, v20
    v_mfma_f32_16x16x32_bf16 v[168:171], v[108:111], v[76:79], v[168:171]
    buffer_load_dwordx4 v[36:39], v7, s[8:11], s32 offen offset:1024 sc1
    v_xor_b32 v21, 0, v20
    v_mfma_f32_16x16x32_bf16 v[172:175], v[112:115], v[76:79], v[172:175]
    v_lshl_add_u32 v10, v21, 5, v19
    v_mfma_f32_16x16x32_bf16 v[176:179], v[100:103], v[80:83], v[176:179]
    v_xor_b32 v21, 1, v20
    v_mfma_f32_16x16x32_bf16 v[180:183], v[104:107], v[80:83], v[180:183]
    buffer_load_dwordx4 v[40:43], v6, s[8:11], s32 offen offset:2048 sc1
    v_lshl_add_u32 v11, v21, 5, v19
    v_mfma_f32_16x16x32_bf16 v[184:187], v[108:111], v[80:83], v[184:187]
    v_xor_b32 v21, 2, v20
    v_mfma_f32_16x16x32_bf16 v[188:191], v[112:115], v[80:83], v[188:191]
    v_lshl_add_u32 v12, v21, 5, v19
    v_mfma_f32_16x16x32_bf16 v[192:195], v[100:103], v[84:87], v[192:195]
    buffer_load_dwordx4 v[44:47], v7, s[8:11], s32 offen offset:2048 sc1
    v_xor_b32 v21, 3, v20
    v_mfma_f32_16x16x32_bf16 v[196:199], v[104:107], v[84:87], v[196:199]
    v_lshl_add_u32 v13, v21, 5, v19
    v_mfma_f32_16x16x32_bf16 v[200:203], v[108:111], v[84:87], v[200:203]
    v_xor_b32 v21, 4, v20
    v_mfma_f32_16x16x32_bf16 v[204:207], v[112:115], v[84:87], v[204:207]
    buffer_load_dwordx4 v[48:51], v6, s[8:11], s32 offen offset:3072 sc1
    v_lshl_add_u32 v14, v21, 5, v19
    v_mfma_f32_16x16x32_bf16 v[208:211], v[100:103], v[88:91], v[208:211]
    v_xor_b32 v21, 5, v20
    v_mfma_f32_16x16x32_bf16 v[212:215], v[104:107], v[88:91], v[212:215]
    v_lshl_add_u32 v15, v21, 5, v19
    v_mfma_f32_16x16x32_bf16 v[216:219], v[108:111], v[88:91], v[216:219]
    buffer_load_dwordx4 v[52:55], v7, s[8:11], s32 offen offset:3072 sc1
    v_xor_b32 v21, 6, v20
    v_mfma_f32_16x16x32_bf16 v[220:223], v[112:115], v[88:91], v[220:223]
    v_lshl_add_u32 v16, v21, 5, v19
    v_mfma_f32_16x16x32_bf16 v[224:227], v[100:103], v[92:95], v[224:227]
    v_xor_b32 v21, 7, v20
    v_mfma_f32_16x16x32_bf16 v[228:231], v[104:107], v[92:95], v[228:231]
    v_lshl_add_u32 v17, v21, 5, v19
    v_mfma_f32_16x16x32_bf16 v[232:235], v[108:111], v[92:95], v[232:235]
    s_lshl_b32 s45, s29, 20
    v_mfma_f32_16x16x32_bf16 v[236:239], v[112:115], v[92:95], v[236:239]
    v_mfma_f32_16x16x32_bf16 v[240:243], v[100:103], v[96:99], v[240:243]
    v_mfma_f32_16x16x32_bf16 v[244:247], v[104:107], v[96:99], v[244:247]
    v_mfma_f32_16x16x32_bf16 v[248:251], v[108:111], v[96:99], v[248:251]
    v_mfma_f32_16x16x32_bf16 v[252:255], v[112:115], v[96:99], v[252:255]
    s_branch L_p1_done
    .p2align 6
L_kv_vloop:
    s_waitcnt lgkmcnt(0)
    v_mfma_f32_16x16x32_bf16 v[128:131], v[20:23], v[52:55], v[128:131]
    ds_read_b128 v[68:71], v11 offset:0
    v_mfma_f32_16x16x32_bf16 v[160:163], v[20:23], v[56:59], v[160:163]
    ds_read_b64_tr_b16 v[100:101], v12 offset:8192
    v_mfma_f32_16x16x32_bf16 v[192:195], v[20:23], v[60:63], v[192:195]
    ds_read_b64_tr_b16 v[102:103], v12 offset:9216
    v_mfma_f32_16x16x32_bf16 v[224:227], v[20:23], v[64:67], v[224:227]
    ds_read_b64_tr_b16 v[104:105], v13 offset:8192
    v_mfma_f32_16x16x32_bf16 v[132:135], v[24:27], v[52:55], v[132:135]
    ds_read_b64_tr_b16 v[106:107], v13 offset:9216
    v_mfma_f32_16x16x32_bf16 v[164:167], v[24:27], v[56:59], v[164:167]
    ds_read_b64_tr_b16 v[108:109], v14 offset:8192
    v_mfma_f32_16x16x32_bf16 v[196:199], v[24:27], v[60:63], v[196:199]
    ds_read_b64_tr_b16 v[110:111], v14 offset:9216
    v_mfma_f32_16x16x32_bf16 v[228:231], v[24:27], v[64:67], v[228:231]
    ds_read_b64_tr_b16 v[112:113], v15 offset:8192
    v_mfma_f32_16x16x32_bf16 v[136:139], v[28:31], v[52:55], v[136:139]
    ds_read_b64_tr_b16 v[114:115], v15 offset:9216
    v_mfma_f32_16x16x32_bf16 v[168:171], v[28:31], v[56:59], v[168:171]
    ds_read_b128 v[72:75], v11 offset:2048
    v_mfma_f32_16x16x32_bf16 v[200:203], v[28:31], v[60:63], v[200:203]
    ds_read_b128 v[76:79], v11 offset:4096
    v_mfma_f32_16x16x32_bf16 v[232:235], v[28:31], v[64:67], v[232:235]
    ds_read_b128 v[80:83], v11 offset:6144
    v_mfma_f32_16x16x32_bf16 v[140:143], v[32:35], v[52:55], v[140:143]
    ds_read_b128 v[84:87], v11 offset:8192
    v_mfma_f32_16x16x32_bf16 v[172:175], v[32:35], v[56:59], v[172:175]
    ds_read_b128 v[88:91], v11 offset:10240
    v_mfma_f32_16x16x32_bf16 v[204:207], v[32:35], v[60:63], v[204:207]
    ds_read_b128 v[92:95], v11 offset:12288
    v_mfma_f32_16x16x32_bf16 v[236:239], v[32:35], v[64:67], v[236:239]
    ds_read_b128 v[96:99], v11 offset:14336
    v_mfma_f32_16x16x32_bf16 v[144:147], v[36:39], v[52:55], v[144:147]
    v_mfma_f32_16x16x32_bf16 v[176:179], v[36:39], v[56:59], v[176:179]
    v_mfma_f32_16x16x32_bf16 v[208:211], v[36:39], v[60:63], v[208:211]
    v_mfma_f32_16x16x32_bf16 v[240:243], v[36:39], v[64:67], v[240:243]
    v_mfma_f32_16x16x32_bf16 v[148:151], v[40:43], v[52:55], v[148:151]
    v_mfma_f32_16x16x32_bf16 v[180:183], v[40:43], v[56:59], v[180:183]
    v_mfma_f32_16x16x32_bf16 v[212:215], v[40:43], v[60:63], v[212:215]
    v_mfma_f32_16x16x32_bf16 v[244:247], v[40:43], v[64:67], v[244:247]
    v_mfma_f32_16x16x32_bf16 v[152:155], v[44:47], v[52:55], v[152:155]
    v_mfma_f32_16x16x32_bf16 v[184:187], v[44:47], v[56:59], v[184:187]
    v_mfma_f32_16x16x32_bf16 v[216:219], v[44:47], v[60:63], v[216:219]
    v_mfma_f32_16x16x32_bf16 v[248:251], v[44:47], v[64:67], v[248:251]
    v_mfma_f32_16x16x32_bf16 v[156:159], v[48:51], v[52:55], v[156:159]
    v_mfma_f32_16x16x32_bf16 v[188:191], v[48:51], v[56:59], v[188:191]
    v_mfma_f32_16x16x32_bf16 v[220:223], v[48:51], v[60:63], v[220:223]
    v_mfma_f32_16x16x32_bf16 v[252:255], v[48:51], v[64:67], v[252:255]
    s_cmp_lt_u32 s35, s44
    s_cbranch_scc1 L_recurrent_scan__compressed_kv_cla__moe_arch_mod__prompt_kernel_w0_29
    s_waitcnt vmcnt(1)
L_recurrent_scan__compressed_kv_cla__moe_arch_mod__prompt_kernel_w0b_30:
    s_waitcnt lgkmcnt(0)
    s_barrier
    s_add_u32 m0, s33, 0
    s_nop 0
    buffer_load_dwordx4 v2, s[4:7], s31 offen offset:0 lds
    buffer_load_dwordx4 v3, s[4:7], s31 offen offset:1024 lds
    buffer_load_dwordx4 v4, s[4:7], s31 offen offset:2048 lds
    buffer_load_dwordx4 v5, s[4:7], s31 offen offset:3072 lds
    s_add_u32 m0, s34, 0
    s_nop 0
    buffer_load_dwordx4 v6, s[8:11], s32 offen offset:0 nt lds
    buffer_load_dwordx4 v7, s[8:11], s32 offen offset:1024 nt lds
    buffer_load_dwordx4 v8, s[8:11], s32 offen offset:2048 nt lds
    buffer_load_dwordx4 v9, s[8:11], s32 offen offset:3072 nt lds
    s_add_u32 s31, s31, s40
    s_add_u32 s32, s32, s41
    s_cmp_eq_u32 s35, 0
    s_cbranch_scc1 L_recurrent_scan__compressed_kv_cla__moe_arch_mod__prompt_kernel_rare_36
L_recurrent_scan__compressed_kv_cla__moe_arch_mod__prompt_kernel_back_37:
    v_mfma_f32_16x16x32_bf16 v[128:131], v[68:71], v[100:103], v[128:131]
    ds_read_b128 v[20:23], v10 offset:32768
    v_mfma_f32_16x16x32_bf16 v[160:163], v[68:71], v[104:107], v[160:163]
    ds_read_b64_tr_b16 v[52:53], v12 offset:32768
    v_mfma_f32_16x16x32_bf16 v[192:195], v[68:71], v[108:111], v[192:195]
    ds_read_b64_tr_b16 v[54:55], v12 offset:33792
    v_mfma_f32_16x16x32_bf16 v[224:227], v[68:71], v[112:115], v[224:227]
    ds_read_b64_tr_b16 v[56:57], v13 offset:32768
    v_mfma_f32_16x16x32_bf16 v[132:135], v[72:75], v[100:103], v[132:135]
    ds_read_b64_tr_b16 v[58:59], v13 offset:33792
    v_mfma_f32_16x16x32_bf16 v[164:167], v[72:75], v[104:107], v[164:167]
    ds_read_b64_tr_b16 v[60:61], v14 offset:32768
    v_mfma_f32_16x16x32_bf16 v[196:199], v[72:75], v[108:111], v[196:199]
    ds_read_b64_tr_b16 v[62:63], v14 offset:33792
    v_mfma_f32_16x16x32_bf16 v[228:231], v[72:75], v[112:115], v[228:231]
    ds_read_b64_tr_b16 v[64:65], v15 offset:32768
    v_mfma_f32_16x16x32_bf16 v[136:139], v[76:79], v[100:103], v[136:139]
    ds_read_b64_tr_b16 v[66:67], v15 offset:33792
    v_mfma_f32_16x16x32_bf16 v[168:171], v[76:79], v[104:107], v[168:171]
    ds_read_b128 v[24:27], v10 offset:34816
    v_mfma_f32_16x16x32_bf16 v[200:203], v[76:79], v[108:111], v[200:203]
    ds_read_b128 v[28:31], v10 offset:36864
    v_mfma_f32_16x16x32_bf16 v[232:235], v[76:79], v[112:115], v[232:235]
    ds_read_b128 v[32:35], v10 offset:38912
    v_mfma_f32_16x16x32_bf16 v[140:143], v[80:83], v[100:103], v[140:143]
    ds_read_b128 v[36:39], v10 offset:40960
    v_mfma_f32_16x16x32_bf16 v[172:175], v[80:83], v[104:107], v[172:175]
    ds_read_b128 v[40:43], v10 offset:43008
    v_mfma_f32_16x16x32_bf16 v[204:207], v[80:83], v[108:111], v[204:207]
    ds_read_b128 v[44:47], v10 offset:45056
    v_mfma_f32_16x16x32_bf16 v[236:239], v[80:83], v[112:115], v[236:239]
    ds_read_b128 v[48:51], v10 offset:47104
    v_mfma_f32_16x16x32_bf16 v[144:147], v[84:87], v[100:103], v[144:147]
    v_mfma_f32_16x16x32_bf16 v[176:179], v[84:87], v[104:107], v[176:179]
    v_mfma_f32_16x16x32_bf16 v[208:211], v[84:87], v[108:111], v[208:211]
    v_mfma_f32_16x16x32_bf16 v[240:243], v[84:87], v[112:115], v[240:243]
    v_mfma_f32_16x16x32_bf16 v[148:151], v[88:91], v[100:103], v[148:151]
    v_mfma_f32_16x16x32_bf16 v[180:183], v[88:91], v[104:107], v[180:183]
    v_mfma_f32_16x16x32_bf16 v[212:215], v[88:91], v[108:111], v[212:215]
    v_mfma_f32_16x16x32_bf16 v[244:247], v[88:91], v[112:115], v[244:247]
    v_mfma_f32_16x16x32_bf16 v[152:155], v[92:95], v[100:103], v[152:155]
    v_mfma_f32_16x16x32_bf16 v[184:187], v[92:95], v[104:107], v[184:187]
    v_mfma_f32_16x16x32_bf16 v[216:219], v[92:95], v[108:111], v[216:219]
    s_cmp_eq_u32 s35, 3
    s_cbranch_scc1 L_recurrent_scan__compressed_kv_cla__moe_arch_mod__prompt_kernel_rare_33
L_recurrent_scan__compressed_kv_cla__moe_arch_mod__prompt_kernel_back_34:
    v_mfma_f32_16x16x32_bf16 v[248:251], v[92:95], v[112:115], v[248:251]
    v_mfma_f32_16x16x32_bf16 v[156:159], v[96:99], v[100:103], v[156:159]
    v_mfma_f32_16x16x32_bf16 v[188:191], v[96:99], v[104:107], v[188:191]
    v_mfma_f32_16x16x32_bf16 v[220:223], v[96:99], v[108:111], v[220:223]
    v_mfma_f32_16x16x32_bf16 v[252:255], v[96:99], v[112:115], v[252:255]
    buffer_load_dword v0, v17, s[16:19], s45 offen
    s_add_u32 s45, s45, 8192
    s_waitcnt lgkmcnt(0)
    v_mfma_f32_16x16x32_bf16 v[128:131], v[20:23], v[52:55], v[128:131]
    ds_read_b128 v[68:71], v11 offset:32768
    v_mfma_f32_16x16x32_bf16 v[160:163], v[20:23], v[56:59], v[160:163]
    ds_read_b64_tr_b16 v[100:101], v12 offset:40960
    v_mfma_f32_16x16x32_bf16 v[192:195], v[20:23], v[60:63], v[192:195]
    ds_read_b64_tr_b16 v[102:103], v12 offset:41984
    v_mfma_f32_16x16x32_bf16 v[224:227], v[20:23], v[64:67], v[224:227]
    ds_read_b64_tr_b16 v[104:105], v13 offset:40960
    v_mfma_f32_16x16x32_bf16 v[132:135], v[24:27], v[52:55], v[132:135]
    ds_read_b64_tr_b16 v[106:107], v13 offset:41984
    v_mfma_f32_16x16x32_bf16 v[164:167], v[24:27], v[56:59], v[164:167]
    ds_read_b64_tr_b16 v[108:109], v14 offset:40960
    v_mfma_f32_16x16x32_bf16 v[196:199], v[24:27], v[60:63], v[196:199]
    ds_read_b64_tr_b16 v[110:111], v14 offset:41984
    v_mfma_f32_16x16x32_bf16 v[228:231], v[24:27], v[64:67], v[228:231]
    ds_read_b64_tr_b16 v[112:113], v15 offset:40960
    v_mfma_f32_16x16x32_bf16 v[136:139], v[28:31], v[52:55], v[136:139]
    ds_read_b64_tr_b16 v[114:115], v15 offset:41984
    v_mfma_f32_16x16x32_bf16 v[168:171], v[28:31], v[56:59], v[168:171]
    ds_read_b128 v[72:75], v11 offset:34816
    v_mfma_f32_16x16x32_bf16 v[200:203], v[28:31], v[60:63], v[200:203]
    ds_read_b128 v[76:79], v11 offset:36864
    v_mfma_f32_16x16x32_bf16 v[232:235], v[28:31], v[64:67], v[232:235]
    ds_read_b128 v[80:83], v11 offset:38912
    v_mfma_f32_16x16x32_bf16 v[140:143], v[32:35], v[52:55], v[140:143]
    ds_read_b128 v[84:87], v11 offset:40960
    v_mfma_f32_16x16x32_bf16 v[172:175], v[32:35], v[56:59], v[172:175]
    ds_read_b128 v[88:91], v11 offset:43008
    v_mfma_f32_16x16x32_bf16 v[204:207], v[32:35], v[60:63], v[204:207]
    ds_read_b128 v[92:95], v11 offset:45056
    v_mfma_f32_16x16x32_bf16 v[236:239], v[32:35], v[64:67], v[236:239]
    ds_read_b128 v[96:99], v11 offset:47104
    v_mfma_f32_16x16x32_bf16 v[144:147], v[36:39], v[52:55], v[144:147]
    v_mfma_f32_16x16x32_bf16 v[176:179], v[36:39], v[56:59], v[176:179]
    v_mfma_f32_16x16x32_bf16 v[208:211], v[36:39], v[60:63], v[208:211]
    v_mfma_f32_16x16x32_bf16 v[240:243], v[36:39], v[64:67], v[240:243]
    v_mfma_f32_16x16x32_bf16 v[148:151], v[40:43], v[52:55], v[148:151]
    v_mfma_f32_16x16x32_bf16 v[180:183], v[40:43], v[56:59], v[180:183]
    v_mfma_f32_16x16x32_bf16 v[212:215], v[40:43], v[60:63], v[212:215]
    v_mfma_f32_16x16x32_bf16 v[244:247], v[40:43], v[64:67], v[244:247]
    v_mfma_f32_16x16x32_bf16 v[152:155], v[44:47], v[52:55], v[152:155]
    v_mfma_f32_16x16x32_bf16 v[184:187], v[44:47], v[56:59], v[184:187]
    v_mfma_f32_16x16x32_bf16 v[216:219], v[44:47], v[60:63], v[216:219]
    v_mfma_f32_16x16x32_bf16 v[248:251], v[44:47], v[64:67], v[248:251]
    v_mfma_f32_16x16x32_bf16 v[156:159], v[48:51], v[52:55], v[156:159]
    v_mfma_f32_16x16x32_bf16 v[188:191], v[48:51], v[56:59], v[188:191]
    v_mfma_f32_16x16x32_bf16 v[220:223], v[48:51], v[60:63], v[220:223]
    v_mfma_f32_16x16x32_bf16 v[252:255], v[48:51], v[64:67], v[252:255]
    s_waitcnt vmcnt(1) lgkmcnt(0)
    s_cmp_eq_u32 s35, 3
    s_barrier
    s_cbranch_scc1 L_p1_fin1
    s_add_u32 m0, s33, 32768
    s_nop 0
    buffer_load_dwordx4 v2, s[4:7], s31 offen offset:0 lds
    buffer_load_dwordx4 v3, s[4:7], s31 offen offset:1024 lds
    buffer_load_dwordx4 v4, s[4:7], s31 offen offset:2048 lds
    buffer_load_dwordx4 v5, s[4:7], s31 offen offset:3072 lds
    s_add_u32 m0, s34, 32768
    s_nop 0
    buffer_load_dwordx4 v6, s[8:11], s32 offen offset:0 nt lds
    buffer_load_dwordx4 v7, s[8:11], s32 offen offset:1024 nt lds
    buffer_load_dwordx4 v8, s[8:11], s32 offen offset:2048 nt lds
    buffer_load_dwordx4 v9, s[8:11], s32 offen offset:3072 nt lds
    s_add_u32 s31, s31, s40
    s_add_u32 s32, s32, s41
    s_cmp_eq_u32 s35, 2
    s_cbranch_scc1 L_recurrent_scan__compressed_kv_cla__moe_arch_mod__prompt_kernel_rare_40
L_recurrent_scan__compressed_kv_cla__moe_arch_mod__prompt_kernel_back_41:
    v_mfma_f32_16x16x32_bf16 v[128:131], v[68:71], v[100:103], v[128:131]
    ds_read_b128 v[20:23], v10 offset:0
    v_mfma_f32_16x16x32_bf16 v[160:163], v[68:71], v[104:107], v[160:163]
    ds_read_b64_tr_b16 v[52:53], v12 offset:0
    v_mfma_f32_16x16x32_bf16 v[192:195], v[68:71], v[108:111], v[192:195]
    ds_read_b64_tr_b16 v[54:55], v12 offset:1024
    v_mfma_f32_16x16x32_bf16 v[224:227], v[68:71], v[112:115], v[224:227]
    ds_read_b64_tr_b16 v[56:57], v13 offset:0
    v_mfma_f32_16x16x32_bf16 v[132:135], v[72:75], v[100:103], v[132:135]
    ds_read_b64_tr_b16 v[58:59], v13 offset:1024
    v_mfma_f32_16x16x32_bf16 v[164:167], v[72:75], v[104:107], v[164:167]
    ds_read_b64_tr_b16 v[60:61], v14 offset:0
    v_mfma_f32_16x16x32_bf16 v[196:199], v[72:75], v[108:111], v[196:199]
    ds_read_b64_tr_b16 v[62:63], v14 offset:1024
    v_mfma_f32_16x16x32_bf16 v[228:231], v[72:75], v[112:115], v[228:231]
    ds_read_b64_tr_b16 v[64:65], v15 offset:0
    v_mfma_f32_16x16x32_bf16 v[136:139], v[76:79], v[100:103], v[136:139]
    ds_read_b64_tr_b16 v[66:67], v15 offset:1024
    v_mfma_f32_16x16x32_bf16 v[168:171], v[76:79], v[104:107], v[168:171]
    ds_read_b128 v[24:27], v10 offset:2048
    v_mfma_f32_16x16x32_bf16 v[200:203], v[76:79], v[108:111], v[200:203]
    ds_read_b128 v[28:31], v10 offset:4096
    v_mfma_f32_16x16x32_bf16 v[232:235], v[76:79], v[112:115], v[232:235]
    ds_read_b128 v[32:35], v10 offset:6144
    v_mfma_f32_16x16x32_bf16 v[140:143], v[80:83], v[100:103], v[140:143]
    ds_read_b128 v[36:39], v10 offset:8192
    v_mfma_f32_16x16x32_bf16 v[172:175], v[80:83], v[104:107], v[172:175]
    ds_read_b128 v[40:43], v10 offset:10240
    v_mfma_f32_16x16x32_bf16 v[204:207], v[80:83], v[108:111], v[204:207]
    ds_read_b128 v[44:47], v10 offset:12288
    v_mfma_f32_16x16x32_bf16 v[236:239], v[80:83], v[112:115], v[236:239]
    ds_read_b128 v[48:51], v10 offset:14336
    v_mfma_f32_16x16x32_bf16 v[144:147], v[84:87], v[100:103], v[144:147]
    v_mfma_f32_16x16x32_bf16 v[176:179], v[84:87], v[104:107], v[176:179]
    v_mfma_f32_16x16x32_bf16 v[208:211], v[84:87], v[108:111], v[208:211]
    v_mfma_f32_16x16x32_bf16 v[240:243], v[84:87], v[112:115], v[240:243]
    v_mfma_f32_16x16x32_bf16 v[148:151], v[88:91], v[100:103], v[148:151]
    v_mfma_f32_16x16x32_bf16 v[180:183], v[88:91], v[104:107], v[180:183]
    v_mfma_f32_16x16x32_bf16 v[212:215], v[88:91], v[108:111], v[212:215]
    v_mfma_f32_16x16x32_bf16 v[244:247], v[88:91], v[112:115], v[244:247]
    v_mfma_f32_16x16x32_bf16 v[152:155], v[92:95], v[100:103], v[152:155]
    v_mfma_f32_16x16x32_bf16 v[184:187], v[92:95], v[104:107], v[184:187]
    v_mfma_f32_16x16x32_bf16 v[216:219], v[92:95], v[108:111], v[216:219]
    v_mfma_f32_16x16x32_bf16 v[248:251], v[92:95], v[112:115], v[248:251]
    v_mfma_f32_16x16x32_bf16 v[156:159], v[96:99], v[100:103], v[156:159]
    v_mfma_f32_16x16x32_bf16 v[188:191], v[96:99], v[104:107], v[188:191]
    v_mfma_f32_16x16x32_bf16 v[220:223], v[96:99], v[108:111], v[220:223]
    v_mfma_f32_16x16x32_bf16 v[252:255], v[96:99], v[112:115], v[252:255]
    buffer_load_dword v0, v17, s[16:19], s45 offen
    s_add_u32 s45, s45, 8192
    s_add_u32 s35, s35, 1
    s_branch L_kv_vloop
L_p1_fin1:
    s_and_b32 s36, s28, 3
    s_sub_u32 s37, 15, s30
    s_cmp_lt_u32 s28, 4
    s_cselect_b32 s37, s37, s30
    s_lshl_b32 s37, s37, 2
    s_add_u32 s37, s37, s36
    s_lshl_b32 s37, s37, 16
    v_lshl_add_u32 v6, v1, 4, s37
    v_add_u32 v7, 32768, v6
    s_mov_b32 s32, 0
    s_mov_b32 s8, s54
    s_and_b32 s9, s55, 0xffff
    s_mov_b32 s10, 104857728
    s_mov_b32 s11, 0x20000
    v_mfma_f32_16x16x32_bf16 v[128:131], v[68:71], v[100:103], v[128:131]
    v_mfma_f32_16x16x32_bf16 v[160:163], v[68:71], v[104:107], v[160:163]
    buffer_load_dwordx4 v[24:27], v6, s[8:11], s32 offen offset:0 sc1
    v_mfma_f32_16x16x32_bf16 v[192:195], v[68:71], v[108:111], v[192:195]
    v_lshrrev_b32 v18, 4, v1
    v_mfma_f32_16x16x32_bf16 v[224:227], v[68:71], v[112:115], v[224:227]
    v_bfe_u32 v20, v1, 2, 2
    v_mfma_f32_16x16x32_bf16 v[132:135], v[72:75], v[100:103], v[132:135]
    buffer_load_dwordx4 v[28:31], v7, s[8:11], s32 offen offset:0 sc1
    v_lshl_add_u32 v19, v18, 3, v20
    v_mfma_f32_16x16x32_bf16 v[164:167], v[72:75], v[104:107], v[164:167]
    v_lshlrev_b32 v19, 8, v19
    v_mfma_f32_16x16x32_bf16 v[196:199], v[72:75], v[108:111], v[196:199]
    v_and_b32 v21, 3, v1
    v_mfma_f32_16x16x32_bf16 v[228:231], v[72:75], v[112:115], v[228:231]
    buffer_load_dwordx4 v[32:35], v6, s[8:11], s32 offen offset:1024 sc1
    v_lshl_add_u32 v19, v21, 3, v19
    v_mfma_f32_16x16x32_bf16 v[136:139], v[76:79], v[100:103], v[136:139]
    v_and_b32 v21, 1, v18
    v_mfma_f32_16x16x32_bf16 v[168:171], v[76:79], v[104:107], v[168:171]
    v_lshl_add_u32 v20, v21, 2, v20
    v_mfma_f32_16x16x32_bf16 v[200:203], v[76:79], v[108:111], v[200:203]
    buffer_load_dwordx4 v[36:39], v7, s[8:11], s32 offen offset:1024 sc1
    v_xor_b32 v21, 0, v20
    v_mfma_f32_16x16x32_bf16 v[232:235], v[76:79], v[112:115], v[232:235]
    v_lshl_add_u32 v10, v21, 5, v19
    v_mfma_f32_16x16x32_bf16 v[140:143], v[80:83], v[100:103], v[140:143]
    v_xor_b32 v21, 1, v20
    v_mfma_f32_16x16x32_bf16 v[172:175], v[80:83], v[104:107], v[172:175]
    buffer_load_dwordx4 v[40:43], v6, s[8:11], s32 offen offset:2048 sc1
    v_lshl_add_u32 v11, v21, 5, v19
    v_mfma_f32_16x16x32_bf16 v[204:207], v[80:83], v[108:111], v[204:207]
    v_xor_b32 v21, 2, v20
    v_mfma_f32_16x16x32_bf16 v[236:239], v[80:83], v[112:115], v[236:239]
    v_lshl_add_u32 v12, v21, 5, v19
    v_mfma_f32_16x16x32_bf16 v[144:147], v[84:87], v[100:103], v[144:147]
    buffer_load_dwordx4 v[44:47], v7, s[8:11], s32 offen offset:2048 sc1
    v_xor_b32 v21, 3, v20
    v_mfma_f32_16x16x32_bf16 v[176:179], v[84:87], v[104:107], v[176:179]
    v_lshl_add_u32 v13, v21, 5, v19
    v_mfma_f32_16x16x32_bf16 v[208:211], v[84:87], v[108:111], v[208:211]
    v_xor_b32 v21, 4, v20
    v_mfma_f32_16x16x32_bf16 v[240:243], v[84:87], v[112:115], v[240:243]
    buffer_load_dwordx4 v[48:51], v6, s[8:11], s32 offen offset:3072 sc1
    v_lshl_add_u32 v14, v21, 5, v19
    v_mfma_f32_16x16x32_bf16 v[148:151], v[88:91], v[100:103], v[148:151]
    v_xor_b32 v21, 5, v20
    v_mfma_f32_16x16x32_bf16 v[180:183], v[88:91], v[104:107], v[180:183]
    v_lshl_add_u32 v15, v21, 5, v19
    v_mfma_f32_16x16x32_bf16 v[212:215], v[88:91], v[108:111], v[212:215]
    buffer_load_dwordx4 v[52:55], v7, s[8:11], s32 offen offset:3072 sc1
    v_xor_b32 v21, 6, v20
    v_mfma_f32_16x16x32_bf16 v[244:247], v[88:91], v[112:115], v[244:247]
    v_lshl_add_u32 v16, v21, 5, v19
    v_mfma_f32_16x16x32_bf16 v[152:155], v[92:95], v[100:103], v[152:155]
    v_xor_b32 v21, 7, v20
    v_mfma_f32_16x16x32_bf16 v[184:187], v[92:95], v[104:107], v[184:187]
    v_lshl_add_u32 v17, v21, 5, v19
    v_mfma_f32_16x16x32_bf16 v[216:219], v[92:95], v[108:111], v[216:219]
    s_lshl_b32 s45, s29, 20
    v_mfma_f32_16x16x32_bf16 v[248:251], v[92:95], v[112:115], v[248:251]
    v_mfma_f32_16x16x32_bf16 v[156:159], v[96:99], v[100:103], v[156:159]
    v_mfma_f32_16x16x32_bf16 v[188:191], v[96:99], v[104:107], v[188:191]
    v_mfma_f32_16x16x32_bf16 v[220:223], v[96:99], v[108:111], v[220:223]
    v_mfma_f32_16x16x32_bf16 v[252:255], v[96:99], v[112:115], v[252:255]
L_p1_done:
    ds_read_b64_tr_b16 v[64:65], v10 offset:0
    ds_read_b64_tr_b16 v[66:67], v10 offset:1024
    ds_read_b64_tr_b16 v[68:69], v11 offset:0
    ds_read_b64_tr_b16 v[70:71], v11 offset:1024
    ds_read_b64_tr_b16 v[72:73], v12 offset:0
    ds_read_b64_tr_b16 v[74:75], v12 offset:1024
    ds_read_b64_tr_b16 v[76:77], v13 offset:0
    ds_read_b64_tr_b16 v[78:79], v13 offset:1024
    ds_read_b64_tr_b16 v[80:81], v14 offset:0
    ds_read_b64_tr_b16 v[82:83], v14 offset:1024
    ds_read_b64_tr_b16 v[84:85], v15 offset:0
    ds_read_b64_tr_b16 v[86:87], v15 offset:1024
    s_add_u32 m0, s33, 32768
    s_add_u32 s32, s32, 4096
    v_cvt_pk_bf16_f32 v128, v128, v129
    v_cvt_pk_bf16_f32 v129, v130, v131
    v_cvt_pk_bf16_f32 v130, v132, v133
    v_cvt_pk_bf16_f32 v131, v134, v135
    v_cvt_pk_bf16_f32 v132, v136, v137
    v_cvt_pk_bf16_f32 v133, v138, v139
    v_cvt_pk_bf16_f32 v134, v140, v141
    v_cvt_pk_bf16_f32 v135, v142, v143
    v_cvt_pk_bf16_f32 v136, v144, v145
    v_cvt_pk_bf16_f32 v137, v146, v147
    v_cvt_pk_bf16_f32 v138, v148, v149
    v_cvt_pk_bf16_f32 v139, v150, v151
    buffer_load_dwordx4 v2, s[4:7], s31 offen offset:0 lds
    v_cvt_pk_bf16_f32 v140, v152, v153
    v_cvt_pk_bf16_f32 v141, v154, v155
    v_cvt_pk_bf16_f32 v142, v156, v157
    v_cvt_pk_bf16_f32 v143, v158, v159
    v_cvt_pk_bf16_f32 v144, v160, v161
    v_cvt_pk_bf16_f32 v145, v162, v163
    v_cvt_pk_bf16_f32 v146, v164, v165
    v_cvt_pk_bf16_f32 v147, v166, v167
    v_cvt_pk_bf16_f32 v148, v168, v169
    v_cvt_pk_bf16_f32 v149, v170, v171
    v_cvt_pk_bf16_f32 v150, v172, v173
    v_cvt_pk_bf16_f32 v151, v174, v175
    buffer_load_dwordx4 v3, s[4:7], s31 offen offset:1024 lds
    v_cvt_pk_bf16_f32 v152, v176, v177
    v_cvt_pk_bf16_f32 v153, v178, v179
    v_cvt_pk_bf16_f32 v154, v180, v181
    v_cvt_pk_bf16_f32 v155, v182, v183
    v_cvt_pk_bf16_f32 v156, v184, v185
    v_cvt_pk_bf16_f32 v157, v186, v187
    v_cvt_pk_bf16_f32 v158, v188, v189
    v_cvt_pk_bf16_f32 v159, v190, v191
    v_cvt_pk_bf16_f32 v160, v192, v193
    v_cvt_pk_bf16_f32 v161, v194, v195
    v_cvt_pk_bf16_f32 v162, v196, v197
    v_cvt_pk_bf16_f32 v163, v198, v199
    buffer_load_dwordx4 v4, s[4:7], s31 offen offset:2048 lds
    v_cvt_pk_bf16_f32 v164, v200, v201
    v_cvt_pk_bf16_f32 v165, v202, v203
    v_cvt_pk_bf16_f32 v166, v204, v205
    v_cvt_pk_bf16_f32 v167, v206, v207
    v_cvt_pk_bf16_f32 v168, v208, v209
    v_cvt_pk_bf16_f32 v169, v210, v211
    v_cvt_pk_bf16_f32 v170, v212, v213
    v_cvt_pk_bf16_f32 v171, v214, v215
    v_cvt_pk_bf16_f32 v172, v216, v217
    v_cvt_pk_bf16_f32 v173, v218, v219
    v_cvt_pk_bf16_f32 v174, v220, v221
    v_cvt_pk_bf16_f32 v175, v222, v223
    buffer_load_dwordx4 v5, s[4:7], s31 offen offset:3072 lds
    v_cvt_pk_bf16_f32 v176, v224, v225
    v_cvt_pk_bf16_f32 v177, v226, v227
    v_cvt_pk_bf16_f32 v178, v228, v229
    v_cvt_pk_bf16_f32 v179, v230, v231
    v_cvt_pk_bf16_f32 v180, v232, v233
    v_cvt_pk_bf16_f32 v181, v234, v235
    v_cvt_pk_bf16_f32 v182, v236, v237
    v_cvt_pk_bf16_f32 v183, v238, v239
    v_cvt_pk_bf16_f32 v184, v240, v241
    v_cvt_pk_bf16_f32 v185, v242, v243
    v_cvt_pk_bf16_f32 v186, v244, v245
    v_cvt_pk_bf16_f32 v187, v246, v247
    v_cvt_pk_bf16_f32 v188, v248, v249
    v_cvt_pk_bf16_f32 v189, v250, v251
    v_cvt_pk_bf16_f32 v190, v252, v253
    v_cvt_pk_bf16_f32 v191, v254, v255
    s_lshl_b32 s38, s29, 20
    s_lshl_b32 s37, s30, 17
    s_add_u32 s38, s38, s37
    s_bfe_u32 s37, s28, 0x10001
    s_lshl_b32 s37, s37, 16
    s_add_u32 s38, s38, s37
    s_lshr_b32 s36, s28, 2
    s_lshl_b32 s37, s36, 15
    s_add_u32 s38, s38, s37
    s_and_b32 s37, s28, 1
    s_add_u32 s36, s36, 11
    s_lshl_b32 s37, s37, s36
    s_add_u32 s38, s38, s37
    s_cmp_lt_u32 s28, 4
    s_cselect_b32 s36, 4, 32
    s_cselect_b32 s37, 16, 64
    s_cselect_b32 s39, 32, 4
    s_lshl_b32 s36, s36, 8
    s_lshl_b32 s37, s37, 8
    s_lshl_b32 s39, s39, 8
    s_mov_b64 s[16:17], s[12:13]
    s_mov_b64 s[18:19], s[14:15]
    s_mov_b32 s46, s38
    s_add_u32 s47, s46, s39
    s_add_u32 s48, s47, s39
    s_add_u32 s49, s48, s39
    v_lshlrev_b32 v58, 4, v1
    v_add_u32 v59, s36, v58
    v_add_u32 v60, s37, v58
    v_add_u32 v61, s36, v60
    v_add_u32 v8, s33, v58
    s_waitcnt vmcnt(8)
    s_cmp_eq_u32 s30, 0
    s_cbranch_scc1 L_recurrent_scan__compressed_kv_cla__moe_arch_mod__prompt_kernel_rare_54
L_recurrent_scan__compressed_kv_cla__moe_arch_mod__prompt_kernel_back_55:
    s_waitcnt lgkmcnt(8)
    v_mfma_f32_16x16x32_bf16 v[192:195], v[64:67], v[24:27], 0
    ds_read_b64_tr_b16 v[88:89], v16 offset:0
    v_mfma_f32_16x16x32_bf16 v[224:227], v[64:67], v[28:31], 0
    ds_read_b64_tr_b16 v[90:91], v16 offset:1024
    buffer_load_dwordx4 v[96:99], v6, s[8:11], s32 offen offset:0 sc1
    v_mfma_f32_16x16x32_bf16 v[196:199], v[68:71], v[24:27], 0
    ds_read_b64_tr_b16 v[92:93], v17 offset:0
    v_mfma_f32_16x16x32_bf16 v[228:231], v[68:71], v[28:31], 0
    ds_read_b64_tr_b16 v[94:95], v17 offset:1024
    s_waitcnt lgkmcnt(8)
    v_mfma_f32_16x16x32_bf16 v[200:203], v[72:75], v[24:27], 0
    ds_read_b64_tr_b16 v[64:65], v10 offset:8192
    v_mfma_f32_16x16x32_bf16 v[232:235], v[72:75], v[28:31], 0
    ds_read_b64_tr_b16 v[66:67], v10 offset:9216
    buffer_load_dwordx4 v[100:103], v7, s[8:11], s32 offen offset:0 sc1
    v_mfma_f32_16x16x32_bf16 v[204:207], v[76:79], v[24:27], 0
    ds_read_b64_tr_b16 v[68:69], v11 offset:8192
    v_mfma_f32_16x16x32_bf16 v[236:239], v[76:79], v[28:31], 0
    ds_read_b64_tr_b16 v[70:71], v11 offset:9216
    s_waitcnt lgkmcnt(8)
    v_mfma_f32_16x16x32_bf16 v[208:211], v[80:83], v[24:27], 0
    ds_read_b64_tr_b16 v[72:73], v12 offset:8192
    v_mfma_f32_16x16x32_bf16 v[240:243], v[80:83], v[28:31], 0
    ds_read_b64_tr_b16 v[74:75], v12 offset:9216
    buffer_load_dwordx4 v[104:107], v6, s[8:11], s32 offen offset:1024 sc1
    v_mfma_f32_16x16x32_bf16 v[212:215], v[84:87], v[24:27], 0
    ds_read_b64_tr_b16 v[76:77], v13 offset:8192
    v_mfma_f32_16x16x32_bf16 v[244:247], v[84:87], v[28:31], 0
    ds_read_b64_tr_b16 v[78:79], v13 offset:9216
    s_waitcnt lgkmcnt(8)
    v_mfma_f32_16x16x32_bf16 v[216:219], v[88:91], v[24:27], 0
    ds_read_b64_tr_b16 v[80:81], v14 offset:8192
    v_mfma_f32_16x16x32_bf16 v[248:251], v[88:91], v[28:31], 0
    ds_read_b64_tr_b16 v[82:83], v14 offset:9216
    buffer_load_dwordx4 v[108:111], v7, s[8:11], s32 offen offset:1024 sc1
    v_mfma_f32_16x16x32_bf16 v[220:223], v[92:95], v[24:27], 0
    ds_read_b64_tr_b16 v[84:85], v15 offset:8192
    v_mfma_f32_16x16x32_bf16 v[252:255], v[92:95], v[28:31], 0
    ds_read_b64_tr_b16 v[86:87], v15 offset:9216
    s_waitcnt lgkmcnt(8)
    v_mfma_f32_16x16x32_bf16 v[192:195], v[64:67], v[32:35], v[192:195]
    ds_read_b64_tr_b16 v[88:89], v16 offset:8192
    v_mfma_f32_16x16x32_bf16 v[224:227], v[64:67], v[36:39], v[224:227]
    ds_read_b64_tr_b16 v[90:91], v16 offset:9216
    buffer_store_dwordx4 v[128:131], v58, s[16:19], s46 offen sc1
    v_mfma_f32_16x16x32_bf16 v[196:199], v[68:71], v[32:35], v[196:199]
    ds_read_b64_tr_b16 v[92:93], v17 offset:8192
    v_mfma_f32_16x16x32_bf16 v[228:231], v[68:71], v[36:39], v[228:231]
    ds_read_b64_tr_b16 v[94:95], v17 offset:9216
    s_waitcnt lgkmcnt(8)
    v_mfma_f32_16x16x32_bf16 v[200:203], v[72:75], v[32:35], v[200:203]
    ds_read_b64_tr_b16 v[64:65], v10 offset:16384
    v_mfma_f32_16x16x32_bf16 v[232:235], v[72:75], v[36:39], v[232:235]
    ds_read_b64_tr_b16 v[66:67], v10 offset:17408
    v_mfma_f32_16x16x32_bf16 v[204:207], v[76:79], v[32:35], v[204:207]
    ds_read_b64_tr_b16 v[68:69], v11 offset:16384
    v_mfma_f32_16x16x32_bf16 v[236:239], v[76:79], v[36:39], v[236:239]
    ds_read_b64_tr_b16 v[70:71], v11 offset:17408
    s_waitcnt lgkmcnt(8)
    v_mfma_f32_16x16x32_bf16 v[208:211], v[80:83], v[32:35], v[208:211]
    ds_read_b64_tr_b16 v[72:73], v12 offset:16384
    v_mfma_f32_16x16x32_bf16 v[240:243], v[80:83], v[36:39], v[240:243]
    ds_read_b64_tr_b16 v[74:75], v12 offset:17408
    v_mfma_f32_16x16x32_bf16 v[212:215], v[84:87], v[32:35], v[212:215]
    ds_read_b64_tr_b16 v[76:77], v13 offset:16384
    v_mfma_f32_16x16x32_bf16 v[244:247], v[84:87], v[36:39], v[244:247]
    ds_read_b64_tr_b16 v[78:79], v13 offset:17408
    s_waitcnt lgkmcnt(8)
    v_mfma_f32_16x16x32_bf16 v[216:219], v[88:91], v[32:35], v[216:219]
    ds_read_b64_tr_b16 v[80:81], v14 offset:16384
    buffer_load_dwordx4 v[112:115], v6, s[8:11], s32 offen offset:2048 sc1
    v_mfma_f32_16x16x32_bf16 v[248:251], v[88:91], v[36:39], v[248:251]
    ds_read_b64_tr_b16 v[82:83], v14 offset:17408
    v_mfma_f32_16x16x32_bf16 v[220:223], v[92:95], v[32:35], v[220:223]
    ds_read_b64_tr_b16 v[84:85], v15 offset:16384
    v_mfma_f32_16x16x32_bf16 v[252:255], v[92:95], v[36:39], v[252:255]
    ds_read_b64_tr_b16 v[86:87], v15 offset:17408
    s_waitcnt lgkmcnt(8)
    s_waitcnt vmcnt(12)
    v_mfma_f32_16x16x32_bf16 v[192:195], v[64:67], v[40:43], v[192:195]
    ds_read_b64_tr_b16 v[88:89], v16 offset:16384
    buffer_load_dwordx4 v[116:119], v7, s[8:11], s32 offen offset:2048 sc1
    v_mfma_f32_16x16x32_bf16 v[224:227], v[64:67], v[44:47], v[224:227]
    ds_read_b64_tr_b16 v[90:91], v16 offset:17408
    v_mfma_f32_16x16x32_bf16 v[196:199], v[68:71], v[40:43], v[196:199]
    ds_read_b64_tr_b16 v[92:93], v17 offset:16384
    v_mfma_f32_16x16x32_bf16 v[228:231], v[68:71], v[44:47], v[228:231]
    ds_read_b64_tr_b16 v[94:95], v17 offset:17408
    s_waitcnt lgkmcnt(8)
    v_mfma_f32_16x16x32_bf16 v[200:203], v[72:75], v[40:43], v[200:203]
    ds_read_b64_tr_b16 v[64:65], v10 offset:24576
    v_mfma_f32_16x16x32_bf16 v[232:235], v[72:75], v[44:47], v[232:235]
    ds_read_b64_tr_b16 v[66:67], v10 offset:25600
    buffer_load_dwordx4 v[120:123], v6, s[8:11], s32 offen offset:3072 sc1
    v_mfma_f32_16x16x32_bf16 v[204:207], v[76:79], v[40:43], v[204:207]
    ds_read_b64_tr_b16 v[68:69], v11 offset:24576
    v_mfma_f32_16x16x32_bf16 v[236:239], v[76:79], v[44:47], v[236:239]
    ds_read_b64_tr_b16 v[70:71], v11 offset:25600
    s_waitcnt lgkmcnt(8)
    v_mfma_f32_16x16x32_bf16 v[208:211], v[80:83], v[40:43], v[208:211]
    ds_read_b64_tr_b16 v[72:73], v12 offset:24576
    v_mfma_f32_16x16x32_bf16 v[240:243], v[80:83], v[44:47], v[240:243]
    ds_read_b64_tr_b16 v[74:75], v12 offset:25600
    buffer_load_dwordx4 v[124:127], v7, s[8:11], s32 offen offset:3072 sc1
    v_mfma_f32_16x16x32_bf16 v[212:215], v[84:87], v[40:43], v[212:215]
    ds_read_b64_tr_b16 v[76:77], v13 offset:24576
    v_mfma_f32_16x16x32_bf16 v[244:247], v[84:87], v[44:47], v[244:247]
    ds_read_b64_tr_b16 v[78:79], v13 offset:25600
    s_waitcnt lgkmcnt(8)
    v_mfma_f32_16x16x32_bf16 v[216:219], v[88:91], v[40:43], v[216:219]
    ds_read_b64_tr_b16 v[80:81], v14 offset:24576
    v_mfma_f32_16x16x32_bf16 v[248:251], v[88:91], v[44:47], v[248:251]
    ds_read_b64_tr_b16 v[82:83], v14 offset:25600
    buffer_store_dwordx4 v[132:135], v59, s[16:19], s46 offen sc1
    v_mfma_f32_16x16x32_bf16 v[220:223], v[92:95], v[40:43], v[220:223]
    ds_read_b64_tr_b16 v[84:85], v15 offset:24576
    v_mfma_f32_16x16x32_bf16 v[252:255], v[92:95], v[44:47], v[252:255]
    ds_read_b64_tr_b16 v[86:87], v15 offset:25600
    s_waitcnt lgkmcnt(8)
    s_waitcnt vmcnt(14)
    v_mfma_f32_16x16x32_bf16 v[192:195], v[64:67], v[48:51], v[192:195]
    ds_read_b64_tr_b16 v[88:89], v16 offset:24576
    v_mfma_f32_16x16x32_bf16 v[224:227], v[64:67], v[52:55], v[224:227]
    ds_read_b64_tr_b16 v[90:91], v16 offset:25600
    v_mfma_f32_16x16x32_bf16 v[196:199], v[68:71], v[48:51], v[196:199]
    ds_read_b64_tr_b16 v[92:93], v17 offset:24576
    v_mfma_f32_16x16x32_bf16 v[228:231], v[68:71], v[52:55], v[228:231]
    ds_read_b64_tr_b16 v[94:95], v17 offset:25600
    s_waitcnt vmcnt(10)
    s_barrier
    s_waitcnt lgkmcnt(8)
    v_mfma_f32_16x16x32_bf16 v[200:203], v[72:75], v[48:51], v[200:203]
    ds_read_b64_tr_b16 v[64:65], v10 offset:32768
    v_mfma_f32_16x16x32_bf16 v[232:235], v[72:75], v[52:55], v[232:235]
    ds_read_b64_tr_b16 v[66:67], v10 offset:33792
    v_mfma_f32_16x16x32_bf16 v[204:207], v[76:79], v[48:51], v[204:207]
    ds_read_b64_tr_b16 v[68:69], v11 offset:32768
    v_mfma_f32_16x16x32_bf16 v[236:239], v[76:79], v[52:55], v[236:239]
    ds_read_b64_tr_b16 v[70:71], v11 offset:33792
    s_waitcnt lgkmcnt(8)
    v_mfma_f32_16x16x32_bf16 v[208:211], v[80:83], v[48:51], v[208:211]
    ds_read_b64_tr_b16 v[72:73], v12 offset:32768
    s_mov_b32 s32, 8192
    buffer_load_dwordx4 v[24:27], v6, s[8:11], s32 offen offset:0 sc1
    v_mfma_f32_16x16x32_bf16 v[240:243], v[80:83], v[52:55], v[240:243]
    ds_read_b64_tr_b16 v[74:75], v12 offset:33792
    v_mfma_f32_16x16x32_bf16 v[212:215], v[84:87], v[48:51], v[212:215]
    ds_read_b64_tr_b16 v[76:77], v13 offset:32768
    v_mfma_f32_16x16x32_bf16 v[244:247], v[84:87], v[52:55], v[244:247]
    ds_read_b64_tr_b16 v[78:79], v13 offset:33792
    s_waitcnt lgkmcnt(8)
    v_mfma_f32_16x16x32_bf16 v[216:219], v[88:91], v[48:51], v[216:219]
    ds_read_b64_tr_b16 v[80:81], v14 offset:32768
    buffer_load_dwordx4 v[28:31], v7, s[8:11], s32 offen offset:0 sc1
    v_mfma_f32_16x16x32_bf16 v[248:251], v[88:91], v[52:55], v[248:251]
    ds_read_b64_tr_b16 v[82:83], v14 offset:33792
    v_mfma_f32_16x16x32_bf16 v[220:223], v[92:95], v[48:51], v[220:223]
    ds_read_b64_tr_b16 v[84:85], v15 offset:32768
    v_mfma_f32_16x16x32_bf16 v[252:255], v[92:95], v[52:55], v[252:255]
    ds_read_b64_tr_b16 v[86:87], v15 offset:33792
    s_waitcnt lgkmcnt(8)
    s_waitcnt vmcnt(10)
    v_mfma_f32_16x16x32_bf16 v[192:195], v[64:67], v[96:99], v[192:195]
    ds_read_b64_tr_b16 v[88:89], v16 offset:32768
    buffer_load_dwordx4 v[32:35], v6, s[8:11], s32 offen offset:1024 sc1
    v_mfma_f32_16x16x32_bf16 v[224:227], v[64:67], v[100:103], v[224:227]
    ds_read_b64_tr_b16 v[90:91], v16 offset:33792
    v_mfma_f32_16x16x32_bf16 v[196:199], v[68:71], v[96:99], v[196:199]
    ds_read_b64_tr_b16 v[92:93], v17 offset:32768
    v_mfma_f32_16x16x32_bf16 v[228:231], v[68:71], v[100:103], v[228:231]
    ds_read_b64_tr_b16 v[94:95], v17 offset:33792
    s_waitcnt lgkmcnt(8)
    v_mfma_f32_16x16x32_bf16 v[200:203], v[72:75], v[96:99], v[200:203]
    ds_read_b64_tr_b16 v[64:65], v10 offset:40960
    buffer_load_dwordx4 v[36:39], v7, s[8:11], s32 offen offset:1024 sc1
    v_mfma_f32_16x16x32_bf16 v[232:235], v[72:75], v[100:103], v[232:235]
    ds_read_b64_tr_b16 v[66:67], v10 offset:41984
    v_mfma_f32_16x16x32_bf16 v[204:207], v[76:79], v[96:99], v[204:207]
    ds_read_b64_tr_b16 v[68:69], v11 offset:40960
    v_mfma_f32_16x16x32_bf16 v[236:239], v[76:79], v[100:103], v[236:239]
    ds_read_b64_tr_b16 v[70:71], v11 offset:41984
    s_waitcnt lgkmcnt(8)
    v_mfma_f32_16x16x32_bf16 v[208:211], v[80:83], v[96:99], v[208:211]
    ds_read_b64_tr_b16 v[72:73], v12 offset:40960
    v_mfma_f32_16x16x32_bf16 v[240:243], v[80:83], v[100:103], v[240:243]
    ds_read_b64_tr_b16 v[74:75], v12 offset:41984
    buffer_store_dwordx4 v[136:139], v60, s[16:19], s46 offen sc1
    v_mfma_f32_16x16x32_bf16 v[212:215], v[84:87], v[96:99], v[212:215]
    ds_read_b64_tr_b16 v[76:77], v13 offset:40960
    v_mfma_f32_16x16x32_bf16 v[244:247], v[84:87], v[100:103], v[244:247]
    ds_read_b64_tr_b16 v[78:79], v13 offset:41984
    s_waitcnt lgkmcnt(8)
    v_mfma_f32_16x16x32_bf16 v[216:219], v[88:91], v[96:99], v[216:219]
    ds_read_b64_tr_b16 v[80:81], v14 offset:40960
    v_mfma_f32_16x16x32_bf16 v[248:251], v[88:91], v[100:103], v[248:251]
    ds_read_b64_tr_b16 v[82:83], v14 offset:41984
    v_mfma_f32_16x16x32_bf16 v[220:223], v[92:95], v[96:99], v[220:223]
    ds_read_b64_tr_b16 v[84:85], v15 offset:40960
    v_mfma_f32_16x16x32_bf16 v[252:255], v[92:95], v[100:103], v[252:255]
    ds_read_b64_tr_b16 v[86:87], v15 offset:41984
    s_waitcnt lgkmcnt(8)
    s_waitcnt vmcnt(11)
    v_mfma_f32_16x16x32_bf16 v[192:195], v[64:67], v[104:107], v[192:195]
    ds_read_b64_tr_b16 v[88:89], v16 offset:40960
    v_mfma_f32_16x16x32_bf16 v[224:227], v[64:67], v[108:111], v[224:227]
    ds_read_b64_tr_b16 v[90:91], v16 offset:41984
    v_mfma_f32_16x16x32_bf16 v[196:199], v[68:71], v[104:107], v[196:199]
    ds_read_b64_tr_b16 v[92:93], v17 offset:40960
    v_mfma_f32_16x16x32_bf16 v[228:231], v[68:71], v[108:111], v[228:231]
    ds_read_b64_tr_b16 v[94:95], v17 offset:41984
    s_waitcnt lgkmcnt(8)
    v_mfma_f32_16x16x32_bf16 v[200:203], v[72:75], v[104:107], v[200:203]
    ds_read_b64_tr_b16 v[64:65], v10 offset:49152
    buffer_load_dwordx4 v[40:43], v6, s[8:11], s32 offen offset:2048 sc1
    v_mfma_f32_16x16x32_bf16 v[232:235], v[72:75], v[108:111], v[232:235]
    ds_read_b64_tr_b16 v[66:67], v10 offset:50176
    v_mfma_f32_16x16x32_bf16 v[204:207], v[76:79], v[104:107], v[204:207]
    ds_read_b64_tr_b16 v[68:69], v11 offset:49152
    v_mfma_f32_16x16x32_bf16 v[236:239], v[76:79], v[108:111], v[236:239]
    ds_read_b64_tr_b16 v[70:71], v11 offset:50176
    s_waitcnt lgkmcnt(8)
    v_mfma_f32_16x16x32_bf16 v[208:211], v[80:83], v[104:107], v[208:211]
    ds_read_b64_tr_b16 v[72:73], v12 offset:49152
    buffer_load_dwordx4 v[44:47], v7, s[8:11], s32 offen offset:2048 sc1
    v_mfma_f32_16x16x32_bf16 v[240:243], v[80:83], v[108:111], v[240:243]
    ds_read_b64_tr_b16 v[74:75], v12 offset:50176
    v_mfma_f32_16x16x32_bf16 v[212:215], v[84:87], v[104:107], v[212:215]
    ds_read_b64_tr_b16 v[76:77], v13 offset:49152
    v_mfma_f32_16x16x32_bf16 v[244:247], v[84:87], v[108:111], v[244:247]
    ds_read_b64_tr_b16 v[78:79], v13 offset:50176
    s_waitcnt lgkmcnt(8)
    v_mfma_f32_16x16x32_bf16 v[216:219], v[88:91], v[104:107], v[216:219]
    ds_read_b64_tr_b16 v[80:81], v14 offset:49152
    buffer_store_dwordx4 v[140:143], v61, s[16:19], s46 offen sc1
    v_mfma_f32_16x16x32_bf16 v[248:251], v[88:91], v[108:111], v[248:251]
    ds_read_b64_tr_b16 v[82:83], v14 offset:50176
    v_mfma_f32_16x16x32_bf16 v[220:223], v[92:95], v[104:107], v[220:223]
    ds_read_b64_tr_b16 v[84:85], v15 offset:49152
    v_mfma_f32_16x16x32_bf16 v[252:255], v[92:95], v[108:111], v[252:255]
    ds_read_b64_tr_b16 v[86:87], v15 offset:50176
    s_waitcnt lgkmcnt(8)
    s_waitcnt vmcnt(11)
    v_mfma_f32_16x16x32_bf16 v[192:195], v[64:67], v[112:115], v[192:195]
    ds_read_b64_tr_b16 v[88:89], v16 offset:49152
    v_mfma_f32_16x16x32_bf16 v[224:227], v[64:67], v[116:119], v[224:227]
    ds_read_b64_tr_b16 v[90:91], v16 offset:50176
    v_mfma_f32_16x16x32_bf16 v[196:199], v[68:71], v[112:115], v[196:199]
    ds_read_b64_tr_b16 v[92:93], v17 offset:49152
    v_mfma_f32_16x16x32_bf16 v[228:231], v[68:71], v[116:119], v[228:231]
    ds_read_b64_tr_b16 v[94:95], v17 offset:50176
    s_waitcnt lgkmcnt(8)
    v_mfma_f32_16x16x32_bf16 v[200:203], v[72:75], v[112:115], v[200:203]
    ds_read_b64_tr_b16 v[64:65], v10 offset:57344
    v_mfma_f32_16x16x32_bf16 v[232:235], v[72:75], v[116:119], v[232:235]
    ds_read_b64_tr_b16 v[66:67], v10 offset:58368
    v_add_u32 v10, 98304, v10
    v_mfma_f32_16x16x32_bf16 v[204:207], v[76:79], v[112:115], v[204:207]
    ds_read_b64_tr_b16 v[68:69], v11 offset:57344
    v_mfma_f32_16x16x32_bf16 v[236:239], v[76:79], v[116:119], v[236:239]
    ds_read_b64_tr_b16 v[70:71], v11 offset:58368
    v_add_u32 v11, 98304, v11
    buffer_load_dwordx4 v[48:51], v6, s[8:11], s32 offen offset:3072 sc1
    s_waitcnt lgkmcnt(8)
    v_mfma_f32_16x16x32_bf16 v[208:211], v[80:83], v[112:115], v[208:211]
    ds_read_b64_tr_b16 v[72:73], v12 offset:57344
    v_mfma_f32_16x16x32_bf16 v[240:243], v[80:83], v[116:119], v[240:243]
    ds_read_b64_tr_b16 v[74:75], v12 offset:58368
    v_add_u32 v12, 98304, v12
    v_mfma_f32_16x16x32_bf16 v[212:215], v[84:87], v[112:115], v[212:215]
    ds_read_b64_tr_b16 v[76:77], v13 offset:57344
    v_mfma_f32_16x16x32_bf16 v[244:247], v[84:87], v[116:119], v[244:247]
    ds_read_b64_tr_b16 v[78:79], v13 offset:58368
    v_add_u32 v13, 98304, v13
    buffer_load_dwordx4 v[52:55], v7, s[8:11], s32 offen offset:3072 sc1
    s_waitcnt lgkmcnt(8)
    v_mfma_f32_16x16x32_bf16 v[216:219], v[88:91], v[112:115], v[216:219]
    ds_read_b64_tr_b16 v[80:81], v14 offset:57344
    v_mfma_f32_16x16x32_bf16 v[248:251], v[88:91], v[116:119], v[248:251]
    ds_read_b64_tr_b16 v[82:83], v14 offset:58368
    v_add_u32 v14, 98304, v14
    v_mfma_f32_16x16x32_bf16 v[220:223], v[92:95], v[112:115], v[220:223]
    ds_read_b64_tr_b16 v[84:85], v15 offset:57344
    v_mfma_f32_16x16x32_bf16 v[252:255], v[92:95], v[116:119], v[252:255]
    ds_read_b64_tr_b16 v[86:87], v15 offset:58368
    v_add_u32 v15, 98304, v15
    s_mov_b32 s32, 12288
    buffer_load_dwordx4 v[96:99], v6, s[8:11], s32 offen offset:0 sc1
    s_waitcnt lgkmcnt(8)
    s_waitcnt vmcnt(12)
    v_mfma_f32_16x16x32_bf16 v[192:195], v[64:67], v[120:123], v[192:195]
    ds_read_b64_tr_b16 v[88:89], v16 offset:57344
    v_mfma_f32_16x16x32_bf16 v[224:227], v[64:67], v[124:127], v[224:227]
    ds_read_b64_tr_b16 v[90:91], v16 offset:58368
    v_add_u32 v16, 98304, v16
    v_mfma_f32_16x16x32_bf16 v[196:199], v[68:71], v[120:123], v[196:199]
    ds_read_b64_tr_b16 v[92:93], v17 offset:57344
    v_mfma_f32_16x16x32_bf16 v[228:231], v[68:71], v[124:127], v[228:231]
    ds_read_b64_tr_b16 v[94:95], v17 offset:58368
    v_add_u32 v17, 98304, v17
    buffer_load_dwordx4 v[100:103], v7, s[8:11], s32 offen offset:0 sc1
    s_barrier
    s_waitcnt lgkmcnt(8)
    v_mfma_f32_16x16x32_bf16 v[200:203], v[72:75], v[120:123], v[200:203]
    ds_read_b64_tr_b16 v[64:65], v10 offset:32768
    v_mfma_f32_16x16x32_bf16 v[232:235], v[72:75], v[124:127], v[232:235]
    ds_read_b64_tr_b16 v[66:67], v10 offset:33792
    v_mfma_f32_16x16x32_bf16 v[204:207], v[76:79], v[120:123], v[204:207]
    ds_read_b64_tr_b16 v[68:69], v11 offset:32768
    v_mfma_f32_16x16x32_bf16 v[236:239], v[76:79], v[124:127], v[236:239]
    ds_read_b64_tr_b16 v[70:71], v11 offset:33792
    s_waitcnt lgkmcnt(8)
    v_mfma_f32_16x16x32_bf16 v[208:211], v[80:83], v[120:123], v[208:211]
    ds_read_b64_tr_b16 v[72:73], v12 offset:32768
    buffer_store_dwordx4 v[144:147], v58, s[16:19], s47 offen sc1
    v_mfma_f32_16x16x32_bf16 v[240:243], v[80:83], v[124:127], v[240:243]
    ds_read_b64_tr_b16 v[74:75], v12 offset:33792
    v_mfma_f32_16x16x32_bf16 v[212:215], v[84:87], v[120:123], v[212:215]
    ds_read_b64_tr_b16 v[76:77], v13 offset:32768
    v_mfma_f32_16x16x32_bf16 v[244:247], v[84:87], v[124:127], v[244:247]
    ds_read_b64_tr_b16 v[78:79], v13 offset:33792
    s_waitcnt lgkmcnt(8)
    v_mfma_f32_16x16x32_bf16 v[216:219], v[88:91], v[120:123], v[216:219]
    ds_read_b64_tr_b16 v[80:81], v14 offset:32768
    v_mfma_f32_16x16x32_bf16 v[248:251], v[88:91], v[124:127], v[248:251]
    ds_read_b64_tr_b16 v[82:83], v14 offset:33792
    v_mfma_f32_16x16x32_bf16 v[220:223], v[92:95], v[120:123], v[220:223]
    ds_read_b64_tr_b16 v[84:85], v15 offset:32768
    v_mfma_f32_16x16x32_bf16 v[252:255], v[92:95], v[124:127], v[252:255]
    ds_read_b64_tr_b16 v[86:87], v15 offset:33792
    s_waitcnt lgkmcnt(8)
    s_waitcnt vmcnt(11)
    v_mfma_f32_16x16x32_bf16 v[192:195], v[64:67], v[24:27], v[192:195]
    ds_read_b64_tr_b16 v[88:89], v16 offset:32768
    v_mfma_f32_16x16x32_bf16 v[224:227], v[64:67], v[28:31], v[224:227]
    ds_read_b64_tr_b16 v[90:91], v16 offset:33792
    v_mfma_f32_16x16x32_bf16 v[196:199], v[68:71], v[24:27], v[196:199]
    ds_read_b64_tr_b16 v[92:93], v17 offset:32768
    v_mfma_f32_16x16x32_bf16 v[228:231], v[68:71], v[28:31], v[228:231]
    ds_read_b64_tr_b16 v[94:95], v17 offset:33792
    buffer_load_dwordx4 v[104:107], v6, s[8:11], s32 offen offset:1024 sc1
    s_waitcnt lgkmcnt(8)
    v_mfma_f32_16x16x32_bf16 v[200:203], v[72:75], v[24:27], v[200:203]
    ds_read_b64_tr_b16 v[64:65], v10 offset:40960
    v_mfma_f32_16x16x32_bf16 v[232:235], v[72:75], v[28:31], v[232:235]
    ds_read_b64_tr_b16 v[66:67], v10 offset:41984
    v_mfma_f32_16x16x32_bf16 v[204:207], v[76:79], v[24:27], v[204:207]
    ds_read_b64_tr_b16 v[68:69], v11 offset:40960
    v_mfma_f32_16x16x32_bf16 v[236:239], v[76:79], v[28:31], v[236:239]
    ds_read_b64_tr_b16 v[70:71], v11 offset:41984
    buffer_load_dwordx4 v[108:111], v7, s[8:11], s32 offen offset:1024 sc1
    s_waitcnt lgkmcnt(8)
    v_mfma_f32_16x16x32_bf16 v[208:211], v[80:83], v[24:27], v[208:211]
    ds_read_b64_tr_b16 v[72:73], v12 offset:40960
    v_mfma_f32_16x16x32_bf16 v[240:243], v[80:83], v[28:31], v[240:243]
    ds_read_b64_tr_b16 v[74:75], v12 offset:41984
    v_mfma_f32_16x16x32_bf16 v[212:215], v[84:87], v[24:27], v[212:215]
    ds_read_b64_tr_b16 v[76:77], v13 offset:40960
    v_mfma_f32_16x16x32_bf16 v[244:247], v[84:87], v[28:31], v[244:247]
    ds_read_b64_tr_b16 v[78:79], v13 offset:41984
    s_add_u32 m0, s33, 98304
    s_mov_b32 s31, 4194304
    buffer_load_dwordx4 v2, s[4:7], s31 offen offset:0 lds
    s_waitcnt lgkmcnt(8)
    v_mfma_f32_16x16x32_bf16 v[216:219], v[88:91], v[24:27], v[216:219]
    ds_read_b64_tr_b16 v[80:81], v14 offset:40960
    v_mfma_f32_16x16x32_bf16 v[248:251], v[88:91], v[28:31], v[248:251]
    ds_read_b64_tr_b16 v[82:83], v14 offset:41984
    v_mfma_f32_16x16x32_bf16 v[220:223], v[92:95], v[24:27], v[220:223]
    ds_read_b64_tr_b16 v[84:85], v15 offset:40960
    buffer_load_dwordx4 v[112:115], v6, s[8:11], s32 offen offset:2048 sc1
    v_mfma_f32_16x16x32_bf16 v[252:255], v[92:95], v[28:31], v[252:255]
    ds_read_b64_tr_b16 v[86:87], v15 offset:41984
    s_waitcnt lgkmcnt(8)
    s_waitcnt vmcnt(13)
    v_mfma_f32_16x16x32_bf16 v[192:195], v[64:67], v[32:35], v[192:195]
    ds_read_b64_tr_b16 v[88:89], v16 offset:40960
    v_mfma_f32_16x16x32_bf16 v[224:227], v[64:67], v[36:39], v[224:227]
    ds_read_b64_tr_b16 v[90:91], v16 offset:41984
    v_mfma_f32_16x16x32_bf16 v[196:199], v[68:71], v[32:35], v[196:199]
    ds_read_b64_tr_b16 v[92:93], v17 offset:40960
    v_mfma_f32_16x16x32_bf16 v[228:231], v[68:71], v[36:39], v[228:231]
    ds_read_b64_tr_b16 v[94:95], v17 offset:41984
    buffer_load_dwordx4 v[116:119], v7, s[8:11], s32 offen offset:2048 sc1
    s_waitcnt lgkmcnt(8)
    v_mfma_f32_16x16x32_bf16 v[200:203], v[72:75], v[32:35], v[200:203]
    ds_read_b64_tr_b16 v[64:65], v10 offset:49152
    v_mfma_f32_16x16x32_bf16 v[232:235], v[72:75], v[36:39], v[232:235]
    ds_read_b64_tr_b16 v[66:67], v10 offset:50176
    v_mfma_f32_16x16x32_bf16 v[204:207], v[76:79], v[32:35], v[204:207]
    ds_read_b64_tr_b16 v[68:69], v11 offset:49152
    v_mfma_f32_16x16x32_bf16 v[236:239], v[76:79], v[36:39], v[236:239]
    ds_read_b64_tr_b16 v[70:71], v11 offset:50176
    buffer_load_dwordx4 v3, s[4:7], s31 offen offset:1024 lds
    s_waitcnt lgkmcnt(8)
    v_mfma_f32_16x16x32_bf16 v[208:211], v[80:83], v[32:35], v[208:211]
    ds_read_b64_tr_b16 v[72:73], v12 offset:49152
    v_mfma_f32_16x16x32_bf16 v[240:243], v[80:83], v[36:39], v[240:243]
    ds_read_b64_tr_b16 v[74:75], v12 offset:50176
    v_mfma_f32_16x16x32_bf16 v[212:215], v[84:87], v[32:35], v[212:215]
    ds_read_b64_tr_b16 v[76:77], v13 offset:49152
    buffer_store_dwordx4 v[148:151], v59, s[16:19], s47 offen sc1
    v_mfma_f32_16x16x32_bf16 v[244:247], v[84:87], v[36:39], v[244:247]
    ds_read_b64_tr_b16 v[78:79], v13 offset:50176
    s_waitcnt lgkmcnt(8)
    v_mfma_f32_16x16x32_bf16 v[216:219], v[88:91], v[32:35], v[216:219]
    ds_read_b64_tr_b16 v[80:81], v14 offset:49152
    v_mfma_f32_16x16x32_bf16 v[248:251], v[88:91], v[36:39], v[248:251]
    ds_read_b64_tr_b16 v[82:83], v14 offset:50176
    v_mfma_f32_16x16x32_bf16 v[220:223], v[92:95], v[32:35], v[220:223]
    ds_read_b64_tr_b16 v[84:85], v15 offset:49152
    v_mfma_f32_16x16x32_bf16 v[252:255], v[92:95], v[36:39], v[252:255]
    ds_read_b64_tr_b16 v[86:87], v15 offset:50176
    s_waitcnt lgkmcnt(8)
    s_waitcnt vmcnt(13)
    v_mfma_f32_16x16x32_bf16 v[192:195], v[64:67], v[40:43], v[192:195]
    ds_read_b64_tr_b16 v[88:89], v16 offset:49152
    v_mfma_f32_16x16x32_bf16 v[224:227], v[64:67], v[44:47], v[224:227]
    ds_read_b64_tr_b16 v[90:91], v16 offset:50176
    v_mfma_f32_16x16x32_bf16 v[196:199], v[68:71], v[40:43], v[196:199]
    ds_read_b64_tr_b16 v[92:93], v17 offset:49152
    v_mfma_f32_16x16x32_bf16 v[228:231], v[68:71], v[44:47], v[228:231]
    ds_read_b64_tr_b16 v[94:95], v17 offset:50176
    s_waitcnt lgkmcnt(8)
    v_mfma_f32_16x16x32_bf16 v[200:203], v[72:75], v[40:43], v[200:203]
    ds_read_b64_tr_b16 v[64:65], v10 offset:57344
    v_mfma_f32_16x16x32_bf16 v[232:235], v[72:75], v[44:47], v[232:235]
    ds_read_b64_tr_b16 v[66:67], v10 offset:58368
    v_add_u32 v10, 4294934528, v10
    buffer_load_dwordx4 v4, s[4:7], s31 offen offset:2048 lds
    v_mfma_f32_16x16x32_bf16 v[204:207], v[76:79], v[40:43], v[204:207]
    ds_read_b64_tr_b16 v[68:69], v11 offset:57344
    v_mfma_f32_16x16x32_bf16 v[236:239], v[76:79], v[44:47], v[236:239]
    ds_read_b64_tr_b16 v[70:71], v11 offset:58368
    v_add_u32 v11, 4294934528, v11
    s_waitcnt lgkmcnt(8)
    v_mfma_f32_16x16x32_bf16 v[208:211], v[80:83], v[40:43], v[208:211]
    ds_read_b64_tr_b16 v[72:73], v12 offset:57344
    v_mfma_f32_16x16x32_bf16 v[240:243], v[80:83], v[44:47], v[240:243]
    ds_read_b64_tr_b16 v[74:75], v12 offset:58368
    v_add_u32 v12, 4294934528, v12
    buffer_load_dwordx4 v[120:123], v6, s[8:11], s32 offen offset:3072 sc1
    v_mfma_f32_16x16x32_bf16 v[212:215], v[84:87], v[40:43], v[212:215]
    ds_read_b64_tr_b16 v[76:77], v13 offset:57344
    v_mfma_f32_16x16x32_bf16 v[244:247], v[84:87], v[44:47], v[244:247]
    ds_read_b64_tr_b16 v[78:79], v13 offset:58368
    v_add_u32 v13, 4294934528, v13
    s_waitcnt lgkmcnt(8)
    v_mfma_f32_16x16x32_bf16 v[216:219], v[88:91], v[40:43], v[216:219]
    ds_read_b64_tr_b16 v[80:81], v14 offset:57344
    v_mfma_f32_16x16x32_bf16 v[248:251], v[88:91], v[44:47], v[248:251]
    ds_read_b64_tr_b16 v[82:83], v14 offset:58368
    v_add_u32 v14, 4294934528, v14
    buffer_load_dwordx4 v[124:127], v7, s[8:11], s32 offen offset:3072 sc1
    v_mfma_f32_16x16x32_bf16 v[220:223], v[92:95], v[40:43], v[220:223]
    ds_read_b64_tr_b16 v[84:85], v15 offset:57344
    v_mfma_f32_16x16x32_bf16 v[252:255], v[92:95], v[44:47], v[252:255]
    ds_read_b64_tr_b16 v[86:87], v15 offset:58368
    v_add_u32 v15, 4294934528, v15
    s_waitcnt lgkmcnt(8)
    s_waitcnt vmcnt(13)
    v_mfma_f32_16x16x32_bf16 v[192:195], v[64:67], v[48:51], v[192:195]
    ds_read_b64_tr_b16 v[88:89], v16 offset:57344
    v_mfma_f32_16x16x32_bf16 v[224:227], v[64:67], v[52:55], v[224:227]
    ds_read_b64_tr_b16 v[90:91], v16 offset:58368
    v_add_u32 v16, 4294934528, v16
    buffer_load_dwordx4 v5, s[4:7], s31 offen offset:3072 lds
    v_mfma_f32_16x16x32_bf16 v[196:199], v[68:71], v[48:51], v[196:199]
    ds_read_b64_tr_b16 v[92:93], v17 offset:57344
    v_mfma_f32_16x16x32_bf16 v[228:231], v[68:71], v[52:55], v[228:231]
    ds_read_b64_tr_b16 v[94:95], v17 offset:58368
    v_add_u32 v17, 4294934528, v17
    s_barrier
    s_waitcnt lgkmcnt(8)
    v_mfma_f32_16x16x32_bf16 v[200:203], v[72:75], v[48:51], v[200:203]
    ds_read_b64_tr_b16 v[64:65], v10 offset:0
    v_mfma_f32_16x16x32_bf16 v[232:235], v[72:75], v[52:55], v[232:235]
    ds_read_b64_tr_b16 v[66:67], v10 offset:1024
    s_mov_b32 s32, 16384
    buffer_load_dwordx4 v[24:27], v6, s[8:11], s32 offen offset:0 sc1
    v_mfma_f32_16x16x32_bf16 v[204:207], v[76:79], v[48:51], v[204:207]
    ds_read_b64_tr_b16 v[68:69], v11 offset:0
    v_mfma_f32_16x16x32_bf16 v[236:239], v[76:79], v[52:55], v[236:239]
    ds_read_b64_tr_b16 v[70:71], v11 offset:1024
    s_waitcnt lgkmcnt(8)
    v_mfma_f32_16x16x32_bf16 v[208:211], v[80:83], v[48:51], v[208:211]
    ds_read_b64_tr_b16 v[72:73], v12 offset:0
    v_mfma_f32_16x16x32_bf16 v[240:243], v[80:83], v[52:55], v[240:243]
    ds_read_b64_tr_b16 v[74:75], v12 offset:1024
    buffer_load_dwordx4 v[28:31], v7, s[8:11], s32 offen offset:0 sc1
    v_mfma_f32_16x16x32_bf16 v[212:215], v[84:87], v[48:51], v[212:215]
    ds_read_b64_tr_b16 v[76:77], v13 offset:0
    v_mfma_f32_16x16x32_bf16 v[244:247], v[84:87], v[52:55], v[244:247]
    ds_read_b64_tr_b16 v[78:79], v13 offset:1024
    s_waitcnt lgkmcnt(8)
    v_mfma_f32_16x16x32_bf16 v[216:219], v[88:91], v[48:51], v[216:219]
    ds_read_b64_tr_b16 v[80:81], v14 offset:0
    v_mfma_f32_16x16x32_bf16 v[248:251], v[88:91], v[52:55], v[248:251]
    ds_read_b64_tr_b16 v[82:83], v14 offset:1024
    buffer_store_dwordx4 v[152:155], v60, s[16:19], s47 offen sc1
    v_mfma_f32_16x16x32_bf16 v[220:223], v[92:95], v[48:51], v[220:223]
    ds_read_b64_tr_b16 v[84:85], v15 offset:0
    v_mfma_f32_16x16x32_bf16 v[252:255], v[92:95], v[52:55], v[252:255]
    ds_read_b64_tr_b16 v[86:87], v15 offset:1024
    s_waitcnt lgkmcnt(8)
    s_waitcnt vmcnt(15)
    v_mfma_f32_16x16x32_bf16 v[192:195], v[64:67], v[96:99], v[192:195]
    ds_read_b64_tr_b16 v[88:89], v16 offset:0
    v_mfma_f32_16x16x32_bf16 v[224:227], v[64:67], v[100:103], v[224:227]
    ds_read_b64_tr_b16 v[90:91], v16 offset:1024
    v_mfma_f32_16x16x32_bf16 v[196:199], v[68:71], v[96:99], v[196:199]
    ds_read_b64_tr_b16 v[92:93], v17 offset:0
    v_mfma_f32_16x16x32_bf16 v[228:231], v[68:71], v[100:103], v[228:231]
    ds_read_b64_tr_b16 v[94:95], v17 offset:1024
    s_waitcnt lgkmcnt(8)
    v_mfma_f32_16x16x32_bf16 v[200:203], v[72:75], v[96:99], v[200:203]
    ds_read_b64_tr_b16 v[64:65], v10 offset:8192
    v_mfma_f32_16x16x32_bf16 v[232:235], v[72:75], v[100:103], v[232:235]
    ds_read_b64_tr_b16 v[66:67], v10 offset:9216
    v_mfma_f32_16x16x32_bf16 v[204:207], v[76:79], v[96:99], v[204:207]
    ds_read_b64_tr_b16 v[68:69], v11 offset:8192
    v_mfma_f32_16x16x32_bf16 v[236:239], v[76:79], v[100:103], v[236:239]
    ds_read_b64_tr_b16 v[70:71], v11 offset:9216
    s_waitcnt lgkmcnt(8)
    v_mfma_f32_16x16x32_bf16 v[208:211], v[80:83], v[96:99], v[208:211]
    ds_read_b64_tr_b16 v[72:73], v12 offset:8192
    buffer_load_dwordx4 v[32:35], v6, s[8:11], s32 offen offset:1024 sc1
    v_mfma_f32_16x16x32_bf16 v[240:243], v[80:83], v[100:103], v[240:243]
    ds_read_b64_tr_b16 v[74:75], v12 offset:9216
    v_mfma_f32_16x16x32_bf16 v[212:215], v[84:87], v[96:99], v[212:215]
    ds_read_b64_tr_b16 v[76:77], v13 offset:8192
    v_mfma_f32_16x16x32_bf16 v[244:247], v[84:87], v[100:103], v[244:247]
    ds_read_b64_tr_b16 v[78:79], v13 offset:9216
    s_waitcnt lgkmcnt(8)
    v_mfma_f32_16x16x32_bf16 v[216:219], v[88:91], v[96:99], v[216:219]
    ds_read_b64_tr_b16 v[80:81], v14 offset:8192
    buffer_load_dwordx4 v[36:39], v7, s[8:11], s32 offen offset:1024 sc1
    v_mfma_f32_16x16x32_bf16 v[248:251], v[88:91], v[100:103], v[248:251]
    ds_read_b64_tr_b16 v[82:83], v14 offset:9216
    v_mfma_f32_16x16x32_bf16 v[220:223], v[92:95], v[96:99], v[220:223]
    ds_read_b64_tr_b16 v[84:85], v15 offset:8192
    v_mfma_f32_16x16x32_bf16 v[252:255], v[92:95], v[100:103], v[252:255]
    ds_read_b64_tr_b16 v[86:87], v15 offset:9216
    s_waitcnt lgkmcnt(8)
    s_waitcnt vmcnt(14)
    v_mfma_f32_16x16x32_bf16 v[192:195], v[64:67], v[104:107], v[192:195]
    ds_read_b64_tr_b16 v[88:89], v16 offset:8192
    v_mfma_f32_16x16x32_bf16 v[224:227], v[64:67], v[108:111], v[224:227]
    ds_read_b64_tr_b16 v[90:91], v16 offset:9216
    s_add_u32 m0, s33, 0
    s_mov_b32 s31, 5242880
    buffer_load_dwordx4 v2, s[4:7], s31 offen offset:0 lds
    v_mfma_f32_16x16x32_bf16 v[196:199], v[68:71], v[104:107], v[196:199]
    ds_read_b64_tr_b16 v[92:93], v17 offset:8192
    v_mfma_f32_16x16x32_bf16 v[228:231], v[68:71], v[108:111], v[228:231]
    ds_read_b64_tr_b16 v[94:95], v17 offset:9216
    s_waitcnt lgkmcnt(8)
    v_mfma_f32_16x16x32_bf16 v[200:203], v[72:75], v[104:107], v[200:203]
    ds_read_b64_tr_b16 v[64:65], v10 offset:16384
    buffer_load_dwordx4 v[40:43], v6, s[8:11], s32 offen offset:2048 sc1
    v_mfma_f32_16x16x32_bf16 v[232:235], v[72:75], v[108:111], v[232:235]
    ds_read_b64_tr_b16 v[66:67], v10 offset:17408
    v_mfma_f32_16x16x32_bf16 v[204:207], v[76:79], v[104:107], v[204:207]
    ds_read_b64_tr_b16 v[68:69], v11 offset:16384
    v_mfma_f32_16x16x32_bf16 v[236:239], v[76:79], v[108:111], v[236:239]
    ds_read_b64_tr_b16 v[70:71], v11 offset:17408
    s_waitcnt lgkmcnt(8)
    v_mfma_f32_16x16x32_bf16 v[208:211], v[80:83], v[104:107], v[208:211]
    ds_read_b64_tr_b16 v[72:73], v12 offset:16384
    buffer_load_dwordx4 v[44:47], v7, s[8:11], s32 offen offset:2048 sc1
    v_mfma_f32_16x16x32_bf16 v[240:243], v[80:83], v[108:111], v[240:243]
    ds_read_b64_tr_b16 v[74:75], v12 offset:17408
    v_mfma_f32_16x16x32_bf16 v[212:215], v[84:87], v[104:107], v[212:215]
    ds_read_b64_tr_b16 v[76:77], v13 offset:16384
    v_mfma_f32_16x16x32_bf16 v[244:247], v[84:87], v[108:111], v[244:247]
    ds_read_b64_tr_b16 v[78:79], v13 offset:17408
    s_waitcnt lgkmcnt(8)
    v_mfma_f32_16x16x32_bf16 v[216:219], v[88:91], v[104:107], v[216:219]
    ds_read_b64_tr_b16 v[80:81], v14 offset:16384
    v_mfma_f32_16x16x32_bf16 v[248:251], v[88:91], v[108:111], v[248:251]
    ds_read_b64_tr_b16 v[82:83], v14 offset:17408
    buffer_store_dwordx4 v[156:159], v61, s[16:19], s47 offen sc1
    v_mfma_f32_16x16x32_bf16 v[220:223], v[92:95], v[104:107], v[220:223]
    ds_read_b64_tr_b16 v[84:85], v15 offset:16384
    v_mfma_f32_16x16x32_bf16 v[252:255], v[92:95], v[108:111], v[252:255]
    ds_read_b64_tr_b16 v[86:87], v15 offset:17408
    s_waitcnt lgkmcnt(8)
    s_waitcnt vmcnt(15)
    v_mfma_f32_16x16x32_bf16 v[192:195], v[64:67], v[112:115], v[192:195]
    ds_read_b64_tr_b16 v[88:89], v16 offset:16384
    v_mfma_f32_16x16x32_bf16 v[224:227], v[64:67], v[116:119], v[224:227]
    ds_read_b64_tr_b16 v[90:91], v16 offset:17408
    v_mfma_f32_16x16x32_bf16 v[196:199], v[68:71], v[112:115], v[196:199]
    ds_read_b64_tr_b16 v[92:93], v17 offset:16384
    v_mfma_f32_16x16x32_bf16 v[228:231], v[68:71], v[116:119], v[228:231]
    ds_read_b64_tr_b16 v[94:95], v17 offset:17408
    s_waitcnt lgkmcnt(8)
    v_mfma_f32_16x16x32_bf16 v[200:203], v[72:75], v[112:115], v[200:203]
    ds_read_b64_tr_b16 v[64:65], v10 offset:24576
    v_mfma_f32_16x16x32_bf16 v[232:235], v[72:75], v[116:119], v[232:235]
    ds_read_b64_tr_b16 v[66:67], v10 offset:25600
    v_mfma_f32_16x16x32_bf16 v[204:207], v[76:79], v[112:115], v[204:207]
    ds_read_b64_tr_b16 v[68:69], v11 offset:24576
    v_mfma_f32_16x16x32_bf16 v[236:239], v[76:79], v[116:119], v[236:239]
    ds_read_b64_tr_b16 v[70:71], v11 offset:25600
    buffer_load_dwordx4 v3, s[4:7], s31 offen offset:1024 lds
    s_waitcnt lgkmcnt(8)
    v_mfma_f32_16x16x32_bf16 v[208:211], v[80:83], v[112:115], v[208:211]
    ds_read_b64_tr_b16 v[72:73], v12 offset:24576
    v_mfma_f32_16x16x32_bf16 v[240:243], v[80:83], v[116:119], v[240:243]
    ds_read_b64_tr_b16 v[74:75], v12 offset:25600
    v_mfma_f32_16x16x32_bf16 v[212:215], v[84:87], v[112:115], v[212:215]
    ds_read_b64_tr_b16 v[76:77], v13 offset:24576
    v_mfma_f32_16x16x32_bf16 v[244:247], v[84:87], v[116:119], v[244:247]
    ds_read_b64_tr_b16 v[78:79], v13 offset:25600
    buffer_load_dwordx4 v4, s[4:7], s31 offen offset:2048 lds
    s_waitcnt lgkmcnt(8)
    v_mfma_f32_16x16x32_bf16 v[216:219], v[88:91], v[112:115], v[216:219]
    ds_read_b64_tr_b16 v[80:81], v14 offset:24576
    v_mfma_f32_16x16x32_bf16 v[248:251], v[88:91], v[116:119], v[248:251]
    ds_read_b64_tr_b16 v[82:83], v14 offset:25600
    v_mfma_f32_16x16x32_bf16 v[220:223], v[92:95], v[112:115], v[220:223]
    ds_read_b64_tr_b16 v[84:85], v15 offset:24576
    v_mfma_f32_16x16x32_bf16 v[252:255], v[92:95], v[116:119], v[252:255]
    ds_read_b64_tr_b16 v[86:87], v15 offset:25600
    buffer_load_dwordx4 v[48:51], v6, s[8:11], s32 offen offset:3072 sc1
    s_waitcnt lgkmcnt(8)
    s_waitcnt vmcnt(13)
    v_mfma_f32_16x16x32_bf16 v[192:195], v[64:67], v[120:123], v[192:195]
    ds_read_b64_tr_b16 v[88:89], v16 offset:24576
    v_mfma_f32_16x16x32_bf16 v[224:227], v[64:67], v[124:127], v[224:227]
    ds_read_b64_tr_b16 v[90:91], v16 offset:25600
    v_mfma_f32_16x16x32_bf16 v[196:199], v[68:71], v[120:123], v[196:199]
    ds_read_b64_tr_b16 v[92:93], v17 offset:24576
    v_mfma_f32_16x16x32_bf16 v[228:231], v[68:71], v[124:127], v[228:231]
    ds_read_b64_tr_b16 v[94:95], v17 offset:25600
    buffer_load_dwordx4 v[52:55], v7, s[8:11], s32 offen offset:3072 sc1
    s_waitcnt vmcnt(13)
    s_barrier
    s_waitcnt lgkmcnt(8)
    v_mfma_f32_16x16x32_bf16 v[200:203], v[72:75], v[120:123], v[200:203]
    ds_read_b64_tr_b16 v[64:65], v10 offset:32768
    v_mfma_f32_16x16x32_bf16 v[232:235], v[72:75], v[124:127], v[232:235]
    ds_read_b64_tr_b16 v[66:67], v10 offset:33792
    v_mfma_f32_16x16x32_bf16 v[204:207], v[76:79], v[120:123], v[204:207]
    ds_read_b64_tr_b16 v[68:69], v11 offset:32768
    v_mfma_f32_16x16x32_bf16 v[236:239], v[76:79], v[124:127], v[236:239]
    ds_read_b64_tr_b16 v[70:71], v11 offset:33792
    buffer_load_dwordx4 v5, s[4:7], s31 offen offset:3072 lds
    s_waitcnt lgkmcnt(8)
    v_mfma_f32_16x16x32_bf16 v[208:211], v[80:83], v[120:123], v[208:211]
    ds_read_b64_tr_b16 v[72:73], v12 offset:32768
    v_mfma_f32_16x16x32_bf16 v[240:243], v[80:83], v[124:127], v[240:243]
    ds_read_b64_tr_b16 v[74:75], v12 offset:33792
    v_mfma_f32_16x16x32_bf16 v[212:215], v[84:87], v[120:123], v[212:215]
    ds_read_b64_tr_b16 v[76:77], v13 offset:32768
    v_mfma_f32_16x16x32_bf16 v[244:247], v[84:87], v[124:127], v[244:247]
    ds_read_b64_tr_b16 v[78:79], v13 offset:33792
    s_mov_b32 s32, 20480
    buffer_load_dwordx4 v[96:99], v6, s[8:11], s32 offen offset:0 sc1
    s_waitcnt lgkmcnt(8)
    v_mfma_f32_16x16x32_bf16 v[216:219], v[88:91], v[120:123], v[216:219]
    ds_read_b64_tr_b16 v[80:81], v14 offset:32768
    v_mfma_f32_16x16x32_bf16 v[248:251], v[88:91], v[124:127], v[248:251]
    ds_read_b64_tr_b16 v[82:83], v14 offset:33792
    v_mfma_f32_16x16x32_bf16 v[220:223], v[92:95], v[120:123], v[220:223]
    ds_read_b64_tr_b16 v[84:85], v15 offset:32768
    v_mfma_f32_16x16x32_bf16 v[252:255], v[92:95], v[124:127], v[252:255]
    ds_read_b64_tr_b16 v[86:87], v15 offset:33792
    buffer_load_dwordx4 v[100:103], v7, s[8:11], s32 offen offset:0 sc1
    s_waitcnt lgkmcnt(8)
    s_waitcnt vmcnt(14)
    v_mfma_f32_16x16x32_bf16 v[192:195], v[64:67], v[24:27], v[192:195]
    ds_read_b64_tr_b16 v[88:89], v16 offset:32768
    v_mfma_f32_16x16x32_bf16 v[224:227], v[64:67], v[28:31], v[224:227]
    ds_read_b64_tr_b16 v[90:91], v16 offset:33792
    v_mfma_f32_16x16x32_bf16 v[196:199], v[68:71], v[24:27], v[196:199]
    ds_read_b64_tr_b16 v[92:93], v17 offset:32768
    v_mfma_f32_16x16x32_bf16 v[228:231], v[68:71], v[28:31], v[228:231]
    ds_read_b64_tr_b16 v[94:95], v17 offset:33792
    s_cmp_eq_u32 s30, 0
    s_cselect_b32 s18, 0, s18
    buffer_store_dwordx4 v[160:163], v58, s[16:19], s48 offen sc1
    s_waitcnt lgkmcnt(8)
    v_mfma_f32_16x16x32_bf16 v[200:203], v[72:75], v[24:27], v[200:203]
    ds_read_b64_tr_b16 v[64:65], v10 offset:40960
    v_mfma_f32_16x16x32_bf16 v[232:235], v[72:75], v[28:31], v[232:235]
    ds_read_b64_tr_b16 v[66:67], v10 offset:41984
    v_mfma_f32_16x16x32_bf16 v[204:207], v[76:79], v[24:27], v[204:207]
    ds_read_b64_tr_b16 v[68:69], v11 offset:40960
    v_mfma_f32_16x16x32_bf16 v[236:239], v[76:79], v[28:31], v[236:239]
    ds_read_b64_tr_b16 v[70:71], v11 offset:41984
    s_waitcnt lgkmcnt(8)
    v_mfma_f32_16x16x32_bf16 v[208:211], v[80:83], v[24:27], v[208:211]
    ds_read_b64_tr_b16 v[72:73], v12 offset:40960
    v_mfma_f32_16x16x32_bf16 v[240:243], v[80:83], v[28:31], v[240:243]
    ds_read_b64_tr_b16 v[74:75], v12 offset:41984
    v_mfma_f32_16x16x32_bf16 v[212:215], v[84:87], v[24:27], v[212:215]
    ds_read_b64_tr_b16 v[76:77], v13 offset:40960
    v_mfma_f32_16x16x32_bf16 v[244:247], v[84:87], v[28:31], v[244:247]
    ds_read_b64_tr_b16 v[78:79], v13 offset:41984
    s_waitcnt lgkmcnt(8)
    v_mfma_f32_16x16x32_bf16 v[216:219], v[88:91], v[24:27], v[216:219]
    ds_read_b64_tr_b16 v[80:81], v14 offset:40960
    v_mfma_f32_16x16x32_bf16 v[248:251], v[88:91], v[28:31], v[248:251]
    ds_read_b64_tr_b16 v[82:83], v14 offset:41984
    v_mfma_f32_16x16x32_bf16 v[220:223], v[92:95], v[24:27], v[220:223]
    ds_read_b64_tr_b16 v[84:85], v15 offset:40960
    buffer_load_dwordx4 v[104:107], v6, s[8:11], s32 offen offset:1024 sc1
    v_mfma_f32_16x16x32_bf16 v[252:255], v[92:95], v[28:31], v[252:255]
    ds_read_b64_tr_b16 v[86:87], v15 offset:41984
    s_waitcnt lgkmcnt(8)
    s_waitcnt vmcnt(13)
    v_mfma_f32_16x16x32_bf16 v[192:195], v[64:67], v[32:35], v[192:195]
    ds_read_b64_tr_b16 v[88:89], v16 offset:40960
    v_mfma_f32_16x16x32_bf16 v[224:227], v[64:67], v[36:39], v[224:227]
    ds_read_b64_tr_b16 v[90:91], v16 offset:41984
    v_mfma_f32_16x16x32_bf16 v[196:199], v[68:71], v[32:35], v[196:199]
    ds_read_b64_tr_b16 v[92:93], v17 offset:40960
    buffer_load_dwordx4 v[108:111], v7, s[8:11], s32 offen offset:1024 sc1
    v_mfma_f32_16x16x32_bf16 v[228:231], v[68:71], v[36:39], v[228:231]
    ds_read_b64_tr_b16 v[94:95], v17 offset:41984
    s_waitcnt lgkmcnt(8)
    v_mfma_f32_16x16x32_bf16 v[200:203], v[72:75], v[32:35], v[200:203]
    ds_read_b64_tr_b16 v[64:65], v10 offset:49152
    v_mfma_f32_16x16x32_bf16 v[232:235], v[72:75], v[36:39], v[232:235]
    ds_read_b64_tr_b16 v[66:67], v10 offset:50176
    v_mfma_f32_16x16x32_bf16 v[204:207], v[76:79], v[32:35], v[204:207]
    ds_read_b64_tr_b16 v[68:69], v11 offset:49152
    s_add_u32 m0, s33, 131072
    s_mov_b32 s31, 6291456
    buffer_load_dwordx4 v2, s[4:7], s31 offen offset:0 lds
    v_mfma_f32_16x16x32_bf16 v[236:239], v[76:79], v[36:39], v[236:239]
    ds_read_b64_tr_b16 v[70:71], v11 offset:50176
    s_waitcnt lgkmcnt(8)
    v_mfma_f32_16x16x32_bf16 v[208:211], v[80:83], v[32:35], v[208:211]
    ds_read_b64_tr_b16 v[72:73], v12 offset:49152
    v_mfma_f32_16x16x32_bf16 v[240:243], v[80:83], v[36:39], v[240:243]
    ds_read_b64_tr_b16 v[74:75], v12 offset:50176
    v_mfma_f32_16x16x32_bf16 v[212:215], v[84:87], v[32:35], v[212:215]
    ds_read_b64_tr_b16 v[76:77], v13 offset:49152
    buffer_store_dwordx4 v[164:167], v59, s[16:19], s48 offen sc1
    v_mfma_f32_16x16x32_bf16 v[244:247], v[84:87], v[36:39], v[244:247]
    ds_read_b64_tr_b16 v[78:79], v13 offset:50176
    s_waitcnt lgkmcnt(8)
    v_mfma_f32_16x16x32_bf16 v[216:219], v[88:91], v[32:35], v[216:219]
    ds_read_b64_tr_b16 v[80:81], v14 offset:49152
    v_mfma_f32_16x16x32_bf16 v[248:251], v[88:91], v[36:39], v[248:251]
    ds_read_b64_tr_b16 v[82:83], v14 offset:50176
    v_mfma_f32_16x16x32_bf16 v[220:223], v[92:95], v[32:35], v[220:223]
    ds_read_b64_tr_b16 v[84:85], v15 offset:49152
    v_mfma_f32_16x16x32_bf16 v[252:255], v[92:95], v[36:39], v[252:255]
    ds_read_b64_tr_b16 v[86:87], v15 offset:50176
    s_waitcnt lgkmcnt(8)
    s_waitcnt vmcnt(13)
    v_mfma_f32_16x16x32_bf16 v[192:195], v[64:67], v[40:43], v[192:195]
    ds_read_b64_tr_b16 v[88:89], v16 offset:49152
    v_mfma_f32_16x16x32_bf16 v[224:227], v[64:67], v[44:47], v[224:227]
    ds_read_b64_tr_b16 v[90:91], v16 offset:50176
    v_mfma_f32_16x16x32_bf16 v[196:199], v[68:71], v[40:43], v[196:199]
    ds_read_b64_tr_b16 v[92:93], v17 offset:49152
    v_mfma_f32_16x16x32_bf16 v[228:231], v[68:71], v[44:47], v[228:231]
    ds_read_b64_tr_b16 v[94:95], v17 offset:50176
    s_waitcnt lgkmcnt(8)
    v_mfma_f32_16x16x32_bf16 v[200:203], v[72:75], v[40:43], v[200:203]
    ds_read_b64_tr_b16 v[64:65], v10 offset:57344
    v_mfma_f32_16x16x32_bf16 v[232:235], v[72:75], v[44:47], v[232:235]
    ds_read_b64_tr_b16 v[66:67], v10 offset:58368
    v_add_u32 v10, 4294901760, v10
    buffer_load_dwordx4 v[112:115], v6, s[8:11], s32 offen offset:2048 sc1
    v_mfma_f32_16x16x32_bf16 v[204:207], v[76:79], v[40:43], v[204:207]
    ds_read_b64_tr_b16 v[68:69], v11 offset:57344
    v_mfma_f32_16x16x32_bf16 v[236:239], v[76:79], v[44:47], v[236:239]
    ds_read_b64_tr_b16 v[70:71], v11 offset:58368
    v_add_u32 v11, 4294901760, v11
    s_waitcnt lgkmcnt(8)
    v_mfma_f32_16x16x32_bf16 v[208:211], v[80:83], v[40:43], v[208:211]
    ds_read_b64_tr_b16 v[72:73], v12 offset:57344
    v_mfma_f32_16x16x32_bf16 v[240:243], v[80:83], v[44:47], v[240:243]
    ds_read_b64_tr_b16 v[74:75], v12 offset:58368
    v_add_u32 v12, 4294901760, v12
    buffer_load_dwordx4 v[116:119], v7, s[8:11], s32 offen offset:2048 sc1
    v_mfma_f32_16x16x32_bf16 v[212:215], v[84:87], v[40:43], v[212:215]
    ds_read_b64_tr_b16 v[76:77], v13 offset:57344
    v_mfma_f32_16x16x32_bf16 v[244:247], v[84:87], v[44:47], v[244:247]
    ds_read_b64_tr_b16 v[78:79], v13 offset:58368
    v_add_u32 v13, 4294901760, v13
    s_waitcnt lgkmcnt(8)
    v_mfma_f32_16x16x32_bf16 v[216:219], v[88:91], v[40:43], v[216:219]
    ds_read_b64_tr_b16 v[80:81], v14 offset:57344
    v_mfma_f32_16x16x32_bf16 v[248:251], v[88:91], v[44:47], v[248:251]
    ds_read_b64_tr_b16 v[82:83], v14 offset:58368
    v_add_u32 v14, 4294901760, v14
    buffer_load_dwordx4 v3, s[4:7], s31 offen offset:1024 lds
    v_mfma_f32_16x16x32_bf16 v[220:223], v[92:95], v[40:43], v[220:223]
    ds_read_b64_tr_b16 v[84:85], v15 offset:57344
    v_mfma_f32_16x16x32_bf16 v[252:255], v[92:95], v[44:47], v[252:255]
    ds_read_b64_tr_b16 v[86:87], v15 offset:58368
    v_add_u32 v15, 4294901760, v15
    s_waitcnt lgkmcnt(8)
    s_waitcnt vmcnt(11)
    v_mfma_f32_16x16x32_bf16 v[192:195], v[64:67], v[48:51], v[192:195]
    ds_read_b64_tr_b16 v[88:89], v16 offset:57344
    v_mfma_f32_16x16x32_bf16 v[224:227], v[64:67], v[52:55], v[224:227]
    ds_read_b64_tr_b16 v[90:91], v16 offset:58368
    v_add_u32 v16, 4294901760, v16
    buffer_load_dwordx4 v4, s[4:7], s31 offen offset:2048 lds
    v_mfma_f32_16x16x32_bf16 v[196:199], v[68:71], v[48:51], v[196:199]
    ds_read_b64_tr_b16 v[92:93], v17 offset:57344
    v_mfma_f32_16x16x32_bf16 v[228:231], v[68:71], v[52:55], v[228:231]
    ds_read_b64_tr_b16 v[94:95], v17 offset:58368
    v_add_u32 v17, 4294901760, v17
    s_waitcnt vmcnt(11)
    s_cmp_eq_u32 s30, 0
    s_cbranch_scc1 L_recurrent_scan__compressed_kv_cla__moe_arch_mod__prompt_kernel_rare_46
L_recurrent_scan__compressed_kv_cla__moe_arch_mod__prompt_kernel_back_47:
    s_barrier
    s_waitcnt lgkmcnt(8)
    v_mfma_f32_16x16x32_bf16 v[200:203], v[72:75], v[48:51], v[200:203]
    ds_read_b64_tr_b16 v[64:65], v10 offset:0
    buffer_load_dwordx4 v[120:123], v6, s[8:11], s32 offen offset:3072 sc1
    v_mfma_f32_16x16x32_bf16 v[232:235], v[72:75], v[52:55], v[232:235]
    ds_read_b64_tr_b16 v[66:67], v10 offset:1024
    s_lshl_b32 s36, s30, 3
    s_add_u32 s36, s28, s36
    s_cmp_eq_u32 s36, 4
    s_cbranch_scc1 L_recurrent_scan__compressed_kv_cla__moe_arch_mod__prompt_kernel_rare_50
L_recurrent_scan__compressed_kv_cla__moe_arch_mod__prompt_kernel_back_51:
    v_mfma_f32_16x16x32_bf16 v[204:207], v[76:79], v[48:51], v[204:207]
    ds_read_b64_tr_b16 v[68:69], v11 offset:0
    v_mfma_f32_16x16x32_bf16 v[236:239], v[76:79], v[52:55], v[236:239]
    ds_read_b64_tr_b16 v[70:71], v11 offset:1024
    s_waitcnt lgkmcnt(8)
    v_mfma_f32_16x16x32_bf16 v[208:211], v[80:83], v[48:51], v[208:211]
    ds_read_b64_tr_b16 v[72:73], v12 offset:0
    buffer_load_dwordx4 v[124:127], v7, s[8:11], s32 offen offset:3072 sc1
    v_mfma_f32_16x16x32_bf16 v[240:243], v[80:83], v[52:55], v[240:243]
    ds_read_b64_tr_b16 v[74:75], v12 offset:1024
    v_mfma_f32_16x16x32_bf16 v[212:215], v[84:87], v[48:51], v[212:215]
    ds_read_b64_tr_b16 v[76:77], v13 offset:0
    v_mfma_f32_16x16x32_bf16 v[244:247], v[84:87], v[52:55], v[244:247]
    ds_read_b64_tr_b16 v[78:79], v13 offset:1024
    s_waitcnt lgkmcnt(8)
    v_mfma_f32_16x16x32_bf16 v[216:219], v[88:91], v[48:51], v[216:219]
    ds_read_b64_tr_b16 v[80:81], v14 offset:0
    v_mfma_f32_16x16x32_bf16 v[248:251], v[88:91], v[52:55], v[248:251]
    ds_read_b64_tr_b16 v[82:83], v14 offset:1024
    buffer_load_dwordx4 v5, s[4:7], s31 offen offset:3072 lds
    v_mfma_f32_16x16x32_bf16 v[220:223], v[92:95], v[48:51], v[220:223]
    ds_read_b64_tr_b16 v[84:85], v15 offset:0
    v_mfma_f32_16x16x32_bf16 v[252:255], v[92:95], v[52:55], v[252:255]
    ds_read_b64_tr_b16 v[86:87], v15 offset:1024
    s_waitcnt lgkmcnt(8)
    s_waitcnt vmcnt(12)
    v_mfma_f32_16x16x32_bf16 v[192:195], v[64:67], v[96:99], v[192:195]
    ds_read_b64_tr_b16 v[88:89], v16 offset:0
    buffer_store_dwordx4 v[168:171], v60, s[16:19], s48 offen sc1
    v_mfma_f32_16x16x32_bf16 v[224:227], v[64:67], v[100:103], v[224:227]
    ds_read_b64_tr_b16 v[90:91], v16 offset:1024
    v_mfma_f32_16x16x32_bf16 v[196:199], v[68:71], v[96:99], v[196:199]
    ds_read_b64_tr_b16 v[92:93], v17 offset:0
    v_mfma_f32_16x16x32_bf16 v[228:231], v[68:71], v[100:103], v[228:231]
    ds_read_b64_tr_b16 v[94:95], v17 offset:1024
    s_waitcnt lgkmcnt(8)
    v_mfma_f32_16x16x32_bf16 v[200:203], v[72:75], v[96:99], v[200:203]
    ds_read_b64_tr_b16 v[64:65], v10 offset:8192
    v_mfma_f32_16x16x32_bf16 v[232:235], v[72:75], v[100:103], v[232:235]
    ds_read_b64_tr_b16 v[66:67], v10 offset:9216
    v_mfma_f32_16x16x32_bf16 v[204:207], v[76:79], v[96:99], v[204:207]
    ds_read_b64_tr_b16 v[68:69], v11 offset:8192
    v_mfma_f32_16x16x32_bf16 v[236:239], v[76:79], v[100:103], v[236:239]
    ds_read_b64_tr_b16 v[70:71], v11 offset:9216
    s_waitcnt lgkmcnt(8)
    v_mfma_f32_16x16x32_bf16 v[208:211], v[80:83], v[96:99], v[208:211]
    ds_read_b64_tr_b16 v[72:73], v12 offset:8192
    v_mfma_f32_16x16x32_bf16 v[240:243], v[80:83], v[100:103], v[240:243]
    ds_read_b64_tr_b16 v[74:75], v12 offset:9216
    v_mfma_f32_16x16x32_bf16 v[212:215], v[84:87], v[96:99], v[212:215]
    ds_read_b64_tr_b16 v[76:77], v13 offset:8192
    v_mfma_f32_16x16x32_bf16 v[244:247], v[84:87], v[100:103], v[244:247]
    ds_read_b64_tr_b16 v[78:79], v13 offset:9216
    s_mov_b32 s32, 24576
    buffer_load_dwordx4 v[24:27], v6, s[8:11], s32 offen offset:0 sc1
    s_waitcnt lgkmcnt(8)
    v_mfma_f32_16x16x32_bf16 v[216:219], v[88:91], v[96:99], v[216:219]
    ds_read_b64_tr_b16 v[80:81], v14 offset:8192
    v_mfma_f32_16x16x32_bf16 v[248:251], v[88:91], v[100:103], v[248:251]
    ds_read_b64_tr_b16 v[82:83], v14 offset:9216
    v_mfma_f32_16x16x32_bf16 v[220:223], v[92:95], v[96:99], v[220:223]
    ds_read_b64_tr_b16 v[84:85], v15 offset:8192
    v_mfma_f32_16x16x32_bf16 v[252:255], v[92:95], v[100:103], v[252:255]
    ds_read_b64_tr_b16 v[86:87], v15 offset:9216
    buffer_load_dwordx4 v[28:31], v7, s[8:11], s32 offen offset:0 sc1
    s_waitcnt lgkmcnt(8)
    s_waitcnt vmcnt(12)
    v_mfma_f32_16x16x32_bf16 v[192:195], v[64:67], v[104:107], v[192:195]
    ds_read_b64_tr_b16 v[88:89], v16 offset:8192
    v_mfma_f32_16x16x32_bf16 v[224:227], v[64:67], v[108:111], v[224:227]
    ds_read_b64_tr_b16 v[90:91], v16 offset:9216
    v_mfma_f32_16x16x32_bf16 v[196:199], v[68:71], v[104:107], v[196:199]
    ds_read_b64_tr_b16 v[92:93], v17 offset:8192
    v_mfma_f32_16x16x32_bf16 v[228:231], v[68:71], v[108:111], v[228:231]
    ds_read_b64_tr_b16 v[94:95], v17 offset:9216
    buffer_load_dwordx4 v[32:35], v6, s[8:11], s32 offen offset:1024 sc1
    s_waitcnt lgkmcnt(8)
    v_mfma_f32_16x16x32_bf16 v[200:203], v[72:75], v[104:107], v[200:203]
    ds_read_b64_tr_b16 v[64:65], v10 offset:16384
    v_mfma_f32_16x16x32_bf16 v[232:235], v[72:75], v[108:111], v[232:235]
    ds_read_b64_tr_b16 v[66:67], v10 offset:17408
    v_mfma_f32_16x16x32_bf16 v[204:207], v[76:79], v[104:107], v[204:207]
    ds_read_b64_tr_b16 v[68:69], v11 offset:16384
    v_mfma_f32_16x16x32_bf16 v[236:239], v[76:79], v[108:111], v[236:239]
    ds_read_b64_tr_b16 v[70:71], v11 offset:17408
    s_waitcnt lgkmcnt(8)
    v_mfma_f32_16x16x32_bf16 v[208:211], v[80:83], v[104:107], v[208:211]
    ds_read_b64_tr_b16 v[72:73], v12 offset:16384
    buffer_load_dwordx4 v[36:39], v7, s[8:11], s32 offen offset:1024 sc1
    v_mfma_f32_16x16x32_bf16 v[240:243], v[80:83], v[108:111], v[240:243]
    ds_read_b64_tr_b16 v[74:75], v12 offset:17408
    v_mfma_f32_16x16x32_bf16 v[212:215], v[84:87], v[104:107], v[212:215]
    ds_read_b64_tr_b16 v[76:77], v13 offset:16384
    v_mfma_f32_16x16x32_bf16 v[244:247], v[84:87], v[108:111], v[244:247]
    ds_read_b64_tr_b16 v[78:79], v13 offset:17408
    s_waitcnt lgkmcnt(8)
    v_mfma_f32_16x16x32_bf16 v[216:219], v[88:91], v[104:107], v[216:219]
    ds_read_b64_tr_b16 v[80:81], v14 offset:16384
    buffer_store_dwordx4 v[172:175], v61, s[16:19], s48 offen sc1
    v_mfma_f32_16x16x32_bf16 v[248:251], v[88:91], v[108:111], v[248:251]
    ds_read_b64_tr_b16 v[82:83], v14 offset:17408
    v_mfma_f32_16x16x32_bf16 v[220:223], v[92:95], v[104:107], v[220:223]
    ds_read_b64_tr_b16 v[84:85], v15 offset:16384
    v_mfma_f32_16x16x32_bf16 v[252:255], v[92:95], v[108:111], v[252:255]
    ds_read_b64_tr_b16 v[86:87], v15 offset:17408
    s_waitcnt lgkmcnt(8)
    s_waitcnt vmcnt(11)
    v_mfma_f32_16x16x32_bf16 v[192:195], v[64:67], v[112:115], v[192:195]
    ds_read_b64_tr_b16 v[88:89], v16 offset:16384
    v_mfma_f32_16x16x32_bf16 v[224:227], v[64:67], v[116:119], v[224:227]
    ds_read_b64_tr_b16 v[90:91], v16 offset:17408
    v_mfma_f32_16x16x32_bf16 v[196:199], v[68:71], v[112:115], v[196:199]
    ds_read_b64_tr_b16 v[92:93], v17 offset:16384
    v_mfma_f32_16x16x32_bf16 v[228:231], v[68:71], v[116:119], v[228:231]
    ds_read_b64_tr_b16 v[94:95], v17 offset:17408
    s_waitcnt lgkmcnt(8)
    v_mfma_f32_16x16x32_bf16 v[200:203], v[72:75], v[112:115], v[200:203]
    ds_read_b64_tr_b16 v[64:65], v10 offset:24576
    v_mfma_f32_16x16x32_bf16 v[232:235], v[72:75], v[116:119], v[232:235]
    ds_read_b64_tr_b16 v[66:67], v10 offset:25600
    v_add_u32 v10, 98304, v10
    v_mfma_f32_16x16x32_bf16 v[204:207], v[76:79], v[112:115], v[204:207]
    ds_read_b64_tr_b16 v[68:69], v11 offset:24576
    v_mfma_f32_16x16x32_bf16 v[236:239], v[76:79], v[116:119], v[236:239]
    ds_read_b64_tr_b16 v[70:71], v11 offset:25600
    v_add_u32 v11, 98304, v11
    s_add_u32 m0, s33, 32768
    s_mov_b32 s31, 7340032
    buffer_load_dwordx4 v2, s[4:7], s31 offen offset:0 lds
    s_waitcnt lgkmcnt(8)
    v_mfma_f32_16x16x32_bf16 v[208:211], v[80:83], v[112:115], v[208:211]
    ds_read_b64_tr_b16 v[72:73], v12 offset:24576
    v_mfma_f32_16x16x32_bf16 v[240:243], v[80:83], v[116:119], v[240:243]
    ds_read_b64_tr_b16 v[74:75], v12 offset:25600
    v_add_u32 v12, 98304, v12
    v_mfma_f32_16x16x32_bf16 v[212:215], v[84:87], v[112:115], v[212:215]
    ds_read_b64_tr_b16 v[76:77], v13 offset:24576
    buffer_load_dwordx4 v[40:43], v6, s[8:11], s32 offen offset:2048 sc1
    v_mfma_f32_16x16x32_bf16 v[244:247], v[84:87], v[116:119], v[244:247]
    ds_read_b64_tr_b16 v[78:79], v13 offset:25600
    v_add_u32 v13, 98304, v13
    s_waitcnt lgkmcnt(8)
    v_mfma_f32_16x16x32_bf16 v[216:219], v[88:91], v[112:115], v[216:219]
    ds_read_b64_tr_b16 v[80:81], v14 offset:24576
    v_mfma_f32_16x16x32_bf16 v[248:251], v[88:91], v[116:119], v[248:251]
    ds_read_b64_tr_b16 v[82:83], v14 offset:25600
    v_add_u32 v14, 98304, v14
    v_mfma_f32_16x16x32_bf16 v[220:223], v[92:95], v[112:115], v[220:223]
    ds_read_b64_tr_b16 v[84:85], v15 offset:24576
    buffer_load_dwordx4 v[44:47], v7, s[8:11], s32 offen offset:2048 sc1
    v_mfma_f32_16x16x32_bf16 v[252:255], v[92:95], v[116:119], v[252:255]
    ds_read_b64_tr_b16 v[86:87], v15 offset:25600
    v_add_u32 v15, 98304, v15
    s_waitcnt lgkmcnt(8)
    s_waitcnt vmcnt(10)
    v_mfma_f32_16x16x32_bf16 v[192:195], v[64:67], v[120:123], v[192:195]
    ds_read_b64_tr_b16 v[88:89], v16 offset:24576
    v_mfma_f32_16x16x32_bf16 v[224:227], v[64:67], v[124:127], v[224:227]
    ds_read_b64_tr_b16 v[90:91], v16 offset:25600
    v_add_u32 v16, 98304, v16
    v_mfma_f32_16x16x32_bf16 v[196:199], v[68:71], v[120:123], v[196:199]
    ds_read_b64_tr_b16 v[92:93], v17 offset:24576
    v_mfma_f32_16x16x32_bf16 v[228:231], v[68:71], v[124:127], v[228:231]
    ds_read_b64_tr_b16 v[94:95], v17 offset:25600
    v_add_u32 v17, 98304, v17
    buffer_load_dwordx4 v3, s[4:7], s31 offen offset:1024 lds
    s_waitcnt vmcnt(10)
    s_barrier
    s_waitcnt lgkmcnt(8)
    v_mfma_f32_16x16x32_bf16 v[200:203], v[72:75], v[120:123], v[200:203]
    ds_read_b64_tr_b16 v[64:65], v10 offset:32768
    v_mfma_f32_16x16x32_bf16 v[232:235], v[72:75], v[124:127], v[232:235]
    ds_read_b64_tr_b16 v[66:67], v10 offset:33792
    v_mfma_f32_16x16x32_bf16 v[204:207], v[76:79], v[120:123], v[204:207]
    ds_read_b64_tr_b16 v[68:69], v11 offset:32768
    buffer_load_dwordx4 v4, s[4:7], s31 offen offset:2048 lds
    v_mfma_f32_16x16x32_bf16 v[236:239], v[76:79], v[124:127], v[236:239]
    ds_read_b64_tr_b16 v[70:71], v11 offset:33792
    s_waitcnt lgkmcnt(8)
    v_mfma_f32_16x16x32_bf16 v[208:211], v[80:83], v[120:123], v[208:211]
    ds_read_b64_tr_b16 v[72:73], v12 offset:32768
    v_mfma_f32_16x16x32_bf16 v[240:243], v[80:83], v[124:127], v[240:243]
    ds_read_b64_tr_b16 v[74:75], v12 offset:33792
    v_mfma_f32_16x16x32_bf16 v[212:215], v[84:87], v[120:123], v[212:215]
    ds_read_b64_tr_b16 v[76:77], v13 offset:32768
    buffer_load_dwordx4 v[48:51], v6, s[8:11], s32 offen offset:3072 sc1
    v_mfma_f32_16x16x32_bf16 v[244:247], v[84:87], v[124:127], v[244:247]
    ds_read_b64_tr_b16 v[78:79], v13 offset:33792
    s_waitcnt lgkmcnt(8)
    v_mfma_f32_16x16x32_bf16 v[216:219], v[88:91], v[120:123], v[216:219]
    ds_read_b64_tr_b16 v[80:81], v14 offset:32768
    v_mfma_f32_16x16x32_bf16 v[248:251], v[88:91], v[124:127], v[248:251]
    ds_read_b64_tr_b16 v[82:83], v14 offset:33792
    v_mfma_f32_16x16x32_bf16 v[220:223], v[92:95], v[120:123], v[220:223]
    ds_read_b64_tr_b16 v[84:85], v15 offset:32768
    buffer_load_dwordx4 v[52:55], v7, s[8:11], s32 offen offset:3072 sc1
    v_mfma_f32_16x16x32_bf16 v[252:255], v[92:95], v[124:127], v[252:255]
    ds_read_b64_tr_b16 v[86:87], v15 offset:33792
    s_waitcnt lgkmcnt(8)
    s_waitcnt vmcnt(10)
    v_mfma_f32_16x16x32_bf16 v[192:195], v[64:67], v[24:27], v[192:195]
    ds_read_b64_tr_b16 v[88:89], v16 offset:32768
    v_mfma_f32_16x16x32_bf16 v[224:227], v[64:67], v[28:31], v[224:227]
    ds_read_b64_tr_b16 v[90:91], v16 offset:33792
    v_mfma_f32_16x16x32_bf16 v[196:199], v[68:71], v[24:27], v[196:199]
    ds_read_b64_tr_b16 v[92:93], v17 offset:32768
    buffer_load_dwordx4 v5, s[4:7], s31 offen offset:3072 lds
    v_mfma_f32_16x16x32_bf16 v[228:231], v[68:71], v[28:31], v[228:231]
    ds_read_b64_tr_b16 v[94:95], v17 offset:33792
    s_waitcnt lgkmcnt(8)
    v_mfma_f32_16x16x32_bf16 v[200:203], v[72:75], v[24:27], v[200:203]
    ds_read_b64_tr_b16 v[64:65], v10 offset:40960
    v_mfma_f32_16x16x32_bf16 v[232:235], v[72:75], v[28:31], v[232:235]
    ds_read_b64_tr_b16 v[66:67], v10 offset:41984
    v_mfma_f32_16x16x32_bf16 v[204:207], v[76:79], v[24:27], v[204:207]
    ds_read_b64_tr_b16 v[68:69], v11 offset:40960
    buffer_store_dwordx4 v[176:179], v58, s[16:19], s49 offen sc1
    v_mfma_f32_16x16x32_bf16 v[236:239], v[76:79], v[28:31], v[236:239]
    ds_read_b64_tr_b16 v[70:71], v11 offset:41984
    s_waitcnt lgkmcnt(8)
    v_mfma_f32_16x16x32_bf16 v[208:211], v[80:83], v[24:27], v[208:211]
    ds_read_b64_tr_b16 v[72:73], v12 offset:40960
    s_cmp_eq_u32 s28, 0
    s_cbranch_scc1 L_recurrent_scan__compressed_kv_cla__moe_arch_mod__prompt_kernel_rare_52
L_recurrent_scan__compressed_kv_cla__moe_arch_mod__prompt_kernel_back_53:
    v_mfma_f32_16x16x32_bf16 v[240:243], v[80:83], v[28:31], v[240:243]
    ds_read_b64_tr_b16 v[74:75], v12 offset:41984
    v_mfma_f32_16x16x32_bf16 v[212:215], v[84:87], v[24:27], v[212:215]
    ds_read_b64_tr_b16 v[76:77], v13 offset:40960
    v_mfma_f32_16x16x32_bf16 v[244:247], v[84:87], v[28:31], v[244:247]
    ds_read_b64_tr_b16 v[78:79], v13 offset:41984
    s_waitcnt lgkmcnt(8)
    v_mfma_f32_16x16x32_bf16 v[216:219], v[88:91], v[24:27], v[216:219]
    ds_read_b64_tr_b16 v[80:81], v14 offset:40960
    v_mfma_f32_16x16x32_bf16 v[248:251], v[88:91], v[28:31], v[248:251]
    ds_read_b64_tr_b16 v[82:83], v14 offset:41984
    v_mfma_f32_16x16x32_bf16 v[220:223], v[92:95], v[24:27], v[220:223]
    ds_read_b64_tr_b16 v[84:85], v15 offset:40960
    v_mfma_f32_16x16x32_bf16 v[252:255], v[92:95], v[28:31], v[252:255]
    ds_read_b64_tr_b16 v[86:87], v15 offset:41984
    s_waitcnt lgkmcnt(8)
    s_waitcnt vmcnt(10)
    v_mfma_f32_16x16x32_bf16 v[192:195], v[64:67], v[32:35], v[192:195]
    ds_read_b64_tr_b16 v[88:89], v16 offset:40960
    v_mfma_f32_16x16x32_bf16 v[224:227], v[64:67], v[36:39], v[224:227]
    ds_read_b64_tr_b16 v[90:91], v16 offset:41984
    s_mov_b32 s32, 28672
    buffer_load_dwordx4 v[96:99], v6, s[8:11], s32 offen offset:0 sc1
    v_mfma_f32_16x16x32_bf16 v[196:199], v[68:71], v[32:35], v[196:199]
    ds_read_b64_tr_b16 v[92:93], v17 offset:40960
    v_mfma_f32_16x16x32_bf16 v[228:231], v[68:71], v[36:39], v[228:231]
    ds_read_b64_tr_b16 v[94:95], v17 offset:41984
    s_waitcnt lgkmcnt(8)
    v_mfma_f32_16x16x32_bf16 v[200:203], v[72:75], v[32:35], v[200:203]
    ds_read_b64_tr_b16 v[64:65], v10 offset:49152
    v_mfma_f32_16x16x32_bf16 v[232:235], v[72:75], v[36:39], v[232:235]
    ds_read_b64_tr_b16 v[66:67], v10 offset:50176
    buffer_load_dwordx4 v[100:103], v7, s[8:11], s32 offen offset:0 sc1
    v_mfma_f32_16x16x32_bf16 v[204:207], v[76:79], v[32:35], v[204:207]
    ds_read_b64_tr_b16 v[68:69], v11 offset:49152
    v_mfma_f32_16x16x32_bf16 v[236:239], v[76:79], v[36:39], v[236:239]
    ds_read_b64_tr_b16 v[70:71], v11 offset:50176
    s_waitcnt lgkmcnt(8)
    v_mfma_f32_16x16x32_bf16 v[208:211], v[80:83], v[32:35], v[208:211]
    ds_read_b64_tr_b16 v[72:73], v12 offset:49152
    v_mfma_f32_16x16x32_bf16 v[240:243], v[80:83], v[36:39], v[240:243]
    ds_read_b64_tr_b16 v[74:75], v12 offset:50176
    buffer_load_dwordx4 v[104:107], v6, s[8:11], s32 offen offset:1024 sc1
    v_mfma_f32_16x16x32_bf16 v[212:215], v[84:87], v[32:35], v[212:215]
    ds_read_b64_tr_b16 v[76:77], v13 offset:49152
    v_mfma_f32_16x16x32_bf16 v[244:247], v[84:87], v[36:39], v[244:247]
    ds_read_b64_tr_b16 v[78:79], v13 offset:50176
    s_waitcnt lgkmcnt(8)
    v_mfma_f32_16x16x32_bf16 v[216:219], v[88:91], v[32:35], v[216:219]
    ds_read_b64_tr_b16 v[80:81], v14 offset:49152
    v_mfma_f32_16x16x32_bf16 v[248:251], v[88:91], v[36:39], v[248:251]
    ds_read_b64_tr_b16 v[82:83], v14 offset:50176
    buffer_load_dwordx4 v[108:111], v7, s[8:11], s32 offen offset:1024 sc1
    v_mfma_f32_16x16x32_bf16 v[220:223], v[92:95], v[32:35], v[220:223]
    ds_read_b64_tr_b16 v[84:85], v15 offset:49152
    v_mfma_f32_16x16x32_bf16 v[252:255], v[92:95], v[36:39], v[252:255]
    ds_read_b64_tr_b16 v[86:87], v15 offset:50176
    s_waitcnt lgkmcnt(8)
    s_waitcnt vmcnt(10)
    v_mfma_f32_16x16x32_bf16 v[192:195], v[64:67], v[40:43], v[192:195]
    ds_read_b64_tr_b16 v[88:89], v16 offset:49152
    v_mfma_f32_16x16x32_bf16 v[224:227], v[64:67], v[44:47], v[224:227]
    ds_read_b64_tr_b16 v[90:91], v16 offset:50176
    buffer_store_dwordx4 v[180:183], v59, s[16:19], s49 offen sc1
    v_mfma_f32_16x16x32_bf16 v[196:199], v[68:71], v[40:43], v[196:199]
    ds_read_b64_tr_b16 v[92:93], v17 offset:49152
    v_mfma_f32_16x16x32_bf16 v[228:231], v[68:71], v[44:47], v[228:231]
    ds_read_b64_tr_b16 v[94:95], v17 offset:50176
    s_waitcnt lgkmcnt(8)
    v_mfma_f32_16x16x32_bf16 v[200:203], v[72:75], v[40:43], v[200:203]
    ds_read_b64_tr_b16 v[64:65], v10 offset:57344
    v_mfma_f32_16x16x32_bf16 v[232:235], v[72:75], v[44:47], v[232:235]
    ds_read_b64_tr_b16 v[66:67], v10 offset:58368
    v_add_u32 v10, 4294868992, v10
    v_mfma_f32_16x16x32_bf16 v[204:207], v[76:79], v[40:43], v[204:207]
    ds_read_b64_tr_b16 v[68:69], v11 offset:57344
    v_mfma_f32_16x16x32_bf16 v[236:239], v[76:79], v[44:47], v[236:239]
    ds_read_b64_tr_b16 v[70:71], v11 offset:58368
    v_add_u32 v11, 4294868992, v11
    s_waitcnt lgkmcnt(8)
    v_mfma_f32_16x16x32_bf16 v[208:211], v[80:83], v[40:43], v[208:211]
    ds_read_b64_tr_b16 v[72:73], v12 offset:57344
    v_mfma_f32_16x16x32_bf16 v[240:243], v[80:83], v[44:47], v[240:243]
    ds_read_b64_tr_b16 v[74:75], v12 offset:58368
    v_add_u32 v12, 4294868992, v12
    v_mfma_f32_16x16x32_bf16 v[212:215], v[84:87], v[40:43], v[212:215]
    ds_read_b64_tr_b16 v[76:77], v13 offset:57344
    v_mfma_f32_16x16x32_bf16 v[244:247], v[84:87], v[44:47], v[244:247]
    ds_read_b64_tr_b16 v[78:79], v13 offset:58368
    v_add_u32 v13, 4294868992, v13
    s_waitcnt lgkmcnt(8)
    v_mfma_f32_16x16x32_bf16 v[216:219], v[88:91], v[40:43], v[216:219]
    ds_read_b64_tr_b16 v[80:81], v14 offset:57344
    buffer_load_dwordx4 v[112:115], v6, s[8:11], s32 offen offset:2048 sc1
    v_mfma_f32_16x16x32_bf16 v[248:251], v[88:91], v[44:47], v[248:251]
    ds_read_b64_tr_b16 v[82:83], v14 offset:58368
    v_add_u32 v14, 4294868992, v14
    v_mfma_f32_16x16x32_bf16 v[220:223], v[92:95], v[40:43], v[220:223]
    ds_read_b64_tr_b16 v[84:85], v15 offset:57344
    v_mfma_f32_16x16x32_bf16 v[252:255], v[92:95], v[44:47], v[252:255]
    ds_read_b64_tr_b16 v[86:87], v15 offset:58368
    v_add_u32 v15, 4294868992, v15
    s_waitcnt lgkmcnt(8)
    s_waitcnt vmcnt(8)
    v_mfma_f32_16x16x32_bf16 v[192:195], v[64:67], v[48:51], v[192:195]
    ds_read_b64_tr_b16 v[88:89], v16 offset:57344
    v_mfma_f32_16x16x32_bf16 v[224:227], v[64:67], v[52:55], v[224:227]
    ds_read_b64_tr_b16 v[90:91], v16 offset:58368
    v_add_u32 v16, 4294868992, v16
    buffer_load_dwordx4 v[116:119], v7, s[8:11], s32 offen offset:2048 sc1
    v_mfma_f32_16x16x32_bf16 v[196:199], v[68:71], v[48:51], v[196:199]
    ds_read_b64_tr_b16 v[92:93], v17 offset:57344
    v_mfma_f32_16x16x32_bf16 v[228:231], v[68:71], v[52:55], v[228:231]
    ds_read_b64_tr_b16 v[94:95], v17 offset:58368
    v_add_u32 v17, 4294868992, v17
    s_waitcnt vmcnt(8)
    s_cmp_eq_u32 s28, 0
    s_cbranch_scc1 L_recurrent_scan__compressed_kv_cla__moe_arch_mod__prompt_kernel_rare_48
L_recurrent_scan__compressed_kv_cla__moe_arch_mod__prompt_kernel_back_49:
    s_waitcnt lgkmcnt(0)
    s_barrier
    v_mfma_f32_16x16x32_bf16 v[200:203], v[72:75], v[48:51], v[200:203]
    ds_read_b64_tr_b16 v[64:65], v10 offset:32768
    v_mfma_f32_16x16x32_bf16 v[232:235], v[72:75], v[52:55], v[232:235]
    ds_read_b64_tr_b16 v[66:67], v10 offset:33792
    s_add_u32 m0, s33, 0
    s_add_u32 s31, s45, 0
    buffer_load_dwordx4 v8, s[12:15], s31 offen offset:0 sc1 lds
    v_mfma_f32_16x16x32_bf16 v[204:207], v[76:79], v[48:51], v[204:207]
    ds_read_b64_tr_b16 v[68:69], v11 offset:32768
    v_mfma_f32_16x16x32_bf16 v[236:239], v[76:79], v[52:55], v[236:239]
    ds_read_b64_tr_b16 v[70:71], v11 offset:33792
    v_mfma_f32_16x16x32_bf16 v[208:211], v[80:83], v[48:51], v[208:211]
    ds_read_b64_tr_b16 v[72:73], v12 offset:32768
    v_mfma_f32_16x16x32_bf16 v[240:243], v[80:83], v[52:55], v[240:243]
    ds_read_b64_tr_b16 v[74:75], v12 offset:33792
    buffer_load_dwordx4 v[120:123], v6, s[8:11], s32 offen offset:3072 sc1
    v_mfma_f32_16x16x32_bf16 v[212:215], v[84:87], v[48:51], v[212:215]
    ds_read_b64_tr_b16 v[76:77], v13 offset:32768
    v_mfma_f32_16x16x32_bf16 v[244:247], v[84:87], v[52:55], v[244:247]
    ds_read_b64_tr_b16 v[78:79], v13 offset:33792
    v_mfma_f32_16x16x32_bf16 v[216:219], v[88:91], v[48:51], v[216:219]
    ds_read_b64_tr_b16 v[80:81], v14 offset:32768
    v_mfma_f32_16x16x32_bf16 v[248:251], v[88:91], v[52:55], v[248:251]
    ds_read_b64_tr_b16 v[82:83], v14 offset:33792
    buffer_load_dwordx4 v[124:127], v7, s[8:11], s32 offen offset:3072 sc1
    v_mfma_f32_16x16x32_bf16 v[220:223], v[92:95], v[48:51], v[220:223]
    ds_read_b64_tr_b16 v[84:85], v15 offset:32768
    v_mfma_f32_16x16x32_bf16 v[252:255], v[92:95], v[52:55], v[252:255]
    ds_read_b64_tr_b16 v[86:87], v15 offset:33792
    s_waitcnt lgkmcnt(8)
    s_waitcnt vmcnt(8)
    v_mfma_f32_16x16x32_bf16 v[192:195], v[64:67], v[96:99], v[192:195]
    ds_read_b64_tr_b16 v[88:89], v16 offset:32768
    v_mfma_f32_16x16x32_bf16 v[224:227], v[64:67], v[100:103], v[224:227]
    ds_read_b64_tr_b16 v[90:91], v16 offset:33792
    buffer_store_dwordx4 v[184:187], v60, s[16:19], s49 offen sc1
    v_mfma_f32_16x16x32_bf16 v[196:199], v[68:71], v[96:99], v[196:199]
    ds_read_b64_tr_b16 v[92:93], v17 offset:32768
    v_mfma_f32_16x16x32_bf16 v[228:231], v[68:71], v[100:103], v[228:231]
    ds_read_b64_tr_b16 v[94:95], v17 offset:33792
    s_waitcnt lgkmcnt(8)
    v_mfma_f32_16x16x32_bf16 v[200:203], v[72:75], v[96:99], v[200:203]
    ds_read_b64_tr_b16 v[64:65], v10 offset:40960
    v_mfma_f32_16x16x32_bf16 v[232:235], v[72:75], v[100:103], v[232:235]
    ds_read_b64_tr_b16 v[66:67], v10 offset:41984
    v_mfma_f32_16x16x32_bf16 v[204:207], v[76:79], v[96:99], v[204:207]
    ds_read_b64_tr_b16 v[68:69], v11 offset:40960
    v_mfma_f32_16x16x32_bf16 v[236:239], v[76:79], v[100:103], v[236:239]
    ds_read_b64_tr_b16 v[70:71], v11 offset:41984
    s_waitcnt lgkmcnt(8)
    v_mfma_f32_16x16x32_bf16 v[208:211], v[80:83], v[96:99], v[208:211]
    ds_read_b64_tr_b16 v[72:73], v12 offset:40960
    v_mfma_f32_16x16x32_bf16 v[240:243], v[80:83], v[100:103], v[240:243]
    ds_read_b64_tr_b16 v[74:75], v12 offset:41984
    v_mfma_f32_16x16x32_bf16 v[212:215], v[84:87], v[96:99], v[212:215]
    ds_read_b64_tr_b16 v[76:77], v13 offset:40960
    v_mfma_f32_16x16x32_bf16 v[244:247], v[84:87], v[100:103], v[244:247]
    ds_read_b64_tr_b16 v[78:79], v13 offset:41984
    s_waitcnt lgkmcnt(8)
    v_mfma_f32_16x16x32_bf16 v[216:219], v[88:91], v[96:99], v[216:219]
    ds_read_b64_tr_b16 v[80:81], v14 offset:40960
    buffer_load_dwordx4 v8, s[12:15], s31 offen offset:1024 sc1 lds
    v_mfma_f32_16x16x32_bf16 v[248:251], v[88:91], v[100:103], v[248:251]
    ds_read_b64_tr_b16 v[82:83], v14 offset:41984
    v_mfma_f32_16x16x32_bf16 v[220:223], v[92:95], v[96:99], v[220:223]
    ds_read_b64_tr_b16 v[84:85], v15 offset:40960
    v_mfma_f32_16x16x32_bf16 v[252:255], v[92:95], v[100:103], v[252:255]
    ds_read_b64_tr_b16 v[86:87], v15 offset:41984
    s_waitcnt lgkmcnt(8)
    s_waitcnt vmcnt(8)
    v_mfma_f32_16x16x32_bf16 v[192:195], v[64:67], v[104:107], v[192:195]
    ds_read_b64_tr_b16 v[88:89], v16 offset:40960
    buffer_load_dwordx4 v8, s[12:15], s31 offen offset:2048 sc1 lds
    v_mfma_f32_16x16x32_bf16 v[224:227], v[64:67], v[108:111], v[224:227]
    ds_read_b64_tr_b16 v[90:91], v16 offset:41984
    v_mfma_f32_16x16x32_bf16 v[196:199], v[68:71], v[104:107], v[196:199]
    ds_read_b64_tr_b16 v[92:93], v17 offset:40960
    v_mfma_f32_16x16x32_bf16 v[228:231], v[68:71], v[108:111], v[228:231]
    ds_read_b64_tr_b16 v[94:95], v17 offset:41984
    s_waitcnt lgkmcnt(8)
    v_mfma_f32_16x16x32_bf16 v[200:203], v[72:75], v[104:107], v[200:203]
    ds_read_b64_tr_b16 v[64:65], v10 offset:49152
    v_mfma_f32_16x16x32_bf16 v[232:235], v[72:75], v[108:111], v[232:235]
    ds_read_b64_tr_b16 v[66:67], v10 offset:50176
    buffer_load_dwordx4 v8, s[12:15], s31 offen offset:3072 sc1 lds
    v_mfma_f32_16x16x32_bf16 v[204:207], v[76:79], v[104:107], v[204:207]
    ds_read_b64_tr_b16 v[68:69], v11 offset:49152
    v_mfma_f32_16x16x32_bf16 v[236:239], v[76:79], v[108:111], v[236:239]
    ds_read_b64_tr_b16 v[70:71], v11 offset:50176
    s_waitcnt lgkmcnt(8)
    v_mfma_f32_16x16x32_bf16 v[208:211], v[80:83], v[104:107], v[208:211]
    ds_read_b64_tr_b16 v[72:73], v12 offset:49152
    v_mfma_f32_16x16x32_bf16 v[240:243], v[80:83], v[108:111], v[240:243]
    ds_read_b64_tr_b16 v[74:75], v12 offset:50176
    s_add_u32 m0, s33, 65536
    s_add_u32 s31, s45, 32768
    buffer_load_dwordx4 v8, s[12:15], s31 offen offset:0 sc1 lds
    v_mfma_f32_16x16x32_bf16 v[212:215], v[84:87], v[104:107], v[212:215]
    ds_read_b64_tr_b16 v[76:77], v13 offset:49152
    v_mfma_f32_16x16x32_bf16 v[244:247], v[84:87], v[108:111], v[244:247]
    ds_read_b64_tr_b16 v[78:79], v13 offset:50176
    s_waitcnt lgkmcnt(8)
    v_mfma_f32_16x16x32_bf16 v[216:219], v[88:91], v[104:107], v[216:219]
    ds_read_b64_tr_b16 v[80:81], v14 offset:49152
    v_mfma_f32_16x16x32_bf16 v[248:251], v[88:91], v[108:111], v[248:251]
    ds_read_b64_tr_b16 v[82:83], v14 offset:50176
    buffer_store_dwordx4 v[188:191], v61, s[16:19], s49 offen sc1
    v_mfma_f32_16x16x32_bf16 v[220:223], v[92:95], v[104:107], v[220:223]
    ds_read_b64_tr_b16 v[84:85], v15 offset:49152
    v_mfma_f32_16x16x32_bf16 v[252:255], v[92:95], v[108:111], v[252:255]
    ds_read_b64_tr_b16 v[86:87], v15 offset:50176
    s_waitcnt lgkmcnt(8)
    s_waitcnt vmcnt(9)
    v_mfma_f32_16x16x32_bf16 v[192:195], v[64:67], v[112:115], v[192:195]
    ds_read_b64_tr_b16 v[88:89], v16 offset:49152
    v_mfma_f32_16x16x32_bf16 v[224:227], v[64:67], v[116:119], v[224:227]
    ds_read_b64_tr_b16 v[90:91], v16 offset:50176
    v_mfma_f32_16x16x32_bf16 v[196:199], v[68:71], v[112:115], v[196:199]
    ds_read_b64_tr_b16 v[92:93], v17 offset:49152
    v_mfma_f32_16x16x32_bf16 v[228:231], v[68:71], v[116:119], v[228:231]
    ds_read_b64_tr_b16 v[94:95], v17 offset:50176
    s_waitcnt lgkmcnt(8)
    v_mfma_f32_16x16x32_bf16 v[200:203], v[72:75], v[112:115], v[200:203]
    ds_read_b64_tr_b16 v[64:65], v10 offset:57344
    v_mfma_f32_16x16x32_bf16 v[232:235], v[72:75], v[116:119], v[232:235]
    ds_read_b64_tr_b16 v[66:67], v10 offset:58368
    v_mfma_f32_16x16x32_bf16 v[204:207], v[76:79], v[112:115], v[204:207]
    ds_read_b64_tr_b16 v[68:69], v11 offset:57344
    v_mfma_f32_16x16x32_bf16 v[236:239], v[76:79], v[116:119], v[236:239]
    ds_read_b64_tr_b16 v[70:71], v11 offset:58368
    s_waitcnt lgkmcnt(8)
    v_mfma_f32_16x16x32_bf16 v[208:211], v[80:83], v[112:115], v[208:211]
    ds_read_b64_tr_b16 v[72:73], v12 offset:57344
    buffer_load_dwordx4 v8, s[12:15], s31 offen offset:1024 sc1 lds
    v_mfma_f32_16x16x32_bf16 v[240:243], v[80:83], v[116:119], v[240:243]
    ds_read_b64_tr_b16 v[74:75], v12 offset:58368
    v_mfma_f32_16x16x32_bf16 v[212:215], v[84:87], v[112:115], v[212:215]
    ds_read_b64_tr_b16 v[76:77], v13 offset:57344
    v_mfma_f32_16x16x32_bf16 v[244:247], v[84:87], v[116:119], v[244:247]
    ds_read_b64_tr_b16 v[78:79], v13 offset:58368
    s_waitcnt lgkmcnt(8)
    v_mfma_f32_16x16x32_bf16 v[216:219], v[88:91], v[112:115], v[216:219]
    ds_read_b64_tr_b16 v[80:81], v14 offset:57344
    buffer_load_dwordx4 v8, s[12:15], s31 offen offset:2048 sc1 lds
    v_mfma_f32_16x16x32_bf16 v[248:251], v[88:91], v[116:119], v[248:251]
    ds_read_b64_tr_b16 v[82:83], v14 offset:58368
    v_mfma_f32_16x16x32_bf16 v[220:223], v[92:95], v[112:115], v[220:223]
    ds_read_b64_tr_b16 v[84:85], v15 offset:57344
    v_mfma_f32_16x16x32_bf16 v[252:255], v[92:95], v[116:119], v[252:255]
    ds_read_b64_tr_b16 v[86:87], v15 offset:58368
    s_waitcnt lgkmcnt(8)
    s_waitcnt vmcnt(8)
    v_mfma_f32_16x16x32_bf16 v[192:195], v[64:67], v[120:123], v[192:195]
    ds_read_b64_tr_b16 v[88:89], v16 offset:57344
    buffer_load_dwordx4 v8, s[12:15], s31 offen offset:3072 sc1 lds
    v_mfma_f32_16x16x32_bf16 v[224:227], v[64:67], v[124:127], v[224:227]
    ds_read_b64_tr_b16 v[90:91], v16 offset:58368
    v_mfma_f32_16x16x32_bf16 v[196:199], v[68:71], v[120:123], v[196:199]
    ds_read_b64_tr_b16 v[92:93], v17 offset:57344
    v_mfma_f32_16x16x32_bf16 v[228:231], v[68:71], v[124:127], v[228:231]
    ds_read_b64_tr_b16 v[94:95], v17 offset:58368
    s_waitcnt lgkmcnt(8)
    v_mfma_f32_16x16x32_bf16 v[200:203], v[72:75], v[120:123], v[200:203]
    v_mfma_f32_16x16x32_bf16 v[232:235], v[72:75], v[124:127], v[232:235]
    v_mfma_f32_16x16x32_bf16 v[204:207], v[76:79], v[120:123], v[204:207]
    v_mfma_f32_16x16x32_bf16 v[236:239], v[76:79], v[124:127], v[236:239]
    s_waitcnt lgkmcnt(4)
    v_mfma_f32_16x16x32_bf16 v[208:211], v[80:83], v[120:123], v[208:211]
    v_mfma_f32_16x16x32_bf16 v[240:243], v[80:83], v[124:127], v[240:243]
    v_mfma_f32_16x16x32_bf16 v[212:215], v[84:87], v[120:123], v[212:215]
    v_mfma_f32_16x16x32_bf16 v[244:247], v[84:87], v[124:127], v[244:247]
    s_waitcnt lgkmcnt(0)
    v_mfma_f32_16x16x32_bf16 v[216:219], v[88:91], v[120:123], v[216:219]
    v_mfma_f32_16x16x32_bf16 v[248:251], v[88:91], v[124:127], v[248:251]
    v_mfma_f32_16x16x32_bf16 v[220:223], v[92:95], v[120:123], v[220:223]
    v_mfma_f32_16x16x32_bf16 v[252:255], v[92:95], v[124:127], v[252:255]
    s_load_dwordx2 s[32:33], s[0:1], 40
    s_load_dwordx2 s[34:35], s[0:1], 80
    s_load_dwordx2 s[96:97], s[0:1], 0
    s_load_dwordx2 s[98:99], s[0:1], 88
    s_cmp_lt_u32 s28, 4
    s_cbranch_scc0 L_grp1
    v_mov_b32 v20, 1040356334
    v_mov_b32 v21, v20
    s_and_b32 s37, s28, 3
    s_lshl_b32 s37, s37, 13
    v_lshlrev_b32 v7, 4, v1
    v_add_u32 v4, s37, v7
    v_add_u32 v19, 131072, v4
    v_add_u32 v6, 4096, v4
    s_add_u32 s43, s37, 32768
    s_add_u32 s44, s37, 98304
    v_pk_mul_f32 v[192:193], v[192:193], v[20:21]
    v_pk_mul_f32 v[194:195], v[194:195], v[20:21]
    v_pk_mul_f32 v[196:197], v[196:197], v[20:21]
    v_pk_mul_f32 v[198:199], v[198:199], v[20:21]
    v_cvt_pk_bf16_f32 v128, v192, v193
    v_cvt_pk_bf16_f32 v129, v194, v195
    v_cvt_pk_bf16_f32 v130, v196, v197
    v_cvt_pk_bf16_f32 v131, v198, v199
    ds_write_b128 v19, v[128:131] offset:0
    v_pk_mul_f32 v[200:201], v[200:201], v[20:21]
    v_pk_mul_f32 v[202:203], v[202:203], v[20:21]
    v_pk_mul_f32 v[204:205], v[204:205], v[20:21]
    v_pk_mul_f32 v[206:207], v[206:207], v[20:21]
    v_cvt_pk_bf16_f32 v132, v200, v201
    v_cvt_pk_bf16_f32 v133, v202, v203
    v_cvt_pk_bf16_f32 v134, v204, v205
    v_cvt_pk_bf16_f32 v135, v206, v207
    ds_write_b128 v19, v[132:135] offset:1024
    v_pk_mul_f32 v[208:209], v[208:209], v[20:21]
    v_pk_mul_f32 v[210:211], v[210:211], v[20:21]
    v_pk_mul_f32 v[212:213], v[212:213], v[20:21]
    v_pk_mul_f32 v[214:215], v[214:215], v[20:21]
    v_cvt_pk_bf16_f32 v136, v208, v209
    v_cvt_pk_bf16_f32 v137, v210, v211
    v_cvt_pk_bf16_f32 v138, v212, v213
    v_cvt_pk_bf16_f32 v139, v214, v215
    ds_write_b128 v19, v[136:139] offset:2048
    v_pk_mul_f32 v[216:217], v[216:217], v[20:21]
    v_pk_mul_f32 v[218:219], v[218:219], v[20:21]
    v_pk_mul_f32 v[220:221], v[220:221], v[20:21]
    v_pk_mul_f32 v[222:223], v[222:223], v[20:21]
    v_cvt_pk_bf16_f32 v140, v216, v217
    v_cvt_pk_bf16_f32 v141, v218, v219
    v_cvt_pk_bf16_f32 v142, v220, v221
    v_cvt_pk_bf16_f32 v143, v222, v223
    ds_write_b128 v19, v[140:143] offset:3072
    v_pk_mul_f32 v[224:225], v[224:225], v[20:21]
    v_pk_mul_f32 v[226:227], v[226:227], v[20:21]
    v_pk_mul_f32 v[228:229], v[228:229], v[20:21]
    v_pk_mul_f32 v[230:231], v[230:231], v[20:21]
    v_cvt_pk_bf16_f32 v144, v224, v225
    v_cvt_pk_bf16_f32 v145, v226, v227
    v_cvt_pk_bf16_f32 v146, v228, v229
    v_cvt_pk_bf16_f32 v147, v230, v231
    ds_write_b128 v19, v[144:147] offset:4096
    v_pk_mul_f32 v[232:233], v[232:233], v[20:21]
    v_pk_mul_f32 v[234:235], v[234:235], v[20:21]
    v_pk_mul_f32 v[236:237], v[236:237], v[20:21]
    v_pk_mul_f32 v[238:239], v[238:239], v[20:21]
    v_cvt_pk_bf16_f32 v148, v232, v233
    v_cvt_pk_bf16_f32 v149, v234, v235
    v_cvt_pk_bf16_f32 v150, v236, v237
    v_cvt_pk_bf16_f32 v151, v238, v239
    ds_write_b128 v19, v[148:151] offset:5120
    v_pk_mul_f32 v[240:241], v[240:241], v[20:21]
    v_pk_mul_f32 v[242:243], v[242:243], v[20:21]
    v_pk_mul_f32 v[244:245], v[244:245], v[20:21]
    v_pk_mul_f32 v[246:247], v[246:247], v[20:21]
    v_cvt_pk_bf16_f32 v152, v240, v241
    v_cvt_pk_bf16_f32 v153, v242, v243
    v_cvt_pk_bf16_f32 v154, v244, v245
    v_cvt_pk_bf16_f32 v155, v246, v247
    ds_write_b128 v19, v[152:155] offset:6144
    v_pk_mul_f32 v[248:249], v[248:249], v[20:21]
    v_pk_mul_f32 v[250:251], v[250:251], v[20:21]
    v_pk_mul_f32 v[252:253], v[252:253], v[20:21]
    v_pk_mul_f32 v[254:255], v[254:255], v[20:21]
    v_cvt_pk_bf16_f32 v156, v248, v249
    v_cvt_pk_bf16_f32 v157, v250, v251
    v_cvt_pk_bf16_f32 v158, v252, v253
    v_cvt_pk_bf16_f32 v159, v254, v255
    ds_write_b128 v19, v[156:159] offset:7168
    v_mov_b32 v2, v7
    v_and_b32 v21, 15, v1
    v_lshrrev_b32 v22, 4, v1
    v_lshlrev_b32 v22, 2, v22
    v_sub_u32 v18, v21, v22
    s_mov_b32 s40, 0
    s_mov_b32 s41, 16384
    s_mov_b32 s49, 0xffff
    s_lshl_b32 s51, s30, 1
    s_add_u32 s51, s51, 1
    s_and_b32 s50, s28, 3
    s_lshl_b32 s50, s50, 5
    s_lshl_b32 s31, 1, s51
    s_or_b32 s31, s31, 0x8000
    s_add_u32 s36, s51, 1
    s_lshl_b32 s36, -1, s36
    s_or_b32 s48, s36, 0xaaaaaaab
    s_and_b32 s48, s48, 0x7fff
    s_or_b32 s39, s36, 0x55555555
    s_and_b32 s39, s39, 0xffff
    s_add_u32 s46, s45, 65536
    s_add_u32 s47, s45, 98304
    s_mov_b64 s[52:53], 0
    s_waitcnt vmcnt(3) lgkmcnt(0)
    s_barrier
    ds_read_b128 v[64:67], v2 offset:0
    ds_read_b128 v[68:71], v2 offset:1024
    ds_read_b128 v[72:75], v2 offset:2048
    ds_read_b128 v[76:79], v2 offset:3072
    ds_read_b128 v[80:83], v2 offset:4096
    ds_read_b128 v[84:87], v2 offset:5120
    ds_read_b128 v[88:91], v2 offset:6144
    ds_read_b128 v[92:95], v2 offset:7168
    v_mov_b32 v36, 0x3f803f80
    v_mov_b32 v37, 0x3f803f80
    v_mov_b32 v38, 0x3f803f80
    v_mov_b32 v39, 0x3f803f80
    s_add_u32 s16, s54, 41943040
    s_addc_u32 s17, s55, 0
    s_and_b32 s17, s17, 0xffff
    s_mov_b32 s18, 117440640
    s_mov_b32 s19, 0x20000
    s_mov_b32 s4, s92
    s_and_b32 s5, s93, 0xffff
    s_mov_b32 s6, 7340032
    s_mov_b32 s7, 0x20000
    s_mov_b32 s8, s94
    s_and_b32 s9, s95, 0xffff
    s_mov_b32 s10, 7340032
    s_mov_b32 s11, 0x20000
    s_and_b32 s60, s29, 3
    s_add_u32 s60, s60, 4
    s_sub_u32 s3, s2, 32
    s_cmp_eq_u32 s28, 0
    s_cselect_b32 s36, 0xad, 0x2d
    s_cselect_b32 s42, 14, 12
    s_cmp_lt_u32 s3, 224
    s_cselect_b32 s36, s36, 0
    s_lshl_b32 s36, s36, s60
    s_or_b32 s42, s42, s36
    s_waitcnt lgkmcnt(7)
    v_mfma_f32_16x16x32_bf16 v[96:99], v[64:67], v[128:131], 0
    v_mov_b64 v[192:193], 0
    v_mov_b64 v[194:195], 0
    v_mfma_f32_16x16x32_bf16 v[104:107], v[64:67], v[144:147], 0
    ds_read_b128 v[64:67], v2 offset:8192
    v_mov_b64 v[196:197], 0
    v_mov_b64 v[198:199], 0
    s_waitcnt lgkmcnt(7)
    v_mfma_f32_16x16x32_bf16 v[96:99], v[68:71], v[132:135], v[96:99]
    v_mov_b64 v[200:201], 0
    v_mov_b64 v[202:203], 0
    v_mfma_f32_16x16x32_bf16 v[104:107], v[68:71], v[148:151], v[104:107]
    ds_read_b128 v[68:71], v2 offset:9216
    v_mov_b64 v[204:205], 0
    v_mov_b64 v[206:207], 0
    s_waitcnt lgkmcnt(7)
    v_mfma_f32_16x16x32_bf16 v[96:99], v[72:75], v[136:139], v[96:99]
    v_mov_b64 v[208:209], 0
    v_mfma_f32_16x16x32_bf16 v[104:107], v[72:75], v[152:155], v[104:107]
    ds_read_b128 v[72:75], v2 offset:10240
    v_mov_b64 v[210:211], 0
    v_mov_b64 v[212:213], 0
    s_waitcnt lgkmcnt(7)
    v_mfma_f32_16x16x32_bf16 v[96:99], v[76:79], v[140:143], v[96:99]
    v_mov_b64 v[214:215], 0
    v_mov_b64 v[216:217], 0
    v_mfma_f32_16x16x32_bf16 v[104:107], v[76:79], v[156:159], v[104:107]
    ds_read_b128 v[76:79], v2 offset:11264
    v_mov_b64 v[218:219], 0
    v_mov_b64 v[220:221], 0
    s_waitcnt lgkmcnt(7)
    v_mfma_f32_16x16x32_bf16 v[100:103], v[80:83], v[128:131], 0
    v_mov_b64 v[222:223], 0
    v_mov_b64 v[224:225], 0
    v_mfma_f32_16x16x32_bf16 v[108:111], v[80:83], v[144:147], 0
    ds_read_b128 v[80:83], v2 offset:12288
    v_mov_b64 v[226:227], 0
    s_waitcnt lgkmcnt(7)
    v_mfma_f32_16x16x32_bf16 v[100:103], v[84:87], v[132:135], v[100:103]
    v_mov_b64 v[228:229], 0
    v_mov_b64 v[230:231], 0
    v_mfma_f32_16x16x32_bf16 v[108:111], v[84:87], v[148:151], v[108:111]
    ds_read_b128 v[84:87], v2 offset:13312
    v_mov_b64 v[232:233], 0
    v_mov_b64 v[234:235], 0
    s_waitcnt lgkmcnt(7)
    v_mfma_f32_16x16x32_bf16 v[100:103], v[88:91], v[136:139], v[100:103]
    v_mov_b64 v[236:237], 0
    v_mov_b64 v[238:239], 0
    v_mfma_f32_16x16x32_bf16 v[108:111], v[88:91], v[152:155], v[108:111]
    ds_read_b128 v[88:91], v2 offset:14336
    v_mov_b64 v[240:241], 0
    v_mov_b64 v[242:243], 0
    s_waitcnt lgkmcnt(7)
    v_mfma_f32_16x16x32_bf16 v[100:103], v[92:95], v[140:143], v[100:103]
    v_mov_b64 v[244:245], 0
    v_mfma_f32_16x16x32_bf16 v[108:111], v[92:95], v[156:159], v[108:111]
    ds_read_b128 v[92:95], v2 offset:15360
    v_mov_b64 v[246:247], 0
    v_mov_b64 v[248:249], 0
    s_waitcnt lgkmcnt(7)
    v_mfma_f32_16x16x32_bf16 v[112:115], v[64:67], v[128:131], 0
    v_mov_b64 v[250:251], 0
    v_mov_b64 v[252:253], 0
    v_mfma_f32_16x16x32_bf16 v[120:123], v[64:67], v[144:147], 0
    v_mov_b64 v[254:255], 0
    v_mov_b64 v[28:29], 0
    s_waitcnt lgkmcnt(6)
    v_mfma_f32_16x16x32_bf16 v[112:115], v[68:71], v[132:135], v[112:115]
    v_mov_b64 v[30:31], 0
    v_mov_b64 v[32:33], 0
    v_mfma_f32_16x16x32_bf16 v[120:123], v[68:71], v[148:151], v[120:123]
    v_mov_b64 v[34:35], 0
    s_waitcnt lgkmcnt(5)
    v_mfma_f32_16x16x32_bf16 v[112:115], v[72:75], v[136:139], v[112:115]
    v_mfma_f32_16x16x32_bf16 v[120:123], v[72:75], v[152:155], v[120:123]
    v_max3_f32 v22, v96, v97, v98
    v_max3_f32 v23, v104, v105, v106
    s_waitcnt lgkmcnt(4)
    v_mfma_f32_16x16x32_bf16 v[112:115], v[76:79], v[140:143], v[112:115]
    v_max3_f32 v22, v22, v99, v100
    v_max3_f32 v23, v23, v107, v108
    v_mfma_f32_16x16x32_bf16 v[120:123], v[76:79], v[156:159], v[120:123]
    v_max3_f32 v22, v22, v101, v102
    v_max3_f32 v23, v23, v109, v110
    s_waitcnt lgkmcnt(3)
    v_mfma_f32_16x16x32_bf16 v[116:119], v[80:83], v[128:131], 0
    v_max_f32 v22, v22, v103
    v_max_f32 v23, v23, v111
    v_mfma_f32_16x16x32_bf16 v[124:127], v[80:83], v[144:147], 0
    v_mov_b32 v24, v22
    v_mov_b32 v25, v23
    s_waitcnt lgkmcnt(2)
    v_mfma_f32_16x16x32_bf16 v[116:119], v[84:87], v[132:135], v[116:119]
    v_permlane16_swap_b32 v22, v24
    v_permlane16_swap_b32 v23, v25
    v_mfma_f32_16x16x32_bf16 v[124:127], v[84:87], v[148:151], v[124:127]
    v_max_f32 v22, v22, v24
    v_max_f32 v23, v23, v25
    s_waitcnt lgkmcnt(1)
    v_mfma_f32_16x16x32_bf16 v[116:119], v[88:91], v[136:139], v[116:119]
    v_mov_b32 v24, v22
    v_mov_b32 v25, v23
    v_mfma_f32_16x16x32_bf16 v[124:127], v[88:91], v[152:155], v[124:127]
    v_permlane32_swap_b32 v22, v24
    v_permlane32_swap_b32 v23, v25
    s_waitcnt lgkmcnt(0)
    v_mfma_f32_16x16x32_bf16 v[116:119], v[92:95], v[140:143], v[116:119]
    v_max_f32 v22, v22, v24
    v_max_f32 v23, v23, v25
    v_mfma_f32_16x16x32_bf16 v[124:127], v[92:95], v[156:159], v[124:127]
    v_sub_f32 v40, 0, v22
    v_sub_f32 v41, 0, v22
    v_sub_f32 v42, 0, v22
    v_sub_f32 v43, 0, v22
    v_sub_f32 v44, 0, v23
    v_sub_f32 v45, 0, v23
    v_sub_f32 v46, 0, v23
    v_sub_f32 v47, 0, v23
    v_add_u32 v3, 65536, v2
    v_add_u32 v2, s41, v2
    v_and_b32 v2, s49, v2
    s_waitcnt vmcnt(0)
    s_barrier
    s_cmp_eq_u32 s28, 0
    s_cbranch_scc1 L_recurrent_scan__compressed_kv_cla__moe_arch_mod__prompt_kernel_rare_56
L_recurrent_scan__compressed_kv_cla__moe_arch_mod__prompt_kernel_back_57:
    ds_read_b128 v[64:67], v2 offset:0
    ds_read_b128 v[68:71], v2 offset:1024
    ds_read_b128 v[72:75], v2 offset:2048
    ds_read_b128 v[76:79], v2 offset:3072
    ds_read_b128 v[80:83], v2 offset:4096
    ds_read_b128 v[84:87], v2 offset:5120
    ds_read_b128 v[88:91], v2 offset:6144
    ds_write_b32 v19, v40
    ds_write_b32 v19, v44 offset:4
    v_pk_add_f32 v[96:97], v[96:97], v[40:41]
    v_pk_add_f32 v[98:99], v[98:99], v[40:41]
    v_pk_add_f32 v[100:101], v[100:101], v[40:41]
    v_pk_add_f32 v[102:103], v[102:103], v[40:41]
    v_pk_add_f32 v[104:105], v[104:105], v[44:45]
    v_pk_add_f32 v[106:107], v[106:107], v[44:45]
    v_pk_add_f32 v[108:109], v[108:109], v[44:45]
    v_pk_add_f32 v[110:111], v[110:111], v[44:45]
    v_pk_add_f32 v[112:113], v[112:113], v[40:41]
    v_pk_add_f32 v[114:115], v[114:115], v[40:41]
    v_pk_add_f32 v[116:117], v[116:117], v[40:41]
    v_pk_add_f32 v[118:119], v[118:119], v[40:41]
    v_pk_add_f32 v[120:121], v[120:121], v[44:45]
    v_pk_add_f32 v[122:123], v[122:123], v[44:45]
    v_pk_add_f32 v[124:125], v[124:125], v[44:45]
    v_pk_add_f32 v[126:127], v[126:127], v[44:45]
    v_exp_f32 v96, v96
    v_exp_f32 v97, v97
    v_exp_f32 v98, v98
    v_exp_f32 v99, v99
    v_exp_f32 v104, v104
    v_exp_f32 v105, v105
    v_exp_f32 v106, v106
    v_exp_f32 v107, v107
    v_exp_f32 v100, v100
    v_exp_f32 v101, v101
    v_exp_f32 v102, v102
    v_exp_f32 v103, v103
    v_exp_f32 v108, v108
    v_exp_f32 v109, v109
    v_exp_f32 v110, v110
    v_exp_f32 v111, v111
    v_cvt_pk_bf16_f32 v48, v96, v97
    v_cvt_pk_bf16_f32 v49, v98, v99
    v_cvt_pk_bf16_f32 v52, v104, v105
    v_cvt_pk_bf16_f32 v53, v106, v107
    v_cvt_pk_bf16_f32 v50, v100, v101
    v_cvt_pk_bf16_f32 v51, v102, v103
    v_cvt_pk_bf16_f32 v54, v108, v109
    v_cvt_pk_bf16_f32 v55, v110, v111
    .p2align 6
L_body00:
    s_waitcnt lgkmcnt(5)
    v_mfma_f32_16x16x32_bf16 v[96:99], v[64:67], v[128:131], v[40:43]
    v_exp_f32 v112, v112
    v_mfma_f32_16x16x32_bf16 v[104:107], v[64:67], v[144:147], v[44:47]
    ds_read_b128 v[92:95], v2 offset:7168
    s_bitcmp1_b32 s48, s40
    s_cbranch_scc0 L_recurrent_scan__compressed_kv_cla__moe_arch_mod__prompt_kernel_nodma_82
    s_add_u32 m0, s43, 0
    s_nop 0
    buffer_load_dwordx4 v4, s[12:15], s46 offen offset:0 sc1 lds
    buffer_load_dwordx4 v4, s[12:15], s46 offen offset:1024 sc1 lds
L_recurrent_scan__compressed_kv_cla__moe_arch_mod__prompt_kernel_nodma_82:
    v_mfma_f32_16x16x32_bf16 v[96:99], v[68:71], v[132:135], v[96:99]
    v_exp_f32 v113, v113
    v_mfma_f32_16x16x32_bf16 v[104:107], v[68:71], v[148:151], v[104:107]
    ds_read_b128 v[64:67], v3 offset:0
    s_waitcnt lgkmcnt(5)
    v_mfma_f32_16x16x32_bf16 v[96:99], v[72:75], v[136:139], v[96:99]
    v_exp_f32 v114, v114
    v_mfma_f32_16x16x32_bf16 v[104:107], v[72:75], v[152:155], v[104:107]
    ds_read_b128 v[68:71], v3 offset:1024
    v_cvt_pk_bf16_f32 v56, v112, v113
    s_bitcmp1_b32 s48, s40
    s_cbranch_scc0 L_recurrent_scan__compressed_kv_cla__moe_arch_mod__prompt_kernel_nodma_83
    s_add_u32 m0, s43, 0
    s_nop 0
    buffer_load_dwordx4 v4, s[12:15], s46 offen offset:2048 sc1 lds
    buffer_load_dwordx4 v4, s[12:15], s46 offen offset:3072 sc1 lds
L_recurrent_scan__compressed_kv_cla__moe_arch_mod__prompt_kernel_nodma_83:
    v_mfma_f32_16x16x32_bf16 v[96:99], v[76:79], v[140:143], v[96:99]
    v_exp_f32 v115, v115
    v_mfma_f32_16x16x32_bf16 v[104:107], v[76:79], v[156:159], v[104:107]
    ds_read_b128 v[72:75], v3 offset:2048
    s_waitcnt lgkmcnt(5)
    v_mfma_f32_16x16x32_bf16 v[100:103], v[80:83], v[128:131], v[40:43]
    v_exp_f32 v120, v120
    v_mfma_f32_16x16x32_bf16 v[108:111], v[80:83], v[144:147], v[44:47]
    ds_read_b128 v[76:79], v3 offset:3072
    v_cvt_pk_bf16_f32 v57, v114, v115
    v_mfma_f32_16x16x32_bf16 v[100:103], v[84:87], v[132:135], v[100:103]
    v_exp_f32 v121, v121
    v_mfma_f32_16x16x32_bf16 v[108:111], v[84:87], v[148:151], v[108:111]
    ds_read_b128 v[80:83], v3 offset:4096
    s_bitcmp1_b32 s48, s40
    s_cbranch_scc0 L_recurrent_scan__compressed_kv_cla__moe_arch_mod__prompt_kernel_nodma_84
    s_add_u32 m0, s43, 4096
    s_nop 0
    buffer_load_dwordx4 v6, s[12:15], s46 offen offset:0 sc1 lds
    buffer_load_dwordx4 v6, s[12:15], s46 offen offset:1024 sc1 lds
L_recurrent_scan__compressed_kv_cla__moe_arch_mod__prompt_kernel_nodma_84:
    s_waitcnt lgkmcnt(5)
    v_mfma_f32_16x16x32_bf16 v[100:103], v[88:91], v[136:139], v[100:103]
    v_exp_f32 v122, v122
    v_mfma_f32_16x16x32_bf16 v[108:111], v[88:91], v[152:155], v[108:111]
    ds_read_b128 v[84:87], v3 offset:5120
    v_cvt_pk_bf16_f32 v60, v120, v121
    v_mfma_f32_16x16x32_bf16 v[100:103], v[92:95], v[140:143], v[100:103]
    v_exp_f32 v123, v123
    v_mfma_f32_16x16x32_bf16 v[108:111], v[92:95], v[156:159], v[108:111]
    ds_read_b128 v[88:91], v3 offset:6144
    s_bitcmp1_b32 s48, s40
    s_cbranch_scc0 L_recurrent_scan__compressed_kv_cla__moe_arch_mod__prompt_kernel_nodma_85
    s_add_u32 m0, s43, 4096
    s_nop 0
    buffer_load_dwordx4 v6, s[12:15], s46 offen offset:2048 sc1 lds
    buffer_load_dwordx4 v6, s[12:15], s46 offen offset:3072 sc1 lds
    s_add_u32 s46, s46, 65536
    s_xor_b32 s43, s43, 32768
L_recurrent_scan__compressed_kv_cla__moe_arch_mod__prompt_kernel_nodma_85:
    s_waitcnt lgkmcnt(5)
    v_mfma_f32_16x16x32_bf16 v[192:195], v[64:67], v[48:51], v[192:195]
    v_exp_f32 v116, v116
    v_mfma_f32_16x16x32_bf16 v[224:227], v[64:67], v[52:55], v[224:227]
    ds_read_b128 v[92:95], v3 offset:7168
    v_cvt_pk_bf16_f32 v61, v122, v123
    v_mfma_f32_16x16x32_bf16 v[196:199], v[68:71], v[48:51], v[196:199]
    v_exp_f32 v117, v117
    v_mfma_f32_16x16x32_bf16 v[228:231], v[68:71], v[52:55], v[228:231]
    ds_read_b128 v[64:67], v2 offset:8192
    s_waitcnt lgkmcnt(5)
    v_mfma_f32_16x16x32_bf16 v[200:203], v[72:75], v[48:51], v[200:203]
    v_exp_f32 v118, v118
    v_mfma_f32_16x16x32_bf16 v[232:235], v[72:75], v[52:55], v[232:235]
    v_mfma_f32_16x16x32_bf16 v[28:31], v[36:39], v[48:51], v[28:31]
    ds_read_b128 v[68:71], v2 offset:9216
    v_cvt_pk_bf16_f32 v58, v116, v117
    s_bitcmp1_b32 s39, s40
    s_cbranch_scc0 L_recurrent_scan__compressed_kv_cla__moe_arch_mod__prompt_kernel_nodma_86
    s_add_u32 m0, s44, 0
    s_nop 0
    buffer_load_dwordx4 v4, s[12:15], s47 offen offset:0 sc1 lds
    buffer_load_dwordx4 v4, s[12:15], s47 offen offset:1024 sc1 lds
L_recurrent_scan__compressed_kv_cla__moe_arch_mod__prompt_kernel_nodma_86:
    v_mfma_f32_16x16x32_bf16 v[204:207], v[76:79], v[48:51], v[204:207]
    v_exp_f32 v119, v119
    v_mfma_f32_16x16x32_bf16 v[236:239], v[76:79], v[52:55], v[236:239]
    ds_read_b128 v[72:75], v2 offset:10240
    s_waitcnt lgkmcnt(5)
    v_mfma_f32_16x16x32_bf16 v[208:211], v[80:83], v[48:51], v[208:211]
    v_exp_f32 v124, v124
    v_mfma_f32_16x16x32_bf16 v[240:243], v[80:83], v[52:55], v[240:243]
    ds_read_b128 v[76:79], v2 offset:11264
    v_cvt_pk_bf16_f32 v59, v118, v119
    s_bitcmp1_b32 s39, s40
    s_cbranch_scc0 L_recurrent_scan__compressed_kv_cla__moe_arch_mod__prompt_kernel_nodma_87
    s_add_u32 m0, s44, 0
    s_nop 0
    buffer_load_dwordx4 v4, s[12:15], s47 offen offset:2048 sc1 lds
    buffer_load_dwordx4 v4, s[12:15], s47 offen offset:3072 sc1 lds
L_recurrent_scan__compressed_kv_cla__moe_arch_mod__prompt_kernel_nodma_87:
    v_mfma_f32_16x16x32_bf16 v[212:215], v[84:87], v[48:51], v[212:215]
    v_exp_f32 v125, v125
    v_mfma_f32_16x16x32_bf16 v[244:247], v[84:87], v[52:55], v[244:247]
    ds_read_b128 v[80:83], v2 offset:12288
    s_waitcnt lgkmcnt(5)
    v_mfma_f32_16x16x32_bf16 v[216:219], v[88:91], v[48:51], v[216:219]
    v_exp_f32 v126, v126
    v_mfma_f32_16x16x32_bf16 v[248:251], v[88:91], v[52:55], v[248:251]
    v_mfma_f32_16x16x32_bf16 v[32:35], v[36:39], v[52:55], v[32:35]
    ds_read_b128 v[84:87], v2 offset:13312
    v_cvt_pk_bf16_f32 v62, v124, v125
    v_mfma_f32_16x16x32_bf16 v[220:223], v[92:95], v[48:51], v[220:223]
    v_exp_f32 v127, v127
    v_mfma_f32_16x16x32_bf16 v[252:255], v[92:95], v[52:55], v[252:255]
    ds_read_b128 v[88:91], v2 offset:14336
    v_cvt_pk_bf16_f32 v63, v126, v127
    s_bitcmp1_b32 s39, s40
    s_cbranch_scc0 L_recurrent_scan__compressed_kv_cla__moe_arch_mod__prompt_kernel_nodma_88
    s_add_u32 m0, s44, 4096
    s_nop 0
    buffer_load_dwordx4 v6, s[12:15], s47 offen offset:0 sc1 lds
    buffer_load_dwordx4 v6, s[12:15], s47 offen offset:1024 sc1 lds
L_recurrent_scan__compressed_kv_cla__moe_arch_mod__prompt_kernel_nodma_88:
    s_bitcmp1_b32 s31, s40
    s_cbranch_scc1 L_recurrent_scan__compressed_kv_cla__moe_arch_mod__prompt_kernel_rare_64
L_recurrent_scan__compressed_kv_cla__moe_arch_mod__prompt_kernel_back_65:
    s_waitcnt lgkmcnt(5)
    v_mfma_f32_16x16x32_bf16 v[112:115], v[64:67], v[128:131], v[40:43]
    v_exp_f32 v96, v96
    v_mfma_f32_16x16x32_bf16 v[120:123], v[64:67], v[144:147], v[44:47]
    ds_read_b128 v[92:95], v2 offset:15360
    v_mfma_f32_16x16x32_bf16 v[112:115], v[68:71], v[132:135], v[112:115]
    v_exp_f32 v97, v97
    v_mfma_f32_16x16x32_bf16 v[120:123], v[68:71], v[148:151], v[120:123]
    ds_read_b128 v[64:67], v3 offset:8192
    s_bitcmp1_b32 s39, s40
    s_cbranch_scc0 L_recurrent_scan__compressed_kv_cla__moe_arch_mod__prompt_kernel_nodma_89
    s_add_u32 m0, s44, 4096
    s_nop 0
    buffer_load_dwordx4 v6, s[12:15], s47 offen offset:2048 sc1 lds
    buffer_load_dwordx4 v6, s[12:15], s47 offen offset:3072 sc1 lds
    s_add_u32 s47, s47, 65536
    s_xor_b32 s44, s44, 32768
L_recurrent_scan__compressed_kv_cla__moe_arch_mod__prompt_kernel_nodma_89:
    s_waitcnt lgkmcnt(5)
    v_mfma_f32_16x16x32_bf16 v[112:115], v[72:75], v[136:139], v[112:115]
    v_exp_f32 v98, v98
    v_mfma_f32_16x16x32_bf16 v[120:123], v[72:75], v[152:155], v[120:123]
    ds_read_b128 v[68:71], v3 offset:9216
    v_cvt_pk_bf16_f32 v48, v96, v97
    v_mfma_f32_16x16x32_bf16 v[112:115], v[76:79], v[140:143], v[112:115]
    v_exp_f32 v99, v99
    v_mfma_f32_16x16x32_bf16 v[120:123], v[76:79], v[156:159], v[120:123]
    ds_read_b128 v[72:75], v3 offset:10240
    s_waitcnt lgkmcnt(5)
    v_mfma_f32_16x16x32_bf16 v[116:119], v[80:83], v[128:131], v[40:43]
    v_exp_f32 v104, v104
    v_mfma_f32_16x16x32_bf16 v[124:127], v[80:83], v[144:147], v[44:47]
    ds_read_b128 v[76:79], v3 offset:11264
    v_cvt_pk_bf16_f32 v49, v98, v99
    v_mfma_f32_16x16x32_bf16 v[116:119], v[84:87], v[132:135], v[116:119]
    v_exp_f32 v105, v105
    v_mfma_f32_16x16x32_bf16 v[124:127], v[84:87], v[148:151], v[124:127]
    ds_read_b128 v[80:83], v3 offset:12288
    s_waitcnt lgkmcnt(5)
    v_mfma_f32_16x16x32_bf16 v[116:119], v[88:91], v[136:139], v[116:119]
    v_exp_f32 v106, v106
    v_mfma_f32_16x16x32_bf16 v[124:127], v[88:91], v[152:155], v[124:127]
    ds_read_b128 v[84:87], v3 offset:13312
    v_cvt_pk_bf16_f32 v52, v104, v105
    v_mfma_f32_16x16x32_bf16 v[116:119], v[92:95], v[140:143], v[116:119]
    v_exp_f32 v107, v107
    v_mfma_f32_16x16x32_bf16 v[124:127], v[92:95], v[156:159], v[124:127]
    ds_read_b128 v[88:91], v3 offset:14336
    s_waitcnt lgkmcnt(5)
    v_mfma_f32_16x16x32_bf16 v[192:195], v[64:67], v[56:59], v[192:195]
    v_exp_f32 v100, v100
    v_mfma_f32_16x16x32_bf16 v[224:227], v[64:67], v[60:63], v[224:227]
    ds_read_b128 v[92:95], v3 offset:15360
    v_cvt_pk_bf16_f32 v53, v106, v107
    v_mfma_f32_16x16x32_bf16 v[196:199], v[68:71], v[56:59], v[196:199]
    v_exp_f32 v101, v101
    v_mfma_f32_16x16x32_bf16 v[228:231], v[68:71], v[60:63], v[228:231]
    v_add_u32 v3, 65536, v2
    v_add_u32 v2, s41, v2
    s_waitcnt lgkmcnt(4)
    v_mfma_f32_16x16x32_bf16 v[200:203], v[72:75], v[56:59], v[200:203]
    v_exp_f32 v102, v102
    s_add_u32 s40, s40, 1
    v_and_b32 v2, s49, v2
    v_mfma_f32_16x16x32_bf16 v[232:235], v[72:75], v[60:63], v[232:235]
    v_mfma_f32_16x16x32_bf16 v[28:31], v[36:39], v[56:59], v[28:31]
    v_cvt_pk_bf16_f32 v50, v100, v101
    s_waitcnt vmcnt(8) lgkmcnt(0)
    s_cmp_le_u32 s40, s51
    s_cbranch_scc1 L_recurrent_scan__compressed_kv_cla__moe_arch_mod__prompt_kernel_rlx_66
    s_waitcnt vmcnt(0)
L_recurrent_scan__compressed_kv_cla__moe_arch_mod__prompt_kernel_rlx_66:
    s_bitcmp1_b32 s42, s40
    s_cbranch_scc1 L_recurrent_scan__compressed_kv_cla__moe_arch_mod__prompt_kernel_rare_80
L_recurrent_scan__compressed_kv_cla__moe_arch_mod__prompt_kernel_back_81:
    s_barrier
    v_mfma_f32_16x16x32_bf16 v[204:207], v[76:79], v[56:59], v[204:207]
    v_exp_f32 v103, v103
    v_mfma_f32_16x16x32_bf16 v[236:239], v[76:79], v[60:63], v[236:239]
    ds_read_b128 v[68:71], v2 offset:1024
    ds_read_b128 v[64:67], v2 offset:0
    v_mfma_f32_16x16x32_bf16 v[208:211], v[80:83], v[56:59], v[208:211]
    v_exp_f32 v108, v108
    v_mfma_f32_16x16x32_bf16 v[240:243], v[80:83], v[60:63], v[240:243]
    ds_read_b128 v[76:79], v2 offset:3072
    ds_read_b128 v[72:75], v2 offset:2048
    v_cvt_pk_bf16_f32 v51, v102, v103
    v_mfma_f32_16x16x32_bf16 v[212:215], v[84:87], v[56:59], v[212:215]
    v_exp_f32 v109, v109
    v_mfma_f32_16x16x32_bf16 v[244:247], v[84:87], v[60:63], v[244:247]
    ds_read_b128 v[80:83], v2 offset:4096
    v_mfma_f32_16x16x32_bf16 v[216:219], v[88:91], v[56:59], v[216:219]
    v_exp_f32 v110, v110
    v_mfma_f32_16x16x32_bf16 v[248:251], v[88:91], v[60:63], v[248:251]
    v_mfma_f32_16x16x32_bf16 v[32:35], v[36:39], v[60:63], v[32:35]
    ds_read_b128 v[84:87], v2 offset:5120
    v_cvt_pk_bf16_f32 v54, v108, v109
    v_mfma_f32_16x16x32_bf16 v[220:223], v[92:95], v[56:59], v[220:223]
    v_exp_f32 v111, v111
    v_mfma_f32_16x16x32_bf16 v[252:255], v[92:95], v[60:63], v[252:255]
    ds_read_b128 v[88:91], v2 offset:6144
    v_cvt_pk_bf16_f32 v55, v110, v111
    s_cmp_lg_u32 s40, 16
    s_cbranch_scc1 L_body00
    s_lshr_b32 s36, s2, 5
    s_add_u32 s36, s36, 48
    s_lshl_b32 s36, s36, 7
    v_mov_b32 v12, s36
    global_load_dword v11, v12, s[90:91] sc1
    s_sub_u32 s36, 32, s50
    s_cmp_lt_i32 s36, 0
    s_cbranch_scc0 L_recurrent_scan__compressed_kv_cla__moe_arch_mod__prompt_kernel_rare_92
L_recurrent_scan__compressed_kv_cla__moe_arch_mod__prompt_kernel_back_93:
    s_lshl_b32 s37, s28, 13
    v_add_u32 v5, s37, v7
    s_waitcnt lgkmcnt(5)
    v_mfma_f32_16x16x32_bf16 v[192:195], v[64:67], v[48:51], v[192:195]
    v_exp_f32 v112, v112
    v_mfma_f32_16x16x32_bf16 v[224:227], v[64:67], v[52:55], v[224:227]
    ds_read_b128 v[92:95], v3 offset:7168
    v_exp_f32 v113, v113
    v_mfma_f32_16x16x32_bf16 v[196:199], v[68:71], v[48:51], v[196:199]
    v_cvt_pk_bf16_f32 v56, v112, v113
    v_exp_f32 v114, v114
    v_mfma_f32_16x16x32_bf16 v[228:231], v[68:71], v[52:55], v[228:231]
    ds_read_b128 v[64:67], v3 offset:8192
    v_exp_f32 v115, v115
    s_waitcnt lgkmcnt(5)
    v_mfma_f32_16x16x32_bf16 v[200:203], v[72:75], v[48:51], v[200:203]
    v_cvt_pk_bf16_f32 v57, v114, v115
    v_exp_f32 v120, v120
    v_mfma_f32_16x16x32_bf16 v[232:235], v[72:75], v[52:55], v[232:235]
    v_mfma_f32_16x16x32_bf16 v[28:31], v[36:39], v[48:51], v[28:31]
    ds_read_b128 v[68:71], v3 offset:9216
    v_exp_f32 v121, v121
    v_mfma_f32_16x16x32_bf16 v[204:207], v[76:79], v[48:51], v[204:207]
    v_cvt_pk_bf16_f32 v60, v120, v121
    v_exp_f32 v122, v122
    v_mfma_f32_16x16x32_bf16 v[236:239], v[76:79], v[52:55], v[236:239]
    ds_read_b128 v[72:75], v3 offset:10240
    v_exp_f32 v123, v123
    s_waitcnt lgkmcnt(6)
    v_mfma_f32_16x16x32_bf16 v[208:211], v[80:83], v[48:51], v[208:211]
    v_cvt_pk_bf16_f32 v61, v122, v123
    v_exp_f32 v116, v116
    v_mfma_f32_16x16x32_bf16 v[240:243], v[80:83], v[52:55], v[240:243]
    ds_read_b128 v[76:79], v3 offset:11264
    v_exp_f32 v117, v117
    s_waitcnt lgkmcnt(6)
    v_mfma_f32_16x16x32_bf16 v[212:215], v[84:87], v[48:51], v[212:215]
    v_cvt_pk_bf16_f32 v58, v116, v117
    v_exp_f32 v118, v118
    v_mfma_f32_16x16x32_bf16 v[244:247], v[84:87], v[52:55], v[244:247]
    ds_read_b128 v[80:83], v3 offset:12288
    v_exp_f32 v119, v119
    s_waitcnt lgkmcnt(6)
    v_mfma_f32_16x16x32_bf16 v[216:219], v[88:91], v[48:51], v[216:219]
    v_cvt_pk_bf16_f32 v59, v118, v119
    v_exp_f32 v124, v124
    v_mfma_f32_16x16x32_bf16 v[248:251], v[88:91], v[52:55], v[248:251]
    v_mfma_f32_16x16x32_bf16 v[32:35], v[36:39], v[52:55], v[32:35]
    ds_read_b128 v[84:87], v3 offset:13312
    v_exp_f32 v125, v125
    s_waitcnt lgkmcnt(6)
    v_mfma_f32_16x16x32_bf16 v[220:223], v[92:95], v[48:51], v[220:223]
    v_cvt_pk_bf16_f32 v62, v124, v125
    v_exp_f32 v126, v126
    v_mfma_f32_16x16x32_bf16 v[252:255], v[92:95], v[52:55], v[252:255]
    ds_read_b128 v[88:91], v3 offset:14336
    v_exp_f32 v127, v127
    s_nop 0
    v_cvt_pk_bf16_f32 v63, v126, v127
    s_nop 1
    s_waitcnt lgkmcnt(6)
    v_mfma_f32_16x16x32_bf16 v[192:195], v[64:67], v[56:59], v[192:195]
    s_mov_b32 s4, s34
    s_and_b32 s5, s35, 0xffff
    s_mov_b32 s6, 7340032
    s_mov_b32 s7, 0x20000
    s_mov_b32 s8, s32
    v_mfma_f32_16x16x32_bf16 v[224:227], v[64:67], v[60:63], v[224:227]
    ds_read_b128 v[92:95], v3 offset:15360
    s_and_b32 s9, s33, 0xffff
    s_mov_b32 s10, 8388608
    s_mov_b32 s11, 0x20000
    s_lshr_b32 s38, s2, 4
    s_waitcnt lgkmcnt(6)
    v_mfma_f32_16x16x32_bf16 v[196:199], v[68:71], v[56:59], v[196:199]
    s_mul_i32 s38, s38, 224
    s_and_b32 s39, s2, 15
    s_lshl_b32 s39, s39, 7
    v_lshrrev_b32 v25, 3, v1
    s_lshl_b32 s36, s28, 5
    v_mfma_f32_16x16x32_bf16 v[228:231], v[68:71], v[60:63], v[228:231]
    s_add_u32 s36, s36, s38
    v_add_u32 v25, s36, v25
    v_mul_u32_u24 v25, 2048, v25
    v_add_u32 v25, s39, v25
    s_waitcnt lgkmcnt(5)
    v_mfma_f32_16x16x32_bf16 v[200:203], v[72:75], v[56:59], v[200:203]
    v_bfe_u32 v26, v1, 4, 1
    v_lshlrev_b32 v26, 1, v26
    v_and_b32 v27, 7, v1
    v_xor_b32 v26, v26, v27
    v_mfma_f32_16x16x32_bf16 v[232:235], v[72:75], v[60:63], v[232:235]
    v_mfma_f32_16x16x32_bf16 v[28:31], v[36:39], v[56:59], v[28:31]
    v_lshl_add_u32 v24, v26, 4, v25
    v_xor_b32 v26, 4, v26
    v_lshl_add_u32 v25, v26, 4, v25
    v_add_u32 v25, 15360, v25
    v_add_u32 v26, 30720, v24
    s_waitcnt lgkmcnt(4)
    v_mfma_f32_16x16x32_bf16 v[204:207], v[76:79], v[56:59], v[204:207]
    v_add_u32 v27, 30720, v25
    s_lshl_b32 s36, s28, 12
    s_add_u32 s36, s36, 131072
    s_cmp_lt_u32 s28, 7
    s_cselect_b32 m0, s36, 0x30000
    s_cselect_b32 s6, 7340032, 0
    v_mfma_f32_16x16x32_bf16 v[236:239], v[76:79], v[60:63], v[236:239]
    buffer_load_dwordx4 v24, s[4:7], 0 offen offset:0 lds
    buffer_load_dwordx4 v25, s[4:7], 0 offen offset:1024 lds
    buffer_load_dwordx4 v26, s[4:7], 0 offen offset:2048 lds
    buffer_load_dwordx4 v27, s[4:7], 0 offen offset:3072 lds
    s_waitcnt lgkmcnt(3)
    v_mfma_f32_16x16x32_bf16 v[208:211], v[80:83], v[56:59], v[208:211]
    v_mfma_f32_16x16x32_bf16 v[240:243], v[80:83], v[60:63], v[240:243]
    ds_write_b128 v5, v[224:227] offset:0
    s_waitcnt lgkmcnt(3)
    v_mfma_f32_16x16x32_bf16 v[212:215], v[84:87], v[56:59], v[212:215]
    v_mfma_f32_16x16x32_bf16 v[244:247], v[84:87], v[60:63], v[244:247]
    ds_write_b128 v5, v[228:231] offset:1024
    s_waitcnt lgkmcnt(3)
    v_mfma_f32_16x16x32_bf16 v[216:219], v[88:91], v[56:59], v[216:219]
    v_mfma_f32_16x16x32_bf16 v[248:251], v[88:91], v[60:63], v[248:251]
    v_mfma_f32_16x16x32_bf16 v[32:35], v[36:39], v[60:63], v[32:35]
    ds_write_b128 v5, v[232:235] offset:2048
    s_waitcnt lgkmcnt(3)
    v_mfma_f32_16x16x32_bf16 v[220:223], v[92:95], v[56:59], v[220:223]
    v_mfma_f32_16x16x32_bf16 v[252:255], v[92:95], v[60:63], v[252:255]
    ds_write_b128 v5, v[236:239] offset:3072
    ds_write_b128 v5, v[240:243] offset:4096
    ds_write_b128 v5, v[244:247] offset:5120
    v_xor_b32 v106, 32768, v5
    s_lshl_b32 s37, s28, 8
    s_add_u32 s37, s37, 159744
    v_lshl_add_u32 v107, v1, 2, s37
    v_xor_b32 v108, 1024, v107
    ds_write_b128 v5, v[248:251] offset:6144
    ds_write_b128 v5, v[252:255] offset:7168
    ds_write_b32 v107, v32
    s_mov_b32 s36, 0x5d800000
    v_cmp_nge_f32 vcc, s36, v28
    s_nop 0
    s_or_b64 s[52:53], s[52:53], vcc
    v_cmp_nge_f32 vcc, s36, v32
    s_nop 0
    s_or_b64 s[52:53], s[52:53], vcc
    s_or_b32 s36, s52, s53
    v_mov_b32 v110, s36
    s_lshl_b32 s37, s28, 2
    s_add_u32 s37, s37, 161792
    v_mov_b32 v111, s37
    ds_write_b32 v111, v110
    v_mov_b32 v112, 161856
    v_mov_b32 v114, s56
    v_mov_b32 v115, s57
    v_mov_b32 v116, s58
    v_mov_b32 v117, s59
    ds_write_b128 v112, v[114:117]
    v_and_b32 v111, 7, v1
    v_lshlrev_b32 v111, 2, v111
    v_add_u32 v111, 161792, v111
    v_mov_b32 v113, v7
    s_sub_u32 s36, 15, s30
    s_lshl_b32 s38, s36, 3
    s_and_b32 s37, s28, 3
    s_lshl_b32 s37, s37, 1
    s_add_u32 s38, s38, s37
    s_lshl_b32 s38, s38, 17
    s_lshl_b32 s37, s29, 12
    s_add_u32 s38, s38, s37
    s_waitcnt vmcnt(4)
    v_readfirstlane_b32 s36, v11
    s_nop 0
    s_cmp_lt_u32 s36, 28
    s_cbranch_scc1 L_recurrent_scan__compressed_kv_cla__moe_arch_mod__prompt_kernel_rare_96
L_recurrent_scan__compressed_kv_cla__moe_arch_mod__prompt_kernel_back_97:
    s_lshr_b32 s36, s2, 4
    s_mul_i32 s36, s36, 7
    s_min_u32 s37, s28, 6
    s_add_u32 s36, s36, s37
    s_lshl_b32 s36, s36, 11
    s_add_u32 s36, s36, 58720256
    v_and_b32 v11, 15, v1
    v_lshlrev_b32 v11, 4, v11
    v_lshrrev_b32 v12, 4, v1
    v_lshl_add_u32 v11, v12, 9, v11
    buffer_load_dwordx4 v[96:99], v11, s[24:27], s36 offen offset:0 sc1
    buffer_load_dwordx4 v[100:103], v11, s[24:27], s36 offen offset:256 sc1
    s_waitcnt lgkmcnt(0)
    s_barrier
    ds_read_b32 v110, v111
    ds_read_b32 v109, v108
    ds_read_b128 v[64:67], v106 offset:0
    ds_read_b128 v[68:71], v106 offset:1024
    ds_read_b128 v[72:75], v106 offset:2048
    ds_read_b128 v[76:79], v106 offset:3072
    ds_read_b128 v[80:83], v106 offset:4096
    ds_read_b128 v[84:87], v106 offset:5120
    ds_read_b128 v[88:91], v106 offset:6144
    ds_read_b128 v[92:95], v106 offset:7168
    s_waitcnt lgkmcnt(8)
    v_add_f32 v109, v109, v28
    v_cmp_ne_u32 s[52:53], 0, v110
    v_rcp_f32 v109, v109
    s_nop 0
    v_mov_b32 v108, v109
    s_waitcnt lgkmcnt(6)
    v_pk_add_f32 v[192:193], v[192:193], v[64:65]
    v_pk_add_f32 v[194:195], v[194:195], v[66:67]
    v_pk_add_f32 v[196:197], v[196:197], v[68:69]
    v_pk_add_f32 v[198:199], v[198:199], v[70:71]
    v_pk_mul_f32 v[192:193], v[192:193], v[108:109]
    v_pk_mul_f32 v[194:195], v[194:195], v[108:109]
    v_pk_mul_f32 v[196:197], v[196:197], v[108:109]
    v_pk_mul_f32 v[198:199], v[198:199], v[108:109]
    v_cvt_pk_bf16_f32 v48, v192, v193
    v_cvt_pk_bf16_f32 v49, v194, v195
    v_cvt_pk_bf16_f32 v50, v196, v197
    v_cvt_pk_bf16_f32 v51, v198, v199
    buffer_store_dwordx4 v[48:51], v113, s[16:19], s38 offen offset:0 sc1
    s_waitcnt lgkmcnt(4)
    v_pk_add_f32 v[200:201], v[200:201], v[72:73]
    v_pk_add_f32 v[202:203], v[202:203], v[74:75]
    v_pk_add_f32 v[204:205], v[204:205], v[76:77]
    v_pk_add_f32 v[206:207], v[206:207], v[78:79]
    v_pk_mul_f32 v[200:201], v[200:201], v[108:109]
    v_pk_mul_f32 v[202:203], v[202:203], v[108:109]
    v_pk_mul_f32 v[204:205], v[204:205], v[108:109]
    v_pk_mul_f32 v[206:207], v[206:207], v[108:109]
    v_cvt_pk_bf16_f32 v52, v200, v201
    v_cvt_pk_bf16_f32 v53, v202, v203
    v_cvt_pk_bf16_f32 v54, v204, v205
    v_cvt_pk_bf16_f32 v55, v206, v207
    buffer_store_dwordx4 v[52:55], v113, s[16:19], s38 offen offset:1024 sc1
    s_waitcnt lgkmcnt(2)
    v_pk_add_f32 v[208:209], v[208:209], v[80:81]
    v_pk_add_f32 v[210:211], v[210:211], v[82:83]
    v_pk_add_f32 v[212:213], v[212:213], v[84:85]
    v_pk_add_f32 v[214:215], v[214:215], v[86:87]
    v_pk_mul_f32 v[208:209], v[208:209], v[108:109]
    v_pk_mul_f32 v[210:211], v[210:211], v[108:109]
    v_pk_mul_f32 v[212:213], v[212:213], v[108:109]
    v_pk_mul_f32 v[214:215], v[214:215], v[108:109]
    v_cvt_pk_bf16_f32 v56, v208, v209
    v_cvt_pk_bf16_f32 v57, v210, v211
    v_cvt_pk_bf16_f32 v58, v212, v213
    v_cvt_pk_bf16_f32 v59, v214, v215
    buffer_store_dwordx4 v[56:59], v113, s[16:19], s38 offen offset:2048 sc1
    s_waitcnt lgkmcnt(0)
    v_pk_add_f32 v[216:217], v[216:217], v[88:89]
    v_pk_add_f32 v[218:219], v[218:219], v[90:91]
    v_pk_add_f32 v[220:221], v[220:221], v[92:93]
    v_pk_add_f32 v[222:223], v[222:223], v[94:95]
    v_pk_mul_f32 v[216:217], v[216:217], v[108:109]
    v_pk_mul_f32 v[218:219], v[218:219], v[108:109]
    v_pk_mul_f32 v[220:221], v[220:221], v[108:109]
    v_pk_mul_f32 v[222:223], v[222:223], v[108:109]
    v_cvt_pk_bf16_f32 v60, v216, v217
    v_cvt_pk_bf16_f32 v61, v218, v219
    v_cvt_pk_bf16_f32 v62, v220, v221
    v_cvt_pk_bf16_f32 v63, v222, v223
    buffer_store_dwordx4 v[60:63], v113, s[16:19], s38 offen offset:3072 sc1
    s_cmp_eq_u64 s[52:53], 0
    s_cbranch_scc1 L_p3_done
    s_waitcnt vmcnt(0)
    v_mov_b32 v112, v96
    v_mov_b32 v113, v97
    v_mov_b32 v114, v98
    v_mov_b32 v115, v99
    v_mov_b32 v116, v100
    v_mov_b32 v117, v101
    v_mov_b32 v118, v102
    v_mov_b32 v119, v103
    v_mov_b32 v192, 0
    v_mov_b32 v193, 0
    v_mov_b32 v194, 0
    v_mov_b32 v195, 0
    v_mov_b32 v196, 0
    v_mov_b32 v197, 0
    v_mov_b32 v198, 0
    v_mov_b32 v199, 0
    v_mov_b32 v200, 0
    v_mov_b32 v201, 0
    v_mov_b32 v202, 0
    v_mov_b32 v203, 0
    v_mov_b32 v204, 0
    v_mov_b32 v205, 0
    v_mov_b32 v206, 0
    v_mov_b32 v207, 0
    v_mov_b32 v208, 0
    v_mov_b32 v209, 0
    v_mov_b32 v210, 0
    v_mov_b32 v211, 0
    v_mov_b32 v212, 0
    v_mov_b32 v213, 0
    v_mov_b32 v214, 0
    v_mov_b32 v215, 0
    v_mov_b32 v216, 0
    v_mov_b32 v217, 0
    v_mov_b32 v218, 0
    v_mov_b32 v219, 0
    v_mov_b32 v220, 0
    v_mov_b32 v221, 0
    v_mov_b32 v222, 0
    v_mov_b32 v223, 0
    v_mov_b32 v224, 0
    v_mov_b32 v225, 0
    v_mov_b32 v226, 0
    v_mov_b32 v227, 0
    v_mov_b32 v228, 0
    v_mov_b32 v229, 0
    v_mov_b32 v230, 0
    v_mov_b32 v231, 0
    v_mov_b32 v232, 0
    v_mov_b32 v233, 0
    v_mov_b32 v234, 0
    v_mov_b32 v235, 0
    v_mov_b32 v236, 0
    v_mov_b32 v237, 0
    v_mov_b32 v238, 0
    v_mov_b32 v239, 0
    v_mov_b32 v240, 0
    v_mov_b32 v241, 0
    v_mov_b32 v242, 0
    v_mov_b32 v243, 0
    v_mov_b32 v244, 0
    v_mov_b32 v245, 0
    v_mov_b32 v246, 0
    v_mov_b32 v247, 0
    v_mov_b32 v248, 0
    v_mov_b32 v249, 0
    v_mov_b32 v250, 0
    v_mov_b32 v251, 0
    v_mov_b32 v252, 0
    v_mov_b32 v253, 0
    v_mov_b32 v254, 0
    v_mov_b32 v255, 0
    v_mov_b32 v28, 0
    v_mov_b32 v40, 4048155338
    v_mov_b32 v32, 0
    v_mov_b32 v41, 4048155338
    s_lshl_b32 s43, s28, 12
    v_add_u32 v4, s43, v7
    s_mov_b32 s46, s45
    s_sub_u32 s40, 16, s30
    s_sub_u32 s39, 15, s30
    s_lshl_b32 s37, s39, 7
    s_and_b32 s36, s28, 3
    s_lshl_b32 s36, s36, 5
    s_add_u32 s36, s36, s37
    s_sub_u32 s50, 0, s36
L_recurrent_scan__compressed_kv_cla__moe_arch_mod__prompt_kernel_stile_98:
    s_waitcnt vmcnt(0) lgkmcnt(0)
    s_barrier
    s_mov_b32 m0, s43
    s_add_u32 s47, s46, 32768
    buffer_load_dwordx4 v4, s[12:15], s46 offen offset:0 sc1 lds
    buffer_load_dwordx4 v4, s[12:15], s46 offen offset:1024 sc1 lds
    buffer_load_dwordx4 v4, s[12:15], s46 offen offset:2048 sc1 lds
    buffer_load_dwordx4 v4, s[12:15], s46 offen offset:3072 sc1 lds
    s_add_u32 m0, s43, 32768
    s_add_u32 s46, s46, 65536
    buffer_load_dwordx4 v4, s[12:15], s47 offen offset:0 sc1 lds
    buffer_load_dwordx4 v4, s[12:15], s47 offen offset:1024 sc1 lds
    buffer_load_dwordx4 v4, s[12:15], s47 offen offset:2048 sc1 lds
    buffer_load_dwordx4 v4, s[12:15], s47 offen offset:3072 sc1 lds
    v_mov_b32 v2, v7
    s_mov_b32 s41, 4
    s_waitcnt vmcnt(0)
    s_barrier
L_recurrent_scan__compressed_kv_cla__moe_arch_mod__prompt_kernel_sunit_99:
    s_cmp_gt_i32 s50, 0
    s_cbranch_scc1 L_recurrent_scan__compressed_kv_cla__moe_arch_mod__prompt_kernel_snext_100
    ds_read_b128 v[64:67], v2 offset:0
    ds_read_b128 v[68:71], v2 offset:1024
    ds_read_b128 v[72:75], v2 offset:2048
    ds_read_b128 v[76:79], v2 offset:3072
    ds_read_b128 v[80:83], v2 offset:4096
    ds_read_b128 v[84:87], v2 offset:5120
    ds_read_b128 v[88:91], v2 offset:6144
    ds_read_b128 v[92:95], v2 offset:7168
    s_waitcnt lgkmcnt(0)
    v_mfma_f32_16x16x32_bf16 v[96:99], v[64:67], v[128:131], 0
    v_mfma_f32_16x16x32_bf16 v[104:107], v[64:67], v[144:147], 0
    v_mfma_f32_16x16x32_bf16 v[96:99], v[68:71], v[132:135], v[96:99]
    v_mfma_f32_16x16x32_bf16 v[104:107], v[68:71], v[148:151], v[104:107]
    v_mfma_f32_16x16x32_bf16 v[96:99], v[72:75], v[136:139], v[96:99]
    v_mfma_f32_16x16x32_bf16 v[104:107], v[72:75], v[152:155], v[104:107]
    v_mfma_f32_16x16x32_bf16 v[96:99], v[76:79], v[140:143], v[96:99]
    v_mfma_f32_16x16x32_bf16 v[104:107], v[76:79], v[156:159], v[104:107]
    v_mfma_f32_16x16x32_bf16 v[100:103], v[80:83], v[128:131], 0
    v_mfma_f32_16x16x32_bf16 v[108:111], v[80:83], v[144:147], 0
    v_mfma_f32_16x16x32_bf16 v[100:103], v[84:87], v[132:135], v[100:103]
    v_mfma_f32_16x16x32_bf16 v[108:111], v[84:87], v[148:151], v[108:111]
    v_mfma_f32_16x16x32_bf16 v[100:103], v[88:91], v[136:139], v[100:103]
    v_mfma_f32_16x16x32_bf16 v[108:111], v[88:91], v[152:155], v[108:111]
    v_mfma_f32_16x16x32_bf16 v[100:103], v[92:95], v[140:143], v[100:103]
    v_mfma_f32_16x16x32_bf16 v[108:111], v[92:95], v[156:159], v[108:111]
    ds_read_b128 v[64:67], v2 offset:32768
    ds_read_b128 v[68:71], v2 offset:33792
    ds_read_b128 v[72:75], v2 offset:34816
    ds_read_b128 v[76:79], v2 offset:35840
    ds_read_b128 v[80:83], v2 offset:36864
    ds_read_b128 v[84:87], v2 offset:37888
    ds_read_b128 v[88:91], v2 offset:38912
    ds_read_b128 v[92:95], v2 offset:39936
    s_nop 1
    s_cmp_lt_i32 s50, 0
    s_cbranch_scc0 L_recurrent_scan__compressed_kv_cla__moe_arch_mod__prompt_kernel_rare_103
L_recurrent_scan__compressed_kv_cla__moe_arch_mod__prompt_kernel_back_104:
    v_max3_f32 v22, v96, v97, v98
    v_max3_f32 v22, v22, v99, v100
    v_max3_f32 v22, v22, v101, v102
    v_max3_f32 v22, v22, v103, v40
    v_mov_b32 v24, v22
    s_nop 1
    v_permlane16_swap_b32 v22, v24
    s_nop 1
    v_max_f32 v22, v22, v24
    v_mov_b32 v24, v22
    s_nop 1
    v_permlane32_swap_b32 v22, v24
    s_nop 1
    v_max_f32 v22, v22, v24
    v_sub_f32 v25, v40, v22
    v_exp_f32 v25, v25
    v_mov_b32 v40, v22
    v_mul_f32 v28, v28, v25
    v_mul_f32 v192, v192, v25
    v_mul_f32 v193, v193, v25
    v_mul_f32 v194, v194, v25
    v_mul_f32 v195, v195, v25
    v_mul_f32 v196, v196, v25
    v_mul_f32 v197, v197, v25
    v_mul_f32 v198, v198, v25
    v_mul_f32 v199, v199, v25
    v_mul_f32 v200, v200, v25
    v_mul_f32 v201, v201, v25
    v_mul_f32 v202, v202, v25
    v_mul_f32 v203, v203, v25
    v_mul_f32 v204, v204, v25
    v_mul_f32 v205, v205, v25
    v_mul_f32 v206, v206, v25
    v_mul_f32 v207, v207, v25
    v_mul_f32 v208, v208, v25
    v_mul_f32 v209, v209, v25
    v_mul_f32 v210, v210, v25
    v_mul_f32 v211, v211, v25
    v_mul_f32 v212, v212, v25
    v_mul_f32 v213, v213, v25
    v_mul_f32 v214, v214, v25
    v_mul_f32 v215, v215, v25
    v_mul_f32 v216, v216, v25
    v_mul_f32 v217, v217, v25
    v_mul_f32 v218, v218, v25
    v_mul_f32 v219, v219, v25
    v_mul_f32 v220, v220, v25
    v_mul_f32 v221, v221, v25
    v_mul_f32 v222, v222, v25
    v_mul_f32 v223, v223, v25
    v_sub_f32 v96, v96, v22
    v_sub_f32 v97, v97, v22
    v_sub_f32 v98, v98, v22
    v_sub_f32 v99, v99, v22
    v_sub_f32 v100, v100, v22
    v_sub_f32 v101, v101, v22
    v_sub_f32 v102, v102, v22
    v_sub_f32 v103, v103, v22
    v_max3_f32 v23, v104, v105, v106
    v_max3_f32 v23, v23, v107, v108
    v_max3_f32 v23, v23, v109, v110
    v_max3_f32 v23, v23, v111, v41
    v_mov_b32 v24, v23
    s_nop 1
    v_permlane16_swap_b32 v23, v24
    s_nop 1
    v_max_f32 v23, v23, v24
    v_mov_b32 v24, v23
    s_nop 1
    v_permlane32_swap_b32 v23, v24
    s_nop 1
    v_max_f32 v23, v23, v24
    v_sub_f32 v25, v41, v23
    v_exp_f32 v25, v25
    v_mov_b32 v41, v23
    v_mul_f32 v32, v32, v25
    v_mul_f32 v224, v224, v25
    v_mul_f32 v225, v225, v25
    v_mul_f32 v226, v226, v25
    v_mul_f32 v227, v227, v25
    v_mul_f32 v228, v228, v25
    v_mul_f32 v229, v229, v25
    v_mul_f32 v230, v230, v25
    v_mul_f32 v231, v231, v25
    v_mul_f32 v232, v232, v25
    v_mul_f32 v233, v233, v25
    v_mul_f32 v234, v234, v25
    v_mul_f32 v235, v235, v25
    v_mul_f32 v236, v236, v25
    v_mul_f32 v237, v237, v25
    v_mul_f32 v238, v238, v25
    v_mul_f32 v239, v239, v25
    v_mul_f32 v240, v240, v25
    v_mul_f32 v241, v241, v25
    v_mul_f32 v242, v242, v25
    v_mul_f32 v243, v243, v25
    v_mul_f32 v244, v244, v25
    v_mul_f32 v245, v245, v25
    v_mul_f32 v246, v246, v25
    v_mul_f32 v247, v247, v25
    v_mul_f32 v248, v248, v25
    v_mul_f32 v249, v249, v25
    v_mul_f32 v250, v250, v25
    v_mul_f32 v251, v251, v25
    v_mul_f32 v252, v252, v25
    v_mul_f32 v253, v253, v25
    v_mul_f32 v254, v254, v25
    v_mul_f32 v255, v255, v25
    v_sub_f32 v104, v104, v23
    v_sub_f32 v105, v105, v23
    v_sub_f32 v106, v106, v23
    v_sub_f32 v107, v107, v23
    v_sub_f32 v108, v108, v23
    v_sub_f32 v109, v109, v23
    v_sub_f32 v110, v110, v23
    v_sub_f32 v111, v111, v23
    v_exp_f32 v96, v96
    v_exp_f32 v97, v97
    v_exp_f32 v98, v98
    v_exp_f32 v99, v99
    v_exp_f32 v104, v104
    v_exp_f32 v105, v105
    v_exp_f32 v106, v106
    v_exp_f32 v107, v107
    v_exp_f32 v100, v100
    v_exp_f32 v101, v101
    v_exp_f32 v102, v102
    v_exp_f32 v103, v103
    v_exp_f32 v108, v108
    v_exp_f32 v109, v109
    v_exp_f32 v110, v110
    v_exp_f32 v111, v111
    v_add_f32 v28, v28, v96
    v_add_f32 v28, v28, v97
    v_cvt_pk_bf16_f32 v48, v96, v97
    v_add_f32 v28, v28, v98
    v_add_f32 v28, v28, v99
    v_cvt_pk_bf16_f32 v49, v98, v99
    v_add_f32 v32, v32, v104
    v_add_f32 v32, v32, v105
    v_cvt_pk_bf16_f32 v52, v104, v105
    v_add_f32 v32, v32, v106
    v_add_f32 v32, v32, v107
    v_cvt_pk_bf16_f32 v53, v106, v107
    v_add_f32 v28, v28, v100
    v_add_f32 v28, v28, v101
    v_cvt_pk_bf16_f32 v50, v100, v101
    v_add_f32 v28, v28, v102
    v_add_f32 v28, v28, v103
    v_cvt_pk_bf16_f32 v51, v102, v103
    v_add_f32 v32, v32, v108
    v_add_f32 v32, v32, v109
    v_cvt_pk_bf16_f32 v54, v108, v109
    v_add_f32 v32, v32, v110
    v_add_f32 v32, v32, v111
    v_cvt_pk_bf16_f32 v55, v110, v111
    s_waitcnt lgkmcnt(0)
    s_nop 0
    v_mfma_f32_16x16x32_bf16 v[192:195], v[64:67], v[48:51], v[192:195]
    v_mfma_f32_16x16x32_bf16 v[224:227], v[64:67], v[52:55], v[224:227]
    v_mfma_f32_16x16x32_bf16 v[196:199], v[68:71], v[48:51], v[196:199]
    v_mfma_f32_16x16x32_bf16 v[228:231], v[68:71], v[52:55], v[228:231]
    v_mfma_f32_16x16x32_bf16 v[200:203], v[72:75], v[48:51], v[200:203]
    v_mfma_f32_16x16x32_bf16 v[232:235], v[72:75], v[52:55], v[232:235]
    v_mfma_f32_16x16x32_bf16 v[204:207], v[76:79], v[48:51], v[204:207]
    v_mfma_f32_16x16x32_bf16 v[236:239], v[76:79], v[52:55], v[236:239]
    v_mfma_f32_16x16x32_bf16 v[208:211], v[80:83], v[48:51], v[208:211]
    v_mfma_f32_16x16x32_bf16 v[240:243], v[80:83], v[52:55], v[240:243]
    v_mfma_f32_16x16x32_bf16 v[212:215], v[84:87], v[48:51], v[212:215]
    v_mfma_f32_16x16x32_bf16 v[244:247], v[84:87], v[52:55], v[244:247]
    v_mfma_f32_16x16x32_bf16 v[216:219], v[88:91], v[48:51], v[216:219]
    v_mfma_f32_16x16x32_bf16 v[248:251], v[88:91], v[52:55], v[248:251]
    v_mfma_f32_16x16x32_bf16 v[220:223], v[92:95], v[48:51], v[220:223]
    v_mfma_f32_16x16x32_bf16 v[252:255], v[92:95], v[52:55], v[252:255]
L_recurrent_scan__compressed_kv_cla__moe_arch_mod__prompt_kernel_snext_100:
    v_add_u32 v2, 8192, v2
    s_add_u32 s50, s50, 32
    s_sub_u32 s41, s41, 1
    s_cmp_lg_u32 s41, 0
    s_cbranch_scc1 L_recurrent_scan__compressed_kv_cla__moe_arch_mod__prompt_kernel_sunit_99
    s_sub_u32 s40, s40, 1
    s_cmp_lg_u32 s40, 0
    s_cbranch_scc1 L_recurrent_scan__compressed_kv_cla__moe_arch_mod__prompt_kernel_stile_98
    v_mov_b32 v20, v28
    s_nop 1
    v_permlane16_swap_b32 v28, v20
    s_nop 1
    v_add_f32 v28, v28, v20
    v_mov_b32 v20, v28
    s_nop 1
    v_permlane32_swap_b32 v28, v20
    s_nop 1
    v_add_f32 v28, v28, v20
    v_mov_b32 v20, v32
    s_nop 1
    v_permlane16_swap_b32 v32, v20
    s_nop 1
    v_add_f32 v32, v32, v20
    v_mov_b32 v20, v32
    s_nop 1
    v_permlane32_swap_b32 v32, v20
    s_nop 1
    v_add_f32 v32, v32, v20
    s_mov_b32 s36, 0x5d800000
    v_cmp_nge_f32 vcc, s36, v28
    s_nop 0
    s_or_b64 s[52:53], s[52:53], vcc
    v_cmp_nge_f32 vcc, s36, v32
    s_nop 0
    s_or_b64 s[52:53], s[52:53], vcc
    v_rcp_f32 v20, v28
    v_rcp_f32 v22, v32
    s_lshl_b32 s38, s39, 3
    s_and_b32 s37, s28, 3
    s_lshl_b32 s37, s37, 1
    s_add_u32 s38, s38, s37
    s_lshl_b32 s38, s38, 17
    s_lshl_b32 s37, s29, 12
    s_add_u32 s38, s38, s37
    v_mov_b32 v21, v20
    v_mov_b32 v23, v22
    v_mov_b32 v24, v7
    v_pk_mul_f32 v[192:193], v[192:193], v[20:21]
    v_pk_mul_f32 v[194:195], v[194:195], v[20:21]
    v_pk_mul_f32 v[196:197], v[196:197], v[20:21]
    v_pk_mul_f32 v[198:199], v[198:199], v[20:21]
    v_cvt_pk_bf16_f32 v192, v192, v193
    v_cvt_pk_bf16_f32 v193, v194, v195
    v_cvt_pk_bf16_f32 v194, v196, v197
    v_cvt_pk_bf16_f32 v195, v198, v199
    buffer_store_dwordx4 v[192:195], v24, s[16:19], s38 offen offset:0 sc1
    v_pk_mul_f32 v[200:201], v[200:201], v[20:21]
    v_pk_mul_f32 v[202:203], v[202:203], v[20:21]
    v_pk_mul_f32 v[204:205], v[204:205], v[20:21]
    v_pk_mul_f32 v[206:207], v[206:207], v[20:21]
    v_cvt_pk_bf16_f32 v200, v200, v201
    v_cvt_pk_bf16_f32 v201, v202, v203
    v_cvt_pk_bf16_f32 v202, v204, v205
    v_cvt_pk_bf16_f32 v203, v206, v207
    buffer_store_dwordx4 v[200:203], v24, s[16:19], s38 offen offset:1024 sc1
    v_pk_mul_f32 v[208:209], v[208:209], v[20:21]
    v_pk_mul_f32 v[210:211], v[210:211], v[20:21]
    v_pk_mul_f32 v[212:213], v[212:213], v[20:21]
    v_pk_mul_f32 v[214:215], v[214:215], v[20:21]
    v_cvt_pk_bf16_f32 v208, v208, v209
    v_cvt_pk_bf16_f32 v209, v210, v211
    v_cvt_pk_bf16_f32 v210, v212, v213
    v_cvt_pk_bf16_f32 v211, v214, v215
    buffer_store_dwordx4 v[208:211], v24, s[16:19], s38 offen offset:2048 sc1
    v_pk_mul_f32 v[216:217], v[216:217], v[20:21]
    v_pk_mul_f32 v[218:219], v[218:219], v[20:21]
    v_pk_mul_f32 v[220:221], v[220:221], v[20:21]
    v_pk_mul_f32 v[222:223], v[222:223], v[20:21]
    v_cvt_pk_bf16_f32 v216, v216, v217
    v_cvt_pk_bf16_f32 v217, v218, v219
    v_cvt_pk_bf16_f32 v218, v220, v221
    v_cvt_pk_bf16_f32 v219, v222, v223
    buffer_store_dwordx4 v[216:219], v24, s[16:19], s38 offen offset:3072 sc1
    s_add_u32 s38, s38, 131072
    v_pk_mul_f32 v[224:225], v[224:225], v[22:23]
    v_pk_mul_f32 v[226:227], v[226:227], v[22:23]
    v_pk_mul_f32 v[228:229], v[228:229], v[22:23]
    v_pk_mul_f32 v[230:231], v[230:231], v[22:23]
    v_cvt_pk_bf16_f32 v224, v224, v225
    v_cvt_pk_bf16_f32 v225, v226, v227
    v_cvt_pk_bf16_f32 v226, v228, v229
    v_cvt_pk_bf16_f32 v227, v230, v231
    buffer_store_dwordx4 v[224:227], v24, s[16:19], s38 offen offset:0 sc1
    v_pk_mul_f32 v[232:233], v[232:233], v[22:23]
    v_pk_mul_f32 v[234:235], v[234:235], v[22:23]
    v_pk_mul_f32 v[236:237], v[236:237], v[22:23]
    v_pk_mul_f32 v[238:239], v[238:239], v[22:23]
    v_cvt_pk_bf16_f32 v232, v232, v233
    v_cvt_pk_bf16_f32 v233, v234, v235
    v_cvt_pk_bf16_f32 v234, v236, v237
    v_cvt_pk_bf16_f32 v235, v238, v239
    buffer_store_dwordx4 v[232:235], v24, s[16:19], s38 offen offset:1024 sc1
    v_pk_mul_f32 v[240:241], v[240:241], v[22:23]
    v_pk_mul_f32 v[242:243], v[242:243], v[22:23]
    v_pk_mul_f32 v[244:245], v[244:245], v[22:23]
    v_pk_mul_f32 v[246:247], v[246:247], v[22:23]
    v_cvt_pk_bf16_f32 v240, v240, v241
    v_cvt_pk_bf16_f32 v241, v242, v243
    v_cvt_pk_bf16_f32 v242, v244, v245
    v_cvt_pk_bf16_f32 v243, v246, v247
    buffer_store_dwordx4 v[240:243], v24, s[16:19], s38 offen offset:2048 sc1
    v_pk_mul_f32 v[248:249], v[248:249], v[22:23]
    v_pk_mul_f32 v[250:251], v[250:251], v[22:23]
    v_pk_mul_f32 v[252:253], v[252:253], v[22:23]
    v_pk_mul_f32 v[254:255], v[254:255], v[22:23]
    v_cvt_pk_bf16_f32 v248, v248, v249
    v_cvt_pk_bf16_f32 v249, v250, v251
    v_cvt_pk_bf16_f32 v250, v252, v253
    v_cvt_pk_bf16_f32 v251, v254, v255
    buffer_store_dwordx4 v[248:251], v24, s[16:19], s38 offen offset:3072 sc1
    v_mov_b32 v96, v112
    v_mov_b32 v97, v113
    v_mov_b32 v98, v114
    v_mov_b32 v99, v115
    v_mov_b32 v100, v116
    v_mov_b32 v101, v117
    v_mov_b32 v102, v118
    v_mov_b32 v103, v119
    s_branch L_p3_done
L_recurrent_scan__compressed_kv_cla__moe_arch_mod__prompt_kernel_rare_1:
    s_mul_i32 s36, s28, 12288
    s_add_u32 s36, s36, 61865984
    v_lshl_add_u32 v16, v1, 4, s36
    v_mov_b32 v108, 0
    v_mov_b32 v109, 0
    v_mov_b32 v110, 0
    v_mov_b32 v111, 0
    global_store_dwordx4 v16, v[108:111], s[90:91] sc1
    v_add_u32 v16, 1024, v16
    global_store_dwordx4 v16, v[108:111], s[90:91] sc1
    v_add_u32 v16, 1024, v16
    global_store_dwordx4 v16, v[108:111], s[90:91] sc1
    v_add_u32 v16, 1024, v16
    global_store_dwordx4 v16, v[108:111], s[90:91] sc1
    v_add_u32 v16, 1024, v16
    global_store_dwordx4 v16, v[108:111], s[90:91] sc1
    v_add_u32 v16, 1024, v16
    global_store_dwordx4 v16, v[108:111], s[90:91] sc1
    v_add_u32 v16, 1024, v16
    global_store_dwordx4 v16, v[108:111], s[90:91] sc1
    v_add_u32 v16, 1024, v16
    global_store_dwordx4 v16, v[108:111], s[90:91] sc1
    v_add_u32 v16, 1024, v16
    global_store_dwordx4 v16, v[108:111], s[90:91] sc1
    v_add_u32 v16, 1024, v16
    global_store_dwordx4 v16, v[108:111], s[90:91] sc1
    v_add_u32 v16, 1024, v16
    global_store_dwordx4 v16, v[108:111], s[90:91] sc1
    v_add_u32 v16, 1024, v16
    global_store_dwordx4 v16, v[108:111], s[90:91] sc1
    v_add_u32 v16, 1024, v16
    s_branch L_recurrent_scan__compressed_kv_cla__moe_arch_mod__prompt_kernel_back_2
L_recurrent_scan__compressed_kv_cla__moe_arch_mod__prompt_kernel_rare_3:
    v_mov_b32 v19, 1
    s_mov_b64 exec, 1
    global_store_dword v118, v19, s[88:89] sc1
    s_mov_b64 exec, -1
    s_branch L_recurrent_scan__compressed_kv_cla__moe_arch_mod__prompt_kernel_back_4
L_recurrent_scan__compressed_kv_cla__moe_arch_mod__prompt_kernel_rare_5:
    v_lshrrev_b32 v3, 4, v1
    s_lshl_b32 s37, s28, 4
    v_add_u32 v19, s37, v3
    v_lshlrev_b32 v19, 13, v19
    s_lshl_b32 s37, s29, 8
    v_add_u32 v19, s37, v19
    v_and_b32 v16, 15, v1
    v_lshlrev_b32 v3, 1, v3
    v_xor_b32 v16, v16, v3
    v_lshl_add_u32 v2, v16, 4, v19
    v_add_u32 v3, 31744, v2
    v_xor_b32 v16, 8, v16
    v_lshl_add_u32 v4, v16, 4, v19
    v_add_u32 v4, 63488, v4
    v_add_u32 v5, 31744, v4
    s_mov_b32 s4, s96
    s_and_b32 s5, s97, 0xffff
    s_mov_b32 s6, 8388608
    s_mov_b32 s7, 0x20000
    s_mov_b32 s31, 0
    s_mov_b32 s40, 1048576
    s_mov_b64 s[8:9], s[4:5]
    s_mov_b32 s10, s6
    s_mov_b32 s32, 3145728
    v_mov_b32 v6, v2
    v_mov_b32 v7, v3
    v_mov_b32 v8, v4
    v_mov_b32 v9, v5
    s_branch L_recurrent_scan__compressed_kv_cla__moe_arch_mod__prompt_kernel_back_6
L_recurrent_scan__compressed_kv_cla__moe_arch_mod__prompt_kernel_w0_7:
    s_cmp_eq_u32 s35, 0
    s_cbranch_scc0 L_recurrent_scan__compressed_kv_cla__moe_arch_mod__prompt_kernel_swn_10
    v_and_b32 v16, 7, v1
    v_lshrrev_b32 v18, 3, v1
    v_mul_u32_u24 v19, 2064, v16
    v_lshl_add_u32 v19, v18, 4, v19
    s_lshl_b32 s36, s28, 8
    s_add_u32 s36, s36, 131072
    v_add_u32 v19, s36, v19
    ds_read_b128 v[120:123], v19
    ds_read_b128 v[124:127], v19 offset:128
    v_lshlrev_b32 v16, 4, v16
    v_lshl_add_u32 v16, v18, 8, v16
    s_lshr_b32 s36, s2, 1
    s_lshl_b32 s36, s36, 15
    s_and_b32 s37, s2, 1
    s_lshl_b32 s37, s37, 7
    s_add_u32 s36, s36, s37
    s_lshl_b32 s37, s28, 12
    s_add_u32 s36, s36, s37
    s_waitcnt lgkmcnt(0)
    buffer_store_dwordx4 v[120:123], v16, s[24:27], s36 offen sc1
    buffer_store_dwordx4 v[124:127], v16, s[24:27], s36 offen offset:2048 sc1
    s_waitcnt vmcnt(2)
    s_branch L_recurrent_scan__compressed_kv_cla__moe_arch_mod__prompt_kernel_swend_9
L_recurrent_scan__compressed_kv_cla__moe_arch_mod__prompt_kernel_swn_10:
    s_waitcnt vmcnt(2)
L_recurrent_scan__compressed_kv_cla__moe_arch_mod__prompt_kernel_swend_9:
    s_branch L_recurrent_scan__compressed_kv_cla__moe_arch_mod__prompt_kernel_w0b_8
L_recurrent_scan__compressed_kv_cla__moe_arch_mod__prompt_kernel_rare_11:
    s_add_u32 m0, s33, 131072
    s_mov_b32 s36, 2097152
    buffer_load_dwordx4 v2, s[4:7], s36 offen offset:0 lds
    buffer_load_dwordx4 v3, s[4:7], s36 offen offset:1024 lds
    buffer_load_dwordx4 v4, s[4:7], s36 offen offset:2048 lds
    buffer_load_dwordx4 v5, s[4:7], s36 offen offset:3072 lds
    s_branch L_recurrent_scan__compressed_kv_cla__moe_arch_mod__prompt_kernel_back_12
L_recurrent_scan__compressed_kv_cla__moe_arch_mod__prompt_kernel_rare_15:
    s_cmp_eq_u32 s35, 0
    s_cbranch_scc0 L_recurrent_scan__compressed_kv_cla__moe_arch_mod__prompt_kernel_swn_14
    global_load_dword v116, v118, s[88:89] sc1
    s_branch L_recurrent_scan__compressed_kv_cla__moe_arch_mod__prompt_kernel_swend_13
L_recurrent_scan__compressed_kv_cla__moe_arch_mod__prompt_kernel_swn_14:
    v_and_b32 v117, 15, v1
    v_add_u32 v117, 112, v117
    v_lshlrev_b32 v117, 7, v117
    global_load_dword v116, v117, s[90:91] sc1
L_recurrent_scan__compressed_kv_cla__moe_arch_mod__prompt_kernel_swend_13:
    s_branch L_recurrent_scan__compressed_kv_cla__moe_arch_mod__prompt_kernel_back_16
L_recurrent_scan__compressed_kv_cla__moe_arch_mod__prompt_kernel_rare_21:
    s_mov_b32 s61, 0x40000
L_recurrent_scan__compressed_kv_cla__moe_arch_mod__prompt_kernel_spin_19:
    s_sub_u32 s61, s61, 1
    s_cbranch_scc1 L_recurrent_scan__compressed_kv_cla__moe_arch_mod__prompt_kernel_spinx_20
    s_sleep 8
    global_load_dword v116, v118, s[88:89] sc1
    s_waitcnt vmcnt(0)
    v_readfirstlane_b32 s36, v116
    s_nop 0
    s_cmp_lt_u32 s36, 1
    s_cbranch_scc1 L_recurrent_scan__compressed_kv_cla__moe_arch_mod__prompt_kernel_spin_19
L_recurrent_scan__compressed_kv_cla__moe_arch_mod__prompt_kernel_spinx_20:
    s_branch L_recurrent_scan__compressed_kv_cla__moe_arch_mod__prompt_kernel_back_22
L_recurrent_scan__compressed_kv_cla__moe_arch_mod__prompt_kernel_w0_17:
    s_waitcnt vmcnt(0)
    s_cmp_eq_u32 s35, 0
    s_cbranch_scc0 L_recurrent_scan__compressed_kv_cla__moe_arch_mod__prompt_kernel_swn_26
    v_readfirstlane_b32 s36, v116
    s_nop 0
    s_cmp_lt_u32 s36, 1
    s_cbranch_scc1 L_recurrent_scan__compressed_kv_cla__moe_arch_mod__prompt_kernel_rare_21
L_recurrent_scan__compressed_kv_cla__moe_arch_mod__prompt_kernel_back_22:
    s_branch L_recurrent_scan__compressed_kv_cla__moe_arch_mod__prompt_kernel_swend_25
L_recurrent_scan__compressed_kv_cla__moe_arch_mod__prompt_kernel_swn_26:
    s_mov_b32 s61, 0x40000
L_recurrent_scan__compressed_kv_cla__moe_arch_mod__prompt_kernel_lspin_23:
    v_cmp_gt_u32 vcc, 16, v116
    s_nop 0
    s_cmp_eq_u64 vcc, 0
    s_cbranch_scc1 L_recurrent_scan__compressed_kv_cla__moe_arch_mod__prompt_kernel_lspinx_24
    s_sub_u32 s61, s61, 1
    s_cbranch_scc1 L_recurrent_scan__compressed_kv_cla__moe_arch_mod__prompt_kernel_lspinx_24
    s_sleep 8
    global_load_dword v116, v117, s[90:91] sc1
    s_waitcnt vmcnt(0)
    s_branch L_recurrent_scan__compressed_kv_cla__moe_arch_mod__prompt_kernel_lspin_23
L_recurrent_scan__compressed_kv_cla__moe_arch_mod__prompt_kernel_lspinx_24:
L_recurrent_scan__compressed_kv_cla__moe_arch_mod__prompt_kernel_swend_25:
    s_branch L_recurrent_scan__compressed_kv_cla__moe_arch_mod__prompt_kernel_w0b_18
L_recurrent_scan__compressed_kv_cla__moe_arch_mod__prompt_kernel_rare_27:
    s_lshr_b32 s36, s2, 4
    s_add_u32 s36, s36, 112
    s_lshl_b32 s36, s36, 7
    v_mov_b32 v16, s36
    v_mov_b32 v19, 1
    s_mov_b64 exec, 1
    global_atomic_add v16, v19, s[90:91]
    s_mov_b64 exec, -1
    s_nop 3
    s_branch L_recurrent_scan__compressed_kv_cla__moe_arch_mod__prompt_kernel_back_28
L_recurrent_scan__compressed_kv_cla__moe_arch_mod__prompt_kernel_w0_29:
    s_cmp_eq_u32 s35, 0
    s_cbranch_scc0 L_recurrent_scan__compressed_kv_cla__moe_arch_mod__prompt_kernel_swn_32
    s_waitcnt vmcnt(2)
    s_branch L_recurrent_scan__compressed_kv_cla__moe_arch_mod__prompt_kernel_swend_31
L_recurrent_scan__compressed_kv_cla__moe_arch_mod__prompt_kernel_swn_32:
    s_waitcnt vmcnt(2)
L_recurrent_scan__compressed_kv_cla__moe_arch_mod__prompt_kernel_swend_31:
    s_branch L_recurrent_scan__compressed_kv_cla__moe_arch_mod__prompt_kernel_w0b_30
L_recurrent_scan__compressed_kv_cla__moe_arch_mod__prompt_kernel_rare_33:
    s_add_u32 m0, s33, 131072
    s_mov_b32 s36, 2097152
    buffer_load_dwordx4 v2, s[4:7], s36 offen offset:0 lds
    buffer_load_dwordx4 v3, s[4:7], s36 offen offset:1024 lds
    buffer_load_dwordx4 v4, s[4:7], s36 offen offset:2048 lds
    buffer_load_dwordx4 v5, s[4:7], s36 offen offset:3072 lds
    s_branch L_recurrent_scan__compressed_kv_cla__moe_arch_mod__prompt_kernel_back_34
L_recurrent_scan__compressed_kv_cla__moe_arch_mod__prompt_kernel_rare_36:
    v_and_b32 v16, 7, v1
    v_lshrrev_b32 v18, 3, v1
    v_mul_u32_u24 v19, 2064, v16
    v_lshl_add_u32 v19, v18, 4, v19
    s_lshl_b32 s36, s28, 8
    s_add_u32 s36, s36, 131072
    v_add_u32 v19, s36, v19
    ds_read_b128 v[120:123], v19
    ds_read_b128 v[124:127], v19 offset:128
    v_lshlrev_b32 v16, 4, v16
    v_lshl_add_u32 v16, v18, 8, v16
    s_lshr_b32 s36, s2, 1
    s_lshl_b32 s36, s36, 15
    s_and_b32 s37, s2, 1
    s_lshl_b32 s37, s37, 7
    s_add_u32 s36, s36, s37
    s_lshl_b32 s37, s28, 12
    s_add_u32 s36, s36, s37
    s_waitcnt lgkmcnt(0)
    buffer_store_dwordx4 v[120:123], v16, s[24:27], s36 offen sc1
    buffer_store_dwordx4 v[124:127], v16, s[24:27], s36 offen offset:2048 sc1
    s_cmp_eq_u32 s28, 7
    s_cbranch_scc0 L_recurrent_scan__compressed_kv_cla__moe_arch_mod__prompt_kernel_l7_35
    v_and_b32 v120, 7, v1
    v_lshlrev_b32 v120, 3, v120
    v_add_u32 v121, 147712, v120
    ds_read_b64 v[122:123], v121
    ds_read_b32 v124, v121 offset:64
    s_lshl_b32 s36, s2, 6
    s_add_u32 s36, s36, 4194304
    s_lshl_b32 s37, s2, 3
    s_add_u32 s37, s37, 4276224
    s_waitcnt lgkmcnt(0)
    v_mov_b32 v126, v124
    s_nop 1
    v_max_u32_dpp v126, v126, v126 quad_perm:[1,0,3,2] row_mask:0xf bank_mask:0xf
    s_nop 1
    v_max_u32_dpp v126, v126, v126 quad_perm:[2,3,0,1] row_mask:0xf bank_mask:0xf
    s_nop 1
    v_max_u32_dpp v126, v126, v126 row_half_mirror row_mask:0xf bank_mask:0xf
    v_cmp_eq_u32 vcc, v126, v124
    s_nop 1
    v_cndmask_b32 v127, v124, v118, vcc
    s_nop 1
    v_max_u32_dpp v127, v127, v127 quad_perm:[1,0,3,2] row_mask:0xf bank_mask:0xf
    s_nop 1
    v_max_u32_dpp v127, v127, v127 quad_perm:[2,3,0,1] row_mask:0xf bank_mask:0xf
    s_nop 1
    v_max_u32_dpp v127, v127, v127 row_half_mirror row_mask:0xf bank_mask:0xf
    s_mov_b64 exec, 0xff
    buffer_store_dwordx2 v[122:123], v120, s[24:27], s36 offen sc1
    s_mov_b64 exec, 1
    buffer_store_dwordx2 v[126:127], v120, s[24:27], s37 offen sc1
    s_mov_b64 exec, -1
    s_nop 3
L_recurrent_scan__compressed_kv_cla__moe_arch_mod__prompt_kernel_l7_35:
    s_branch L_recurrent_scan__compressed_kv_cla__moe_arch_mod__prompt_kernel_back_37
L_recurrent_scan__compressed_kv_cla__moe_arch_mod__prompt_kernel_rare_40:
    v_lshrrev_b32 v3, 4, v1
    s_lshl_b32 s37, s28, 4
    v_add_u32 v19, s37, v3
    v_lshlrev_b32 v19, 13, v19
    s_lshl_b32 s37, s29, 8
    v_add_u32 v19, s37, v19
    v_and_b32 v16, 15, v1
    v_lshlrev_b32 v3, 1, v3
    v_xor_b32 v16, v16, v3
    v_lshl_add_u32 v2, v16, 4, v19
    v_add_u32 v3, 31744, v2
    v_xor_b32 v16, 8, v16
    v_lshl_add_u32 v4, v16, 4, v19
    v_add_u32 v4, 63488, v4
    v_add_u32 v5, 31744, v4
    s_mov_b32 s4, s96
    s_and_b32 s5, s97, 0xffff
    s_mov_b32 s6, 8388608
    s_mov_b32 s7, 0x20000
    s_mov_b32 s31, 0
    s_mov_b32 s40, 1048576
    s_mov_b64 s[8:9], s[4:5]
    s_mov_b32 s10, s6
    s_mov_b32 s32, 3145728
    v_mov_b32 v6, v2
    v_mov_b32 v7, v3
    v_mov_b32 v8, v4
    v_mov_b32 v9, v5
    s_branch L_recurrent_scan__compressed_kv_cla__moe_arch_mod__prompt_kernel_back_41
L_recurrent_scan__compressed_kv_cla__moe_arch_mod__prompt_kernel_rare_44:
    s_mov_b32 s61, 0x40000
L_recurrent_scan__compressed_kv_cla__moe_arch_mod__prompt_kernel_spin_42:
    s_sub_u32 s61, s61, 1
    s_cbranch_scc1 L_recurrent_scan__compressed_kv_cla__moe_arch_mod__prompt_kernel_spinx_43
    s_sleep 8
    global_load_dword v56, v57, s[90:91] sc1
    s_waitcnt vmcnt(0)
    v_readfirstlane_b32 s36, v56
    s_nop 0
    s_cmp_lt_u32 s36, 1
    s_cbranch_scc1 L_recurrent_scan__compressed_kv_cla__moe_arch_mod__prompt_kernel_spin_42
L_recurrent_scan__compressed_kv_cla__moe_arch_mod__prompt_kernel_spinx_43:
    s_branch L_recurrent_scan__compressed_kv_cla__moe_arch_mod__prompt_kernel_back_45
L_recurrent_scan__compressed_kv_cla__moe_arch_mod__prompt_kernel_rare_46:
    s_branch L_recurrent_scan__compressed_kv_cla__moe_arch_mod__prompt_kernel_back_47
L_recurrent_scan__compressed_kv_cla__moe_arch_mod__prompt_kernel_rare_48:
    s_waitcnt vmcnt(7)
    v_readfirstlane_b32 s36, v56
    s_nop 0
    s_cmp_lt_u32 s36, 1
    s_cbranch_scc1 L_recurrent_scan__compressed_kv_cla__moe_arch_mod__prompt_kernel_rare_44
L_recurrent_scan__compressed_kv_cla__moe_arch_mod__prompt_kernel_back_45:
    s_branch L_recurrent_scan__compressed_kv_cla__moe_arch_mod__prompt_kernel_back_49
L_recurrent_scan__compressed_kv_cla__moe_arch_mod__prompt_kernel_rare_50:
    s_add_u32 s36, s29, 64
    s_lshl_b32 s36, s36, 7
    v_mov_b32 v62, s36
    v_mov_b32 v63, 1
    s_mov_b64 exec, 1
    global_atomic_add v62, v63, s[90:91]
    s_mov_b64 exec, -1
    s_nop 3
    s_branch L_recurrent_scan__compressed_kv_cla__moe_arch_mod__prompt_kernel_back_51
L_recurrent_scan__compressed_kv_cla__moe_arch_mod__prompt_kernel_rare_52:
    s_add_u32 s36, s29, 64
    s_lshl_b32 s36, s36, 7
    v_mov_b32 v57, s36
    global_load_dword v56, v57, s[90:91] sc1
    s_branch L_recurrent_scan__compressed_kv_cla__moe_arch_mod__prompt_kernel_back_53
L_recurrent_scan__compressed_kv_cla__moe_arch_mod__prompt_kernel_rare_54:
    buffer_store_dwordx4 v[160:163], v58, s[16:19], s48 offen sc1
    buffer_store_dwordx4 v[164:167], v59, s[16:19], s48 offen sc1
    buffer_store_dwordx4 v[168:171], v60, s[16:19], s48 offen sc1
    buffer_store_dwordx4 v[172:175], v61, s[16:19], s48 offen sc1
    buffer_store_dwordx4 v[176:179], v58, s[16:19], s49 offen sc1
    buffer_store_dwordx4 v[180:183], v59, s[16:19], s49 offen sc1
    buffer_store_dwordx4 v[184:187], v60, s[16:19], s49 offen sc1
    buffer_store_dwordx4 v[188:191], v61, s[16:19], s49 offen sc1
    s_branch L_recurrent_scan__compressed_kv_cla__moe_arch_mod__prompt_kernel_back_55
L_recurrent_scan__compressed_kv_cla__moe_arch_mod__prompt_kernel_rare_56:
    s_lshl_b32 s36, s29, 7
    v_mov_b32 v13, s36
    global_load_dword v14, v13, s[90:91] sc1
    s_branch L_recurrent_scan__compressed_kv_cla__moe_arch_mod__prompt_kernel_back_57
L_recurrent_scan__compressed_kv_cla__moe_arch_mod__prompt_kernel_rare_64:
    s_mov_b32 s41, 32768
    s_cmp_eq_u32 s40, 15
    s_cbranch_scc0 L_recurrent_scan__compressed_kv_cla__moe_arch_mod__prompt_kernel_r_58
    s_mov_b32 s41, 65536
    s_mov_b32 s49, 0x1ffff
    s_sub_u32 s36, 0, s50
    s_cmp_lt_i32 s36, 0
    s_cbranch_scc1 L_recurrent_scan__compressed_kv_cla__moe_arch_mod__prompt_kernel_nm_63
    v_mov_b32 v20, 4048155338
    s_cmp_gt_i32 s36, 0
    s_cbranch_scc1 L_recurrent_scan__compressed_kv_cla__moe_arch_mod__prompt_kernel_mf_61
    v_cmp_gt_i32 s[20:21], 0, v18
    v_cmp_gt_i32 s[22:23], 1, v18
    v_cmp_gt_i32 s[62:63], 2, v18
    v_cmp_gt_i32 vcc, 3, v18
    v_mov_b32 v100, v20
    v_mov_b32 v101, v20
    v_mov_b32 v102, v20
    v_mov_b32 v103, v20
    v_cndmask_b32 v96, v96, v20, s[20:21]
    v_cndmask_b32 v97, v97, v20, s[22:23]
    v_cndmask_b32 v98, v98, v20, s[62:63]
    v_cndmask_b32 v99, v99, v20, vcc
    v_cndmask_b32 v108, v108, v20, s[20:21]
    v_cndmask_b32 v109, v109, v20, s[22:23]
    v_cndmask_b32 v110, v110, v20, s[62:63]
    v_cndmask_b32 v111, v111, v20, vcc
    s_branch L_recurrent_scan__compressed_kv_cla__moe_arch_mod__prompt_kernel_me_62
L_recurrent_scan__compressed_kv_cla__moe_arch_mod__prompt_kernel_mf_61:
    v_mov_b32 v96, v20
    v_mov_b32 v97, v20
    v_mov_b32 v98, v20
    v_mov_b32 v99, v20
    v_mov_b32 v100, v20
    v_mov_b32 v101, v20
    v_mov_b32 v102, v20
    v_mov_b32 v103, v20
    v_mov_b32 v104, v20
    v_mov_b32 v105, v20
    v_mov_b32 v106, v20
    v_mov_b32 v107, v20
    v_mov_b32 v108, v20
    v_mov_b32 v109, v20
    v_mov_b32 v110, v20
    v_mov_b32 v111, v20
L_recurrent_scan__compressed_kv_cla__moe_arch_mod__prompt_kernel_me_62:
L_recurrent_scan__compressed_kv_cla__moe_arch_mod__prompt_kernel_nm_63:
L_recurrent_scan__compressed_kv_cla__moe_arch_mod__prompt_kernel_r_58:
    s_branch L_recurrent_scan__compressed_kv_cla__moe_arch_mod__prompt_kernel_back_65
L_recurrent_scan__compressed_kv_cla__moe_arch_mod__prompt_kernel_rare_74:
    s_mov_b32 s61, 0x40000
L_recurrent_scan__compressed_kv_cla__moe_arch_mod__prompt_kernel_spin_72:
    s_sub_u32 s61, s61, 1
    s_cbranch_scc1 L_recurrent_scan__compressed_kv_cla__moe_arch_mod__prompt_kernel_spinx_73
    s_sleep 8
    global_load_dword v14, v13, s[90:91] sc1
    s_waitcnt vmcnt(0)
    v_readfirstlane_b32 s36, v14
    s_nop 0
    s_cmp_lt_u32 s36, 7
    s_cbranch_scc1 L_recurrent_scan__compressed_kv_cla__moe_arch_mod__prompt_kernel_spin_72
L_recurrent_scan__compressed_kv_cla__moe_arch_mod__prompt_kernel_spinx_73:
    s_branch L_recurrent_scan__compressed_kv_cla__moe_arch_mod__prompt_kernel_back_75
L_recurrent_scan__compressed_kv_cla__moe_arch_mod__prompt_kernel_rare_80:
    s_cmp_eq_u32 s40, 1
    s_cbranch_scc0 L_recurrent_scan__compressed_kv_cla__moe_arch_mod__prompt_kernel_swn_77
    v_readfirstlane_b32 s36, v14
    s_nop 0
    s_cmp_lt_u32 s36, 7
    s_cbranch_scc1 L_recurrent_scan__compressed_kv_cla__moe_arch_mod__prompt_kernel_rare_74
L_recurrent_scan__compressed_kv_cla__moe_arch_mod__prompt_kernel_back_75:
    s_branch L_recurrent_scan__compressed_kv_cla__moe_arch_mod__prompt_kernel_swend_76
L_recurrent_scan__compressed_kv_cla__moe_arch_mod__prompt_kernel_swn_77:
    s_cmp_eq_u32 s40, 2
    s_cbranch_scc0 L_recurrent_scan__compressed_kv_cla__moe_arch_mod__prompt_kernel_swn_78
    s_mov_b32 s36, 4276224
    buffer_load_dwordx4 v[160:163], v7, s[24:27], s36 offen offset:0 sc1
    buffer_load_dwordx4 v[164:167], v7, s[24:27], s36 offen offset:1024 sc1
    s_branch L_recurrent_scan__compressed_kv_cla__moe_arch_mod__prompt_kernel_swend_76
L_recurrent_scan__compressed_kv_cla__moe_arch_mod__prompt_kernel_swn_78:
    s_cmp_eq_u32 s40, 3
    s_cbranch_scc0 L_recurrent_scan__compressed_kv_cla__moe_arch_mod__prompt_kernel_swn_79
    v_max_u32 v24, v160, v161
    v_min_u32 v25, v160, v161
    v_med3_u32 v25, v24, v25, v162
    v_max_u32 v24, v24, v162
    v_med3_u32 v25, v24, v25, v163
    v_max_u32 v24, v24, v163
    v_med3_u32 v25, v24, v25, v164
    v_max_u32 v24, v24, v164
    v_med3_u32 v25, v24, v25, v165
    v_max_u32 v24, v24, v165
    v_med3_u32 v25, v24, v25, v166
    v_max_u32 v24, v24, v166
    v_med3_u32 v25, v24, v25, v167
    v_max_u32 v24, v24, v167
    v_mov_b32 v26, v24
    s_nop 1
    v_max_u32_dpp v26, v26, v26 quad_perm:[1,0,3,2] row_mask:0xf bank_mask:0xf
    s_nop 1
    v_max_u32_dpp v26, v26, v26 quad_perm:[2,3,0,1] row_mask:0xf bank_mask:0xf
    s_nop 1
    v_max_u32_dpp v26, v26, v26 row_half_mirror row_mask:0xf bank_mask:0xf
    s_nop 1
    v_max_u32_dpp v26, v26, v26 row_mirror row_mask:0xf bank_mask:0xf
    s_nop 0
    v_readlane_b32 s20, v26, 0
    v_readlane_b32 s21, v26, 16
    v_readlane_b32 s22, v26, 32
    v_readlane_b32 s23, v26, 48
    s_max_u32 s20, s20, s21
    s_max_u32 s22, s22, s23
    s_max_u32 s20, s20, s22
    s_mov_b32 s58, s20
    v_cmp_eq_u32 vcc, s58, v24
    s_nop 1
    v_cndmask_b32 v26, v24, v25, vcc
    s_nop 1
    v_max_u32_dpp v26, v26, v26 quad_perm:[1,0,3,2] row_mask:0xf bank_mask:0xf
    s_nop 1
    v_max_u32_dpp v26, v26, v26 quad_perm:[2,3,0,1] row_mask:0xf bank_mask:0xf
    s_nop 1
    v_max_u32_dpp v26, v26, v26 row_half_mirror row_mask:0xf bank_mask:0xf
    s_nop 1
    v_max_u32_dpp v26, v26, v26 row_mirror row_mask:0xf bank_mask:0xf
    s_nop 0
    v_readlane_b32 s20, v26, 0
    v_readlane_b32 s21, v26, 16
    v_readlane_b32 s22, v26, 32
    v_readlane_b32 s23, v26, 48
    s_max_u32 s20, s20, s21
    s_max_u32 s22, s22, s23
    s_max_u32 s20, s20, s22
    s_mov_b32 s59, s20
    s_and_b32 s36, s58, 0xffff
    s_sub_u32 s56, 0xffff, s36
    s_and_b32 s36, s59, 0xffff
    s_sub_u32 s57, 0xffff, s36
    v_and_b32 v24, 1, v1
    v_mov_b32 v25, s56
    v_mov_b32 v26, s57
    v_cmp_eq_u32 vcc, 1, v24
    s_nop 1
    v_cndmask_b32 v25, v25, v26, vcc
    v_lshrrev_b32 v26, 4, v25
    v_lshlrev_b32 v26, 15, v26
    v_and_b32 v25, 15, v25
    v_lshl_add_u32 v26, v25, 4, v26
    v_lshrrev_b32 v27, 4, v1
    v_lshl_add_u32 v26, v27, 8, v26
    s_and_b32 s36, s3, 3
    s_lshl_b32 s36, s36, 13
    s_add_u32 s37, s36, 4096
    s_mov_b32 exec_lo, 0x00030003
    s_mov_b32 exec_hi, 0x00030003
    buffer_load_dwordx4 v[160:163], v26, s[24:27], s36 offen offset:0 sc1
    buffer_load_dwordx4 v[164:167], v26, s[24:27], s36 offen offset:1024 sc1
    buffer_load_dwordx4 v[168:171], v26, s[24:27], s36 offen offset:2048 sc1
    buffer_load_dwordx4 v[172:175], v26, s[24:27], s36 offen offset:3072 sc1
    buffer_load_dwordx4 v[176:179], v26, s[24:27], s37 offen offset:0 sc1
    buffer_load_dwordx4 v[180:183], v26, s[24:27], s37 offen offset:1024 sc1
    buffer_load_dwordx4 v[184:187], v26, s[24:27], s37 offen offset:2048 sc1
    buffer_load_dwordx4 v[188:191], v26, s[24:27], s37 offen offset:3072 sc1
    s_mov_b64 exec, -1
    s_branch L_recurrent_scan__compressed_kv_cla__moe_arch_mod__prompt_kernel_swend_76
L_recurrent_scan__compressed_kv_cla__moe_arch_mod__prompt_kernel_swn_79:
    s_sub_u32 s38, s40, s60
    s_cmp_eq_u32 s38, 0
    s_cbranch_scc0 L_recurrent_scan__compressed_kv_cla__moe_arch_mod__prompt_kernel_swn_68
    s_and_b32 s20, s3, 3
    s_lshl_b32 s20, s20, 8
    s_lshl_b32 s21, s28, 5
    s_add_u32 s20, s20, s21
    s_lshr_b32 s21, s3, 2
    s_lshl_b32 s21, s21, 7
    v_lshrrev_b32 v25, 3, v1
    s_lshl_b32 s36, s28, 5
    s_add_u32 s36, s36, s20
    v_add_u32 v25, s36, v25
    v_mul_u32_u24 v25, 7168, v25
    v_add_u32 v25, s21, v25
    v_bfe_u32 v26, v1, 4, 1
    v_lshlrev_b32 v26, 1, v26
    v_and_b32 v27, 7, v1
    v_xor_b32 v26, v26, v27
    v_lshl_add_u32 v24, v26, 4, v25
    v_xor_b32 v26, 4, v26
    v_lshl_add_u32 v25, v26, 4, v25
    v_add_u32 v25, 56320, v25
    v_add_u32 v26, 112640, v24
    v_add_u32 v27, 112640, v25
    s_lshl_b32 s36, s28, 13
    s_add_u32 m0, s36, 131072
    s_mov_b32 s37, 229376
    buffer_load_dwordx4 v24, s[4:7], 0 offen offset:0 nt lds
    buffer_load_dwordx4 v25, s[4:7], 0 offen offset:1024 nt lds
    buffer_load_dwordx4 v26, s[4:7], 0 offen offset:2048 nt lds
    buffer_load_dwordx4 v27, s[4:7], 0 offen offset:3072 nt lds
    s_add_u32 m0, s36, 135168
    s_nop 0
    buffer_load_dwordx4 v24, s[4:7], s37 offen offset:0 nt lds
    buffer_load_dwordx4 v25, s[4:7], s37 offen offset:1024 nt lds
    buffer_load_dwordx4 v26, s[4:7], s37 offen offset:2048 nt lds
    buffer_load_dwordx4 v27, s[4:7], s37 offen offset:3072 nt lds
    s_branch L_recurrent_scan__compressed_kv_cla__moe_arch_mod__prompt_kernel_swend_67
L_recurrent_scan__compressed_kv_cla__moe_arch_mod__prompt_kernel_swn_68:
    s_cmp_eq_u32 s38, 2
    s_cbranch_scc0 L_recurrent_scan__compressed_kv_cla__moe_arch_mod__prompt_kernel_swn_69
    v_lshrrev_b32 v8, 4, v1
    v_bfe_u32 v5, v1, 2, 2
    v_lshl_add_u32 v5, v8, 3, v5
    v_lshlrev_b32 v5, 7, v5
    v_and_b32 v9, 3, v1
    v_lshl_add_u32 v5, v9, 3, v5
    v_bfe_u32 v9, v1, 3, 2
    v_xor_b32 v9, s28, v9
    v_lshl_add_u32 v5, v9, 5, v5
    v_add_u32 v5, 131072, v5
    ds_read_b64_tr_b16 v[14:15], v5 offset:0
    ds_read_b64_tr_b16 v[16:17], v5 offset:512
    ds_read_b64_tr_b16 v[20:21], v5 offset:4096
    ds_read_b64_tr_b16 v[22:23], v5 offset:4608
    ds_read_b64_tr_b16 v[24:25], v5 offset:8192
    ds_read_b64_tr_b16 v[26:27], v5 offset:8704
    s_and_b32 s36, s3, 3
    s_lshl_b32 s36, s36, 6
    s_lshr_b32 s37, s3, 2
    s_lshl_b32 s37, s37, 12
    s_add_u32 s36, s36, s37
    s_lshl_b32 s37, s28, 10
    s_add_u32 s36, s36, s37
    s_add_u32 s36, s36, 58720256
    v_and_b32 v9, 1, v1
    v_lshlrev_b32 v9, 4, v9
    v_lshl_add_u32 v9, v8, 8, v9
    s_waitcnt lgkmcnt(4)
    v_mfma_f32_16x16x32_bf16 v[10:13], v[14:17], v[160:163], 0
    ds_read_b64_tr_b16 v[14:15], v5 offset:12288
    ds_read_b64_tr_b16 v[16:17], v5 offset:12800
    s_waitcnt lgkmcnt(4)
    v_mfma_f32_16x16x32_bf16 v[10:13], v[20:23], v[164:167], v[10:13]
    ds_read_b64_tr_b16 v[20:21], v5 offset:16384
    ds_read_b64_tr_b16 v[22:23], v5 offset:16896
    s_waitcnt lgkmcnt(4)
    v_mfma_f32_16x16x32_bf16 v[10:13], v[24:27], v[168:171], v[10:13]
    ds_read_b64_tr_b16 v[24:25], v5 offset:20480
    ds_read_b64_tr_b16 v[26:27], v5 offset:20992
    s_waitcnt lgkmcnt(4)
    v_mfma_f32_16x16x32_bf16 v[10:13], v[14:17], v[172:175], v[10:13]
    ds_read_b64_tr_b16 v[14:15], v5 offset:24576
    ds_read_b64_tr_b16 v[16:17], v5 offset:25088
    s_waitcnt lgkmcnt(4)
    v_mfma_f32_16x16x32_bf16 v[10:13], v[20:23], v[176:179], v[10:13]
    ds_read_b64_tr_b16 v[20:21], v5 offset:28672
    ds_read_b64_tr_b16 v[22:23], v5 offset:29184
    s_waitcnt lgkmcnt(4)
    v_mfma_f32_16x16x32_bf16 v[10:13], v[24:27], v[180:183], v[10:13]
    s_waitcnt lgkmcnt(2)
    v_mfma_f32_16x16x32_bf16 v[10:13], v[14:17], v[184:187], v[10:13]
    s_waitcnt lgkmcnt(0)
    v_mfma_f32_16x16x32_bf16 v[10:13], v[20:23], v[188:191], v[10:13]
    s_nop 5
    s_mov_b32 exec_lo, 0x00030003
    s_mov_b32 exec_hi, 0x00030003
    buffer_store_dwordx4 v[10:13], v9, s[24:27], s36 offen sc1
    s_mov_b64 exec, -1
    s_nop 1
    s_branch L_recurrent_scan__compressed_kv_cla__moe_arch_mod__prompt_kernel_swend_67
L_recurrent_scan__compressed_kv_cla__moe_arch_mod__prompt_kernel_swn_69:
    s_cmp_eq_u32 s38, 3
    s_cbranch_scc0 L_recurrent_scan__compressed_kv_cla__moe_arch_mod__prompt_kernel_swn_70
    s_and_b32 s20, s3, 3
    s_lshl_b32 s20, s20, 8
    s_lshl_b32 s21, s28, 5
    s_add_u32 s20, s20, s21
    s_lshr_b32 s21, s3, 2
    s_lshl_b32 s21, s21, 7
    v_lshrrev_b32 v25, 3, v1
    s_lshl_b32 s36, s28, 5
    s_add_u32 s36, s36, s20
    v_add_u32 v25, s36, v25
    v_mul_u32_u24 v25, 7168, v25
    v_add_u32 v25, s21, v25
    v_bfe_u32 v26, v1, 4, 1
    v_lshlrev_b32 v26, 1, v26
    v_and_b32 v27, 7, v1
    v_xor_b32 v26, v26, v27
    v_lshl_add_u32 v24, v26, 4, v25
    v_xor_b32 v26, 4, v26
    v_lshl_add_u32 v25, v26, 4, v25
    v_add_u32 v25, 56320, v25
    v_add_u32 v26, 112640, v24
    v_add_u32 v27, 112640, v25
    s_lshl_b32 s36, s28, 13
    s_add_u32 m0, s36, 131072
    s_mov_b32 s37, 229376
    buffer_load_dwordx4 v24, s[8:11], 0 offen offset:0 nt lds
    buffer_load_dwordx4 v25, s[8:11], 0 offen offset:1024 nt lds
    buffer_load_dwordx4 v26, s[8:11], 0 offen offset:2048 nt lds
    buffer_load_dwordx4 v27, s[8:11], 0 offen offset:3072 nt lds
    s_add_u32 m0, s36, 135168
    s_nop 0
    buffer_load_dwordx4 v24, s[8:11], s37 offen offset:0 nt lds
    buffer_load_dwordx4 v25, s[8:11], s37 offen offset:1024 nt lds
    buffer_load_dwordx4 v26, s[8:11], s37 offen offset:2048 nt lds
    buffer_load_dwordx4 v27, s[8:11], s37 offen offset:3072 nt lds
    s_branch L_recurrent_scan__compressed_kv_cla__moe_arch_mod__prompt_kernel_swend_67
L_recurrent_scan__compressed_kv_cla__moe_arch_mod__prompt_kernel_swn_70:
    s_cmp_eq_u32 s38, 5
    s_cbranch_scc0 L_recurrent_scan__compressed_kv_cla__moe_arch_mod__prompt_kernel_swn_71
    v_lshrrev_b32 v8, 4, v1
    v_bfe_u32 v5, v1, 2, 2
    v_lshl_add_u32 v5, v8, 3, v5
    v_lshlrev_b32 v5, 7, v5
    v_and_b32 v9, 3, v1
    v_lshl_add_u32 v5, v9, 3, v5
    v_bfe_u32 v9, v1, 3, 2
    v_xor_b32 v9, s28, v9
    v_lshl_add_u32 v5, v9, 5, v5
    v_add_u32 v5, 131072, v5
    ds_read_b64_tr_b16 v[14:15], v5 offset:0
    ds_read_b64_tr_b16 v[16:17], v5 offset:512
    ds_read_b64_tr_b16 v[20:21], v5 offset:4096
    ds_read_b64_tr_b16 v[22:23], v5 offset:4608
    ds_read_b64_tr_b16 v[24:25], v5 offset:8192
    ds_read_b64_tr_b16 v[26:27], v5 offset:8704
    s_and_b32 s36, s3, 3
    s_lshl_b32 s36, s36, 6
    s_lshr_b32 s37, s3, 2
    s_lshl_b32 s37, s37, 12
    s_add_u32 s36, s36, s37
    s_lshl_b32 s37, s28, 10
    s_add_u32 s36, s36, s37
    s_add_u32 s36, s36, 58720288
    v_and_b32 v9, 1, v1
    v_lshlrev_b32 v9, 4, v9
    v_lshl_add_u32 v9, v8, 8, v9
    s_waitcnt lgkmcnt(4)
    v_mfma_f32_16x16x32_bf16 v[10:13], v[14:17], v[160:163], 0
    ds_read_b64_tr_b16 v[14:15], v5 offset:12288
    ds_read_b64_tr_b16 v[16:17], v5 offset:12800
    s_waitcnt lgkmcnt(4)
    v_mfma_f32_16x16x32_bf16 v[10:13], v[20:23], v[164:167], v[10:13]
    ds_read_b64_tr_b16 v[20:21], v5 offset:16384
    ds_read_b64_tr_b16 v[22:23], v5 offset:16896
    s_waitcnt lgkmcnt(4)
    v_mfma_f32_16x16x32_bf16 v[10:13], v[24:27], v[168:171], v[10:13]
    ds_read_b64_tr_b16 v[24:25], v5 offset:20480
    ds_read_b64_tr_b16 v[26:27], v5 offset:20992
    s_waitcnt lgkmcnt(4)
    v_mfma_f32_16x16x32_bf16 v[10:13], v[14:17], v[172:175], v[10:13]
    ds_read_b64_tr_b16 v[14:15], v5 offset:24576
    ds_read_b64_tr_b16 v[16:17], v5 offset:25088
    s_waitcnt lgkmcnt(4)
    v_mfma_f32_16x16x32_bf16 v[10:13], v[20:23], v[176:179], v[10:13]
    ds_read_b64_tr_b16 v[20:21], v5 offset:28672
    ds_read_b64_tr_b16 v[22:23], v5 offset:29184
    s_waitcnt lgkmcnt(4)
    v_mfma_f32_16x16x32_bf16 v[10:13], v[24:27], v[180:183], v[10:13]
    s_waitcnt lgkmcnt(2)
    v_mfma_f32_16x16x32_bf16 v[10:13], v[14:17], v[184:187], v[10:13]
    s_waitcnt lgkmcnt(0)
    v_mfma_f32_16x16x32_bf16 v[10:13], v[20:23], v[188:191], v[10:13]
    s_nop 5
    s_mov_b32 exec_lo, 0x00030003
    s_mov_b32 exec_hi, 0x00030003
    buffer_store_dwordx4 v[10:13], v9, s[24:27], s36 offen sc1
    s_mov_b64 exec, -1
    s_nop 1
    s_branch L_recurrent_scan__compressed_kv_cla__moe_arch_mod__prompt_kernel_swend_67
L_recurrent_scan__compressed_kv_cla__moe_arch_mod__prompt_kernel_swn_71:
    s_mul_i32 s36, s3, 2341
    s_lshr_b32 s36, s36, 16
    s_add_u32 s36, s36, 48
    s_lshl_b32 s36, s36, 7
    v_mov_b32 v20, s36
    v_mov_b32 v21, 1
    s_mov_b64 exec, 1
    global_atomic_add v20, v21, s[90:91]
    s_mov_b64 exec, -1
    s_nop 3
L_recurrent_scan__compressed_kv_cla__moe_arch_mod__prompt_kernel_swend_67:
L_recurrent_scan__compressed_kv_cla__moe_arch_mod__prompt_kernel_swend_76:
    s_branch L_recurrent_scan__compressed_kv_cla__moe_arch_mod__prompt_kernel_back_81
L_recurrent_scan__compressed_kv_cla__moe_arch_mod__prompt_kernel_rare_92:
    v_mov_b32 v20, 4048155338
    s_cmp_gt_i32 s36, 0
    s_cbranch_scc1 L_recurrent_scan__compressed_kv_cla__moe_arch_mod__prompt_kernel_mf_90
    v_cmp_gt_i32 s[20:21], 0, v18
    v_cmp_gt_i32 s[22:23], 1, v18
    v_cmp_gt_i32 s[62:63], 2, v18
    v_cmp_gt_i32 vcc, 3, v18
    v_mov_b32 v116, v20
    v_mov_b32 v117, v20
    v_mov_b32 v118, v20
    v_mov_b32 v119, v20
    v_cndmask_b32 v112, v112, v20, s[20:21]
    v_cndmask_b32 v113, v113, v20, s[22:23]
    v_cndmask_b32 v114, v114, v20, s[62:63]
    v_cndmask_b32 v115, v115, v20, vcc
    v_cndmask_b32 v124, v124, v20, s[20:21]
    v_cndmask_b32 v125, v125, v20, s[22:23]
    v_cndmask_b32 v126, v126, v20, s[62:63]
    v_cndmask_b32 v127, v127, v20, vcc
    s_branch L_recurrent_scan__compressed_kv_cla__moe_arch_mod__prompt_kernel_me_91
L_recurrent_scan__compressed_kv_cla__moe_arch_mod__prompt_kernel_mf_90:
    v_mov_b32 v112, v20
    v_mov_b32 v113, v20
    v_mov_b32 v114, v20
    v_mov_b32 v115, v20
    v_mov_b32 v116, v20
    v_mov_b32 v117, v20
    v_mov_b32 v118, v20
    v_mov_b32 v119, v20
    v_mov_b32 v120, v20
    v_mov_b32 v121, v20
    v_mov_b32 v122, v20
    v_mov_b32 v123, v20
    v_mov_b32 v124, v20
    v_mov_b32 v125, v20
    v_mov_b32 v126, v20
    v_mov_b32 v127, v20
L_recurrent_scan__compressed_kv_cla__moe_arch_mod__prompt_kernel_me_91:
    s_branch L_recurrent_scan__compressed_kv_cla__moe_arch_mod__prompt_kernel_back_93
L_recurrent_scan__compressed_kv_cla__moe_arch_mod__prompt_kernel_rare_96:
    s_mov_b32 s61, 0x40000
L_recurrent_scan__compressed_kv_cla__moe_arch_mod__prompt_kernel_spin_94:
    s_sub_u32 s61, s61, 1
    s_cbranch_scc1 L_recurrent_scan__compressed_kv_cla__moe_arch_mod__prompt_kernel_spinx_95
    s_sleep 8
    global_load_dword v11, v12, s[90:91] sc1
    s_waitcnt vmcnt(0)
    v_readfirstlane_b32 s36, v11
    s_nop 0
    s_cmp_lt_u32 s36, 28
    s_cbranch_scc1 L_recurrent_scan__compressed_kv_cla__moe_arch_mod__prompt_kernel_spin_94
L_recurrent_scan__compressed_kv_cla__moe_arch_mod__prompt_kernel_spinx_95:
    s_branch L_recurrent_scan__compressed_kv_cla__moe_arch_mod__prompt_kernel_back_97
L_recurrent_scan__compressed_kv_cla__moe_arch_mod__prompt_kernel_rare_103:
    v_mov_b32 v20, 4048155338
    s_cmp_gt_i32 s50, 0
    s_cbranch_scc1 L_recurrent_scan__compressed_kv_cla__moe_arch_mod__prompt_kernel_mf_101
    v_cmp_gt_i32 s[20:21], 0, v18
    v_cmp_gt_i32 s[22:23], 1, v18
    v_cmp_gt_i32 s[62:63], 2, v18
    v_cmp_gt_i32 vcc, 3, v18
    v_mov_b32 v100, v20
    v_mov_b32 v101, v20
    v_mov_b32 v102, v20
    v_mov_b32 v103, v20
    v_cndmask_b32 v96, v96, v20, s[20:21]
    v_cndmask_b32 v97, v97, v20, s[22:23]
    v_cndmask_b32 v98, v98, v20, s[62:63]
    v_cndmask_b32 v99, v99, v20, vcc
    v_cndmask_b32 v108, v108, v20, s[20:21]
    v_cndmask_b32 v109, v109, v20, s[22:23]
    v_cndmask_b32 v110, v110, v20, s[62:63]
    v_cndmask_b32 v111, v111, v20, vcc
    s_branch L_recurrent_scan__compressed_kv_cla__moe_arch_mod__prompt_kernel_me_102
L_recurrent_scan__compressed_kv_cla__moe_arch_mod__prompt_kernel_mf_101:
    v_mov_b32 v96, v20
    v_mov_b32 v97, v20
    v_mov_b32 v98, v20
    v_mov_b32 v99, v20
    v_mov_b32 v100, v20
    v_mov_b32 v101, v20
    v_mov_b32 v102, v20
    v_mov_b32 v103, v20
    v_mov_b32 v104, v20
    v_mov_b32 v105, v20
    v_mov_b32 v106, v20
    v_mov_b32 v107, v20
    v_mov_b32 v108, v20
    v_mov_b32 v109, v20
    v_mov_b32 v110, v20
    v_mov_b32 v111, v20
L_recurrent_scan__compressed_kv_cla__moe_arch_mod__prompt_kernel_me_102:
    s_branch L_recurrent_scan__compressed_kv_cla__moe_arch_mod__prompt_kernel_back_104
L_grp1:
    v_mov_b32 v20, 1040356334
    v_mov_b32 v21, v20
    s_and_b32 s37, s28, 3
    s_lshl_b32 s37, s37, 13
    v_lshlrev_b32 v7, 4, v1
    v_add_u32 v4, s37, v7
    v_add_u32 v19, 131072, v4
    v_add_u32 v6, 4096, v4
    s_add_u32 s43, s37, 32768
    s_add_u32 s44, s37, 98304
    v_pk_mul_f32 v[192:193], v[192:193], v[20:21]
    v_pk_mul_f32 v[194:195], v[194:195], v[20:21]
    v_pk_mul_f32 v[196:197], v[196:197], v[20:21]
    v_pk_mul_f32 v[198:199], v[198:199], v[20:21]
    v_cvt_pk_bf16_f32 v128, v192, v193
    v_cvt_pk_bf16_f32 v129, v194, v195
    v_cvt_pk_bf16_f32 v130, v196, v197
    v_cvt_pk_bf16_f32 v131, v198, v199
    v_pk_mul_f32 v[200:201], v[200:201], v[20:21]
    v_pk_mul_f32 v[202:203], v[202:203], v[20:21]
    v_pk_mul_f32 v[204:205], v[204:205], v[20:21]
    v_pk_mul_f32 v[206:207], v[206:207], v[20:21]
    v_cvt_pk_bf16_f32 v132, v200, v201
    v_cvt_pk_bf16_f32 v133, v202, v203
    v_cvt_pk_bf16_f32 v134, v204, v205
    v_cvt_pk_bf16_f32 v135, v206, v207
    v_pk_mul_f32 v[208:209], v[208:209], v[20:21]
    v_pk_mul_f32 v[210:211], v[210:211], v[20:21]
    v_pk_mul_f32 v[212:213], v[212:213], v[20:21]
    v_pk_mul_f32 v[214:215], v[214:215], v[20:21]
    v_cvt_pk_bf16_f32 v136, v208, v209
    v_cvt_pk_bf16_f32 v137, v210, v211
    v_cvt_pk_bf16_f32 v138, v212, v213
    v_cvt_pk_bf16_f32 v139, v214, v215
    v_pk_mul_f32 v[216:217], v[216:217], v[20:21]
    v_pk_mul_f32 v[218:219], v[218:219], v[20:21]
    v_pk_mul_f32 v[220:221], v[220:221], v[20:21]
    v_pk_mul_f32 v[222:223], v[222:223], v[20:21]
    v_cvt_pk_bf16_f32 v140, v216, v217
    v_cvt_pk_bf16_f32 v141, v218, v219
    v_cvt_pk_bf16_f32 v142, v220, v221
    v_cvt_pk_bf16_f32 v143, v222, v223
    v_pk_mul_f32 v[224:225], v[224:225], v[20:21]
    v_pk_mul_f32 v[226:227], v[226:227], v[20:21]
    v_pk_mul_f32 v[228:229], v[228:229], v[20:21]
    v_pk_mul_f32 v[230:231], v[230:231], v[20:21]
    v_cvt_pk_bf16_f32 v144, v224, v225
    v_cvt_pk_bf16_f32 v145, v226, v227
    v_cvt_pk_bf16_f32 v146, v228, v229
    v_cvt_pk_bf16_f32 v147, v230, v231
    v_pk_mul_f32 v[232:233], v[232:233], v[20:21]
    v_pk_mul_f32 v[234:235], v[234:235], v[20:21]
    v_pk_mul_f32 v[236:237], v[236:237], v[20:21]
    v_pk_mul_f32 v[238:239], v[238:239], v[20:21]
    v_cvt_pk_bf16_f32 v148, v232, v233
    v_cvt_pk_bf16_f32 v149, v234, v235
    v_cvt_pk_bf16_f32 v150, v236, v237
    v_cvt_pk_bf16_f32 v151, v238, v239
    v_pk_mul_f32 v[240:241], v[240:241], v[20:21]
    v_pk_mul_f32 v[242:243], v[242:243], v[20:21]
    v_pk_mul_f32 v[244:245], v[244:245], v[20:21]
    v_pk_mul_f32 v[246:247], v[246:247], v[20:21]
    v_cvt_pk_bf16_f32 v152, v240, v241
    v_cvt_pk_bf16_f32 v153, v242, v243
    v_cvt_pk_bf16_f32 v154, v244, v245
    v_cvt_pk_bf16_f32 v155, v246, v247
    v_pk_mul_f32 v[248:249], v[248:249], v[20:21]
    v_pk_mul_f32 v[250:251], v[250:251], v[20:21]
    v_pk_mul_f32 v[252:253], v[252:253], v[20:21]
    v_pk_mul_f32 v[254:255], v[254:255], v[20:21]
    v_cvt_pk_bf16_f32 v156, v248, v249
    v_cvt_pk_bf16_f32 v157, v250, v251
    v_cvt_pk_bf16_f32 v158, v252, v253
    v_cvt_pk_bf16_f32 v159, v254, v255
    v_mov_b32 v2, v7
    v_and_b32 v21, 15, v1
    v_lshrrev_b32 v22, 4, v1
    v_lshlrev_b32 v22, 2, v22
    v_sub_u32 v18, v21, v22
    s_mov_b32 s40, 0
    s_mov_b32 s41, 16384
    s_mov_b32 s49, 0xffff
    s_lshl_b32 s51, s30, 1
    s_add_u32 s51, s51, 1
    s_and_b32 s50, s28, 3
    s_lshl_b32 s50, s50, 5
    s_lshl_b32 s42, 7, s51
    s_lshr_b32 s42, s42, 2
    s_or_b32 s42, s42, 0x8001
    s_mov_b64 s[52:53], 0
    s_waitcnt vmcnt(3) lgkmcnt(0)
    s_barrier
    ds_read_b128 v[64:67], v2 offset:0
    ds_read_b128 v[68:71], v2 offset:1024
    ds_read_b128 v[72:75], v2 offset:2048
    ds_read_b128 v[76:79], v2 offset:3072
    ds_read_b128 v[80:83], v2 offset:4096
    ds_read_b128 v[84:87], v2 offset:5120
    ds_read_b128 v[88:91], v2 offset:6144
    ds_read_b128 v[92:95], v2 offset:7168
    ds_read_b128 v[160:163], v19 offset:0
    ds_read_b128 v[164:167], v19 offset:1024
    ds_read_b128 v[168:171], v19 offset:2048
    ds_read_b128 v[172:175], v19 offset:3072
    ds_read_b128 v[176:179], v19 offset:4096
    ds_read_b128 v[180:183], v19 offset:5120
    ds_read_b128 v[184:187], v19 offset:6144
    ds_read_b128 v[188:191], v19 offset:7168
    v_mov_b32 v36, 0x3f803f80
    v_mov_b32 v37, 0x3f803f80
    v_mov_b32 v38, 0x3f803f80
    v_mov_b32 v39, 0x3f803f80
    s_add_u32 s16, s54, 41943040
    s_addc_u32 s17, s55, 0
    s_and_b32 s17, s17, 0xffff
    s_mov_b32 s18, 117440640
    s_mov_b32 s19, 0x20000
    s_cmp_eq_u32 s28, 4
    s_cbranch_scc1 L_recurrent_scan__compressed_kv_cla__moe_arch_mod__prompt_kernel_rare_143
L_recurrent_scan__compressed_kv_cla__moe_arch_mod__prompt_kernel_back_144:
    s_sub_u32 s36, s2, 160
    s_lshl_b32 s36, s36, 1
    s_and_b32 s37, s28, 1
    s_add_u32 s36, s36, s37
    s_min_u32 s36, s36, 1024
    s_mul_i32 s36, s36, 43776
    s_cmp_lt_u32 s28, 6
    s_cselect_b64 s[4:5], s[32:33], s[34:35]
    s_cselect_b32 s37, 32, 28
    s_lshl_b32 s37, s37, 18
    s_min_u32 s36, s36, s37
    s_sub_u32 s6, s37, s36
    s_min_u32 s6, s6, 43776
    s_add_u32 s4, s4, s36
    s_addc_u32 s5, s5, 0
    s_and_b32 s5, s5, 0xffff
    s_mov_b32 s7, 0x20000
    v_cmp_gt_u32 vcc, 32, v1
    v_lshlrev_b32 v13, 7, v1
    v_mov_b32 v12, 0x100000
    v_cndmask_b32 v13, v12, v13, vcc
    s_mov_b32 s48, 0
    s_cmp_eq_u32 s28, 5
    s_cselect_b32 s36, 0x1000, 0
    s_or_b32 s42, s42, s36
    s_waitcnt lgkmcnt(15)
    v_mfma_f32_16x16x32_bf16 v[96:99], v[64:67], v[128:131], 0
    v_mov_b64 v[192:193], 0
    v_mov_b64 v[194:195], 0
    v_mfma_f32_16x16x32_bf16 v[104:107], v[64:67], v[144:147], 0
    ds_read_b128 v[64:67], v2 offset:8192
    v_mov_b64 v[196:197], 0
    v_mov_b64 v[198:199], 0
    s_waitcnt lgkmcnt(15)
    v_mfma_f32_16x16x32_bf16 v[96:99], v[68:71], v[132:135], v[96:99]
    v_mov_b64 v[200:201], 0
    v_mov_b64 v[202:203], 0
    v_mfma_f32_16x16x32_bf16 v[104:107], v[68:71], v[148:151], v[104:107]
    ds_read_b128 v[68:71], v2 offset:9216
    v_mov_b64 v[204:205], 0
    v_mov_b64 v[206:207], 0
    s_waitcnt lgkmcnt(15)
    v_mfma_f32_16x16x32_bf16 v[96:99], v[72:75], v[136:139], v[96:99]
    v_mov_b64 v[208:209], 0
    v_mfma_f32_16x16x32_bf16 v[104:107], v[72:75], v[152:155], v[104:107]
    ds_read_b128 v[72:75], v2 offset:10240
    v_mov_b64 v[210:211], 0
    v_mov_b64 v[212:213], 0
    s_waitcnt lgkmcnt(15)
    v_mfma_f32_16x16x32_bf16 v[96:99], v[76:79], v[140:143], v[96:99]
    v_mov_b64 v[214:215], 0
    v_mov_b64 v[216:217], 0
    v_mfma_f32_16x16x32_bf16 v[104:107], v[76:79], v[156:159], v[104:107]
    ds_read_b128 v[76:79], v2 offset:11264
    v_mov_b64 v[218:219], 0
    v_mov_b64 v[220:221], 0
    s_waitcnt lgkmcnt(15)
    v_mfma_f32_16x16x32_bf16 v[100:103], v[80:83], v[128:131], 0
    v_mov_b64 v[222:223], 0
    v_mov_b64 v[224:225], 0
    v_mfma_f32_16x16x32_bf16 v[108:111], v[80:83], v[144:147], 0
    ds_read_b128 v[80:83], v2 offset:12288
    v_mov_b64 v[226:227], 0
    s_waitcnt lgkmcnt(15)
    v_mfma_f32_16x16x32_bf16 v[100:103], v[84:87], v[132:135], v[100:103]
    v_mov_b64 v[228:229], 0
    v_mov_b64 v[230:231], 0
    v_mfma_f32_16x16x32_bf16 v[108:111], v[84:87], v[148:151], v[108:111]
    ds_read_b128 v[84:87], v2 offset:13312
    v_mov_b64 v[232:233], 0
    v_mov_b64 v[234:235], 0
    s_waitcnt lgkmcnt(15)
    v_mfma_f32_16x16x32_bf16 v[100:103], v[88:91], v[136:139], v[100:103]
    v_mov_b64 v[236:237], 0
    v_mov_b64 v[238:239], 0
    v_mfma_f32_16x16x32_bf16 v[108:111], v[88:91], v[152:155], v[108:111]
    ds_read_b128 v[88:91], v2 offset:14336
    v_mov_b64 v[240:241], 0
    v_mov_b64 v[242:243], 0
    s_waitcnt lgkmcnt(15)
    v_mfma_f32_16x16x32_bf16 v[100:103], v[92:95], v[140:143], v[100:103]
    v_mov_b64 v[244:245], 0
    v_mfma_f32_16x16x32_bf16 v[108:111], v[92:95], v[156:159], v[108:111]
    ds_read_b128 v[92:95], v2 offset:15360
    v_mov_b64 v[246:247], 0
    v_mov_b64 v[248:249], 0
    s_waitcnt lgkmcnt(7)
    v_mfma_f32_16x16x32_bf16 v[112:115], v[64:67], v[128:131], 0
    v_mov_b64 v[250:251], 0
    v_mov_b64 v[252:253], 0
    v_mfma_f32_16x16x32_bf16 v[120:123], v[64:67], v[144:147], 0
    v_mov_b64 v[254:255], 0
    v_mov_b64 v[28:29], 0
    s_waitcnt lgkmcnt(6)
    v_mfma_f32_16x16x32_bf16 v[112:115], v[68:71], v[132:135], v[112:115]
    v_mov_b64 v[30:31], 0
    v_mov_b64 v[32:33], 0
    v_mfma_f32_16x16x32_bf16 v[120:123], v[68:71], v[148:151], v[120:123]
    v_mov_b64 v[34:35], 0
    s_waitcnt lgkmcnt(5)
    v_mfma_f32_16x16x32_bf16 v[112:115], v[72:75], v[136:139], v[112:115]
    s_add_u32 s36, s30, s50
    s_cmp_eq_u32 s36, 0
    s_cbranch_scc1 L_recurrent_scan__compressed_kv_cla__moe_arch_mod__prompt_kernel_rare_108
L_recurrent_scan__compressed_kv_cla__moe_arch_mod__prompt_kernel_back_109:
    v_mfma_f32_16x16x32_bf16 v[120:123], v[72:75], v[152:155], v[120:123]
    v_max3_f32 v22, v96, v97, v98
    v_max3_f32 v23, v104, v105, v106
    s_waitcnt lgkmcnt(4)
    v_mfma_f32_16x16x32_bf16 v[112:115], v[76:79], v[140:143], v[112:115]
    v_max3_f32 v22, v22, v99, v100
    v_max3_f32 v23, v23, v107, v108
    v_mfma_f32_16x16x32_bf16 v[120:123], v[76:79], v[156:159], v[120:123]
    v_max3_f32 v22, v22, v101, v102
    v_max3_f32 v23, v23, v109, v110
    s_waitcnt lgkmcnt(3)
    v_mfma_f32_16x16x32_bf16 v[116:119], v[80:83], v[128:131], 0
    v_max_f32 v22, v22, v103
    v_max_f32 v23, v23, v111
    v_mfma_f32_16x16x32_bf16 v[124:127], v[80:83], v[144:147], 0
    v_mov_b32 v24, v22
    v_mov_b32 v25, v23
    s_waitcnt lgkmcnt(2)
    v_mfma_f32_16x16x32_bf16 v[116:119], v[84:87], v[132:135], v[116:119]
    v_permlane16_swap_b32 v22, v24
    v_permlane16_swap_b32 v23, v25
    v_mfma_f32_16x16x32_bf16 v[124:127], v[84:87], v[148:151], v[124:127]
    v_max_f32 v22, v22, v24
    v_max_f32 v23, v23, v25
    s_waitcnt lgkmcnt(1)
    v_mfma_f32_16x16x32_bf16 v[116:119], v[88:91], v[136:139], v[116:119]
    v_mov_b32 v24, v22
    v_mov_b32 v25, v23
    v_mfma_f32_16x16x32_bf16 v[124:127], v[88:91], v[152:155], v[124:127]
    v_permlane32_swap_b32 v22, v24
    v_permlane32_swap_b32 v23, v25
    s_waitcnt lgkmcnt(0)
    v_mfma_f32_16x16x32_bf16 v[116:119], v[92:95], v[140:143], v[116:119]
    v_max_f32 v22, v22, v24
    v_max_f32 v23, v23, v25
    v_mfma_f32_16x16x32_bf16 v[124:127], v[92:95], v[156:159], v[124:127]
    v_sub_f32 v40, 0, v22
    v_sub_f32 v41, 0, v22
    v_sub_f32 v42, 0, v22
    v_sub_f32 v43, 0, v22
    v_sub_f32 v44, 0, v23
    v_sub_f32 v45, 0, v23
    v_sub_f32 v46, 0, v23
    v_sub_f32 v47, 0, v23
    v_add_u32 v3, 65536, v2
    v_add_u32 v2, s41, v2
    v_and_b32 v2, s49, v2
    s_waitcnt vmcnt(1)
    s_cmp_eq_u32 s28, 4
    s_cbranch_scc1 L_recurrent_scan__compressed_kv_cla__moe_arch_mod__prompt_kernel_pw_110
    s_waitcnt vmcnt(0)
L_recurrent_scan__compressed_kv_cla__moe_arch_mod__prompt_kernel_pw_110:
    s_barrier
    ds_read_b128 v[64:67], v2 offset:0
    ds_read_b128 v[68:71], v2 offset:1024
    ds_read_b128 v[72:75], v2 offset:2048
    ds_read_b128 v[76:79], v2 offset:3072
    ds_read_b128 v[80:83], v2 offset:4096
    ds_read_b128 v[84:87], v2 offset:5120
    ds_read_b128 v[88:91], v2 offset:6144
    v_pk_add_f32 v[96:97], v[96:97], v[40:41]
    v_pk_add_f32 v[98:99], v[98:99], v[40:41]
    v_pk_add_f32 v[100:101], v[100:101], v[40:41]
    v_pk_add_f32 v[102:103], v[102:103], v[40:41]
    v_pk_add_f32 v[104:105], v[104:105], v[44:45]
    v_pk_add_f32 v[106:107], v[106:107], v[44:45]
    v_pk_add_f32 v[108:109], v[108:109], v[44:45]
    v_pk_add_f32 v[110:111], v[110:111], v[44:45]
    v_pk_add_f32 v[112:113], v[112:113], v[40:41]
    v_pk_add_f32 v[114:115], v[114:115], v[40:41]
    v_pk_add_f32 v[116:117], v[116:117], v[40:41]
    v_pk_add_f32 v[118:119], v[118:119], v[40:41]
    v_pk_add_f32 v[120:121], v[120:121], v[44:45]
    v_pk_add_f32 v[122:123], v[122:123], v[44:45]
    v_pk_add_f32 v[124:125], v[124:125], v[44:45]
    v_pk_add_f32 v[126:127], v[126:127], v[44:45]
    v_exp_f32 v96, v96
    v_exp_f32 v97, v97
    v_exp_f32 v98, v98
    v_exp_f32 v99, v99
    v_exp_f32 v104, v104
    v_exp_f32 v105, v105
    v_exp_f32 v106, v106
    v_exp_f32 v107, v107
    v_exp_f32 v100, v100
    v_exp_f32 v101, v101
    v_exp_f32 v102, v102
    v_exp_f32 v103, v103
    v_exp_f32 v108, v108
    v_exp_f32 v109, v109
    v_exp_f32 v110, v110
    v_exp_f32 v111, v111
    v_cvt_pk_bf16_f32 v48, v96, v97
    v_cvt_pk_bf16_f32 v49, v98, v99
    v_cvt_pk_bf16_f32 v52, v104, v105
    v_cvt_pk_bf16_f32 v53, v106, v107
    v_cvt_pk_bf16_f32 v50, v100, v101
    v_cvt_pk_bf16_f32 v51, v102, v103
    v_cvt_pk_bf16_f32 v54, v108, v109
    v_cvt_pk_bf16_f32 v55, v110, v111
    .p2align 6
L_body10:
    s_bitcmp1_b32 s42, s40
    s_cbranch_scc1 L_recurrent_scan__compressed_kv_cla__moe_arch_mod__prompt_kernel_rare_117
L_recurrent_scan__compressed_kv_cla__moe_arch_mod__prompt_kernel_back_118:
    s_waitcnt lgkmcnt(5)
    v_mfma_f32_16x16x32_bf16 v[96:99], v[64:67], v[128:131], v[40:43]
    v_exp_f32 v112, v112
    v_mfma_f32_16x16x32_bf16 v[104:107], v[64:67], v[144:147], v[44:47]
    ds_read_b128 v[92:95], v2 offset:7168
    v_mfma_f32_16x16x32_bf16 v[96:99], v[68:71], v[132:135], v[96:99]
    v_exp_f32 v113, v113
    v_mfma_f32_16x16x32_bf16 v[104:107], v[68:71], v[148:151], v[104:107]
    ds_read_b128 v[64:67], v3 offset:0
    s_waitcnt lgkmcnt(5)
    v_mfma_f32_16x16x32_bf16 v[96:99], v[72:75], v[136:139], v[96:99]
    v_exp_f32 v114, v114
    v_mfma_f32_16x16x32_bf16 v[104:107], v[72:75], v[152:155], v[104:107]
    ds_read_b128 v[68:71], v3 offset:1024
    v_cvt_pk_bf16_f32 v56, v112, v113
    v_mfma_f32_16x16x32_bf16 v[96:99], v[76:79], v[140:143], v[96:99]
    v_exp_f32 v115, v115
    v_mfma_f32_16x16x32_bf16 v[104:107], v[76:79], v[156:159], v[104:107]
    ds_read_b128 v[72:75], v3 offset:2048
    s_waitcnt lgkmcnt(5)
    v_mfma_f32_16x16x32_bf16 v[100:103], v[80:83], v[128:131], v[40:43]
    v_exp_f32 v120, v120
    v_mfma_f32_16x16x32_bf16 v[108:111], v[80:83], v[144:147], v[44:47]
    ds_read_b128 v[76:79], v3 offset:3072
    v_cvt_pk_bf16_f32 v57, v114, v115
    v_mfma_f32_16x16x32_bf16 v[100:103], v[84:87], v[132:135], v[100:103]
    v_exp_f32 v121, v121
    v_mfma_f32_16x16x32_bf16 v[108:111], v[84:87], v[148:151], v[108:111]
    ds_read_b128 v[80:83], v3 offset:4096
    s_waitcnt lgkmcnt(5)
    v_mfma_f32_16x16x32_bf16 v[100:103], v[88:91], v[136:139], v[100:103]
    v_exp_f32 v122, v122
    v_mfma_f32_16x16x32_bf16 v[108:111], v[88:91], v[152:155], v[108:111]
    ds_read_b128 v[84:87], v3 offset:5120
    v_cvt_pk_bf16_f32 v60, v120, v121
    v_mfma_f32_16x16x32_bf16 v[100:103], v[92:95], v[140:143], v[100:103]
    v_exp_f32 v123, v123
    v_mfma_f32_16x16x32_bf16 v[108:111], v[92:95], v[156:159], v[108:111]
    ds_read_b128 v[88:91], v3 offset:6144
    s_waitcnt lgkmcnt(5)
    v_mfma_f32_16x16x32_bf16 v[192:195], v[64:67], v[48:51], v[192:195]
    v_exp_f32 v116, v116
    v_mfma_f32_16x16x32_bf16 v[224:227], v[64:67], v[52:55], v[224:227]
    ds_read_b128 v[92:95], v3 offset:7168
    v_cvt_pk_bf16_f32 v61, v122, v123
    v_mfma_f32_16x16x32_bf16 v[196:199], v[68:71], v[48:51], v[196:199]
    v_exp_f32 v117, v117
    v_mfma_f32_16x16x32_bf16 v[228:231], v[68:71], v[52:55], v[228:231]
    ds_read_b128 v[64:67], v2 offset:8192
    s_waitcnt lgkmcnt(5)
    v_mfma_f32_16x16x32_bf16 v[200:203], v[72:75], v[48:51], v[200:203]
    v_exp_f32 v118, v118
    v_mfma_f32_16x16x32_bf16 v[232:235], v[72:75], v[52:55], v[232:235]
    v_mfma_f32_16x16x32_bf16 v[28:31], v[36:39], v[48:51], v[28:31]
    ds_read_b128 v[68:71], v2 offset:9216
    v_cvt_pk_bf16_f32 v58, v116, v117
    v_mfma_f32_16x16x32_bf16 v[204:207], v[76:79], v[48:51], v[204:207]
    v_exp_f32 v119, v119
    v_mfma_f32_16x16x32_bf16 v[236:239], v[76:79], v[52:55], v[236:239]
    ds_read_b128 v[72:75], v2 offset:10240
    s_waitcnt lgkmcnt(5)
    v_mfma_f32_16x16x32_bf16 v[208:211], v[80:83], v[48:51], v[208:211]
    v_exp_f32 v124, v124
    buffer_load_dword v0, v13, s[4:7], s48 offen
    s_add_u32 s48, s48, 4096
    v_mfma_f32_16x16x32_bf16 v[240:243], v[80:83], v[52:55], v[240:243]
    ds_read_b128 v[76:79], v2 offset:11264
    v_cvt_pk_bf16_f32 v59, v118, v119
    v_mfma_f32_16x16x32_bf16 v[212:215], v[84:87], v[48:51], v[212:215]
    v_exp_f32 v125, v125
    v_mfma_f32_16x16x32_bf16 v[244:247], v[84:87], v[52:55], v[244:247]
    ds_read_b128 v[80:83], v2 offset:12288
    s_waitcnt lgkmcnt(5)
    v_mfma_f32_16x16x32_bf16 v[216:219], v[88:91], v[48:51], v[216:219]
    v_exp_f32 v126, v126
    v_mfma_f32_16x16x32_bf16 v[248:251], v[88:91], v[52:55], v[248:251]
    v_mfma_f32_16x16x32_bf16 v[32:35], v[36:39], v[52:55], v[32:35]
    ds_read_b128 v[84:87], v2 offset:13312
    v_cvt_pk_bf16_f32 v62, v124, v125
    v_mfma_f32_16x16x32_bf16 v[220:223], v[92:95], v[48:51], v[220:223]
    v_exp_f32 v127, v127
    v_mfma_f32_16x16x32_bf16 v[252:255], v[92:95], v[52:55], v[252:255]
    ds_read_b128 v[88:91], v2 offset:14336
    v_cvt_pk_bf16_f32 v63, v126, v127
    s_bitcmp1_b32 s42, s40
    s_cbranch_scc1 L_recurrent_scan__compressed_kv_cla__moe_arch_mod__prompt_kernel_rare_122
L_recurrent_scan__compressed_kv_cla__moe_arch_mod__prompt_kernel_back_123:
    s_waitcnt lgkmcnt(5)
    v_mfma_f32_16x16x32_bf16 v[112:115], v[64:67], v[128:131], v[40:43]
    v_exp_f32 v96, v96
    v_mfma_f32_16x16x32_bf16 v[120:123], v[64:67], v[144:147], v[44:47]
    ds_read_b128 v[92:95], v2 offset:15360
    v_mfma_f32_16x16x32_bf16 v[112:115], v[68:71], v[132:135], v[112:115]
    v_exp_f32 v97, v97
    v_mfma_f32_16x16x32_bf16 v[120:123], v[68:71], v[148:151], v[120:123]
    ds_read_b128 v[64:67], v3 offset:8192
    s_waitcnt lgkmcnt(5)
    v_mfma_f32_16x16x32_bf16 v[112:115], v[72:75], v[136:139], v[112:115]
    v_exp_f32 v98, v98
    v_mfma_f32_16x16x32_bf16 v[120:123], v[72:75], v[152:155], v[120:123]
    ds_read_b128 v[68:71], v3 offset:9216
    v_cvt_pk_bf16_f32 v48, v96, v97
    v_mfma_f32_16x16x32_bf16 v[112:115], v[76:79], v[140:143], v[112:115]
    v_exp_f32 v99, v99
    v_mfma_f32_16x16x32_bf16 v[120:123], v[76:79], v[156:159], v[120:123]
    ds_read_b128 v[72:75], v3 offset:10240
    s_waitcnt lgkmcnt(5)
    v_mfma_f32_16x16x32_bf16 v[116:119], v[80:83], v[128:131], v[40:43]
    v_exp_f32 v104, v104
    v_mfma_f32_16x16x32_bf16 v[124:127], v[80:83], v[144:147], v[44:47]
    ds_read_b128 v[76:79], v3 offset:11264
    v_cvt_pk_bf16_f32 v49, v98, v99
    v_mfma_f32_16x16x32_bf16 v[116:119], v[84:87], v[132:135], v[116:119]
    v_exp_f32 v105, v105
    v_mfma_f32_16x16x32_bf16 v[124:127], v[84:87], v[148:151], v[124:127]
    ds_read_b128 v[80:83], v3 offset:12288
    s_waitcnt lgkmcnt(5)
    v_mfma_f32_16x16x32_bf16 v[116:119], v[88:91], v[136:139], v[116:119]
    v_exp_f32 v106, v106
    v_mfma_f32_16x16x32_bf16 v[124:127], v[88:91], v[152:155], v[124:127]
    ds_read_b128 v[84:87], v3 offset:13312
    v_cvt_pk_bf16_f32 v52, v104, v105
    v_mfma_f32_16x16x32_bf16 v[116:119], v[92:95], v[140:143], v[116:119]
    v_exp_f32 v107, v107
    v_mfma_f32_16x16x32_bf16 v[124:127], v[92:95], v[156:159], v[124:127]
    ds_read_b128 v[88:91], v3 offset:14336
    s_waitcnt lgkmcnt(5)
    v_mfma_f32_16x16x32_bf16 v[192:195], v[64:67], v[56:59], v[192:195]
    v_exp_f32 v100, v100
    v_mfma_f32_16x16x32_bf16 v[224:227], v[64:67], v[60:63], v[224:227]
    ds_read_b128 v[92:95], v3 offset:15360
    v_cvt_pk_bf16_f32 v53, v106, v107
    v_mfma_f32_16x16x32_bf16 v[196:199], v[68:71], v[56:59], v[196:199]
    v_exp_f32 v101, v101
    v_mfma_f32_16x16x32_bf16 v[228:231], v[68:71], v[60:63], v[228:231]
    v_add_u32 v3, 65536, v2
    v_add_u32 v2, s41, v2
    s_waitcnt lgkmcnt(4)
    v_mfma_f32_16x16x32_bf16 v[200:203], v[72:75], v[56:59], v[200:203]
    v_exp_f32 v102, v102
    v_and_b32 v2, s49, v2
    v_mfma_f32_16x16x32_bf16 v[232:235], v[72:75], v[60:63], v[232:235]
    v_mfma_f32_16x16x32_bf16 v[28:31], v[36:39], v[56:59], v[28:31]
    v_cvt_pk_bf16_f32 v50, v100, v101
    s_waitcnt lgkmcnt(0)
    s_barrier
    v_mfma_f32_16x16x32_bf16 v[204:207], v[76:79], v[56:59], v[204:207]
    v_exp_f32 v103, v103
    v_mfma_f32_16x16x32_bf16 v[236:239], v[76:79], v[60:63], v[236:239]
    ds_read_b128 v[68:71], v2 offset:1024
    ds_read_b128 v[64:67], v2 offset:0
    v_mfma_f32_16x16x32_bf16 v[208:211], v[80:83], v[56:59], v[208:211]
    v_exp_f32 v108, v108
    v_mfma_f32_16x16x32_bf16 v[240:243], v[80:83], v[60:63], v[240:243]
    ds_read_b128 v[76:79], v2 offset:3072
    ds_read_b128 v[72:75], v2 offset:2048
    v_cvt_pk_bf16_f32 v51, v102, v103
    v_mfma_f32_16x16x32_bf16 v[212:215], v[84:87], v[56:59], v[212:215]
    v_exp_f32 v109, v109
    v_mfma_f32_16x16x32_bf16 v[244:247], v[84:87], v[60:63], v[244:247]
    ds_read_b128 v[80:83], v2 offset:4096
    v_mfma_f32_16x16x32_bf16 v[216:219], v[88:91], v[56:59], v[216:219]
    v_exp_f32 v110, v110
    v_mfma_f32_16x16x32_bf16 v[248:251], v[88:91], v[60:63], v[248:251]
    v_mfma_f32_16x16x32_bf16 v[32:35], v[36:39], v[60:63], v[32:35]
    ds_read_b128 v[84:87], v2 offset:5120
    v_cvt_pk_bf16_f32 v54, v108, v109
    v_mfma_f32_16x16x32_bf16 v[220:223], v[92:95], v[56:59], v[220:223]
    v_exp_f32 v111, v111
    v_mfma_f32_16x16x32_bf16 v[252:255], v[92:95], v[60:63], v[252:255]
    ds_read_b128 v[88:91], v2 offset:6144
    v_cvt_pk_bf16_f32 v55, v110, v111
    s_bitcmp1_b32 s42, s40
    s_cbranch_scc1 L_recurrent_scan__compressed_kv_cla__moe_arch_mod__prompt_kernel_rare_150
L_recurrent_scan__compressed_kv_cla__moe_arch_mod__prompt_kernel_back_151:
    s_add_u32 s40, s40, 1
    s_cmp_lg_u32 s40, s51
    s_cbranch_scc1 L_body10
    v_mov_b32 v40, v14
    v_mov_b32 v41, v14
    v_mov_b32 v42, v14
    v_mov_b32 v43, v14
    v_mov_b32 v44, v15
    v_mov_b32 v45, v15
    v_mov_b32 v46, v15
    v_mov_b32 v47, v15
    s_nop 1
    .p2align 6
L_body11:
    s_bitcmp1_b32 s42, s40
    s_cbranch_scc1 L_recurrent_scan__compressed_kv_cla__moe_arch_mod__prompt_kernel_rare_135
L_recurrent_scan__compressed_kv_cla__moe_arch_mod__prompt_kernel_back_136:
    s_waitcnt lgkmcnt(5)
    v_mfma_f32_16x16x32_bf16 v[96:99], v[64:67], v[160:163], v[40:43]
    v_exp_f32 v112, v112
    v_mfma_f32_16x16x32_bf16 v[104:107], v[64:67], v[176:179], v[44:47]
    ds_read_b128 v[92:95], v2 offset:7168
    v_mfma_f32_16x16x32_bf16 v[96:99], v[68:71], v[164:167], v[96:99]
    v_exp_f32 v113, v113
    v_mfma_f32_16x16x32_bf16 v[104:107], v[68:71], v[180:183], v[104:107]
    ds_read_b128 v[64:67], v3 offset:0
    s_waitcnt lgkmcnt(5)
    v_mfma_f32_16x16x32_bf16 v[96:99], v[72:75], v[168:171], v[96:99]
    v_exp_f32 v114, v114
    v_mfma_f32_16x16x32_bf16 v[104:107], v[72:75], v[184:187], v[104:107]
    ds_read_b128 v[68:71], v3 offset:1024
    v_cvt_pk_bf16_f32 v56, v112, v113
    v_mfma_f32_16x16x32_bf16 v[96:99], v[76:79], v[172:175], v[96:99]
    v_exp_f32 v115, v115
    v_mfma_f32_16x16x32_bf16 v[104:107], v[76:79], v[188:191], v[104:107]
    ds_read_b128 v[72:75], v3 offset:2048
    s_waitcnt lgkmcnt(5)
    v_mfma_f32_16x16x32_bf16 v[100:103], v[80:83], v[160:163], v[40:43]
    v_exp_f32 v120, v120
    v_mfma_f32_16x16x32_bf16 v[108:111], v[80:83], v[176:179], v[44:47]
    ds_read_b128 v[76:79], v3 offset:3072
    v_cvt_pk_bf16_f32 v57, v114, v115
    v_mfma_f32_16x16x32_bf16 v[100:103], v[84:87], v[164:167], v[100:103]
    v_exp_f32 v121, v121
    v_mfma_f32_16x16x32_bf16 v[108:111], v[84:87], v[180:183], v[108:111]
    ds_read_b128 v[80:83], v3 offset:4096
    s_waitcnt lgkmcnt(5)
    v_mfma_f32_16x16x32_bf16 v[100:103], v[88:91], v[168:171], v[100:103]
    v_exp_f32 v122, v122
    v_mfma_f32_16x16x32_bf16 v[108:111], v[88:91], v[184:187], v[108:111]
    ds_read_b128 v[84:87], v3 offset:5120
    v_cvt_pk_bf16_f32 v60, v120, v121
    v_mfma_f32_16x16x32_bf16 v[100:103], v[92:95], v[172:175], v[100:103]
    v_exp_f32 v123, v123
    v_mfma_f32_16x16x32_bf16 v[108:111], v[92:95], v[188:191], v[108:111]
    ds_read_b128 v[88:91], v3 offset:6144
    s_waitcnt lgkmcnt(5)
    v_mfma_f32_16x16x32_bf16 v[192:195], v[64:67], v[48:51], v[192:195]
    v_exp_f32 v116, v116
    v_mfma_f32_16x16x32_bf16 v[224:227], v[64:67], v[52:55], v[224:227]
    ds_read_b128 v[92:95], v3 offset:7168
    v_cvt_pk_bf16_f32 v61, v122, v123
    v_mfma_f32_16x16x32_bf16 v[196:199], v[68:71], v[48:51], v[196:199]
    v_exp_f32 v117, v117
    v_mfma_f32_16x16x32_bf16 v[228:231], v[68:71], v[52:55], v[228:231]
    ds_read_b128 v[64:67], v2 offset:8192
    s_waitcnt lgkmcnt(5)
    v_mfma_f32_16x16x32_bf16 v[200:203], v[72:75], v[48:51], v[200:203]
    v_exp_f32 v118, v118
    v_mfma_f32_16x16x32_bf16 v[232:235], v[72:75], v[52:55], v[232:235]
    v_mfma_f32_16x16x32_bf16 v[28:31], v[36:39], v[48:51], v[28:31]
    ds_read_b128 v[68:71], v2 offset:9216
    v_cvt_pk_bf16_f32 v58, v116, v117
    v_mfma_f32_16x16x32_bf16 v[204:207], v[76:79], v[48:51], v[204:207]
    v_exp_f32 v119, v119
    v_mfma_f32_16x16x32_bf16 v[236:239], v[76:79], v[52:55], v[236:239]
    ds_read_b128 v[72:75], v2 offset:10240
    s_waitcnt lgkmcnt(5)
    v_mfma_f32_16x16x32_bf16 v[208:211], v[80:83], v[48:51], v[208:211]
    v_exp_f32 v124, v124
    buffer_load_dword v0, v13, s[4:7], s48 offen
    s_add_u32 s48, s48, 4096
    v_mfma_f32_16x16x32_bf16 v[240:243], v[80:83], v[52:55], v[240:243]
    ds_read_b128 v[76:79], v2 offset:11264
    v_cvt_pk_bf16_f32 v59, v118, v119
    v_mfma_f32_16x16x32_bf16 v[212:215], v[84:87], v[48:51], v[212:215]
    v_exp_f32 v125, v125
    v_mfma_f32_16x16x32_bf16 v[244:247], v[84:87], v[52:55], v[244:247]
    ds_read_b128 v[80:83], v2 offset:12288
    s_waitcnt lgkmcnt(5)
    v_mfma_f32_16x16x32_bf16 v[216:219], v[88:91], v[48:51], v[216:219]
    v_exp_f32 v126, v126
    v_mfma_f32_16x16x32_bf16 v[248:251], v[88:91], v[52:55], v[248:251]
    v_mfma_f32_16x16x32_bf16 v[32:35], v[36:39], v[52:55], v[32:35]
    ds_read_b128 v[84:87], v2 offset:13312
    v_cvt_pk_bf16_f32 v62, v124, v125
    v_mfma_f32_16x16x32_bf16 v[220:223], v[92:95], v[48:51], v[220:223]
    v_exp_f32 v127, v127
    v_mfma_f32_16x16x32_bf16 v[252:255], v[92:95], v[52:55], v[252:255]
    ds_read_b128 v[88:91], v2 offset:14336
    v_cvt_pk_bf16_f32 v63, v126, v127
    s_bitcmp1_b32 s42, s40
    s_cbranch_scc1 L_recurrent_scan__compressed_kv_cla__moe_arch_mod__prompt_kernel_rare_140
L_recurrent_scan__compressed_kv_cla__moe_arch_mod__prompt_kernel_back_141:
    s_waitcnt lgkmcnt(5)
    v_mfma_f32_16x16x32_bf16 v[112:115], v[64:67], v[160:163], v[40:43]
    v_exp_f32 v96, v96
    v_mfma_f32_16x16x32_bf16 v[120:123], v[64:67], v[176:179], v[44:47]
    ds_read_b128 v[92:95], v2 offset:15360
    v_mfma_f32_16x16x32_bf16 v[112:115], v[68:71], v[164:167], v[112:115]
    v_exp_f32 v97, v97
    v_mfma_f32_16x16x32_bf16 v[120:123], v[68:71], v[180:183], v[120:123]
    ds_read_b128 v[64:67], v3 offset:8192
    s_waitcnt lgkmcnt(5)
    v_mfma_f32_16x16x32_bf16 v[112:115], v[72:75], v[168:171], v[112:115]
    v_exp_f32 v98, v98
    v_mfma_f32_16x16x32_bf16 v[120:123], v[72:75], v[184:187], v[120:123]
    ds_read_b128 v[68:71], v3 offset:9216
    v_cvt_pk_bf16_f32 v48, v96, v97
    v_mfma_f32_16x16x32_bf16 v[112:115], v[76:79], v[172:175], v[112:115]
    v_exp_f32 v99, v99
    v_mfma_f32_16x16x32_bf16 v[120:123], v[76:79], v[188:191], v[120:123]
    ds_read_b128 v[72:75], v3 offset:10240
    s_waitcnt lgkmcnt(5)
    v_mfma_f32_16x16x32_bf16 v[116:119], v[80:83], v[160:163], v[40:43]
    v_exp_f32 v104, v104
    v_mfma_f32_16x16x32_bf16 v[124:127], v[80:83], v[176:179], v[44:47]
    ds_read_b128 v[76:79], v3 offset:11264
    v_cvt_pk_bf16_f32 v49, v98, v99
    v_mfma_f32_16x16x32_bf16 v[116:119], v[84:87], v[164:167], v[116:119]
    v_exp_f32 v105, v105
    v_mfma_f32_16x16x32_bf16 v[124:127], v[84:87], v[180:183], v[124:127]
    ds_read_b128 v[80:83], v3 offset:12288
    s_waitcnt lgkmcnt(5)
    v_mfma_f32_16x16x32_bf16 v[116:119], v[88:91], v[168:171], v[116:119]
    v_exp_f32 v106, v106
    v_mfma_f32_16x16x32_bf16 v[124:127], v[88:91], v[184:187], v[124:127]
    ds_read_b128 v[84:87], v3 offset:13312
    v_cvt_pk_bf16_f32 v52, v104, v105
    v_mfma_f32_16x16x32_bf16 v[116:119], v[92:95], v[172:175], v[116:119]
    v_exp_f32 v107, v107
    v_mfma_f32_16x16x32_bf16 v[124:127], v[92:95], v[188:191], v[124:127]
    ds_read_b128 v[88:91], v3 offset:14336
    s_waitcnt lgkmcnt(5)
    v_mfma_f32_16x16x32_bf16 v[192:195], v[64:67], v[56:59], v[192:195]
    v_exp_f32 v100, v100
    v_mfma_f32_16x16x32_bf16 v[224:227], v[64:67], v[60:63], v[224:227]
    ds_read_b128 v[92:95], v3 offset:15360
    v_cvt_pk_bf16_f32 v53, v106, v107
    v_mfma_f32_16x16x32_bf16 v[196:199], v[68:71], v[56:59], v[196:199]
    v_exp_f32 v101, v101
    v_mfma_f32_16x16x32_bf16 v[228:231], v[68:71], v[60:63], v[228:231]
    v_add_u32 v3, 65536, v2
    v_add_u32 v2, s41, v2
    s_waitcnt lgkmcnt(4)
    v_mfma_f32_16x16x32_bf16 v[200:203], v[72:75], v[56:59], v[200:203]
    v_exp_f32 v102, v102
    v_and_b32 v2, s49, v2
    v_mfma_f32_16x16x32_bf16 v[232:235], v[72:75], v[60:63], v[232:235]
    v_mfma_f32_16x16x32_bf16 v[28:31], v[36:39], v[56:59], v[28:31]
    v_cvt_pk_bf16_f32 v50, v100, v101
    s_waitcnt lgkmcnt(0)
    s_barrier
    v_mfma_f32_16x16x32_bf16 v[204:207], v[76:79], v[56:59], v[204:207]
    v_exp_f32 v103, v103
    v_mfma_f32_16x16x32_bf16 v[236:239], v[76:79], v[60:63], v[236:239]
    ds_read_b128 v[68:71], v2 offset:1024
    ds_read_b128 v[64:67], v2 offset:0
    v_mfma_f32_16x16x32_bf16 v[208:211], v[80:83], v[56:59], v[208:211]
    v_exp_f32 v108, v108
    v_mfma_f32_16x16x32_bf16 v[240:243], v[80:83], v[60:63], v[240:243]
    ds_read_b128 v[76:79], v2 offset:3072
    ds_read_b128 v[72:75], v2 offset:2048
    v_cvt_pk_bf16_f32 v51, v102, v103
    v_mfma_f32_16x16x32_bf16 v[212:215], v[84:87], v[56:59], v[212:215]
    v_exp_f32 v109, v109
    v_mfma_f32_16x16x32_bf16 v[244:247], v[84:87], v[60:63], v[244:247]
    ds_read_b128 v[80:83], v2 offset:4096
    v_mfma_f32_16x16x32_bf16 v[216:219], v[88:91], v[56:59], v[216:219]
    v_exp_f32 v110, v110
    v_mfma_f32_16x16x32_bf16 v[248:251], v[88:91], v[60:63], v[248:251]
    v_mfma_f32_16x16x32_bf16 v[32:35], v[36:39], v[60:63], v[32:35]
    ds_read_b128 v[84:87], v2 offset:5120
    v_cvt_pk_bf16_f32 v54, v108, v109
    v_mfma_f32_16x16x32_bf16 v[220:223], v[92:95], v[56:59], v[220:223]
    v_exp_f32 v111, v111
    v_mfma_f32_16x16x32_bf16 v[252:255], v[92:95], v[60:63], v[252:255]
    ds_read_b128 v[88:91], v2 offset:6144
    v_cvt_pk_bf16_f32 v55, v110, v111
    s_bitcmp1_b32 s42, s40
    s_cbranch_scc1 L_recurrent_scan__compressed_kv_cla__moe_arch_mod__prompt_kernel_rare_157
L_recurrent_scan__compressed_kv_cla__moe_arch_mod__prompt_kernel_back_158:
    s_add_u32 s40, s40, 1
    s_cmp_lg_u32 s40, 16
    s_cbranch_scc1 L_body11
    s_lshr_b32 s36, s2, 5
    s_add_u32 s36, s36, 48
    s_lshl_b32 s36, s36, 7
    v_mov_b32 v12, s36
    global_load_dword v11, v12, s[90:91] sc1
    s_sub_u32 s36, 96, s50
    s_cmp_lt_i32 s36, 0
    s_cbranch_scc0 L_recurrent_scan__compressed_kv_cla__moe_arch_mod__prompt_kernel_rare_127
L_recurrent_scan__compressed_kv_cla__moe_arch_mod__prompt_kernel_back_128:
    s_lshl_b32 s37, s28, 13
    v_add_u32 v5, s37, v7
    s_waitcnt lgkmcnt(5)
    v_mfma_f32_16x16x32_bf16 v[192:195], v[64:67], v[48:51], v[192:195]
    v_exp_f32 v112, v112
    v_mfma_f32_16x16x32_bf16 v[224:227], v[64:67], v[52:55], v[224:227]
    ds_read_b128 v[92:95], v3 offset:7168
    v_exp_f32 v113, v113
    v_mfma_f32_16x16x32_bf16 v[196:199], v[68:71], v[48:51], v[196:199]
    v_cvt_pk_bf16_f32 v56, v112, v113
    v_exp_f32 v114, v114
    v_mfma_f32_16x16x32_bf16 v[228:231], v[68:71], v[52:55], v[228:231]
    ds_read_b128 v[64:67], v3 offset:8192
    v_exp_f32 v115, v115
    s_waitcnt lgkmcnt(5)
    v_mfma_f32_16x16x32_bf16 v[200:203], v[72:75], v[48:51], v[200:203]
    v_cvt_pk_bf16_f32 v57, v114, v115
    v_exp_f32 v120, v120
    v_mfma_f32_16x16x32_bf16 v[232:235], v[72:75], v[52:55], v[232:235]
    v_mfma_f32_16x16x32_bf16 v[28:31], v[36:39], v[48:51], v[28:31]
    ds_read_b128 v[68:71], v3 offset:9216
    v_exp_f32 v121, v121
    v_mfma_f32_16x16x32_bf16 v[204:207], v[76:79], v[48:51], v[204:207]
    v_cvt_pk_bf16_f32 v60, v120, v121
    v_exp_f32 v122, v122
    v_mfma_f32_16x16x32_bf16 v[236:239], v[76:79], v[52:55], v[236:239]
    ds_read_b128 v[72:75], v3 offset:10240
    v_exp_f32 v123, v123
    s_waitcnt lgkmcnt(6)
    v_mfma_f32_16x16x32_bf16 v[208:211], v[80:83], v[48:51], v[208:211]
    v_cvt_pk_bf16_f32 v61, v122, v123
    v_exp_f32 v116, v116
    v_mfma_f32_16x16x32_bf16 v[240:243], v[80:83], v[52:55], v[240:243]
    ds_read_b128 v[76:79], v3 offset:11264
    v_exp_f32 v117, v117
    s_waitcnt lgkmcnt(6)
    v_mfma_f32_16x16x32_bf16 v[212:215], v[84:87], v[48:51], v[212:215]
    v_cvt_pk_bf16_f32 v58, v116, v117
    v_exp_f32 v118, v118
    v_mfma_f32_16x16x32_bf16 v[244:247], v[84:87], v[52:55], v[244:247]
    ds_read_b128 v[80:83], v3 offset:12288
    v_exp_f32 v119, v119
    s_waitcnt lgkmcnt(6)
    v_mfma_f32_16x16x32_bf16 v[216:219], v[88:91], v[48:51], v[216:219]
    v_cvt_pk_bf16_f32 v59, v118, v119
    v_exp_f32 v124, v124
    v_mfma_f32_16x16x32_bf16 v[248:251], v[88:91], v[52:55], v[248:251]
    v_mfma_f32_16x16x32_bf16 v[32:35], v[36:39], v[52:55], v[32:35]
    ds_read_b128 v[84:87], v3 offset:13312
    v_exp_f32 v125, v125
    s_waitcnt lgkmcnt(6)
    v_mfma_f32_16x16x32_bf16 v[220:223], v[92:95], v[48:51], v[220:223]
    v_cvt_pk_bf16_f32 v62, v124, v125
    v_exp_f32 v126, v126
    v_mfma_f32_16x16x32_bf16 v[252:255], v[92:95], v[52:55], v[252:255]
    ds_read_b128 v[88:91], v3 offset:14336
    v_exp_f32 v127, v127
    s_nop 0
    v_cvt_pk_bf16_f32 v63, v126, v127
    s_nop 1
    s_waitcnt lgkmcnt(6)
    v_mfma_f32_16x16x32_bf16 v[192:195], v[64:67], v[56:59], v[192:195]
    s_mov_b32 s4, s34
    s_and_b32 s5, s35, 0xffff
    s_mov_b32 s6, 7340032
    s_mov_b32 s7, 0x20000
    s_mov_b32 s8, s32
    v_mfma_f32_16x16x32_bf16 v[224:227], v[64:67], v[60:63], v[224:227]
    ds_read_b128 v[92:95], v3 offset:15360
    s_and_b32 s9, s33, 0xffff
    s_mov_b32 s10, 8388608
    s_mov_b32 s11, 0x20000
    s_lshr_b32 s38, s2, 4
    s_waitcnt lgkmcnt(6)
    v_mfma_f32_16x16x32_bf16 v[196:199], v[68:71], v[56:59], v[196:199]
    s_mul_i32 s38, s38, 224
    s_and_b32 s39, s2, 15
    s_lshl_b32 s39, s39, 7
    v_lshrrev_b32 v25, 3, v1
    s_lshl_b32 s36, s28, 5
    v_mfma_f32_16x16x32_bf16 v[228:231], v[68:71], v[60:63], v[228:231]
    s_add_u32 s36, s36, s38
    v_add_u32 v25, s36, v25
    v_mul_u32_u24 v25, 2048, v25
    v_add_u32 v25, s39, v25
    s_waitcnt lgkmcnt(5)
    v_mfma_f32_16x16x32_bf16 v[200:203], v[72:75], v[56:59], v[200:203]
    v_bfe_u32 v26, v1, 4, 1
    v_lshlrev_b32 v26, 1, v26
    v_and_b32 v27, 7, v1
    v_xor_b32 v26, v26, v27
    v_mfma_f32_16x16x32_bf16 v[232:235], v[72:75], v[60:63], v[232:235]
    v_mfma_f32_16x16x32_bf16 v[28:31], v[36:39], v[56:59], v[28:31]
    v_lshl_add_u32 v24, v26, 4, v25
    v_xor_b32 v26, 4, v26
    v_lshl_add_u32 v25, v26, 4, v25
    v_add_u32 v25, 15360, v25
    v_add_u32 v26, 30720, v24
    s_waitcnt lgkmcnt(4)
    v_mfma_f32_16x16x32_bf16 v[204:207], v[76:79], v[56:59], v[204:207]
    v_add_u32 v27, 30720, v25
    s_lshl_b32 s36, s28, 12
    s_add_u32 s36, s36, 131072
    s_cmp_lt_u32 s28, 7
    s_cselect_b32 m0, s36, 0x30000
    s_cselect_b32 s6, 7340032, 0
    v_mfma_f32_16x16x32_bf16 v[236:239], v[76:79], v[60:63], v[236:239]
    buffer_load_dwordx4 v24, s[4:7], 0 offen offset:0 lds
    buffer_load_dwordx4 v25, s[4:7], 0 offen offset:1024 lds
    buffer_load_dwordx4 v26, s[4:7], 0 offen offset:2048 lds
    buffer_load_dwordx4 v27, s[4:7], 0 offen offset:3072 lds
    s_waitcnt lgkmcnt(3)
    v_mfma_f32_16x16x32_bf16 v[208:211], v[80:83], v[56:59], v[208:211]
    v_mfma_f32_16x16x32_bf16 v[240:243], v[80:83], v[60:63], v[240:243]
    ds_write_b128 v5, v[192:195] offset:0
    s_waitcnt lgkmcnt(3)
    v_mfma_f32_16x16x32_bf16 v[212:215], v[84:87], v[56:59], v[212:215]
    v_mfma_f32_16x16x32_bf16 v[244:247], v[84:87], v[60:63], v[244:247]
    ds_write_b128 v5, v[196:199] offset:1024
    s_waitcnt lgkmcnt(3)
    v_mfma_f32_16x16x32_bf16 v[216:219], v[88:91], v[56:59], v[216:219]
    v_mfma_f32_16x16x32_bf16 v[248:251], v[88:91], v[60:63], v[248:251]
    v_mfma_f32_16x16x32_bf16 v[32:35], v[36:39], v[60:63], v[32:35]
    ds_write_b128 v5, v[200:203] offset:2048
    s_waitcnt lgkmcnt(3)
    v_mfma_f32_16x16x32_bf16 v[220:223], v[92:95], v[56:59], v[220:223]
    v_mfma_f32_16x16x32_bf16 v[252:255], v[92:95], v[60:63], v[252:255]
    ds_write_b128 v5, v[204:207] offset:3072
    ds_write_b128 v5, v[208:211] offset:4096
    ds_write_b128 v5, v[212:215] offset:5120
    v_xor_b32 v106, 32768, v5
    s_lshl_b32 s37, s28, 8
    s_add_u32 s37, s37, 159744
    v_lshl_add_u32 v107, v1, 2, s37
    v_xor_b32 v108, 1024, v107
    ds_write_b128 v5, v[216:219] offset:6144
    ds_write_b128 v5, v[220:223] offset:7168
    ds_write_b32 v107, v28
    s_mov_b32 s36, 0x5d800000
    v_cmp_nge_f32 vcc, s36, v28
    s_nop 0
    s_or_b64 s[52:53], s[52:53], vcc
    v_cmp_nge_f32 vcc, s36, v32
    s_nop 0
    s_or_b64 s[52:53], s[52:53], vcc
    s_or_b32 s36, s52, s53
    v_mov_b32 v110, s36
    s_lshl_b32 s37, s28, 2
    s_add_u32 s37, s37, 161792
    v_mov_b32 v111, s37
    ds_write_b32 v111, v110
    v_mov_b32 v112, 161856
    v_and_b32 v111, 7, v1
    v_lshlrev_b32 v111, 2, v111
    v_add_u32 v111, 161792, v111
    v_mov_b32 v113, v7
    s_sub_u32 s36, 15, s30
    s_lshl_b32 s38, s36, 3
    s_and_b32 s37, s28, 3
    s_lshl_b32 s37, s37, 1
    s_add_u32 s38, s38, s37
    s_add_u32 s38, s38, 1
    s_lshl_b32 s38, s38, 17
    s_lshl_b32 s37, s29, 12
    s_add_u32 s38, s38, s37
    s_waitcnt vmcnt(4)
    v_readfirstlane_b32 s36, v11
    s_nop 0
    s_cmp_lt_u32 s36, 28
    s_cbranch_scc1 L_recurrent_scan__compressed_kv_cla__moe_arch_mod__prompt_kernel_rare_161
L_recurrent_scan__compressed_kv_cla__moe_arch_mod__prompt_kernel_back_162:
    s_lshr_b32 s36, s2, 4
    s_mul_i32 s36, s36, 7
    s_min_u32 s37, s28, 6
    s_add_u32 s36, s36, s37
    s_lshl_b32 s36, s36, 11
    s_add_u32 s36, s36, 58720256
    v_and_b32 v11, 15, v1
    v_lshlrev_b32 v11, 4, v11
    v_lshrrev_b32 v12, 4, v1
    v_lshl_add_u32 v11, v12, 9, v11
    buffer_load_dwordx4 v[96:99], v11, s[24:27], s36 offen offset:0 sc1
    buffer_load_dwordx4 v[100:103], v11, s[24:27], s36 offen offset:256 sc1
    s_waitcnt lgkmcnt(0)
    s_barrier
    ds_read_b128 v[114:117], v112
    ds_read_b32 v110, v111
    ds_read_b32 v109, v108
    ds_read_b128 v[64:67], v106 offset:0
    ds_read_b128 v[68:71], v106 offset:1024
    ds_read_b128 v[72:75], v106 offset:2048
    ds_read_b128 v[76:79], v106 offset:3072
    ds_read_b128 v[80:83], v106 offset:4096
    ds_read_b128 v[84:87], v106 offset:5120
    ds_read_b128 v[88:91], v106 offset:6144
    ds_read_b128 v[92:95], v106 offset:7168
    s_waitcnt lgkmcnt(8)
    v_add_f32 v109, v109, v32
    v_cmp_ne_u32 s[52:53], 0, v110
    v_readfirstlane_b32 s56, v114
    v_readfirstlane_b32 s57, v115
    v_readfirstlane_b32 s58, v116
    v_readfirstlane_b32 s59, v117
    v_rcp_f32 v109, v109
    s_nop 0
    v_mov_b32 v108, v109
    s_waitcnt lgkmcnt(6)
    v_pk_add_f32 v[224:225], v[224:225], v[64:65]
    v_pk_add_f32 v[226:227], v[226:227], v[66:67]
    v_pk_add_f32 v[228:229], v[228:229], v[68:69]
    v_pk_add_f32 v[230:231], v[230:231], v[70:71]
    v_pk_mul_f32 v[224:225], v[224:225], v[108:109]
    v_pk_mul_f32 v[226:227], v[226:227], v[108:109]
    v_pk_mul_f32 v[228:229], v[228:229], v[108:109]
    v_pk_mul_f32 v[230:231], v[230:231], v[108:109]
    v_cvt_pk_bf16_f32 v48, v224, v225
    v_cvt_pk_bf16_f32 v49, v226, v227
    v_cvt_pk_bf16_f32 v50, v228, v229
    v_cvt_pk_bf16_f32 v51, v230, v231
    buffer_store_dwordx4 v[48:51], v113, s[16:19], s38 offen offset:0 sc1
    s_waitcnt lgkmcnt(4)
    v_pk_add_f32 v[232:233], v[232:233], v[72:73]
    v_pk_add_f32 v[234:235], v[234:235], v[74:75]
    v_pk_add_f32 v[236:237], v[236:237], v[76:77]
    v_pk_add_f32 v[238:239], v[238:239], v[78:79]
    v_pk_mul_f32 v[232:233], v[232:233], v[108:109]
    v_pk_mul_f32 v[234:235], v[234:235], v[108:109]
    v_pk_mul_f32 v[236:237], v[236:237], v[108:109]
    v_pk_mul_f32 v[238:239], v[238:239], v[108:109]
    v_cvt_pk_bf16_f32 v52, v232, v233
    v_cvt_pk_bf16_f32 v53, v234, v235
    v_cvt_pk_bf16_f32 v54, v236, v237
    v_cvt_pk_bf16_f32 v55, v238, v239
    buffer_store_dwordx4 v[52:55], v113, s[16:19], s38 offen offset:1024 sc1
    s_waitcnt lgkmcnt(2)
    v_pk_add_f32 v[240:241], v[240:241], v[80:81]
    v_pk_add_f32 v[242:243], v[242:243], v[82:83]
    v_pk_add_f32 v[244:245], v[244:245], v[84:85]
    v_pk_add_f32 v[246:247], v[246:247], v[86:87]
    v_pk_mul_f32 v[240:241], v[240:241], v[108:109]
    v_pk_mul_f32 v[242:243], v[242:243], v[108:109]
    v_pk_mul_f32 v[244:245], v[244:245], v[108:109]
    v_pk_mul_f32 v[246:247], v[246:247], v[108:109]
    v_cvt_pk_bf16_f32 v56, v240, v241
    v_cvt_pk_bf16_f32 v57, v242, v243
    v_cvt_pk_bf16_f32 v58, v244, v245
    v_cvt_pk_bf16_f32 v59, v246, v247
    buffer_store_dwordx4 v[56:59], v113, s[16:19], s38 offen offset:2048 sc1
    s_waitcnt lgkmcnt(0)
    v_pk_add_f32 v[248:249], v[248:249], v[88:89]
    v_pk_add_f32 v[250:251], v[250:251], v[90:91]
    v_pk_add_f32 v[252:253], v[252:253], v[92:93]
    v_pk_add_f32 v[254:255], v[254:255], v[94:95]
    v_pk_mul_f32 v[248:249], v[248:249], v[108:109]
    v_pk_mul_f32 v[250:251], v[250:251], v[108:109]
    v_pk_mul_f32 v[252:253], v[252:253], v[108:109]
    v_pk_mul_f32 v[254:255], v[254:255], v[108:109]
    v_cvt_pk_bf16_f32 v60, v248, v249
    v_cvt_pk_bf16_f32 v61, v250, v251
    v_cvt_pk_bf16_f32 v62, v252, v253
    v_cvt_pk_bf16_f32 v63, v254, v255
    buffer_store_dwordx4 v[60:63], v113, s[16:19], s38 offen offset:3072 sc1
    s_cmp_eq_u64 s[52:53], 0
    s_cbranch_scc1 L_p3_done
    s_waitcnt vmcnt(0)
    v_mov_b32 v112, v96
    v_mov_b32 v113, v97
    v_mov_b32 v114, v98
    v_mov_b32 v115, v99
    v_mov_b32 v116, v100
    v_mov_b32 v117, v101
    v_mov_b32 v118, v102
    v_mov_b32 v119, v103
    v_mov_b32 v192, 0
    v_mov_b32 v193, 0
    v_mov_b32 v194, 0
    v_mov_b32 v195, 0
    v_mov_b32 v196, 0
    v_mov_b32 v197, 0
    v_mov_b32 v198, 0
    v_mov_b32 v199, 0
    v_mov_b32 v200, 0
    v_mov_b32 v201, 0
    v_mov_b32 v202, 0
    v_mov_b32 v203, 0
    v_mov_b32 v204, 0
    v_mov_b32 v205, 0
    v_mov_b32 v206, 0
    v_mov_b32 v207, 0
    v_mov_b32 v208, 0
    v_mov_b32 v209, 0
    v_mov_b32 v210, 0
    v_mov_b32 v211, 0
    v_mov_b32 v212, 0
    v_mov_b32 v213, 0
    v_mov_b32 v214, 0
    v_mov_b32 v215, 0
    v_mov_b32 v216, 0
    v_mov_b32 v217, 0
    v_mov_b32 v218, 0
    v_mov_b32 v219, 0
    v_mov_b32 v220, 0
    v_mov_b32 v221, 0
    v_mov_b32 v222, 0
    v_mov_b32 v223, 0
    v_mov_b32 v224, 0
    v_mov_b32 v225, 0
    v_mov_b32 v226, 0
    v_mov_b32 v227, 0
    v_mov_b32 v228, 0
    v_mov_b32 v229, 0
    v_mov_b32 v230, 0
    v_mov_b32 v231, 0
    v_mov_b32 v232, 0
    v_mov_b32 v233, 0
    v_mov_b32 v234, 0
    v_mov_b32 v235, 0
    v_mov_b32 v236, 0
    v_mov_b32 v237, 0
    v_mov_b32 v238, 0
    v_mov_b32 v239, 0
    v_mov_b32 v240, 0
    v_mov_b32 v241, 0
    v_mov_b32 v242, 0
    v_mov_b32 v243, 0
    v_mov_b32 v244, 0
    v_mov_b32 v245, 0
    v_mov_b32 v246, 0
    v_mov_b32 v247, 0
    v_mov_b32 v248, 0
    v_mov_b32 v249, 0
    v_mov_b32 v250, 0
    v_mov_b32 v251, 0
    v_mov_b32 v252, 0
    v_mov_b32 v253, 0
    v_mov_b32 v254, 0
    v_mov_b32 v255, 0
    v_mov_b32 v28, 0
    v_mov_b32 v40, 4048155338
    v_mov_b32 v32, 0
    v_mov_b32 v41, 4048155338
    s_lshl_b32 s43, s28, 12
    v_add_u32 v4, s43, v7
    s_mov_b32 s46, s45
    s_sub_u32 s40, 16, s30
    s_mov_b32 s39, s30
    s_lshl_b32 s37, s39, 7
    s_and_b32 s36, s28, 3
    s_lshl_b32 s36, s36, 5
    s_add_u32 s36, s36, s37
    s_sub_u32 s50, 0, s36
L_recurrent_scan__compressed_kv_cla__moe_arch_mod__prompt_kernel_stile_163:
    s_waitcnt vmcnt(0) lgkmcnt(0)
    s_barrier
    s_mov_b32 m0, s43
    s_add_u32 s47, s46, 32768
    buffer_load_dwordx4 v4, s[12:15], s46 offen offset:0 sc1 lds
    buffer_load_dwordx4 v4, s[12:15], s46 offen offset:1024 sc1 lds
    buffer_load_dwordx4 v4, s[12:15], s46 offen offset:2048 sc1 lds
    buffer_load_dwordx4 v4, s[12:15], s46 offen offset:3072 sc1 lds
    s_add_u32 m0, s43, 32768
    s_add_u32 s46, s46, 65536
    buffer_load_dwordx4 v4, s[12:15], s47 offen offset:0 sc1 lds
    buffer_load_dwordx4 v4, s[12:15], s47 offen offset:1024 sc1 lds
    buffer_load_dwordx4 v4, s[12:15], s47 offen offset:2048 sc1 lds
    buffer_load_dwordx4 v4, s[12:15], s47 offen offset:3072 sc1 lds
    v_mov_b32 v2, v7
    s_mov_b32 s41, 4
    s_waitcnt vmcnt(0)
    s_barrier
L_recurrent_scan__compressed_kv_cla__moe_arch_mod__prompt_kernel_sunit_164:
    s_cmp_gt_i32 s50, 0
    s_cbranch_scc1 L_recurrent_scan__compressed_kv_cla__moe_arch_mod__prompt_kernel_snext_165
    ds_read_b128 v[64:67], v2 offset:0
    ds_read_b128 v[68:71], v2 offset:1024
    ds_read_b128 v[72:75], v2 offset:2048
    ds_read_b128 v[76:79], v2 offset:3072
    ds_read_b128 v[80:83], v2 offset:4096
    ds_read_b128 v[84:87], v2 offset:5120
    ds_read_b128 v[88:91], v2 offset:6144
    ds_read_b128 v[92:95], v2 offset:7168
    s_waitcnt lgkmcnt(0)
    v_mfma_f32_16x16x32_bf16 v[96:99], v[64:67], v[128:131], 0
    v_mfma_f32_16x16x32_bf16 v[104:107], v[64:67], v[144:147], 0
    v_mfma_f32_16x16x32_bf16 v[96:99], v[68:71], v[132:135], v[96:99]
    v_mfma_f32_16x16x32_bf16 v[104:107], v[68:71], v[148:151], v[104:107]
    v_mfma_f32_16x16x32_bf16 v[96:99], v[72:75], v[136:139], v[96:99]
    v_mfma_f32_16x16x32_bf16 v[104:107], v[72:75], v[152:155], v[104:107]
    v_mfma_f32_16x16x32_bf16 v[96:99], v[76:79], v[140:143], v[96:99]
    v_mfma_f32_16x16x32_bf16 v[104:107], v[76:79], v[156:159], v[104:107]
    v_mfma_f32_16x16x32_bf16 v[100:103], v[80:83], v[128:131], 0
    v_mfma_f32_16x16x32_bf16 v[108:111], v[80:83], v[144:147], 0
    v_mfma_f32_16x16x32_bf16 v[100:103], v[84:87], v[132:135], v[100:103]
    v_mfma_f32_16x16x32_bf16 v[108:111], v[84:87], v[148:151], v[108:111]
    v_mfma_f32_16x16x32_bf16 v[100:103], v[88:91], v[136:139], v[100:103]
    v_mfma_f32_16x16x32_bf16 v[108:111], v[88:91], v[152:155], v[108:111]
    v_mfma_f32_16x16x32_bf16 v[100:103], v[92:95], v[140:143], v[100:103]
    v_mfma_f32_16x16x32_bf16 v[108:111], v[92:95], v[156:159], v[108:111]
    ds_read_b128 v[64:67], v2 offset:32768
    ds_read_b128 v[68:71], v2 offset:33792
    ds_read_b128 v[72:75], v2 offset:34816
    ds_read_b128 v[76:79], v2 offset:35840
    ds_read_b128 v[80:83], v2 offset:36864
    ds_read_b128 v[84:87], v2 offset:37888
    ds_read_b128 v[88:91], v2 offset:38912
    ds_read_b128 v[92:95], v2 offset:39936
    s_nop 1
    s_cmp_lt_i32 s50, 0
    s_cbranch_scc0 L_recurrent_scan__compressed_kv_cla__moe_arch_mod__prompt_kernel_rare_168
L_recurrent_scan__compressed_kv_cla__moe_arch_mod__prompt_kernel_back_169:
    v_max3_f32 v22, v96, v97, v98
    v_max3_f32 v22, v22, v99, v100
    v_max3_f32 v22, v22, v101, v102
    v_max3_f32 v22, v22, v103, v40
    v_mov_b32 v24, v22
    s_nop 1
    v_permlane16_swap_b32 v22, v24
    s_nop 1
    v_max_f32 v22, v22, v24
    v_mov_b32 v24, v22
    s_nop 1
    v_permlane32_swap_b32 v22, v24
    s_nop 1
    v_max_f32 v22, v22, v24
    v_sub_f32 v25, v40, v22
    v_exp_f32 v25, v25
    v_mov_b32 v40, v22
    v_mul_f32 v28, v28, v25
    v_mul_f32 v192, v192, v25
    v_mul_f32 v193, v193, v25
    v_mul_f32 v194, v194, v25
    v_mul_f32 v195, v195, v25
    v_mul_f32 v196, v196, v25
    v_mul_f32 v197, v197, v25
    v_mul_f32 v198, v198, v25
    v_mul_f32 v199, v199, v25
    v_mul_f32 v200, v200, v25
    v_mul_f32 v201, v201, v25
    v_mul_f32 v202, v202, v25
    v_mul_f32 v203, v203, v25
    v_mul_f32 v204, v204, v25
    v_mul_f32 v205, v205, v25
    v_mul_f32 v206, v206, v25
    v_mul_f32 v207, v207, v25
    v_mul_f32 v208, v208, v25
    v_mul_f32 v209, v209, v25
    v_mul_f32 v210, v210, v25
    v_mul_f32 v211, v211, v25
    v_mul_f32 v212, v212, v25
    v_mul_f32 v213, v213, v25
    v_mul_f32 v214, v214, v25
    v_mul_f32 v215, v215, v25
    v_mul_f32 v216, v216, v25
    v_mul_f32 v217, v217, v25
    v_mul_f32 v218, v218, v25
    v_mul_f32 v219, v219, v25
    v_mul_f32 v220, v220, v25
    v_mul_f32 v221, v221, v25
    v_mul_f32 v222, v222, v25
    v_mul_f32 v223, v223, v25
    v_sub_f32 v96, v96, v22
    v_sub_f32 v97, v97, v22
    v_sub_f32 v98, v98, v22
    v_sub_f32 v99, v99, v22
    v_sub_f32 v100, v100, v22
    v_sub_f32 v101, v101, v22
    v_sub_f32 v102, v102, v22
    v_sub_f32 v103, v103, v22
    v_max3_f32 v23, v104, v105, v106
    v_max3_f32 v23, v23, v107, v108
    v_max3_f32 v23, v23, v109, v110
    v_max3_f32 v23, v23, v111, v41
    v_mov_b32 v24, v23
    s_nop 1
    v_permlane16_swap_b32 v23, v24
    s_nop 1
    v_max_f32 v23, v23, v24
    v_mov_b32 v24, v23
    s_nop 1
    v_permlane32_swap_b32 v23, v24
    s_nop 1
    v_max_f32 v23, v23, v24
    v_sub_f32 v25, v41, v23
    v_exp_f32 v25, v25
    v_mov_b32 v41, v23
    v_mul_f32 v32, v32, v25
    v_mul_f32 v224, v224, v25
    v_mul_f32 v225, v225, v25
    v_mul_f32 v226, v226, v25
    v_mul_f32 v227, v227, v25
    v_mul_f32 v228, v228, v25
    v_mul_f32 v229, v229, v25
    v_mul_f32 v230, v230, v25
    v_mul_f32 v231, v231, v25
    v_mul_f32 v232, v232, v25
    v_mul_f32 v233, v233, v25
    v_mul_f32 v234, v234, v25
    v_mul_f32 v235, v235, v25
    v_mul_f32 v236, v236, v25
    v_mul_f32 v237, v237, v25
    v_mul_f32 v238, v238, v25
    v_mul_f32 v239, v239, v25
    v_mul_f32 v240, v240, v25
    v_mul_f32 v241, v241, v25
    v_mul_f32 v242, v242, v25
    v_mul_f32 v243, v243, v25
    v_mul_f32 v244, v244, v25
    v_mul_f32 v245, v245, v25
    v_mul_f32 v246, v246, v25
    v_mul_f32 v247, v247, v25
    v_mul_f32 v248, v248, v25
    v_mul_f32 v249, v249, v25
    v_mul_f32 v250, v250, v25
    v_mul_f32 v251, v251, v25
    v_mul_f32 v252, v252, v25
    v_mul_f32 v253, v253, v25
    v_mul_f32 v254, v254, v25
    v_mul_f32 v255, v255, v25
    v_sub_f32 v104, v104, v23
    v_sub_f32 v105, v105, v23
    v_sub_f32 v106, v106, v23
    v_sub_f32 v107, v107, v23
    v_sub_f32 v108, v108, v23
    v_sub_f32 v109, v109, v23
    v_sub_f32 v110, v110, v23
    v_sub_f32 v111, v111, v23
    v_exp_f32 v96, v96
    v_exp_f32 v97, v97
    v_exp_f32 v98, v98
    v_exp_f32 v99, v99
    v_exp_f32 v104, v104
    v_exp_f32 v105, v105
    v_exp_f32 v106, v106
    v_exp_f32 v107, v107
    v_exp_f32 v100, v100
    v_exp_f32 v101, v101
    v_exp_f32 v102, v102
    v_exp_f32 v103, v103
    v_exp_f32 v108, v108
    v_exp_f32 v109, v109
    v_exp_f32 v110, v110
    v_exp_f32 v111, v111
    v_add_f32 v28, v28, v96
    v_add_f32 v28, v28, v97
    v_cvt_pk_bf16_f32 v48, v96, v97
    v_add_f32 v28, v28, v98
    v_add_f32 v28, v28, v99
    v_cvt_pk_bf16_f32 v49, v98, v99
    v_add_f32 v32, v32, v104
    v_add_f32 v32, v32, v105
    v_cvt_pk_bf16_f32 v52, v104, v105
    v_add_f32 v32, v32, v106
    v_add_f32 v32, v32, v107
    v_cvt_pk_bf16_f32 v53, v106, v107
    v_add_f32 v28, v28, v100
    v_add_f32 v28, v28, v101
    v_cvt_pk_bf16_f32 v50, v100, v101
    v_add_f32 v28, v28, v102
    v_add_f32 v28, v28, v103
    v_cvt_pk_bf16_f32 v51, v102, v103
    v_add_f32 v32, v32, v108
    v_add_f32 v32, v32, v109
    v_cvt_pk_bf16_f32 v54, v108, v109
    v_add_f32 v32, v32, v110
    v_add_f32 v32, v32, v111
    v_cvt_pk_bf16_f32 v55, v110, v111
    s_waitcnt lgkmcnt(0)
    s_nop 0
    v_mfma_f32_16x16x32_bf16 v[192:195], v[64:67], v[48:51], v[192:195]
    v_mfma_f32_16x16x32_bf16 v[224:227], v[64:67], v[52:55], v[224:227]
    v_mfma_f32_16x16x32_bf16 v[196:199], v[68:71], v[48:51], v[196:199]
    v_mfma_f32_16x16x32_bf16 v[228:231], v[68:71], v[52:55], v[228:231]
    v_mfma_f32_16x16x32_bf16 v[200:203], v[72:75], v[48:51], v[200:203]
    v_mfma_f32_16x16x32_bf16 v[232:235], v[72:75], v[52:55], v[232:235]
    v_mfma_f32_16x16x32_bf16 v[204:207], v[76:79], v[48:51], v[204:207]
    v_mfma_f32_16x16x32_bf16 v[236:239], v[76:79], v[52:55], v[236:239]
    v_mfma_f32_16x16x32_bf16 v[208:211], v[80:83], v[48:51], v[208:211]
    v_mfma_f32_16x16x32_bf16 v[240:243], v[80:83], v[52:55], v[240:243]
    v_mfma_f32_16x16x32_bf16 v[212:215], v[84:87], v[48:51], v[212:215]
    v_mfma_f32_16x16x32_bf16 v[244:247], v[84:87], v[52:55], v[244:247]
    v_mfma_f32_16x16x32_bf16 v[216:219], v[88:91], v[48:51], v[216:219]
    v_mfma_f32_16x16x32_bf16 v[248:251], v[88:91], v[52:55], v[248:251]
    v_mfma_f32_16x16x32_bf16 v[220:223], v[92:95], v[48:51], v[220:223]
    v_mfma_f32_16x16x32_bf16 v[252:255], v[92:95], v[52:55], v[252:255]
L_recurrent_scan__compressed_kv_cla__moe_arch_mod__prompt_kernel_snext_165:
    v_add_u32 v2, 8192, v2
    s_add_u32 s50, s50, 32
    s_sub_u32 s41, s41, 1
    s_cmp_lg_u32 s41, 0
    s_cbranch_scc1 L_recurrent_scan__compressed_kv_cla__moe_arch_mod__prompt_kernel_sunit_164
    s_sub_u32 s40, s40, 1
    s_cmp_lg_u32 s40, 0
    s_cbranch_scc1 L_recurrent_scan__compressed_kv_cla__moe_arch_mod__prompt_kernel_stile_163
    v_mov_b32 v20, v28
    s_nop 1
    v_permlane16_swap_b32 v28, v20
    s_nop 1
    v_add_f32 v28, v28, v20
    v_mov_b32 v20, v28
    s_nop 1
    v_permlane32_swap_b32 v28, v20
    s_nop 1
    v_add_f32 v28, v28, v20
    v_mov_b32 v20, v32
    s_nop 1
    v_permlane16_swap_b32 v32, v20
    s_nop 1
    v_add_f32 v32, v32, v20
    v_mov_b32 v20, v32
    s_nop 1
    v_permlane32_swap_b32 v32, v20
    s_nop 1
    v_add_f32 v32, v32, v20
    s_mov_b32 s36, 0x5d800000
    v_cmp_nge_f32 vcc, s36, v28
    s_nop 0
    s_or_b64 s[52:53], s[52:53], vcc
    v_cmp_nge_f32 vcc, s36, v32
    s_nop 0
    s_or_b64 s[52:53], s[52:53], vcc
    v_rcp_f32 v20, v28
    v_rcp_f32 v22, v32
    s_lshl_b32 s38, s39, 3
    s_and_b32 s37, s28, 3
    s_lshl_b32 s37, s37, 1
    s_add_u32 s38, s38, s37
    s_lshl_b32 s38, s38, 17
    s_lshl_b32 s37, s29, 12
    s_add_u32 s38, s38, s37
    v_mov_b32 v21, v20
    v_mov_b32 v23, v22
    v_mov_b32 v24, v7
    v_pk_mul_f32 v[192:193], v[192:193], v[20:21]
    v_pk_mul_f32 v[194:195], v[194:195], v[20:21]
    v_pk_mul_f32 v[196:197], v[196:197], v[20:21]
    v_pk_mul_f32 v[198:199], v[198:199], v[20:21]
    v_cvt_pk_bf16_f32 v192, v192, v193
    v_cvt_pk_bf16_f32 v193, v194, v195
    v_cvt_pk_bf16_f32 v194, v196, v197
    v_cvt_pk_bf16_f32 v195, v198, v199
    buffer_store_dwordx4 v[192:195], v24, s[16:19], s38 offen offset:0 sc1
    v_pk_mul_f32 v[200:201], v[200:201], v[20:21]
    v_pk_mul_f32 v[202:203], v[202:203], v[20:21]
    v_pk_mul_f32 v[204:205], v[204:205], v[20:21]
    v_pk_mul_f32 v[206:207], v[206:207], v[20:21]
    v_cvt_pk_bf16_f32 v200, v200, v201
    v_cvt_pk_bf16_f32 v201, v202, v203
    v_cvt_pk_bf16_f32 v202, v204, v205
    v_cvt_pk_bf16_f32 v203, v206, v207
    buffer_store_dwordx4 v[200:203], v24, s[16:19], s38 offen offset:1024 sc1
    v_pk_mul_f32 v[208:209], v[208:209], v[20:21]
    v_pk_mul_f32 v[210:211], v[210:211], v[20:21]
    v_pk_mul_f32 v[212:213], v[212:213], v[20:21]
    v_pk_mul_f32 v[214:215], v[214:215], v[20:21]
    v_cvt_pk_bf16_f32 v208, v208, v209
    v_cvt_pk_bf16_f32 v209, v210, v211
    v_cvt_pk_bf16_f32 v210, v212, v213
    v_cvt_pk_bf16_f32 v211, v214, v215
    buffer_store_dwordx4 v[208:211], v24, s[16:19], s38 offen offset:2048 sc1
    v_pk_mul_f32 v[216:217], v[216:217], v[20:21]
    v_pk_mul_f32 v[218:219], v[218:219], v[20:21]
    v_pk_mul_f32 v[220:221], v[220:221], v[20:21]
    v_pk_mul_f32 v[222:223], v[222:223], v[20:21]
    v_cvt_pk_bf16_f32 v216, v216, v217
    v_cvt_pk_bf16_f32 v217, v218, v219
    v_cvt_pk_bf16_f32 v218, v220, v221
    v_cvt_pk_bf16_f32 v219, v222, v223
    buffer_store_dwordx4 v[216:219], v24, s[16:19], s38 offen offset:3072 sc1
    s_add_u32 s38, s38, 131072
    v_pk_mul_f32 v[224:225], v[224:225], v[22:23]
    v_pk_mul_f32 v[226:227], v[226:227], v[22:23]
    v_pk_mul_f32 v[228:229], v[228:229], v[22:23]
    v_pk_mul_f32 v[230:231], v[230:231], v[22:23]
    v_cvt_pk_bf16_f32 v224, v224, v225
    v_cvt_pk_bf16_f32 v225, v226, v227
    v_cvt_pk_bf16_f32 v226, v228, v229
    v_cvt_pk_bf16_f32 v227, v230, v231
    buffer_store_dwordx4 v[224:227], v24, s[16:19], s38 offen offset:0 sc1
    v_pk_mul_f32 v[232:233], v[232:233], v[22:23]
    v_pk_mul_f32 v[234:235], v[234:235], v[22:23]
    v_pk_mul_f32 v[236:237], v[236:237], v[22:23]
    v_pk_mul_f32 v[238:239], v[238:239], v[22:23]
    v_cvt_pk_bf16_f32 v232, v232, v233
    v_cvt_pk_bf16_f32 v233, v234, v235
    v_cvt_pk_bf16_f32 v234, v236, v237
    v_cvt_pk_bf16_f32 v235, v238, v239
    buffer_store_dwordx4 v[232:235], v24, s[16:19], s38 offen offset:1024 sc1
    v_pk_mul_f32 v[240:241], v[240:241], v[22:23]
    v_pk_mul_f32 v[242:243], v[242:243], v[22:23]
    v_pk_mul_f32 v[244:245], v[244:245], v[22:23]
    v_pk_mul_f32 v[246:247], v[246:247], v[22:23]
    v_cvt_pk_bf16_f32 v240, v240, v241
    v_cvt_pk_bf16_f32 v241, v242, v243
    v_cvt_pk_bf16_f32 v242, v244, v245
    v_cvt_pk_bf16_f32 v243, v246, v247
    buffer_store_dwordx4 v[240:243], v24, s[16:19], s38 offen offset:2048 sc1
    v_pk_mul_f32 v[248:249], v[248:249], v[22:23]
    v_pk_mul_f32 v[250:251], v[250:251], v[22:23]
    v_pk_mul_f32 v[252:253], v[252:253], v[22:23]
    v_pk_mul_f32 v[254:255], v[254:255], v[22:23]
    v_cvt_pk_bf16_f32 v248, v248, v249
    v_cvt_pk_bf16_f32 v249, v250, v251
    v_cvt_pk_bf16_f32 v250, v252, v253
    v_cvt_pk_bf16_f32 v251, v254, v255
    buffer_store_dwordx4 v[248:251], v24, s[16:19], s38 offen offset:3072 sc1
    v_mov_b32 v96, v112
    v_mov_b32 v97, v113
    v_mov_b32 v98, v114
    v_mov_b32 v99, v115
    v_mov_b32 v100, v116
    v_mov_b32 v101, v117
    v_mov_b32 v102, v118
    v_mov_b32 v103, v119
    s_branch L_p3_done
L_recurrent_scan__compressed_kv_cla__moe_arch_mod__prompt_kernel_rare_108:
    s_cmp_lt_i32 s36, 0
    s_cbranch_scc1 L_recurrent_scan__compressed_kv_cla__moe_arch_mod__prompt_kernel_nm_107
    v_mov_b32 v20, 4048155338
    s_cmp_gt_i32 s36, 0
    s_cbranch_scc1 L_recurrent_scan__compressed_kv_cla__moe_arch_mod__prompt_kernel_mf_105
    v_cmp_gt_i32 s[20:21], 0, v18
    v_cmp_gt_i32 s[22:23], 1, v18
    v_cmp_gt_i32 s[62:63], 2, v18
    v_cmp_gt_i32 vcc, 3, v18
    v_mov_b32 v100, v20
    v_mov_b32 v101, v20
    v_mov_b32 v102, v20
    v_mov_b32 v103, v20
    v_cndmask_b32 v96, v96, v20, s[20:21]
    v_cndmask_b32 v97, v97, v20, s[22:23]
    v_cndmask_b32 v98, v98, v20, s[62:63]
    v_cndmask_b32 v99, v99, v20, vcc
    v_cndmask_b32 v108, v108, v20, s[20:21]
    v_cndmask_b32 v109, v109, v20, s[22:23]
    v_cndmask_b32 v110, v110, v20, s[62:63]
    v_cndmask_b32 v111, v111, v20, vcc
    s_branch L_recurrent_scan__compressed_kv_cla__moe_arch_mod__prompt_kernel_me_106
L_recurrent_scan__compressed_kv_cla__moe_arch_mod__prompt_kernel_mf_105:
    v_mov_b32 v96, v20
    v_mov_b32 v97, v20
    v_mov_b32 v98, v20
    v_mov_b32 v99, v20
    v_mov_b32 v100, v20
    v_mov_b32 v101, v20
    v_mov_b32 v102, v20
    v_mov_b32 v103, v20
    v_mov_b32 v104, v20
    v_mov_b32 v105, v20
    v_mov_b32 v106, v20
    v_mov_b32 v107, v20
    v_mov_b32 v108, v20
    v_mov_b32 v109, v20
    v_mov_b32 v110, v20
    v_mov_b32 v111, v20
L_recurrent_scan__compressed_kv_cla__moe_arch_mod__prompt_kernel_me_106:
L_recurrent_scan__compressed_kv_cla__moe_arch_mod__prompt_kernel_nm_107:
    s_branch L_recurrent_scan__compressed_kv_cla__moe_arch_mod__prompt_kernel_back_109
L_recurrent_scan__compressed_kv_cla__moe_arch_mod__prompt_kernel_rare_117:
    s_add_u32 s36, s40, 1
    s_sub_u32 s36, s36, s51
    s_cmp_lt_u32 s36, 2
    s_cbranch_scc0 L_recurrent_scan__compressed_kv_cla__moe_arch_mod__prompt_kernel_r_111
    s_lshl_b32 s36, s36, 6
    s_add_u32 s36, s36, 32
    s_sub_u32 s36, s36, s50
    s_cmp_lt_i32 s36, 0
    s_cbranch_scc1 L_recurrent_scan__compressed_kv_cla__moe_arch_mod__prompt_kernel_nm_116
    v_mov_b32 v20, 4048155338
    s_cmp_gt_i32 s36, 0
    s_cbranch_scc1 L_recurrent_scan__compressed_kv_cla__moe_arch_mod__prompt_kernel_mf_114
    v_cmp_gt_i32 s[20:21], 0, v18
    v_cmp_gt_i32 s[22:23], 1, v18
    v_cmp_gt_i32 s[62:63], 2, v18
    v_cmp_gt_i32 vcc, 3, v18
    v_mov_b32 v116, v20
    v_mov_b32 v117, v20
    v_mov_b32 v118, v20
    v_mov_b32 v119, v20
    v_cndmask_b32 v112, v112, v20, s[20:21]
    v_cndmask_b32 v113, v113, v20, s[22:23]
    v_cndmask_b32 v114, v114, v20, s[62:63]
    v_cndmask_b32 v115, v115, v20, vcc
    v_cndmask_b32 v124, v124, v20, s[20:21]
    v_cndmask_b32 v125, v125, v20, s[22:23]
    v_cndmask_b32 v126, v126, v20, s[62:63]
    v_cndmask_b32 v127, v127, v20, vcc
    s_branch L_recurrent_scan__compressed_kv_cla__moe_arch_mod__prompt_kernel_me_115
L_recurrent_scan__compressed_kv_cla__moe_arch_mod__prompt_kernel_mf_114:
    v_mov_b32 v112, v20
    v_mov_b32 v113, v20
    v_mov_b32 v114, v20
    v_mov_b32 v115, v20
    v_mov_b32 v116, v20
    v_mov_b32 v117, v20
    v_mov_b32 v118, v20
    v_mov_b32 v119, v20
    v_mov_b32 v120, v20
    v_mov_b32 v121, v20
    v_mov_b32 v122, v20
    v_mov_b32 v123, v20
    v_mov_b32 v124, v20
    v_mov_b32 v125, v20
    v_mov_b32 v126, v20
    v_mov_b32 v127, v20
L_recurrent_scan__compressed_kv_cla__moe_arch_mod__prompt_kernel_me_115:
L_recurrent_scan__compressed_kv_cla__moe_arch_mod__prompt_kernel_nm_116:
L_recurrent_scan__compressed_kv_cla__moe_arch_mod__prompt_kernel_r_111:
    s_branch L_recurrent_scan__compressed_kv_cla__moe_arch_mod__prompt_kernel_back_118
L_recurrent_scan__compressed_kv_cla__moe_arch_mod__prompt_kernel_rare_122:
    s_add_u32 s36, s40, 2
    s_sub_u32 s36, s36, s51
    s_cmp_eq_u32 s36, 1
    s_cselect_b32 s41, 0x8000, s41
    s_cmp_eq_u32 s40, 15
    s_cbranch_scc0 L_recurrent_scan__compressed_kv_cla__moe_arch_mod__prompt_kernel_r_112
    s_mov_b32 s41, 65536
    s_mov_b32 s49, 0x1ffff
    s_mov_b32 s36, 1
L_recurrent_scan__compressed_kv_cla__moe_arch_mod__prompt_kernel_r_112:
    s_cmp_lt_u32 s36, 2
    s_cbranch_scc0 L_recurrent_scan__compressed_kv_cla__moe_arch_mod__prompt_kernel_r_113
    s_lshl_b32 s36, s36, 6
    s_sub_u32 s36, s36, s50
    s_cmp_lt_i32 s36, 0
    s_cbranch_scc1 L_recurrent_scan__compressed_kv_cla__moe_arch_mod__prompt_kernel_nm_121
    v_mov_b32 v20, 4048155338
    s_cmp_gt_i32 s36, 0
    s_cbranch_scc1 L_recurrent_scan__compressed_kv_cla__moe_arch_mod__prompt_kernel_mf_119
    v_cmp_gt_i32 s[20:21], 0, v18
    v_cmp_gt_i32 s[22:23], 1, v18
    v_cmp_gt_i32 s[62:63], 2, v18
    v_cmp_gt_i32 vcc, 3, v18
    v_mov_b32 v100, v20
    v_mov_b32 v101, v20
    v_mov_b32 v102, v20
    v_mov_b32 v103, v20
    v_cndmask_b32 v96, v96, v20, s[20:21]
    v_cndmask_b32 v97, v97, v20, s[22:23]
    v_cndmask_b32 v98, v98, v20, s[62:63]
    v_cndmask_b32 v99, v99, v20, vcc
    v_cndmask_b32 v108, v108, v20, s[20:21]
    v_cndmask_b32 v109, v109, v20, s[22:23]
    v_cndmask_b32 v110, v110, v20, s[62:63]
    v_cndmask_b32 v111, v111, v20, vcc
    s_branch L_recurrent_scan__compressed_kv_cla__moe_arch_mod__prompt_kernel_me_120
L_recurrent_scan__compressed_kv_cla__moe_arch_mod__prompt_kernel_mf_119:
    v_mov_b32 v96, v20
    v_mov_b32 v97, v20
    v_mov_b32 v98, v20
    v_mov_b32 v99, v20
    v_mov_b32 v100, v20
    v_mov_b32 v101, v20
    v_mov_b32 v102, v20
    v_mov_b32 v103, v20
    v_mov_b32 v104, v20
    v_mov_b32 v105, v20
    v_mov_b32 v106, v20
    v_mov_b32 v107, v20
    v_mov_b32 v108, v20
    v_mov_b32 v109, v20
    v_mov_b32 v110, v20
    v_mov_b32 v111, v20
L_recurrent_scan__compressed_kv_cla__moe_arch_mod__prompt_kernel_me_120:
L_recurrent_scan__compressed_kv_cla__moe_arch_mod__prompt_kernel_nm_121:
L_recurrent_scan__compressed_kv_cla__moe_arch_mod__prompt_kernel_r_113:
    s_branch L_recurrent_scan__compressed_kv_cla__moe_arch_mod__prompt_kernel_back_123
L_recurrent_scan__compressed_kv_cla__moe_arch_mod__prompt_kernel_rare_127:
    v_mov_b32 v20, 4048155338
    s_cmp_gt_i32 s36, 0
    s_cbranch_scc1 L_recurrent_scan__compressed_kv_cla__moe_arch_mod__prompt_kernel_mf_125
    v_cmp_gt_i32 s[20:21], 0, v18
    v_cmp_gt_i32 s[22:23], 1, v18
    v_cmp_gt_i32 s[62:63], 2, v18
    v_cmp_gt_i32 vcc, 3, v18
    v_mov_b32 v116, v20
    v_mov_b32 v117, v20
    v_mov_b32 v118, v20
    v_mov_b32 v119, v20
    v_cndmask_b32 v112, v112, v20, s[20:21]
    v_cndmask_b32 v113, v113, v20, s[22:23]
    v_cndmask_b32 v114, v114, v20, s[62:63]
    v_cndmask_b32 v115, v115, v20, vcc
    v_cndmask_b32 v124, v124, v20, s[20:21]
    v_cndmask_b32 v125, v125, v20, s[22:23]
    v_cndmask_b32 v126, v126, v20, s[62:63]
    v_cndmask_b32 v127, v127, v20, vcc
    s_branch L_recurrent_scan__compressed_kv_cla__moe_arch_mod__prompt_kernel_me_126
L_recurrent_scan__compressed_kv_cla__moe_arch_mod__prompt_kernel_mf_125:
    v_mov_b32 v112, v20
    v_mov_b32 v113, v20
    v_mov_b32 v114, v20
    v_mov_b32 v115, v20
    v_mov_b32 v116, v20
    v_mov_b32 v117, v20
    v_mov_b32 v118, v20
    v_mov_b32 v119, v20
    v_mov_b32 v120, v20
    v_mov_b32 v121, v20
    v_mov_b32 v122, v20
    v_mov_b32 v123, v20
    v_mov_b32 v124, v20
    v_mov_b32 v125, v20
    v_mov_b32 v126, v20
    v_mov_b32 v127, v20
L_recurrent_scan__compressed_kv_cla__moe_arch_mod__prompt_kernel_me_126:
    s_branch L_recurrent_scan__compressed_kv_cla__moe_arch_mod__prompt_kernel_back_128
L_recurrent_scan__compressed_kv_cla__moe_arch_mod__prompt_kernel_rare_135:
    s_add_u32 s36, s40, 1
    s_sub_u32 s36, s36, s51
    s_cmp_lt_u32 s36, 2
    s_cbranch_scc0 L_recurrent_scan__compressed_kv_cla__moe_arch_mod__prompt_kernel_r_129
    s_lshl_b32 s36, s36, 6
    s_add_u32 s36, s36, 32
    s_sub_u32 s36, s36, s50
    s_cmp_lt_i32 s36, 0
    s_cbranch_scc1 L_recurrent_scan__compressed_kv_cla__moe_arch_mod__prompt_kernel_nm_134
    v_mov_b32 v20, 4048155338
    s_cmp_gt_i32 s36, 0
    s_cbranch_scc1 L_recurrent_scan__compressed_kv_cla__moe_arch_mod__prompt_kernel_mf_132
    v_cmp_gt_i32 s[20:21], 0, v18
    v_cmp_gt_i32 s[22:23], 1, v18
    v_cmp_gt_i32 s[62:63], 2, v18
    v_cmp_gt_i32 vcc, 3, v18
    v_mov_b32 v116, v20
    v_mov_b32 v117, v20
    v_mov_b32 v118, v20
    v_mov_b32 v119, v20
    v_cndmask_b32 v112, v112, v20, s[20:21]
    v_cndmask_b32 v113, v113, v20, s[22:23]
    v_cndmask_b32 v114, v114, v20, s[62:63]
    v_cndmask_b32 v115, v115, v20, vcc
    v_cndmask_b32 v124, v124, v20, s[20:21]
    v_cndmask_b32 v125, v125, v20, s[22:23]
    v_cndmask_b32 v126, v126, v20, s[62:63]
    v_cndmask_b32 v127, v127, v20, vcc
    s_branch L_recurrent_scan__compressed_kv_cla__moe_arch_mod__prompt_kernel_me_133
L_recurrent_scan__compressed_kv_cla__moe_arch_mod__prompt_kernel_mf_132:
    v_mov_b32 v112, v20
    v_mov_b32 v113, v20
    v_mov_b32 v114, v20
    v_mov_b32 v115, v20
    v_mov_b32 v116, v20
    v_mov_b32 v117, v20
    v_mov_b32 v118, v20
    v_mov_b32 v119, v20
    v_mov_b32 v120, v20
    v_mov_b32 v121, v20
    v_mov_b32 v122, v20
    v_mov_b32 v123, v20
    v_mov_b32 v124, v20
    v_mov_b32 v125, v20
    v_mov_b32 v126, v20
    v_mov_b32 v127, v20
L_recurrent_scan__compressed_kv_cla__moe_arch_mod__prompt_kernel_me_133:
L_recurrent_scan__compressed_kv_cla__moe_arch_mod__prompt_kernel_nm_134:
L_recurrent_scan__compressed_kv_cla__moe_arch_mod__prompt_kernel_r_129:
    s_branch L_recurrent_scan__compressed_kv_cla__moe_arch_mod__prompt_kernel_back_136
L_recurrent_scan__compressed_kv_cla__moe_arch_mod__prompt_kernel_rare_140:
    s_add_u32 s36, s40, 2
    s_sub_u32 s36, s36, s51
    s_cmp_eq_u32 s36, 1
    s_cselect_b32 s41, 0x8000, s41
    s_cmp_eq_u32 s40, 15
    s_cbranch_scc0 L_recurrent_scan__compressed_kv_cla__moe_arch_mod__prompt_kernel_r_130
    s_mov_b32 s41, 65536
    s_mov_b32 s49, 0x1ffff
    s_mov_b32 s36, 1
L_recurrent_scan__compressed_kv_cla__moe_arch_mod__prompt_kernel_r_130:
    s_cmp_lt_u32 s36, 2
    s_cbranch_scc0 L_recurrent_scan__compressed_kv_cla__moe_arch_mod__prompt_kernel_r_131
    s_lshl_b32 s36, s36, 6
    s_sub_u32 s36, s36, s50
    s_cmp_lt_i32 s36, 0
    s_cbranch_scc1 L_recurrent_scan__compressed_kv_cla__moe_arch_mod__prompt_kernel_nm_139
    v_mov_b32 v20, 4048155338
    s_cmp_gt_i32 s36, 0
    s_cbranch_scc1 L_recurrent_scan__compressed_kv_cla__moe_arch_mod__prompt_kernel_mf_137
    v_cmp_gt_i32 s[20:21], 0, v18
    v_cmp_gt_i32 s[22:23], 1, v18
    v_cmp_gt_i32 s[62:63], 2, v18
    v_cmp_gt_i32 vcc, 3, v18
    v_mov_b32 v100, v20
    v_mov_b32 v101, v20
    v_mov_b32 v102, v20
    v_mov_b32 v103, v20
    v_cndmask_b32 v96, v96, v20, s[20:21]
    v_cndmask_b32 v97, v97, v20, s[22:23]
    v_cndmask_b32 v98, v98, v20, s[62:63]
    v_cndmask_b32 v99, v99, v20, vcc
    v_cndmask_b32 v108, v108, v20, s[20:21]
    v_cndmask_b32 v109, v109, v20, s[22:23]
    v_cndmask_b32 v110, v110, v20, s[62:63]
    v_cndmask_b32 v111, v111, v20, vcc
    s_branch L_recurrent_scan__compressed_kv_cla__moe_arch_mod__prompt_kernel_me_138
L_recurrent_scan__compressed_kv_cla__moe_arch_mod__prompt_kernel_mf_137:
    v_mov_b32 v96, v20
    v_mov_b32 v97, v20
    v_mov_b32 v98, v20
    v_mov_b32 v99, v20
    v_mov_b32 v100, v20
    v_mov_b32 v101, v20
    v_mov_b32 v102, v20
    v_mov_b32 v103, v20
    v_mov_b32 v104, v20
    v_mov_b32 v105, v20
    v_mov_b32 v106, v20
    v_mov_b32 v107, v20
    v_mov_b32 v108, v20
    v_mov_b32 v109, v20
    v_mov_b32 v110, v20
    v_mov_b32 v111, v20
L_recurrent_scan__compressed_kv_cla__moe_arch_mod__prompt_kernel_me_138:
L_recurrent_scan__compressed_kv_cla__moe_arch_mod__prompt_kernel_nm_139:
L_recurrent_scan__compressed_kv_cla__moe_arch_mod__prompt_kernel_r_131:
    s_branch L_recurrent_scan__compressed_kv_cla__moe_arch_mod__prompt_kernel_back_141
L_recurrent_scan__compressed_kv_cla__moe_arch_mod__prompt_kernel_rare_143:
    s_lshl_b32 s36, s29, 7
    s_cmp_eq_u32 s30, 0
    s_cselect_b32 s37, 4, 0
    s_add_u32 s36, s36, s37
    v_mov_b32 v20, s36
    v_mov_b32 v21, 1
    s_mov_b64 exec, 1
    global_atomic_add v20, v21, s[90:91]
    s_mov_b64 exec, -1
    s_nop 3
    s_branch L_recurrent_scan__compressed_kv_cla__moe_arch_mod__prompt_kernel_back_144
L_recurrent_scan__compressed_kv_cla__moe_arch_mod__prompt_kernel_rare_150:
    s_cmp_eq_u32 s40, 12
    s_cbranch_scc0 L_recurrent_scan__compressed_kv_cla__moe_arch_mod__prompt_kernel_bh_148
    s_getpc_b64 s[36:37]
L_recurrent_scan__compressed_kv_cla__moe_arch_mod__prompt_kernel_pc_149:
    s_sub_u32 s36, s36, L_recurrent_scan__compressed_kv_cla__moe_arch_mod__prompt_kernel_pc_149-L_pc
    s_subb_u32 s37, s37, 0
    s_lshr_b32 s38, s2, 3
    s_lshl_b32 s38, s38, 7
    v_lshl_add_u32 v26, v1, 12, s38
    v_min_u32 v26, L_end-L_pc-4, v26
    v_mov_b32 v27, s37
    v_add_co_u32 v26, vcc, s36, v26
    s_mov_b64 exec, 0xffff
    s_nop 0
    v_addc_co_u32 v27, vcc, 0, v27, vcc
    global_load_dword v0, v[26:27], off
    s_mov_b64 exec, -1
    s_nop 1
L_recurrent_scan__compressed_kv_cla__moe_arch_mod__prompt_kernel_bh_148:
    s_cmp_eq_u32 s40, 0
    s_cbranch_scc0 L_recurrent_scan__compressed_kv_cla__moe_arch_mod__prompt_kernel_nm_145
    ds_read_b64 v[14:15], v19
    s_waitcnt lgkmcnt(0)
L_recurrent_scan__compressed_kv_cla__moe_arch_mod__prompt_kernel_nm_145:
    s_branch L_recurrent_scan__compressed_kv_cla__moe_arch_mod__prompt_kernel_back_151
L_recurrent_scan__compressed_kv_cla__moe_arch_mod__prompt_kernel_rare_157:
    s_cmp_eq_u32 s40, 12
    s_cbranch_scc0 L_recurrent_scan__compressed_kv_cla__moe_arch_mod__prompt_kernel_bh_155
    s_getpc_b64 s[36:37]
L_recurrent_scan__compressed_kv_cla__moe_arch_mod__prompt_kernel_pc_156:
    s_sub_u32 s36, s36, L_recurrent_scan__compressed_kv_cla__moe_arch_mod__prompt_kernel_pc_156-L_pc
    s_subb_u32 s37, s37, 0
    s_lshr_b32 s38, s2, 3
    s_lshl_b32 s38, s38, 7
    v_lshl_add_u32 v26, v1, 12, s38
    v_min_u32 v26, L_end-L_pc-4, v26
    v_mov_b32 v27, s37
    v_add_co_u32 v26, vcc, s36, v26
    s_mov_b64 exec, 0xffff
    s_nop 0
    v_addc_co_u32 v27, vcc, 0, v27, vcc
    global_load_dword v0, v[26:27], off
    s_mov_b64 exec, -1
    s_nop 1
L_recurrent_scan__compressed_kv_cla__moe_arch_mod__prompt_kernel_bh_155:
    s_cmp_eq_u32 s40, s51
    s_cbranch_scc0 L_recurrent_scan__compressed_kv_cla__moe_arch_mod__prompt_kernel_ne_154
    s_nop 4
    s_mov_b32 s36, 0x5d800000
    v_cmp_nge_f32 vcc, s36, v28
    s_nop 0
    s_or_b64 s[52:53], s[52:53], vcc
    v_cmp_nge_f32 vcc, s36, v32
    s_nop 0
    s_or_b64 s[52:53], s[52:53], vcc
    v_rcp_f32 v20, v28
    v_rcp_f32 v22, v32
    s_lshl_b32 s38, s30, 3
    s_and_b32 s37, s28, 3
    s_lshl_b32 s37, s37, 1
    s_add_u32 s38, s38, s37
    s_lshl_b32 s38, s38, 17
    s_lshl_b32 s37, s29, 12
    s_add_u32 s38, s38, s37
    v_mov_b32 v21, v20
    v_mov_b32 v23, v22
    v_mov_b32 v24, v7
    v_pk_mul_f32 v[192:193], v[192:193], v[20:21]
    v_pk_mul_f32 v[194:195], v[194:195], v[20:21]
    v_pk_mul_f32 v[196:197], v[196:197], v[20:21]
    v_pk_mul_f32 v[198:199], v[198:199], v[20:21]
    v_cvt_pk_bf16_f32 v192, v192, v193
    v_cvt_pk_bf16_f32 v193, v194, v195
    v_cvt_pk_bf16_f32 v194, v196, v197
    v_cvt_pk_bf16_f32 v195, v198, v199
    buffer_store_dwordx4 v[192:195], v24, s[16:19], s38 offen offset:0 sc1
    v_pk_mul_f32 v[200:201], v[200:201], v[20:21]
    v_pk_mul_f32 v[202:203], v[202:203], v[20:21]
    v_pk_mul_f32 v[204:205], v[204:205], v[20:21]
    v_pk_mul_f32 v[206:207], v[206:207], v[20:21]
    v_cvt_pk_bf16_f32 v200, v200, v201
    v_cvt_pk_bf16_f32 v201, v202, v203
    v_cvt_pk_bf16_f32 v202, v204, v205
    v_cvt_pk_bf16_f32 v203, v206, v207
    buffer_store_dwordx4 v[200:203], v24, s[16:19], s38 offen offset:1024 sc1
    v_pk_mul_f32 v[208:209], v[208:209], v[20:21]
    v_pk_mul_f32 v[210:211], v[210:211], v[20:21]
    v_pk_mul_f32 v[212:213], v[212:213], v[20:21]
    v_pk_mul_f32 v[214:215], v[214:215], v[20:21]
    v_cvt_pk_bf16_f32 v208, v208, v209
    v_cvt_pk_bf16_f32 v209, v210, v211
    v_cvt_pk_bf16_f32 v210, v212, v213
    v_cvt_pk_bf16_f32 v211, v214, v215
    buffer_store_dwordx4 v[208:211], v24, s[16:19], s38 offen offset:2048 sc1
    v_pk_mul_f32 v[216:217], v[216:217], v[20:21]
    v_pk_mul_f32 v[218:219], v[218:219], v[20:21]
    v_pk_mul_f32 v[220:221], v[220:221], v[20:21]
    v_pk_mul_f32 v[222:223], v[222:223], v[20:21]
    v_cvt_pk_bf16_f32 v216, v216, v217
    v_cvt_pk_bf16_f32 v217, v218, v219
    v_cvt_pk_bf16_f32 v218, v220, v221
    v_cvt_pk_bf16_f32 v219, v222, v223
    buffer_store_dwordx4 v[216:219], v24, s[16:19], s38 offen offset:3072 sc1
    s_add_u32 s38, s38, 131072
    v_pk_mul_f32 v[224:225], v[224:225], v[22:23]
    v_pk_mul_f32 v[226:227], v[226:227], v[22:23]
    v_pk_mul_f32 v[228:229], v[228:229], v[22:23]
    v_pk_mul_f32 v[230:231], v[230:231], v[22:23]
    v_cvt_pk_bf16_f32 v224, v224, v225
    v_cvt_pk_bf16_f32 v225, v226, v227
    v_cvt_pk_bf16_f32 v226, v228, v229
    v_cvt_pk_bf16_f32 v227, v230, v231
    buffer_store_dwordx4 v[224:227], v24, s[16:19], s38 offen offset:0 sc1
    v_pk_mul_f32 v[232:233], v[232:233], v[22:23]
    v_pk_mul_f32 v[234:235], v[234:235], v[22:23]
    v_pk_mul_f32 v[236:237], v[236:237], v[22:23]
    v_pk_mul_f32 v[238:239], v[238:239], v[22:23]
    v_cvt_pk_bf16_f32 v232, v232, v233
    v_cvt_pk_bf16_f32 v233, v234, v235
    v_cvt_pk_bf16_f32 v234, v236, v237
    v_cvt_pk_bf16_f32 v235, v238, v239
    buffer_store_dwordx4 v[232:235], v24, s[16:19], s38 offen offset:1024 sc1
    v_pk_mul_f32 v[240:241], v[240:241], v[22:23]
    v_pk_mul_f32 v[242:243], v[242:243], v[22:23]
    v_pk_mul_f32 v[244:245], v[244:245], v[22:23]
    v_pk_mul_f32 v[246:247], v[246:247], v[22:23]
    v_cvt_pk_bf16_f32 v240, v240, v241
    v_cvt_pk_bf16_f32 v241, v242, v243
    v_cvt_pk_bf16_f32 v242, v244, v245
    v_cvt_pk_bf16_f32 v243, v246, v247
    buffer_store_dwordx4 v[240:243], v24, s[16:19], s38 offen offset:2048 sc1
    v_pk_mul_f32 v[248:249], v[248:249], v[22:23]
    v_pk_mul_f32 v[250:251], v[250:251], v[22:23]
    v_pk_mul_f32 v[252:253], v[252:253], v[22:23]
    v_pk_mul_f32 v[254:255], v[254:255], v[22:23]
    v_cvt_pk_bf16_f32 v248, v248, v249
    v_cvt_pk_bf16_f32 v249, v250, v251
    v_cvt_pk_bf16_f32 v250, v252, v253
    v_cvt_pk_bf16_f32 v251, v254, v255
    buffer_store_dwordx4 v[248:251], v24, s[16:19], s38 offen offset:3072 sc1
    v_mov_b64 v[28:29], 0
    v_mov_b64 v[30:31], 0
    v_mov_b64 v[32:33], 0
    v_mov_b64 v[34:35], 0
    v_mov_b64 v[192:193], 0
    v_mov_b64 v[194:195], 0
    v_mov_b64 v[196:197], 0
    v_mov_b64 v[198:199], 0
    v_mov_b64 v[200:201], 0
    v_mov_b64 v[202:203], 0
    v_mov_b64 v[204:205], 0
    v_mov_b64 v[206:207], 0
    v_mov_b64 v[208:209], 0
    v_mov_b64 v[210:211], 0
    v_mov_b64 v[212:213], 0
    v_mov_b64 v[214:215], 0
    v_mov_b64 v[216:217], 0
    v_mov_b64 v[218:219], 0
    v_mov_b64 v[220:221], 0
    v_mov_b64 v[222:223], 0
    v_mov_b64 v[224:225], 0
    v_mov_b64 v[226:227], 0
    v_mov_b64 v[228:229], 0
    v_mov_b64 v[230:231], 0
    v_mov_b64 v[232:233], 0
    v_mov_b64 v[234:235], 0
    v_mov_b64 v[236:237], 0
    v_mov_b64 v[238:239], 0
    v_mov_b64 v[240:241], 0
    v_mov_b64 v[242:243], 0
    v_mov_b64 v[244:245], 0
    v_mov_b64 v[246:247], 0
    v_mov_b64 v[248:249], 0
    v_mov_b64 v[250:251], 0
    v_mov_b64 v[252:253], 0
    v_mov_b64 v[254:255], 0
L_recurrent_scan__compressed_kv_cla__moe_arch_mod__prompt_kernel_ne_154:
    s_branch L_recurrent_scan__compressed_kv_cla__moe_arch_mod__prompt_kernel_back_158
L_recurrent_scan__compressed_kv_cla__moe_arch_mod__prompt_kernel_rare_161:
    s_mov_b32 s61, 0x40000
L_recurrent_scan__compressed_kv_cla__moe_arch_mod__prompt_kernel_spin_159:
    s_sub_u32 s61, s61, 1
    s_cbranch_scc1 L_recurrent_scan__compressed_kv_cla__moe_arch_mod__prompt_kernel_spinx_160
    s_sleep 8
    global_load_dword v11, v12, s[90:91] sc1
    s_waitcnt vmcnt(0)
    v_readfirstlane_b32 s36, v11
    s_nop 0
    s_cmp_lt_u32 s36, 28
    s_cbranch_scc1 L_recurrent_scan__compressed_kv_cla__moe_arch_mod__prompt_kernel_spin_159
L_recurrent_scan__compressed_kv_cla__moe_arch_mod__prompt_kernel_spinx_160:
    s_branch L_recurrent_scan__compressed_kv_cla__moe_arch_mod__prompt_kernel_back_162
L_recurrent_scan__compressed_kv_cla__moe_arch_mod__prompt_kernel_rare_168:
    v_mov_b32 v20, 4048155338
    s_cmp_gt_i32 s50, 0
    s_cbranch_scc1 L_recurrent_scan__compressed_kv_cla__moe_arch_mod__prompt_kernel_mf_166
    v_cmp_gt_i32 s[20:21], 0, v18
    v_cmp_gt_i32 s[22:23], 1, v18
    v_cmp_gt_i32 s[62:63], 2, v18
    v_cmp_gt_i32 vcc, 3, v18
    v_mov_b32 v100, v20
    v_mov_b32 v101, v20
    v_mov_b32 v102, v20
    v_mov_b32 v103, v20
    v_cndmask_b32 v96, v96, v20, s[20:21]
    v_cndmask_b32 v97, v97, v20, s[22:23]
    v_cndmask_b32 v98, v98, v20, s[62:63]
    v_cndmask_b32 v99, v99, v20, vcc
    v_cndmask_b32 v108, v108, v20, s[20:21]
    v_cndmask_b32 v109, v109, v20, s[22:23]
    v_cndmask_b32 v110, v110, v20, s[62:63]
    v_cndmask_b32 v111, v111, v20, vcc
    s_branch L_recurrent_scan__compressed_kv_cla__moe_arch_mod__prompt_kernel_me_167
L_recurrent_scan__compressed_kv_cla__moe_arch_mod__prompt_kernel_mf_166:
    v_mov_b32 v96, v20
    v_mov_b32 v97, v20
    v_mov_b32 v98, v20
    v_mov_b32 v99, v20
    v_mov_b32 v100, v20
    v_mov_b32 v101, v20
    v_mov_b32 v102, v20
    v_mov_b32 v103, v20
    v_mov_b32 v104, v20
    v_mov_b32 v105, v20
    v_mov_b32 v106, v20
    v_mov_b32 v107, v20
    v_mov_b32 v108, v20
    v_mov_b32 v109, v20
    v_mov_b32 v110, v20
    v_mov_b32 v111, v20
L_recurrent_scan__compressed_kv_cla__moe_arch_mod__prompt_kernel_me_167:
    s_branch L_recurrent_scan__compressed_kv_cla__moe_arch_mod__prompt_kernel_back_169
L_p3_done:
    s_and_b32 s36, s29, 28
    s_sub_u32 s40, 47, s30
    s_lshl_b32 s40, s40, 7
    s_add_u32 s40, s40, s36
    s_add_u32 s41, s30, 32
    s_lshl_b32 s41, s41, 7
    s_add_u32 s41, s41, s36
    s_lshr_b32 s63, s29, 4
    s_lshl_b32 s36, s30, 2
    s_lshr_b32 s30, 0x76534210, s36
    s_and_b32 s30, s30, 7
    s_and_b32 s36, s30, 4
    s_add_u32 s43, s30, s36
    s_lshl_b32 s36, s63, 2
    s_add_u32 s30, s43, s36
    s_and_b32 s29, s29, 15
    s_and_b32 s36, s28, 3
    s_lshl_b32 s37, s29, 2
    s_add_u32 s36, s36, s37
    s_lshl_b32 s36, s36, 18
    s_lshr_b32 s37, s28, 2
    s_lshl_b32 s37, s37, 12
    s_add_u32 s36, s36, s37
    s_lshl_b32 s37, s63, 16
    s_add_u32 s36, s36, s37
    s_lshr_b32 s37, s28, 2
    s_lshl_b32 s37, s37, 17
    s_add_u32 s36, s36, s37
    v_lshl_add_u32 v2, v1, 4, s36
    v_xor_b32 v3, 131072, v2
    v_lshrrev_b32 v19, 4, v1
    s_lshr_b32 s36, s28, 2
    s_lshl_b32 s36, s36, 7
    s_and_b32 s37, s28, 3
    s_lshl_b32 s37, s37, 4
    s_add_u32 s36, s36, s37
    s_lshl_b32 s33, s36, 8
    s_lshl_b32 s37, s63, 11
    s_add_u32 s36, s36, s37
    v_add_u32 v18, s36, v19
    v_lshlrev_b32 v18, 11, v18
    s_lshl_b32 s36, s43, 7
    v_add_u32 v18, s36, v18
    v_lshlrev_b32 v20, 1, v19
    v_and_b32 v21, 7, v1
    v_xor_b32 v20, v20, v21
    v_lshl_add_u32 v18, v20, 4, v18
    v_and_b32 v21, 8, v1
    v_lshl_add_u32 v6, v21, 6, v18
    v_xor_b32 v21, 8, v21
    v_lshl_add_u32 v7, v21, 6, v18
    v_add_u32 v7, 7168, v7
    v_add_u32 v8, 14336, v6
    v_add_u32 v9, 14336, v7
    s_add_u32 s36, s2, 1
    s_mov_b32 s62, 0
    s_mov_b32 s31, 0
    s_mov_b32 s32, 0
    s_add_u32 s4, s54, 41943040
    s_addc_u32 s5, s55, 0
    s_and_b32 s5, s5, 0xffff
    s_mov_b32 s6, 117440640
    s_mov_b32 s7, 0x20000
    s_mov_b32 s16, s96
    s_and_b32 s17, s97, 0xffff
    s_mov_b32 s18, 4194304
    s_mov_b32 s19, 0x20000
    s_mov_b32 s20, s98
    s_and_b32 s21, s99, 0xffff
    s_mov_b32 s22, 4194304
    s_mov_b32 s23, 0x20000
    s_lshl_b32 s36, s29, 7
    s_and_b32 s37, s28, 3
    s_lshl_b32 s37, s37, 5
    s_add_u32 s36, s36, s37
    s_lshr_b32 s37, s28, 2
    s_lshl_b32 s37, s37, 4
    s_add_u32 s38, s36, s37
    v_and_b32 v63, 15, v1
    v_add_u32 v14, s38, v63
    v_lshlrev_b32 v16, 3, v14
    v_lshrrev_b32 v15, 3, v1
    v_add_u32 v15, s38, v15
    v_lshlrev_b32 v15, 11, v15
    v_and_b32 v4, 7, v1
    v_lshl_add_u32 v15, v4, 4, v15
    s_lshl_b32 s36, s30, 7
    v_add_u32 v15, s36, v15
    s_lshl_b32 s36, s28, 12
    s_add_u32 s42, s36, 131072
    v_lshl_add_u32 v63, v63, 7, s42
    v_lshl_add_u32 v63, v19, 3, v63
    v_bfe_u32 v20, v1, 2, 2
    v_lshl_add_u32 v18, v19, 2, v20
    v_and_b32 v20, 7, v18
    s_lshl_b32 s36, s63, 2
    s_xor_b32 s36, s36, 4
    v_xor_b32 v20, s36, v20
    v_lshlrev_b32 v18, 8, v18
    s_lshr_b32 s36, s28, 2
    s_lshl_b32 s36, s36, 15
    s_add_u32 s36, s36, 65536
    v_add_u32 v18, s36, v18
    v_and_b32 v21, 3, v1
    v_lshl_add_u32 v18, v21, 3, v18
    v_xor_b32 v21, 0, v20
    v_lshl_add_u32 v50, v21, 5, v18
    v_xor_b32 v21, 1, v20
    v_lshl_add_u32 v51, v21, 5, v18
    v_xor_b32 v21, 2, v20
    v_lshl_add_u32 v52, v21, 5, v18
    v_xor_b32 v21, 3, v20
    v_lshl_add_u32 v53, v21, 5, v18
    v_xor_b32 v21, 4, v20
    v_lshl_add_u32 v54, v21, 5, v18
    v_xor_b32 v21, 5, v20
    v_lshl_add_u32 v55, v21, 5, v18
    v_xor_b32 v21, 6, v20
    v_lshl_add_u32 v56, v21, 5, v18
    v_xor_b32 v21, 7, v20
    v_lshl_add_u32 v57, v21, 5, v18
    s_waitcnt vmcnt(0)
    s_barrier
    s_cmp_eq_u32 s28, 0
    s_cbranch_scc1 L_recurrent_scan__compressed_kv_cla__moe_arch_mod__prompt_kernel_rare_170
L_recurrent_scan__compressed_kv_cla__moe_arch_mod__prompt_kernel_back_171:
    s_bitcmp1_b32 0x70, s28
    s_cbranch_scc1 L_recurrent_scan__compressed_kv_cla__moe_arch_mod__prompt_kernel_f2m_198
L_recurrent_scan__compressed_kv_cla__moe_arch_mod__prompt_kernel_f2a_199:
    s_add_u32 m0, s33, 65536
    s_mov_b32 s32, 0
    buffer_load_dwordx4 v6, s[8:11], s32 offen offset:0 lds
    buffer_load_dwordx4 v7, s[8:11], s32 offen offset:1024 lds
    buffer_load_dwordx4 v8, s[8:11], s32 offen offset:2048 lds
    buffer_load_dwordx4 v9, s[8:11], s32 offen offset:3072 lds
    s_add_u32 m0, s33, 81920
    s_mov_b32 s32, 131072
    buffer_load_dwordx4 v6, s[8:11], s32 offen offset:0 lds
    buffer_load_dwordx4 v7, s[8:11], s32 offen offset:1024 lds
    buffer_load_dwordx4 v8, s[8:11], s32 offen offset:2048 lds
    buffer_load_dwordx4 v9, s[8:11], s32 offen offset:3072 lds
    s_add_u32 m0, s33, 0
    s_mov_b32 s32, 524288
    buffer_load_dwordx4 v6, s[8:11], s32 offen offset:0 lds
    buffer_load_dwordx4 v7, s[8:11], s32 offen offset:1024 lds
    buffer_load_dwordx4 v8, s[8:11], s32 offen offset:2048 lds
    buffer_load_dwordx4 v9, s[8:11], s32 offen offset:3072 lds
    s_add_u32 m0, s33, 16384
    s_mov_b32 s32, 655360
    buffer_load_dwordx4 v6, s[8:11], s32 offen offset:0 lds
    buffer_load_dwordx4 v7, s[8:11], s32 offen offset:1024 lds
    buffer_load_dwordx4 v8, s[8:11], s32 offen offset:2048 lds
    buffer_load_dwordx4 v9, s[8:11], s32 offen offset:3072 lds
    s_cmp_lt_u32 s28, 4
    s_cbranch_scc1 L_recurrent_scan__compressed_kv_cla__moe_arch_mod__prompt_kernel_f2m_198
L_recurrent_scan__compressed_kv_cla__moe_arch_mod__prompt_kernel_f2b_200:
    s_mov_b32 s60, 31
    s_cmp_eq_u32 s28, 3
    s_cbranch_scc0 L_recurrent_scan__compressed_kv_cla__moe_arch_mod__prompt_kernel_w7j_201
    v_min_u32 v58, 3, v1
    s_lshl_b32 s36, s63, 2
    v_add_u32 v58, s36, v58
    s_add_u32 s36, s29, 32
    s_lshl_b32 s36, s36, 7
    v_lshl_add_u32 v58, v58, 2, s36
    s_mov_b32 s44, 3
    s_mov_b32 s61, 0x40000
L_recurrent_scan__compressed_kv_cla__moe_arch_mod__prompt_kernel_cspin_202:
    s_sub_u32 s61, s61, 1
    s_cbranch_scc1 L_recurrent_scan__compressed_kv_cla__moe_arch_mod__prompt_kernel_cspinx_203
    global_load_dword v59, v58, s[90:91] sc1
    s_waitcnt vmcnt(0)
L_recurrent_scan__compressed_kv_cla__moe_arch_mod__prompt_kernel_cchk_204:
    v_cmp_le_u32 vcc, 4, v59
    s_nop 0
    s_and_b32 s60, vcc_lo, 31
    s_and_b32 s36, s60, s44
    s_cmp_eq_u32 s36, s44
    s_cbranch_scc1 L_recurrent_scan__compressed_kv_cla__moe_arch_mod__prompt_kernel_cspinx_203
    s_sleep 6
    s_branch L_recurrent_scan__compressed_kv_cla__moe_arch_mod__prompt_kernel_cspin_202
L_recurrent_scan__compressed_kv_cla__moe_arch_mod__prompt_kernel_cspinx_203:
    s_lshl_b32 s44, s44, 1
    s_or_b32 s44, s44, 1
    s_and_b32 s44, s44, 31
L_recurrent_scan__compressed_kv_cla__moe_arch_mod__prompt_kernel_w7j_201:
    s_waitcnt vmcnt(12)
    s_waitcnt lgkmcnt(0)
    s_barrier
    s_mov_b32 s31, 0
    buffer_load_dwordx4 v[128:131], v2, s[4:7], s31 offen offset:0 sc1
    buffer_load_dwordx4 v[132:135], v3, s[4:7], s31 offen offset:0 sc1
    buffer_load_dwordx4 v[136:139], v2, s[4:7], s31 offen offset:1024 sc1
    buffer_load_dwordx4 v[140:143], v3, s[4:7], s31 offen offset:1024 sc1
    buffer_load_dwordx4 v[144:147], v2, s[4:7], s31 offen offset:2048 sc1
    buffer_load_dwordx4 v[148:151], v3, s[4:7], s31 offen offset:2048 sc1
    buffer_load_dwordx4 v[152:155], v2, s[4:7], s31 offen offset:3072 sc1
    buffer_load_dwordx4 v[156:159], v3, s[4:7], s31 offen offset:3072 sc1
    s_mov_b32 s31, 8192
    s_cmp_lt_u32 s28, 4
    s_cbranch_scc0 L_recurrent_scan__compressed_kv_cla__moe_arch_mod__prompt_kernel_g_172
    s_lshl_b32 s36, s28, 10
    s_add_u32 s36, s36, 131072
    v_lshl_add_u32 v28, v1, 4, s36
    ds_read_b128 v[96:99], v28 offset:0
    ds_read_b128 v[100:103], v28 offset:4096
    ds_read_b128 v[104:107], v28 offset:8192
    ds_read_b128 v[108:111], v28 offset:12288
    ds_read_b128 v[112:115], v28 offset:16384
    ds_read_b128 v[116:119], v28 offset:20480
    ds_read_b128 v[120:123], v28 offset:24576
    s_lshr_b32 s36, s2, 4
    s_lshl_b32 s36, s36, 13
    s_and_b32 s37, s2, 15
    s_lshl_b32 s37, s37, 8
    s_add_u32 s36, s36, s37
    s_lshl_b32 s37, s28, 6
    s_add_u32 s36, s36, s37
    s_add_u32 s36, s36, 59768832
    v_and_b32 v28, 1, v1
    v_lshlrev_b32 v28, 12, v28
    v_lshl_add_u32 v28, v19, 4, v28
    s_waitcnt lgkmcnt(0)
    v_add_f32 v96, v96, v100
    v_add_f32 v97, v97, v101
    v_add_f32 v98, v98, v102
    v_add_f32 v99, v99, v103
    v_add_f32 v96, v96, v104
    v_add_f32 v97, v97, v105
    v_add_f32 v98, v98, v106
    v_add_f32 v99, v99, v107
    v_add_f32 v96, v96, v108
    v_add_f32 v97, v97, v109
    v_add_f32 v98, v98, v110
    v_add_f32 v99, v99, v111
    v_add_f32 v96, v96, v112
    v_add_f32 v97, v97, v113
    v_add_f32 v98, v98, v114
    v_add_f32 v99, v99, v115
    v_add_f32 v96, v96, v116
    v_add_f32 v97, v97, v117
    v_add_f32 v98, v98, v118
    v_add_f32 v99, v99, v119
    v_add_f32 v96, v96, v120
    v_add_f32 v97, v97, v121
    v_add_f32 v98, v98, v122
    v_add_f32 v99, v99, v123
    s_mov_b32 exec_lo, 0x00030003
    s_mov_b32 exec_hi, 0x00030003
    buffer_store_dwordx4 v[96:99], v28, s[24:27], s36 offen sc1
    s_mov_b64 exec, -1
    s_nop 3
L_recurrent_scan__compressed_kv_cla__moe_arch_mod__prompt_kernel_g_172:
    v_lshlrev_b32 v22, 4, v1
    v_mov_b32 v18, v22
    v_add_u32 v20, s42, v22
    v_xor_b32 v21, 16384, v20
    s_lshl_b32 s36, s2, 15
    s_lshl_b32 s37, s28, 12
    s_add_u32 s36, s36, s37
    s_add_u32 s36, s36, 67108864
    s_mov_b32 s41, s36
    s_xor_b32 s39, s36, 131072
    s_add_u32 s40, s2, 128
    s_lshl_b32 s40, s40, 7
    ds_read_b64_tr_b16 v[64:65], v50 offset:0
    ds_read_b64_tr_b16 v[66:67], v50 offset:4096
    ds_read_b64_tr_b16 v[68:69], v51 offset:0
    ds_read_b64_tr_b16 v[70:71], v51 offset:4096
    ds_read_b64_tr_b16 v[72:73], v52 offset:0
    ds_read_b64_tr_b16 v[74:75], v52 offset:4096
    ds_read_b64_tr_b16 v[76:77], v53 offset:0
    ds_read_b64_tr_b16 v[78:79], v53 offset:4096
    ds_read_b64_tr_b16 v[80:81], v54 offset:0
    ds_read_b64_tr_b16 v[82:83], v54 offset:4096
    ds_read_b64_tr_b16 v[84:85], v55 offset:0
    ds_read_b64_tr_b16 v[86:87], v55 offset:4096
    s_waitcnt vmcnt(6)
    buffer_load_dwordx4 v[160:163], v2, s[4:7], s31 offen offset:0 sc1
    buffer_load_dwordx4 v[164:167], v3, s[4:7], s31 offen offset:0 sc1
    buffer_load_dwordx4 v[168:171], v2, s[4:7], s31 offen offset:1024 sc1
    buffer_load_dwordx4 v[172:175], v3, s[4:7], s31 offen offset:1024 sc1
    s_waitcnt lgkmcnt(8)
    v_mfma_f32_16x16x32_bf16 v[192:195], v[64:67], v[128:131], 0
    ds_read_b64_tr_b16 v[88:89], v56 offset:0
    buffer_load_dwordx4 v[176:179], v2, s[4:7], s31 offen offset:2048 sc1
    v_mfma_f32_16x16x32_bf16 v[224:227], v[64:67], v[132:135], 0
    ds_read_b64_tr_b16 v[90:91], v56 offset:4096
    v_mfma_f32_16x16x32_bf16 v[196:199], v[68:71], v[128:131], 0
    ds_read_b64_tr_b16 v[92:93], v57 offset:0
    v_mfma_f32_16x16x32_bf16 v[228:231], v[68:71], v[132:135], 0
    ds_read_b64_tr_b16 v[94:95], v57 offset:4096
    s_waitcnt lgkmcnt(8)
    v_mfma_f32_16x16x32_bf16 v[200:203], v[72:75], v[128:131], 0
    ds_read_b64_tr_b16 v[64:65], v50 offset:8192
    buffer_load_dwordx4 v[180:183], v3, s[4:7], s31 offen offset:2048 sc1
    v_mfma_f32_16x16x32_bf16 v[232:235], v[72:75], v[132:135], 0
    ds_read_b64_tr_b16 v[66:67], v50 offset:12288
    v_mfma_f32_16x16x32_bf16 v[204:207], v[76:79], v[128:131], 0
    ds_read_b64_tr_b16 v[68:69], v51 offset:8192
    v_mfma_f32_16x16x32_bf16 v[236:239], v[76:79], v[132:135], 0
    ds_read_b64_tr_b16 v[70:71], v51 offset:12288
    s_waitcnt lgkmcnt(8)
    v_mfma_f32_16x16x32_bf16 v[208:211], v[80:83], v[128:131], 0
    ds_read_b64_tr_b16 v[72:73], v52 offset:8192
    buffer_load_dwordx4 v[184:187], v2, s[4:7], s31 offen offset:3072 sc1
    v_mfma_f32_16x16x32_bf16 v[240:243], v[80:83], v[132:135], 0
    ds_read_b64_tr_b16 v[74:75], v52 offset:12288
    v_mfma_f32_16x16x32_bf16 v[212:215], v[84:87], v[128:131], 0
    ds_read_b64_tr_b16 v[76:77], v53 offset:8192
    v_mfma_f32_16x16x32_bf16 v[244:247], v[84:87], v[132:135], 0
    ds_read_b64_tr_b16 v[78:79], v53 offset:12288
    s_waitcnt lgkmcnt(8)
    v_mfma_f32_16x16x32_bf16 v[216:219], v[88:91], v[128:131], 0
    ds_read_b64_tr_b16 v[80:81], v54 offset:8192
    buffer_load_dwordx4 v[188:191], v3, s[4:7], s31 offen offset:3072 sc1
    v_mfma_f32_16x16x32_bf16 v[248:251], v[88:91], v[132:135], 0
    ds_read_b64_tr_b16 v[82:83], v54 offset:12288
    v_mfma_f32_16x16x32_bf16 v[220:223], v[92:95], v[128:131], 0
    ds_read_b64_tr_b16 v[84:85], v55 offset:8192
    v_mfma_f32_16x16x32_bf16 v[252:255], v[92:95], v[132:135], 0
    ds_read_b64_tr_b16 v[86:87], v55 offset:12288
    s_waitcnt lgkmcnt(8)
    s_waitcnt vmcnt(12)
    v_mfma_f32_16x16x32_bf16 v[192:195], v[64:67], v[136:139], v[192:195]
    ds_read_b64_tr_b16 v[88:89], v56 offset:8192
    v_mfma_f32_16x16x32_bf16 v[224:227], v[64:67], v[140:143], v[224:227]
    ds_read_b64_tr_b16 v[90:91], v56 offset:12288
    s_mov_b32 s31, 16384
    buffer_load_dwordx4 v[128:131], v2, s[4:7], s31 offen offset:0 sc1
    v_mfma_f32_16x16x32_bf16 v[196:199], v[68:71], v[136:139], v[196:199]
    ds_read_b64_tr_b16 v[92:93], v57 offset:8192
    v_mfma_f32_16x16x32_bf16 v[228:231], v[68:71], v[140:143], v[228:231]
    ds_read_b64_tr_b16 v[94:95], v57 offset:12288
    s_waitcnt lgkmcnt(8)
    v_mfma_f32_16x16x32_bf16 v[200:203], v[72:75], v[136:139], v[200:203]
    v_mfma_f32_16x16x32_bf16 v[232:235], v[72:75], v[140:143], v[232:235]
    buffer_load_dwordx4 v[132:135], v3, s[4:7], s31 offen offset:0 sc1
    v_mfma_f32_16x16x32_bf16 v[204:207], v[76:79], v[136:139], v[204:207]
    v_mfma_f32_16x16x32_bf16 v[236:239], v[76:79], v[140:143], v[236:239]
    s_waitcnt lgkmcnt(0)
    s_barrier
    v_mfma_f32_16x16x32_bf16 v[208:211], v[80:83], v[136:139], v[208:211]
    ds_read_b64_tr_b16 v[64:65], v50 offset:16384
    ds_read_b64_tr_b16 v[66:67], v50 offset:20480
    v_mfma_f32_16x16x32_bf16 v[240:243], v[80:83], v[140:143], v[240:243]
    ds_read_b64_tr_b16 v[68:69], v51 offset:16384
    ds_read_b64_tr_b16 v[70:71], v51 offset:20480
    s_add_u32 m0, s33, 65536
    s_mov_b32 s32, 1048576
    buffer_load_dwordx4 v6, s[8:11], s32 offen offset:0 lds
    v_mfma_f32_16x16x32_bf16 v[212:215], v[84:87], v[136:139], v[212:215]
    ds_read_b64_tr_b16 v[72:73], v52 offset:16384
    ds_read_b64_tr_b16 v[74:75], v52 offset:20480
    v_mfma_f32_16x16x32_bf16 v[244:247], v[84:87], v[140:143], v[244:247]
    ds_read_b64_tr_b16 v[76:77], v53 offset:16384
    ds_read_b64_tr_b16 v[78:79], v53 offset:20480
    v_mfma_f32_16x16x32_bf16 v[216:219], v[88:91], v[136:139], v[216:219]
    ds_read_b64_tr_b16 v[80:81], v54 offset:16384
    ds_read_b64_tr_b16 v[82:83], v54 offset:20480
    v_mfma_f32_16x16x32_bf16 v[248:251], v[88:91], v[140:143], v[248:251]
    buffer_load_dwordx4 v7, s[8:11], s32 offen offset:1024 lds
    v_mfma_f32_16x16x32_bf16 v[220:223], v[92:95], v[136:139], v[220:223]
    ds_read_b64_tr_b16 v[84:85], v55 offset:16384
    ds_read_b64_tr_b16 v[86:87], v55 offset:20480
    v_mfma_f32_16x16x32_bf16 v[252:255], v[92:95], v[140:143], v[252:255]
    s_waitcnt lgkmcnt(8)
    s_waitcnt vmcnt(14)
    v_mfma_f32_16x16x32_bf16 v[192:195], v[64:67], v[144:147], v[192:195]
    ds_read_b64_tr_b16 v[88:89], v56 offset:16384
    v_mfma_f32_16x16x32_bf16 v[224:227], v[64:67], v[148:151], v[224:227]
    ds_read_b64_tr_b16 v[90:91], v56 offset:20480
    v_mfma_f32_16x16x32_bf16 v[196:199], v[68:71], v[144:147], v[196:199]
    ds_read_b64_tr_b16 v[92:93], v57 offset:16384
    buffer_load_dwordx4 v8, s[8:11], s32 offen offset:2048 lds
    v_mfma_f32_16x16x32_bf16 v[228:231], v[68:71], v[148:151], v[228:231]
    ds_read_b64_tr_b16 v[94:95], v57 offset:20480
    s_waitcnt lgkmcnt(8)
    v_mfma_f32_16x16x32_bf16 v[200:203], v[72:75], v[144:147], v[200:203]
    ds_read_b64_tr_b16 v[64:65], v50 offset:24576
    v_mfma_f32_16x16x32_bf16 v[232:235], v[72:75], v[148:151], v[232:235]
    ds_read_b64_tr_b16 v[66:67], v50 offset:28672
    v_xor_b32 v50, 65536, v50
    v_mfma_f32_16x16x32_bf16 v[204:207], v[76:79], v[144:147], v[204:207]
    ds_read_b64_tr_b16 v[68:69], v51 offset:24576
    buffer_load_dwordx4 v9, s[8:11], s32 offen offset:3072 lds
    v_mfma_f32_16x16x32_bf16 v[236:239], v[76:79], v[148:151], v[236:239]
    ds_read_b64_tr_b16 v[70:71], v51 offset:28672
    v_xor_b32 v51, 65536, v51
    s_waitcnt lgkmcnt(8)
    v_mfma_f32_16x16x32_bf16 v[208:211], v[80:83], v[144:147], v[208:211]
    ds_read_b64_tr_b16 v[72:73], v52 offset:24576
    v_mfma_f32_16x16x32_bf16 v[240:243], v[80:83], v[148:151], v[240:243]
    ds_read_b64_tr_b16 v[74:75], v52 offset:28672
    v_xor_b32 v52, 65536, v52
    v_mfma_f32_16x16x32_bf16 v[212:215], v[84:87], v[144:147], v[212:215]
    ds_read_b64_tr_b16 v[76:77], v53 offset:24576
    buffer_load_dwordx4 v[136:139], v2, s[4:7], s31 offen offset:1024 sc1
    v_mfma_f32_16x16x32_bf16 v[244:247], v[84:87], v[148:151], v[244:247]
    ds_read_b64_tr_b16 v[78:79], v53 offset:28672
    v_xor_b32 v53, 65536, v53
    s_waitcnt lgkmcnt(8)
    v_mfma_f32_16x16x32_bf16 v[216:219], v[88:91], v[144:147], v[216:219]
    ds_read_b64_tr_b16 v[80:81], v54 offset:24576
    v_mfma_f32_16x16x32_bf16 v[248:251], v[88:91], v[148:151], v[248:251]
    ds_read_b64_tr_b16 v[82:83], v54 offset:28672
    v_xor_b32 v54, 65536, v54
    v_mfma_f32_16x16x32_bf16 v[220:223], v[92:95], v[144:147], v[220:223]
    ds_read_b64_tr_b16 v[84:85], v55 offset:24576
    buffer_load_dwordx4 v[140:143], v3, s[4:7], s31 offen offset:1024 sc1
    v_mfma_f32_16x16x32_bf16 v[252:255], v[92:95], v[148:151], v[252:255]
    ds_read_b64_tr_b16 v[86:87], v55 offset:28672
    v_xor_b32 v55, 65536, v55
    s_waitcnt lgkmcnt(8)
    s_waitcnt vmcnt(16)
    v_mfma_f32_16x16x32_bf16 v[192:195], v[64:67], v[152:155], v[192:195]
    ds_read_b64_tr_b16 v[88:89], v56 offset:24576
    v_mfma_f32_16x16x32_bf16 v[224:227], v[64:67], v[156:159], v[224:227]
    ds_read_b64_tr_b16 v[90:91], v56 offset:28672
    v_xor_b32 v56, 65536, v56
    v_mfma_f32_16x16x32_bf16 v[196:199], v[68:71], v[152:155], v[196:199]
    ds_read_b64_tr_b16 v[92:93], v57 offset:24576
    v_mfma_f32_16x16x32_bf16 v[228:231], v[68:71], v[156:159], v[228:231]
    ds_read_b64_tr_b16 v[94:95], v57 offset:28672
    v_xor_b32 v57, 65536, v57
    buffer_load_dwordx4 v[144:147], v2, s[4:7], s31 offen offset:2048 sc1
    s_waitcnt lgkmcnt(8)
    v_mfma_f32_16x16x32_bf16 v[200:203], v[72:75], v[152:155], v[200:203]
    v_mfma_f32_16x16x32_bf16 v[232:235], v[72:75], v[156:159], v[232:235]
    v_mfma_f32_16x16x32_bf16 v[204:207], v[76:79], v[152:155], v[204:207]
    v_mfma_f32_16x16x32_bf16 v[236:239], v[76:79], v[156:159], v[236:239]
    buffer_load_dwordx4 v[148:151], v3, s[4:7], s31 offen offset:2048 sc1
    s_waitcnt lgkmcnt(0)
    s_barrier
    v_mfma_f32_16x16x32_bf16 v[208:211], v[80:83], v[152:155], v[208:211]
    ds_read_b64_tr_b16 v[64:65], v50 offset:0
    ds_read_b64_tr_b16 v[66:67], v50 offset:4096
    v_mfma_f32_16x16x32_bf16 v[240:243], v[80:83], v[156:159], v[240:243]
    ds_read_b64_tr_b16 v[68:69], v51 offset:0
    ds_read_b64_tr_b16 v[70:71], v51 offset:4096
    v_mfma_f32_16x16x32_bf16 v[212:215], v[84:87], v[152:155], v[212:215]
    ds_read_b64_tr_b16 v[72:73], v52 offset:0
    ds_read_b64_tr_b16 v[74:75], v52 offset:4096
    v_mfma_f32_16x16x32_bf16 v[244:247], v[84:87], v[156:159], v[244:247]
    ds_read_b64_tr_b16 v[76:77], v53 offset:0
    ds_read_b64_tr_b16 v[78:79], v53 offset:4096
    s_add_u32 m0, s33, 81920
    s_mov_b32 s32, 1179648
    buffer_load_dwordx4 v6, s[8:11], s32 offen offset:0 lds
    v_mfma_f32_16x16x32_bf16 v[216:219], v[88:91], v[152:155], v[216:219]
    ds_read_b64_tr_b16 v[80:81], v54 offset:0
    ds_read_b64_tr_b16 v[82:83], v54 offset:4096
    v_mfma_f32_16x16x32_bf16 v[248:251], v[88:91], v[156:159], v[248:251]
    v_mfma_f32_16x16x32_bf16 v[220:223], v[92:95], v[152:155], v[220:223]
    ds_read_b64_tr_b16 v[84:85], v55 offset:0
    ds_read_b64_tr_b16 v[86:87], v55 offset:4096
    v_mfma_f32_16x16x32_bf16 v[252:255], v[92:95], v[156:159], v[252:255]
    buffer_load_dwordx4 v7, s[8:11], s32 offen offset:1024 lds
    s_waitcnt lgkmcnt(8)
    s_waitcnt vmcnt(18)
    v_mfma_f32_16x16x32_bf16 v[192:195], v[64:67], v[160:163], v[192:195]
    ds_read_b64_tr_b16 v[88:89], v56 offset:0
    v_mfma_f32_16x16x32_bf16 v[224:227], v[64:67], v[164:167], v[224:227]
    ds_read_b64_tr_b16 v[90:91], v56 offset:4096
    v_mfma_f32_16x16x32_bf16 v[196:199], v[68:71], v[160:163], v[196:199]
    ds_read_b64_tr_b16 v[92:93], v57 offset:0
    v_mfma_f32_16x16x32_bf16 v[228:231], v[68:71], v[164:167], v[228:231]
    ds_read_b64_tr_b16 v[94:95], v57 offset:4096
    s_waitcnt lgkmcnt(8)
    v_mfma_f32_16x16x32_bf16 v[200:203], v[72:75], v[160:163], v[200:203]
    ds_read_b64_tr_b16 v[64:65], v50 offset:8192
    buffer_load_dwordx4 v8, s[8:11], s32 offen offset:2048 lds
    v_mfma_f32_16x16x32_bf16 v[232:235], v[72:75], v[164:167], v[232:235]
    ds_read_b64_tr_b16 v[66:67], v50 offset:12288
    v_mfma_f32_16x16x32_bf16 v[204:207], v[76:79], v[160:163], v[204:207]
    ds_read_b64_tr_b16 v[68:69], v51 offset:8192
    v_mfma_f32_16x16x32_bf16 v[236:239], v[76:79], v[164:167], v[236:239]
    ds_read_b64_tr_b16 v[70:71], v51 offset:12288
    s_waitcnt lgkmcnt(8)
    v_mfma_f32_16x16x32_bf16 v[208:211], v[80:83], v[160:163], v[208:211]
    ds_read_b64_tr_b16 v[72:73], v52 offset:8192
    buffer_load_dwordx4 v9, s[8:11], s32 offen offset:3072 lds
    v_mfma_f32_16x16x32_bf16 v[240:243], v[80:83], v[164:167], v[240:243]
    ds_read_b64_tr_b16 v[74:75], v52 offset:12288
    v_mfma_f32_16x16x32_bf16 v[212:215], v[84:87], v[160:163], v[212:215]
    ds_read_b64_tr_b16 v[76:77], v53 offset:8192
    v_mfma_f32_16x16x32_bf16 v[244:247], v[84:87], v[164:167], v[244:247]
    ds_read_b64_tr_b16 v[78:79], v53 offset:12288
    s_waitcnt lgkmcnt(8)
    v_mfma_f32_16x16x32_bf16 v[216:219], v[88:91], v[160:163], v[216:219]
    ds_read_b64_tr_b16 v[80:81], v54 offset:8192
    buffer_load_dwordx4 v[152:155], v2, s[4:7], s31 offen offset:3072 sc1
    v_mfma_f32_16x16x32_bf16 v[248:251], v[88:91], v[164:167], v[248:251]
    ds_read_b64_tr_b16 v[82:83], v54 offset:12288
    v_mfma_f32_16x16x32_bf16 v[220:223], v[92:95], v[160:163], v[220:223]
    ds_read_b64_tr_b16 v[84:85], v55 offset:8192
    v_mfma_f32_16x16x32_bf16 v[252:255], v[92:95], v[164:167], v[252:255]
    ds_read_b64_tr_b16 v[86:87], v55 offset:12288
    s_waitcnt lgkmcnt(8)
    s_waitcnt vmcnt(19)
    v_mfma_f32_16x16x32_bf16 v[192:195], v[64:67], v[168:171], v[192:195]
    ds_read_b64_tr_b16 v[88:89], v56 offset:8192
    buffer_load_dwordx4 v[156:159], v3, s[4:7], s31 offen offset:3072 sc1
    v_mfma_f32_16x16x32_bf16 v[224:227], v[64:67], v[172:175], v[224:227]
    ds_read_b64_tr_b16 v[90:91], v56 offset:12288
    v_mfma_f32_16x16x32_bf16 v[196:199], v[68:71], v[168:171], v[196:199]
    ds_read_b64_tr_b16 v[92:93], v57 offset:8192
    v_mfma_f32_16x16x32_bf16 v[228:231], v[68:71], v[172:175], v[228:231]
    ds_read_b64_tr_b16 v[94:95], v57 offset:12288
    s_waitcnt lgkmcnt(8)
    v_mfma_f32_16x16x32_bf16 v[200:203], v[72:75], v[168:171], v[200:203]
    v_mfma_f32_16x16x32_bf16 v[232:235], v[72:75], v[172:175], v[232:235]
    s_mov_b32 s31, 24576
    buffer_load_dwordx4 v[160:163], v2, s[4:7], s31 offen offset:0 sc1
    v_mfma_f32_16x16x32_bf16 v[204:207], v[76:79], v[168:171], v[204:207]
    v_mfma_f32_16x16x32_bf16 v[236:239], v[76:79], v[172:175], v[236:239]
    s_waitcnt lgkmcnt(0)
    s_barrier
    v_mfma_f32_16x16x32_bf16 v[208:211], v[80:83], v[168:171], v[208:211]
    ds_read_b64_tr_b16 v[64:65], v50 offset:16384
    ds_read_b64_tr_b16 v[66:67], v50 offset:20480
    v_mfma_f32_16x16x32_bf16 v[240:243], v[80:83], v[172:175], v[240:243]
    ds_read_b64_tr_b16 v[68:69], v51 offset:16384
    ds_read_b64_tr_b16 v[70:71], v51 offset:20480
    s_add_u32 m0, s33, 0
    s_mov_b32 s32, 1572864
    buffer_load_dwordx4 v6, s[8:11], s32 offen offset:0 lds
    v_mfma_f32_16x16x32_bf16 v[212:215], v[84:87], v[168:171], v[212:215]
    ds_read_b64_tr_b16 v[72:73], v52 offset:16384
    ds_read_b64_tr_b16 v[74:75], v52 offset:20480
    s_cmp_eq_u32 s28, 0
    s_cbranch_scc1 L_recurrent_scan__compressed_kv_cla__moe_arch_mod__prompt_kernel_rare_174
L_recurrent_scan__compressed_kv_cla__moe_arch_mod__prompt_kernel_back_175:
    v_mfma_f32_16x16x32_bf16 v[244:247], v[84:87], v[172:175], v[244:247]
    ds_read_b64_tr_b16 v[76:77], v53 offset:16384
    ds_read_b64_tr_b16 v[78:79], v53 offset:20480
    v_mfma_f32_16x16x32_bf16 v[216:219], v[88:91], v[168:171], v[216:219]
    ds_read_b64_tr_b16 v[80:81], v54 offset:16384
    ds_read_b64_tr_b16 v[82:83], v54 offset:20480
    v_mfma_f32_16x16x32_bf16 v[248:251], v[88:91], v[172:175], v[248:251]
    buffer_load_dwordx4 v7, s[8:11], s32 offen offset:1024 lds
    v_mfma_f32_16x16x32_bf16 v[220:223], v[92:95], v[168:171], v[220:223]
    ds_read_b64_tr_b16 v[84:85], v55 offset:16384
    ds_read_b64_tr_b16 v[86:87], v55 offset:20480
    v_mfma_f32_16x16x32_bf16 v[252:255], v[92:95], v[172:175], v[252:255]
    s_waitcnt lgkmcnt(8)
    s_waitcnt vmcnt(21)
    v_mfma_f32_16x16x32_bf16 v[192:195], v[64:67], v[176:179], v[192:195]
    ds_read_b64_tr_b16 v[88:89], v56 offset:16384
    v_mfma_f32_16x16x32_bf16 v[224:227], v[64:67], v[180:183], v[224:227]
    ds_read_b64_tr_b16 v[90:91], v56 offset:20480
    buffer_load_dwordx4 v8, s[8:11], s32 offen offset:2048 lds
    v_mfma_f32_16x16x32_bf16 v[196:199], v[68:71], v[176:179], v[196:199]
    ds_read_b64_tr_b16 v[92:93], v57 offset:16384
    v_mfma_f32_16x16x32_bf16 v[228:231], v[68:71], v[180:183], v[228:231]
    ds_read_b64_tr_b16 v[94:95], v57 offset:20480
    s_waitcnt lgkmcnt(8)
    v_mfma_f32_16x16x32_bf16 v[200:203], v[72:75], v[176:179], v[200:203]
    ds_read_b64_tr_b16 v[64:65], v50 offset:24576
    v_mfma_f32_16x16x32_bf16 v[232:235], v[72:75], v[180:183], v[232:235]
    ds_read_b64_tr_b16 v[66:67], v50 offset:28672
    v_xor_b32 v50, 65536, v50
    v_mfma_f32_16x16x32_bf16 v[204:207], v[76:79], v[176:179], v[204:207]
    ds_read_b64_tr_b16 v[68:69], v51 offset:24576
    buffer_load_dwordx4 v9, s[8:11], s32 offen offset:3072 lds
    v_mfma_f32_16x16x32_bf16 v[236:239], v[76:79], v[180:183], v[236:239]
    ds_read_b64_tr_b16 v[70:71], v51 offset:28672
    v_xor_b32 v51, 65536, v51
    s_waitcnt lgkmcnt(8)
    v_mfma_f32_16x16x32_bf16 v[208:211], v[80:83], v[176:179], v[208:211]
    ds_read_b64_tr_b16 v[72:73], v52 offset:24576
    v_mfma_f32_16x16x32_bf16 v[240:243], v[80:83], v[180:183], v[240:243]
    ds_read_b64_tr_b16 v[74:75], v52 offset:28672
    v_xor_b32 v52, 65536, v52
    v_mfma_f32_16x16x32_bf16 v[212:215], v[84:87], v[176:179], v[212:215]
    ds_read_b64_tr_b16 v[76:77], v53 offset:24576
    buffer_load_dwordx4 v[164:167], v3, s[4:7], s31 offen offset:0 sc1
    v_mfma_f32_16x16x32_bf16 v[244:247], v[84:87], v[180:183], v[244:247]
    ds_read_b64_tr_b16 v[78:79], v53 offset:28672
    v_xor_b32 v53, 65536, v53
    s_waitcnt lgkmcnt(8)
    v_mfma_f32_16x16x32_bf16 v[216:219], v[88:91], v[176:179], v[216:219]
    ds_read_b64_tr_b16 v[80:81], v54 offset:24576
    v_mfma_f32_16x16x32_bf16 v[248:251], v[88:91], v[180:183], v[248:251]
    ds_read_b64_tr_b16 v[82:83], v54 offset:28672
    v_xor_b32 v54, 65536, v54
    v_mfma_f32_16x16x32_bf16 v[220:223], v[92:95], v[176:179], v[220:223]
    ds_read_b64_tr_b16 v[84:85], v55 offset:24576
    buffer_load_dwordx4 v[168:171], v2, s[4:7], s31 offen offset:1024 sc1
    v_mfma_f32_16x16x32_bf16 v[252:255], v[92:95], v[180:183], v[252:255]
    ds_read_b64_tr_b16 v[86:87], v55 offset:28672
    v_xor_b32 v55, 65536, v55
    s_waitcnt lgkmcnt(8)
    s_waitcnt vmcnt(23)
    v_mfma_f32_16x16x32_bf16 v[192:195], v[64:67], v[184:187], v[192:195]
    ds_read_b64_tr_b16 v[88:89], v56 offset:24576
    v_mfma_f32_16x16x32_bf16 v[224:227], v[64:67], v[188:191], v[224:227]
    ds_read_b64_tr_b16 v[90:91], v56 offset:28672
    v_xor_b32 v56, 65536, v56
    v_mfma_f32_16x16x32_bf16 v[196:199], v[68:71], v[184:187], v[196:199]
    ds_read_b64_tr_b16 v[92:93], v57 offset:24576
    v_mfma_f32_16x16x32_bf16 v[228:231], v[68:71], v[188:191], v[228:231]
    ds_read_b64_tr_b16 v[94:95], v57 offset:28672
    v_xor_b32 v57, 65536, v57
    buffer_load_dwordx4 v[172:175], v3, s[4:7], s31 offen offset:1024 sc1
    s_waitcnt lgkmcnt(8)
    v_mfma_f32_16x16x32_bf16 v[200:203], v[72:75], v[184:187], v[200:203]
    v_mfma_f32_16x16x32_bf16 v[232:235], v[72:75], v[188:191], v[232:235]
    v_mfma_f32_16x16x32_bf16 v[204:207], v[76:79], v[184:187], v[204:207]
    v_mfma_f32_16x16x32_bf16 v[236:239], v[76:79], v[188:191], v[236:239]
    buffer_load_dwordx4 v[176:179], v2, s[4:7], s31 offen offset:2048 sc1
    s_waitcnt lgkmcnt(0)
    s_waitcnt vmcnt(19)
    s_barrier
    v_mfma_f32_16x16x32_bf16 v[208:211], v[80:83], v[184:187], v[208:211]
    ds_read_b64_tr_b16 v[64:65], v50 offset:0
    ds_read_b64_tr_b16 v[66:67], v50 offset:4096
    v_mfma_f32_16x16x32_bf16 v[240:243], v[80:83], v[188:191], v[240:243]
    ds_read_b64_tr_b16 v[68:69], v51 offset:0
    ds_read_b64_tr_b16 v[70:71], v51 offset:4096
    s_cmp_lt_u32 s60, 31
    s_cbranch_scc1 L_recurrent_scan__compressed_kv_cla__moe_arch_mod__prompt_kernel_rare_176
L_recurrent_scan__compressed_kv_cla__moe_arch_mod__prompt_kernel_back_177:
    v_mfma_f32_16x16x32_bf16 v[212:215], v[84:87], v[184:187], v[212:215]
    ds_read_b64_tr_b16 v[72:73], v52 offset:0
    ds_read_b64_tr_b16 v[74:75], v52 offset:4096
    v_mfma_f32_16x16x32_bf16 v[244:247], v[84:87], v[188:191], v[244:247]
    ds_read_b64_tr_b16 v[76:77], v53 offset:0
    ds_read_b64_tr_b16 v[78:79], v53 offset:4096
    s_add_u32 m0, s33, 16384
    s_mov_b32 s32, 1703936
    buffer_load_dwordx4 v6, s[8:11], s32 offen offset:0 lds
    v_mfma_f32_16x16x32_bf16 v[216:219], v[88:91], v[184:187], v[216:219]
    ds_read_b64_tr_b16 v[80:81], v54 offset:0
    ds_read_b64_tr_b16 v[82:83], v54 offset:4096
    v_mfma_f32_16x16x32_bf16 v[248:251], v[88:91], v[188:191], v[248:251]
    v_mfma_f32_16x16x32_bf16 v[220:223], v[92:95], v[184:187], v[220:223]
    ds_read_b64_tr_b16 v[84:85], v55 offset:0
    ds_read_b64_tr_b16 v[86:87], v55 offset:4096
    v_mfma_f32_16x16x32_bf16 v[252:255], v[92:95], v[188:191], v[252:255]
    buffer_load_dwordx4 v7, s[8:11], s32 offen offset:1024 lds
    s_waitcnt lgkmcnt(8)
    v_mfma_f32_16x16x32_bf16 v[192:195], v[64:67], v[128:131], v[192:195]
    ds_read_b64_tr_b16 v[88:89], v56 offset:0
    v_mfma_f32_16x16x32_bf16 v[224:227], v[64:67], v[132:135], v[224:227]
    ds_read_b64_tr_b16 v[90:91], v56 offset:4096
    v_mfma_f32_16x16x32_bf16 v[196:199], v[68:71], v[128:131], v[196:199]
    ds_read_b64_tr_b16 v[92:93], v57 offset:0
    v_mfma_f32_16x16x32_bf16 v[228:231], v[68:71], v[132:135], v[228:231]
    ds_read_b64_tr_b16 v[94:95], v57 offset:4096
    s_waitcnt lgkmcnt(8)
    v_mfma_f32_16x16x32_bf16 v[200:203], v[72:75], v[128:131], v[200:203]
    ds_read_b64_tr_b16 v[64:65], v50 offset:8192
    buffer_load_dwordx4 v8, s[8:11], s32 offen offset:2048 lds
    v_mfma_f32_16x16x32_bf16 v[232:235], v[72:75], v[132:135], v[232:235]
    ds_read_b64_tr_b16 v[66:67], v50 offset:12288
    v_mfma_f32_16x16x32_bf16 v[204:207], v[76:79], v[128:131], v[204:207]
    ds_read_b64_tr_b16 v[68:69], v51 offset:8192
    v_mfma_f32_16x16x32_bf16 v[236:239], v[76:79], v[132:135], v[236:239]
    ds_read_b64_tr_b16 v[70:71], v51 offset:12288
    s_waitcnt lgkmcnt(8)
    v_mfma_f32_16x16x32_bf16 v[208:211], v[80:83], v[128:131], v[208:211]
    ds_read_b64_tr_b16 v[72:73], v52 offset:8192
    buffer_load_dwordx4 v9, s[8:11], s32 offen offset:3072 lds
    v_mfma_f32_16x16x32_bf16 v[240:243], v[80:83], v[132:135], v[240:243]
    ds_read_b64_tr_b16 v[74:75], v52 offset:12288
    v_mfma_f32_16x16x32_bf16 v[212:215], v[84:87], v[128:131], v[212:215]
    ds_read_b64_tr_b16 v[76:77], v53 offset:8192
    v_mfma_f32_16x16x32_bf16 v[244:247], v[84:87], v[132:135], v[244:247]
    ds_read_b64_tr_b16 v[78:79], v53 offset:12288
    s_waitcnt lgkmcnt(8)
    v_mfma_f32_16x16x32_bf16 v[216:219], v[88:91], v[128:131], v[216:219]
    ds_read_b64_tr_b16 v[80:81], v54 offset:8192
    buffer_load_dwordx4 v[180:183], v3, s[4:7], s31 offen offset:2048 sc1
    v_mfma_f32_16x16x32_bf16 v[248:251], v[88:91], v[132:135], v[248:251]
    ds_read_b64_tr_b16 v[82:83], v54 offset:12288
    v_mfma_f32_16x16x32_bf16 v[220:223], v[92:95], v[128:131], v[220:223]
    ds_read_b64_tr_b16 v[84:85], v55 offset:8192
    v_mfma_f32_16x16x32_bf16 v[252:255], v[92:95], v[132:135], v[252:255]
    ds_read_b64_tr_b16 v[86:87], v55 offset:12288
    s_waitcnt lgkmcnt(8)
    s_waitcnt vmcnt(22)
    v_mfma_f32_16x16x32_bf16 v[192:195], v[64:67], v[136:139], v[192:195]
    ds_read_b64_tr_b16 v[88:89], v56 offset:8192
    buffer_load_dwordx4 v[184:187], v2, s[4:7], s31 offen offset:3072 sc1
    v_mfma_f32_16x16x32_bf16 v[224:227], v[64:67], v[140:143], v[224:227]
    ds_read_b64_tr_b16 v[90:91], v56 offset:12288
    v_mfma_f32_16x16x32_bf16 v[196:199], v[68:71], v[136:139], v[196:199]
    ds_read_b64_tr_b16 v[92:93], v57 offset:8192
    v_mfma_f32_16x16x32_bf16 v[228:231], v[68:71], v[140:143], v[228:231]
    ds_read_b64_tr_b16 v[94:95], v57 offset:12288
    s_waitcnt lgkmcnt(8)
    v_mfma_f32_16x16x32_bf16 v[200:203], v[72:75], v[136:139], v[200:203]
    v_mfma_f32_16x16x32_bf16 v[232:235], v[72:75], v[140:143], v[232:235]
    buffer_load_dwordx4 v[188:191], v3, s[4:7], s31 offen offset:3072 sc1
    v_mfma_f32_16x16x32_bf16 v[204:207], v[76:79], v[136:139], v[204:207]
    v_mfma_f32_16x16x32_bf16 v[236:239], v[76:79], v[140:143], v[236:239]
    s_cmp_lt_u32 s60, 31
    s_cbranch_scc1 L_recurrent_scan__compressed_kv_cla__moe_arch_mod__prompt_kernel_rare_181
L_recurrent_scan__compressed_kv_cla__moe_arch_mod__prompt_kernel_back_182:
    s_waitcnt lgkmcnt(0)
    s_waitcnt vmcnt(18)
    s_barrier
    v_mfma_f32_16x16x32_bf16 v[208:211], v[80:83], v[136:139], v[208:211]
    ds_read_b64_tr_b16 v[64:65], v50 offset:16384
    ds_read_b64_tr_b16 v[66:67], v50 offset:20480
    v_mfma_f32_16x16x32_bf16 v[240:243], v[80:83], v[140:143], v[240:243]
    ds_read_b64_tr_b16 v[68:69], v51 offset:16384
    ds_read_b64_tr_b16 v[70:71], v51 offset:20480
    s_add_u32 m0, s33, 65536
    s_mov_b32 s32, 2097152
    buffer_load_dwordx4 v6, s[8:11], s32 offen offset:0 lds
    v_mfma_f32_16x16x32_bf16 v[212:215], v[84:87], v[136:139], v[212:215]
    ds_read_b64_tr_b16 v[72:73], v52 offset:16384
    ds_read_b64_tr_b16 v[74:75], v52 offset:20480
    v_mfma_f32_16x16x32_bf16 v[244:247], v[84:87], v[140:143], v[244:247]
    ds_read_b64_tr_b16 v[76:77], v53 offset:16384
    ds_read_b64_tr_b16 v[78:79], v53 offset:20480
    v_mfma_f32_16x16x32_bf16 v[216:219], v[88:91], v[136:139], v[216:219]
    ds_read_b64_tr_b16 v[80:81], v54 offset:16384
    ds_read_b64_tr_b16 v[82:83], v54 offset:20480
    v_mfma_f32_16x16x32_bf16 v[248:251], v[88:91], v[140:143], v[248:251]
    buffer_load_dwordx4 v7, s[8:11], s32 offen offset:1024 lds
    v_mfma_f32_16x16x32_bf16 v[220:223], v[92:95], v[136:139], v[220:223]
    ds_read_b64_tr_b16 v[84:85], v55 offset:16384
    ds_read_b64_tr_b16 v[86:87], v55 offset:20480
    v_mfma_f32_16x16x32_bf16 v[252:255], v[92:95], v[140:143], v[252:255]
    s_waitcnt lgkmcnt(8)
    v_mfma_f32_16x16x32_bf16 v[192:195], v[64:67], v[144:147], v[192:195]
    ds_read_b64_tr_b16 v[88:89], v56 offset:16384
    v_mfma_f32_16x16x32_bf16 v[224:227], v[64:67], v[148:151], v[224:227]
    ds_read_b64_tr_b16 v[90:91], v56 offset:20480
    buffer_load_dwordx4 v8, s[8:11], s32 offen offset:2048 lds
    v_mfma_f32_16x16x32_bf16 v[196:199], v[68:71], v[144:147], v[196:199]
    ds_read_b64_tr_b16 v[92:93], v57 offset:16384
    v_mfma_f32_16x16x32_bf16 v[228:231], v[68:71], v[148:151], v[228:231]
    ds_read_b64_tr_b16 v[94:95], v57 offset:20480
    s_waitcnt lgkmcnt(8)
    v_mfma_f32_16x16x32_bf16 v[200:203], v[72:75], v[144:147], v[200:203]
    ds_read_b64_tr_b16 v[64:65], v50 offset:24576
    v_mfma_f32_16x16x32_bf16 v[232:235], v[72:75], v[148:151], v[232:235]
    ds_read_b64_tr_b16 v[66:67], v50 offset:28672
    v_xor_b32 v50, 65536, v50
    v_mfma_f32_16x16x32_bf16 v[204:207], v[76:79], v[144:147], v[204:207]
    ds_read_b64_tr_b16 v[68:69], v51 offset:24576
    buffer_load_dwordx4 v9, s[8:11], s32 offen offset:3072 lds
    v_mfma_f32_16x16x32_bf16 v[236:239], v[76:79], v[148:151], v[236:239]
    ds_read_b64_tr_b16 v[70:71], v51 offset:28672
    v_xor_b32 v51, 65536, v51
    s_waitcnt lgkmcnt(8)
    v_mfma_f32_16x16x32_bf16 v[208:211], v[80:83], v[144:147], v[208:211]
    ds_read_b64_tr_b16 v[72:73], v52 offset:24576
    v_mfma_f32_16x16x32_bf16 v[240:243], v[80:83], v[148:151], v[240:243]
    ds_read_b64_tr_b16 v[74:75], v52 offset:28672
    v_xor_b32 v52, 65536, v52
    v_mfma_f32_16x16x32_bf16 v[212:215], v[84:87], v[144:147], v[212:215]
    ds_read_b64_tr_b16 v[76:77], v53 offset:24576
    s_mov_b32 s31, 32768
    buffer_load_dwordx4 v[128:131], v2, s[4:7], s31 offen offset:0 sc1
    v_mfma_f32_16x16x32_bf16 v[244:247], v[84:87], v[148:151], v[244:247]
    ds_read_b64_tr_b16 v[78:79], v53 offset:28672
    v_xor_b32 v53, 65536, v53
    s_waitcnt lgkmcnt(8)
    v_mfma_f32_16x16x32_bf16 v[216:219], v[88:91], v[144:147], v[216:219]
    ds_read_b64_tr_b16 v[80:81], v54 offset:24576
    v_mfma_f32_16x16x32_bf16 v[248:251], v[88:91], v[148:151], v[248:251]
    ds_read_b64_tr_b16 v[82:83], v54 offset:28672
    v_xor_b32 v54, 65536, v54
    v_mfma_f32_16x16x32_bf16 v[220:223], v[92:95], v[144:147], v[220:223]
    ds_read_b64_tr_b16 v[84:85], v55 offset:24576
    buffer_load_dwordx4 v[132:135], v3, s[4:7], s31 offen offset:0 sc1
    v_mfma_f32_16x16x32_bf16 v[252:255], v[92:95], v[148:151], v[252:255]
    ds_read_b64_tr_b16 v[86:87], v55 offset:28672
    v_xor_b32 v55, 65536, v55
    s_waitcnt lgkmcnt(8)
    s_waitcnt vmcnt(22)
    v_mfma_f32_16x16x32_bf16 v[192:195], v[64:67], v[152:155], v[192:195]
    ds_read_b64_tr_b16 v[88:89], v56 offset:24576
    v_mfma_f32_16x16x32_bf16 v[224:227], v[64:67], v[156:159], v[224:227]
    ds_read_b64_tr_b16 v[90:91], v56 offset:28672
    v_xor_b32 v56, 65536, v56
    v_mfma_f32_16x16x32_bf16 v[196:199], v[68:71], v[152:155], v[196:199]
    ds_read_b64_tr_b16 v[92:93], v57 offset:24576
    buffer_load_dwordx4 v[136:139], v2, s[4:7], s31 offen offset:1024 sc1
    v_mfma_f32_16x16x32_bf16 v[228:231], v[68:71], v[156:159], v[228:231]
    ds_read_b64_tr_b16 v[94:95], v57 offset:28672
    v_xor_b32 v57, 65536, v57
    s_waitcnt lgkmcnt(8)
    v_mfma_f32_16x16x32_bf16 v[200:203], v[72:75], v[152:155], v[200:203]
    v_mfma_f32_16x16x32_bf16 v[232:235], v[72:75], v[156:159], v[232:235]
    v_mfma_f32_16x16x32_bf16 v[204:207], v[76:79], v[152:155], v[204:207]
    v_mfma_f32_16x16x32_bf16 v[236:239], v[76:79], v[156:159], v[236:239]
    buffer_load_dwordx4 v[140:143], v3, s[4:7], s31 offen offset:1024 sc1
    s_waitcnt lgkmcnt(0)
    s_waitcnt vmcnt(19)
    s_barrier
    v_mfma_f32_16x16x32_bf16 v[208:211], v[80:83], v[152:155], v[208:211]
    ds_read_b64_tr_b16 v[64:65], v50 offset:0
    ds_read_b64_tr_b16 v[66:67], v50 offset:4096
    v_mfma_f32_16x16x32_bf16 v[240:243], v[80:83], v[156:159], v[240:243]
    ds_read_b64_tr_b16 v[68:69], v51 offset:0
    ds_read_b64_tr_b16 v[70:71], v51 offset:4096
    v_mfma_f32_16x16x32_bf16 v[212:215], v[84:87], v[152:155], v[212:215]
    ds_read_b64_tr_b16 v[72:73], v52 offset:0
    ds_read_b64_tr_b16 v[74:75], v52 offset:4096
    v_mfma_f32_16x16x32_bf16 v[244:247], v[84:87], v[156:159], v[244:247]
    ds_read_b64_tr_b16 v[76:77], v53 offset:0
    ds_read_b64_tr_b16 v[78:79], v53 offset:4096
    s_add_u32 m0, s33, 81920
    s_mov_b32 s32, 2228224
    buffer_load_dwordx4 v6, s[8:11], s32 offen offset:0 lds
    v_mfma_f32_16x16x32_bf16 v[216:219], v[88:91], v[152:155], v[216:219]
    ds_read_b64_tr_b16 v[80:81], v54 offset:0
    ds_read_b64_tr_b16 v[82:83], v54 offset:4096
    v_mfma_f32_16x16x32_bf16 v[248:251], v[88:91], v[156:159], v[248:251]
    v_mfma_f32_16x16x32_bf16 v[220:223], v[92:95], v[152:155], v[220:223]
    ds_read_b64_tr_b16 v[84:85], v55 offset:0
    ds_read_b64_tr_b16 v[86:87], v55 offset:4096
    v_mfma_f32_16x16x32_bf16 v[252:255], v[92:95], v[156:159], v[252:255]
    buffer_load_dwordx4 v7, s[8:11], s32 offen offset:1024 lds
    s_waitcnt lgkmcnt(8)
    s_waitcnt vmcnt(20)
    v_mfma_f32_16x16x32_bf16 v[192:195], v[64:67], v[160:163], v[192:195]
    ds_read_b64_tr_b16 v[88:89], v56 offset:0
    v_mfma_f32_16x16x32_bf16 v[224:227], v[64:67], v[164:167], v[224:227]
    ds_read_b64_tr_b16 v[90:91], v56 offset:4096
    v_mfma_f32_16x16x32_bf16 v[196:199], v[68:71], v[160:163], v[196:199]
    ds_read_b64_tr_b16 v[92:93], v57 offset:0
    v_mfma_f32_16x16x32_bf16 v[228:231], v[68:71], v[164:167], v[228:231]
    ds_read_b64_tr_b16 v[94:95], v57 offset:4096
    buffer_load_dwordx4 v8, s[8:11], s32 offen offset:2048 lds
    s_waitcnt lgkmcnt(8)
    v_mfma_f32_16x16x32_bf16 v[200:203], v[72:75], v[160:163], v[200:203]
    ds_read_b64_tr_b16 v[64:65], v50 offset:8192
    v_mfma_f32_16x16x32_bf16 v[232:235], v[72:75], v[164:167], v[232:235]
    ds_read_b64_tr_b16 v[66:67], v50 offset:12288
    v_mfma_f32_16x16x32_bf16 v[204:207], v[76:79], v[160:163], v[204:207]
    ds_read_b64_tr_b16 v[68:69], v51 offset:8192
    v_mfma_f32_16x16x32_bf16 v[236:239], v[76:79], v[164:167], v[236:239]
    ds_read_b64_tr_b16 v[70:71], v51 offset:12288
    s_waitcnt lgkmcnt(8)
    v_mfma_f32_16x16x32_bf16 v[208:211], v[80:83], v[160:163], v[208:211]
    ds_read_b64_tr_b16 v[72:73], v52 offset:8192
    buffer_load_dwordx4 v9, s[8:11], s32 offen offset:3072 lds
    v_mfma_f32_16x16x32_bf16 v[240:243], v[80:83], v[164:167], v[240:243]
    ds_read_b64_tr_b16 v[74:75], v52 offset:12288
    v_mfma_f32_16x16x32_bf16 v[212:215], v[84:87], v[160:163], v[212:215]
    ds_read_b64_tr_b16 v[76:77], v53 offset:8192
    v_mfma_f32_16x16x32_bf16 v[244:247], v[84:87], v[164:167], v[244:247]
    ds_read_b64_tr_b16 v[78:79], v53 offset:12288
    s_waitcnt lgkmcnt(8)
    v_mfma_f32_16x16x32_bf16 v[216:219], v[88:91], v[160:163], v[216:219]
    ds_read_b64_tr_b16 v[80:81], v54 offset:8192
    buffer_load_dwordx4 v[144:147], v2, s[4:7], s31 offen offset:2048 sc1
    v_mfma_f32_16x16x32_bf16 v[248:251], v[88:91], v[164:167], v[248:251]
    ds_read_b64_tr_b16 v[82:83], v54 offset:12288
    v_mfma_f32_16x16x32_bf16 v[220:223], v[92:95], v[160:163], v[220:223]
    ds_read_b64_tr_b16 v[84:85], v55 offset:8192
    v_mfma_f32_16x16x32_bf16 v[252:255], v[92:95], v[164:167], v[252:255]
    ds_read_b64_tr_b16 v[86:87], v55 offset:12288
    s_waitcnt lgkmcnt(8)
    s_waitcnt vmcnt(21)
    v_mfma_f32_16x16x32_bf16 v[192:195], v[64:67], v[168:171], v[192:195]
    ds_read_b64_tr_b16 v[88:89], v56 offset:8192
    buffer_load_dwordx4 v[148:151], v3, s[4:7], s31 offen offset:2048 sc1
    v_mfma_f32_16x16x32_bf16 v[224:227], v[64:67], v[172:175], v[224:227]
    ds_read_b64_tr_b16 v[90:91], v56 offset:12288
    v_mfma_f32_16x16x32_bf16 v[196:199], v[68:71], v[168:171], v[196:199]
    ds_read_b64_tr_b16 v[92:93], v57 offset:8192
    v_mfma_f32_16x16x32_bf16 v[228:231], v[68:71], v[172:175], v[228:231]
    ds_read_b64_tr_b16 v[94:95], v57 offset:12288
    s_waitcnt lgkmcnt(8)
    v_mfma_f32_16x16x32_bf16 v[200:203], v[72:75], v[168:171], v[200:203]
    buffer_load_dwordx4 v[152:155], v2, s[4:7], s31 offen offset:3072 sc1
    v_mfma_f32_16x16x32_bf16 v[232:235], v[72:75], v[172:175], v[232:235]
    v_mfma_f32_16x16x32_bf16 v[204:207], v[76:79], v[168:171], v[204:207]
    v_mfma_f32_16x16x32_bf16 v[236:239], v[76:79], v[172:175], v[236:239]
    s_waitcnt lgkmcnt(0)
    s_waitcnt vmcnt(18)
    s_barrier
    v_mfma_f32_16x16x32_bf16 v[208:211], v[80:83], v[168:171], v[208:211]
    ds_read_b64_tr_b16 v[64:65], v50 offset:16384
    ds_read_b64_tr_b16 v[66:67], v50 offset:20480
    v_mfma_f32_16x16x32_bf16 v[240:243], v[80:83], v[172:175], v[240:243]
    ds_read_b64_tr_b16 v[68:69], v51 offset:16384
    ds_read_b64_tr_b16 v[70:71], v51 offset:20480
    s_add_u32 m0, s33, 0
    s_mov_b32 s32, 2621440
    buffer_load_dwordx4 v6, s[8:11], s32 offen offset:0 lds
    v_mfma_f32_16x16x32_bf16 v[212:215], v[84:87], v[168:171], v[212:215]
    ds_read_b64_tr_b16 v[72:73], v52 offset:16384
    ds_read_b64_tr_b16 v[74:75], v52 offset:20480
    v_mfma_f32_16x16x32_bf16 v[244:247], v[84:87], v[172:175], v[244:247]
    ds_read_b64_tr_b16 v[76:77], v53 offset:16384
    ds_read_b64_tr_b16 v[78:79], v53 offset:20480
    v_mfma_f32_16x16x32_bf16 v[216:219], v[88:91], v[168:171], v[216:219]
    ds_read_b64_tr_b16 v[80:81], v54 offset:16384
    ds_read_b64_tr_b16 v[82:83], v54 offset:20480
    v_mfma_f32_16x16x32_bf16 v[248:251], v[88:91], v[172:175], v[248:251]
    buffer_load_dwordx4 v[156:159], v3, s[4:7], s31 offen offset:3072 sc1
    v_mfma_f32_16x16x32_bf16 v[220:223], v[92:95], v[168:171], v[220:223]
    ds_read_b64_tr_b16 v[84:85], v55 offset:16384
    ds_read_b64_tr_b16 v[86:87], v55 offset:20480
    v_mfma_f32_16x16x32_bf16 v[252:255], v[92:95], v[172:175], v[252:255]
    s_waitcnt lgkmcnt(8)
    s_waitcnt vmcnt(19)
    v_mfma_f32_16x16x32_bf16 v[192:195], v[64:67], v[176:179], v[192:195]
    ds_read_b64_tr_b16 v[88:89], v56 offset:16384
    v_mfma_f32_16x16x32_bf16 v[224:227], v[64:67], v[180:183], v[224:227]
    ds_read_b64_tr_b16 v[90:91], v56 offset:20480
    buffer_load_dwordx4 v7, s[8:11], s32 offen offset:1024 lds
    v_mfma_f32_16x16x32_bf16 v[196:199], v[68:71], v[176:179], v[196:199]
    ds_read_b64_tr_b16 v[92:93], v57 offset:16384
    v_mfma_f32_16x16x32_bf16 v[228:231], v[68:71], v[180:183], v[228:231]
    ds_read_b64_tr_b16 v[94:95], v57 offset:20480
    s_waitcnt lgkmcnt(8)
    v_mfma_f32_16x16x32_bf16 v[200:203], v[72:75], v[176:179], v[200:203]
    ds_read_b64_tr_b16 v[64:65], v50 offset:24576
    v_mfma_f32_16x16x32_bf16 v[232:235], v[72:75], v[180:183], v[232:235]
    ds_read_b64_tr_b16 v[66:67], v50 offset:28672
    v_xor_b32 v50, 65536, v50
    v_mfma_f32_16x16x32_bf16 v[204:207], v[76:79], v[176:179], v[204:207]
    ds_read_b64_tr_b16 v[68:69], v51 offset:24576
    buffer_load_dwordx4 v8, s[8:11], s32 offen offset:2048 lds
    v_mfma_f32_16x16x32_bf16 v[236:239], v[76:79], v[180:183], v[236:239]
    ds_read_b64_tr_b16 v[70:71], v51 offset:28672
    v_xor_b32 v51, 65536, v51
    s_waitcnt lgkmcnt(8)
    v_mfma_f32_16x16x32_bf16 v[208:211], v[80:83], v[176:179], v[208:211]
    ds_read_b64_tr_b16 v[72:73], v52 offset:24576
    v_mfma_f32_16x16x32_bf16 v[240:243], v[80:83], v[180:183], v[240:243]
    ds_read_b64_tr_b16 v[74:75], v52 offset:28672
    v_xor_b32 v52, 65536, v52
    v_mfma_f32_16x16x32_bf16 v[212:215], v[84:87], v[176:179], v[212:215]
    ds_read_b64_tr_b16 v[76:77], v53 offset:24576
    buffer_load_dwordx4 v9, s[8:11], s32 offen offset:3072 lds
    v_mfma_f32_16x16x32_bf16 v[244:247], v[84:87], v[180:183], v[244:247]
    ds_read_b64_tr_b16 v[78:79], v53 offset:28672
    v_xor_b32 v53, 65536, v53
    s_waitcnt lgkmcnt(8)
    v_mfma_f32_16x16x32_bf16 v[216:219], v[88:91], v[176:179], v[216:219]
    ds_read_b64_tr_b16 v[80:81], v54 offset:24576
    v_mfma_f32_16x16x32_bf16 v[248:251], v[88:91], v[180:183], v[248:251]
    ds_read_b64_tr_b16 v[82:83], v54 offset:28672
    v_xor_b32 v54, 65536, v54
    v_mfma_f32_16x16x32_bf16 v[220:223], v[92:95], v[176:179], v[220:223]
    ds_read_b64_tr_b16 v[84:85], v55 offset:24576
    s_mov_b32 s31, 40960
    buffer_load_dwordx4 v[160:163], v2, s[4:7], s31 offen offset:0 sc1
    v_mfma_f32_16x16x32_bf16 v[252:255], v[92:95], v[180:183], v[252:255]
    ds_read_b64_tr_b16 v[86:87], v55 offset:28672
    v_xor_b32 v55, 65536, v55
    s_waitcnt lgkmcnt(8)
    s_waitcnt vmcnt(21)
    v_mfma_f32_16x16x32_bf16 v[192:195], v[64:67], v[184:187], v[192:195]
    ds_read_b64_tr_b16 v[88:89], v56 offset:24576
    v_mfma_f32_16x16x32_bf16 v[224:227], v[64:67], v[188:191], v[224:227]
    ds_read_b64_tr_b16 v[90:91], v56 offset:28672
    v_xor_b32 v56, 65536, v56
    v_mfma_f32_16x16x32_bf16 v[196:199], v[68:71], v[184:187], v[196:199]
    ds_read_b64_tr_b16 v[92:93], v57 offset:24576
    buffer_load_dwordx4 v[164:167], v3, s[4:7], s31 offen offset:0 sc1
    v_mfma_f32_16x16x32_bf16 v[228:231], v[68:71], v[188:191], v[228:231]
    ds_read_b64_tr_b16 v[94:95], v57 offset:28672
    v_xor_b32 v57, 65536, v57
    s_waitcnt lgkmcnt(8)
    v_mfma_f32_16x16x32_bf16 v[200:203], v[72:75], v[184:187], v[200:203]
    v_mfma_f32_16x16x32_bf16 v[232:235], v[72:75], v[188:191], v[232:235]
    v_mfma_f32_16x16x32_bf16 v[204:207], v[76:79], v[184:187], v[204:207]
    v_mfma_f32_16x16x32_bf16 v[236:239], v[76:79], v[188:191], v[236:239]
    buffer_load_dwordx4 v[168:171], v2, s[4:7], s31 offen offset:1024 sc1
    s_waitcnt lgkmcnt(0)
    s_waitcnt vmcnt(19)
    s_barrier
    v_mfma_f32_16x16x32_bf16 v[208:211], v[80:83], v[184:187], v[208:211]
    ds_read_b64_tr_b16 v[64:65], v50 offset:0
    ds_read_b64_tr_b16 v[66:67], v50 offset:4096
    v_mfma_f32_16x16x32_bf16 v[240:243], v[80:83], v[188:191], v[240:243]
    ds_read_b64_tr_b16 v[68:69], v51 offset:0
    ds_read_b64_tr_b16 v[70:71], v51 offset:4096
    s_cmp_lt_u32 s60, 31
    s_cbranch_scc1 L_recurrent_scan__compressed_kv_cla__moe_arch_mod__prompt_kernel_rare_183
L_recurrent_scan__compressed_kv_cla__moe_arch_mod__prompt_kernel_back_184:
    v_mfma_f32_16x16x32_bf16 v[212:215], v[84:87], v[184:187], v[212:215]
    ds_read_b64_tr_b16 v[72:73], v52 offset:0
    ds_read_b64_tr_b16 v[74:75], v52 offset:4096
    s_sub_u32 s36, s56, s38
    s_sub_u32 s37, s57, s38
    s_min_u32 s36, s36, s37
    s_cmp_lt_u32 s36, 16
    s_cbranch_scc1 L_recurrent_scan__compressed_kv_cla__moe_arch_mod__prompt_kernel_rare_190
L_recurrent_scan__compressed_kv_cla__moe_arch_mod__prompt_kernel_back_191:
    v_mfma_f32_16x16x32_bf16 v[244:247], v[84:87], v[188:191], v[244:247]
    ds_read_b64_tr_b16 v[76:77], v53 offset:0
    ds_read_b64_tr_b16 v[78:79], v53 offset:4096
    s_add_u32 m0, s33, 16384
    s_mov_b32 s32, 2752512
    buffer_load_dwordx4 v6, s[8:11], s32 offen offset:0 lds
    v_mfma_f32_16x16x32_bf16 v[216:219], v[88:91], v[184:187], v[216:219]
    ds_read_b64_tr_b16 v[80:81], v54 offset:0
    ds_read_b64_tr_b16 v[82:83], v54 offset:4096
    v_mfma_f32_16x16x32_bf16 v[248:251], v[88:91], v[188:191], v[248:251]
    v_mfma_f32_16x16x32_bf16 v[220:223], v[92:95], v[184:187], v[220:223]
    ds_read_b64_tr_b16 v[84:85], v55 offset:0
    ds_read_b64_tr_b16 v[86:87], v55 offset:4096
    v_mfma_f32_16x16x32_bf16 v[252:255], v[92:95], v[188:191], v[252:255]
    buffer_load_dwordx4 v[172:175], v3, s[4:7], s31 offen offset:1024 sc1
    s_waitcnt lgkmcnt(8)
    s_waitcnt vmcnt(19)
    v_mfma_f32_16x16x32_bf16 v[192:195], v[64:67], v[128:131], v[192:195]
    ds_read_b64_tr_b16 v[88:89], v56 offset:0
    v_mfma_f32_16x16x32_bf16 v[224:227], v[64:67], v[132:135], v[224:227]
    ds_read_b64_tr_b16 v[90:91], v56 offset:4096
    v_mfma_f32_16x16x32_bf16 v[196:199], v[68:71], v[128:131], v[196:199]
    ds_read_b64_tr_b16 v[92:93], v57 offset:0
    v_mfma_f32_16x16x32_bf16 v[228:231], v[68:71], v[132:135], v[228:231]
    ds_read_b64_tr_b16 v[94:95], v57 offset:4096
    buffer_load_dwordx4 v7, s[8:11], s32 offen offset:1024 lds
    s_waitcnt lgkmcnt(8)
    v_mfma_f32_16x16x32_bf16 v[200:203], v[72:75], v[128:131], v[200:203]
    ds_read_b64_tr_b16 v[64:65], v50 offset:8192
    v_mfma_f32_16x16x32_bf16 v[232:235], v[72:75], v[132:135], v[232:235]
    ds_read_b64_tr_b16 v[66:67], v50 offset:12288
    v_mfma_f32_16x16x32_bf16 v[204:207], v[76:79], v[128:131], v[204:207]
    ds_read_b64_tr_b16 v[68:69], v51 offset:8192
    v_mfma_f32_16x16x32_bf16 v[236:239], v[76:79], v[132:135], v[236:239]
    ds_read_b64_tr_b16 v[70:71], v51 offset:12288
    s_waitcnt lgkmcnt(8)
    v_mfma_f32_16x16x32_bf16 v[208:211], v[80:83], v[128:131], v[208:211]
    ds_read_b64_tr_b16 v[72:73], v52 offset:8192
    buffer_load_dwordx4 v8, s[8:11], s32 offen offset:2048 lds
    v_mfma_f32_16x16x32_bf16 v[240:243], v[80:83], v[132:135], v[240:243]
    ds_read_b64_tr_b16 v[74:75], v52 offset:12288
    v_mfma_f32_16x16x32_bf16 v[212:215], v[84:87], v[128:131], v[212:215]
    ds_read_b64_tr_b16 v[76:77], v53 offset:8192
    v_mfma_f32_16x16x32_bf16 v[244:247], v[84:87], v[132:135], v[244:247]
    ds_read_b64_tr_b16 v[78:79], v53 offset:12288
    s_waitcnt lgkmcnt(8)
    v_mfma_f32_16x16x32_bf16 v[216:219], v[88:91], v[128:131], v[216:219]
    ds_read_b64_tr_b16 v[80:81], v54 offset:8192
    buffer_load_dwordx4 v9, s[8:11], s32 offen offset:3072 lds
    v_mfma_f32_16x16x32_bf16 v[248:251], v[88:91], v[132:135], v[248:251]
    ds_read_b64_tr_b16 v[82:83], v54 offset:12288
    v_mfma_f32_16x16x32_bf16 v[220:223], v[92:95], v[128:131], v[220:223]
    ds_read_b64_tr_b16 v[84:85], v55 offset:8192
    v_mfma_f32_16x16x32_bf16 v[252:255], v[92:95], v[132:135], v[252:255]
    ds_read_b64_tr_b16 v[86:87], v55 offset:12288
    s_waitcnt lgkmcnt(8)
    s_waitcnt vmcnt(20)
    v_mfma_f32_16x16x32_bf16 v[192:195], v[64:67], v[136:139], v[192:195]
    ds_read_b64_tr_b16 v[88:89], v56 offset:8192
    buffer_load_dwordx4 v[176:179], v2, s[4:7], s31 offen offset:2048 sc1
    v_mfma_f32_16x16x32_bf16 v[224:227], v[64:67], v[140:143], v[224:227]
    ds_read_b64_tr_b16 v[90:91], v56 offset:12288
    v_mfma_f32_16x16x32_bf16 v[196:199], v[68:71], v[136:139], v[196:199]
    ds_read_b64_tr_b16 v[92:93], v57 offset:8192
    v_mfma_f32_16x16x32_bf16 v[228:231], v[68:71], v[140:143], v[228:231]
    ds_read_b64_tr_b16 v[94:95], v57 offset:12288
    s_waitcnt lgkmcnt(8)
    v_mfma_f32_16x16x32_bf16 v[200:203], v[72:75], v[136:139], v[200:203]
    buffer_load_dwordx4 v[180:183], v3, s[4:7], s31 offen offset:2048 sc1
    v_mfma_f32_16x16x32_bf16 v[232:235], v[72:75], v[140:143], v[232:235]
    v_mfma_f32_16x16x32_bf16 v[204:207], v[76:79], v[136:139], v[204:207]
    v_mfma_f32_16x16x32_bf16 v[236:239], v[76:79], v[140:143], v[236:239]
    s_cmp_lt_u32 s60, 31
    s_cbranch_scc1 L_recurrent_scan__compressed_kv_cla__moe_arch_mod__prompt_kernel_rare_188
L_recurrent_scan__compressed_kv_cla__moe_arch_mod__prompt_kernel_back_189:
    s_waitcnt lgkmcnt(0)
    s_waitcnt vmcnt(18)
    s_barrier
    v_mfma_f32_16x16x32_bf16 v[208:211], v[80:83], v[136:139], v[208:211]
    ds_read_b64_tr_b16 v[64:65], v50 offset:16384
    ds_read_b64_tr_b16 v[66:67], v50 offset:20480
    v_mfma_f32_16x16x32_bf16 v[240:243], v[80:83], v[140:143], v[240:243]
    s_mov_b32 m0, s42
    s_mov_b32 s36, 15360
    buffer_load_dwordx4 v15, s[16:19], 0 offen lds
    buffer_load_dwordx4 v15, s[16:19], s36 offen offset:1024 lds
    s_mov_b32 s36, 4194304
    buffer_load_dwordx2 v[48:49], v16, s[24:27], s36 offen sc1
    ds_read_b64_tr_b16 v[68:69], v51 offset:16384
    ds_read_b64_tr_b16 v[70:71], v51 offset:20480
    s_add_u32 m0, s33, 65536
    s_mov_b32 s32, 3145728
    buffer_load_dwordx4 v6, s[8:11], s32 offen offset:0 lds
    v_mfma_f32_16x16x32_bf16 v[212:215], v[84:87], v[136:139], v[212:215]
    ds_read_b64_tr_b16 v[72:73], v52 offset:16384
    ds_read_b64_tr_b16 v[74:75], v52 offset:20480
    v_mfma_f32_16x16x32_bf16 v[244:247], v[84:87], v[140:143], v[244:247]
    ds_read_b64_tr_b16 v[76:77], v53 offset:16384
    ds_read_b64_tr_b16 v[78:79], v53 offset:20480
    v_mfma_f32_16x16x32_bf16 v[216:219], v[88:91], v[136:139], v[216:219]
    ds_read_b64_tr_b16 v[80:81], v54 offset:16384
    ds_read_b64_tr_b16 v[82:83], v54 offset:20480
    v_mfma_f32_16x16x32_bf16 v[248:251], v[88:91], v[140:143], v[248:251]
    buffer_load_dwordx4 v[184:187], v2, s[4:7], s31 offen offset:3072 sc1
    v_mfma_f32_16x16x32_bf16 v[220:223], v[92:95], v[136:139], v[220:223]
    ds_read_b64_tr_b16 v[84:85], v55 offset:16384
    ds_read_b64_tr_b16 v[86:87], v55 offset:20480
    v_mfma_f32_16x16x32_bf16 v[252:255], v[92:95], v[140:143], v[252:255]
    s_waitcnt lgkmcnt(8)
    s_waitcnt vmcnt(21)
    v_mfma_f32_16x16x32_bf16 v[192:195], v[64:67], v[144:147], v[192:195]
    ds_read_b64_tr_b16 v[88:89], v56 offset:16384
    v_mfma_f32_16x16x32_bf16 v[224:227], v[64:67], v[148:151], v[224:227]
    ds_read_b64_tr_b16 v[90:91], v56 offset:20480
    buffer_load_dwordx4 v[188:191], v3, s[4:7], s31 offen offset:3072 sc1
    v_mfma_f32_16x16x32_bf16 v[196:199], v[68:71], v[144:147], v[196:199]
    ds_read_b64_tr_b16 v[92:93], v57 offset:16384
    v_mfma_f32_16x16x32_bf16 v[228:231], v[68:71], v[148:151], v[228:231]
    ds_read_b64_tr_b16 v[94:95], v57 offset:20480
    s_waitcnt lgkmcnt(8)
    v_mfma_f32_16x16x32_bf16 v[200:203], v[72:75], v[144:147], v[200:203]
    ds_read_b64_tr_b16 v[64:65], v50 offset:24576
    v_mfma_f32_16x16x32_bf16 v[232:235], v[72:75], v[148:151], v[232:235]
    ds_read_b64_tr_b16 v[66:67], v50 offset:28672
    v_xor_b32 v50, 65536, v50
    buffer_load_dwordx4 v7, s[8:11], s32 offen offset:1024 lds
    v_mfma_f32_16x16x32_bf16 v[204:207], v[76:79], v[144:147], v[204:207]
    ds_read_b64_tr_b16 v[68:69], v51 offset:24576
    v_mfma_f32_16x16x32_bf16 v[236:239], v[76:79], v[148:151], v[236:239]
    ds_read_b64_tr_b16 v[70:71], v51 offset:28672
    v_xor_b32 v51, 65536, v51
    s_waitcnt lgkmcnt(8)
    v_mfma_f32_16x16x32_bf16 v[208:211], v[80:83], v[144:147], v[208:211]
    ds_read_b64_tr_b16 v[72:73], v52 offset:24576
    v_mfma_f32_16x16x32_bf16 v[240:243], v[80:83], v[148:151], v[240:243]
    ds_read_b64_tr_b16 v[74:75], v52 offset:28672
    v_xor_b32 v52, 65536, v52
    v_mfma_f32_16x16x32_bf16 v[212:215], v[84:87], v[144:147], v[212:215]
    ds_read_b64_tr_b16 v[76:77], v53 offset:24576
    buffer_load_dwordx4 v8, s[8:11], s32 offen offset:2048 lds
    v_mfma_f32_16x16x32_bf16 v[244:247], v[84:87], v[148:151], v[244:247]
    ds_read_b64_tr_b16 v[78:79], v53 offset:28672
    v_xor_b32 v53, 65536, v53
    s_waitcnt lgkmcnt(8)
    v_mfma_f32_16x16x32_bf16 v[216:219], v[88:91], v[144:147], v[216:219]
    ds_read_b64_tr_b16 v[80:81], v54 offset:24576
    s_cmp_eq_u32 s28, 0
    s_cbranch_scc0 L_recurrent_scan__compressed_kv_cla__moe_arch_mod__prompt_kernel_g_197
    s_mov_b32 s43, s38
    s_getpc_b64 s[36:37]
L_recurrent_scan__compressed_kv_cla__moe_arch_mod__prompt_kernel_pc_196:
    s_sub_u32 s36, s36, L_recurrent_scan__compressed_kv_cla__moe_arch_mod__prompt_kernel_pc_196-L_pc
    s_subb_u32 s37, s37, 0
    s_lshr_b32 s38, s2, 3
    s_lshl_b32 s38, s38, 7
    v_lshl_add_u32 v4, v1, 12, s38
    v_min_u32 v4, L_end-L_pc-4, v4
    v_mov_b32 v5, s37
    v_add_co_u32 v4, vcc, s36, v4
    s_mov_b64 exec, 0xffff
    s_nop 0
    v_addc_co_u32 v5, vcc, 0, v5, vcc
    global_load_dword v0, v[4:5], off
    s_mov_b64 exec, -1
    s_nop 1
    s_mov_b32 s38, s43
L_recurrent_scan__compressed_kv_cla__moe_arch_mod__prompt_kernel_g_197:
    v_mfma_f32_16x16x32_bf16 v[248:251], v[88:91], v[148:151], v[248:251]
    ds_read_b64_tr_b16 v[82:83], v54 offset:28672
    v_xor_b32 v54, 65536, v54
    v_mfma_f32_16x16x32_bf16 v[220:223], v[92:95], v[144:147], v[220:223]
    ds_read_b64_tr_b16 v[84:85], v55 offset:24576
    buffer_load_dwordx4 v9, s[8:11], s32 offen offset:3072 lds
    v_mfma_f32_16x16x32_bf16 v[252:255], v[92:95], v[148:151], v[252:255]
    ds_read_b64_tr_b16 v[86:87], v55 offset:28672
    v_xor_b32 v55, 65536, v55
    s_waitcnt lgkmcnt(8)
    s_waitcnt vmcnt(22)
    v_mfma_f32_16x16x32_bf16 v[192:195], v[64:67], v[152:155], v[192:195]
    ds_read_b64_tr_b16 v[88:89], v56 offset:24576
    v_mfma_f32_16x16x32_bf16 v[224:227], v[64:67], v[156:159], v[224:227]
    ds_read_b64_tr_b16 v[90:91], v56 offset:28672
    v_xor_b32 v56, 65536, v56
    v_mfma_f32_16x16x32_bf16 v[196:199], v[68:71], v[152:155], v[196:199]
    ds_read_b64_tr_b16 v[92:93], v57 offset:24576
    s_mov_b32 s31, 49152
    buffer_load_dwordx4 v[128:131], v2, s[4:7], s31 offen offset:0 sc1
    v_mfma_f32_16x16x32_bf16 v[228:231], v[68:71], v[156:159], v[228:231]
    ds_read_b64_tr_b16 v[94:95], v57 offset:28672
    v_xor_b32 v57, 65536, v57
    s_waitcnt lgkmcnt(8)
    v_mfma_f32_16x16x32_bf16 v[200:203], v[72:75], v[152:155], v[200:203]
    v_mfma_f32_16x16x32_bf16 v[232:235], v[72:75], v[156:159], v[232:235]
    v_mfma_f32_16x16x32_bf16 v[204:207], v[76:79], v[152:155], v[204:207]
    buffer_load_dwordx4 v[132:135], v3, s[4:7], s31 offen offset:0 sc1
    s_sub_u32 s36, s56, s38
    s_sub_u32 s37, s57, s38
    s_min_u32 s36, s36, s37
    s_cmp_lt_u32 s36, 16
    s_cbranch_scc1 L_recurrent_scan__compressed_kv_cla__moe_arch_mod__prompt_kernel_rare_192
L_recurrent_scan__compressed_kv_cla__moe_arch_mod__prompt_kernel_back_193:
    v_mfma_f32_16x16x32_bf16 v[236:239], v[76:79], v[156:159], v[236:239]
    s_waitcnt lgkmcnt(0)
    s_waitcnt vmcnt(21)
    s_barrier
    v_mfma_f32_16x16x32_bf16 v[208:211], v[80:83], v[152:155], v[208:211]
    ds_read_b64_tr_b16 v[64:65], v50 offset:0
    ds_read_b64_tr_b16 v[66:67], v50 offset:4096
    v_mfma_f32_16x16x32_bf16 v[240:243], v[80:83], v[156:159], v[240:243]
    ds_read_b64_tr_b16 v[68:69], v51 offset:0
    ds_read_b64_tr_b16 v[70:71], v51 offset:4096
    v_mfma_f32_16x16x32_bf16 v[212:215], v[84:87], v[152:155], v[212:215]
    ds_read_b64_tr_b16 v[72:73], v52 offset:0
    ds_read_b64_tr_b16 v[74:75], v52 offset:4096
    v_mfma_f32_16x16x32_bf16 v[244:247], v[84:87], v[156:159], v[244:247]
    ds_read_b64_tr_b16 v[76:77], v53 offset:0
    ds_read_b64_tr_b16 v[78:79], v53 offset:4096
    s_add_u32 m0, s33, 81920
    s_mov_b32 s32, 3276800
    buffer_load_dwordx4 v6, s[8:11], s32 offen offset:0 lds
    v_mfma_f32_16x16x32_bf16 v[216:219], v[88:91], v[152:155], v[216:219]
    ds_read_b64_tr_b16 v[80:81], v54 offset:0
    ds_read_b64_tr_b16 v[82:83], v54 offset:4096
    v_mfma_f32_16x16x32_bf16 v[248:251], v[88:91], v[156:159], v[248:251]
    v_mfma_f32_16x16x32_bf16 v[220:223], v[92:95], v[152:155], v[220:223]
    ds_read_b64_tr_b16 v[84:85], v55 offset:0
    ds_read_b64_tr_b16 v[86:87], v55 offset:4096
    v_mfma_f32_16x16x32_bf16 v[252:255], v[92:95], v[156:159], v[252:255]
    buffer_load_dwordx4 v7, s[8:11], s32 offen offset:1024 lds
    s_waitcnt lgkmcnt(8)
    s_waitcnt vmcnt(21)
    v_mfma_f32_16x16x32_bf16 v[192:195], v[64:67], v[160:163], v[192:195]
    ds_read_b64_tr_b16 v[88:89], v56 offset:0
    v_mfma_f32_16x16x32_bf16 v[224:227], v[64:67], v[164:167], v[224:227]
    ds_read_b64_tr_b16 v[90:91], v56 offset:4096
    v_mfma_f32_16x16x32_bf16 v[196:199], v[68:71], v[160:163], v[196:199]
    ds_read_b64_tr_b16 v[92:93], v57 offset:0
    v_mfma_f32_16x16x32_bf16 v[228:231], v[68:71], v[164:167], v[228:231]
    ds_read_b64_tr_b16 v[94:95], v57 offset:4096
    buffer_load_dwordx4 v[136:139], v2, s[4:7], s31 offen offset:1024 sc1
    s_waitcnt lgkmcnt(8)
    v_mfma_f32_16x16x32_bf16 v[200:203], v[72:75], v[160:163], v[200:203]
    ds_read_b64_tr_b16 v[64:65], v50 offset:8192
    v_mfma_f32_16x16x32_bf16 v[232:235], v[72:75], v[164:167], v[232:235]
    ds_read_b64_tr_b16 v[66:67], v50 offset:12288
    v_mfma_f32_16x16x32_bf16 v[204:207], v[76:79], v[160:163], v[204:207]
    ds_read_b64_tr_b16 v[68:69], v51 offset:8192
    v_mfma_f32_16x16x32_bf16 v[236:239], v[76:79], v[164:167], v[236:239]
    ds_read_b64_tr_b16 v[70:71], v51 offset:12288
    s_waitcnt lgkmcnt(8)
    v_mfma_f32_16x16x32_bf16 v[208:211], v[80:83], v[160:163], v[208:211]
    ds_read_b64_tr_b16 v[72:73], v52 offset:8192
    buffer_load_dwordx4 v[140:143], v3, s[4:7], s31 offen offset:1024 sc1
    v_mfma_f32_16x16x32_bf16 v[240:243], v[80:83], v[164:167], v[240:243]
    ds_read_b64_tr_b16 v[74:75], v52 offset:12288
    v_mfma_f32_16x16x32_bf16 v[212:215], v[84:87], v[160:163], v[212:215]
    ds_read_b64_tr_b16 v[76:77], v53 offset:8192
    v_mfma_f32_16x16x32_bf16 v[244:247], v[84:87], v[164:167], v[244:247]
    ds_read_b64_tr_b16 v[78:79], v53 offset:12288
    s_waitcnt lgkmcnt(8)
    v_mfma_f32_16x16x32_bf16 v[216:219], v[88:91], v[160:163], v[216:219]
    ds_read_b64_tr_b16 v[80:81], v54 offset:8192
    buffer_load_dwordx4 v8, s[8:11], s32 offen offset:2048 lds
    v_mfma_f32_16x16x32_bf16 v[248:251], v[88:91], v[164:167], v[248:251]
    ds_read_b64_tr_b16 v[82:83], v54 offset:12288
    v_mfma_f32_16x16x32_bf16 v[220:223], v[92:95], v[160:163], v[220:223]
    ds_read_b64_tr_b16 v[84:85], v55 offset:8192
    v_mfma_f32_16x16x32_bf16 v[252:255], v[92:95], v[164:167], v[252:255]
    ds_read_b64_tr_b16 v[86:87], v55 offset:12288
    s_waitcnt lgkmcnt(8)
    s_waitcnt vmcnt(21)
    v_mfma_f32_16x16x32_bf16 v[192:195], v[64:67], v[168:171], v[192:195]
    ds_read_b64_tr_b16 v[88:89], v56 offset:8192
    buffer_load_dwordx4 v9, s[8:11], s32 offen offset:3072 lds
    v_mfma_f32_16x16x32_bf16 v[224:227], v[64:67], v[172:175], v[224:227]
    ds_read_b64_tr_b16 v[90:91], v56 offset:12288
    v_mfma_f32_16x16x32_bf16 v[196:199], v[68:71], v[168:171], v[196:199]
    ds_read_b64_tr_b16 v[92:93], v57 offset:8192
    v_mfma_f32_16x16x32_bf16 v[228:231], v[68:71], v[172:175], v[228:231]
    ds_read_b64_tr_b16 v[94:95], v57 offset:12288
    s_waitcnt lgkmcnt(8)
    v_mfma_f32_16x16x32_bf16 v[200:203], v[72:75], v[168:171], v[200:203]
    buffer_load_dwordx4 v[144:147], v2, s[4:7], s31 offen offset:2048 sc1
    v_mfma_f32_16x16x32_bf16 v[232:235], v[72:75], v[172:175], v[232:235]
    v_mfma_f32_16x16x32_bf16 v[204:207], v[76:79], v[168:171], v[204:207]
    v_mfma_f32_16x16x32_bf16 v[236:239], v[76:79], v[172:175], v[236:239]
    s_waitcnt lgkmcnt(0)
    s_waitcnt vmcnt(20)
    s_barrier
    v_mfma_f32_16x16x32_bf16 v[208:211], v[80:83], v[168:171], v[208:211]
    ds_read_b64_tr_b16 v[64:65], v50 offset:16384
    ds_read_b64_tr_b16 v[66:67], v50 offset:20480
    v_mfma_f32_16x16x32_bf16 v[240:243], v[80:83], v[172:175], v[240:243]
    ds_read_b64_tr_b16 v[68:69], v51 offset:16384
    ds_read_b64_tr_b16 v[70:71], v51 offset:20480
    s_add_u32 m0, s33, 0
    s_mov_b32 s32, 3670016
    buffer_load_dwordx4 v6, s[8:11], s32 offen offset:0 lds
    v_mfma_f32_16x16x32_bf16 v[212:215], v[84:87], v[168:171], v[212:215]
    ds_read_b64_tr_b16 v[72:73], v52 offset:16384
    ds_read_b64_tr_b16 v[74:75], v52 offset:20480
    v_mfma_f32_16x16x32_bf16 v[244:247], v[84:87], v[172:175], v[244:247]
    ds_read_b64_tr_b16 v[76:77], v53 offset:16384
    ds_read_b64_tr_b16 v[78:79], v53 offset:20480
    v_mfma_f32_16x16x32_bf16 v[216:219], v[88:91], v[168:171], v[216:219]
    ds_read_b64_tr_b16 v[80:81], v54 offset:16384
    ds_read_b64_tr_b16 v[82:83], v54 offset:20480
    v_mfma_f32_16x16x32_bf16 v[248:251], v[88:91], v[172:175], v[248:251]
    buffer_load_dwordx4 v7, s[8:11], s32 offen offset:1024 lds
    v_mfma_f32_16x16x32_bf16 v[220:223], v[92:95], v[168:171], v[220:223]
    ds_read_b64_tr_b16 v[84:85], v55 offset:16384
    ds_read_b64_tr_b16 v[86:87], v55 offset:20480
    v_mfma_f32_16x16x32_bf16 v[252:255], v[92:95], v[172:175], v[252:255]
    s_waitcnt lgkmcnt(8)
    s_waitcnt vmcnt(20)
    v_mfma_f32_16x16x32_bf16 v[192:195], v[64:67], v[176:179], v[192:195]
    ds_read_b64_tr_b16 v[88:89], v56 offset:16384
    v_mfma_f32_16x16x32_bf16 v[224:227], v[64:67], v[180:183], v[224:227]
    ds_read_b64_tr_b16 v[90:91], v56 offset:20480
    buffer_load_dwordx4 v[148:151], v3, s[4:7], s31 offen offset:2048 sc1
    v_mfma_f32_16x16x32_bf16 v[196:199], v[68:71], v[176:179], v[196:199]
    ds_read_b64_tr_b16 v[92:93], v57 offset:16384
    v_mfma_f32_16x16x32_bf16 v[228:231], v[68:71], v[180:183], v[228:231]
    ds_read_b64_tr_b16 v[94:95], v57 offset:20480
    s_waitcnt lgkmcnt(8)
    v_mfma_f32_16x16x32_bf16 v[200:203], v[72:75], v[176:179], v[200:203]
    ds_read_b64_tr_b16 v[64:65], v50 offset:24576
    v_mfma_f32_16x16x32_bf16 v[232:235], v[72:75], v[180:183], v[232:235]
    ds_read_b64_tr_b16 v[66:67], v50 offset:28672
    v_xor_b32 v50, 65536, v50
    buffer_load_dwordx4 v8, s[8:11], s32 offen offset:2048 lds
    v_mfma_f32_16x16x32_bf16 v[204:207], v[76:79], v[176:179], v[204:207]
    ds_read_b64_tr_b16 v[68:69], v51 offset:24576
    v_mfma_f32_16x16x32_bf16 v[236:239], v[76:79], v[180:183], v[236:239]
    ds_read_b64_tr_b16 v[70:71], v51 offset:28672
    v_xor_b32 v51, 65536, v51
    s_waitcnt lgkmcnt(8)
    v_mfma_f32_16x16x32_bf16 v[208:211], v[80:83], v[176:179], v[208:211]
    ds_read_b64_tr_b16 v[72:73], v52 offset:24576
    v_mfma_f32_16x16x32_bf16 v[240:243], v[80:83], v[180:183], v[240:243]
    ds_read_b64_tr_b16 v[74:75], v52 offset:28672
    v_xor_b32 v52, 65536, v52
    v_mfma_f32_16x16x32_bf16 v[212:215], v[84:87], v[176:179], v[212:215]
    ds_read_b64_tr_b16 v[76:77], v53 offset:24576
    buffer_load_dwordx4 v9, s[8:11], s32 offen offset:3072 lds
    v_mfma_f32_16x16x32_bf16 v[244:247], v[84:87], v[180:183], v[244:247]
    ds_read_b64_tr_b16 v[78:79], v53 offset:28672
    v_xor_b32 v53, 65536, v53
    s_waitcnt lgkmcnt(8)
    v_mfma_f32_16x16x32_bf16 v[216:219], v[88:91], v[176:179], v[216:219]
    ds_read_b64_tr_b16 v[80:81], v54 offset:24576
    v_mfma_f32_16x16x32_bf16 v[248:251], v[88:91], v[180:183], v[248:251]
    ds_read_b64_tr_b16 v[82:83], v54 offset:28672
    v_xor_b32 v54, 65536, v54
    v_mfma_f32_16x16x32_bf16 v[220:223], v[92:95], v[176:179], v[220:223]
    ds_read_b64_tr_b16 v[84:85], v55 offset:24576
    buffer_load_dwordx4 v[152:155], v2, s[4:7], s31 offen offset:3072 sc1
    v_mfma_f32_16x16x32_bf16 v[252:255], v[92:95], v[180:183], v[252:255]
    ds_read_b64_tr_b16 v[86:87], v55 offset:28672
    v_xor_b32 v55, 65536, v55
    s_waitcnt lgkmcnt(8)
    s_waitcnt vmcnt(18)
    v_mfma_f32_16x16x32_bf16 v[192:195], v[64:67], v[184:187], v[192:195]
    ds_read_b64_tr_b16 v[88:89], v56 offset:24576
    v_mfma_f32_16x16x32_bf16 v[224:227], v[64:67], v[188:191], v[224:227]
    ds_read_b64_tr_b16 v[90:91], v56 offset:28672
    v_xor_b32 v56, 65536, v56
    v_mfma_f32_16x16x32_bf16 v[196:199], v[68:71], v[184:187], v[196:199]
    ds_read_b64_tr_b16 v[92:93], v57 offset:24576
    buffer_load_dwordx4 v[156:159], v3, s[4:7], s31 offen offset:3072 sc1
    v_mfma_f32_16x16x32_bf16 v[228:231], v[68:71], v[188:191], v[228:231]
    ds_read_b64_tr_b16 v[94:95], v57 offset:28672
    v_xor_b32 v57, 65536, v57
    s_waitcnt lgkmcnt(8)
    v_mfma_f32_16x16x32_bf16 v[200:203], v[72:75], v[184:187], v[200:203]
    s_sub_u32 s36, s56, s38
    s_sub_u32 s37, s57, s38
    s_min_u32 s36, s36, s37
    s_cmp_lt_u32 s36, 16
    s_cbranch_scc1 L_recurrent_scan__compressed_kv_cla__moe_arch_mod__prompt_kernel_rare_194
L_recurrent_scan__compressed_kv_cla__moe_arch_mod__prompt_kernel_back_195:
    v_mfma_f32_16x16x32_bf16 v[232:235], v[72:75], v[188:191], v[232:235]
    v_mfma_f32_16x16x32_bf16 v[204:207], v[76:79], v[184:187], v[204:207]
    s_mov_b32 s31, 57344
    buffer_load_dwordx4 v[160:163], v2, s[4:7], s31 offen offset:0 sc1
    v_mfma_f32_16x16x32_bf16 v[236:239], v[76:79], v[188:191], v[236:239]
    s_waitcnt lgkmcnt(0)
    s_waitcnt vmcnt(17)
    s_barrier
    v_mfma_f32_16x16x32_bf16 v[208:211], v[80:83], v[184:187], v[208:211]
    ds_read_b64_tr_b16 v[64:65], v50 offset:0
    ds_read_b64_tr_b16 v[66:67], v50 offset:4096
    v_mfma_f32_16x16x32_bf16 v[240:243], v[80:83], v[188:191], v[240:243]
    ds_read_b64_tr_b16 v[68:69], v51 offset:0
    ds_read_b64_tr_b16 v[70:71], v51 offset:4096
    v_mfma_f32_16x16x32_bf16 v[212:215], v[84:87], v[184:187], v[212:215]
    ds_read_b64_tr_b16 v[72:73], v52 offset:0
    ds_read_b64_tr_b16 v[74:75], v52 offset:4096
    v_mfma_f32_16x16x32_bf16 v[244:247], v[84:87], v[188:191], v[244:247]
    ds_read_b64_tr_b16 v[76:77], v53 offset:0
    ds_read_b64_tr_b16 v[78:79], v53 offset:4096
    s_add_u32 m0, s33, 16384
    s_mov_b32 s32, 3801088
    buffer_load_dwordx4 v6, s[8:11], s32 offen offset:0 lds
    v_mfma_f32_16x16x32_bf16 v[216:219], v[88:91], v[184:187], v[216:219]
    ds_read_b64_tr_b16 v[80:81], v54 offset:0
    ds_read_b64_tr_b16 v[82:83], v54 offset:4096
    v_mfma_f32_16x16x32_bf16 v[248:251], v[88:91], v[188:191], v[248:251]
    v_mfma_f32_16x16x32_bf16 v[220:223], v[92:95], v[184:187], v[220:223]
    ds_read_b64_tr_b16 v[84:85], v55 offset:0
    ds_read_b64_tr_b16 v[86:87], v55 offset:4096
    v_mfma_f32_16x16x32_bf16 v[252:255], v[92:95], v[188:191], v[252:255]
    buffer_load_dwordx4 v7, s[8:11], s32 offen offset:1024 lds
    s_waitcnt lgkmcnt(8)
    s_waitcnt vmcnt(17)
    v_mfma_f32_16x16x32_bf16 v[192:195], v[64:67], v[128:131], v[192:195]
    ds_read_b64_tr_b16 v[88:89], v56 offset:0
    v_mfma_f32_16x16x32_bf16 v[224:227], v[64:67], v[132:135], v[224:227]
    ds_read_b64_tr_b16 v[90:91], v56 offset:4096
    v_mfma_f32_16x16x32_bf16 v[196:199], v[68:71], v[128:131], v[196:199]
    ds_read_b64_tr_b16 v[92:93], v57 offset:0
    v_mfma_f32_16x16x32_bf16 v[228:231], v[68:71], v[132:135], v[228:231]
    ds_read_b64_tr_b16 v[94:95], v57 offset:4096
    buffer_load_dwordx4 v[164:167], v3, s[4:7], s31 offen offset:0 sc1
    s_waitcnt lgkmcnt(8)
    v_mfma_f32_16x16x32_bf16 v[200:203], v[72:75], v[128:131], v[200:203]
    ds_read_b64_tr_b16 v[64:65], v50 offset:8192
    v_mfma_f32_16x16x32_bf16 v[232:235], v[72:75], v[132:135], v[232:235]
    ds_read_b64_tr_b16 v[66:67], v50 offset:12288
    v_mfma_f32_16x16x32_bf16 v[204:207], v[76:79], v[128:131], v[204:207]
    ds_read_b64_tr_b16 v[68:69], v51 offset:8192
    v_mfma_f32_16x16x32_bf16 v[236:239], v[76:79], v[132:135], v[236:239]
    ds_read_b64_tr_b16 v[70:71], v51 offset:12288
    buffer_load_dwordx4 v8, s[8:11], s32 offen offset:2048 lds
    s_waitcnt lgkmcnt(8)
    v_mfma_f32_16x16x32_bf16 v[208:211], v[80:83], v[128:131], v[208:211]
    ds_read_b64_tr_b16 v[72:73], v52 offset:8192
    v_mfma_f32_16x16x32_bf16 v[240:243], v[80:83], v[132:135], v[240:243]
    ds_read_b64_tr_b16 v[74:75], v52 offset:12288
    v_mfma_f32_16x16x32_bf16 v[212:215], v[84:87], v[128:131], v[212:215]
    ds_read_b64_tr_b16 v[76:77], v53 offset:8192
    v_mfma_f32_16x16x32_bf16 v[244:247], v[84:87], v[132:135], v[244:247]
    ds_read_b64_tr_b16 v[78:79], v53 offset:12288
    s_waitcnt lgkmcnt(8)
    v_mfma_f32_16x16x32_bf16 v[216:219], v[88:91], v[128:131], v[216:219]
    ds_read_b64_tr_b16 v[80:81], v54 offset:8192
    buffer_load_dwordx4 v9, s[8:11], s32 offen offset:3072 lds
    v_mfma_f32_16x16x32_bf16 v[248:251], v[88:91], v[132:135], v[248:251]
    ds_read_b64_tr_b16 v[82:83], v54 offset:12288
    v_mfma_f32_16x16x32_bf16 v[220:223], v[92:95], v[128:131], v[220:223]
    ds_read_b64_tr_b16 v[84:85], v55 offset:8192
    v_mfma_f32_16x16x32_bf16 v[252:255], v[92:95], v[132:135], v[252:255]
    ds_read_b64_tr_b16 v[86:87], v55 offset:12288
    s_waitcnt lgkmcnt(8)
    s_waitcnt vmcnt(16)
    v_mfma_f32_16x16x32_bf16 v[192:195], v[64:67], v[136:139], v[192:195]
    ds_read_b64_tr_b16 v[88:89], v56 offset:8192
    buffer_load_dwordx4 v[168:171], v2, s[4:7], s31 offen offset:1024 sc1
    v_mfma_f32_16x16x32_bf16 v[224:227], v[64:67], v[140:143], v[224:227]
    ds_read_b64_tr_b16 v[90:91], v56 offset:12288
    v_mfma_f32_16x16x32_bf16 v[196:199], v[68:71], v[136:139], v[196:199]
    ds_read_b64_tr_b16 v[92:93], v57 offset:8192
    v_mfma_f32_16x16x32_bf16 v[228:231], v[68:71], v[140:143], v[228:231]
    ds_read_b64_tr_b16 v[94:95], v57 offset:12288
    s_waitcnt vmcnt(15)
    s_barrier
    s_waitcnt lgkmcnt(8)
    v_mfma_f32_16x16x32_bf16 v[200:203], v[72:75], v[136:139], v[200:203]
    ds_read_b64_tr_b16 v[64:65], v50 offset:16384
    buffer_load_dwordx4 v[172:175], v3, s[4:7], s31 offen offset:1024 sc1
    v_mfma_f32_16x16x32_bf16 v[232:235], v[72:75], v[140:143], v[232:235]
    ds_read_b64_tr_b16 v[66:67], v50 offset:20480
    v_mfma_f32_16x16x32_bf16 v[204:207], v[76:79], v[136:139], v[204:207]
    ds_read_b64_tr_b16 v[68:69], v51 offset:16384
    v_mfma_f32_16x16x32_bf16 v[236:239], v[76:79], v[140:143], v[236:239]
    ds_read_b64_tr_b16 v[70:71], v51 offset:20480
    s_waitcnt lgkmcnt(8)
    v_mfma_f32_16x16x32_bf16 v[208:211], v[80:83], v[136:139], v[208:211]
    ds_read_b64_tr_b16 v[72:73], v52 offset:16384
    buffer_load_dwordx4 v[176:179], v2, s[4:7], s31 offen offset:2048 sc1
    v_mfma_f32_16x16x32_bf16 v[240:243], v[80:83], v[140:143], v[240:243]
    ds_read_b64_tr_b16 v[74:75], v52 offset:20480
    v_mfma_f32_16x16x32_bf16 v[212:215], v[84:87], v[136:139], v[212:215]
    ds_read_b64_tr_b16 v[76:77], v53 offset:16384
    v_mfma_f32_16x16x32_bf16 v[244:247], v[84:87], v[140:143], v[244:247]
    ds_read_b64_tr_b16 v[78:79], v53 offset:20480
    s_waitcnt lgkmcnt(8)
    v_mfma_f32_16x16x32_bf16 v[216:219], v[88:91], v[136:139], v[216:219]
    ds_read_b64_tr_b16 v[80:81], v50 offset:24576
    v_mfma_f32_16x16x32_bf16 v[248:251], v[88:91], v[140:143], v[248:251]
    ds_read_b64_tr_b16 v[82:83], v50 offset:28672
    v_xor_b32 v50, 65536, v50
    buffer_load_dwordx4 v[180:183], v3, s[4:7], s31 offen offset:2048 sc1
    v_mfma_f32_16x16x32_bf16 v[220:223], v[92:95], v[136:139], v[220:223]
    ds_read_b64_tr_b16 v[84:85], v51 offset:24576
    v_mfma_f32_16x16x32_bf16 v[252:255], v[92:95], v[140:143], v[252:255]
    ds_read_b64_tr_b16 v[86:87], v51 offset:28672
    v_xor_b32 v51, 65536, v51
    s_waitcnt lgkmcnt(8)
    s_waitcnt vmcnt(14)
    v_mfma_f32_16x16x32_bf16 v[192:195], v[64:67], v[144:147], v[192:195]
    ds_read_b64_tr_b16 v[88:89], v52 offset:24576
    v_mfma_f32_16x16x32_bf16 v[224:227], v[64:67], v[148:151], v[224:227]
    ds_read_b64_tr_b16 v[90:91], v52 offset:28672
    v_xor_b32 v52, 65536, v52
    buffer_load_dwordx4 v[184:187], v2, s[4:7], s31 offen offset:3072 sc1
    v_mfma_f32_16x16x32_bf16 v[196:199], v[68:71], v[144:147], v[196:199]
    ds_read_b64_tr_b16 v[92:93], v53 offset:24576
    v_mfma_f32_16x16x32_bf16 v[228:231], v[68:71], v[148:151], v[228:231]
    ds_read_b64_tr_b16 v[94:95], v53 offset:28672
    v_xor_b32 v53, 65536, v53
    s_waitcnt vmcnt(13)
    s_barrier
    s_waitcnt lgkmcnt(8)
    v_mfma_f32_16x16x32_bf16 v[200:203], v[72:75], v[144:147], v[200:203]
    ds_read_b64_tr_b16 v[64:65], v50 offset:0
    v_mfma_f32_16x16x32_bf16 v[232:235], v[72:75], v[148:151], v[232:235]
    ds_read_b64_tr_b16 v[66:67], v50 offset:4096
    buffer_load_dwordx4 v[188:191], v3, s[4:7], s31 offen offset:3072 sc1
    v_mfma_f32_16x16x32_bf16 v[204:207], v[76:79], v[144:147], v[204:207]
    ds_read_b64_tr_b16 v[68:69], v51 offset:0
    v_mfma_f32_16x16x32_bf16 v[236:239], v[76:79], v[148:151], v[236:239]
    ds_read_b64_tr_b16 v[70:71], v51 offset:4096
    s_waitcnt lgkmcnt(8)
    s_waitcnt vmcnt(12)
    v_mfma_f32_16x16x32_bf16 v[192:195], v[80:83], v[152:155], v[192:195]
    ds_read_b64_tr_b16 v[72:73], v52 offset:0
    v_mfma_f32_16x16x32_bf16 v[224:227], v[80:83], v[156:159], v[224:227]
    ds_read_b64_tr_b16 v[74:75], v52 offset:4096
    v_mfma_f32_16x16x32_bf16 v[196:199], v[84:87], v[152:155], v[196:199]
    ds_read_b64_tr_b16 v[76:77], v53 offset:0
    v_mfma_f32_16x16x32_bf16 v[228:231], v[84:87], v[156:159], v[228:231]
    ds_read_b64_tr_b16 v[78:79], v53 offset:4096
    s_waitcnt lgkmcnt(8)
    v_mfma_f32_16x16x32_bf16 v[200:203], v[88:91], v[152:155], v[200:203]
    ds_read_b64_tr_b16 v[80:81], v50 offset:8192
    v_mfma_f32_16x16x32_bf16 v[232:235], v[88:91], v[156:159], v[232:235]
    ds_read_b64_tr_b16 v[82:83], v50 offset:12288
    v_mfma_f32_16x16x32_bf16 v[204:207], v[92:95], v[152:155], v[204:207]
    ds_read_b64_tr_b16 v[84:85], v51 offset:8192
    v_mfma_f32_16x16x32_bf16 v[236:239], v[92:95], v[156:159], v[236:239]
    ds_read_b64_tr_b16 v[86:87], v51 offset:12288
    s_waitcnt lgkmcnt(8)
    s_waitcnt vmcnt(8)
    v_mfma_f32_16x16x32_bf16 v[192:195], v[64:67], v[160:163], v[192:195]
    ds_read_b64_tr_b16 v[88:89], v52 offset:8192
    v_mfma_f32_16x16x32_bf16 v[224:227], v[64:67], v[164:167], v[224:227]
    ds_read_b64_tr_b16 v[90:91], v52 offset:12288
    v_mfma_f32_16x16x32_bf16 v[196:199], v[68:71], v[160:163], v[196:199]
    ds_read_b64_tr_b16 v[92:93], v53 offset:8192
    v_mfma_f32_16x16x32_bf16 v[228:231], v[68:71], v[164:167], v[228:231]
    ds_read_b64_tr_b16 v[94:95], v53 offset:12288
    s_waitcnt vmcnt(6)
    s_barrier
    s_waitcnt lgkmcnt(8)
    v_mfma_f32_16x16x32_bf16 v[200:203], v[72:75], v[160:163], v[200:203]
    ds_read_b64_tr_b16 v[64:65], v50 offset:16384
    v_mfma_f32_16x16x32_bf16 v[232:235], v[72:75], v[164:167], v[232:235]
    ds_read_b64_tr_b16 v[66:67], v50 offset:20480
    v_mfma_f32_16x16x32_bf16 v[204:207], v[76:79], v[160:163], v[204:207]
    ds_read_b64_tr_b16 v[68:69], v51 offset:16384
    v_mfma_f32_16x16x32_bf16 v[236:239], v[76:79], v[164:167], v[236:239]
    ds_read_b64_tr_b16 v[70:71], v51 offset:20480
    s_waitcnt lgkmcnt(8)
    s_waitcnt vmcnt(4)
    v_mfma_f32_16x16x32_bf16 v[192:195], v[80:83], v[168:171], v[192:195]
    ds_read_b64_tr_b16 v[72:73], v52 offset:16384
    v_mfma_f32_16x16x32_bf16 v[224:227], v[80:83], v[172:175], v[224:227]
    ds_read_b64_tr_b16 v[74:75], v52 offset:20480
    v_mfma_f32_16x16x32_bf16 v[196:199], v[84:87], v[168:171], v[196:199]
    ds_read_b64_tr_b16 v[76:77], v53 offset:16384
    v_mfma_f32_16x16x32_bf16 v[228:231], v[84:87], v[172:175], v[228:231]
    ds_read_b64_tr_b16 v[78:79], v53 offset:20480
    s_waitcnt lgkmcnt(8)
    v_mfma_f32_16x16x32_bf16 v[200:203], v[88:91], v[168:171], v[200:203]
    ds_read_b64_tr_b16 v[80:81], v50 offset:24576
    s_xor_b32 s37, s40, 512
    v_mov_b32 v5, s37
    ds_read_b64 v[40:41], v63 offset:0
    ds_read_b64 v[42:43], v63 offset:32
    ds_read_b64 v[44:45], v63 offset:64
    ds_read_b64 v[46:47], v63 offset:96
    v_mfma_f32_16x16x32_bf16 v[232:235], v[88:91], v[172:175], v[232:235]
    ds_read_b64_tr_b16 v[82:83], v50 offset:28672
    v_mfma_f32_16x16x32_bf16 v[204:207], v[92:95], v[168:171], v[204:207]
    ds_read_b64_tr_b16 v[84:85], v51 offset:24576
    v_mfma_f32_16x16x32_bf16 v[236:239], v[92:95], v[172:175], v[236:239]
    ds_read_b64_tr_b16 v[86:87], v51 offset:28672
    s_waitcnt lgkmcnt(12)
    s_waitcnt vmcnt(2)
    v_mfma_f32_16x16x32_bf16 v[192:195], v[64:67], v[176:179], v[192:195]
    ds_read_b64_tr_b16 v[88:89], v52 offset:24576
    v_mfma_f32_16x16x32_bf16 v[224:227], v[64:67], v[180:183], v[224:227]
    ds_read_b64_tr_b16 v[90:91], v52 offset:28672
    v_mfma_f32_16x16x32_bf16 v[196:199], v[68:71], v[176:179], v[196:199]
    ds_read_b64_tr_b16 v[92:93], v53 offset:24576
    v_mfma_f32_16x16x32_bf16 v[228:231], v[68:71], v[180:183], v[228:231]
    ds_read_b64_tr_b16 v[94:95], v53 offset:28672
    s_waitcnt lgkmcnt(12)
    v_mfma_f32_16x16x32_bf16 v[200:203], v[72:75], v[176:179], v[200:203]
    ds_read_b64_tr_b16 v[64:65], v54 offset:16384
    v_mfma_f32_16x16x32_bf16 v[232:235], v[72:75], v[180:183], v[232:235]
    ds_read_b64_tr_b16 v[66:67], v54 offset:20480
    v_mfma_f32_16x16x32_bf16 v[204:207], v[76:79], v[176:179], v[204:207]
    ds_read_b64_tr_b16 v[68:69], v55 offset:16384
    v_mfma_f32_16x16x32_bf16 v[236:239], v[76:79], v[180:183], v[236:239]
    ds_read_b64_tr_b16 v[70:71], v55 offset:20480
    s_waitcnt lgkmcnt(8)
    s_waitcnt vmcnt(0)
    v_mfma_f32_16x16x32_bf16 v[192:195], v[80:83], v[184:187], v[192:195]
    ds_read_b64_tr_b16 v[72:73], v56 offset:16384
    v_mfma_f32_16x16x32_bf16 v[224:227], v[80:83], v[188:191], v[224:227]
    ds_read_b64_tr_b16 v[74:75], v56 offset:20480
    v_mfma_f32_16x16x32_bf16 v[196:199], v[84:87], v[184:187], v[196:199]
    ds_read_b64_tr_b16 v[76:77], v57 offset:16384
    v_mfma_f32_16x16x32_bf16 v[228:231], v[84:87], v[188:191], v[228:231]
    ds_read_b64_tr_b16 v[78:79], v57 offset:20480
    s_waitcnt lgkmcnt(8)
    v_mfma_f32_16x16x32_bf16 v[200:203], v[88:91], v[184:187], v[200:203]
    ds_read_b64_tr_b16 v[80:81], v54 offset:24576
    v_mfma_f32_16x16x32_bf16 v[232:235], v[88:91], v[188:191], v[232:235]
    ds_read_b64_tr_b16 v[82:83], v54 offset:28672
    v_xor_b32 v54, 65536, v54
    v_mfma_f32_16x16x32_bf16 v[204:207], v[92:95], v[184:187], v[204:207]
    ds_read_b64_tr_b16 v[84:85], v55 offset:24576
    v_mfma_f32_16x16x32_bf16 v[236:239], v[92:95], v[188:191], v[236:239]
    ds_read_b64_tr_b16 v[86:87], v55 offset:28672
    v_xor_b32 v55, 65536, v55
    s_waitcnt lgkmcnt(8)
    v_mfma_f32_16x16x32_bf16 v[208:211], v[64:67], v[144:147], v[208:211]
    ds_read_b64_tr_b16 v[88:89], v56 offset:24576
    v_mfma_f32_16x16x32_bf16 v[240:243], v[64:67], v[148:151], v[240:243]
    ds_read_b64_tr_b16 v[90:91], v56 offset:28672
    v_xor_b32 v56, 65536, v56
    v_mfma_f32_16x16x32_bf16 v[212:215], v[68:71], v[144:147], v[212:215]
    ds_read_b64_tr_b16 v[92:93], v57 offset:24576
    ds_write_b128 v20, v[224:227] offset:0
    v_mfma_f32_16x16x32_bf16 v[244:247], v[68:71], v[148:151], v[244:247]
    ds_read_b64_tr_b16 v[94:95], v57 offset:28672
    v_xor_b32 v57, 65536, v57
    ds_write_b128 v20, v[228:231] offset:1024
    s_waitcnt lgkmcnt(10)
    v_mfma_f32_16x16x32_bf16 v[216:219], v[72:75], v[144:147], v[216:219]
    ds_read_b64_tr_b16 v[64:65], v54 offset:0
    ds_write_b128 v20, v[232:235] offset:2048
    v_mfma_f32_16x16x32_bf16 v[248:251], v[72:75], v[148:151], v[248:251]
    ds_read_b64_tr_b16 v[66:67], v54 offset:4096
    ds_write_b128 v20, v[236:239] offset:3072
    v_mfma_f32_16x16x32_bf16 v[220:223], v[76:79], v[144:147], v[220:223]
    ds_read_b64_tr_b16 v[68:69], v55 offset:0
    v_mfma_f32_16x16x32_bf16 v[252:255], v[76:79], v[148:151], v[252:255]
    ds_read_b64_tr_b16 v[70:71], v55 offset:4096
    s_waitcnt lgkmcnt(12)
    v_mfma_f32_16x16x32_bf16 v[208:211], v[80:83], v[152:155], v[208:211]
    ds_read_b64_tr_b16 v[72:73], v56 offset:0
    v_mfma_f32_16x16x32_bf16 v[240:243], v[80:83], v[156:159], v[240:243]
    ds_read_b64_tr_b16 v[74:75], v56 offset:4096
    v_mfma_f32_16x16x32_bf16 v[212:215], v[84:87], v[152:155], v[212:215]
    ds_read_b64_tr_b16 v[76:77], v57 offset:0
    s_waitcnt lgkmcnt(5)
    s_barrier
    v_mfma_f32_16x16x32_bf16 v[244:247], v[84:87], v[156:159], v[244:247]
    ds_read_b64_tr_b16 v[78:79], v57 offset:4096
    ds_read_b128 v[224:227], v21 offset:0
    ds_read_b128 v[228:231], v21 offset:1024
    v_mfma_f32_16x16x32_bf16 v[216:219], v[88:91], v[152:155], v[216:219]
    ds_read_b64_tr_b16 v[80:81], v54 offset:8192
    ds_read_b128 v[232:235], v21 offset:2048
    ds_read_b128 v[236:239], v21 offset:3072
    v_mfma_f32_16x16x32_bf16 v[248:251], v[88:91], v[156:159], v[248:251]
    ds_read_b64_tr_b16 v[82:83], v54 offset:12288
    v_mfma_f32_16x16x32_bf16 v[220:223], v[92:95], v[152:155], v[220:223]
    ds_read_b64_tr_b16 v[84:85], v55 offset:8192
    v_mfma_f32_16x16x32_bf16 v[252:255], v[92:95], v[156:159], v[252:255]
    ds_read_b64_tr_b16 v[86:87], v55 offset:12288
    s_waitcnt lgkmcnt(12)
    v_mfma_f32_16x16x32_bf16 v[208:211], v[64:67], v[160:163], v[208:211]
    ds_read_b64_tr_b16 v[88:89], v56 offset:8192
    s_waitcnt lgkmcnt(8)
    v_add_f32 v192, v192, v224
    v_add_f32 v193, v193, v225
    v_mfma_f32_16x16x32_bf16 v[240:243], v[64:67], v[164:167], v[240:243]
    ds_read_b64_tr_b16 v[90:91], v56 offset:12288
    v_add_f32 v194, v194, v226
    v_add_f32 v195, v195, v227
    buffer_store_dwordx4 v[192:195], v18, s[24:27], s41 offen offset:0 sc1
    v_mfma_f32_16x16x32_bf16 v[212:215], v[68:71], v[160:163], v[212:215]
    ds_read_b64_tr_b16 v[92:93], v57 offset:8192
    s_waitcnt lgkmcnt(9)
    v_add_f32 v196, v196, v228
    v_add_f32 v197, v197, v229
    v_mfma_f32_16x16x32_bf16 v[244:247], v[68:71], v[164:167], v[244:247]
    ds_read_b64_tr_b16 v[94:95], v57 offset:12288
    v_add_f32 v198, v198, v230
    v_add_f32 v199, v199, v231
    buffer_store_dwordx4 v[196:199], v18, s[24:27], s41 offen offset:1024 sc1
    v_mfma_f32_16x16x32_bf16 v[216:219], v[72:75], v[160:163], v[216:219]
    ds_read_b64_tr_b16 v[64:65], v54 offset:16384
    s_waitcnt lgkmcnt(9)
    v_add_f32 v200, v200, v232
    v_add_f32 v201, v201, v233
    v_mfma_f32_16x16x32_bf16 v[248:251], v[72:75], v[164:167], v[248:251]
    ds_read_b64_tr_b16 v[66:67], v54 offset:20480
    v_add_f32 v202, v202, v234
    v_add_f32 v203, v203, v235
    buffer_store_dwordx4 v[200:203], v18, s[24:27], s41 offen offset:2048 sc1
    v_mfma_f32_16x16x32_bf16 v[220:223], v[76:79], v[160:163], v[220:223]
    ds_read_b64_tr_b16 v[68:69], v55 offset:16384
    s_waitcnt lgkmcnt(10)
    v_add_f32 v204, v204, v236
    v_add_f32 v205, v205, v237
    v_mfma_f32_16x16x32_bf16 v[252:255], v[76:79], v[164:167], v[252:255]
    ds_read_b64_tr_b16 v[70:71], v55 offset:20480
    v_add_f32 v206, v206, v238
    v_add_f32 v207, v207, v239
    buffer_store_dwordx4 v[204:207], v18, s[24:27], s41 offen offset:3072 sc1
    s_waitcnt lgkmcnt(8)
    v_mfma_f32_16x16x32_bf16 v[208:211], v[80:83], v[168:171], v[208:211]
    ds_read_b64_tr_b16 v[72:73], v56 offset:16384
    v_mfma_f32_16x16x32_bf16 v[240:243], v[80:83], v[172:175], v[240:243]
    ds_read_b64_tr_b16 v[74:75], v56 offset:20480
    v_mfma_f32_16x16x32_bf16 v[212:215], v[84:87], v[168:171], v[212:215]
    ds_read_b64_tr_b16 v[76:77], v57 offset:16384
    v_mfma_f32_16x16x32_bf16 v[244:247], v[84:87], v[172:175], v[244:247]
    ds_read_b64_tr_b16 v[78:79], v57 offset:20480
    s_waitcnt lgkmcnt(8)
    v_mfma_f32_16x16x32_bf16 v[216:219], v[88:91], v[168:171], v[216:219]
    ds_read_b64_tr_b16 v[80:81], v54 offset:24576
    v_mfma_f32_16x16x32_bf16 v[248:251], v[88:91], v[172:175], v[248:251]
    ds_read_b64_tr_b16 v[82:83], v54 offset:28672
    v_mfma_f32_16x16x32_bf16 v[220:223], v[92:95], v[168:171], v[220:223]
    ds_read_b64_tr_b16 v[84:85], v55 offset:24576
    v_mfma_f32_16x16x32_bf16 v[252:255], v[92:95], v[172:175], v[252:255]
    ds_read_b64_tr_b16 v[86:87], v55 offset:28672
    s_waitcnt lgkmcnt(8)
    v_mfma_f32_16x16x32_bf16 v[208:211], v[64:67], v[176:179], v[208:211]
    ds_read_b64_tr_b16 v[88:89], v56 offset:24576
    v_mfma_f32_16x16x32_bf16 v[240:243], v[64:67], v[180:183], v[240:243]
    ds_read_b64_tr_b16 v[90:91], v56 offset:28672
    v_mfma_f32_16x16x32_bf16 v[212:215], v[68:71], v[176:179], v[212:215]
    ds_read_b64_tr_b16 v[92:93], v57 offset:24576
    v_mfma_f32_16x16x32_bf16 v[244:247], v[68:71], v[180:183], v[244:247]
    ds_read_b64_tr_b16 v[94:95], v57 offset:28672
    s_waitcnt lgkmcnt(8)
    v_mfma_f32_16x16x32_bf16 v[216:219], v[72:75], v[176:179], v[216:219]
    v_mfma_f32_16x16x32_bf16 v[248:251], v[72:75], v[180:183], v[248:251]
    v_mfma_f32_16x16x32_bf16 v[220:223], v[76:79], v[176:179], v[220:223]
    v_mfma_f32_16x16x32_bf16 v[252:255], v[76:79], v[180:183], v[252:255]
    s_waitcnt lgkmcnt(4)
    v_mfma_f32_16x16x32_bf16 v[208:211], v[80:83], v[184:187], v[208:211]
    v_mfma_f32_16x16x32_bf16 v[240:243], v[80:83], v[188:191], v[240:243]
    v_mfma_f32_16x16x32_bf16 v[212:215], v[84:87], v[184:187], v[212:215]
    s_lshr_b32 s36, s28, 2
    s_lshl_b32 s36, s36, 15
    s_and_b32 s37, s28, 3
    v_mfma_f32_16x16x32_bf16 v[244:247], v[84:87], v[188:191], v[244:247]
    s_lshl_b32 s37, s37, 12
    s_add_u32 s36, s36, s37
    s_add_u32 s36, s36, 65536
    s_waitcnt lgkmcnt(0)
    v_mfma_f32_16x16x32_bf16 v[216:219], v[88:91], v[184:187], v[216:219]
    v_add_u32 v20, s36, v22
    v_xor_b32 v21, 32768, v20
    v_mfma_f32_16x16x32_bf16 v[248:251], v[88:91], v[188:191], v[248:251]
    v_mfma_f32_16x16x32_bf16 v[220:223], v[92:95], v[184:187], v[220:223]
    v_mfma_f32_16x16x32_bf16 v[252:255], v[92:95], v[188:191], v[252:255]
    s_waitcnt vmcnt(0)
    v_mov_b32 v4, s40
    v_mov_b32 v13, 1
    s_mov_b64 exec, 1
    global_atomic_add v4, v13, s[90:91]
    s_mov_b64 exec, -1
    s_nop 3
    s_nop 4
    ds_write_b128 v20, v[240:243] offset:0
    ds_write_b128 v20, v[244:247] offset:1024
    ds_write_b128 v20, v[248:251] offset:2048
    ds_write_b128 v20, v[252:255] offset:3072
    v_lshlrev_b32 v96, 16, v40
    v_and_b32 v97, 0xffff0000, v40
    v_sub_f32 v112, v96, v48
    v_sub_f32 v113, v97, v48
    v_cvt_pk_bf16_f32 v10, v112, v113
    v_lshlrev_b32 v112, 16, v10
    v_and_b32 v113, 0xffff0000, v10
    v_mul_f32 v112, v112, v49
    v_mul_f32 v113, v113, v49
    v_cvt_pk_bf16_f32 v10, v112, v113
    v_lshlrev_b32 v112, 16, v10
    v_and_b32 v113, 0xffff0000, v10
    v_mul_f32 v11, 0xbfb8aa3b, v112
    v_mul_f32 v12, 0xbfb8aa3b, v113
    v_exp_f32 v11, v11
    v_exp_f32 v12, v12
    s_nop 0
    v_add_f32 v11, 1.0, v11
    v_add_f32 v12, 1.0, v12
    v_rcp_f32 v11, v11
    v_rcp_f32 v12, v12
    s_nop 0
    v_mul_f32 v112, v112, v11
    v_mul_f32 v113, v113, v12
    v_cvt_pk_bf16_f32 v10, v112, v113
    v_lshlrev_b32 v112, 16, v10
    v_and_b32 v113, 0xffff0000, v10
    v_lshlrev_b32 v98, 16, v41
    v_and_b32 v99, 0xffff0000, v41
    v_sub_f32 v114, v98, v48
    v_sub_f32 v115, v99, v48
    v_cvt_pk_bf16_f32 v10, v114, v115
    v_lshlrev_b32 v114, 16, v10
    v_and_b32 v115, 0xffff0000, v10
    v_mul_f32 v114, v114, v49
    v_mul_f32 v115, v115, v49
    v_cvt_pk_bf16_f32 v10, v114, v115
    v_lshlrev_b32 v114, 16, v10
    v_and_b32 v115, 0xffff0000, v10
    v_mul_f32 v11, 0xbfb8aa3b, v114
    v_mul_f32 v12, 0xbfb8aa3b, v115
    v_exp_f32 v11, v11
    v_exp_f32 v12, v12
    s_nop 0
    v_add_f32 v11, 1.0, v11
    v_add_f32 v12, 1.0, v12
    v_rcp_f32 v11, v11
    v_rcp_f32 v12, v12
    s_nop 0
    v_mul_f32 v114, v114, v11
    v_mul_f32 v115, v115, v12
    v_cvt_pk_bf16_f32 v10, v114, v115
    v_lshlrev_b32 v114, 16, v10
    v_and_b32 v115, 0xffff0000, v10
    v_lshlrev_b32 v100, 16, v42
    v_and_b32 v101, 0xffff0000, v42
    v_sub_f32 v116, v100, v48
    v_sub_f32 v117, v101, v48
    v_cvt_pk_bf16_f32 v10, v116, v117
    v_lshlrev_b32 v116, 16, v10
    v_and_b32 v117, 0xffff0000, v10
    v_mul_f32 v116, v116, v49
    v_mul_f32 v117, v117, v49
    v_cvt_pk_bf16_f32 v10, v116, v117
    v_lshlrev_b32 v116, 16, v10
    v_and_b32 v117, 0xffff0000, v10
    v_mul_f32 v11, 0xbfb8aa3b, v116
    v_mul_f32 v12, 0xbfb8aa3b, v117
    v_exp_f32 v11, v11
    v_exp_f32 v12, v12
    s_nop 0
    v_add_f32 v11, 1.0, v11
    v_add_f32 v12, 1.0, v12
    v_rcp_f32 v11, v11
    v_rcp_f32 v12, v12
    s_nop 0
    v_mul_f32 v116, v116, v11
    v_mul_f32 v117, v117, v12
    v_cvt_pk_bf16_f32 v10, v116, v117
    v_lshlrev_b32 v116, 16, v10
    v_and_b32 v117, 0xffff0000, v10
    v_lshlrev_b32 v102, 16, v43
    v_and_b32 v103, 0xffff0000, v43
    v_sub_f32 v118, v102, v48
    v_sub_f32 v119, v103, v48
    v_cvt_pk_bf16_f32 v10, v118, v119
    v_lshlrev_b32 v118, 16, v10
    v_and_b32 v119, 0xffff0000, v10
    v_mul_f32 v118, v118, v49
    v_mul_f32 v119, v119, v49
    v_cvt_pk_bf16_f32 v10, v118, v119
    v_lshlrev_b32 v118, 16, v10
    v_and_b32 v119, 0xffff0000, v10
    v_mul_f32 v11, 0xbfb8aa3b, v118
    v_mul_f32 v12, 0xbfb8aa3b, v119
    v_exp_f32 v11, v11
    v_exp_f32 v12, v12
    s_nop 0
    v_add_f32 v11, 1.0, v11
    v_add_f32 v12, 1.0, v12
    v_rcp_f32 v11, v11
    v_rcp_f32 v12, v12
    s_nop 0
    v_mul_f32 v118, v118, v11
    v_mul_f32 v119, v119, v12
    v_cvt_pk_bf16_f32 v10, v118, v119
    v_lshlrev_b32 v118, 16, v10
    v_and_b32 v119, 0xffff0000, v10
    s_cmp_eq_u32 s28, 3
    s_cbranch_scc1 L_recurrent_scan__compressed_kv_cla__moe_arch_mod__prompt_kernel_rare_207
L_recurrent_scan__compressed_kv_cla__moe_arch_mod__prompt_kernel_back_208:
    s_waitcnt lgkmcnt(0)
    s_barrier
    buffer_load_dwordx4 v[64:67], v18, s[24:27], s39 offen offset:0 sc1
    buffer_load_dwordx4 v[68:71], v18, s[24:27], s39 offen offset:1024 sc1
    buffer_load_dwordx4 v[72:75], v18, s[24:27], s39 offen offset:2048 sc1
    buffer_load_dwordx4 v[76:79], v18, s[24:27], s39 offen offset:3072 sc1
    ds_read_b128 v[128:131], v21 offset:0
    ds_read_b128 v[132:135], v21 offset:1024
    ds_read_b128 v[136:139], v21 offset:2048
    ds_read_b128 v[140:143], v21 offset:3072
    s_waitcnt lgkmcnt(3)
    v_pk_add_f32 v[128:129], v[128:129], v[208:209]
    v_pk_add_f32 v[130:131], v[130:131], v[210:211]
    s_waitcnt lgkmcnt(2)
    v_pk_add_f32 v[132:133], v[132:133], v[212:213]
    v_pk_add_f32 v[134:135], v[134:135], v[214:215]
    s_waitcnt lgkmcnt(1)
    v_pk_add_f32 v[136:137], v[136:137], v[216:217]
    v_pk_add_f32 v[138:139], v[138:139], v[218:219]
    s_waitcnt lgkmcnt(0)
    v_pk_add_f32 v[140:141], v[140:141], v[220:221]
    v_pk_add_f32 v[142:143], v[142:143], v[222:223]
    v_lshlrev_b32 v104, 16, v44
    v_and_b32 v105, 0xffff0000, v44
    v_sub_f32 v120, v104, v48
    v_sub_f32 v121, v105, v48
    v_cvt_pk_bf16_f32 v10, v120, v121
    v_lshlrev_b32 v120, 16, v10
    v_and_b32 v121, 0xffff0000, v10
    v_mul_f32 v120, v120, v49
    v_mul_f32 v121, v121, v49
    v_cvt_pk_bf16_f32 v10, v120, v121
    v_lshlrev_b32 v120, 16, v10
    v_and_b32 v121, 0xffff0000, v10
    v_mul_f32 v11, 0xbfb8aa3b, v120
    v_mul_f32 v12, 0xbfb8aa3b, v121
    v_exp_f32 v11, v11
    v_exp_f32 v12, v12
    s_nop 0
    v_add_f32 v11, 1.0, v11
    v_add_f32 v12, 1.0, v12
    v_rcp_f32 v11, v11
    v_rcp_f32 v12, v12
    s_nop 0
    v_mul_f32 v120, v120, v11
    v_mul_f32 v121, v121, v12
    v_cvt_pk_bf16_f32 v10, v120, v121
    v_lshlrev_b32 v120, 16, v10
    v_and_b32 v121, 0xffff0000, v10
    v_lshlrev_b32 v106, 16, v45
    v_and_b32 v107, 0xffff0000, v45
    v_sub_f32 v122, v106, v48
    v_sub_f32 v123, v107, v48
    v_cvt_pk_bf16_f32 v10, v122, v123
    v_lshlrev_b32 v122, 16, v10
    v_and_b32 v123, 0xffff0000, v10
    v_mul_f32 v122, v122, v49
    v_mul_f32 v123, v123, v49
    v_cvt_pk_bf16_f32 v10, v122, v123
    v_lshlrev_b32 v122, 16, v10
    v_and_b32 v123, 0xffff0000, v10
    v_mul_f32 v11, 0xbfb8aa3b, v122
    v_mul_f32 v12, 0xbfb8aa3b, v123
    v_exp_f32 v11, v11
    v_exp_f32 v12, v12
    s_nop 0
    v_add_f32 v11, 1.0, v11
    v_add_f32 v12, 1.0, v12
    v_rcp_f32 v11, v11
    v_rcp_f32 v12, v12
    s_nop 0
    v_mul_f32 v122, v122, v11
    v_mul_f32 v123, v123, v12
    v_cvt_pk_bf16_f32 v10, v122, v123
    v_lshlrev_b32 v122, 16, v10
    v_and_b32 v123, 0xffff0000, v10
    v_lshlrev_b32 v108, 16, v46
    v_and_b32 v109, 0xffff0000, v46
    v_sub_f32 v124, v108, v48
    v_sub_f32 v125, v109, v48
    v_cvt_pk_bf16_f32 v10, v124, v125
    v_lshlrev_b32 v124, 16, v10
    v_and_b32 v125, 0xffff0000, v10
    v_mul_f32 v124, v124, v49
    v_mul_f32 v125, v125, v49
    v_cvt_pk_bf16_f32 v10, v124, v125
    v_lshlrev_b32 v124, 16, v10
    v_and_b32 v125, 0xffff0000, v10
    v_mul_f32 v11, 0xbfb8aa3b, v124
    v_mul_f32 v12, 0xbfb8aa3b, v125
    v_exp_f32 v11, v11
    v_exp_f32 v12, v12
    s_nop 0
    v_add_f32 v11, 1.0, v11
    v_add_f32 v12, 1.0, v12
    v_rcp_f32 v11, v11
    v_rcp_f32 v12, v12
    s_nop 0
    v_mul_f32 v124, v124, v11
    v_mul_f32 v125, v125, v12
    v_cvt_pk_bf16_f32 v10, v124, v125
    v_lshlrev_b32 v124, 16, v10
    v_and_b32 v125, 0xffff0000, v10
    v_lshlrev_b32 v110, 16, v47
    v_and_b32 v111, 0xffff0000, v47
    v_sub_f32 v126, v110, v48
    v_sub_f32 v127, v111, v48
    v_cvt_pk_bf16_f32 v10, v126, v127
    v_lshlrev_b32 v126, 16, v10
    v_and_b32 v127, 0xffff0000, v10
    v_mul_f32 v126, v126, v49
    v_mul_f32 v127, v127, v49
    v_cvt_pk_bf16_f32 v10, v126, v127
    v_lshlrev_b32 v126, 16, v10
    v_and_b32 v127, 0xffff0000, v10
    v_mul_f32 v11, 0xbfb8aa3b, v126
    v_mul_f32 v12, 0xbfb8aa3b, v127
    v_exp_f32 v11, v11
    v_exp_f32 v12, v12
    s_nop 0
    v_add_f32 v11, 1.0, v11
    v_add_f32 v12, 1.0, v12
    v_rcp_f32 v11, v11
    v_rcp_f32 v12, v12
    s_nop 0
    v_mul_f32 v126, v126, v11
    v_mul_f32 v127, v127, v12
    v_cvt_pk_bf16_f32 v10, v126, v127
    v_lshlrev_b32 v126, 16, v10
    v_and_b32 v127, 0xffff0000, v10
    s_sub_u32 s36, s56, s38
    s_sub_u32 s37, s57, s38
    s_min_u32 s36, s36, s37
    s_cmp_lt_u32 s36, 16
    s_cbranch_scc1 L_recurrent_scan__compressed_kv_cla__moe_arch_mod__prompt_kernel_rare_209
L_recurrent_scan__compressed_kv_cla__moe_arch_mod__prompt_kernel_back_210:
    s_waitcnt vmcnt(3)
    v_pk_add_f32 v[128:129], v[128:129], v[64:65]
    v_cvt_pk_bf16_f32 v23, v128, v129
    v_lshlrev_b32 v128, 16, v23
    v_and_b32 v129, 0xffff0000, v23
    v_pk_mul_f32 v[128:129], v[128:129], v[112:113]
    v_cvt_pk_bf16_f32 v23, v128, v129
    v_lshlrev_b32 v128, 16, v23
    v_and_b32 v129, 0xffff0000, v23
    v_pk_add_f32 v[128:129], v[128:129], v[96:97]
    v_cvt_pk_bf16_f32 v80, v128, v129
    v_pk_add_f32 v[130:131], v[130:131], v[66:67]
    v_cvt_pk_bf16_f32 v23, v130, v131
    v_lshlrev_b32 v130, 16, v23
    v_and_b32 v131, 0xffff0000, v23
    v_pk_mul_f32 v[130:131], v[130:131], v[114:115]
    v_cvt_pk_bf16_f32 v23, v130, v131
    v_lshlrev_b32 v130, 16, v23
    v_and_b32 v131, 0xffff0000, v23
    v_pk_add_f32 v[130:131], v[130:131], v[98:99]
    v_cvt_pk_bf16_f32 v81, v130, v131
    ds_write_b64 v63, v[80:81] offset:0
    s_waitcnt vmcnt(2)
    v_pk_add_f32 v[132:133], v[132:133], v[68:69]
    v_cvt_pk_bf16_f32 v23, v132, v133
    v_lshlrev_b32 v132, 16, v23
    v_and_b32 v133, 0xffff0000, v23
    v_pk_mul_f32 v[132:133], v[132:133], v[116:117]
    v_cvt_pk_bf16_f32 v23, v132, v133
    v_lshlrev_b32 v132, 16, v23
    v_and_b32 v133, 0xffff0000, v23
    v_pk_add_f32 v[132:133], v[132:133], v[100:101]
    v_cvt_pk_bf16_f32 v82, v132, v133
    v_pk_add_f32 v[134:135], v[134:135], v[70:71]
    v_cvt_pk_bf16_f32 v23, v134, v135
    v_lshlrev_b32 v134, 16, v23
    v_and_b32 v135, 0xffff0000, v23
    v_pk_mul_f32 v[134:135], v[134:135], v[118:119]
    v_cvt_pk_bf16_f32 v23, v134, v135
    v_lshlrev_b32 v134, 16, v23
    v_and_b32 v135, 0xffff0000, v23
    v_pk_add_f32 v[134:135], v[134:135], v[102:103]
    v_cvt_pk_bf16_f32 v83, v134, v135
    ds_write_b64 v63, v[82:83] offset:32
    s_waitcnt vmcnt(1)
    v_pk_add_f32 v[136:137], v[136:137], v[72:73]
    v_cvt_pk_bf16_f32 v23, v136, v137
    v_lshlrev_b32 v136, 16, v23
    v_and_b32 v137, 0xffff0000, v23
    v_pk_mul_f32 v[136:137], v[136:137], v[120:121]
    v_cvt_pk_bf16_f32 v23, v136, v137
    v_lshlrev_b32 v136, 16, v23
    v_and_b32 v137, 0xffff0000, v23
    v_pk_add_f32 v[136:137], v[136:137], v[104:105]
    v_cvt_pk_bf16_f32 v84, v136, v137
    v_pk_add_f32 v[138:139], v[138:139], v[74:75]
    v_cvt_pk_bf16_f32 v23, v138, v139
    v_lshlrev_b32 v138, 16, v23
    v_and_b32 v139, 0xffff0000, v23
    v_pk_mul_f32 v[138:139], v[138:139], v[122:123]
    v_cvt_pk_bf16_f32 v23, v138, v139
    v_lshlrev_b32 v138, 16, v23
    v_and_b32 v139, 0xffff0000, v23
    v_pk_add_f32 v[138:139], v[138:139], v[106:107]
    v_cvt_pk_bf16_f32 v85, v138, v139
    ds_write_b64 v63, v[84:85] offset:64
    s_waitcnt vmcnt(0)
    v_pk_add_f32 v[140:141], v[140:141], v[76:77]
    v_cvt_pk_bf16_f32 v23, v140, v141
    v_lshlrev_b32 v140, 16, v23
    v_and_b32 v141, 0xffff0000, v23
    v_pk_mul_f32 v[140:141], v[140:141], v[124:125]
    v_cvt_pk_bf16_f32 v23, v140, v141
    v_lshlrev_b32 v140, 16, v23
    v_and_b32 v141, 0xffff0000, v23
    v_pk_add_f32 v[140:141], v[140:141], v[108:109]
    v_cvt_pk_bf16_f32 v86, v140, v141
    v_pk_add_f32 v[142:143], v[142:143], v[78:79]
    v_cvt_pk_bf16_f32 v23, v142, v143
    v_lshlrev_b32 v142, 16, v23
    v_and_b32 v143, 0xffff0000, v23
    v_pk_mul_f32 v[142:143], v[142:143], v[126:127]
    v_cvt_pk_bf16_f32 v23, v142, v143
    v_lshlrev_b32 v142, 16, v23
    v_and_b32 v143, 0xffff0000, v23
    v_pk_add_f32 v[142:143], v[142:143], v[110:111]
    v_cvt_pk_bf16_f32 v87, v142, v143
    ds_write_b64 v63, v[86:87] offset:96
    v_add_u32 v22, s42, v22
    s_mov_b32 s36, 16384
    s_waitcnt lgkmcnt(0)
    ds_read_b128 v[64:67], v22
    ds_read_b128 v[68:71], v22 offset:1024
    s_waitcnt lgkmcnt(1)
    buffer_store_dwordx4 v[64:67], v15, s[20:23], 0 offen sc1
    s_waitcnt lgkmcnt(0)
    buffer_store_dwordx4 v[68:71], v15, s[20:23], s36 offen sc1
    s_endpgm
L_recurrent_scan__compressed_kv_cla__moe_arch_mod__prompt_kernel_rare_170:
    v_mov_b32 v26, s40
    v_mov_b32 v28, 1
    v_writelane_b32 v26, s41, 1
    s_mov_b64 exec, 3
    global_atomic_add v26, v28, s[90:91]
    s_mov_b64 exec, -1
    s_branch L_recurrent_scan__compressed_kv_cla__moe_arch_mod__prompt_kernel_back_171
L_recurrent_scan__compressed_kv_cla__moe_arch_mod__prompt_kernel_rare_174:
    s_and_b32 s36, s2, 15
    s_add_u32 s36, s36, 96
    s_lshl_b32 s36, s36, 7
    v_mov_b32 v26, s36
    v_mov_b32 v27, 1
    s_mov_b64 exec, 1
    global_atomic_add v26, v27, s[90:91]
    s_mov_b64 exec, -1
    s_nop 3
    s_branch L_recurrent_scan__compressed_kv_cla__moe_arch_mod__prompt_kernel_back_175
L_recurrent_scan__compressed_kv_cla__moe_arch_mod__prompt_kernel_rare_176:
    global_load_dword v59, v58, s[90:91] sc1
    s_branch L_recurrent_scan__compressed_kv_cla__moe_arch_mod__prompt_kernel_back_177
L_recurrent_scan__compressed_kv_cla__moe_arch_mod__prompt_kernel_rare_181:
    s_mov_b32 s61, 0x40000
    s_waitcnt vmcnt(7)
    s_branch L_recurrent_scan__compressed_kv_cla__moe_arch_mod__prompt_kernel_cchk_180
L_recurrent_scan__compressed_kv_cla__moe_arch_mod__prompt_kernel_cspin_178:
    s_sub_u32 s61, s61, 1
    s_cbranch_scc1 L_recurrent_scan__compressed_kv_cla__moe_arch_mod__prompt_kernel_cspinx_179
    global_load_dword v59, v58, s[90:91] sc1
    s_waitcnt vmcnt(0)
L_recurrent_scan__compressed_kv_cla__moe_arch_mod__prompt_kernel_cchk_180:
    v_cmp_le_u32 vcc, 4, v59
    s_nop 0
    s_and_b32 s60, vcc_lo, 31
    s_and_b32 s36, s60, s44
    s_cmp_eq_u32 s36, s44
    s_cbranch_scc1 L_recurrent_scan__compressed_kv_cla__moe_arch_mod__prompt_kernel_cspinx_179
    s_sleep 6
    s_branch L_recurrent_scan__compressed_kv_cla__moe_arch_mod__prompt_kernel_cspin_178
L_recurrent_scan__compressed_kv_cla__moe_arch_mod__prompt_kernel_cspinx_179:
    s_lshl_b32 s44, s44, 1
    s_or_b32 s44, s44, 1
    s_and_b32 s44, s44, 31
    s_branch L_recurrent_scan__compressed_kv_cla__moe_arch_mod__prompt_kernel_back_182
L_recurrent_scan__compressed_kv_cla__moe_arch_mod__prompt_kernel_rare_183:
    global_load_dword v59, v58, s[90:91] sc1
    s_branch L_recurrent_scan__compressed_kv_cla__moe_arch_mod__prompt_kernel_back_184
L_recurrent_scan__compressed_kv_cla__moe_arch_mod__prompt_kernel_rare_188:
    s_mov_b32 s61, 0x40000
    s_waitcnt vmcnt(7)
    s_branch L_recurrent_scan__compressed_kv_cla__moe_arch_mod__prompt_kernel_cchk_187
L_recurrent_scan__compressed_kv_cla__moe_arch_mod__prompt_kernel_cspin_185:
    s_sub_u32 s61, s61, 1
    s_cbranch_scc1 L_recurrent_scan__compressed_kv_cla__moe_arch_mod__prompt_kernel_cspinx_186
    global_load_dword v59, v58, s[90:91] sc1
    s_waitcnt vmcnt(0)
L_recurrent_scan__compressed_kv_cla__moe_arch_mod__prompt_kernel_cchk_187:
    v_cmp_le_u32 vcc, 4, v59
    s_nop 0
    s_and_b32 s60, vcc_lo, 31
    s_and_b32 s36, s60, s44
    s_cmp_eq_u32 s36, s44
    s_cbranch_scc1 L_recurrent_scan__compressed_kv_cla__moe_arch_mod__prompt_kernel_cspinx_186
    s_sleep 6
    s_branch L_recurrent_scan__compressed_kv_cla__moe_arch_mod__prompt_kernel_cspin_185
L_recurrent_scan__compressed_kv_cla__moe_arch_mod__prompt_kernel_cspinx_186:
    s_lshl_b32 s44, s44, 1
    s_or_b32 s44, s44, 1
    s_and_b32 s44, s44, 31
    s_branch L_recurrent_scan__compressed_kv_cla__moe_arch_mod__prompt_kernel_back_189
L_recurrent_scan__compressed_kv_cla__moe_arch_mod__prompt_kernel_rare_190:
    s_add_u32 s36, s30, 96
    s_lshl_b32 s36, s36, 7
    v_mov_b32 v60, s36
    global_load_dword v61, v60, s[90:91] sc1
    s_branch L_recurrent_scan__compressed_kv_cla__moe_arch_mod__prompt_kernel_back_191
L_recurrent_scan__compressed_kv_cla__moe_arch_mod__prompt_kernel_rt1_rare_3:
    s_mov_b32 s61, 0x40000
L_recurrent_scan__compressed_kv_cla__moe_arch_mod__prompt_kernel_rt1_spin_1:
    s_sub_u32 s61, s61, 1
    s_cbranch_scc1 L_recurrent_scan__compressed_kv_cla__moe_arch_mod__prompt_kernel_rt1_spinx_2
    s_sleep 1
    global_load_dword v61, v60, s[90:91] sc1
    s_waitcnt vmcnt(0)
    v_readfirstlane_b32 s36, v61
    s_nop 0
    s_cmp_lt_u32 s36, 16
    s_cbranch_scc1 L_recurrent_scan__compressed_kv_cla__moe_arch_mod__prompt_kernel_rt1_spin_1
L_recurrent_scan__compressed_kv_cla__moe_arch_mod__prompt_kernel_rt1_spinx_2:
    s_branch L_recurrent_scan__compressed_kv_cla__moe_arch_mod__prompt_kernel_rt1_back_4
L_recurrent_scan__compressed_kv_cla__moe_arch_mod__prompt_kernel_rare_192:
    s_waitcnt vmcnt(14)
    v_readfirstlane_b32 s36, v61
    s_nop 0
    s_cmp_lt_u32 s36, 16
    s_cbranch_scc1 L_recurrent_scan__compressed_kv_cla__moe_arch_mod__prompt_kernel_rt1_rare_3
L_recurrent_scan__compressed_kv_cla__moe_arch_mod__prompt_kernel_rt1_back_4:
    s_lshl_b32 s37, s30, 8
    s_add_u32 s36, s37, 59768832
    s_add_u32 s37, s36, 4096
    v_and_b32 v60, 15, v1
    v_lshlrev_b32 v60, 13, v60
    v_lshl_add_u32 v60, v19, 4, v60
    buffer_load_dwordx4 v[96:99], v60, s[24:27], s36 offen offset:0 sc1
    buffer_load_dwordx4 v[100:103], v60, s[24:27], s36 offen offset:64 sc1
    buffer_load_dwordx4 v[104:107], v60, s[24:27], s36 offen offset:128 sc1
    buffer_load_dwordx4 v[108:111], v60, s[24:27], s36 offen offset:192 sc1
    buffer_load_dwordx4 v[112:115], v60, s[24:27], s37 offen offset:0 sc1
    buffer_load_dwordx4 v[116:119], v60, s[24:27], s37 offen offset:64 sc1
    buffer_load_dwordx4 v[120:123], v60, s[24:27], s37 offen offset:128 sc1
    buffer_load_dwordx4 v[124:127], v60, s[24:27], s37 offen offset:192 sc1
    s_branch L_recurrent_scan__compressed_kv_cla__moe_arch_mod__prompt_kernel_back_193
L_recurrent_scan__compressed_kv_cla__moe_arch_mod__prompt_kernel_rare_194:
    v_mov_b64 v[24:25], 0
    v_mov_b64 v[26:27], 0
    v_mov_b64 v[28:29], 0
    v_mov_b64 v[30:31], 0
    v_mov_b64 v[32:33], 0
    v_mov_b64 v[34:35], 0
    v_mov_b64 v[36:37], 0
    v_mov_b64 v[38:39], 0
    s_waitcnt vmcnt(14)
    s_sub_u32 s36, s56, s38
    s_cmp_lt_u32 s36, 16
    s_cbranch_scc0 L_recurrent_scan__compressed_kv_cla__moe_arch_mod__prompt_kernel_rt2_noy_1
    s_and_b32 s36, s58, 0xffff0000
    s_cmp_lt_i32 s36, 0
    s_cselect_b32 s37, 0x80000000, -1
    s_xor_b32 s36, s36, s37
    s_and_b32 s36, s36, 0xffff0000
    v_mov_b32 v62, s36
    v_mul_f32 v62, 0xbfb8aa3b, v62
    v_exp_f32 v62, v62
    s_nop 0
    v_add_f32 v62, 1.0, v62
    v_rcp_f32 v62, v62
    s_nop 0
    v_cvt_pk_bf16_f32 v62, v62, v62
    v_lshlrev_b32 v62, 16, v62
    v_add_f32_dpp v96, v96, v96 quad_perm:[1,0,3,2] row_mask:0xf bank_mask:0xf
    v_add_f32_dpp v97, v97, v97 quad_perm:[1,0,3,2] row_mask:0xf bank_mask:0xf
    v_add_f32_dpp v98, v98, v98 quad_perm:[1,0,3,2] row_mask:0xf bank_mask:0xf
    v_add_f32_dpp v99, v99, v99 quad_perm:[1,0,3,2] row_mask:0xf bank_mask:0xf
    v_add_f32_dpp v100, v100, v100 quad_perm:[1,0,3,2] row_mask:0xf bank_mask:0xf
    v_add_f32_dpp v101, v101, v101 quad_perm:[1,0,3,2] row_mask:0xf bank_mask:0xf
    v_add_f32_dpp v102, v102, v102 quad_perm:[1,0,3,2] row_mask:0xf bank_mask:0xf
    v_add_f32_dpp v103, v103, v103 quad_perm:[1,0,3,2] row_mask:0xf bank_mask:0xf
    v_add_f32_dpp v104, v104, v104 quad_perm:[1,0,3,2] row_mask:0xf bank_mask:0xf
    v_add_f32_dpp v105, v105, v105 quad_perm:[1,0,3,2] row_mask:0xf bank_mask:0xf
    v_add_f32_dpp v106, v106, v106 quad_perm:[1,0,3,2] row_mask:0xf bank_mask:0xf
    v_add_f32_dpp v107, v107, v107 quad_perm:[1,0,3,2] row_mask:0xf bank_mask:0xf
    v_add_f32_dpp v108, v108, v108 quad_perm:[1,0,3,2] row_mask:0xf bank_mask:0xf
    v_add_f32_dpp v109, v109, v109 quad_perm:[1,0,3,2] row_mask:0xf bank_mask:0xf
    v_add_f32_dpp v110, v110, v110 quad_perm:[1,0,3,2] row_mask:0xf bank_mask:0xf
    v_add_f32_dpp v111, v111, v111 quad_perm:[1,0,3,2] row_mask:0xf bank_mask:0xf
    v_add_f32_dpp v96, v96, v96 quad_perm:[2,3,0,1] row_mask:0xf bank_mask:0xf
    v_add_f32_dpp v97, v97, v97 quad_perm:[2,3,0,1] row_mask:0xf bank_mask:0xf
    v_add_f32_dpp v98, v98, v98 quad_perm:[2,3,0,1] row_mask:0xf bank_mask:0xf
    v_add_f32_dpp v99, v99, v99 quad_perm:[2,3,0,1] row_mask:0xf bank_mask:0xf
    v_add_f32_dpp v100, v100, v100 quad_perm:[2,3,0,1] row_mask:0xf bank_mask:0xf
    v_add_f32_dpp v101, v101, v101 quad_perm:[2,3,0,1] row_mask:0xf bank_mask:0xf
    v_add_f32_dpp v102, v102, v102 quad_perm:[2,3,0,1] row_mask:0xf bank_mask:0xf
    v_add_f32_dpp v103, v103, v103 quad_perm:[2,3,0,1] row_mask:0xf bank_mask:0xf
    v_add_f32_dpp v104, v104, v104 quad_perm:[2,3,0,1] row_mask:0xf bank_mask:0xf
    v_add_f32_dpp v105, v105, v105 quad_perm:[2,3,0,1] row_mask:0xf bank_mask:0xf
    v_add_f32_dpp v106, v106, v106 quad_perm:[2,3,0,1] row_mask:0xf bank_mask:0xf
    v_add_f32_dpp v107, v107, v107 quad_perm:[2,3,0,1] row_mask:0xf bank_mask:0xf
    v_add_f32_dpp v108, v108, v108 quad_perm:[2,3,0,1] row_mask:0xf bank_mask:0xf
    v_add_f32_dpp v109, v109, v109 quad_perm:[2,3,0,1] row_mask:0xf bank_mask:0xf
    v_add_f32_dpp v110, v110, v110 quad_perm:[2,3,0,1] row_mask:0xf bank_mask:0xf
    v_add_f32_dpp v111, v111, v111 quad_perm:[2,3,0,1] row_mask:0xf bank_mask:0xf
    v_add_f32_dpp v96, v96, v96 row_half_mirror row_mask:0xf bank_mask:0xf
    v_add_f32_dpp v97, v97, v97 row_half_mirror row_mask:0xf bank_mask:0xf
    v_add_f32_dpp v98, v98, v98 row_half_mirror row_mask:0xf bank_mask:0xf
    v_add_f32_dpp v99, v99, v99 row_half_mirror row_mask:0xf bank_mask:0xf
    v_add_f32_dpp v100, v100, v100 row_half_mirror row_mask:0xf bank_mask:0xf
    v_add_f32_dpp v101, v101, v101 row_half_mirror row_mask:0xf bank_mask:0xf
    v_add_f32_dpp v102, v102, v102 row_half_mirror row_mask:0xf bank_mask:0xf
    v_add_f32_dpp v103, v103, v103 row_half_mirror row_mask:0xf bank_mask:0xf
    v_add_f32_dpp v104, v104, v104 row_half_mirror row_mask:0xf bank_mask:0xf
    v_add_f32_dpp v105, v105, v105 row_half_mirror row_mask:0xf bank_mask:0xf
    v_add_f32_dpp v106, v106, v106 row_half_mirror row_mask:0xf bank_mask:0xf
    v_add_f32_dpp v107, v107, v107 row_half_mirror row_mask:0xf bank_mask:0xf
    v_add_f32_dpp v108, v108, v108 row_half_mirror row_mask:0xf bank_mask:0xf
    v_add_f32_dpp v109, v109, v109 row_half_mirror row_mask:0xf bank_mask:0xf
    v_add_f32_dpp v110, v110, v110 row_half_mirror row_mask:0xf bank_mask:0xf
    v_add_f32_dpp v111, v111, v111 row_half_mirror row_mask:0xf bank_mask:0xf
    v_add_f32_dpp v96, v96, v96 row_mirror row_mask:0xf bank_mask:0xf
    v_add_f32_dpp v97, v97, v97 row_mirror row_mask:0xf bank_mask:0xf
    v_add_f32_dpp v98, v98, v98 row_mirror row_mask:0xf bank_mask:0xf
    v_add_f32_dpp v99, v99, v99 row_mirror row_mask:0xf bank_mask:0xf
    v_add_f32_dpp v100, v100, v100 row_mirror row_mask:0xf bank_mask:0xf
    v_add_f32_dpp v101, v101, v101 row_mirror row_mask:0xf bank_mask:0xf
    v_add_f32_dpp v102, v102, v102 row_mirror row_mask:0xf bank_mask:0xf
    v_add_f32_dpp v103, v103, v103 row_mirror row_mask:0xf bank_mask:0xf
    v_add_f32_dpp v104, v104, v104 row_mirror row_mask:0xf bank_mask:0xf
    v_add_f32_dpp v105, v105, v105 row_mirror row_mask:0xf bank_mask:0xf
    v_add_f32_dpp v106, v106, v106 row_mirror row_mask:0xf bank_mask:0xf
    v_add_f32_dpp v107, v107, v107 row_mirror row_mask:0xf bank_mask:0xf
    v_add_f32_dpp v108, v108, v108 row_mirror row_mask:0xf bank_mask:0xf
    v_add_f32_dpp v109, v109, v109 row_mirror row_mask:0xf bank_mask:0xf
    v_add_f32_dpp v110, v110, v110 row_mirror row_mask:0xf bank_mask:0xf
    v_add_f32_dpp v111, v111, v111 row_mirror row_mask:0xf bank_mask:0xf
    v_cmp_eq_u32 vcc, s56, v14
    v_cvt_pk_bf16_f32 v61, v96, v97
    v_lshlrev_b32 v96, 16, v61
    v_and_b32 v97, 0xffff0000, v61
    v_mul_f32 v96, v62, v96
    v_mul_f32 v97, v62, v97
    v_cvt_pk_bf16_f32 v61, v96, v97
    v_lshlrev_b32 v96, 16, v61
    v_and_b32 v97, 0xffff0000, v61
    v_cndmask_b32 v24, v24, v96, vcc
    v_cndmask_b32 v25, v25, v97, vcc
    v_cvt_pk_bf16_f32 v61, v98, v99
    v_lshlrev_b32 v98, 16, v61
    v_and_b32 v99, 0xffff0000, v61
    v_mul_f32 v98, v62, v98
    v_mul_f32 v99, v62, v99
    v_cvt_pk_bf16_f32 v61, v98, v99
    v_lshlrev_b32 v98, 16, v61
    v_and_b32 v99, 0xffff0000, v61
    v_cndmask_b32 v26, v26, v98, vcc
    v_cndmask_b32 v27, v27, v99, vcc
    v_cvt_pk_bf16_f32 v61, v100, v101
    v_lshlrev_b32 v100, 16, v61
    v_and_b32 v101, 0xffff0000, v61
    v_mul_f32 v100, v62, v100
    v_mul_f32 v101, v62, v101
    v_cvt_pk_bf16_f32 v61, v100, v101
    v_lshlrev_b32 v100, 16, v61
    v_and_b32 v101, 0xffff0000, v61
    v_cndmask_b32 v28, v28, v100, vcc
    v_cndmask_b32 v29, v29, v101, vcc
    v_cvt_pk_bf16_f32 v61, v102, v103
    v_lshlrev_b32 v102, 16, v61
    v_and_b32 v103, 0xffff0000, v61
    v_mul_f32 v102, v62, v102
    v_mul_f32 v103, v62, v103
    v_cvt_pk_bf16_f32 v61, v102, v103
    v_lshlrev_b32 v102, 16, v61
    v_and_b32 v103, 0xffff0000, v61
    v_cndmask_b32 v30, v30, v102, vcc
    v_cndmask_b32 v31, v31, v103, vcc
    v_cvt_pk_bf16_f32 v61, v104, v105
    v_lshlrev_b32 v104, 16, v61
    v_and_b32 v105, 0xffff0000, v61
    v_mul_f32 v104, v62, v104
    v_mul_f32 v105, v62, v105
    v_cvt_pk_bf16_f32 v61, v104, v105
    v_lshlrev_b32 v104, 16, v61
    v_and_b32 v105, 0xffff0000, v61
    v_cndmask_b32 v32, v32, v104, vcc
    v_cndmask_b32 v33, v33, v105, vcc
    v_cvt_pk_bf16_f32 v61, v106, v107
    v_lshlrev_b32 v106, 16, v61
    v_and_b32 v107, 0xffff0000, v61
    v_mul_f32 v106, v62, v106
    v_mul_f32 v107, v62, v107
    v_cvt_pk_bf16_f32 v61, v106, v107
    v_lshlrev_b32 v106, 16, v61
    v_and_b32 v107, 0xffff0000, v61
    v_cndmask_b32 v34, v34, v106, vcc
    v_cndmask_b32 v35, v35, v107, vcc
    v_cvt_pk_bf16_f32 v61, v108, v109
    v_lshlrev_b32 v108, 16, v61
    v_and_b32 v109, 0xffff0000, v61
    v_mul_f32 v108, v62, v108
    v_mul_f32 v109, v62, v109
    v_cvt_pk_bf16_f32 v61, v108, v109
    v_lshlrev_b32 v108, 16, v61
    v_and_b32 v109, 0xffff0000, v61
    v_cndmask_b32 v36, v36, v108, vcc
    v_cndmask_b32 v37, v37, v109, vcc
    v_cvt_pk_bf16_f32 v61, v110, v111
    v_lshlrev_b32 v110, 16, v61
    v_and_b32 v111, 0xffff0000, v61
    v_mul_f32 v110, v62, v110
    v_mul_f32 v111, v62, v111
    v_cvt_pk_bf16_f32 v61, v110, v111
    v_lshlrev_b32 v110, 16, v61
    v_and_b32 v111, 0xffff0000, v61
    v_cndmask_b32 v38, v38, v110, vcc
    v_cndmask_b32 v39, v39, v111, vcc
L_recurrent_scan__compressed_kv_cla__moe_arch_mod__prompt_kernel_rt2_noy_1:
    s_sub_u32 s36, s57, s38
    s_cmp_lt_u32 s36, 16
    s_cbranch_scc0 L_recurrent_scan__compressed_kv_cla__moe_arch_mod__prompt_kernel_rt2_noy_2
    s_and_b32 s36, s59, 0xffff0000
    s_cmp_lt_i32 s36, 0
    s_cselect_b32 s37, 0x80000000, -1
    s_xor_b32 s36, s36, s37
    s_and_b32 s36, s36, 0xffff0000
    v_mov_b32 v62, s36
    v_mul_f32 v62, 0xbfb8aa3b, v62
    v_exp_f32 v62, v62
    s_nop 0
    v_add_f32 v62, 1.0, v62
    v_rcp_f32 v62, v62
    s_nop 0
    v_cvt_pk_bf16_f32 v62, v62, v62
    v_lshlrev_b32 v62, 16, v62
    v_add_f32_dpp v112, v112, v112 quad_perm:[1,0,3,2] row_mask:0xf bank_mask:0xf
    v_add_f32_dpp v113, v113, v113 quad_perm:[1,0,3,2] row_mask:0xf bank_mask:0xf
    v_add_f32_dpp v114, v114, v114 quad_perm:[1,0,3,2] row_mask:0xf bank_mask:0xf
    v_add_f32_dpp v115, v115, v115 quad_perm:[1,0,3,2] row_mask:0xf bank_mask:0xf
    v_add_f32_dpp v116, v116, v116 quad_perm:[1,0,3,2] row_mask:0xf bank_mask:0xf
    v_add_f32_dpp v117, v117, v117 quad_perm:[1,0,3,2] row_mask:0xf bank_mask:0xf
    v_add_f32_dpp v118, v118, v118 quad_perm:[1,0,3,2] row_mask:0xf bank_mask:0xf
    v_add_f32_dpp v119, v119, v119 quad_perm:[1,0,3,2] row_mask:0xf bank_mask:0xf
    v_add_f32_dpp v120, v120, v120 quad_perm:[1,0,3,2] row_mask:0xf bank_mask:0xf
    v_add_f32_dpp v121, v121, v121 quad_perm:[1,0,3,2] row_mask:0xf bank_mask:0xf
    v_add_f32_dpp v122, v122, v122 quad_perm:[1,0,3,2] row_mask:0xf bank_mask:0xf
    v_add_f32_dpp v123, v123, v123 quad_perm:[1,0,3,2] row_mask:0xf bank_mask:0xf
    v_add_f32_dpp v124, v124, v124 quad_perm:[1,0,3,2] row_mask:0xf bank_mask:0xf
    v_add_f32_dpp v125, v125, v125 quad_perm:[1,0,3,2] row_mask:0xf bank_mask:0xf
    v_add_f32_dpp v126, v126, v126 quad_perm:[1,0,3,2] row_mask:0xf bank_mask:0xf
    v_add_f32_dpp v127, v127, v127 quad_perm:[1,0,3,2] row_mask:0xf bank_mask:0xf
    v_add_f32_dpp v112, v112, v112 quad_perm:[2,3,0,1] row_mask:0xf bank_mask:0xf
    v_add_f32_dpp v113, v113, v113 quad_perm:[2,3,0,1] row_mask:0xf bank_mask:0xf
    v_add_f32_dpp v114, v114, v114 quad_perm:[2,3,0,1] row_mask:0xf bank_mask:0xf
    v_add_f32_dpp v115, v115, v115 quad_perm:[2,3,0,1] row_mask:0xf bank_mask:0xf
    v_add_f32_dpp v116, v116, v116 quad_perm:[2,3,0,1] row_mask:0xf bank_mask:0xf
    v_add_f32_dpp v117, v117, v117 quad_perm:[2,3,0,1] row_mask:0xf bank_mask:0xf
    v_add_f32_dpp v118, v118, v118 quad_perm:[2,3,0,1] row_mask:0xf bank_mask:0xf
    v_add_f32_dpp v119, v119, v119 quad_perm:[2,3,0,1] row_mask:0xf bank_mask:0xf
    v_add_f32_dpp v120, v120, v120 quad_perm:[2,3,0,1] row_mask:0xf bank_mask:0xf
    v_add_f32_dpp v121, v121, v121 quad_perm:[2,3,0,1] row_mask:0xf bank_mask:0xf
    v_add_f32_dpp v122, v122, v122 quad_perm:[2,3,0,1] row_mask:0xf bank_mask:0xf
    v_add_f32_dpp v123, v123, v123 quad_perm:[2,3,0,1] row_mask:0xf bank_mask:0xf
    v_add_f32_dpp v124, v124, v124 quad_perm:[2,3,0,1] row_mask:0xf bank_mask:0xf
    v_add_f32_dpp v125, v125, v125 quad_perm:[2,3,0,1] row_mask:0xf bank_mask:0xf
    v_add_f32_dpp v126, v126, v126 quad_perm:[2,3,0,1] row_mask:0xf bank_mask:0xf
    v_add_f32_dpp v127, v127, v127 quad_perm:[2,3,0,1] row_mask:0xf bank_mask:0xf
    v_add_f32_dpp v112, v112, v112 row_half_mirror row_mask:0xf bank_mask:0xf
    v_add_f32_dpp v113, v113, v113 row_half_mirror row_mask:0xf bank_mask:0xf
    v_add_f32_dpp v114, v114, v114 row_half_mirror row_mask:0xf bank_mask:0xf
    v_add_f32_dpp v115, v115, v115 row_half_mirror row_mask:0xf bank_mask:0xf
    v_add_f32_dpp v116, v116, v116 row_half_mirror row_mask:0xf bank_mask:0xf
    v_add_f32_dpp v117, v117, v117 row_half_mirror row_mask:0xf bank_mask:0xf
    v_add_f32_dpp v118, v118, v118 row_half_mirror row_mask:0xf bank_mask:0xf
    v_add_f32_dpp v119, v119, v119 row_half_mirror row_mask:0xf bank_mask:0xf
    v_add_f32_dpp v120, v120, v120 row_half_mirror row_mask:0xf bank_mask:0xf
    v_add_f32_dpp v121, v121, v121 row_half_mirror row_mask:0xf bank_mask:0xf
    v_add_f32_dpp v122, v122, v122 row_half_mirror row_mask:0xf bank_mask:0xf
    v_add_f32_dpp v123, v123, v123 row_half_mirror row_mask:0xf bank_mask:0xf
    v_add_f32_dpp v124, v124, v124 row_half_mirror row_mask:0xf bank_mask:0xf
    v_add_f32_dpp v125, v125, v125 row_half_mirror row_mask:0xf bank_mask:0xf
    v_add_f32_dpp v126, v126, v126 row_half_mirror row_mask:0xf bank_mask:0xf
    v_add_f32_dpp v127, v127, v127 row_half_mirror row_mask:0xf bank_mask:0xf
    v_add_f32_dpp v112, v112, v112 row_mirror row_mask:0xf bank_mask:0xf
    v_add_f32_dpp v113, v113, v113 row_mirror row_mask:0xf bank_mask:0xf
    v_add_f32_dpp v114, v114, v114 row_mirror row_mask:0xf bank_mask:0xf
    v_add_f32_dpp v115, v115, v115 row_mirror row_mask:0xf bank_mask:0xf
    v_add_f32_dpp v116, v116, v116 row_mirror row_mask:0xf bank_mask:0xf
    v_add_f32_dpp v117, v117, v117 row_mirror row_mask:0xf bank_mask:0xf
    v_add_f32_dpp v118, v118, v118 row_mirror row_mask:0xf bank_mask:0xf
    v_add_f32_dpp v119, v119, v119 row_mirror row_mask:0xf bank_mask:0xf
    v_add_f32_dpp v120, v120, v120 row_mirror row_mask:0xf bank_mask:0xf
    v_add_f32_dpp v121, v121, v121 row_mirror row_mask:0xf bank_mask:0xf
    v_add_f32_dpp v122, v122, v122 row_mirror row_mask:0xf bank_mask:0xf
    v_add_f32_dpp v123, v123, v123 row_mirror row_mask:0xf bank_mask:0xf
    v_add_f32_dpp v124, v124, v124 row_mirror row_mask:0xf bank_mask:0xf
    v_add_f32_dpp v125, v125, v125 row_mirror row_mask:0xf bank_mask:0xf
    v_add_f32_dpp v126, v126, v126 row_mirror row_mask:0xf bank_mask:0xf
    v_add_f32_dpp v127, v127, v127 row_mirror row_mask:0xf bank_mask:0xf
    v_cmp_eq_u32 vcc, s57, v14
    v_cvt_pk_bf16_f32 v61, v112, v113
    v_lshlrev_b32 v112, 16, v61
    v_and_b32 v113, 0xffff0000, v61
    v_mul_f32 v112, v62, v112
    v_mul_f32 v113, v62, v113
    v_cvt_pk_bf16_f32 v61, v112, v113
    v_lshlrev_b32 v112, 16, v61
    v_and_b32 v113, 0xffff0000, v61
    v_cndmask_b32 v24, v24, v112, vcc
    v_cndmask_b32 v25, v25, v113, vcc
    v_cvt_pk_bf16_f32 v61, v114, v115
    v_lshlrev_b32 v114, 16, v61
    v_and_b32 v115, 0xffff0000, v61
    v_mul_f32 v114, v62, v114
    v_mul_f32 v115, v62, v115
    v_cvt_pk_bf16_f32 v61, v114, v115
    v_lshlrev_b32 v114, 16, v61
    v_and_b32 v115, 0xffff0000, v61
    v_cndmask_b32 v26, v26, v114, vcc
    v_cndmask_b32 v27, v27, v115, vcc
    v_cvt_pk_bf16_f32 v61, v116, v117
    v_lshlrev_b32 v116, 16, v61
    v_and_b32 v117, 0xffff0000, v61
    v_mul_f32 v116, v62, v116
    v_mul_f32 v117, v62, v117
    v_cvt_pk_bf16_f32 v61, v116, v117
    v_lshlrev_b32 v116, 16, v61
    v_and_b32 v117, 0xffff0000, v61
    v_cndmask_b32 v28, v28, v116, vcc
    v_cndmask_b32 v29, v29, v117, vcc
    v_cvt_pk_bf16_f32 v61, v118, v119
    v_lshlrev_b32 v118, 16, v61
    v_and_b32 v119, 0xffff0000, v61
    v_mul_f32 v118, v62, v118
    v_mul_f32 v119, v62, v119
    v_cvt_pk_bf16_f32 v61, v118, v119
    v_lshlrev_b32 v118, 16, v61
    v_and_b32 v119, 0xffff0000, v61
    v_cndmask_b32 v30, v30, v118, vcc
    v_cndmask_b32 v31, v31, v119, vcc
    v_cvt_pk_bf16_f32 v61, v120, v121
    v_lshlrev_b32 v120, 16, v61
    v_and_b32 v121, 0xffff0000, v61
    v_mul_f32 v120, v62, v120
    v_mul_f32 v121, v62, v121
    v_cvt_pk_bf16_f32 v61, v120, v121
    v_lshlrev_b32 v120, 16, v61
    v_and_b32 v121, 0xffff0000, v61
    v_cndmask_b32 v32, v32, v120, vcc
    v_cndmask_b32 v33, v33, v121, vcc
    v_cvt_pk_bf16_f32 v61, v122, v123
    v_lshlrev_b32 v122, 16, v61
    v_and_b32 v123, 0xffff0000, v61
    v_mul_f32 v122, v62, v122
    v_mul_f32 v123, v62, v123
    v_cvt_pk_bf16_f32 v61, v122, v123
    v_lshlrev_b32 v122, 16, v61
    v_and_b32 v123, 0xffff0000, v61
    v_cndmask_b32 v34, v34, v122, vcc
    v_cndmask_b32 v35, v35, v123, vcc
    v_cvt_pk_bf16_f32 v61, v124, v125
    v_lshlrev_b32 v124, 16, v61
    v_and_b32 v125, 0xffff0000, v61
    v_mul_f32 v124, v62, v124
    v_mul_f32 v125, v62, v125
    v_cvt_pk_bf16_f32 v61, v124, v125
    v_lshlrev_b32 v124, 16, v61
    v_and_b32 v125, 0xffff0000, v61
    v_cndmask_b32 v36, v36, v124, vcc
    v_cndmask_b32 v37, v37, v125, vcc
    v_cvt_pk_bf16_f32 v61, v126, v127
    v_lshlrev_b32 v126, 16, v61
    v_and_b32 v127, 0xffff0000, v61
    v_mul_f32 v126, v62, v126
    v_mul_f32 v127, v62, v127
    v_cvt_pk_bf16_f32 v61, v126, v127
    v_lshlrev_b32 v126, 16, v61
    v_and_b32 v127, 0xffff0000, v61
    v_cndmask_b32 v38, v38, v126, vcc
    v_cndmask_b32 v39, v39, v127, vcc
L_recurrent_scan__compressed_kv_cla__moe_arch_mod__prompt_kernel_rt2_noy_2:
    s_branch L_recurrent_scan__compressed_kv_cla__moe_arch_mod__prompt_kernel_back_195
L_recurrent_scan__compressed_kv_cla__moe_arch_mod__prompt_kernel_f2m_198:
    v_lshrrev_b32 v28, 4, v1
    v_bfe_u32 v26, v1, 2, 2
    v_lshl_add_u32 v26, v28, 3, v26
    v_lshlrev_b32 v26, 7, v26
    v_and_b32 v27, 3, v1
    v_lshl_add_u32 v26, v27, 3, v26
    v_bfe_u32 v27, v1, 3, 2
    s_lshl_b32 s36, s28, 12
    s_add_u32 s36, s36, 131072
    v_add_u32 v26, s36, v26
    v_xor_b32 v28, 0, v27
    v_lshl_add_u32 v28, v28, 5, v26
    ds_read_b64_tr_b16 v[112:113], v28 offset:0
    ds_read_b64_tr_b16 v[114:115], v28 offset:512
    v_xor_b32 v28, 1, v27
    v_lshl_add_u32 v28, v28, 5, v26
    ds_read_b64_tr_b16 v[116:117], v28 offset:0
    ds_read_b64_tr_b16 v[118:119], v28 offset:512
    v_xor_b32 v28, 2, v27
    v_lshl_add_u32 v28, v28, 5, v26
    ds_read_b64_tr_b16 v[120:121], v28 offset:0
    ds_read_b64_tr_b16 v[122:123], v28 offset:512
    v_xor_b32 v28, 3, v27
    v_lshl_add_u32 v28, v28, 5, v26
    ds_read_b64_tr_b16 v[124:125], v28 offset:0
    ds_read_b64_tr_b16 v[126:127], v28 offset:512
    v_add_f32_dpp v96, v96, v96 row_ror:4 row_mask:0xf bank_mask:0xf
    v_add_f32_dpp v97, v97, v97 row_ror:4 row_mask:0xf bank_mask:0xf
    v_add_f32_dpp v98, v98, v98 row_ror:4 row_mask:0xf bank_mask:0xf
    v_add_f32_dpp v99, v99, v99 row_ror:4 row_mask:0xf bank_mask:0xf
    v_add_f32_dpp v100, v100, v100 row_ror:4 row_mask:0xf bank_mask:0xf
    v_add_f32_dpp v101, v101, v101 row_ror:4 row_mask:0xf bank_mask:0xf
    v_add_f32_dpp v102, v102, v102 row_ror:4 row_mask:0xf bank_mask:0xf
    v_add_f32_dpp v103, v103, v103 row_ror:4 row_mask:0xf bank_mask:0xf
    v_add_f32_dpp v96, v96, v96 row_ror:8 row_mask:0xf bank_mask:0xf
    v_add_f32_dpp v97, v97, v97 row_ror:8 row_mask:0xf bank_mask:0xf
    v_add_f32_dpp v98, v98, v98 row_ror:8 row_mask:0xf bank_mask:0xf
    v_add_f32_dpp v99, v99, v99 row_ror:8 row_mask:0xf bank_mask:0xf
    v_add_f32_dpp v100, v100, v100 row_ror:8 row_mask:0xf bank_mask:0xf
    v_add_f32_dpp v101, v101, v101 row_ror:8 row_mask:0xf bank_mask:0xf
    v_add_f32_dpp v102, v102, v102 row_ror:8 row_mask:0xf bank_mask:0xf
    v_add_f32_dpp v103, v103, v103 row_ror:8 row_mask:0xf bank_mask:0xf
    v_cvt_pk_bf16_f32 v29, v96, v97
    v_lshlrev_b32 v96, 16, v29
    v_and_b32 v97, 0xffff0000, v29
    v_cvt_pk_bf16_f32 v29, v98, v99
    v_lshlrev_b32 v98, 16, v29
    v_and_b32 v99, 0xffff0000, v29
    v_cvt_pk_bf16_f32 v29, v100, v101
    v_lshlrev_b32 v100, 16, v29
    v_and_b32 v101, 0xffff0000, v29
    v_cvt_pk_bf16_f32 v29, v102, v103
    v_lshlrev_b32 v102, 16, v29
    v_and_b32 v103, 0xffff0000, v29
    v_mul_f32 v104, 0xbfb8aa3b, v96
    v_mul_f32 v105, 0xbfb8aa3b, v97
    v_mul_f32 v106, 0xbfb8aa3b, v98
    v_mul_f32 v107, 0xbfb8aa3b, v99
    v_mul_f32 v108, 0xbfb8aa3b, v100
    v_mul_f32 v109, 0xbfb8aa3b, v101
    v_mul_f32 v110, 0xbfb8aa3b, v102
    v_mul_f32 v111, 0xbfb8aa3b, v103
    v_exp_f32 v104, v104
    v_exp_f32 v105, v105
    v_exp_f32 v106, v106
    v_exp_f32 v107, v107
    v_exp_f32 v108, v108
    v_exp_f32 v109, v109
    v_exp_f32 v110, v110
    v_exp_f32 v111, v111
    v_add_f32 v104, 1.0, v104
    v_add_f32 v105, 1.0, v105
    v_add_f32 v106, 1.0, v106
    v_add_f32 v107, 1.0, v107
    v_add_f32 v108, 1.0, v108
    v_add_f32 v109, 1.0, v109
    v_add_f32 v110, 1.0, v110
    v_add_f32 v111, 1.0, v111
    v_rcp_f32 v104, v104
    v_rcp_f32 v105, v105
    v_rcp_f32 v106, v106
    v_rcp_f32 v107, v107
    v_rcp_f32 v108, v108
    v_rcp_f32 v109, v109
    v_rcp_f32 v110, v110
    v_rcp_f32 v111, v111
    v_mul_f32 v104, v96, v104
    v_mul_f32 v105, v97, v105
    v_mul_f32 v106, v98, v106
    v_mul_f32 v107, v99, v107
    v_mul_f32 v108, v100, v108
    v_mul_f32 v109, v101, v109
    v_mul_f32 v110, v102, v110
    v_mul_f32 v111, v103, v111
    v_cvt_pk_bf16_f32 v29, v104, v105
    v_lshlrev_b32 v104, 16, v29
    v_and_b32 v105, 0xffff0000, v29
    v_cvt_pk_bf16_f32 v29, v106, v107
    v_lshlrev_b32 v106, 16, v29
    v_and_b32 v107, 0xffff0000, v29
    v_cvt_pk_bf16_f32 v29, v108, v109
    v_lshlrev_b32 v108, 16, v29
    v_and_b32 v109, 0xffff0000, v29
    v_cvt_pk_bf16_f32 v29, v110, v111
    v_lshlrev_b32 v110, 16, v29
    v_and_b32 v111, 0xffff0000, v29
    v_mul_f32_dpp v96, v96, v104 quad_perm:[2,3,0,1] row_mask:0xf bank_mask:0xf
    v_mul_f32_dpp v97, v97, v105 quad_perm:[2,3,0,1] row_mask:0xf bank_mask:0xf
    v_mul_f32_dpp v98, v98, v106 quad_perm:[2,3,0,1] row_mask:0xf bank_mask:0xf
    v_mul_f32_dpp v99, v99, v107 quad_perm:[2,3,0,1] row_mask:0xf bank_mask:0xf
    v_mul_f32_dpp v100, v100, v108 quad_perm:[2,3,0,1] row_mask:0xf bank_mask:0xf
    v_mul_f32_dpp v101, v101, v109 quad_perm:[2,3,0,1] row_mask:0xf bank_mask:0xf
    v_mul_f32_dpp v102, v102, v110 quad_perm:[2,3,0,1] row_mask:0xf bank_mask:0xf
    v_mul_f32_dpp v103, v103, v111 quad_perm:[2,3,0,1] row_mask:0xf bank_mask:0xf
    v_cvt_pk_bf16_f32 v36, v96, v97
    v_cvt_pk_bf16_f32 v37, v98, v99
    v_cvt_pk_bf16_f32 v38, v100, v101
    v_cvt_pk_bf16_f32 v39, v102, v103
    s_waitcnt lgkmcnt(0)
    v_lshl_add_u32 v28, v1, 4, s36
    v_mfma_f32_16x16x32_bf16 v[96:99], v[112:115], v[36:39], 0
    v_mfma_f32_16x16x32_bf16 v[100:103], v[116:119], v[36:39], 0
    v_mfma_f32_16x16x32_bf16 v[104:107], v[120:123], v[36:39], 0
    v_mfma_f32_16x16x32_bf16 v[108:111], v[124:127], v[36:39], 0
    s_nop 7
    ds_write_b128 v28, v[96:99] offset:0
    ds_write_b128 v28, v[100:103] offset:1024
    ds_write_b128 v28, v[104:107] offset:2048
    ds_write_b128 v28, v[108:111] offset:3072
    s_cmp_lt_u32 s28, 4
    s_cbranch_scc1 L_recurrent_scan__compressed_kv_cla__moe_arch_mod__prompt_kernel_f2b_200
    s_branch L_recurrent_scan__compressed_kv_cla__moe_arch_mod__prompt_kernel_f2a_199
L_recurrent_scan__compressed_kv_cla__moe_arch_mod__prompt_kernel_rare_207:
    s_mov_b32 s61, 0x40000
L_recurrent_scan__compressed_kv_cla__moe_arch_mod__prompt_kernel_spin_205:
    s_sub_u32 s61, s61, 1
    s_cbranch_scc1 L_recurrent_scan__compressed_kv_cla__moe_arch_mod__prompt_kernel_spinx_206
    s_sleep 1
    global_load_dword v23, v5, s[90:91] sc1
    s_waitcnt vmcnt(0)
    v_readfirstlane_b32 s36, v23
    s_nop 0
    s_cmp_lt_u32 s36, 8
    s_cbranch_scc1 L_recurrent_scan__compressed_kv_cla__moe_arch_mod__prompt_kernel_spin_205
L_recurrent_scan__compressed_kv_cla__moe_arch_mod__prompt_kernel_spinx_206:
    s_branch L_recurrent_scan__compressed_kv_cla__moe_arch_mod__prompt_kernel_back_208
L_recurrent_scan__compressed_kv_cla__moe_arch_mod__prompt_kernel_rare_209:
    v_lshlrev_b32 v96, 16, v40
    v_and_b32 v97, 0xffff0000, v40
    v_sub_f32 v112, v96, v48
    v_sub_f32 v113, v97, v48
    v_cvt_pk_bf16_f32 v10, v112, v113
    v_lshlrev_b32 v112, 16, v10
    v_and_b32 v113, 0xffff0000, v10
    v_mul_f32 v112, v112, v49
    v_mul_f32 v113, v113, v49
    v_cvt_pk_bf16_f32 v10, v112, v113
    v_lshlrev_b32 v112, 16, v10
    v_and_b32 v113, 0xffff0000, v10
    v_add_f32 v112, v112, v24
    v_add_f32 v113, v113, v25
    v_cvt_pk_bf16_f32 v10, v112, v113
    v_lshlrev_b32 v112, 16, v10
    v_and_b32 v113, 0xffff0000, v10
    v_mul_f32 v11, 0xbfb8aa3b, v112
    v_mul_f32 v12, 0xbfb8aa3b, v113
    v_exp_f32 v11, v11
    v_exp_f32 v12, v12
    s_nop 0
    v_add_f32 v11, 1.0, v11
    v_add_f32 v12, 1.0, v12
    v_rcp_f32 v11, v11
    v_rcp_f32 v12, v12
    s_nop 0
    v_mul_f32 v112, v112, v11
    v_mul_f32 v113, v113, v12
    v_cvt_pk_bf16_f32 v10, v112, v113
    v_lshlrev_b32 v112, 16, v10
    v_and_b32 v113, 0xffff0000, v10
    v_lshlrev_b32 v98, 16, v41
    v_and_b32 v99, 0xffff0000, v41
    v_sub_f32 v114, v98, v48
    v_sub_f32 v115, v99, v48
    v_cvt_pk_bf16_f32 v10, v114, v115
    v_lshlrev_b32 v114, 16, v10
    v_and_b32 v115, 0xffff0000, v10
    v_mul_f32 v114, v114, v49
    v_mul_f32 v115, v115, v49
    v_cvt_pk_bf16_f32 v10, v114, v115
    v_lshlrev_b32 v114, 16, v10
    v_and_b32 v115, 0xffff0000, v10
    v_add_f32 v114, v114, v26
    v_add_f32 v115, v115, v27
    v_cvt_pk_bf16_f32 v10, v114, v115
    v_lshlrev_b32 v114, 16, v10
    v_and_b32 v115, 0xffff0000, v10
    v_mul_f32 v11, 0xbfb8aa3b, v114
    v_mul_f32 v12, 0xbfb8aa3b, v115
    v_exp_f32 v11, v11
    v_exp_f32 v12, v12
    s_nop 0
    v_add_f32 v11, 1.0, v11
    v_add_f32 v12, 1.0, v12
    v_rcp_f32 v11, v11
    v_rcp_f32 v12, v12
    s_nop 0
    v_mul_f32 v114, v114, v11
    v_mul_f32 v115, v115, v12
    v_cvt_pk_bf16_f32 v10, v114, v115
    v_lshlrev_b32 v114, 16, v10
    v_and_b32 v115, 0xffff0000, v10
    v_lshlrev_b32 v100, 16, v42
    v_and_b32 v101, 0xffff0000, v42
    v_sub_f32 v116, v100, v48
    v_sub_f32 v117, v101, v48
    v_cvt_pk_bf16_f32 v10, v116, v117
    v_lshlrev_b32 v116, 16, v10
    v_and_b32 v117, 0xffff0000, v10
    v_mul_f32 v116, v116, v49
    v_mul_f32 v117, v117, v49
    v_cvt_pk_bf16_f32 v10, v116, v117
    v_lshlrev_b32 v116, 16, v10
    v_and_b32 v117, 0xffff0000, v10
    v_add_f32 v116, v116, v28
    v_add_f32 v117, v117, v29
    v_cvt_pk_bf16_f32 v10, v116, v117
    v_lshlrev_b32 v116, 16, v10
    v_and_b32 v117, 0xffff0000, v10
    v_mul_f32 v11, 0xbfb8aa3b, v116
    v_mul_f32 v12, 0xbfb8aa3b, v117
    v_exp_f32 v11, v11
    v_exp_f32 v12, v12
    s_nop 0
    v_add_f32 v11, 1.0, v11
    v_add_f32 v12, 1.0, v12
    v_rcp_f32 v11, v11
    v_rcp_f32 v12, v12
    s_nop 0
    v_mul_f32 v116, v116, v11
    v_mul_f32 v117, v117, v12
    v_cvt_pk_bf16_f32 v10, v116, v117
    v_lshlrev_b32 v116, 16, v10
    v_and_b32 v117, 0xffff0000, v10
    v_lshlrev_b32 v102, 16, v43
    v_and_b32 v103, 0xffff0000, v43
    v_sub_f32 v118, v102, v48
    v_sub_f32 v119, v103, v48
    v_cvt_pk_bf16_f32 v10, v118, v119
    v_lshlrev_b32 v118, 16, v10
    v_and_b32 v119, 0xffff0000, v10
    v_mul_f32 v118, v118, v49
    v_mul_f32 v119, v119, v49
    v_cvt_pk_bf16_f32 v10, v118, v119
    v_lshlrev_b32 v118, 16, v10
    v_and_b32 v119, 0xffff0000, v10
    v_add_f32 v118, v118, v30
    v_add_f32 v119, v119, v31
    v_cvt_pk_bf16_f32 v10, v118, v119
    v_lshlrev_b32 v118, 16, v10
    v_and_b32 v119, 0xffff0000, v10
    v_mul_f32 v11, 0xbfb8aa3b, v118
    v_mul_f32 v12, 0xbfb8aa3b, v119
    v_exp_f32 v11, v11
    v_exp_f32 v12, v12
    s_nop 0
    v_add_f32 v11, 1.0, v11
    v_add_f32 v12, 1.0, v12
    v_rcp_f32 v11, v11
    v_rcp_f32 v12, v12
    s_nop 0
    v_mul_f32 v118, v118, v11
    v_mul_f32 v119, v119, v12
    v_cvt_pk_bf16_f32 v10, v118, v119
    v_lshlrev_b32 v118, 16, v10
    v_and_b32 v119, 0xffff0000, v10
    v_lshlrev_b32 v104, 16, v44
    v_and_b32 v105, 0xffff0000, v44
    v_sub_f32 v120, v104, v48
    v_sub_f32 v121, v105, v48
    v_cvt_pk_bf16_f32 v10, v120, v121
    v_lshlrev_b32 v120, 16, v10
    v_and_b32 v121, 0xffff0000, v10
    v_mul_f32 v120, v120, v49
    v_mul_f32 v121, v121, v49
    v_cvt_pk_bf16_f32 v10, v120, v121
    v_lshlrev_b32 v120, 16, v10
    v_and_b32 v121, 0xffff0000, v10
    v_add_f32 v120, v120, v32
    v_add_f32 v121, v121, v33
    v_cvt_pk_bf16_f32 v10, v120, v121
    v_lshlrev_b32 v120, 16, v10
    v_and_b32 v121, 0xffff0000, v10
    v_mul_f32 v11, 0xbfb8aa3b, v120
    v_mul_f32 v12, 0xbfb8aa3b, v121
    v_exp_f32 v11, v11
    v_exp_f32 v12, v12
    s_nop 0
    v_add_f32 v11, 1.0, v11
    v_add_f32 v12, 1.0, v12
    v_rcp_f32 v11, v11
    v_rcp_f32 v12, v12
    s_nop 0
    v_mul_f32 v120, v120, v11
    v_mul_f32 v121, v121, v12
    v_cvt_pk_bf16_f32 v10, v120, v121
    v_lshlrev_b32 v120, 16, v10
    v_and_b32 v121, 0xffff0000, v10
    v_lshlrev_b32 v106, 16, v45
    v_and_b32 v107, 0xffff0000, v45
    v_sub_f32 v122, v106, v48
    v_sub_f32 v123, v107, v48
    v_cvt_pk_bf16_f32 v10, v122, v123
    v_lshlrev_b32 v122, 16, v10
    v_and_b32 v123, 0xffff0000, v10
    v_mul_f32 v122, v122, v49
    v_mul_f32 v123, v123, v49
    v_cvt_pk_bf16_f32 v10, v122, v123
    v_lshlrev_b32 v122, 16, v10
    v_and_b32 v123, 0xffff0000, v10
    v_add_f32 v122, v122, v34
    v_add_f32 v123, v123, v35
    v_cvt_pk_bf16_f32 v10, v122, v123
    v_lshlrev_b32 v122, 16, v10
    v_and_b32 v123, 0xffff0000, v10
    v_mul_f32 v11, 0xbfb8aa3b, v122
    v_mul_f32 v12, 0xbfb8aa3b, v123
    v_exp_f32 v11, v11
    v_exp_f32 v12, v12
    s_nop 0
    v_add_f32 v11, 1.0, v11
    v_add_f32 v12, 1.0, v12
    v_rcp_f32 v11, v11
    v_rcp_f32 v12, v12
    s_nop 0
    v_mul_f32 v122, v122, v11
    v_mul_f32 v123, v123, v12
    v_cvt_pk_bf16_f32 v10, v122, v123
    v_lshlrev_b32 v122, 16, v10
    v_and_b32 v123, 0xffff0000, v10
    v_lshlrev_b32 v108, 16, v46
    v_and_b32 v109, 0xffff0000, v46
    v_sub_f32 v124, v108, v48
    v_sub_f32 v125, v109, v48
    v_cvt_pk_bf16_f32 v10, v124, v125
    v_lshlrev_b32 v124, 16, v10
    v_and_b32 v125, 0xffff0000, v10
    v_mul_f32 v124, v124, v49
    v_mul_f32 v125, v125, v49
    v_cvt_pk_bf16_f32 v10, v124, v125
    v_lshlrev_b32 v124, 16, v10
    v_and_b32 v125, 0xffff0000, v10
    v_add_f32 v124, v124, v36
    v_add_f32 v125, v125, v37
    v_cvt_pk_bf16_f32 v10, v124, v125
    v_lshlrev_b32 v124, 16, v10
    v_and_b32 v125, 0xffff0000, v10
    v_mul_f32 v11, 0xbfb8aa3b, v124
    v_mul_f32 v12, 0xbfb8aa3b, v125
    v_exp_f32 v11, v11
    v_exp_f32 v12, v12
    s_nop 0
    v_add_f32 v11, 1.0, v11
    v_add_f32 v12, 1.0, v12
    v_rcp_f32 v11, v11
    v_rcp_f32 v12, v12
    s_nop 0
    v_mul_f32 v124, v124, v11
    v_mul_f32 v125, v125, v12
    v_cvt_pk_bf16_f32 v10, v124, v125
    v_lshlrev_b32 v124, 16, v10
    v_and_b32 v125, 0xffff0000, v10
    v_lshlrev_b32 v110, 16, v47
    v_and_b32 v111, 0xffff0000, v47
    v_sub_f32 v126, v110, v48
    v_sub_f32 v127, v111, v48
    v_cvt_pk_bf16_f32 v10, v126, v127
    v_lshlrev_b32 v126, 16, v10
    v_and_b32 v127, 0xffff0000, v10
    v_mul_f32 v126, v126, v49
    v_mul_f32 v127, v127, v49
    v_cvt_pk_bf16_f32 v10, v126, v127
    v_lshlrev_b32 v126, 16, v10
    v_and_b32 v127, 0xffff0000, v10
    v_add_f32 v126, v126, v38
    v_add_f32 v127, v127, v39
    v_cvt_pk_bf16_f32 v10, v126, v127
    v_lshlrev_b32 v126, 16, v10
    v_and_b32 v127, 0xffff0000, v10
    v_mul_f32 v11, 0xbfb8aa3b, v126
    v_mul_f32 v12, 0xbfb8aa3b, v127
    v_exp_f32 v11, v11
    v_exp_f32 v12, v12
    s_nop 0
    v_add_f32 v11, 1.0, v11
    v_add_f32 v12, 1.0, v12
    v_rcp_f32 v11, v11
    v_rcp_f32 v12, v12
    s_nop 0
    v_mul_f32 v126, v126, v11
    v_mul_f32 v127, v127, v12
    v_cvt_pk_bf16_f32 v10, v126, v127
    v_lshlrev_b32 v126, 16, v10
    v_and_b32 v127, 0xffff0000, v10
    s_branch L_recurrent_scan__compressed_kv_cla__moe_arch_mod__prompt_kernel_back_210
L_end:
    s_endpgm
.section .rodata,"a"
.p2align 6
.amdhsa_kernel recurrent_scan__compressed_kv_cla__moe_arch_mod__prompt_kernel
  .amdhsa_next_free_vgpr 256
  .amdhsa_next_free_sgpr 102
  .amdhsa_accum_offset 256
  .amdhsa_group_segment_fixed_size 0
  .amdhsa_kernarg_size 112
  .amdhsa_user_sgpr_count 2
  .amdhsa_user_sgpr_kernarg_segment_ptr 1
  .amdhsa_system_sgpr_workgroup_id_x 1
.end_amdhsa_kernel
```

```asm
; @launch kernel=recurrent_scan__compressed_kv_cla__moe_arch_mod__prompt_kernel grid=(256,1,1) block=(512,1,1) lds=163840
.amdgcn_target "amdgcn-amd-amdhsa--gfx950"
.text
.globl recurrent_scan__compressed_kv_cla__moe_arch_mod__prompt_kernel
.p2align 8
.type recurrent_scan__compressed_kv_cla__moe_arch_mod__prompt_kernel,@function
recurrent_scan__compressed_kv_cla__moe_arch_mod__prompt_kernel:
    s_cmp_ge_u32 s2, 256
    s_cbranch_scc1 L_end
    s_load_dwordx4 s[44:47], s[0:1], 0
    s_load_dwordx2 s[52:53], s[0:1], 56
    s_load_dwordx4 s[48:51], s[0:1], 24
    s_getpc_b64 s[36:37]
L_pc:
    s_lshr_b32 s38, s2, 3
    s_lshl_b32 s38, s38, 7
    v_lshl_add_u32 v16, v0, 12, s38
    v_cmp_gt_u32 vcc, L_end-L_pc-4, v16
    v_mov_b32 v17, s37
    s_and_b64 exec, exec, vcc
    s_cbranch_execz L_nocpf
    v_add_co_u32 v16, vcc, s36, v16
    s_nop 1
    v_addc_co_u32 v17, vcc, 0, v17, vcc
    global_load_dword v119, v[16:17], off
L_nocpf:
    s_mov_b64 exec, -1
    v_lshrrev_b32 v16, 6, v0
    v_and_b32 v1, 63, v0
    v_readfirstlane_b32 s28, v16
    v_lshlrev_b32 v116, 4, v1
    s_lshl_b32 s42, s2, 3
    s_cmp_lt_u32 s28, 4
    s_cbranch_scc1 L_nox
    s_add_u32 s43, s42, s28
    s_sub_u32 s42, s43, 4
    v_lshl_add_u32 v18, s42, 11, v116
    v_add_u32 v19, 8192, v18
    s_waitcnt lgkmcnt(0)
    global_load_dwordx4 v[20:23], v18, s[44:45]
    global_load_dwordx4 v[24:27], v18, s[44:45] offset:1024
    global_load_dwordx4 v[28:31], v19, s[44:45]
    global_load_dwordx4 v[32:35], v19, s[44:45] offset:1024
    global_load_dwordx4 v[36:39], v116, s[52:53]
    global_load_dwordx4 v[40:43], v116, s[52:53] offset:1024
    s_barrier
L_nox:
    s_load_dwordx4 s[88:91], s[0:1], 96
    s_load_dwordx4 s[92:95], s[0:1], 64
    s_load_dwordx2 s[96:97], s[0:1], 16
    s_and_b32 s29, s2, 7
    s_lshl_b32 s29, s29, 2
    s_lshr_b32 s29, 0x75643120, s29
    s_and_b32 s29, s29, 7
    s_lshl_b32 s29, s29, 2
    s_bfe_u32 s36, s2, 0x20003
    s_add_u32 s29, s29, s36
    s_lshr_b32 s30, s2, 5
    v_lshrrev_b32 v16, 3, v1
    s_lshl_b32 s36, s30, 8
    s_lshl_b32 s37, s28, 5
    s_add_u32 s36, s36, s37
    v_add_u32 v16, s36, v16
    v_lshlrev_b32 v16, 10, v16
    v_lshrrev_b32 v18, 4, v1
    v_and_b32 v19, 7, v1
    v_xor_b32 v19, v19, v18
    v_lshl_add_u32 v2, v19, 4, v16
    v_xor_b32 v19, 4, v19
    v_lshl_add_u32 v3, v19, 4, v16
    v_add_u32 v3, 7168, v3
    v_add_u32 v4, 14336, v2
    v_add_u32 v5, 14336, v3
    s_and_b32 s36, s28, 3
    s_lshl_b32 s37, s36, 4
    v_add_u32 v16, s37, v18
    v_lshlrev_b32 v16, 13, v16
    s_lshl_b32 s37, s29, 8
    v_add_u32 v16, s37, v16
    v_and_b32 v19, 15, v1
    v_lshlrev_b32 v18, 1, v18
    v_xor_b32 v19, v19, v18
    v_lshl_add_u32 v6, v19, 4, v16
    v_add_u32 v7, 31744, v6
    v_xor_b32 v19, 8, v19
    v_lshl_add_u32 v8, v19, 4, v16
    v_add_u32 v8, 63488, v8
    v_add_u32 v9, 31744, v8
    s_lshl_b32 s33, s28, 12
    s_add_u32 s34, s33, 65536
    s_mov_b32 s31, 0
    s_mov_b32 s32, 0
    s_mov_b32 s40, 128
    s_mov_b32 s41, 524288
    s_waitcnt lgkmcnt(0)
    s_mov_b32 s4, s46
    s_and_b32 s5, s47, 0xffff
    s_mov_b32 s6, 2097152
    s_mov_b32 s7, 0x20000
    s_mov_b32 s8, s48
    s_and_b32 s9, s49, 0xffff
    s_mov_b32 s10, 4194304
    s_mov_b32 s11, 0x20000
    s_mov_b32 s20, s50
    s_and_b32 s21, s51, 0xffff
    s_mov_b32 s22, 4194304
    s_mov_b32 s23, 0x20000
    s_cmp_lt_u32 s28, 4
    s_cbranch_scc0 L_pro_s
    s_barrier
    s_cmp_eq_u32 s2, 0
    s_cbranch_scc1 L_recurrent_scan__compressed_kv_cla__moe_arch_mod__prompt_kernel_rare_1
L_recurrent_scan__compressed_kv_cla__moe_arch_mod__prompt_kernel_back_2:
    s_add_u32 m0, s33, 0
    s_add_u32 s36, s31, 131072
    buffer_load_dwordx4 v2, s[4:7], s31 offen offset:0 lds
    buffer_load_dwordx4 v3, s[4:7], s31 offen offset:1024 lds
    buffer_load_dwordx4 v4, s[4:7], s31 offen offset:2048 lds
    buffer_load_dwordx4 v5, s[4:7], s31 offen offset:3072 lds
    s_add_u32 m0, s34, 0
    s_nop 0
    buffer_load_dwordx4 v6, s[8:11], s32 offen offset:0 nt lds
    buffer_load_dwordx4 v7, s[8:11], s32 offen offset:1024 nt lds
    buffer_load_dwordx4 v8, s[8:11], s32 offen offset:2048 nt lds
    buffer_load_dwordx4 v9, s[8:11], s32 offen offset:3072 nt lds
    s_add_u32 m0, s33, 16384
    s_nop 0
    buffer_load_dwordx4 v2, s[4:7], s36 offen offset:0 lds
    buffer_load_dwordx4 v3, s[4:7], s36 offen offset:1024 lds
    buffer_load_dwordx4 v4, s[4:7], s36 offen offset:2048 lds
    buffer_load_dwordx4 v5, s[4:7], s36 offen offset:3072 lds
    s_add_u32 m0, s34, 16384
    s_nop 0
    buffer_load_dwordx4 v6, s[20:23], s32 offen offset:0 nt lds
    buffer_load_dwordx4 v7, s[20:23], s32 offen offset:1024 nt lds
    buffer_load_dwordx4 v8, s[20:23], s32 offen offset:2048 nt lds
    buffer_load_dwordx4 v9, s[20:23], s32 offen offset:3072 nt lds
    s_add_u32 s31, s31, s40
    s_add_u32 s32, s32, s41
L_pro_s:
    s_add_u32 s54, s90, 0
    s_addc_u32 s55, s91, 0
    s_add_u32 s12, s54, 8388608
    s_addc_u32 s13, s55, 0
    s_and_b32 s13, s13, 0xffff
    s_mov_b32 s14, 134217856
    s_mov_b32 s15, 0x20000
    s_mov_b32 s24, s54
    s_and_b32 s25, s55, 0xffff
    s_mov_b32 s26, 184549504
    s_mov_b32 s27, 0x20000
    s_add_u32 s90, s54, 61865984
    s_addc_u32 s91, s55, 0
    v_and_b32 v16, 15, v1
    v_lshrrev_b32 v17, 4, v1
    s_bfe_u32 s36, s28, 0x10001
    s_lshl_b32 s36, s36, 14
    v_lshl_add_u32 v18, v16, 7, s36
    v_lshrrev_b32 v19, 1, v16
    v_xor_b32 v19, v19, v17
    v_lshl_add_u32 v10, v19, 4, v18
    v_xor_b32 v19, 4, v19
    v_lshl_add_u32 v11, v19, 4, v18
    v_lshrrev_b32 v16, 2, v16
    v_lshl_add_u32 v18, v17, 3, v16
    v_lshlrev_b32 v18, 8, v18
    s_lshr_b32 s36, s28, 2
    s_lshl_b32 s36, s36, 14
    s_add_u32 s36, s36, 65536
    v_add_u32 v18, s36, v18
    v_and_b32 v19, 3, v1
    v_lshl_add_u32 v18, v19, 3, v18
    v_and_b32 v17, 1, v17
    v_lshl_add_u32 v16, v17, 2, v16
    s_and_b32 s36, s28, 1
    s_lshl_b32 s36, s36, 2
    s_add_u32 s37, s36, 0
    v_xor_b32 v19, s37, v16
    v_lshl_add_u32 v12, v19, 5, v18
    s_add_u32 s37, s36, 1
    v_xor_b32 v19, s37, v16
    v_lshl_add_u32 v13, v19, 5, v18
    s_add_u32 s37, s36, 2
    v_xor_b32 v19, s37, v16
    v_lshl_add_u32 v14, v19, 5, v18
    s_add_u32 s37, s36, 3
    v_xor_b32 v19, s37, v16
    v_lshl_add_u32 v15, v19, 5, v18
    v_mov_b64 v[128:129], 0
    v_mov_b64 v[130:131], 0
    v_mov_b64 v[132:133], 0
    v_mov_b64 v[134:135], 0
    v_mov_b64 v[136:137], 0
    v_mov_b64 v[138:139], 0
    v_mov_b64 v[140:141], 0
    v_mov_b64 v[142:143], 0
    v_mov_b64 v[144:145], 0
    v_mov_b64 v[146:147], 0
    v_mov_b64 v[148:149], 0
    v_mov_b64 v[150:151], 0
    v_mov_b64 v[152:153], 0
    v_mov_b64 v[154:155], 0
    v_mov_b64 v[156:157], 0
    v_mov_b64 v[158:159], 0
    v_mov_b64 v[160:161], 0
    v_mov_b64 v[162:163], 0
    v_mov_b64 v[164:165], 0
    v_mov_b64 v[166:167], 0
    v_mov_b64 v[168:169], 0
    v_mov_b64 v[170:171], 0
    v_mov_b64 v[172:173], 0
    v_mov_b64 v[174:175], 0
    v_mov_b64 v[176:177], 0
    v_mov_b64 v[178:179], 0
    v_mov_b64 v[180:181], 0
    v_mov_b64 v[182:183], 0
    v_mov_b64 v[184:185], 0
    v_mov_b64 v[186:187], 0
    v_mov_b64 v[188:189], 0
    v_mov_b64 v[190:191], 0
    v_mov_b64 v[192:193], 0
    v_mov_b64 v[194:195], 0
    v_mov_b64 v[196:197], 0
    v_mov_b64 v[198:199], 0
    v_mov_b64 v[200:201], 0
    v_mov_b64 v[202:203], 0
    v_mov_b64 v[204:205], 0
    v_mov_b64 v[206:207], 0
    v_mov_b64 v[208:209], 0
    v_mov_b64 v[210:211], 0
    v_mov_b64 v[212:213], 0
    v_mov_b64 v[214:215], 0
    v_mov_b64 v[216:217], 0
    v_mov_b64 v[218:219], 0
    v_mov_b64 v[220:221], 0
    v_mov_b64 v[222:223], 0
    v_mov_b64 v[224:225], 0
    v_mov_b64 v[226:227], 0
    v_mov_b64 v[228:229], 0
    v_mov_b64 v[230:231], 0
    v_mov_b64 v[232:233], 0
    v_mov_b64 v[234:235], 0
    v_mov_b64 v[236:237], 0
    v_mov_b64 v[238:239], 0
    v_mov_b64 v[240:241], 0
    v_mov_b64 v[242:243], 0
    v_mov_b64 v[244:245], 0
    v_mov_b64 v[246:247], 0
    v_mov_b64 v[248:249], 0
    v_mov_b64 v[250:251], 0
    v_mov_b64 v[252:253], 0
    v_mov_b64 v[254:255], 0
    v_mov_b32 v118, 0
    v_mov_b32 v117, 0
    s_lshr_b32 s36, s2, 3
    s_lshl_b32 s36, s36, 5
    s_lshl_b32 s37, s28, 2
    s_add_u32 s36, s36, s37
    s_lshl_b32 s36, s36, 13
    s_and_b32 s37, s29, 28
    s_lshl_b32 s37, s37, 8
    s_add_u32 s36, s36, s37
    s_add_u32 s16, s96, s36
    s_addc_u32 s17, s97, 0
    s_and_b32 s17, s17, 0xffff
    s_mov_b32 s18, 25600
    s_mov_b32 s19, 0x20000
    v_cmp_gt_u32 vcc, 8, v1
    v_lshlrev_b32 v17, 7, v1
    v_mov_b32 v19, 0x100000
    v_cndmask_b32 v17, v19, v17, vcc
    s_mov_b32 s45, 0
    s_cmp_lt_u32 s28, 4
    s_cbranch_scc0 L_pro_b
    s_add_u32 m0, s33, 32768
    s_add_u32 s36, s31, 131072
    buffer_load_dwordx4 v2, s[4:7], s31 offen offset:0 lds
    buffer_load_dwordx4 v3, s[4:7], s31 offen offset:1024 lds
    buffer_load_dwordx4 v4, s[4:7], s31 offen offset:2048 lds
    buffer_load_dwordx4 v5, s[4:7], s31 offen offset:3072 lds
    s_add_u32 m0, s34, 32768
    s_nop 0
    buffer_load_dwordx4 v6, s[8:11], s32 offen offset:0 nt lds
    buffer_load_dwordx4 v7, s[8:11], s32 offen offset:1024 nt lds
    buffer_load_dwordx4 v8, s[8:11], s32 offen offset:2048 nt lds
    buffer_load_dwordx4 v9, s[8:11], s32 offen offset:3072 nt lds
    s_add_u32 m0, s33, 49152
    s_nop 0
    buffer_load_dwordx4 v2, s[4:7], s36 offen offset:0 lds
    buffer_load_dwordx4 v3, s[4:7], s36 offen offset:1024 lds
    buffer_load_dwordx4 v4, s[4:7], s36 offen offset:2048 lds
    buffer_load_dwordx4 v5, s[4:7], s36 offen offset:3072 lds
    s_add_u32 m0, s34, 49152
    s_nop 0
    buffer_load_dwordx4 v6, s[20:23], s32 offen offset:0 nt lds
    buffer_load_dwordx4 v7, s[20:23], s32 offen offset:1024 nt lds
    buffer_load_dwordx4 v8, s[20:23], s32 offen offset:2048 nt lds
    buffer_load_dwordx4 v9, s[20:23], s32 offen offset:3072 nt lds
    s_add_u32 s31, s31, s40
    s_add_u32 s32, s32, s41
    s_waitcnt vmcnt(16)
    s_branch L_pro_j
L_pro_b:
    s_mov_b64 s[8:9], s[20:21]
    s_mov_b32 s31, 256
    s_mov_b32 s32, 1048576
    s_and_b32 s60, s28, 3
    s_waitcnt vmcnt(0)
    s_mov_b32 s3, 0
L_ln:
    v_lshlrev_b32 v44, 16, v36
    v_and_b32 v45, 0xffff0000, v36
    v_lshlrev_b32 v46, 16, v37
    v_and_b32 v47, 0xffff0000, v37
    v_lshlrev_b32 v48, 16, v38
    v_and_b32 v49, 0xffff0000, v38
    v_lshlrev_b32 v50, 16, v39
    v_and_b32 v51, 0xffff0000, v39
    v_lshlrev_b32 v52, 16, v40
    v_and_b32 v53, 0xffff0000, v40
    v_lshlrev_b32 v54, 16, v41
    v_and_b32 v55, 0xffff0000, v41
    v_lshlrev_b32 v56, 16, v42
    v_and_b32 v57, 0xffff0000, v42
    v_lshlrev_b32 v58, 16, v43
    v_and_b32 v59, 0xffff0000, v43
    v_lshlrev_b32 v60, 16, v20
    v_lshlrev_b32 v76, 16, v28
    v_and_b32 v61, 0xffff0000, v20
    v_and_b32 v77, 0xffff0000, v28
    v_lshlrev_b32 v62, 16, v21
    v_lshlrev_b32 v78, 16, v29
    v_and_b32 v63, 0xffff0000, v21
    v_and_b32 v79, 0xffff0000, v29
    v_lshlrev_b32 v64, 16, v22
    v_lshlrev_b32 v80, 16, v30
    v_and_b32 v65, 0xffff0000, v22
    v_and_b32 v81, 0xffff0000, v30
    v_lshlrev_b32 v66, 16, v23
    v_lshlrev_b32 v82, 16, v31
    v_and_b32 v67, 0xffff0000, v23
    v_and_b32 v83, 0xffff0000, v31
    v_lshlrev_b32 v68, 16, v24
    v_lshlrev_b32 v84, 16, v32
    v_and_b32 v69, 0xffff0000, v24
    v_and_b32 v85, 0xffff0000, v32
    v_lshlrev_b32 v70, 16, v25
    v_lshlrev_b32 v86, 16, v33
    v_and_b32 v71, 0xffff0000, v25
    v_and_b32 v87, 0xffff0000, v33
    v_lshlrev_b32 v72, 16, v26
    v_lshlrev_b32 v88, 16, v34
    v_and_b32 v73, 0xffff0000, v26
    v_and_b32 v89, 0xffff0000, v34
    v_lshlrev_b32 v74, 16, v27
    v_lshlrev_b32 v90, 16, v35
    v_and_b32 v75, 0xffff0000, v27
    v_and_b32 v91, 0xffff0000, v35
    v_pk_add_f32 v[92:93], v[60:61], v[62:63]
    v_pk_add_f32 v[100:101], v[76:77], v[78:79]
    v_pk_add_f32 v[92:93], v[92:93], v[64:65]
    v_pk_add_f32 v[100:101], v[100:101], v[80:81]
    v_pk_add_f32 v[92:93], v[92:93], v[66:67]
    v_pk_add_f32 v[100:101], v[100:101], v[82:83]
    v_pk_add_f32 v[92:93], v[92:93], v[68:69]
    v_pk_add_f32 v[100:101], v[100:101], v[84:85]
    v_pk_add_f32 v[92:93], v[92:93], v[70:71]
    v_pk_add_f32 v[100:101], v[100:101], v[86:87]
    v_pk_add_f32 v[92:93], v[92:93], v[72:73]
    v_pk_add_f32 v[100:101], v[100:101], v[88:89]
    v_pk_add_f32 v[92:93], v[92:93], v[74:75]
    v_pk_add_f32 v[100:101], v[100:101], v[90:91]
    v_add_f32 v92, v92, v93
    v_add_f32 v100, v100, v101
    s_nop 0
    v_add_f32_dpp v92, v92, v92 quad_perm:[1,0,3,2] row_mask:0xf bank_mask:0xf
    v_add_f32_dpp v100, v100, v100 quad_perm:[1,0,3,2] row_mask:0xf bank_mask:0xf
    s_nop 0
    v_add_f32_dpp v92, v92, v92 quad_perm:[2,3,0,1] row_mask:0xf bank_mask:0xf
    v_add_f32_dpp v100, v100, v100 quad_perm:[2,3,0,1] row_mask:0xf bank_mask:0xf
    s_nop 0
    v_add_f32_dpp v92, v92, v92 row_half_mirror row_mask:0xf bank_mask:0xf
    v_add_f32_dpp v100, v100, v100 row_half_mirror row_mask:0xf bank_mask:0xf
    s_nop 0
    v_add_f32_dpp v92, v92, v92 row_mirror row_mask:0xf bank_mask:0xf
    v_add_f32_dpp v100, v100, v100 row_mirror row_mask:0xf bank_mask:0xf
    v_readlane_b32 s36, v92, 0
    v_readlane_b32 s56, v100, 0
    v_readlane_b32 s37, v92, 16
    v_readlane_b32 s57, v100, 16
    v_readlane_b32 s38, v92, 32
    v_readlane_b32 s58, v100, 32
    v_readlane_b32 s39, v92, 48
    v_readlane_b32 s59, v100, 48
    v_mov_b32 v96, s36
    v_mov_b32 v104, s56
    v_add_f32 v96, s37, v96
    v_add_f32 v104, s57, v104
    v_add_f32 v96, s38, v96
    v_add_f32 v104, s58, v104
    v_add_f32 v96, s39, v96
    v_add_f32 v104, s59, v104
    v_mul_f32 v96, 0xba800000, v96
    v_mul_f32 v104, 0xba800000, v104
    v_mov_b32 v97, v96
    v_mov_b32 v105, v104
    v_pk_add_f32 v[94:95], v[60:61], v[96:97]
    v_pk_add_f32 v[102:103], v[76:77], v[104:105]
    v_pk_mul_f32 v[92:93], v[94:95], v[94:95]
    v_pk_mul_f32 v[100:101], v[102:103], v[102:103]
    v_pk_add_f32 v[94:95], v[62:63], v[96:97]
    v_pk_add_f32 v[102:103], v[78:79], v[104:105]
    v_pk_fma_f32 v[92:93], v[94:95], v[94:95], v[92:93]
    v_pk_fma_f32 v[100:101], v[102:103], v[102:103], v[100:101]
    v_pk_add_f32 v[94:95], v[64:65], v[96:97]
    v_pk_add_f32 v[102:103], v[80:81], v[104:105]
    v_pk_fma_f32 v[92:93], v[94:95], v[94:95], v[92:93]
    v_pk_fma_f32 v[100:101], v[102:103], v[102:103], v[100:101]
    v_pk_add_f32 v[94:95], v[66:67], v[96:97]
    v_pk_add_f32 v[102:103], v[82:83], v[104:105]
    v_pk_fma_f32 v[92:93], v[94:95], v[94:95], v[92:93]
    v_pk_fma_f32 v[100:101], v[102:103], v[102:103], v[100:101]
    v_pk_add_f32 v[94:95], v[68:69], v[96:97]
    v_pk_add_f32 v[102:103], v[84:85], v[104:105]
    v_pk_fma_f32 v[92:93], v[94:95], v[94:95], v[92:93]
    v_pk_fma_f32 v[100:101], v[102:103], v[102:103], v[100:101]
    v_pk_add_f32 v[94:95], v[70:71], v[96:97]
    v_pk_add_f32 v[102:103], v[86:87], v[104:105]
    v_pk_fma_f32 v[92:93], v[94:95], v[94:95], v[92:93]
    v_pk_fma_f32 v[100:101], v[102:103], v[102:103], v[100:101]
    v_pk_add_f32 v[94:95], v[72:73], v[96:97]
    v_pk_add_f32 v[102:103], v[88:89], v[104:105]
    v_pk_fma_f32 v[92:93], v[94:95], v[94:95], v[92:93]
    v_pk_fma_f32 v[100:101], v[102:103], v[102:103], v[100:101]
    v_pk_add_f32 v[94:95], v[74:75], v[96:97]
    v_pk_add_f32 v[102:103], v[90:91], v[104:105]
    v_pk_fma_f32 v[92:93], v[94:95], v[94:95], v[92:93]
    v_pk_fma_f32 v[100:101], v[102:103], v[102:103], v[100:101]
    v_add_f32 v92, v92, v93
    v_add_f32 v100, v100, v101
    s_nop 0
    v_add_f32_dpp v92, v92, v92 quad_perm:[1,0,3,2] row_mask:0xf bank_mask:0xf
    v_add_f32_dpp v100, v100, v100 quad_perm:[1,0,3,2] row_mask:0xf bank_mask:0xf
    s_nop 0
    v_add_f32_dpp v92, v92, v92 quad_perm:[2,3,0,1] row_mask:0xf bank_mask:0xf
    v_add_f32_dpp v100, v100, v100 quad_perm:[2,3,0,1] row_mask:0xf bank_mask:0xf
    s_nop 0
    v_add_f32_dpp v92, v92, v92 row_half_mirror row_mask:0xf bank_mask:0xf
    v_add_f32_dpp v100, v100, v100 row_half_mirror row_mask:0xf bank_mask:0xf
    s_nop 0
    v_add_f32_dpp v92, v92, v92 row_mirror row_mask:0xf bank_mask:0xf
    v_add_f32_dpp v100, v100, v100 row_mirror row_mask:0xf bank_mask:0xf
    v_readlane_b32 s36, v92, 0
    v_readlane_b32 s56, v100, 0
    v_readlane_b32 s37, v92, 16
    v_readlane_b32 s57, v100, 16
    v_readlane_b32 s38, v92, 32
    v_readlane_b32 s58, v100, 32
    v_readlane_b32 s39, v92, 48
    v_readlane_b32 s59, v100, 48
    v_mov_b32 v94, s36
    v_mov_b32 v102, s56
    v_add_f32 v94, s37, v94
    v_add_f32 v102, s57, v102
    v_add_f32 v94, s38, v94
    v_add_f32 v102, s58, v102
    v_add_f32 v94, s39, v94
    v_add_f32 v102, s59, v102
    v_mul_f32 v94, 0x3a800000, v94
    v_mul_f32 v102, 0x3a800000, v102
    v_cvt_pk_bf16_f32 v95, v96, v94
    v_cvt_pk_bf16_f32 v103, v104, v102
    v_lshlrev_b32 v96, 16, v95
    v_lshlrev_b32 v104, 16, v103
    v_and_b32 v94, 0xffff0000, v95
    v_and_b32 v102, 0xffff0000, v103
    v_add_f32 v94, 0x3727c5ac, v94
    v_add_f32 v102, 0x3727c5ac, v102
    v_cvt_pk_bf16_f32 v94, v94, v94
    v_cvt_pk_bf16_f32 v102, v102, v102
    v_lshlrev_b32 v94, 16, v94
    v_lshlrev_b32 v102, 16, v102
    v_sqrt_f32 v94, v94
    v_sqrt_f32 v102, v102
    v_mov_b32 v97, v96
    v_mov_b32 v105, v104
    v_cvt_pk_bf16_f32 v94, v94, v94
    v_cvt_pk_bf16_f32 v102, v102, v102
    v_lshlrev_b32 v94, 16, v94
    v_lshlrev_b32 v102, 16, v102
    v_rcp_f32 v99, v94
    v_rcp_f32 v107, v102
    v_fma_f32 v95, -v94, v99, 1.0
    v_fma_f32 v103, -v102, v107, 1.0
    v_fma_f32 v99, v95, v99, v99
    v_fma_f32 v107, v103, v107, v107
    v_mov_b32 v98, v99
    v_mov_b32 v106, v107
    v_pk_add_f32 v[60:61], v[60:61], v[96:97]
    v_pk_add_f32 v[76:77], v[76:77], v[104:105]
    v_cvt_pk_bf16_f32 v94, v60, v61
    v_cvt_pk_bf16_f32 v102, v76, v77
    v_lshlrev_b32 v60, 16, v94
    v_lshlrev_b32 v76, 16, v102
    v_and_b32 v61, 0xffff0000, v94
    v_and_b32 v77, 0xffff0000, v102
    v_pk_mul_f32 v[60:61], v[60:61], v[98:99]
    v_pk_mul_f32 v[76:77], v[76:77], v[106:107]
    v_cvt_pk_bf16_f32 v108, v60, v61
    v_cvt_pk_bf16_f32 v120, v76, v77
    v_lshlrev_b32 v60, 16, v108
    v_lshlrev_b32 v76, 16, v120
    v_and_b32 v61, 0xffff0000, v108
    v_and_b32 v77, 0xffff0000, v120
    v_pk_mul_f32 v[92:93], v[60:61], v[44:45]
    v_pk_mul_f32 v[100:101], v[76:77], v[44:45]
    v_pk_add_f32 v[62:63], v[62:63], v[96:97]
    v_pk_add_f32 v[78:79], v[78:79], v[104:105]
    v_cvt_pk_bf16_f32 v94, v62, v63
    v_cvt_pk_bf16_f32 v102, v78, v79
    v_lshlrev_b32 v62, 16, v94
    v_lshlrev_b32 v78, 16, v102
    v_and_b32 v63, 0xffff0000, v94
    v_and_b32 v79, 0xffff0000, v102
    v_pk_mul_f32 v[62:63], v[62:63], v[98:99]
    v_pk_mul_f32 v[78:79], v[78:79], v[106:107]
    v_cvt_pk_bf16_f32 v109, v62, v63
    v_cvt_pk_bf16_f32 v121, v78, v79
    v_lshlrev_b32 v62, 16, v109
    v_lshlrev_b32 v78, 16, v121
    v_and_b32 v63, 0xffff0000, v109
    v_and_b32 v79, 0xffff0000, v121
    v_pk_fma_f32 v[92:93], v[62:63], v[46:47], v[92:93]
    v_pk_fma_f32 v[100:101], v[78:79], v[46:47], v[100:101]
    v_pk_add_f32 v[64:65], v[64:65], v[96:97]
    v_pk_add_f32 v[80:81], v[80:81], v[104:105]
    v_cvt_pk_bf16_f32 v94, v64, v65
    v_cvt_pk_bf16_f32 v102, v80, v81
    v_lshlrev_b32 v64, 16, v94
    v_lshlrev_b32 v80, 16, v102
    v_and_b32 v65, 0xffff0000, v94
    v_and_b32 v81, 0xffff0000, v102
    v_pk_mul_f32 v[64:65], v[64:65], v[98:99]
    v_pk_mul_f32 v[80:81], v[80:81], v[106:107]
    v_cvt_pk_bf16_f32 v110, v64, v65
    v_cvt_pk_bf16_f32 v122, v80, v81
    v_lshlrev_b32 v64, 16, v110
    v_lshlrev_b32 v80, 16, v122
    v_and_b32 v65, 0xffff0000, v110
    v_and_b32 v81, 0xffff0000, v122
    v_pk_fma_f32 v[92:93], v[64:65], v[48:49], v[92:93]
    v_pk_fma_f32 v[100:101], v[80:81], v[48:49], v[100:101]
    v_pk_add_f32 v[66:67], v[66:67], v[96:97]
    v_pk_add_f32 v[82:83], v[82:83], v[104:105]
    v_cvt_pk_bf16_f32 v94, v66, v67
    v_cvt_pk_bf16_f32 v102, v82, v83
    v_lshlrev_b32 v66, 16, v94
    v_lshlrev_b32 v82, 16, v102
    v_and_b32 v67, 0xffff0000, v94
    v_and_b32 v83, 0xffff0000, v102
    v_pk_mul_f32 v[66:67], v[66:67], v[98:99]
    v_pk_mul_f32 v[82:83], v[82:83], v[106:107]
    v_cvt_pk_bf16_f32 v111, v66, v67
    v_cvt_pk_bf16_f32 v123, v82, v83
    v_lshlrev_b32 v66, 16, v111
    v_lshlrev_b32 v82, 16, v123
    v_and_b32 v67, 0xffff0000, v111
    v_and_b32 v83, 0xffff0000, v123
    v_pk_fma_f32 v[92:93], v[66:67], v[50:51], v[92:93]
    v_pk_fma_f32 v[100:101], v[82:83], v[50:51], v[100:101]
    v_pk_add_f32 v[68:69], v[68:69], v[96:97]
    v_pk_add_f32 v[84:85], v[84:85], v[104:105]
    v_cvt_pk_bf16_f32 v94, v68, v69
    v_cvt_pk_bf16_f32 v102, v84, v85
    v_lshlrev_b32 v68, 16, v94
    v_lshlrev_b32 v84, 16, v102
    v_and_b32 v69, 0xffff0000, v94
    v_and_b32 v85, 0xffff0000, v102
    v_pk_mul_f32 v[68:69], v[68:69], v[98:99]
    v_pk_mul_f32 v[84:85], v[84:85], v[106:107]
    v_cvt_pk_bf16_f32 v112, v68, v69
    v_cvt_pk_bf16_f32 v124, v84, v85
    v_lshlrev_b32 v68, 16, v112
    v_lshlrev_b32 v84, 16, v124
    v_and_b32 v69, 0xffff0000, v112
    v_and_b32 v85, 0xffff0000, v124
    v_pk_fma_f32 v[92:93], v[68:69], v[52:53], v[92:93]
    v_pk_fma_f32 v[100:101], v[84:85], v[52:53], v[100:101]
    v_pk_add_f32 v[70:71], v[70:71], v[96:97]
    v_pk_add_f32 v[86:87], v[86:87], v[104:105]
    v_cvt_pk_bf16_f32 v94, v70, v71
    v_cvt_pk_bf16_f32 v102, v86, v87
    v_lshlrev_b32 v70, 16, v94
    v_lshlrev_b32 v86, 16, v102
    v_and_b32 v71, 0xffff0000, v94
    v_and_b32 v87, 0xffff0000, v102
    v_pk_mul_f32 v[70:71], v[70:71], v[98:99]
    v_pk_mul_f32 v[86:87], v[86:87], v[106:107]
    v_cvt_pk_bf16_f32 v113, v70, v71
    v_cvt_pk_bf16_f32 v125, v86, v87
    v_lshlrev_b32 v70, 16, v113
    v_lshlrev_b32 v86, 16, v125
    v_and_b32 v71, 0xffff0000, v113
    v_and_b32 v87, 0xffff0000, v125
    v_pk_fma_f32 v[92:93], v[70:71], v[54:55], v[92:93]
    v_pk_fma_f32 v[100:101], v[86:87], v[54:55], v[100:101]
    v_pk_add_f32 v[72:73], v[72:73], v[96:97]
    v_pk_add_f32 v[88:89], v[88:89], v[104:105]
    v_cvt_pk_bf16_f32 v94, v72, v73
    v_cvt_pk_bf16_f32 v102, v88, v89
    v_lshlrev_b32 v72, 16, v94
    v_lshlrev_b32 v88, 16, v102
    v_and_b32 v73, 0xffff0000, v94
    v_and_b32 v89, 0xffff0000, v102
    v_pk_mul_f32 v[72:73], v[72:73], v[98:99]
    v_pk_mul_f32 v[88:89], v[88:89], v[106:107]
    v_cvt_pk_bf16_f32 v114, v72, v73
    v_cvt_pk_bf16_f32 v126, v88, v89
    v_lshlrev_b32 v72, 16, v114
    v_lshlrev_b32 v88, 16, v126
    v_and_b32 v73, 0xffff0000, v114
    v_and_b32 v89, 0xffff0000, v126
    v_pk_fma_f32 v[92:93], v[72:73], v[56:57], v[92:93]
    v_pk_fma_f32 v[100:101], v[88:89], v[56:57], v[100:101]
    v_pk_add_f32 v[74:75], v[74:75], v[96:97]
    v_pk_add_f32 v[90:91], v[90:91], v[104:105]
    v_cvt_pk_bf16_f32 v94, v74, v75
    v_cvt_pk_bf16_f32 v102, v90, v91
    v_lshlrev_b32 v74, 16, v94
    v_lshlrev_b32 v90, 16, v102
    v_and_b32 v75, 0xffff0000, v94
    v_and_b32 v91, 0xffff0000, v102
    v_pk_mul_f32 v[74:75], v[74:75], v[98:99]
    v_pk_mul_f32 v[90:91], v[90:91], v[106:107]
    v_cvt_pk_bf16_f32 v115, v74, v75
    v_cvt_pk_bf16_f32 v127, v90, v91
    v_lshlrev_b32 v74, 16, v115
    v_lshlrev_b32 v90, 16, v127
    v_and_b32 v75, 0xffff0000, v115
    v_and_b32 v91, 0xffff0000, v127
    v_pk_fma_f32 v[92:93], v[74:75], v[58:59], v[92:93]
    v_pk_fma_f32 v[100:101], v[90:91], v[58:59], v[100:101]
    v_add_f32 v92, v92, v93
    v_add_f32 v100, v100, v101
    v_xor_b32 v98, 0x80000000, v96
    v_xor_b32 v106, 0x80000000, v104
    s_mul_i32 s36, s60, 2064
    s_mul_i32 s56, s28, 2064
    s_add_u32 s36, s36, 131072
    s_add_u32 s56, s56, 131072
    v_lshl_add_u32 v95, v1, 4, s36
    v_lshl_add_u32 v103, v1, 4, s56
    ds_write_b128 v95, v[108:111]
    ds_write_b128 v103, v[120:123]
    ds_write_b128 v95, v[112:115] offset:1024
    ds_write_b128 v103, v[124:127] offset:1024
    s_nop 0
    v_add_f32_dpp v92, v92, v92 quad_perm:[1,0,3,2] row_mask:0xf bank_mask:0xf
    v_add_f32_dpp v100, v100, v100 quad_perm:[1,0,3,2] row_mask:0xf bank_mask:0xf
    s_nop 0
    v_add_f32_dpp v92, v92, v92 quad_perm:[2,3,0,1] row_mask:0xf bank_mask:0xf
    v_add_f32_dpp v100, v100, v100 quad_perm:[2,3,0,1] row_mask:0xf bank_mask:0xf
    s_nop 0
    v_add_f32_dpp v92, v92, v92 row_half_mirror row_mask:0xf bank_mask:0xf
    v_add_f32_dpp v100, v100, v100 row_half_mirror row_mask:0xf bank_mask:0xf
    s_nop 0
    v_add_f32_dpp v92, v92, v92 row_mirror row_mask:0xf bank_mask:0xf
    v_add_f32_dpp v100, v100, v100 row_mirror row_mask:0xf bank_mask:0xf
    v_readlane_b32 s36, v92, 0
    v_readlane_b32 s56, v100, 0
    v_readlane_b32 s37, v92, 16
    v_readlane_b32 s57, v100, 16
    v_readlane_b32 s38, v92, 32
    v_readlane_b32 s58, v100, 32
    v_readlane_b32 s39, v92, 48
    v_readlane_b32 s59, v100, 48
    v_mov_b32 v93, s36
    v_mov_b32 v101, s56
    v_add_f32 v93, s37, v93
    v_add_f32 v101, s57, v101
    v_add_f32 v93, s38, v93
    v_add_f32 v101, s58, v101
    v_add_f32 v93, s39, v93
    v_add_f32 v101, s59, v101
    v_cvt_pk_bf16_f32 v93, v93, v93
    v_cvt_pk_bf16_f32 v101, v101, v101
    v_lshlrev_b32 v93, 16, v93
    v_lshlrev_b32 v101, 16, v101
    v_ashrrev_i32 v95, 31, v93
    v_ashrrev_i32 v103, 31, v101
    v_or_b32 v95, 0x80000000, v95
    v_or_b32 v103, 0x80000000, v103
    v_xor_b32 v95, v93, v95
    v_xor_b32 v103, v101, v103
    v_and_b32 v95, 0xffff0000, v95
    v_and_b32 v103, 0xffff0000, v103
    s_sub_u32 s36, 0xffff, s42
    s_sub_u32 s56, 0xffff, s43
    v_or_b32 v95, s36, v95
    v_or_b32 v103, s56, v103
    s_lshl_b32 s37, s60, 3
    s_lshl_b32 s57, s28, 3
    s_add_u32 s37, s37, 147712
    s_add_u32 s57, s57, 147712
    v_mov_b32 v94, s37
    v_mov_b32 v102, s57
    ds_write_b64 v94, v[98:99]
    ds_write_b64 v102, v[106:107]
    ds_write_b32 v94, v95 offset:64
    ds_write_b32 v102, v103 offset:64
    s_lshl_b32 s36, s2, 13
    s_lshl_b32 s37, s60, 11
    s_add_u32 s36, s36, s37
    v_lshl_add_u32 v16, v1, 7, s36
    s_cmp_lt_u32 s60, 2
    s_cselect_b64 s[38:39], s[48:49], s[50:51]
    s_lshr_b32 s36, s2, 3
    s_lshl_b32 s36, s36, 1
    s_and_b32 s37, s60, 1
    s_add_u32 s36, s36, s37
    s_lshl_b32 s36, s36, 16
    s_and_b32 s37, s29, 28
    s_lshl_b32 s37, s37, 8
    s_add_u32 s36, s36, s37
    s_sub_u32 s37, 256, s38
    s_and_b32 s37, s37, 0x300
    s_add_u32 s36, s36, s37
    v_lshrrev_b32 v18, 1, v1
    v_lshl_add_u32 v18, v18, 13, s36
    v_and_b32 v19, 1, v1
    v_lshl_add_u32 v18, v19, 7, v18
    s_mov_b64 exec, 0xffff
    global_load_dword v0, v16, s[46:47]
    global_load_dword v0, v18, s[38:39]
    s_mov_b64 exec, -1
    s_waitcnt lgkmcnt(0)
    s_cmp_eq_u32 s3, 0
    s_mov_b32 s3, 0
    s_cbranch_scc0 L_ln
L_pro_j:
    s_barrier
    ds_read_b128 v[20:23], v10 offset:0
    ds_read_b64_tr_b16 v[52:53], v12 offset:0
    ds_read_b64_tr_b16 v[54:55], v12 offset:1024
    ds_read_b64_tr_b16 v[56:57], v13 offset:0
    ds_read_b64_tr_b16 v[58:59], v13 offset:1024
    ds_read_b64_tr_b16 v[60:61], v14 offset:0
    ds_read_b64_tr_b16 v[62:63], v14 offset:1024
    ds_read_b64_tr_b16 v[64:65], v15 offset:0
    ds_read_b64_tr_b16 v[66:67], v15 offset:1024
    ds_read_b128 v[24:27], v10 offset:2048
    ds_read_b128 v[28:31], v10 offset:4096
    ds_read_b128 v[32:35], v10 offset:6144
    ds_read_b128 v[36:39], v10 offset:8192
    ds_read_b128 v[40:43], v10 offset:10240
    ds_read_b128 v[44:47], v10 offset:12288
    ds_read_b128 v[48:51], v10 offset:14336
    s_add_u32 s36, s2, s28
    s_cmp_eq_u32 s36, 0
    s_cbranch_scc1 L_recurrent_scan__compressed_kv_cla__moe_arch_mod__prompt_kernel_rare_3
L_recurrent_scan__compressed_kv_cla__moe_arch_mod__prompt_kernel_back_4:
    s_mov_b32 s35, 0
    s_cmp_eq_u32 s28, 0
    s_cselect_b32 s43, 9, 0
    s_cselect_b32 s44, 2, 1
    s_cmp_lt_u32 s28, 4
    s_cbranch_scc0 L_kv_vloop
    .p2align 6
L_kv_kloop:
    s_waitcnt lgkmcnt(0)
    v_mfma_f32_16x16x32_bf16 v[128:131], v[52:55], v[20:23], v[128:131]
    ds_read_b128 v[68:71], v11 offset:0
    v_mfma_f32_16x16x32_bf16 v[132:135], v[56:59], v[20:23], v[132:135]
    ds_read_b64_tr_b16 v[100:101], v12 offset:8192
    v_mfma_f32_16x16x32_bf16 v[136:139], v[60:63], v[20:23], v[136:139]
    ds_read_b64_tr_b16 v[102:103], v12 offset:9216
    v_mfma_f32_16x16x32_bf16 v[140:143], v[64:67], v[20:23], v[140:143]
    ds_read_b64_tr_b16 v[104:105], v13 offset:8192
    v_mfma_f32_16x16x32_bf16 v[144:147], v[52:55], v[24:27], v[144:147]
    ds_read_b64_tr_b16 v[106:107], v13 offset:9216
    v_mfma_f32_16x16x32_bf16 v[148:151], v[56:59], v[24:27], v[148:151]
    ds_read_b64_tr_b16 v[108:109], v14 offset:8192
    v_mfma_f32_16x16x32_bf16 v[152:155], v[60:63], v[24:27], v[152:155]
    ds_read_b64_tr_b16 v[110:111], v14 offset:9216
    v_mfma_f32_16x16x32_bf16 v[156:159], v[64:67], v[24:27], v[156:159]
    ds_read_b64_tr_b16 v[112:113], v15 offset:8192
    v_mfma_f32_16x16x32_bf16 v[160:163], v[52:55], v[28:31], v[160:163]
    ds_read_b64_tr_b16 v[114:115], v15 offset:9216
    v_mfma_f32_16x16x32_bf16 v[164:167], v[56:59], v[28:31], v[164:167]
    ds_read_b128 v[72:75], v11 offset:2048
    v_mfma_f32_16x16x32_bf16 v[168:171], v[60:63], v[28:31], v[168:171]
    ds_read_b128 v[76:79], v11 offset:4096
    v_mfma_f32_16x16x32_bf16 v[172:175], v[64:67], v[28:31], v[172:175]
    ds_read_b128 v[80:83], v11 offset:6144
    v_mfma_f32_16x16x32_bf16 v[176:179], v[52:55], v[32:35], v[176:179]
    ds_read_b128 v[84:87], v11 offset:8192
    v_mfma_f32_16x16x32_bf16 v[180:183], v[56:59], v[32:35], v[180:183]
    ds_read_b128 v[88:91], v11 offset:10240
    v_mfma_f32_16x16x32_bf16 v[184:187], v[60:63], v[32:35], v[184:187]
    ds_read_b128 v[92:95], v11 offset:12288
    v_mfma_f32_16x16x32_bf16 v[188:191], v[64:67], v[32:35], v[188:191]
    ds_read_b128 v[96:99], v11 offset:14336
    v_mfma_f32_16x16x32_bf16 v[192:195], v[52:55], v[36:39], v[192:195]
    v_mfma_f32_16x16x32_bf16 v[196:199], v[56:59], v[36:39], v[196:199]
    v_mfma_f32_16x16x32_bf16 v[200:203], v[60:63], v[36:39], v[200:203]
    v_mfma_f32_16x16x32_bf16 v[204:207], v[64:67], v[36:39], v[204:207]
    v_mfma_f32_16x16x32_bf16 v[208:211], v[52:55], v[40:43], v[208:211]
    v_mfma_f32_16x16x32_bf16 v[212:215], v[56:59], v[40:43], v[212:215]
    v_mfma_f32_16x16x32_bf16 v[216:219], v[60:63], v[40:43], v[216:219]
    v_mfma_f32_16x16x32_bf16 v[220:223], v[64:67], v[40:43], v[220:223]
    v_mfma_f32_16x16x32_bf16 v[224:227], v[52:55], v[44:47], v[224:227]
    v_mfma_f32_16x16x32_bf16 v[228:231], v[56:59], v[44:47], v[228:231]
    v_mfma_f32_16x16x32_bf16 v[232:235], v[60:63], v[44:47], v[232:235]
    v_mfma_f32_16x16x32_bf16 v[236:239], v[64:67], v[44:47], v[236:239]
    v_mfma_f32_16x16x32_bf16 v[240:243], v[52:55], v[48:51], v[240:243]
    v_mfma_f32_16x16x32_bf16 v[244:247], v[56:59], v[48:51], v[244:247]
    v_mfma_f32_16x16x32_bf16 v[248:251], v[60:63], v[48:51], v[248:251]
    v_mfma_f32_16x16x32_bf16 v[252:255], v[64:67], v[48:51], v[252:255]
    s_cmp_eq_u32 s35, 3
    s_cbranch_scc1 L_recurrent_scan__compressed_kv_cla__moe_arch_mod__prompt_kernel_rare_5
L_recurrent_scan__compressed_kv_cla__moe_arch_mod__prompt_kernel_back_6:
    s_cmp_lt_u32 s35, s44
    s_cbranch_scc1 L_recurrent_scan__compressed_kv_cla__moe_arch_mod__prompt_kernel_w0_7
    s_waitcnt vmcnt(1)
L_recurrent_scan__compressed_kv_cla__moe_arch_mod__prompt_kernel_w0b_8:
    s_waitcnt lgkmcnt(0)
    s_barrier
    v_mfma_f32_16x16x32_bf16 v[128:131], v[100:103], v[68:71], v[128:131]
    ds_read_b128 v[20:23], v10 offset:32768
    s_add_u32 m0, s33, 0
    v_mfma_f32_16x16x32_bf16 v[132:135], v[104:107], v[68:71], v[132:135]
    ds_read_b64_tr_b16 v[52:53], v12 offset:32768
    buffer_load_dwordx4 v2, s[4:7], s31 offen offset:0 lds
    v_mfma_f32_16x16x32_bf16 v[136:139], v[108:111], v[68:71], v[136:139]
    ds_read_b64_tr_b16 v[54:55], v12 offset:33792
    v_mfma_f32_16x16x32_bf16 v[140:143], v[112:115], v[68:71], v[140:143]
    ds_read_b64_tr_b16 v[56:57], v13 offset:32768
    v_mfma_f32_16x16x32_bf16 v[144:147], v[100:103], v[72:75], v[144:147]
    ds_read_b64_tr_b16 v[58:59], v13 offset:33792
    buffer_load_dwordx4 v3, s[4:7], s31 offen offset:1024 lds
    v_mfma_f32_16x16x32_bf16 v[148:151], v[104:107], v[72:75], v[148:151]
    ds_read_b64_tr_b16 v[60:61], v14 offset:32768
    v_mfma_f32_16x16x32_bf16 v[152:155], v[108:111], v[72:75], v[152:155]
    ds_read_b64_tr_b16 v[62:63], v14 offset:33792
    v_mfma_f32_16x16x32_bf16 v[156:159], v[112:115], v[72:75], v[156:159]
    ds_read_b64_tr_b16 v[64:65], v15 offset:32768
    buffer_load_dwordx4 v4, s[4:7], s31 offen offset:2048 lds
    v_mfma_f32_16x16x32_bf16 v[160:163], v[100:103], v[76:79], v[160:163]
    ds_read_b64_tr_b16 v[66:67], v15 offset:33792
    v_mfma_f32_16x16x32_bf16 v[164:167], v[104:107], v[76:79], v[164:167]
    ds_read_b128 v[24:27], v10 offset:34816
    v_mfma_f32_16x16x32_bf16 v[168:171], v[108:111], v[76:79], v[168:171]
    ds_read_b128 v[28:31], v10 offset:36864
    buffer_load_dwordx4 v5, s[4:7], s31 offen offset:3072 lds
    v_mfma_f32_16x16x32_bf16 v[172:175], v[112:115], v[76:79], v[172:175]
    ds_read_b128 v[32:35], v10 offset:38912
    v_mfma_f32_16x16x32_bf16 v[176:179], v[100:103], v[80:83], v[176:179]
    ds_read_b128 v[36:39], v10 offset:40960
    s_add_u32 m0, s34, 0
    v_mfma_f32_16x16x32_bf16 v[180:183], v[104:107], v[80:83], v[180:183]
    ds_read_b128 v[40:43], v10 offset:43008
    buffer_load_dwordx4 v6, s[8:11], s32 offen offset:0 nt lds
    v_mfma_f32_16x16x32_bf16 v[184:187], v[108:111], v[80:83], v[184:187]
    ds_read_b128 v[44:47], v10 offset:45056
    v_mfma_f32_16x16x32_bf16 v[188:191], v[112:115], v[80:83], v[188:191]
    ds_read_b128 v[48:51], v10 offset:47104
    v_mfma_f32_16x16x32_bf16 v[192:195], v[100:103], v[84:87], v[192:195]
    buffer_load_dwordx4 v7, s[8:11], s32 offen offset:1024 nt lds
    v_mfma_f32_16x16x32_bf16 v[196:199], v[104:107], v[84:87], v[196:199]
    v_mfma_f32_16x16x32_bf16 v[200:203], v[108:111], v[84:87], v[200:203]
    v_mfma_f32_16x16x32_bf16 v[204:207], v[112:115], v[84:87], v[204:207]
    buffer_load_dwordx4 v8, s[8:11], s32 offen offset:2048 nt lds
    v_mfma_f32_16x16x32_bf16 v[208:211], v[100:103], v[88:91], v[208:211]
    v_mfma_f32_16x16x32_bf16 v[212:215], v[104:107], v[88:91], v[212:215]
    v_mfma_f32_16x16x32_bf16 v[216:219], v[108:111], v[88:91], v[216:219]
    buffer_load_dwordx4 v9, s[8:11], s32 offen offset:3072 nt lds
    v_mfma_f32_16x16x32_bf16 v[220:223], v[112:115], v[88:91], v[220:223]
    v_mfma_f32_16x16x32_bf16 v[224:227], v[100:103], v[92:95], v[224:227]
    v_mfma_f32_16x16x32_bf16 v[228:231], v[104:107], v[92:95], v[228:231]
    v_mfma_f32_16x16x32_bf16 v[232:235], v[108:111], v[92:95], v[232:235]
    s_cmp_eq_u32 s35, 3
    s_cbranch_scc1 L_recurrent_scan__compressed_kv_cla__moe_arch_mod__prompt_kernel_rare_11
L_recurrent_scan__compressed_kv_cla__moe_arch_mod__prompt_kernel_back_12:
    v_mfma_f32_16x16x32_bf16 v[236:239], v[112:115], v[92:95], v[236:239]
    v_mfma_f32_16x16x32_bf16 v[240:243], v[100:103], v[96:99], v[240:243]
    v_mfma_f32_16x16x32_bf16 v[244:247], v[104:107], v[96:99], v[244:247]
    v_mfma_f32_16x16x32_bf16 v[248:251], v[108:111], v[96:99], v[248:251]
    v_mfma_f32_16x16x32_bf16 v[252:255], v[112:115], v[96:99], v[252:255]
    buffer_load_dword v0, v17, s[16:19], s45 offen
    s_add_u32 s45, s45, 8192
    s_add_u32 s31, s31, s40
    s_add_u32 s32, s32, s41
    s_waitcnt lgkmcnt(0)
    v_mfma_f32_16x16x32_bf16 v[128:131], v[52:55], v[20:23], v[128:131]
    ds_read_b128 v[68:71], v11 offset:32768
    v_mfma_f32_16x16x32_bf16 v[132:135], v[56:59], v[20:23], v[132:135]
    ds_read_b64_tr_b16 v[100:101], v12 offset:40960
    v_mfma_f32_16x16x32_bf16 v[136:139], v[60:63], v[20:23], v[136:139]
    ds_read_b64_tr_b16 v[102:103], v12 offset:41984
    v_mfma_f32_16x16x32_bf16 v[140:143], v[64:67], v[20:23], v[140:143]
    ds_read_b64_tr_b16 v[104:105], v13 offset:40960
    v_mfma_f32_16x16x32_bf16 v[144:147], v[52:55], v[24:27], v[144:147]
    ds_read_b64_tr_b16 v[106:107], v13 offset:41984
    v_mfma_f32_16x16x32_bf16 v[148:151], v[56:59], v[24:27], v[148:151]
    ds_read_b64_tr_b16 v[108:109], v14 offset:40960
    v_mfma_f32_16x16x32_bf16 v[152:155], v[60:63], v[24:27], v[152:155]
    ds_read_b64_tr_b16 v[110:111], v14 offset:41984
    v_mfma_f32_16x16x32_bf16 v[156:159], v[64:67], v[24:27], v[156:159]
    ds_read_b64_tr_b16 v[112:113], v15 offset:40960
    v_mfma_f32_16x16x32_bf16 v[160:163], v[52:55], v[28:31], v[160:163]
    ds_read_b64_tr_b16 v[114:115], v15 offset:41984
    v_mfma_f32_16x16x32_bf16 v[164:167], v[56:59], v[28:31], v[164:167]
    ds_read_b128 v[72:75], v11 offset:34816
    v_mfma_f32_16x16x32_bf16 v[168:171], v[60:63], v[28:31], v[168:171]
    ds_read_b128 v[76:79], v11 offset:36864
    v_mfma_f32_16x16x32_bf16 v[172:175], v[64:67], v[28:31], v[172:175]
    ds_read_b128 v[80:83], v11 offset:38912
    v_mfma_f32_16x16x32_bf16 v[176:179], v[52:55], v[32:35], v[176:179]
    ds_read_b128 v[84:87], v11 offset:40960
    v_mfma_f32_16x16x32_bf16 v[180:183], v[56:59], v[32:35], v[180:183]
    ds_read_b128 v[88:91], v11 offset:43008
    v_mfma_f32_16x16x32_bf16 v[184:187], v[60:63], v[32:35], v[184:187]
    ds_read_b128 v[92:95], v11 offset:45056
    v_mfma_f32_16x16x32_bf16 v[188:191], v[64:67], v[32:35], v[188:191]
    ds_read_b128 v[96:99], v11 offset:47104
    v_mfma_f32_16x16x32_bf16 v[192:195], v[52:55], v[36:39], v[192:195]
    v_mfma_f32_16x16x32_bf16 v[196:199], v[56:59], v[36:39], v[196:199]
    v_mfma_f32_16x16x32_bf16 v[200:203], v[60:63], v[36:39], v[200:203]
    v_mfma_f32_16x16x32_bf16 v[204:207], v[64:67], v[36:39], v[204:207]
    v_mfma_f32_16x16x32_bf16 v[208:211], v[52:55], v[40:43], v[208:211]
    s_bitcmp1_b32 s43, s35
    s_cbranch_scc1 L_recurrent_scan__compressed_kv_cla__moe_arch_mod__prompt_kernel_rare_15
L_recurrent_scan__compressed_kv_cla__moe_arch_mod__prompt_kernel_back_16:
    v_mfma_f32_16x16x32_bf16 v[212:215], v[56:59], v[40:43], v[212:215]
    v_mfma_f32_16x16x32_bf16 v[216:219], v[60:63], v[40:43], v[216:219]
    v_mfma_f32_16x16x32_bf16 v[220:223], v[64:67], v[40:43], v[220:223]
    v_mfma_f32_16x16x32_bf16 v[224:227], v[52:55], v[44:47], v[224:227]
    v_mfma_f32_16x16x32_bf16 v[228:231], v[56:59], v[44:47], v[228:231]
    v_mfma_f32_16x16x32_bf16 v[232:235], v[60:63], v[44:47], v[232:235]
    v_mfma_f32_16x16x32_bf16 v[236:239], v[64:67], v[44:47], v[236:239]
    v_mfma_f32_16x16x32_bf16 v[240:243], v[52:55], v[48:51], v[240:243]
    v_mfma_f32_16x16x32_bf16 v[244:247], v[56:59], v[48:51], v[244:247]
    v_mfma_f32_16x16x32_bf16 v[248:251], v[60:63], v[48:51], v[248:251]
    v_mfma_f32_16x16x32_bf16 v[252:255], v[64:67], v[48:51], v[252:255]
    s_bitcmp1_b32 s43, s35
    s_cbranch_scc1 L_recurrent_scan__compressed_kv_cla__moe_arch_mod__prompt_kernel_w0_17
    s_waitcnt vmcnt(1)
L_recurrent_scan__compressed_kv_cla__moe_arch_mod__prompt_kernel_w0b_18:
    s_waitcnt lgkmcnt(0)
    s_cmp_eq_u32 s35, 3
    s_barrier
    s_cbranch_scc1 L_p1_fin0
    v_mfma_f32_16x16x32_bf16 v[128:131], v[100:103], v[68:71], v[128:131]
    ds_read_b128 v[20:23], v10 offset:0
    s_add_u32 m0, s33, 32768
    v_mfma_f32_16x16x32_bf16 v[132:135], v[104:107], v[68:71], v[132:135]
    ds_read_b64_tr_b16 v[52:53], v12 offset:0
    buffer_load_dwordx4 v2, s[4:7], s31 offen offset:0 lds
    v_mfma_f32_16x16x32_bf16 v[136:139], v[108:111], v[68:71], v[136:139]
    ds_read_b64_tr_b16 v[54:55], v12 offset:1024
    v_mfma_f32_16x16x32_bf16 v[140:143], v[112:115], v[68:71], v[140:143]
    ds_read_b64_tr_b16 v[56:57], v13 offset:0
    v_mfma_f32_16x16x32_bf16 v[144:147], v[100:103], v[72:75], v[144:147]
    ds_read_b64_tr_b16 v[58:59], v13 offset:1024
    buffer_load_dwordx4 v3, s[4:7], s31 offen offset:1024 lds
    v_mfma_f32_16x16x32_bf16 v[148:151], v[104:107], v[72:75], v[148:151]
    ds_read_b64_tr_b16 v[60:61], v14 offset:0
    v_mfma_f32_16x16x32_bf16 v[152:155], v[108:111], v[72:75], v[152:155]
    ds_read_b64_tr_b16 v[62:63], v14 offset:1024
    v_mfma_f32_16x16x32_bf16 v[156:159], v[112:115], v[72:75], v[156:159]
    ds_read_b64_tr_b16 v[64:65], v15 offset:0
    buffer_load_dwordx4 v4, s[4:7], s31 offen offset:2048 lds
    v_mfma_f32_16x16x32_bf16 v[160:163], v[100:103], v[76:79], v[160:163]
    ds_read_b64_tr_b16 v[66:67], v15 offset:1024
    v_mfma_f32_16x16x32_bf16 v[164:167], v[104:107], v[76:79], v[164:167]
    ds_read_b128 v[24:27], v10 offset:2048
    v_mfma_f32_16x16x32_bf16 v[168:171], v[108:111], v[76:79], v[168:171]
    ds_read_b128 v[28:31], v10 offset:4096
    buffer_load_dwordx4 v5, s[4:7], s31 offen offset:3072 lds
    v_mfma_f32_16x16x32_bf16 v[172:175], v[112:115], v[76:79], v[172:175]
    ds_read_b128 v[32:35], v10 offset:6144
    v_mfma_f32_16x16x32_bf16 v[176:179], v[100:103], v[80:83], v[176:179]
    ds_read_b128 v[36:39], v10 offset:8192
    s_add_u32 m0, s34, 32768
    v_mfma_f32_16x16x32_bf16 v[180:183], v[104:107], v[80:83], v[180:183]
    ds_read_b128 v[40:43], v10 offset:10240
    buffer_load_dwordx4 v6, s[8:11], s32 offen offset:0 nt lds
    v_mfma_f32_16x16x32_bf16 v[184:187], v[108:111], v[80:83], v[184:187]
    ds_read_b128 v[44:47], v10 offset:12288
    v_mfma_f32_16x16x32_bf16 v[188:191], v[112:115], v[80:83], v[188:191]
    ds_read_b128 v[48:51], v10 offset:14336
    v_mfma_f32_16x16x32_bf16 v[192:195], v[100:103], v[84:87], v[192:195]
    buffer_load_dwordx4 v7, s[8:11], s32 offen offset:1024 nt lds
    v_mfma_f32_16x16x32_bf16 v[196:199], v[104:107], v[84:87], v[196:199]
    v_mfma_f32_16x16x32_bf16 v[200:203], v[108:111], v[84:87], v[200:203]
    v_mfma_f32_16x16x32_bf16 v[204:207], v[112:115], v[84:87], v[204:207]
    buffer_load_dwordx4 v8, s[8:11], s32 offen offset:2048 nt lds
    v_mfma_f32_16x16x32_bf16 v[208:211], v[100:103], v[88:91], v[208:211]
    v_mfma_f32_16x16x32_bf16 v[212:215], v[104:107], v[88:91], v[212:215]
    v_mfma_f32_16x16x32_bf16 v[216:219], v[108:111], v[88:91], v[216:219]
    buffer_load_dwordx4 v9, s[8:11], s32 offen offset:3072 nt lds
    v_mfma_f32_16x16x32_bf16 v[220:223], v[112:115], v[88:91], v[220:223]
    v_mfma_f32_16x16x32_bf16 v[224:227], v[100:103], v[92:95], v[224:227]
    v_mfma_f32_16x16x32_bf16 v[228:231], v[104:107], v[92:95], v[228:231]
    v_mfma_f32_16x16x32_bf16 v[232:235], v[108:111], v[92:95], v[232:235]
    v_mfma_f32_16x16x32_bf16 v[236:239], v[112:115], v[92:95], v[236:239]
    v_mfma_f32_16x16x32_bf16 v[240:243], v[100:103], v[96:99], v[240:243]
    v_mfma_f32_16x16x32_bf16 v[244:247], v[104:107], v[96:99], v[244:247]
    v_mfma_f32_16x16x32_bf16 v[248:251], v[108:111], v[96:99], v[248:251]
    s_add_u32 s36, s35, s28
    s_cmp_eq_u32 s36, 0
    s_cbranch_scc1 L_recurrent_scan__compressed_kv_cla__moe_arch_mod__prompt_kernel_rare_27
L_recurrent_scan__compressed_kv_cla__moe_arch_mod__prompt_kernel_back_28:
    v_mfma_f32_16x16x32_bf16 v[252:255], v[112:115], v[96:99], v[252:255]
    buffer_load_dword v0, v17, s[16:19], s45 offen
    s_add_u32 s45, s45, 8192
    s_add_u32 s31, s31, s40
    s_add_u32 s32, s32, s41
    s_add_u32 s35, s35, 1
    s_branch L_kv_kloop
L_p1_fin0:
    v_mfma_f32_16x16x32_bf16 v[128:131], v[100:103], v[68:71], v[128:131]
    s_and_b32 s36, s28, 3
    s_sub_u32 s37, 15, s30
    s_cmp_lt_u32 s28, 4
    s_cselect_b32 s37, s37, s30
    s_lshl_b32 s37, s37, 2
    s_add_u32 s37, s37, s36
    s_lshl_b32 s37, s37, 16
    v_lshl_add_u32 v6, v1, 4, s37
    v_add_u32 v7, 32768, v6
    s_mov_b32 s32, 0
    s_mov_b32 s8, s54
    s_and_b32 s9, s55, 0xffff
    s_mov_b32 s10, 104857728
    s_mov_b32 s11, 0x20000
    v_mfma_f32_16x16x32_bf16 v[132:135], v[104:107], v[68:71], v[132:135]
    buffer_load_dwordx4 v[24:27], v6, s[8:11], s32 offen offset:0 sc1
    v_mfma_f32_16x16x32_bf16 v[136:139], v[108:111], v[68:71], v[136:139]
    v_lshrrev_b32 v18, 4, v1
    v_mfma_f32_16x16x32_bf16 v[140:143], v[112:115], v[68:71], v[140:143]
    v_bfe_u32 v20, v1, 2, 2
    v_mfma_f32_16x16x32_bf16 v[144:147], v[100:103], v[72:75], v[144:147]
    buffer_load_dwordx4 v[28:31], v7, s[8:11], s32 offen offset:0 sc1
    v_lshl_add_u32 v19, v18, 3, v20
    v_mfma_f32_16x16x32_bf16 v[148:151], v[104:107], v[72:75], v[148:151]
    v_lshlrev_b32 v19, 8, v19
    v_mfma_f32_16x16x32_bf16 v[152:155], v[108:111], v[72:75], v[152:155]
    v_and_b32 v21, 3, v1
    v_mfma_f32_16x16x32_bf16 v[156:159], v[112:115], v[72:75], v[156:159]
    buffer_load_dwordx4 v[32:35], v6, s[8:11], s32 offen offset:1024 sc1
    v_lshl_add_u32 v19, v21, 3, v19
    v_mfma_f32_16x16x32_bf16 v[160:163], v[100:103], v[76:79], v[160:163]
    v_and_b32 v21, 1, v18
    v_mfma_f32_16x16x32_bf16 v[164:167], v[104:107], v[76:79], v[164:167]
    v_lshl_add_u32 v20, v21, 2, v20
    v_mfma_f32_16x16x32_bf16 v[168:171], v[108:111], v[76:79], v[168:171]
    buffer_load_dwordx4 v[36:39], v7, s[8:11], s32 offen offset:1024 sc1
    v_xor_b32 v21, 0, v20
    v_mfma_f32_16x16x32_bf16 v[172:175], v[112:115], v[76:79], v[172:175]
    v_lshl_add_u32 v10, v21, 5, v19
    v_mfma_f32_16x16x32_bf16 v[176:179], v[100:103], v[80:83], v[176:179]
    v_xor_b32 v21, 1, v20
    v_mfma_f32_16x16x32_bf16 v[180:183], v[104:107], v[80:83], v[180:183]
    buffer_load_dwordx4 v[40:43], v6, s[8:11], s32 offen offset:2048 sc1
    v_lshl_add_u32 v11, v21, 5, v19
    v_mfma_f32_16x16x32_bf16 v[184:187], v[108:111], v[80:83], v[184:187]
    v_xor_b32 v21, 2, v20
    v_mfma_f32_16x16x32_bf16 v[188:191], v[112:115], v[80:83], v[188:191]
    v_lshl_add_u32 v12, v21, 5, v19
    v_mfma_f32_16x16x32_bf16 v[192:195], v[100:103], v[84:87], v[192:195]
    buffer_load_dwordx4 v[44:47], v7, s[8:11], s32 offen offset:2048 sc1
    v_xor_b32 v21, 3, v20
    v_mfma_f32_16x16x32_bf16 v[196:199], v[104:107], v[84:87], v[196:199]
    v_lshl_add_u32 v13, v21, 5, v19
    v_mfma_f32_16x16x32_bf16 v[200:203], v[108:111], v[84:87], v[200:203]
    v_xor_b32 v21, 4, v20
    v_mfma_f32_16x16x32_bf16 v[204:207], v[112:115], v[84:87], v[204:207]
    buffer_load_dwordx4 v[48:51], v6, s[8:11], s32 offen offset:3072 sc1
    v_lshl_add_u32 v14, v21, 5, v19
    v_mfma_f32_16x16x32_bf16 v[208:211], v[100:103], v[88:91], v[208:211]
    v_xor_b32 v21, 5, v20
    v_mfma_f32_16x16x32_bf16 v[212:215], v[104:107], v[88:91], v[212:215]
    v_lshl_add_u32 v15, v21, 5, v19
    v_mfma_f32_16x16x32_bf16 v[216:219], v[108:111], v[88:91], v[216:219]
    buffer_load_dwordx4 v[52:55], v7, s[8:11], s32 offen offset:3072 sc1
    v_xor_b32 v21, 6, v20
    v_mfma_f32_16x16x32_bf16 v[220:223], v[112:115], v[88:91], v[220:223]
    v_lshl_add_u32 v16, v21, 5, v19
    v_mfma_f32_16x16x32_bf16 v[224:227], v[100:103], v[92:95], v[224:227]
    v_xor_b32 v21, 7, v20
    v_mfma_f32_16x16x32_bf16 v[228:231], v[104:107], v[92:95], v[228:231]
    v_lshl_add_u32 v17, v21, 5, v19
    v_mfma_f32_16x16x32_bf16 v[232:235], v[108:111], v[92:95], v[232:235]
    s_lshl_b32 s45, s29, 20
    v_mfma_f32_16x16x32_bf16 v[236:239], v[112:115], v[92:95], v[236:239]
    v_mfma_f32_16x16x32_bf16 v[240:243], v[100:103], v[96:99], v[240:243]
    v_mfma_f32_16x16x32_bf16 v[244:247], v[104:107], v[96:99], v[244:247]
    v_mfma_f32_16x16x32_bf16 v[248:251], v[108:111], v[96:99], v[248:251]
    v_mfma_f32_16x16x32_bf16 v[252:255], v[112:115], v[96:99], v[252:255]
    s_branch L_p1_done
    .p2align 6
L_kv_vloop:
    s_waitcnt lgkmcnt(0)
    v_mfma_f32_16x16x32_bf16 v[128:131], v[20:23], v[52:55], v[128:131]
    ds_read_b128 v[68:71], v11 offset:0
    v_mfma_f32_16x16x32_bf16 v[160:163], v[20:23], v[56:59], v[160:163]
    ds_read_b64_tr_b16 v[100:101], v12 offset:8192
    v_mfma_f32_16x16x32_bf16 v[192:195], v[20:23], v[60:63], v[192:195]
    ds_read_b64_tr_b16 v[102:103], v12 offset:9216
    v_mfma_f32_16x16x32_bf16 v[224:227], v[20:23], v[64:67], v[224:227]
    ds_read_b64_tr_b16 v[104:105], v13 offset:8192
    v_mfma_f32_16x16x32_bf16 v[132:135], v[24:27], v[52:55], v[132:135]
    ds_read_b64_tr_b16 v[106:107], v13 offset:9216
    v_mfma_f32_16x16x32_bf16 v[164:167], v[24:27], v[56:59], v[164:167]
    ds_read_b64_tr_b16 v[108:109], v14 offset:8192
    v_mfma_f32_16x16x32_bf16 v[196:199], v[24:27], v[60:63], v[196:199]
    ds_read_b64_tr_b16 v[110:111], v14 offset:9216
    v_mfma_f32_16x16x32_bf16 v[228:231], v[24:27], v[64:67], v[228:231]
    ds_read_b64_tr_b16 v[112:113], v15 offset:8192
    v_mfma_f32_16x16x32_bf16 v[136:139], v[28:31], v[52:55], v[136:139]
    ds_read_b64_tr_b16 v[114:115], v15 offset:9216
    v_mfma_f32_16x16x32_bf16 v[168:171], v[28:31], v[56:59], v[168:171]
    ds_read_b128 v[72:75], v11 offset:2048
    v_mfma_f32_16x16x32_bf16 v[200:203], v[28:31], v[60:63], v[200:203]
    ds_read_b128 v[76:79], v11 offset:4096
    v_mfma_f32_16x16x32_bf16 v[232:235], v[28:31], v[64:67], v[232:235]
    ds_read_b128 v[80:83], v11 offset:6144
    v_mfma_f32_16x16x32_bf16 v[140:143], v[32:35], v[52:55], v[140:143]
    ds_read_b128 v[84:87], v11 offset:8192
    v_mfma_f32_16x16x32_bf16 v[172:175], v[32:35], v[56:59], v[172:175]
    ds_read_b128 v[88:91], v11 offset:10240
    v_mfma_f32_16x16x32_bf16 v[204:207], v[32:35], v[60:63], v[204:207]
    ds_read_b128 v[92:95], v11 offset:12288
    v_mfma_f32_16x16x32_bf16 v[236:239], v[32:35], v[64:67], v[236:239]
    ds_read_b128 v[96:99], v11 offset:14336
    v_mfma_f32_16x16x32_bf16 v[144:147], v[36:39], v[52:55], v[144:147]
    v_mfma_f32_16x16x32_bf16 v[176:179], v[36:39], v[56:59], v[176:179]
    v_mfma_f32_16x16x32_bf16 v[208:211], v[36:39], v[60:63], v[208:211]
    v_mfma_f32_16x16x32_bf16 v[240:243], v[36:39], v[64:67], v[240:243]
    v_mfma_f32_16x16x32_bf16 v[148:151], v[40:43], v[52:55], v[148:151]
    v_mfma_f32_16x16x32_bf16 v[180:183], v[40:43], v[56:59], v[180:183]
    v_mfma_f32_16x16x32_bf16 v[212:215], v[40:43], v[60:63], v[212:215]
    v_mfma_f32_16x16x32_bf16 v[244:247], v[40:43], v[64:67], v[244:247]
    v_mfma_f32_16x16x32_bf16 v[152:155], v[44:47], v[52:55], v[152:155]
    v_mfma_f32_16x16x32_bf16 v[184:187], v[44:47], v[56:59], v[184:187]
    v_mfma_f32_16x16x32_bf16 v[216:219], v[44:47], v[60:63], v[216:219]
    v_mfma_f32_16x16x32_bf16 v[248:251], v[44:47], v[64:67], v[248:251]
    v_mfma_f32_16x16x32_bf16 v[156:159], v[48:51], v[52:55], v[156:159]
    v_mfma_f32_16x16x32_bf16 v[188:191], v[48:51], v[56:59], v[188:191]
    v_mfma_f32_16x16x32_bf16 v[220:223], v[48:51], v[60:63], v[220:223]
    v_mfma_f32_16x16x32_bf16 v[252:255], v[48:51], v[64:67], v[252:255]
    s_cmp_lt_u32 s35, s44
    s_cbranch_scc1 L_recurrent_scan__compressed_kv_cla__moe_arch_mod__prompt_kernel_w0_29
    s_waitcnt vmcnt(1)
L_recurrent_scan__compressed_kv_cla__moe_arch_mod__prompt_kernel_w0b_30:
    s_waitcnt lgkmcnt(0)
    s_barrier
    s_add_u32 m0, s33, 0
    s_nop 0
    buffer_load_dwordx4 v2, s[4:7], s31 offen offset:0 lds
    buffer_load_dwordx4 v3, s[4:7], s31 offen offset:1024 lds
    buffer_load_dwordx4 v4, s[4:7], s31 offen offset:2048 lds
    buffer_load_dwordx4 v5, s[4:7], s31 offen offset:3072 lds
    s_add_u32 m0, s34, 0
    s_nop 0
    buffer_load_dwordx4 v6, s[8:11], s32 offen offset:0 nt lds
    buffer_load_dwordx4 v7, s[8:11], s32 offen offset:1024 nt lds
    buffer_load_dwordx4 v8, s[8:11], s32 offen offset:2048 nt lds
    buffer_load_dwordx4 v9, s[8:11], s32 offen offset:3072 nt lds
    s_add_u32 s31, s31, s40
    s_add_u32 s32, s32, s41
    s_cmp_eq_u32 s35, 0
    s_cbranch_scc1 L_recurrent_scan__compressed_kv_cla__moe_arch_mod__prompt_kernel_rare_36
L_recurrent_scan__compressed_kv_cla__moe_arch_mod__prompt_kernel_back_37:
    v_mfma_f32_16x16x32_bf16 v[128:131], v[68:71], v[100:103], v[128:131]
    ds_read_b128 v[20:23], v10 offset:32768
    v_mfma_f32_16x16x32_bf16 v[160:163], v[68:71], v[104:107], v[160:163]
    ds_read_b64_tr_b16 v[52:53], v12 offset:32768
    v_mfma_f32_16x16x32_bf16 v[192:195], v[68:71], v[108:111], v[192:195]
    ds_read_b64_tr_b16 v[54:55], v12 offset:33792
    v_mfma_f32_16x16x32_bf16 v[224:227], v[68:71], v[112:115], v[224:227]
    ds_read_b64_tr_b16 v[56:57], v13 offset:32768
    v_mfma_f32_16x16x32_bf16 v[132:135], v[72:75], v[100:103], v[132:135]
    ds_read_b64_tr_b16 v[58:59], v13 offset:33792
    v_mfma_f32_16x16x32_bf16 v[164:167], v[72:75], v[104:107], v[164:167]
    ds_read_b64_tr_b16 v[60:61], v14 offset:32768
    v_mfma_f32_16x16x32_bf16 v[196:199], v[72:75], v[108:111], v[196:199]
    ds_read_b64_tr_b16 v[62:63], v14 offset:33792
    v_mfma_f32_16x16x32_bf16 v[228:231], v[72:75], v[112:115], v[228:231]
    ds_read_b64_tr_b16 v[64:65], v15 offset:32768
    v_mfma_f32_16x16x32_bf16 v[136:139], v[76:79], v[100:103], v[136:139]
    ds_read_b64_tr_b16 v[66:67], v15 offset:33792
    v_mfma_f32_16x16x32_bf16 v[168:171], v[76:79], v[104:107], v[168:171]
    ds_read_b128 v[24:27], v10 offset:34816
    v_mfma_f32_16x16x32_bf16 v[200:203], v[76:79], v[108:111], v[200:203]
    ds_read_b128 v[28:31], v10 offset:36864
    v_mfma_f32_16x16x32_bf16 v[232:235], v[76:79], v[112:115], v[232:235]
    ds_read_b128 v[32:35], v10 offset:38912
    v_mfma_f32_16x16x32_bf16 v[140:143], v[80:83], v[100:103], v[140:143]
    ds_read_b128 v[36:39], v10 offset:40960
    v_mfma_f32_16x16x32_bf16 v[172:175], v[80:83], v[104:107], v[172:175]
    ds_read_b128 v[40:43], v10 offset:43008
    v_mfma_f32_16x16x32_bf16 v[204:207], v[80:83], v[108:111], v[204:207]
    ds_read_b128 v[44:47], v10 offset:45056
    v_mfma_f32_16x16x32_bf16 v[236:239], v[80:83], v[112:115], v[236:239]
    ds_read_b128 v[48:51], v10 offset:47104
    v_mfma_f32_16x16x32_bf16 v[144:147], v[84:87], v[100:103], v[144:147]
    v_mfma_f32_16x16x32_bf16 v[176:179], v[84:87], v[104:107], v[176:179]
    v_mfma_f32_16x16x32_bf16 v[208:211], v[84:87], v[108:111], v[208:211]
    v_mfma_f32_16x16x32_bf16 v[240:243], v[84:87], v[112:115], v[240:243]
    v_mfma_f32_16x16x32_bf16 v[148:151], v[88:91], v[100:103], v[148:151]
    v_mfma_f32_16x16x32_bf16 v[180:183], v[88:91], v[104:107], v[180:183]
    v_mfma_f32_16x16x32_bf16 v[212:215], v[88:91], v[108:111], v[212:215]
    v_mfma_f32_16x16x32_bf16 v[244:247], v[88:91], v[112:115], v[244:247]
    v_mfma_f32_16x16x32_bf16 v[152:155], v[92:95], v[100:103], v[152:155]
    v_mfma_f32_16x16x32_bf16 v[184:187], v[92:95], v[104:107], v[184:187]
    v_mfma_f32_16x16x32_bf16 v[216:219], v[92:95], v[108:111], v[216:219]
    s_cmp_eq_u32 s35, 3
    s_cbranch_scc1 L_recurrent_scan__compressed_kv_cla__moe_arch_mod__prompt_kernel_rare_33
L_recurrent_scan__compressed_kv_cla__moe_arch_mod__prompt_kernel_back_34:
    v_mfma_f32_16x16x32_bf16 v[248:251], v[92:95], v[112:115], v[248:251]
    v_mfma_f32_16x16x32_bf16 v[156:159], v[96:99], v[100:103], v[156:159]
    v_mfma_f32_16x16x32_bf16 v[188:191], v[96:99], v[104:107], v[188:191]
    v_mfma_f32_16x16x32_bf16 v[220:223], v[96:99], v[108:111], v[220:223]
    v_mfma_f32_16x16x32_bf16 v[252:255], v[96:99], v[112:115], v[252:255]
    buffer_load_dword v0, v17, s[16:19], s45 offen
    s_add_u32 s45, s45, 8192
    s_waitcnt lgkmcnt(0)
    v_mfma_f32_16x16x32_bf16 v[128:131], v[20:23], v[52:55], v[128:131]
    ds_read_b128 v[68:71], v11 offset:32768
    v_mfma_f32_16x16x32_bf16 v[160:163], v[20:23], v[56:59], v[160:163]
    ds_read_b64_tr_b16 v[100:101], v12 offset:40960
    v_mfma_f32_16x16x32_bf16 v[192:195], v[20:23], v[60:63], v[192:195]
    ds_read_b64_tr_b16 v[102:103], v12 offset:41984
    v_mfma_f32_16x16x32_bf16 v[224:227], v[20:23], v[64:67], v[224:227]
    ds_read_b64_tr_b16 v[104:105], v13 offset:40960
    v_mfma_f32_16x16x32_bf16 v[132:135], v[24:27], v[52:55], v[132:135]
    ds_read_b64_tr_b16 v[106:107], v13 offset:41984
    v_mfma_f32_16x16x32_bf16 v[164:167], v[24:27], v[56:59], v[164:167]
    ds_read_b64_tr_b16 v[108:109], v14 offset:40960
    v_mfma_f32_16x16x32_bf16 v[196:199], v[24:27], v[60:63], v[196:199]
    ds_read_b64_tr_b16 v[110:111], v14 offset:41984
    v_mfma_f32_16x16x32_bf16 v[228:231], v[24:27], v[64:67], v[228:231]
    ds_read_b64_tr_b16 v[112:113], v15 offset:40960
    v_mfma_f32_16x16x32_bf16 v[136:139], v[28:31], v[52:55], v[136:139]
    ds_read_b64_tr_b16 v[114:115], v15 offset:41984
    v_mfma_f32_16x16x32_bf16 v[168:171], v[28:31], v[56:59], v[168:171]
    ds_read_b128 v[72:75], v11 offset:34816
    v_mfma_f32_16x16x32_bf16 v[200:203], v[28:31], v[60:63], v[200:203]
    ds_read_b128 v[76:79], v11 offset:36864
    v_mfma_f32_16x16x32_bf16 v[232:235], v[28:31], v[64:67], v[232:235]
    ds_read_b128 v[80:83], v11 offset:38912
    v_mfma_f32_16x16x32_bf16 v[140:143], v[32:35], v[52:55], v[140:143]
    ds_read_b128 v[84:87], v11 offset:40960
    v_mfma_f32_16x16x32_bf16 v[172:175], v[32:35], v[56:59], v[172:175]
    ds_read_b128 v[88:91], v11 offset:43008
    v_mfma_f32_16x16x32_bf16 v[204:207], v[32:35], v[60:63], v[204:207]
    ds_read_b128 v[92:95], v11 offset:45056
    v_mfma_f32_16x16x32_bf16 v[236:239], v[32:35], v[64:67], v[236:239]
    ds_read_b128 v[96:99], v11 offset:47104
    v_mfma_f32_16x16x32_bf16 v[144:147], v[36:39], v[52:55], v[144:147]
    v_mfma_f32_16x16x32_bf16 v[176:179], v[36:39], v[56:59], v[176:179]
    v_mfma_f32_16x16x32_bf16 v[208:211], v[36:39], v[60:63], v[208:211]
    v_mfma_f32_16x16x32_bf16 v[240:243], v[36:39], v[64:67], v[240:243]
    v_mfma_f32_16x16x32_bf16 v[148:151], v[40:43], v[52:55], v[148:151]
    v_mfma_f32_16x16x32_bf16 v[180:183], v[40:43], v[56:59], v[180:183]
    v_mfma_f32_16x16x32_bf16 v[212:215], v[40:43], v[60:63], v[212:215]
    v_mfma_f32_16x16x32_bf16 v[244:247], v[40:43], v[64:67], v[244:247]
    v_mfma_f32_16x16x32_bf16 v[152:155], v[44:47], v[52:55], v[152:155]
    v_mfma_f32_16x16x32_bf16 v[184:187], v[44:47], v[56:59], v[184:187]
    v_mfma_f32_16x16x32_bf16 v[216:219], v[44:47], v[60:63], v[216:219]
    v_mfma_f32_16x16x32_bf16 v[248:251], v[44:47], v[64:67], v[248:251]
    v_mfma_f32_16x16x32_bf16 v[156:159], v[48:51], v[52:55], v[156:159]
    v_mfma_f32_16x16x32_bf16 v[188:191], v[48:51], v[56:59], v[188:191]
    v_mfma_f32_16x16x32_bf16 v[220:223], v[48:51], v[60:63], v[220:223]
    v_mfma_f32_16x16x32_bf16 v[252:255], v[48:51], v[64:67], v[252:255]
    s_waitcnt vmcnt(1) lgkmcnt(0)
    s_cmp_eq_u32 s35, 3
    s_barrier
    s_cbranch_scc1 L_p1_fin1
    s_add_u32 m0, s33, 32768
    s_nop 0
    buffer_load_dwordx4 v2, s[4:7], s31 offen offset:0 lds
    buffer_load_dwordx4 v3, s[4:7], s31 offen offset:1024 lds
    buffer_load_dwordx4 v4, s[4:7], s31 offen offset:2048 lds
    buffer_load_dwordx4 v5, s[4:7], s31 offen offset:3072 lds
    s_add_u32 m0, s34, 32768
    s_nop 0
    buffer_load_dwordx4 v6, s[8:11], s32 offen offset:0 nt lds
    buffer_load_dwordx4 v7, s[8:11], s32 offen offset:1024 nt lds
    buffer_load_dwordx4 v8, s[8:11], s32 offen offset:2048 nt lds
    buffer_load_dwordx4 v9, s[8:11], s32 offen offset:3072 nt lds
    s_add_u32 s31, s31, s40
    s_add_u32 s32, s32, s41
    s_cmp_eq_u32 s35, 2
    s_cbranch_scc1 L_recurrent_scan__compressed_kv_cla__moe_arch_mod__prompt_kernel_rare_40
L_recurrent_scan__compressed_kv_cla__moe_arch_mod__prompt_kernel_back_41:
    v_mfma_f32_16x16x32_bf16 v[128:131], v[68:71], v[100:103], v[128:131]
    ds_read_b128 v[20:23], v10 offset:0
    v_mfma_f32_16x16x32_bf16 v[160:163], v[68:71], v[104:107], v[160:163]
    ds_read_b64_tr_b16 v[52:53], v12 offset:0
    v_mfma_f32_16x16x32_bf16 v[192:195], v[68:71], v[108:111], v[192:195]
    ds_read_b64_tr_b16 v[54:55], v12 offset:1024
    v_mfma_f32_16x16x32_bf16 v[224:227], v[68:71], v[112:115], v[224:227]
    ds_read_b64_tr_b16 v[56:57], v13 offset:0
    v_mfma_f32_16x16x32_bf16 v[132:135], v[72:75], v[100:103], v[132:135]
    ds_read_b64_tr_b16 v[58:59], v13 offset:1024
    v_mfma_f32_16x16x32_bf16 v[164:167], v[72:75], v[104:107], v[164:167]
    ds_read_b64_tr_b16 v[60:61], v14 offset:0
    v_mfma_f32_16x16x32_bf16 v[196:199], v[72:75], v[108:111], v[196:199]
    ds_read_b64_tr_b16 v[62:63], v14 offset:1024
    v_mfma_f32_16x16x32_bf16 v[228:231], v[72:75], v[112:115], v[228:231]
    ds_read_b64_tr_b16 v[64:65], v15 offset:0
    v_mfma_f32_16x16x32_bf16 v[136:139], v[76:79], v[100:103], v[136:139]
    ds_read_b64_tr_b16 v[66:67], v15 offset:1024
    v_mfma_f32_16x16x32_bf16 v[168:171], v[76:79], v[104:107], v[168:171]
    ds_read_b128 v[24:27], v10 offset:2048
    v_mfma_f32_16x16x32_bf16 v[200:203], v[76:79], v[108:111], v[200:203]
    ds_read_b128 v[28:31], v10 offset:4096
    v_mfma_f32_16x16x32_bf16 v[232:235], v[76:79], v[112:115], v[232:235]
    ds_read_b128 v[32:35], v10 offset:6144
    v_mfma_f32_16x16x32_bf16 v[140:143], v[80:83], v[100:103], v[140:143]
    ds_read_b128 v[36:39], v10 offset:8192
    v_mfma_f32_16x16x32_bf16 v[172:175], v[80:83], v[104:107], v[172:175]
    ds_read_b128 v[40:43], v10 offset:10240
    v_mfma_f32_16x16x32_bf16 v[204:207], v[80:83], v[108:111], v[204:207]
    ds_read_b128 v[44:47], v10 offset:12288
    v_mfma_f32_16x16x32_bf16 v[236:239], v[80:83], v[112:115], v[236:239]
    ds_read_b128 v[48:51], v10 offset:14336
    v_mfma_f32_16x16x32_bf16 v[144:147], v[84:87], v[100:103], v[144:147]
    v_mfma_f32_16x16x32_bf16 v[176:179], v[84:87], v[104:107], v[176:179]
    v_mfma_f32_16x16x32_bf16 v[208:211], v[84:87], v[108:111], v[208:211]
    v_mfma_f32_16x16x32_bf16 v[240:243], v[84:87], v[112:115], v[240:243]
    v_mfma_f32_16x16x32_bf16 v[148:151], v[88:91], v[100:103], v[148:151]
    v_mfma_f32_16x16x32_bf16 v[180:183], v[88:91], v[104:107], v[180:183]
    v_mfma_f32_16x16x32_bf16 v[212:215], v[88:91], v[108:111], v[212:215]
    v_mfma_f32_16x16x32_bf16 v[244:247], v[88:91], v[112:115], v[244:247]
    v_mfma_f32_16x16x32_bf16 v[152:155], v[92:95], v[100:103], v[152:155]
    v_mfma_f32_16x16x32_bf16 v[184:187], v[92:95], v[104:107], v[184:187]
    v_mfma_f32_16x16x32_bf16 v[216:219], v[92:95], v[108:111], v[216:219]
    v_mfma_f32_16x16x32_bf16 v[248:251], v[92:95], v[112:115], v[248:251]
    v_mfma_f32_16x16x32_bf16 v[156:159], v[96:99], v[100:103], v[156:159]
    v_mfma_f32_16x16x32_bf16 v[188:191], v[96:99], v[104:107], v[188:191]
    v_mfma_f32_16x16x32_bf16 v[220:223], v[96:99], v[108:111], v[220:223]
    v_mfma_f32_16x16x32_bf16 v[252:255], v[96:99], v[112:115], v[252:255]
    buffer_load_dword v0, v17, s[16:19], s45 offen
    s_add_u32 s45, s45, 8192
    s_add_u32 s35, s35, 1
    s_branch L_kv_vloop
L_p1_fin1:
    s_and_b32 s36, s28, 3
    s_sub_u32 s37, 15, s30
    s_cmp_lt_u32 s28, 4
    s_cselect_b32 s37, s37, s30
    s_lshl_b32 s37, s37, 2
    s_add_u32 s37, s37, s36
    s_lshl_b32 s37, s37, 16
    v_lshl_add_u32 v6, v1, 4, s37
    v_add_u32 v7, 32768, v6
    s_mov_b32 s32, 0
    s_mov_b32 s8, s54
    s_and_b32 s9, s55, 0xffff
    s_mov_b32 s10, 104857728
    s_mov_b32 s11, 0x20000
    v_mfma_f32_16x16x32_bf16 v[128:131], v[68:71], v[100:103], v[128:131]
    v_mfma_f32_16x16x32_bf16 v[160:163], v[68:71], v[104:107], v[160:163]
    buffer_load_dwordx4 v[24:27], v6, s[8:11], s32 offen offset:0 sc1
    v_mfma_f32_16x16x32_bf16 v[192:195], v[68:71], v[108:111], v[192:195]
    v_lshrrev_b32 v18, 4, v1
    v_mfma_f32_16x16x32_bf16 v[224:227], v[68:71], v[112:115], v[224:227]
    v_bfe_u32 v20, v1, 2, 2
    v_mfma_f32_16x16x32_bf16 v[132:135], v[72:75], v[100:103], v[132:135]
    buffer_load_dwordx4 v[28:31], v7, s[8:11], s32 offen offset:0 sc1
    v_lshl_add_u32 v19, v18, 3, v20
    v_mfma_f32_16x16x32_bf16 v[164:167], v[72:75], v[104:107], v[164:167]
    v_lshlrev_b32 v19, 8, v19
    v_mfma_f32_16x16x32_bf16 v[196:199], v[72:75], v[108:111], v[196:199]
    v_and_b32 v21, 3, v1
    v_mfma_f32_16x16x32_bf16 v[228:231], v[72:75], v[112:115], v[228:231]
    buffer_load_dwordx4 v[32:35], v6, s[8:11], s32 offen offset:1024 sc1
    v_lshl_add_u32 v19, v21, 3, v19
    v_mfma_f32_16x16x32_bf16 v[136:139], v[76:79], v[100:103], v[136:139]
    v_and_b32 v21, 1, v18
    v_mfma_f32_16x16x32_bf16 v[168:171], v[76:79], v[104:107], v[168:171]
    v_lshl_add_u32 v20, v21, 2, v20
    v_mfma_f32_16x16x32_bf16 v[200:203], v[76:79], v[108:111], v[200:203]
    buffer_load_dwordx4 v[36:39], v7, s[8:11], s32 offen offset:1024 sc1
    v_xor_b32 v21, 0, v20
    v_mfma_f32_16x16x32_bf16 v[232:235], v[76:79], v[112:115], v[232:235]
    v_lshl_add_u32 v10, v21, 5, v19
    v_mfma_f32_16x16x32_bf16 v[140:143], v[80:83], v[100:103], v[140:143]
    v_xor_b32 v21, 1, v20
    v_mfma_f32_16x16x32_bf16 v[172:175], v[80:83], v[104:107], v[172:175]
    buffer_load_dwordx4 v[40:43], v6, s[8:11], s32 offen offset:2048 sc1
    v_lshl_add_u32 v11, v21, 5, v19
    v_mfma_f32_16x16x32_bf16 v[204:207], v[80:83], v[108:111], v[204:207]
    v_xor_b32 v21, 2, v20
    v_mfma_f32_16x16x32_bf16 v[236:239], v[80:83], v[112:115], v[236:239]
    v_lshl_add_u32 v12, v21, 5, v19
    v_mfma_f32_16x16x32_bf16 v[144:147], v[84:87], v[100:103], v[144:147]
    buffer_load_dwordx4 v[44:47], v7, s[8:11], s32 offen offset:2048 sc1
    v_xor_b32 v21, 3, v20
    v_mfma_f32_16x16x32_bf16 v[176:179], v[84:87], v[104:107], v[176:179]
    v_lshl_add_u32 v13, v21, 5, v19
    v_mfma_f32_16x16x32_bf16 v[208:211], v[84:87], v[108:111], v[208:211]
    v_xor_b32 v21, 4, v20
    v_mfma_f32_16x16x32_bf16 v[240:243], v[84:87], v[112:115], v[240:243]
    buffer_load_dwordx4 v[48:51], v6, s[8:11], s32 offen offset:3072 sc1
    v_lshl_add_u32 v14, v21, 5, v19
    v_mfma_f32_16x16x32_bf16 v[148:151], v[88:91], v[100:103], v[148:151]
    v_xor_b32 v21, 5, v20
    v_mfma_f32_16x16x32_bf16 v[180:183], v[88:91], v[104:107], v[180:183]
    v_lshl_add_u32 v15, v21, 5, v19
    v_mfma_f32_16x16x32_bf16 v[212:215], v[88:91], v[108:111], v[212:215]
    buffer_load_dwordx4 v[52:55], v7, s[8:11], s32 offen offset:3072 sc1
    v_xor_b32 v21, 6, v20
    v_mfma_f32_16x16x32_bf16 v[244:247], v[88:91], v[112:115], v[244:247]
    v_lshl_add_u32 v16, v21, 5, v19
    v_mfma_f32_16x16x32_bf16 v[152:155], v[92:95], v[100:103], v[152:155]
    v_xor_b32 v21, 7, v20
    v_mfma_f32_16x16x32_bf16 v[184:187], v[92:95], v[104:107], v[184:187]
    v_lshl_add_u32 v17, v21, 5, v19
    v_mfma_f32_16x16x32_bf16 v[216:219], v[92:95], v[108:111], v[216:219]
    s_lshl_b32 s45, s29, 20
    v_mfma_f32_16x16x32_bf16 v[248:251], v[92:95], v[112:115], v[248:251]
    v_mfma_f32_16x16x32_bf16 v[156:159], v[96:99], v[100:103], v[156:159]
    v_mfma_f32_16x16x32_bf16 v[188:191], v[96:99], v[104:107], v[188:191]
    v_mfma_f32_16x16x32_bf16 v[220:223], v[96:99], v[108:111], v[220:223]
    v_mfma_f32_16x16x32_bf16 v[252:255], v[96:99], v[112:115], v[252:255]
L_p1_done:
    ds_read_b64_tr_b16 v[64:65], v10 offset:0
    ds_read_b64_tr_b16 v[66:67], v10 offset:1024
    ds_read_b64_tr_b16 v[68:69], v11 offset:0
    ds_read_b64_tr_b16 v[70:71], v11 offset:1024
    ds_read_b64_tr_b16 v[72:73], v12 offset:0
    ds_read_b64_tr_b16 v[74:75], v12 offset:1024
    ds_read_b64_tr_b16 v[76:77], v13 offset:0
    ds_read_b64_tr_b16 v[78:79], v13 offset:1024
    ds_read_b64_tr_b16 v[80:81], v14 offset:0
    ds_read_b64_tr_b16 v[82:83], v14 offset:1024
    ds_read_b64_tr_b16 v[84:85], v15 offset:0
    ds_read_b64_tr_b16 v[86:87], v15 offset:1024
    s_add_u32 m0, s33, 32768
    s_add_u32 s32, s32, 4096
    v_cvt_pk_bf16_f32 v128, v128, v129
    v_cvt_pk_bf16_f32 v129, v130, v131
    v_cvt_pk_bf16_f32 v130, v132, v133
    v_cvt_pk_bf16_f32 v131, v134, v135
    v_cvt_pk_bf16_f32 v132, v136, v137
    v_cvt_pk_bf16_f32 v133, v138, v139
    v_cvt_pk_bf16_f32 v134, v140, v141
    v_cvt_pk_bf16_f32 v135, v142, v143
    v_cvt_pk_bf16_f32 v136, v144, v145
    v_cvt_pk_bf16_f32 v137, v146, v147
    v_cvt_pk_bf16_f32 v138, v148, v149
    v_cvt_pk_bf16_f32 v139, v150, v151
    buffer_load_dwordx4 v2, s[4:7], s31 offen offset:0 lds
    v_cvt_pk_bf16_f32 v140, v152, v153
    v_cvt_pk_bf16_f32 v141, v154, v155
    v_cvt_pk_bf16_f32 v142, v156, v157
    v_cvt_pk_bf16_f32 v143, v158, v159
    v_cvt_pk_bf16_f32 v144, v160, v161
    v_cvt_pk_bf16_f32 v145, v162, v163
    v_cvt_pk_bf16_f32 v146, v164, v165
    v_cvt_pk_bf16_f32 v147, v166, v167
    v_cvt_pk_bf16_f32 v148, v168, v169
    v_cvt_pk_bf16_f32 v149, v170, v171
    v_cvt_pk_bf16_f32 v150, v172, v173
    v_cvt_pk_bf16_f32 v151, v174, v175
    buffer_load_dwordx4 v3, s[4:7], s31 offen offset:1024 lds
    v_cvt_pk_bf16_f32 v152, v176, v177
    v_cvt_pk_bf16_f32 v153, v178, v179
    v_cvt_pk_bf16_f32 v154, v180, v181
    v_cvt_pk_bf16_f32 v155, v182, v183
    v_cvt_pk_bf16_f32 v156, v184, v185
    v_cvt_pk_bf16_f32 v157, v186, v187
    v_cvt_pk_bf16_f32 v158, v188, v189
    v_cvt_pk_bf16_f32 v159, v190, v191
    v_cvt_pk_bf16_f32 v160, v192, v193
    v_cvt_pk_bf16_f32 v161, v194, v195
    v_cvt_pk_bf16_f32 v162, v196, v197
    v_cvt_pk_bf16_f32 v163, v198, v199
    buffer_load_dwordx4 v4, s[4:7], s31 offen offset:2048 lds
    v_cvt_pk_bf16_f32 v164, v200, v201
    v_cvt_pk_bf16_f32 v165, v202, v203
    v_cvt_pk_bf16_f32 v166, v204, v205
    v_cvt_pk_bf16_f32 v167, v206, v207
    v_cvt_pk_bf16_f32 v168, v208, v209
    v_cvt_pk_bf16_f32 v169, v210, v211
    v_cvt_pk_bf16_f32 v170, v212, v213
    v_cvt_pk_bf16_f32 v171, v214, v215
    v_cvt_pk_bf16_f32 v172, v216, v217
    v_cvt_pk_bf16_f32 v173, v218, v219
    v_cvt_pk_bf16_f32 v174, v220, v221
    v_cvt_pk_bf16_f32 v175, v222, v223
    buffer_load_dwordx4 v5, s[4:7], s31 offen offset:3072 lds
    v_cvt_pk_bf16_f32 v176, v224, v225
    v_cvt_pk_bf16_f32 v177, v226, v227
    v_cvt_pk_bf16_f32 v178, v228, v229
    v_cvt_pk_bf16_f32 v179, v230, v231
    v_cvt_pk_bf16_f32 v180, v232, v233
    v_cvt_pk_bf16_f32 v181, v234, v235
    v_cvt_pk_bf16_f32 v182, v236, v237
    v_cvt_pk_bf16_f32 v183, v238, v239
    v_cvt_pk_bf16_f32 v184, v240, v241
    v_cvt_pk_bf16_f32 v185, v242, v243
    v_cvt_pk_bf16_f32 v186, v244, v245
    v_cvt_pk_bf16_f32 v187, v246, v247
    v_cvt_pk_bf16_f32 v188, v248, v249
    v_cvt_pk_bf16_f32 v189, v250, v251
    v_cvt_pk_bf16_f32 v190, v252, v253
    v_cvt_pk_bf16_f32 v191, v254, v255
    s_lshl_b32 s38, s29, 20
    s_lshl_b32 s37, s30, 17
    s_add_u32 s38, s38, s37
    s_bfe_u32 s37, s28, 0x10001
    s_lshl_b32 s37, s37, 16
    s_add_u32 s38, s38, s37
    s_lshr_b32 s36, s28, 2
    s_lshl_b32 s37, s36, 15
    s_add_u32 s38, s38, s37
    s_and_b32 s37, s28, 1
    s_add_u32 s36, s36, 11
    s_lshl_b32 s37, s37, s36
    s_add_u32 s38, s38, s37
    s_cmp_lt_u32 s28, 4
    s_cselect_b32 s36, 4, 32
    s_cselect_b32 s37, 16, 64
    s_cselect_b32 s39, 32, 4
    s_lshl_b32 s36, s36, 8
    s_lshl_b32 s37, s37, 8
    s_lshl_b32 s39, s39, 8
    s_mov_b64 s[16:17], s[12:13]
    s_mov_b64 s[18:19], s[14:15]
    s_mov_b32 s46, s38
    s_add_u32 s47, s46, s39
    s_add_u32 s48, s47, s39
    s_add_u32 s49, s48, s39
    v_lshlrev_b32 v58, 4, v1
    v_add_u32 v59, s36, v58
    v_add_u32 v60, s37, v58
    v_add_u32 v61, s36, v60
    v_add_u32 v8, s33, v58
    s_waitcnt vmcnt(8)
    s_cmp_eq_u32 s30, 0
    s_cbranch_scc1 L_recurrent_scan__compressed_kv_cla__moe_arch_mod__prompt_kernel_rare_54
L_recurrent_scan__compressed_kv_cla__moe_arch_mod__prompt_kernel_back_55:
    s_waitcnt lgkmcnt(8)
    v_mfma_f32_16x16x32_bf16 v[192:195], v[64:67], v[24:27], 0
    ds_read_b64_tr_b16 v[88:89], v16 offset:0
    v_mfma_f32_16x16x32_bf16 v[224:227], v[64:67], v[28:31], 0
    ds_read_b64_tr_b16 v[90:91], v16 offset:1024
    buffer_load_dwordx4 v[96:99], v6, s[8:11], s32 offen offset:0 sc1
    v_mfma_f32_16x16x32_bf16 v[196:199], v[68:71], v[24:27], 0
    ds_read_b64_tr_b16 v[92:93], v17 offset:0
    v_mfma_f32_16x16x32_bf16 v[228:231], v[68:71], v[28:31], 0
    ds_read_b64_tr_b16 v[94:95], v17 offset:1024
    s_waitcnt lgkmcnt(8)
    v_mfma_f32_16x16x32_bf16 v[200:203], v[72:75], v[24:27], 0
    ds_read_b64_tr_b16 v[64:65], v10 offset:8192
    v_mfma_f32_16x16x32_bf16 v[232:235], v[72:75], v[28:31], 0
    ds_read_b64_tr_b16 v[66:67], v10 offset:9216
    buffer_load_dwordx4 v[100:103], v7, s[8:11], s32 offen offset:0 sc1
    v_mfma_f32_16x16x32_bf16 v[204:207], v[76:79], v[24:27], 0
    ds_read_b64_tr_b16 v[68:69], v11 offset:8192
    v_mfma_f32_16x16x32_bf16 v[236:239], v[76:79], v[28:31], 0
    ds_read_b64_tr_b16 v[70:71], v11 offset:9216
    s_waitcnt lgkmcnt(8)
    v_mfma_f32_16x16x32_bf16 v[208:211], v[80:83], v[24:27], 0
    ds_read_b64_tr_b16 v[72:73], v12 offset:8192
    v_mfma_f32_16x16x32_bf16 v[240:243], v[80:83], v[28:31], 0
    ds_read_b64_tr_b16 v[74:75], v12 offset:9216
    buffer_load_dwordx4 v[104:107], v6, s[8:11], s32 offen offset:1024 sc1
    v_mfma_f32_16x16x32_bf16 v[212:215], v[84:87], v[24:27], 0
    ds_read_b64_tr_b16 v[76:77], v13 offset:8192
    v_mfma_f32_16x16x32_bf16 v[244:247], v[84:87], v[28:31], 0
    ds_read_b64_tr_b16 v[78:79], v13 offset:9216
    s_waitcnt lgkmcnt(8)
    v_mfma_f32_16x16x32_bf16 v[216:219], v[88:91], v[24:27], 0
    ds_read_b64_tr_b16 v[80:81], v14 offset:8192
    v_mfma_f32_16x16x32_bf16 v[248:251], v[88:91], v[28:31], 0
    ds_read_b64_tr_b16 v[82:83], v14 offset:9216
    buffer_load_dwordx4 v[108:111], v7, s[8:11], s32 offen offset:1024 sc1
    v_mfma_f32_16x16x32_bf16 v[220:223], v[92:95], v[24:27], 0
    ds_read_b64_tr_b16 v[84:85], v15 offset:8192
    v_mfma_f32_16x16x32_bf16 v[252:255], v[92:95], v[28:31], 0
    ds_read_b64_tr_b16 v[86:87], v15 offset:9216
    s_waitcnt lgkmcnt(8)
    v_mfma_f32_16x16x32_bf16 v[192:195], v[64:67], v[32:35], v[192:195]
    ds_read_b64_tr_b16 v[88:89], v16 offset:8192
    v_mfma_f32_16x16x32_bf16 v[224:227], v[64:67], v[36:39], v[224:227]
    ds_read_b64_tr_b16 v[90:91], v16 offset:9216
    buffer_store_dwordx4 v[128:131], v58, s[16:19], s46 offen sc1
    v_mfma_f32_16x16x32_bf16 v[196:199], v[68:71], v[32:35], v[196:199]
    ds_read_b64_tr_b16 v[92:93], v17 offset:8192
    v_mfma_f32_16x16x32_bf16 v[228:231], v[68:71], v[36:39], v[228:231]
    ds_read_b64_tr_b16 v[94:95], v17 offset:9216
    s_waitcnt lgkmcnt(8)
    v_mfma_f32_16x16x32_bf16 v[200:203], v[72:75], v[32:35], v[200:203]
    ds_read_b64_tr_b16 v[64:65], v10 offset:16384
    v_mfma_f32_16x16x32_bf16 v[232:235], v[72:75], v[36:39], v[232:235]
    ds_read_b64_tr_b16 v[66:67], v10 offset:17408
    v_mfma_f32_16x16x32_bf16 v[204:207], v[76:79], v[32:35], v[204:207]
    ds_read_b64_tr_b16 v[68:69], v11 offset:16384
    v_mfma_f32_16x16x32_bf16 v[236:239], v[76:79], v[36:39], v[236:239]
    ds_read_b64_tr_b16 v[70:71], v11 offset:17408
    s_waitcnt lgkmcnt(8)
    v_mfma_f32_16x16x32_bf16 v[208:211], v[80:83], v[32:35], v[208:211]
    ds_read_b64_tr_b16 v[72:73], v12 offset:16384
    v_mfma_f32_16x16x32_bf16 v[240:243], v[80:83], v[36:39], v[240:243]
    ds_read_b64_tr_b16 v[74:75], v12 offset:17408
    v_mfma_f32_16x16x32_bf16 v[212:215], v[84:87], v[32:35], v[212:215]
    ds_read_b64_tr_b16 v[76:77], v13 offset:16384
    v_mfma_f32_16x16x32_bf16 v[244:247], v[84:87], v[36:39], v[244:247]
    ds_read_b64_tr_b16 v[78:79], v13 offset:17408
    s_waitcnt lgkmcnt(8)
    v_mfma_f32_16x16x32_bf16 v[216:219], v[88:91], v[32:35], v[216:219]
    ds_read_b64_tr_b16 v[80:81], v14 offset:16384
    buffer_load_dwordx4 v[112:115], v6, s[8:11], s32 offen offset:2048 sc1
    v_mfma_f32_16x16x32_bf16 v[248:251], v[88:91], v[36:39], v[248:251]
    ds_read_b64_tr_b16 v[82:83], v14 offset:17408
    v_mfma_f32_16x16x32_bf16 v[220:223], v[92:95], v[32:35], v[220:223]
    ds_read_b64_tr_b16 v[84:85], v15 offset:16384
    v_mfma_f32_16x16x32_bf16 v[252:255], v[92:95], v[36:39], v[252:255]
    ds_read_b64_tr_b16 v[86:87], v15 offset:17408
    s_waitcnt lgkmcnt(8)
    s_waitcnt vmcnt(12)
    v_mfma_f32_16x16x32_bf16 v[192:195], v[64:67], v[40:43], v[192:195]
    ds_read_b64_tr_b16 v[88:89], v16 offset:16384
    buffer_load_dwordx4 v[116:119], v7, s[8:11], s32 offen offset:2048 sc1
    v_mfma_f32_16x16x32_bf16 v[224:227], v[64:67], v[44:47], v[224:227]
    ds_read_b64_tr_b16 v[90:91], v16 offset:17408
    v_mfma_f32_16x16x32_bf16 v[196:199], v[68:71], v[40:43], v[196:199]
    ds_read_b64_tr_b16 v[92:93], v17 offset:16384
    v_mfma_f32_16x16x32_bf16 v[228:231], v[68:71], v[44:47], v[228:231]
    ds_read_b64_tr_b16 v[94:95], v17 offset:17408
    s_waitcnt lgkmcnt(8)
    v_mfma_f32_16x16x32_bf16 v[200:203], v[72:75], v[40:43], v[200:203]
    ds_read_b64_tr_b16 v[64:65], v10 offset:24576
    v_mfma_f32_16x16x32_bf16 v[232:235], v[72:75], v[44:47], v[232:235]
    ds_read_b64_tr_b16 v[66:67], v10 offset:25600
    buffer_load_dwordx4 v[120:123], v6, s[8:11], s32 offen offset:3072 sc1
    v_mfma_f32_16x16x32_bf16 v[204:207], v[76:79], v[40:43], v[204:207]
    ds_read_b64_tr_b16 v[68:69], v11 offset:24576
    v_mfma_f32_16x16x32_bf16 v[236:239], v[76:79], v[44:47], v[236:239]
    ds_read_b64_tr_b16 v[70:71], v11 offset:25600
    s_waitcnt lgkmcnt(8)
    v_mfma_f32_16x16x32_bf16 v[208:211], v[80:83], v[40:43], v[208:211]
    ds_read_b64_tr_b16 v[72:73], v12 offset:24576
    v_mfma_f32_16x16x32_bf16 v[240:243], v[80:83], v[44:47], v[240:243]
    ds_read_b64_tr_b16 v[74:75], v12 offset:25600
    buffer_load_dwordx4 v[124:127], v7, s[8:11], s32 offen offset:3072 sc1
    v_mfma_f32_16x16x32_bf16 v[212:215], v[84:87], v[40:43], v[212:215]
    ds_read_b64_tr_b16 v[76:77], v13 offset:24576
    v_mfma_f32_16x16x32_bf16 v[244:247], v[84:87], v[44:47], v[244:247]
    ds_read_b64_tr_b16 v[78:79], v13 offset:25600
    s_waitcnt lgkmcnt(8)
    v_mfma_f32_16x16x32_bf16 v[216:219], v[88:91], v[40:43], v[216:219]
    ds_read_b64_tr_b16 v[80:81], v14 offset:24576
    v_mfma_f32_16x16x32_bf16 v[248:251], v[88:91], v[44:47], v[248:251]
    ds_read_b64_tr_b16 v[82:83], v14 offset:25600
    buffer_store_dwordx4 v[132:135], v59, s[16:19], s46 offen sc1
    v_mfma_f32_16x16x32_bf16 v[220:223], v[92:95], v[40:43], v[220:223]
    ds_read_b64_tr_b16 v[84:85], v15 offset:24576
    v_mfma_f32_16x16x32_bf16 v[252:255], v[92:95], v[44:47], v[252:255]
    ds_read_b64_tr_b16 v[86:87], v15 offset:25600
    s_waitcnt lgkmcnt(8)
    s_waitcnt vmcnt(14)
    v_mfma_f32_16x16x32_bf16 v[192:195], v[64:67], v[48:51], v[192:195]
    ds_read_b64_tr_b16 v[88:89], v16 offset:24576
    v_mfma_f32_16x16x32_bf16 v[224:227], v[64:67], v[52:55], v[224:227]
    ds_read_b64_tr_b16 v[90:91], v16 offset:25600
    v_mfma_f32_16x16x32_bf16 v[196:199], v[68:71], v[48:51], v[196:199]
    ds_read_b64_tr_b16 v[92:93], v17 offset:24576
    v_mfma_f32_16x16x32_bf16 v[228:231], v[68:71], v[52:55], v[228:231]
    ds_read_b64_tr_b16 v[94:95], v17 offset:25600
    s_waitcnt vmcnt(10)
    s_barrier
    s_waitcnt lgkmcnt(8)
    v_mfma_f32_16x16x32_bf16 v[200:203], v[72:75], v[48:51], v[200:203]
    ds_read_b64_tr_b16 v[64:65], v10 offset:32768
    v_mfma_f32_16x16x32_bf16 v[232:235], v[72:75], v[52:55], v[232:235]
    ds_read_b64_tr_b16 v[66:67], v10 offset:33792
    v_mfma_f32_16x16x32_bf16 v[204:207], v[76:79], v[48:51], v[204:207]
    ds_read_b64_tr_b16 v[68:69], v11 offset:32768
    v_mfma_f32_16x16x32_bf16 v[236:239], v[76:79], v[52:55], v[236:239]
    ds_read_b64_tr_b16 v[70:71], v11 offset:33792
    s_waitcnt lgkmcnt(8)
    v_mfma_f32_16x16x32_bf16 v[208:211], v[80:83], v[48:51], v[208:211]
    ds_read_b64_tr_b16 v[72:73], v12 offset:32768
    s_mov_b32 s32, 8192
    buffer_load_dwordx4 v[24:27], v6, s[8:11], s32 offen offset:0 sc1
    v_mfma_f32_16x16x32_bf16 v[240:243], v[80:83], v[52:55], v[240:243]
    ds_read_b64_tr_b16 v[74:75], v12 offset:33792
    v_mfma_f32_16x16x32_bf16 v[212:215], v[84:87], v[48:51], v[212:215]
    ds_read_b64_tr_b16 v[76:77], v13 offset:32768
    v_mfma_f32_16x16x32_bf16 v[244:247], v[84:87], v[52:55], v[244:247]
    ds_read_b64_tr_b16 v[78:79], v13 offset:33792
    s_waitcnt lgkmcnt(8)
    v_mfma_f32_16x16x32_bf16 v[216:219], v[88:91], v[48:51], v[216:219]
    ds_read_b64_tr_b16 v[80:81], v14 offset:32768
    buffer_load_dwordx4 v[28:31], v7, s[8:11], s32 offen offset:0 sc1
    v_mfma_f32_16x16x32_bf16 v[248:251], v[88:91], v[52:55], v[248:251]
    ds_read_b64_tr_b16 v[82:83], v14 offset:33792
    v_mfma_f32_16x16x32_bf16 v[220:223], v[92:95], v[48:51], v[220:223]
    ds_read_b64_tr_b16 v[84:85], v15 offset:32768
    v_mfma_f32_16x16x32_bf16 v[252:255], v[92:95], v[52:55], v[252:255]
    ds_read_b64_tr_b16 v[86:87], v15 offset:33792
    s_waitcnt lgkmcnt(8)
    s_waitcnt vmcnt(10)
    v_mfma_f32_16x16x32_bf16 v[192:195], v[64:67], v[96:99], v[192:195]
    ds_read_b64_tr_b16 v[88:89], v16 offset:32768
    buffer_load_dwordx4 v[32:35], v6, s[8:11], s32 offen offset:1024 sc1
    v_mfma_f32_16x16x32_bf16 v[224:227], v[64:67], v[100:103], v[224:227]
    ds_read_b64_tr_b16 v[90:91], v16 offset:33792
    v_mfma_f32_16x16x32_bf16 v[196:199], v[68:71], v[96:99], v[196:199]
    ds_read_b64_tr_b16 v[92:93], v17 offset:32768
    v_mfma_f32_16x16x32_bf16 v[228:231], v[68:71], v[100:103], v[228:231]
    ds_read_b64_tr_b16 v[94:95], v17 offset:33792
    s_waitcnt lgkmcnt(8)
    v_mfma_f32_16x16x32_bf16 v[200:203], v[72:75], v[96:99], v[200:203]
    ds_read_b64_tr_b16 v[64:65], v10 offset:40960
    buffer_load_dwordx4 v[36:39], v7, s[8:11], s32 offen offset:1024 sc1
    v_mfma_f32_16x16x32_bf16 v[232:235], v[72:75], v[100:103], v[232:235]
    ds_read_b64_tr_b16 v[66:67], v10 offset:41984
    v_mfma_f32_16x16x32_bf16 v[204:207], v[76:79], v[96:99], v[204:207]
    ds_read_b64_tr_b16 v[68:69], v11 offset:40960
    v_mfma_f32_16x16x32_bf16 v[236:239], v[76:79], v[100:103], v[236:239]
    ds_read_b64_tr_b16 v[70:71], v11 offset:41984
    s_waitcnt lgkmcnt(8)
    v_mfma_f32_16x16x32_bf16 v[208:211], v[80:83], v[96:99], v[208:211]
    ds_read_b64_tr_b16 v[72:73], v12 offset:40960
    v_mfma_f32_16x16x32_bf16 v[240:243], v[80:83], v[100:103], v[240:243]
    ds_read_b64_tr_b16 v[74:75], v12 offset:41984
    buffer_store_dwordx4 v[136:139], v60, s[16:19], s46 offen sc1
    v_mfma_f32_16x16x32_bf16 v[212:215], v[84:87], v[96:99], v[212:215]
    ds_read_b64_tr_b16 v[76:77], v13 offset:40960
    v_mfma_f32_16x16x32_bf16 v[244:247], v[84:87], v[100:103], v[244:247]
    ds_read_b64_tr_b16 v[78:79], v13 offset:41984
    s_waitcnt lgkmcnt(8)
    v_mfma_f32_16x16x32_bf16 v[216:219], v[88:91], v[96:99], v[216:219]
    ds_read_b64_tr_b16 v[80:81], v14 offset:40960
    v_mfma_f32_16x16x32_bf16 v[248:251], v[88:91], v[100:103], v[248:251]
    ds_read_b64_tr_b16 v[82:83], v14 offset:41984
    v_mfma_f32_16x16x32_bf16 v[220:223], v[92:95], v[96:99], v[220:223]
    ds_read_b64_tr_b16 v[84:85], v15 offset:40960
    v_mfma_f32_16x16x32_bf16 v[252:255], v[92:95], v[100:103], v[252:255]
    ds_read_b64_tr_b16 v[86:87], v15 offset:41984
    s_waitcnt lgkmcnt(8)
    s_waitcnt vmcnt(11)
    v_mfma_f32_16x16x32_bf16 v[192:195], v[64:67], v[104:107], v[192:195]
    ds_read_b64_tr_b16 v[88:89], v16 offset:40960
    v_mfma_f32_16x16x32_bf16 v[224:227], v[64:67], v[108:111], v[224:227]
    ds_read_b64_tr_b16 v[90:91], v16 offset:41984
    v_mfma_f32_16x16x32_bf16 v[196:199], v[68:71], v[104:107], v[196:199]
    ds_read_b64_tr_b16 v[92:93], v17 offset:40960
    v_mfma_f32_16x16x32_bf16 v[228:231], v[68:71], v[108:111], v[228:231]
    ds_read_b64_tr_b16 v[94:95], v17 offset:41984
    s_waitcnt lgkmcnt(8)
    v_mfma_f32_16x16x32_bf16 v[200:203], v[72:75], v[104:107], v[200:203]
    ds_read_b64_tr_b16 v[64:65], v10 offset:49152
    buffer_load_dwordx4 v[40:43], v6, s[8:11], s32 offen offset:2048 sc1
    v_mfma_f32_16x16x32_bf16 v[232:235], v[72:75], v[108:111], v[232:235]
    ds_read_b64_tr_b16 v[66:67], v10 offset:50176
    v_mfma_f32_16x16x32_bf16 v[204:207], v[76:79], v[104:107], v[204:207]
    ds_read_b64_tr_b16 v[68:69], v11 offset:49152
    v_mfma_f32_16x16x32_bf16 v[236:239], v[76:79], v[108:111], v[236:239]
    ds_read_b64_tr_b16 v[70:71], v11 offset:50176
    s_waitcnt lgkmcnt(8)
    v_mfma_f32_16x16x32_bf16 v[208:211], v[80:83], v[104:107], v[208:211]
    ds_read_b64_tr_b16 v[72:73], v12 offset:49152
    buffer_load_dwordx4 v[44:47], v7, s[8:11], s32 offen offset:2048 sc1
    v_mfma_f32_16x16x32_bf16 v[240:243], v[80:83], v[108:111], v[240:243]
    ds_read_b64_tr_b16 v[74:75], v12 offset:50176
    v_mfma_f32_16x16x32_bf16 v[212:215], v[84:87], v[104:107], v[212:215]
    ds_read_b64_tr_b16 v[76:77], v13 offset:49152
    v_mfma_f32_16x16x32_bf16 v[244:247], v[84:87], v[108:111], v[244:247]
    ds_read_b64_tr_b16 v[78:79], v13 offset:50176
    s_waitcnt lgkmcnt(8)
    v_mfma_f32_16x16x32_bf16 v[216:219], v[88:91], v[104:107], v[216:219]
    ds_read_b64_tr_b16 v[80:81], v14 offset:49152
    buffer_store_dwordx4 v[140:143], v61, s[16:19], s46 offen sc1
    v_mfma_f32_16x16x32_bf16 v[248:251], v[88:91], v[108:111], v[248:251]
    ds_read_b64_tr_b16 v[82:83], v14 offset:50176
    v_mfma_f32_16x16x32_bf16 v[220:223], v[92:95], v[104:107], v[220:223]
    ds_read_b64_tr_b16 v[84:85], v15 offset:49152
    v_mfma_f32_16x16x32_bf16 v[252:255], v[92:95], v[108:111], v[252:255]
    ds_read_b64_tr_b16 v[86:87], v15 offset:50176
    s_waitcnt lgkmcnt(8)
    s_waitcnt vmcnt(11)
    v_mfma_f32_16x16x32_bf16 v[192:195], v[64:67], v[112:115], v[192:195]
    ds_read_b64_tr_b16 v[88:89], v16 offset:49152
    v_mfma_f32_16x16x32_bf16 v[224:227], v[64:67], v[116:119], v[224:227]
    ds_read_b64_tr_b16 v[90:91], v16 offset:50176
    v_mfma_f32_16x16x32_bf16 v[196:199], v[68:71], v[112:115], v[196:199]
    ds_read_b64_tr_b16 v[92:93], v17 offset:49152
    v_mfma_f32_16x16x32_bf16 v[228:231], v[68:71], v[116:119], v[228:231]
    ds_read_b64_tr_b16 v[94:95], v17 offset:50176
    s_waitcnt lgkmcnt(8)
    v_mfma_f32_16x16x32_bf16 v[200:203], v[72:75], v[112:115], v[200:203]
    ds_read_b64_tr_b16 v[64:65], v10 offset:57344
    v_mfma_f32_16x16x32_bf16 v[232:235], v[72:75], v[116:119], v[232:235]
    ds_read_b64_tr_b16 v[66:67], v10 offset:58368
    v_add_u32 v10, 98304, v10
    v_mfma_f32_16x16x32_bf16 v[204:207], v[76:79], v[112:115], v[204:207]
    ds_read_b64_tr_b16 v[68:69], v11 offset:57344
    v_mfma_f32_16x16x32_bf16 v[236:239], v[76:79], v[116:119], v[236:239]
    ds_read_b64_tr_b16 v[70:71], v11 offset:58368
    v_add_u32 v11, 98304, v11
    buffer_load_dwordx4 v[48:51], v6, s[8:11], s32 offen offset:3072 sc1
    s_waitcnt lgkmcnt(8)
    v_mfma_f32_16x16x32_bf16 v[208:211], v[80:83], v[112:115], v[208:211]
    ds_read_b64_tr_b16 v[72:73], v12 offset:57344
    v_mfma_f32_16x16x32_bf16 v[240:243], v[80:83], v[116:119], v[240:243]
    ds_read_b64_tr_b16 v[74:75], v12 offset:58368
    v_add_u32 v12, 98304, v12
    v_mfma_f32_16x16x32_bf16 v[212:215], v[84:87], v[112:115], v[212:215]
    ds_read_b64_tr_b16 v[76:77], v13 offset:57344
    v_mfma_f32_16x16x32_bf16 v[244:247], v[84:87], v[116:119], v[244:247]
    ds_read_b64_tr_b16 v[78:79], v13 offset:58368
    v_add_u32 v13, 98304, v13
    buffer_load_dwordx4 v[52:55], v7, s[8:11], s32 offen offset:3072 sc1
    s_waitcnt lgkmcnt(8)
    v_mfma_f32_16x16x32_bf16 v[216:219], v[88:91], v[112:115], v[216:219]
    ds_read_b64_tr_b16 v[80:81], v14 offset:57344
    v_mfma_f32_16x16x32_bf16 v[248:251], v[88:91], v[116:119], v[248:251]
    ds_read_b64_tr_b16 v[82:83], v14 offset:58368
    v_add_u32 v14, 98304, v14
    v_mfma_f32_16x16x32_bf16 v[220:223], v[92:95], v[112:115], v[220:223]
    ds_read_b64_tr_b16 v[84:85], v15 offset:57344
    v_mfma_f32_16x16x32_bf16 v[252:255], v[92:95], v[116:119], v[252:255]
    ds_read_b64_tr_b16 v[86:87], v15 offset:58368
    v_add_u32 v15, 98304, v15
    s_mov_b32 s32, 12288
    buffer_load_dwordx4 v[96:99], v6, s[8:11], s32 offen offset:0 sc1
    s_waitcnt lgkmcnt(8)
    s_waitcnt vmcnt(12)
    v_mfma_f32_16x16x32_bf16 v[192:195], v[64:67], v[120:123], v[192:195]
    ds_read_b64_tr_b16 v[88:89], v16 offset:57344
    v_mfma_f32_16x16x32_bf16 v[224:227], v[64:67], v[124:127], v[224:227]
    ds_read_b64_tr_b16 v[90:91], v16 offset:58368
    v_add_u32 v16, 98304, v16
    v_mfma_f32_16x16x32_bf16 v[196:199], v[68:71], v[120:123], v[196:199]
    ds_read_b64_tr_b16 v[92:93], v17 offset:57344
    v_mfma_f32_16x16x32_bf16 v[228:231], v[68:71], v[124:127], v[228:231]
    ds_read_b64_tr_b16 v[94:95], v17 offset:58368
    v_add_u32 v17, 98304, v17
    buffer_load_dwordx4 v[100:103], v7, s[8:11], s32 offen offset:0 sc1
    s_barrier
    s_waitcnt lgkmcnt(8)
    v_mfma_f32_16x16x32_bf16 v[200:203], v[72:75], v[120:123], v[200:203]
    ds_read_b64_tr_b16 v[64:65], v10 offset:32768
    v_mfma_f32_16x16x32_bf16 v[232:235], v[72:75], v[124:127], v[232:235]
    ds_read_b64_tr_b16 v[66:67], v10 offset:33792
    v_mfma_f32_16x16x32_bf16 v[204:207], v[76:79], v[120:123], v[204:207]
    ds_read_b64_tr_b16 v[68:69], v11 offset:32768
    v_mfma_f32_16x16x32_bf16 v[236:239], v[76:79], v[124:127], v[236:239]
    ds_read_b64_tr_b16 v[70:71], v11 offset:33792
    s_waitcnt lgkmcnt(8)
    v_mfma_f32_16x16x32_bf16 v[208:211], v[80:83], v[120:123], v[208:211]
    ds_read_b64_tr_b16 v[72:73], v12 offset:32768
    buffer_store_dwordx4 v[144:147], v58, s[16:19], s47 offen sc1
    v_mfma_f32_16x16x32_bf16 v[240:243], v[80:83], v[124:127], v[240:243]
    ds_read_b64_tr_b16 v[74:75], v12 offset:33792
    v_mfma_f32_16x16x32_bf16 v[212:215], v[84:87], v[120:123], v[212:215]
    ds_read_b64_tr_b16 v[76:77], v13 offset:32768
    v_mfma_f32_16x16x32_bf16 v[244:247], v[84:87], v[124:127], v[244:247]
    ds_read_b64_tr_b16 v[78:79], v13 offset:33792
    s_waitcnt lgkmcnt(8)
    v_mfma_f32_16x16x32_bf16 v[216:219], v[88:91], v[120:123], v[216:219]
    ds_read_b64_tr_b16 v[80:81], v14 offset:32768
    v_mfma_f32_16x16x32_bf16 v[248:251], v[88:91], v[124:127], v[248:251]
    ds_read_b64_tr_b16 v[82:83], v14 offset:33792
    v_mfma_f32_16x16x32_bf16 v[220:223], v[92:95], v[120:123], v[220:223]
    ds_read_b64_tr_b16 v[84:85], v15 offset:32768
    v_mfma_f32_16x16x32_bf16 v[252:255], v[92:95], v[124:127], v[252:255]
    ds_read_b64_tr_b16 v[86:87], v15 offset:33792
    s_waitcnt lgkmcnt(8)
    s_waitcnt vmcnt(11)
    v_mfma_f32_16x16x32_bf16 v[192:195], v[64:67], v[24:27], v[192:195]
    ds_read_b64_tr_b16 v[88:89], v16 offset:32768
    v_mfma_f32_16x16x32_bf16 v[224:227], v[64:67], v[28:31], v[224:227]
    ds_read_b64_tr_b16 v[90:91], v16 offset:33792
    v_mfma_f32_16x16x32_bf16 v[196:199], v[68:71], v[24:27], v[196:199]
    ds_read_b64_tr_b16 v[92:93], v17 offset:32768
    v_mfma_f32_16x16x32_bf16 v[228:231], v[68:71], v[28:31], v[228:231]
    ds_read_b64_tr_b16 v[94:95], v17 offset:33792
    buffer_load_dwordx4 v[104:107], v6, s[8:11], s32 offen offset:1024 sc1
    s_waitcnt lgkmcnt(8)
    v_mfma_f32_16x16x32_bf16 v[200:203], v[72:75], v[24:27], v[200:203]
    ds_read_b64_tr_b16 v[64:65], v10 offset:40960
    v_mfma_f32_16x16x32_bf16 v[232:235], v[72:75], v[28:31], v[232:235]
    ds_read_b64_tr_b16 v[66:67], v10 offset:41984
    v_mfma_f32_16x16x32_bf16 v[204:207], v[76:79], v[24:27], v[204:207]
    ds_read_b64_tr_b16 v[68:69], v11 offset:40960
    v_mfma_f32_16x16x32_bf16 v[236:239], v[76:79], v[28:31], v[236:239]
    ds_read_b64_tr_b16 v[70:71], v11 offset:41984
    buffer_load_dwordx4 v[108:111], v7, s[8:11], s32 offen offset:1024 sc1
    s_waitcnt lgkmcnt(8)
    v_mfma_f32_16x16x32_bf16 v[208:211], v[80:83], v[24:27], v[208:211]
    ds_read_b64_tr_b16 v[72:73], v12 offset:40960
    v_mfma_f32_16x16x32_bf16 v[240:243], v[80:83], v[28:31], v[240:243]
    ds_read_b64_tr_b16 v[74:75], v12 offset:41984
    v_mfma_f32_16x16x32_bf16 v[212:215], v[84:87], v[24:27], v[212:215]
    ds_read_b64_tr_b16 v[76:77], v13 offset:40960
    v_mfma_f32_16x16x32_bf16 v[244:247], v[84:87], v[28:31], v[244:247]
    ds_read_b64_tr_b16 v[78:79], v13 offset:41984
    s_add_u32 m0, s33, 98304
    s_mov_b32 s31, 4194304
    buffer_load_dwordx4 v2, s[4:7], s31 offen offset:0 lds
    s_waitcnt lgkmcnt(8)
    v_mfma_f32_16x16x32_bf16 v[216:219], v[88:91], v[24:27], v[216:219]
    ds_read_b64_tr_b16 v[80:81], v14 offset:40960
    v_mfma_f32_16x16x32_bf16 v[248:251], v[88:91], v[28:31], v[248:251]
    ds_read_b64_tr_b16 v[82:83], v14 offset:41984
    v_mfma_f32_16x16x32_bf16 v[220:223], v[92:95], v[24:27], v[220:223]
    ds_read_b64_tr_b16 v[84:85], v15 offset:40960
    buffer_load_dwordx4 v[112:115], v6, s[8:11], s32 offen offset:2048 sc1
    v_mfma_f32_16x16x32_bf16 v[252:255], v[92:95], v[28:31], v[252:255]
    ds_read_b64_tr_b16 v[86:87], v15 offset:41984
    s_waitcnt lgkmcnt(8)
    s_waitcnt vmcnt(13)
    v_mfma_f32_16x16x32_bf16 v[192:195], v[64:67], v[32:35], v[192:195]
    ds_read_b64_tr_b16 v[88:89], v16 offset:40960
    v_mfma_f32_16x16x32_bf16 v[224:227], v[64:67], v[36:39], v[224:227]
    ds_read_b64_tr_b16 v[90:91], v16 offset:41984
    v_mfma_f32_16x16x32_bf16 v[196:199], v[68:71], v[32:35], v[196:199]
    ds_read_b64_tr_b16 v[92:93], v17 offset:40960
    v_mfma_f32_16x16x32_bf16 v[228:231], v[68:71], v[36:39], v[228:231]
    ds_read_b64_tr_b16 v[94:95], v17 offset:41984
    buffer_load_dwordx4 v[116:119], v7, s[8:11], s32 offen offset:2048 sc1
    s_waitcnt lgkmcnt(8)
    v_mfma_f32_16x16x32_bf16 v[200:203], v[72:75], v[32:35], v[200:203]
    ds_read_b64_tr_b16 v[64:65], v10 offset:49152
    v_mfma_f32_16x16x32_bf16 v[232:235], v[72:75], v[36:39], v[232:235]
    ds_read_b64_tr_b16 v[66:67], v10 offset:50176
    v_mfma_f32_16x16x32_bf16 v[204:207], v[76:79], v[32:35], v[204:207]
    ds_read_b64_tr_b16 v[68:69], v11 offset:49152
    v_mfma_f32_16x16x32_bf16 v[236:239], v[76:79], v[36:39], v[236:239]
    ds_read_b64_tr_b16 v[70:71], v11 offset:50176
    buffer_load_dwordx4 v3, s[4:7], s31 offen offset:1024 lds
    s_waitcnt lgkmcnt(8)
    v_mfma_f32_16x16x32_bf16 v[208:211], v[80:83], v[32:35], v[208:211]
    ds_read_b64_tr_b16 v[72:73], v12 offset:49152
    v_mfma_f32_16x16x32_bf16 v[240:243], v[80:83], v[36:39], v[240:243]
    ds_read_b64_tr_b16 v[74:75], v12 offset:50176
    v_mfma_f32_16x16x32_bf16 v[212:215], v[84:87], v[32:35], v[212:215]
    ds_read_b64_tr_b16 v[76:77], v13 offset:49152
    buffer_store_dwordx4 v[148:151], v59, s[16:19], s47 offen sc1
    v_mfma_f32_16x16x32_bf16 v[244:247], v[84:87], v[36:39], v[244:247]
    ds_read_b64_tr_b16 v[78:79], v13 offset:50176
    s_waitcnt lgkmcnt(8)
    v_mfma_f32_16x16x32_bf16 v[216:219], v[88:91], v[32:35], v[216:219]
    ds_read_b64_tr_b16 v[80:81], v14 offset:49152
    v_mfma_f32_16x16x32_bf16 v[248:251], v[88:91], v[36:39], v[248:251]
    ds_read_b64_tr_b16 v[82:83], v14 offset:50176
    v_mfma_f32_16x16x32_bf16 v[220:223], v[92:95], v[32:35], v[220:223]
    ds_read_b64_tr_b16 v[84:85], v15 offset:49152
    v_mfma_f32_16x16x32_bf16 v[252:255], v[92:95], v[36:39], v[252:255]
    ds_read_b64_tr_b16 v[86:87], v15 offset:50176
    s_waitcnt lgkmcnt(8)
    s_waitcnt vmcnt(13)
    v_mfma_f32_16x16x32_bf16 v[192:195], v[64:67], v[40:43], v[192:195]
    ds_read_b64_tr_b16 v[88:89], v16 offset:49152
    v_mfma_f32_16x16x32_bf16 v[224:227], v[64:67], v[44:47], v[224:227]
    ds_read_b64_tr_b16 v[90:91], v16 offset:50176
    v_mfma_f32_16x16x32_bf16 v[196:199], v[68:71], v[40:43], v[196:199]
    ds_read_b64_tr_b16 v[92:93], v17 offset:49152
    v_mfma_f32_16x16x32_bf16 v[228:231], v[68:71], v[44:47], v[228:231]
    ds_read_b64_tr_b16 v[94:95], v17 offset:50176
    s_waitcnt lgkmcnt(8)
    v_mfma_f32_16x16x32_bf16 v[200:203], v[72:75], v[40:43], v[200:203]
    ds_read_b64_tr_b16 v[64:65], v10 offset:57344
    v_mfma_f32_16x16x32_bf16 v[232:235], v[72:75], v[44:47], v[232:235]
    ds_read_b64_tr_b16 v[66:67], v10 offset:58368
    v_add_u32 v10, 4294934528, v10
    buffer_load_dwordx4 v4, s[4:7], s31 offen offset:2048 lds
    v_mfma_f32_16x16x32_bf16 v[204:207], v[76:79], v[40:43], v[204:207]
    ds_read_b64_tr_b16 v[68:69], v11 offset:57344
    v_mfma_f32_16x16x32_bf16 v[236:239], v[76:79], v[44:47], v[236:239]
    ds_read_b64_tr_b16 v[70:71], v11 offset:58368
    v_add_u32 v11, 4294934528, v11
    s_waitcnt lgkmcnt(8)
    v_mfma_f32_16x16x32_bf16 v[208:211], v[80:83], v[40:43], v[208:211]
    ds_read_b64_tr_b16 v[72:73], v12 offset:57344
    v_mfma_f32_16x16x32_bf16 v[240:243], v[80:83], v[44:47], v[240:243]
    ds_read_b64_tr_b16 v[74:75], v12 offset:58368
    v_add_u32 v12, 4294934528, v12
    buffer_load_dwordx4 v[120:123], v6, s[8:11], s32 offen offset:3072 sc1
    v_mfma_f32_16x16x32_bf16 v[212:215], v[84:87], v[40:43], v[212:215]
    ds_read_b64_tr_b16 v[76:77], v13 offset:57344
    v_mfma_f32_16x16x32_bf16 v[244:247], v[84:87], v[44:47], v[244:247]
    ds_read_b64_tr_b16 v[78:79], v13 offset:58368
    v_add_u32 v13, 4294934528, v13
    s_waitcnt lgkmcnt(8)
    v_mfma_f32_16x16x32_bf16 v[216:219], v[88:91], v[40:43], v[216:219]
    ds_read_b64_tr_b16 v[80:81], v14 offset:57344
    v_mfma_f32_16x16x32_bf16 v[248:251], v[88:91], v[44:47], v[248:251]
    ds_read_b64_tr_b16 v[82:83], v14 offset:58368
    v_add_u32 v14, 4294934528, v14
    buffer_load_dwordx4 v[124:127], v7, s[8:11], s32 offen offset:3072 sc1
    v_mfma_f32_16x16x32_bf16 v[220:223], v[92:95], v[40:43], v[220:223]
    ds_read_b64_tr_b16 v[84:85], v15 offset:57344
    v_mfma_f32_16x16x32_bf16 v[252:255], v[92:95], v[44:47], v[252:255]
    ds_read_b64_tr_b16 v[86:87], v15 offset:58368
    v_add_u32 v15, 4294934528, v15
    s_waitcnt lgkmcnt(8)
    s_waitcnt vmcnt(13)
    v_mfma_f32_16x16x32_bf16 v[192:195], v[64:67], v[48:51], v[192:195]
    ds_read_b64_tr_b16 v[88:89], v16 offset:57344
    v_mfma_f32_16x16x32_bf16 v[224:227], v[64:67], v[52:55], v[224:227]
    ds_read_b64_tr_b16 v[90:91], v16 offset:58368
    v_add_u32 v16, 4294934528, v16
    buffer_load_dwordx4 v5, s[4:7], s31 offen offset:3072 lds
    v_mfma_f32_16x16x32_bf16 v[196:199], v[68:71], v[48:51], v[196:199]
    ds_read_b64_tr_b16 v[92:93], v17 offset:57344
    v_mfma_f32_16x16x32_bf16 v[228:231], v[68:71], v[52:55], v[228:231]
    ds_read_b64_tr_b16 v[94:95], v17 offset:58368
    v_add_u32 v17, 4294934528, v17
    s_barrier
    s_waitcnt lgkmcnt(8)
    v_mfma_f32_16x16x32_bf16 v[200:203], v[72:75], v[48:51], v[200:203]
    ds_read_b64_tr_b16 v[64:65], v10 offset:0
    v_mfma_f32_16x16x32_bf16 v[232:235], v[72:75], v[52:55], v[232:235]
    ds_read_b64_tr_b16 v[66:67], v10 offset:1024
    s_mov_b32 s32, 16384
    buffer_load_dwordx4 v[24:27], v6, s[8:11], s32 offen offset:0 sc1
    v_mfma_f32_16x16x32_bf16 v[204:207], v[76:79], v[48:51], v[204:207]
    ds_read_b64_tr_b16 v[68:69], v11 offset:0
    v_mfma_f32_16x16x32_bf16 v[236:239], v[76:79], v[52:55], v[236:239]
    ds_read_b64_tr_b16 v[70:71], v11 offset:1024
    s_waitcnt lgkmcnt(8)
    v_mfma_f32_16x16x32_bf16 v[208:211], v[80:83], v[48:51], v[208:211]
    ds_read_b64_tr_b16 v[72:73], v12 offset:0
    v_mfma_f32_16x16x32_bf16 v[240:243], v[80:83], v[52:55], v[240:243]
    ds_read_b64_tr_b16 v[74:75], v12 offset:1024
    buffer_load_dwordx4 v[28:31], v7, s[8:11], s32 offen offset:0 sc1
    v_mfma_f32_16x16x32_bf16 v[212:215], v[84:87], v[48:51], v[212:215]
    ds_read_b64_tr_b16 v[76:77], v13 offset:0
    v_mfma_f32_16x16x32_bf16 v[244:247], v[84:87], v[52:55], v[244:247]
    ds_read_b64_tr_b16 v[78:79], v13 offset:1024
    s_waitcnt lgkmcnt(8)
    v_mfma_f32_16x16x32_bf16 v[216:219], v[88:91], v[48:51], v[216:219]
    ds_read_b64_tr_b16 v[80:81], v14 offset:0
    v_mfma_f32_16x16x32_bf16 v[248:251], v[88:91], v[52:55], v[248:251]
    ds_read_b64_tr_b16 v[82:83], v14 offset:1024
    buffer_store_dwordx4 v[152:155], v60, s[16:19], s47 offen sc1
    v_mfma_f32_16x16x32_bf16 v[220:223], v[92:95], v[48:51], v[220:223]
    ds_read_b64_tr_b16 v[84:85], v15 offset:0
    v_mfma_f32_16x16x32_bf16 v[252:255], v[92:95], v[52:55], v[252:255]
    ds_read_b64_tr_b16 v[86:87], v15 offset:1024
    s_waitcnt lgkmcnt(8)
    s_waitcnt vmcnt(15)
    v_mfma_f32_16x16x32_bf16 v[192:195], v[64:67], v[96:99], v[192:195]
    ds_read_b64_tr_b16 v[88:89], v16 offset:0
    v_mfma_f32_16x16x32_bf16 v[224:227], v[64:67], v[100:103], v[224:227]
    ds_read_b64_tr_b16 v[90:91], v16 offset:1024
    v_mfma_f32_16x16x32_bf16 v[196:199], v[68:71], v[96:99], v[196:199]
    ds_read_b64_tr_b16 v[92:93], v17 offset:0
    v_mfma_f32_16x16x32_bf16 v[228:231], v[68:71], v[100:103], v[228:231]
    ds_read_b64_tr_b16 v[94:95], v17 offset:1024
    s_waitcnt lgkmcnt(8)
    v_mfma_f32_16x16x32_bf16 v[200:203], v[72:75], v[96:99], v[200:203]
    ds_read_b64_tr_b16 v[64:65], v10 offset:8192
    v_mfma_f32_16x16x32_bf16 v[232:235], v[72:75], v[100:103], v[232:235]
    ds_read_b64_tr_b16 v[66:67], v10 offset:9216
    v_mfma_f32_16x16x32_bf16 v[204:207], v[76:79], v[96:99], v[204:207]
    ds_read_b64_tr_b16 v[68:69], v11 offset:8192
    v_mfma_f32_16x16x32_bf16 v[236:239], v[76:79], v[100:103], v[236:239]
    ds_read_b64_tr_b16 v[70:71], v11 offset:9216
    s_waitcnt lgkmcnt(8)
    v_mfma_f32_16x16x32_bf16 v[208:211], v[80:83], v[96:99], v[208:211]
    ds_read_b64_tr_b16 v[72:73], v12 offset:8192
    buffer_load_dwordx4 v[32:35], v6, s[8:11], s32 offen offset:1024 sc1
    v_mfma_f32_16x16x32_bf16 v[240:243], v[80:83], v[100:103], v[240:243]
    ds_read_b64_tr_b16 v[74:75], v12 offset:9216
    v_mfma_f32_16x16x32_bf16 v[212:215], v[84:87], v[96:99], v[212:215]
    ds_read_b64_tr_b16 v[76:77], v13 offset:8192
    v_mfma_f32_16x16x32_bf16 v[244:247], v[84:87], v[100:103], v[244:247]
    ds_read_b64_tr_b16 v[78:79], v13 offset:9216
    s_waitcnt lgkmcnt(8)
    v_mfma_f32_16x16x32_bf16 v[216:219], v[88:91], v[96:99], v[216:219]
    ds_read_b64_tr_b16 v[80:81], v14 offset:8192
    buffer_load_dwordx4 v[36:39], v7, s[8:11], s32 offen offset:1024 sc1
    v_mfma_f32_16x16x32_bf16 v[248:251], v[88:91], v[100:103], v[248:251]
    ds_read_b64_tr_b16 v[82:83], v14 offset:9216
    v_mfma_f32_16x16x32_bf16 v[220:223], v[92:95], v[96:99], v[220:223]
    ds_read_b64_tr_b16 v[84:85], v15 offset:8192
    v_mfma_f32_16x16x32_bf16 v[252:255], v[92:95], v[100:103], v[252:255]
    ds_read_b64_tr_b16 v[86:87], v15 offset:9216
    s_waitcnt lgkmcnt(8)
    s_waitcnt vmcnt(14)
    v_mfma_f32_16x16x32_bf16 v[192:195], v[64:67], v[104:107], v[192:195]
    ds_read_b64_tr_b16 v[88:89], v16 offset:8192
    v_mfma_f32_16x16x32_bf16 v[224:227], v[64:67], v[108:111], v[224:227]
    ds_read_b64_tr_b16 v[90:91], v16 offset:9216
    s_add_u32 m0, s33, 0
    s_mov_b32 s31, 5242880
    buffer_load_dwordx4 v2, s[4:7], s31 offen offset:0 lds
    v_mfma_f32_16x16x32_bf16 v[196:199], v[68:71], v[104:107], v[196:199]
    ds_read_b64_tr_b16 v[92:93], v17 offset:8192
    v_mfma_f32_16x16x32_bf16 v[228:231], v[68:71], v[108:111], v[228:231]
    ds_read_b64_tr_b16 v[94:95], v17 offset:9216
    s_waitcnt lgkmcnt(8)
    v_mfma_f32_16x16x32_bf16 v[200:203], v[72:75], v[104:107], v[200:203]
    ds_read_b64_tr_b16 v[64:65], v10 offset:16384
    buffer_load_dwordx4 v[40:43], v6, s[8:11], s32 offen offset:2048 sc1
    v_mfma_f32_16x16x32_bf16 v[232:235], v[72:75], v[108:111], v[232:235]
    ds_read_b64_tr_b16 v[66:67], v10 offset:17408
    v_mfma_f32_16x16x32_bf16 v[204:207], v[76:79], v[104:107], v[204:207]
    ds_read_b64_tr_b16 v[68:69], v11 offset:16384
    v_mfma_f32_16x16x32_bf16 v[236:239], v[76:79], v[108:111], v[236:239]
    ds_read_b64_tr_b16 v[70:71], v11 offset:17408
    s_waitcnt lgkmcnt(8)
    v_mfma_f32_16x16x32_bf16 v[208:211], v[80:83], v[104:107], v[208:211]
    ds_read_b64_tr_b16 v[72:73], v12 offset:16384
    buffer_load_dwordx4 v[44:47], v7, s[8:11], s32 offen offset:2048 sc1
    v_mfma_f32_16x16x32_bf16 v[240:243], v[80:83], v[108:111], v[240:243]
    ds_read_b64_tr_b16 v[74:75], v12 offset:17408
    v_mfma_f32_16x16x32_bf16 v[212:215], v[84:87], v[104:107], v[212:215]
    ds_read_b64_tr_b16 v[76:77], v13 offset:16384
    v_mfma_f32_16x16x32_bf16 v[244:247], v[84:87], v[108:111], v[244:247]
    ds_read_b64_tr_b16 v[78:79], v13 offset:17408
    s_waitcnt lgkmcnt(8)
    v_mfma_f32_16x16x32_bf16 v[216:219], v[88:91], v[104:107], v[216:219]
    ds_read_b64_tr_b16 v[80:81], v14 offset:16384
    v_mfma_f32_16x16x32_bf16 v[248:251], v[88:91], v[108:111], v[248:251]
    ds_read_b64_tr_b16 v[82:83], v14 offset:17408
    buffer_store_dwordx4 v[156:159], v61, s[16:19], s47 offen sc1
    v_mfma_f32_16x16x32_bf16 v[220:223], v[92:95], v[104:107], v[220:223]
    ds_read_b64_tr_b16 v[84:85], v15 offset:16384
    v_mfma_f32_16x16x32_bf16 v[252:255], v[92:95], v[108:111], v[252:255]
    ds_read_b64_tr_b16 v[86:87], v15 offset:17408
    s_waitcnt lgkmcnt(8)
    s_waitcnt vmcnt(15)
    v_mfma_f32_16x16x32_bf16 v[192:195], v[64:67], v[112:115], v[192:195]
    ds_read_b64_tr_b16 v[88:89], v16 offset:16384
    v_mfma_f32_16x16x32_bf16 v[224:227], v[64:67], v[116:119], v[224:227]
    ds_read_b64_tr_b16 v[90:91], v16 offset:17408
    v_mfma_f32_16x16x32_bf16 v[196:199], v[68:71], v[112:115], v[196:199]
    ds_read_b64_tr_b16 v[92:93], v17 offset:16384
    v_mfma_f32_16x16x32_bf16 v[228:231], v[68:71], v[116:119], v[228:231]
    ds_read_b64_tr_b16 v[94:95], v17 offset:17408
    s_waitcnt lgkmcnt(8)
    v_mfma_f32_16x16x32_bf16 v[200:203], v[72:75], v[112:115], v[200:203]
    ds_read_b64_tr_b16 v[64:65], v10 offset:24576
    v_mfma_f32_16x16x32_bf16 v[232:235], v[72:75], v[116:119], v[232:235]
    ds_read_b64_tr_b16 v[66:67], v10 offset:25600
    v_mfma_f32_16x16x32_bf16 v[204:207], v[76:79], v[112:115], v[204:207]
    ds_read_b64_tr_b16 v[68:69], v11 offset:24576
    v_mfma_f32_16x16x32_bf16 v[236:239], v[76:79], v[116:119], v[236:239]
    ds_read_b64_tr_b16 v[70:71], v11 offset:25600
    buffer_load_dwordx4 v3, s[4:7], s31 offen offset:1024 lds
    s_waitcnt lgkmcnt(8)
    v_mfma_f32_16x16x32_bf16 v[208:211], v[80:83], v[112:115], v[208:211]
    ds_read_b64_tr_b16 v[72:73], v12 offset:24576
    v_mfma_f32_16x16x32_bf16 v[240:243], v[80:83], v[116:119], v[240:243]
    ds_read_b64_tr_b16 v[74:75], v12 offset:25600
    v_mfma_f32_16x16x32_bf16 v[212:215], v[84:87], v[112:115], v[212:215]
    ds_read_b64_tr_b16 v[76:77], v13 offset:24576
    v_mfma_f32_16x16x32_bf16 v[244:247], v[84:87], v[116:119], v[244:247]
    ds_read_b64_tr_b16 v[78:79], v13 offset:25600
    buffer_load_dwordx4 v4, s[4:7], s31 offen offset:2048 lds
    s_waitcnt lgkmcnt(8)
    v_mfma_f32_16x16x32_bf16 v[216:219], v[88:91], v[112:115], v[216:219]
    ds_read_b64_tr_b16 v[80:81], v14 offset:24576
    v_mfma_f32_16x16x32_bf16 v[248:251], v[88:91], v[116:119], v[248:251]
    ds_read_b64_tr_b16 v[82:83], v14 offset:25600
    v_mfma_f32_16x16x32_bf16 v[220:223], v[92:95], v[112:115], v[220:223]
    ds_read_b64_tr_b16 v[84:85], v15 offset:24576
    v_mfma_f32_16x16x32_bf16 v[252:255], v[92:95], v[116:119], v[252:255]
    ds_read_b64_tr_b16 v[86:87], v15 offset:25600
    buffer_load_dwordx4 v[48:51], v6, s[8:11], s32 offen offset:3072 sc1
    s_waitcnt lgkmcnt(8)
    s_waitcnt vmcnt(13)
    v_mfma_f32_16x16x32_bf16 v[192:195], v[64:67], v[120:123], v[192:195]
    ds_read_b64_tr_b16 v[88:89], v16 offset:24576
    v_mfma_f32_16x16x32_bf16 v[224:227], v[64:67], v[124:127], v[224:227]
    ds_read_b64_tr_b16 v[90:91], v16 offset:25600
    v_mfma_f32_16x16x32_bf16 v[196:199], v[68:71], v[120:123], v[196:199]
    ds_read_b64_tr_b16 v[92:93], v17 offset:24576
    v_mfma_f32_16x16x32_bf16 v[228:231], v[68:71], v[124:127], v[228:231]
    ds_read_b64_tr_b16 v[94:95], v17 offset:25600
    buffer_load_dwordx4 v[52:55], v7, s[8:11], s32 offen offset:3072 sc1
    s_waitcnt vmcnt(13)
    s_barrier
    s_waitcnt lgkmcnt(8)
    v_mfma_f32_16x16x32_bf16 v[200:203], v[72:75], v[120:123], v[200:203]
    ds_read_b64_tr_b16 v[64:65], v10 offset:32768
    v_mfma_f32_16x16x32_bf16 v[232:235], v[72:75], v[124:127], v[232:235]
    ds_read_b64_tr_b16 v[66:67], v10 offset:33792
    v_mfma_f32_16x16x32_bf16 v[204:207], v[76:79], v[120:123], v[204:207]
    ds_read_b64_tr_b16 v[68:69], v11 offset:32768
    v_mfma_f32_16x16x32_bf16 v[236:239], v[76:79], v[124:127], v[236:239]
    ds_read_b64_tr_b16 v[70:71], v11 offset:33792
    buffer_load_dwordx4 v5, s[4:7], s31 offen offset:3072 lds
    s_waitcnt lgkmcnt(8)
    v_mfma_f32_16x16x32_bf16 v[208:211], v[80:83], v[120:123], v[208:211]
    ds_read_b64_tr_b16 v[72:73], v12 offset:32768
    v_mfma_f32_16x16x32_bf16 v[240:243], v[80:83], v[124:127], v[240:243]
    ds_read_b64_tr_b16 v[74:75], v12 offset:33792
    v_mfma_f32_16x16x32_bf16 v[212:215], v[84:87], v[120:123], v[212:215]
    ds_read_b64_tr_b16 v[76:77], v13 offset:32768
    v_mfma_f32_16x16x32_bf16 v[244:247], v[84:87], v[124:127], v[244:247]
    ds_read_b64_tr_b16 v[78:79], v13 offset:33792
    s_mov_b32 s32, 20480
    buffer_load_dwordx4 v[96:99], v6, s[8:11], s32 offen offset:0 sc1
    s_waitcnt lgkmcnt(8)
    v_mfma_f32_16x16x32_bf16 v[216:219], v[88:91], v[120:123], v[216:219]
    ds_read_b64_tr_b16 v[80:81], v14 offset:32768
    v_mfma_f32_16x16x32_bf16 v[248:251], v[88:91], v[124:127], v[248:251]
    ds_read_b64_tr_b16 v[82:83], v14 offset:33792
    v_mfma_f32_16x16x32_bf16 v[220:223], v[92:95], v[120:123], v[220:223]
    ds_read_b64_tr_b16 v[84:85], v15 offset:32768
    v_mfma_f32_16x16x32_bf16 v[252:255], v[92:95], v[124:127], v[252:255]
    ds_read_b64_tr_b16 v[86:87], v15 offset:33792
    buffer_load_dwordx4 v[100:103], v7, s[8:11], s32 offen offset:0 sc1
    s_waitcnt lgkmcnt(8)
    s_waitcnt vmcnt(14)
    v_mfma_f32_16x16x32_bf16 v[192:195], v[64:67], v[24:27], v[192:195]
    ds_read_b64_tr_b16 v[88:89], v16 offset:32768
    v_mfma_f32_16x16x32_bf16 v[224:227], v[64:67], v[28:31], v[224:227]
    ds_read_b64_tr_b16 v[90:91], v16 offset:33792
    v_mfma_f32_16x16x32_bf16 v[196:199], v[68:71], v[24:27], v[196:199]
    ds_read_b64_tr_b16 v[92:93], v17 offset:32768
    v_mfma_f32_16x16x32_bf16 v[228:231], v[68:71], v[28:31], v[228:231]
    ds_read_b64_tr_b16 v[94:95], v17 offset:33792
    s_cmp_eq_u32 s30, 0
    s_cselect_b32 s18, 0, s18
    buffer_store_dwordx4 v[160:163], v58, s[16:19], s48 offen sc1
    s_waitcnt lgkmcnt(8)
    v_mfma_f32_16x16x32_bf16 v[200:203], v[72:75], v[24:27], v[200:203]
    ds_read_b64_tr_b16 v[64:65], v10 offset:40960
    v_mfma_f32_16x16x32_bf16 v[232:235], v[72:75], v[28:31], v[232:235]
    ds_read_b64_tr_b16 v[66:67], v10 offset:41984
    v_mfma_f32_16x16x32_bf16 v[204:207], v[76:79], v[24:27], v[204:207]
    ds_read_b64_tr_b16 v[68:69], v11 offset:40960
    v_mfma_f32_16x16x32_bf16 v[236:239], v[76:79], v[28:31], v[236:239]
    ds_read_b64_tr_b16 v[70:71], v11 offset:41984
    s_waitcnt lgkmcnt(8)
    v_mfma_f32_16x16x32_bf16 v[208:211], v[80:83], v[24:27], v[208:211]
    ds_read_b64_tr_b16 v[72:73], v12 offset:40960
    v_mfma_f32_16x16x32_bf16 v[240:243], v[80:83], v[28:31], v[240:243]
    ds_read_b64_tr_b16 v[74:75], v12 offset:41984
    v_mfma_f32_16x16x32_bf16 v[212:215], v[84:87], v[24:27], v[212:215]
    ds_read_b64_tr_b16 v[76:77], v13 offset:40960
    v_mfma_f32_16x16x32_bf16 v[244:247], v[84:87], v[28:31], v[244:247]
    ds_read_b64_tr_b16 v[78:79], v13 offset:41984
    s_waitcnt lgkmcnt(8)
    v_mfma_f32_16x16x32_bf16 v[216:219], v[88:91], v[24:27], v[216:219]
    ds_read_b64_tr_b16 v[80:81], v14 offset:40960
    v_mfma_f32_16x16x32_bf16 v[248:251], v[88:91], v[28:31], v[248:251]
    ds_read_b64_tr_b16 v[82:83], v14 offset:41984
    v_mfma_f32_16x16x32_bf16 v[220:223], v[92:95], v[24:27], v[220:223]
    ds_read_b64_tr_b16 v[84:85], v15 offset:40960
    buffer_load_dwordx4 v[104:107], v6, s[8:11], s32 offen offset:1024 sc1
    v_mfma_f32_16x16x32_bf16 v[252:255], v[92:95], v[28:31], v[252:255]
    ds_read_b64_tr_b16 v[86:87], v15 offset:41984
    s_waitcnt lgkmcnt(8)
    s_waitcnt vmcnt(13)
    v_mfma_f32_16x16x32_bf16 v[192:195], v[64:67], v[32:35], v[192:195]
    ds_read_b64_tr_b16 v[88:89], v16 offset:40960
    v_mfma_f32_16x16x32_bf16 v[224:227], v[64:67], v[36:39], v[224:227]
    ds_read_b64_tr_b16 v[90:91], v16 offset:41984
    v_mfma_f32_16x16x32_bf16 v[196:199], v[68:71], v[32:35], v[196:199]
    ds_read_b64_tr_b16 v[92:93], v17 offset:40960
    buffer_load_dwordx4 v[108:111], v7, s[8:11], s32 offen offset:1024 sc1
    v_mfma_f32_16x16x32_bf16 v[228:231], v[68:71], v[36:39], v[228:231]
    ds_read_b64_tr_b16 v[94:95], v17 offset:41984
    s_waitcnt lgkmcnt(8)
    v_mfma_f32_16x16x32_bf16 v[200:203], v[72:75], v[32:35], v[200:203]
    ds_read_b64_tr_b16 v[64:65], v10 offset:49152
    v_mfma_f32_16x16x32_bf16 v[232:235], v[72:75], v[36:39], v[232:235]
    ds_read_b64_tr_b16 v[66:67], v10 offset:50176
    v_mfma_f32_16x16x32_bf16 v[204:207], v[76:79], v[32:35], v[204:207]
    ds_read_b64_tr_b16 v[68:69], v11 offset:49152
    s_add_u32 m0, s33, 131072
    s_mov_b32 s31, 6291456
    buffer_load_dwordx4 v2, s[4:7], s31 offen offset:0 lds
    v_mfma_f32_16x16x32_bf16 v[236:239], v[76:79], v[36:39], v[236:239]
    ds_read_b64_tr_b16 v[70:71], v11 offset:50176
    s_waitcnt lgkmcnt(8)
    v_mfma_f32_16x16x32_bf16 v[208:211], v[80:83], v[32:35], v[208:211]
    ds_read_b64_tr_b16 v[72:73], v12 offset:49152
    v_mfma_f32_16x16x32_bf16 v[240:243], v[80:83], v[36:39], v[240:243]
    ds_read_b64_tr_b16 v[74:75], v12 offset:50176
    v_mfma_f32_16x16x32_bf16 v[212:215], v[84:87], v[32:35], v[212:215]
    ds_read_b64_tr_b16 v[76:77], v13 offset:49152
    buffer_store_dwordx4 v[164:167], v59, s[16:19], s48 offen sc1
    v_mfma_f32_16x16x32_bf16 v[244:247], v[84:87], v[36:39], v[244:247]
    ds_read_b64_tr_b16 v[78:79], v13 offset:50176
    s_waitcnt lgkmcnt(8)
    v_mfma_f32_16x16x32_bf16 v[216:219], v[88:91], v[32:35], v[216:219]
    ds_read_b64_tr_b16 v[80:81], v14 offset:49152
    v_mfma_f32_16x16x32_bf16 v[248:251], v[88:91], v[36:39], v[248:251]
    ds_read_b64_tr_b16 v[82:83], v14 offset:50176
    v_mfma_f32_16x16x32_bf16 v[220:223], v[92:95], v[32:35], v[220:223]
    ds_read_b64_tr_b16 v[84:85], v15 offset:49152
    v_mfma_f32_16x16x32_bf16 v[252:255], v[92:95], v[36:39], v[252:255]
    ds_read_b64_tr_b16 v[86:87], v15 offset:50176
    s_waitcnt lgkmcnt(8)
    s_waitcnt vmcnt(13)
    v_mfma_f32_16x16x32_bf16 v[192:195], v[64:67], v[40:43], v[192:195]
    ds_read_b64_tr_b16 v[88:89], v16 offset:49152
    v_mfma_f32_16x16x32_bf16 v[224:227], v[64:67], v[44:47], v[224:227]
    ds_read_b64_tr_b16 v[90:91], v16 offset:50176
    v_mfma_f32_16x16x32_bf16 v[196:199], v[68:71], v[40:43], v[196:199]
    ds_read_b64_tr_b16 v[92:93], v17 offset:49152
    v_mfma_f32_16x16x32_bf16 v[228:231], v[68:71], v[44:47], v[228:231]
    ds_read_b64_tr_b16 v[94:95], v17 offset:50176
    s_waitcnt lgkmcnt(8)
    v_mfma_f32_16x16x32_bf16 v[200:203], v[72:75], v[40:43], v[200:203]
    ds_read_b64_tr_b16 v[64:65], v10 offset:57344
    v_mfma_f32_16x16x32_bf16 v[232:235], v[72:75], v[44:47], v[232:235]
    ds_read_b64_tr_b16 v[66:67], v10 offset:58368
    v_add_u32 v10, 4294901760, v10
    buffer_load_dwordx4 v[112:115], v6, s[8:11], s32 offen offset:2048 sc1
    v_mfma_f32_16x16x32_bf16 v[204:207], v[76:79], v[40:43], v[204:207]
    ds_read_b64_tr_b16 v[68:69], v11 offset:57344
    v_mfma_f32_16x16x32_bf16 v[236:239], v[76:79], v[44:47], v[236:239]
    ds_read_b64_tr_b16 v[70:71], v11 offset:58368
    v_add_u32 v11, 4294901760, v11
    s_waitcnt lgkmcnt(8)
    v_mfma_f32_16x16x32_bf16 v[208:211], v[80:83], v[40:43], v[208:211]
    ds_read_b64_tr_b16 v[72:73], v12 offset:57344
    v_mfma_f32_16x16x32_bf16 v[240:243], v[80:83], v[44:47], v[240:243]
    ds_read_b64_tr_b16 v[74:75], v12 offset:58368
    v_add_u32 v12, 4294901760, v12
    buffer_load_dwordx4 v[116:119], v7, s[8:11], s32 offen offset:2048 sc1
    v_mfma_f32_16x16x32_bf16 v[212:215], v[84:87], v[40:43], v[212:215]
    ds_read_b64_tr_b16 v[76:77], v13 offset:57344
    v_mfma_f32_16x16x32_bf16 v[244:247], v[84:87], v[44:47], v[244:247]
    ds_read_b64_tr_b16 v[78:79], v13 offset:58368
    v_add_u32 v13, 4294901760, v13
    s_waitcnt lgkmcnt(8)
    v_mfma_f32_16x16x32_bf16 v[216:219], v[88:91], v[40:43], v[216:219]
    ds_read_b64_tr_b16 v[80:81], v14 offset:57344
    v_mfma_f32_16x16x32_bf16 v[248:251], v[88:91], v[44:47], v[248:251]
    ds_read_b64_tr_b16 v[82:83], v14 offset:58368
    v_add_u32 v14, 4294901760, v14
    buffer_load_dwordx4 v3, s[4:7], s31 offen offset:1024 lds
    v_mfma_f32_16x16x32_bf16 v[220:223], v[92:95], v[40:43], v[220:223]
    ds_read_b64_tr_b16 v[84:85], v15 offset:57344
    v_mfma_f32_16x16x32_bf16 v[252:255], v[92:95], v[44:47], v[252:255]
    ds_read_b64_tr_b16 v[86:87], v15 offset:58368
    v_add_u32 v15, 4294901760, v15
    s_waitcnt lgkmcnt(8)
    s_waitcnt vmcnt(11)
    v_mfma_f32_16x16x32_bf16 v[192:195], v[64:67], v[48:51], v[192:195]
    ds_read_b64_tr_b16 v[88:89], v16 offset:57344
    v_mfma_f32_16x16x32_bf16 v[224:227], v[64:67], v[52:55], v[224:227]
    ds_read_b64_tr_b16 v[90:91], v16 offset:58368
    v_add_u32 v16, 4294901760, v16
    buffer_load_dwordx4 v4, s[4:7], s31 offen offset:2048 lds
    v_mfma_f32_16x16x32_bf16 v[196:199], v[68:71], v[48:51], v[196:199]
    ds_read_b64_tr_b16 v[92:93], v17 offset:57344
    v_mfma_f32_16x16x32_bf16 v[228:231], v[68:71], v[52:55], v[228:231]
    ds_read_b64_tr_b16 v[94:95], v17 offset:58368
    v_add_u32 v17, 4294901760, v17
    s_waitcnt vmcnt(11)
    s_cmp_eq_u32 s30, 0
    s_cbranch_scc1 L_recurrent_scan__compressed_kv_cla__moe_arch_mod__prompt_kernel_rare_46
L_recurrent_scan__compressed_kv_cla__moe_arch_mod__prompt_kernel_back_47:
    s_barrier
    s_waitcnt lgkmcnt(8)
    v_mfma_f32_16x16x32_bf16 v[200:203], v[72:75], v[48:51], v[200:203]
    ds_read_b64_tr_b16 v[64:65], v10 offset:0
    buffer_load_dwordx4 v[120:123], v6, s[8:11], s32 offen offset:3072 sc1
    v_mfma_f32_16x16x32_bf16 v[232:235], v[72:75], v[52:55], v[232:235]
    ds_read_b64_tr_b16 v[66:67], v10 offset:1024
    s_lshl_b32 s36, s30, 3
    s_add_u32 s36, s28, s36
    s_cmp_eq_u32 s36, 4
    s_cbranch_scc1 L_recurrent_scan__compressed_kv_cla__moe_arch_mod__prompt_kernel_rare_50
L_recurrent_scan__compressed_kv_cla__moe_arch_mod__prompt_kernel_back_51:
    v_mfma_f32_16x16x32_bf16 v[204:207], v[76:79], v[48:51], v[204:207]
    ds_read_b64_tr_b16 v[68:69], v11 offset:0
    v_mfma_f32_16x16x32_bf16 v[236:239], v[76:79], v[52:55], v[236:239]
    ds_read_b64_tr_b16 v[70:71], v11 offset:1024
    s_waitcnt lgkmcnt(8)
    v_mfma_f32_16x16x32_bf16 v[208:211], v[80:83], v[48:51], v[208:211]
    ds_read_b64_tr_b16 v[72:73], v12 offset:0
    buffer_load_dwordx4 v[124:127], v7, s[8:11], s32 offen offset:3072 sc1
    v_mfma_f32_16x16x32_bf16 v[240:243], v[80:83], v[52:55], v[240:243]
    ds_read_b64_tr_b16 v[74:75], v12 offset:1024
    v_mfma_f32_16x16x32_bf16 v[212:215], v[84:87], v[48:51], v[212:215]
    ds_read_b64_tr_b16 v[76:77], v13 offset:0
    v_mfma_f32_16x16x32_bf16 v[244:247], v[84:87], v[52:55], v[244:247]
    ds_read_b64_tr_b16 v[78:79], v13 offset:1024
    s_waitcnt lgkmcnt(8)
    v_mfma_f32_16x16x32_bf16 v[216:219], v[88:91], v[48:51], v[216:219]
    ds_read_b64_tr_b16 v[80:81], v14 offset:0
    v_mfma_f32_16x16x32_bf16 v[248:251], v[88:91], v[52:55], v[248:251]
    ds_read_b64_tr_b16 v[82:83], v14 offset:1024
    buffer_load_dwordx4 v5, s[4:7], s31 offen offset:3072 lds
    v_mfma_f32_16x16x32_bf16 v[220:223], v[92:95], v[48:51], v[220:223]
    ds_read_b64_tr_b16 v[84:85], v15 offset:0
    v_mfma_f32_16x16x32_bf16 v[252:255], v[92:95], v[52:55], v[252:255]
    ds_read_b64_tr_b16 v[86:87], v15 offset:1024
    s_waitcnt lgkmcnt(8)
    s_waitcnt vmcnt(12)
    v_mfma_f32_16x16x32_bf16 v[192:195], v[64:67], v[96:99], v[192:195]
    ds_read_b64_tr_b16 v[88:89], v16 offset:0
    buffer_store_dwordx4 v[168:171], v60, s[16:19], s48 offen sc1
    v_mfma_f32_16x16x32_bf16 v[224:227], v[64:67], v[100:103], v[224:227]
    ds_read_b64_tr_b16 v[90:91], v16 offset:1024
    v_mfma_f32_16x16x32_bf16 v[196:199], v[68:71], v[96:99], v[196:199]
    ds_read_b64_tr_b16 v[92:93], v17 offset:0
    v_mfma_f32_16x16x32_bf16 v[228:231], v[68:71], v[100:103], v[228:231]
    ds_read_b64_tr_b16 v[94:95], v17 offset:1024
    s_waitcnt lgkmcnt(8)
    v_mfma_f32_16x16x32_bf16 v[200:203], v[72:75], v[96:99], v[200:203]
    ds_read_b64_tr_b16 v[64:65], v10 offset:8192
    v_mfma_f32_16x16x32_bf16 v[232:235], v[72:75], v[100:103], v[232:235]
    ds_read_b64_tr_b16 v[66:67], v10 offset:9216
    v_mfma_f32_16x16x32_bf16 v[204:207], v[76:79], v[96:99], v[204:207]
    ds_read_b64_tr_b16 v[68:69], v11 offset:8192
    v_mfma_f32_16x16x32_bf16 v[236:239], v[76:79], v[100:103], v[236:239]
    ds_read_b64_tr_b16 v[70:71], v11 offset:9216
    s_waitcnt lgkmcnt(8)
    v_mfma_f32_16x16x32_bf16 v[208:211], v[80:83], v[96:99], v[208:211]
    ds_read_b64_tr_b16 v[72:73], v12 offset:8192
    v_mfma_f32_16x16x32_bf16 v[240:243], v[80:83], v[100:103], v[240:243]
    ds_read_b64_tr_b16 v[74:75], v12 offset:9216
    v_mfma_f32_16x16x32_bf16 v[212:215], v[84:87], v[96:99], v[212:215]
    ds_read_b64_tr_b16 v[76:77], v13 offset:8192
    v_mfma_f32_16x16x32_bf16 v[244:247], v[84:87], v[100:103], v[244:247]
    ds_read_b64_tr_b16 v[78:79], v13 offset:9216
    s_mov_b32 s32, 24576
    buffer_load_dwordx4 v[24:27], v6, s[8:11], s32 offen offset:0 sc1
    s_waitcnt lgkmcnt(8)
    v_mfma_f32_16x16x32_bf16 v[216:219], v[88:91], v[96:99], v[216:219]
    ds_read_b64_tr_b16 v[80:81], v14 offset:8192
    v_mfma_f32_16x16x32_bf16 v[248:251], v[88:91], v[100:103], v[248:251]
    ds_read_b64_tr_b16 v[82:83], v14 offset:9216
    v_mfma_f32_16x16x32_bf16 v[220:223], v[92:95], v[96:99], v[220:223]
    ds_read_b64_tr_b16 v[84:85], v15 offset:8192
    v_mfma_f32_16x16x32_bf16 v[252:255], v[92:95], v[100:103], v[252:255]
    ds_read_b64_tr_b16 v[86:87], v15 offset:9216
    buffer_load_dwordx4 v[28:31], v7, s[8:11], s32 offen offset:0 sc1
    s_waitcnt lgkmcnt(8)
    s_waitcnt vmcnt(12)
    v_mfma_f32_16x16x32_bf16 v[192:195], v[64:67], v[104:107], v[192:195]
    ds_read_b64_tr_b16 v[88:89], v16 offset:8192
    v_mfma_f32_16x16x32_bf16 v[224:227], v[64:67], v[108:111], v[224:227]
    ds_read_b64_tr_b16 v[90:91], v16 offset:9216
    v_mfma_f32_16x16x32_bf16 v[196:199], v[68:71], v[104:107], v[196:199]
    ds_read_b64_tr_b16 v[92:93], v17 offset:8192
    v_mfma_f32_16x16x32_bf16 v[228:231], v[68:71], v[108:111], v[228:231]
    ds_read_b64_tr_b16 v[94:95], v17 offset:9216
    buffer_load_dwordx4 v[32:35], v6, s[8:11], s32 offen offset:1024 sc1
    s_waitcnt lgkmcnt(8)
    v_mfma_f32_16x16x32_bf16 v[200:203], v[72:75], v[104:107], v[200:203]
    ds_read_b64_tr_b16 v[64:65], v10 offset:16384
    v_mfma_f32_16x16x32_bf16 v[232:235], v[72:75], v[108:111], v[232:235]
    ds_read_b64_tr_b16 v[66:67], v10 offset:17408
    v_mfma_f32_16x16x32_bf16 v[204:207], v[76:79], v[104:107], v[204:207]
    ds_read_b64_tr_b16 v[68:69], v11 offset:16384
    v_mfma_f32_16x16x32_bf16 v[236:239], v[76:79], v[108:111], v[236:239]
    ds_read_b64_tr_b16 v[70:71], v11 offset:17408
    s_waitcnt lgkmcnt(8)
    v_mfma_f32_16x16x32_bf16 v[208:211], v[80:83], v[104:107], v[208:211]
    ds_read_b64_tr_b16 v[72:73], v12 offset:16384
    buffer_load_dwordx4 v[36:39], v7, s[8:11], s32 offen offset:1024 sc1
    v_mfma_f32_16x16x32_bf16 v[240:243], v[80:83], v[108:111], v[240:243]
    ds_read_b64_tr_b16 v[74:75], v12 offset:17408
    v_mfma_f32_16x16x32_bf16 v[212:215], v[84:87], v[104:107], v[212:215]
    ds_read_b64_tr_b16 v[76:77], v13 offset:16384
    v_mfma_f32_16x16x32_bf16 v[244:247], v[84:87], v[108:111], v[244:247]
    ds_read_b64_tr_b16 v[78:79], v13 offset:17408
    s_waitcnt lgkmcnt(8)
    v_mfma_f32_16x16x32_bf16 v[216:219], v[88:91], v[104:107], v[216:219]
    ds_read_b64_tr_b16 v[80:81], v14 offset:16384
    buffer_store_dwordx4 v[172:175], v61, s[16:19], s48 offen sc1
    v_mfma_f32_16x16x32_bf16 v[248:251], v[88:91], v[108:111], v[248:251]
    ds_read_b64_tr_b16 v[82:83], v14 offset:17408
    v_mfma_f32_16x16x32_bf16 v[220:223], v[92:95], v[104:107], v[220:223]
    ds_read_b64_tr_b16 v[84:85], v15 offset:16384
    v_mfma_f32_16x16x32_bf16 v[252:255], v[92:95], v[108:111], v[252:255]
    ds_read_b64_tr_b16 v[86:87], v15 offset:17408
    s_waitcnt lgkmcnt(8)
    s_waitcnt vmcnt(11)
    v_mfma_f32_16x16x32_bf16 v[192:195], v[64:67], v[112:115], v[192:195]
    ds_read_b64_tr_b16 v[88:89], v16 offset:16384
    v_mfma_f32_16x16x32_bf16 v[224:227], v[64:67], v[116:119], v[224:227]
    ds_read_b64_tr_b16 v[90:91], v16 offset:17408
    v_mfma_f32_16x16x32_bf16 v[196:199], v[68:71], v[112:115], v[196:199]
    ds_read_b64_tr_b16 v[92:93], v17 offset:16384
    v_mfma_f32_16x16x32_bf16 v[228:231], v[68:71], v[116:119], v[228:231]
    ds_read_b64_tr_b16 v[94:95], v17 offset:17408
    s_waitcnt lgkmcnt(8)
    v_mfma_f32_16x16x32_bf16 v[200:203], v[72:75], v[112:115], v[200:203]
    ds_read_b64_tr_b16 v[64:65], v10 offset:24576
    v_mfma_f32_16x16x32_bf16 v[232:235], v[72:75], v[116:119], v[232:235]
    ds_read_b64_tr_b16 v[66:67], v10 offset:25600
    v_add_u32 v10, 98304, v10
    v_mfma_f32_16x16x32_bf16 v[204:207], v[76:79], v[112:115], v[204:207]
    ds_read_b64_tr_b16 v[68:69], v11 offset:24576
    v_mfma_f32_16x16x32_bf16 v[236:239], v[76:79], v[116:119], v[236:239]
    ds_read_b64_tr_b16 v[70:71], v11 offset:25600
    v_add_u32 v11, 98304, v11
    s_add_u32 m0, s33, 32768
    s_mov_b32 s31, 7340032
    buffer_load_dwordx4 v2, s[4:7], s31 offen offset:0 lds
    s_waitcnt lgkmcnt(8)
    v_mfma_f32_16x16x32_bf16 v[208:211], v[80:83], v[112:115], v[208:211]
    ds_read_b64_tr_b16 v[72:73], v12 offset:24576
    v_mfma_f32_16x16x32_bf16 v[240:243], v[80:83], v[116:119], v[240:243]
    ds_read_b64_tr_b16 v[74:75], v12 offset:25600
    v_add_u32 v12, 98304, v12
    v_mfma_f32_16x16x32_bf16 v[212:215], v[84:87], v[112:115], v[212:215]
    ds_read_b64_tr_b16 v[76:77], v13 offset:24576
    buffer_load_dwordx4 v[40:43], v6, s[8:11], s32 offen offset:2048 sc1
    v_mfma_f32_16x16x32_bf16 v[244:247], v[84:87], v[116:119], v[244:247]
    ds_read_b64_tr_b16 v[78:79], v13 offset:25600
    v_add_u32 v13, 98304, v13
    s_waitcnt lgkmcnt(8)
    v_mfma_f32_16x16x32_bf16 v[216:219], v[88:91], v[112:115], v[216:219]
    ds_read_b64_tr_b16 v[80:81], v14 offset:24576
    v_mfma_f32_16x16x32_bf16 v[248:251], v[88:91], v[116:119], v[248:251]
    ds_read_b64_tr_b16 v[82:83], v14 offset:25600
    v_add_u32 v14, 98304, v14
    v_mfma_f32_16x16x32_bf16 v[220:223], v[92:95], v[112:115], v[220:223]
    ds_read_b64_tr_b16 v[84:85], v15 offset:24576
    buffer_load_dwordx4 v[44:47], v7, s[8:11], s32 offen offset:2048 sc1
    v_mfma_f32_16x16x32_bf16 v[252:255], v[92:95], v[116:119], v[252:255]
    ds_read_b64_tr_b16 v[86:87], v15 offset:25600
    v_add_u32 v15, 98304, v15
    s_waitcnt lgkmcnt(8)
    s_waitcnt vmcnt(10)
    v_mfma_f32_16x16x32_bf16 v[192:195], v[64:67], v[120:123], v[192:195]
    ds_read_b64_tr_b16 v[88:89], v16 offset:24576
    v_mfma_f32_16x16x32_bf16 v[224:227], v[64:67], v[124:127], v[224:227]
    ds_read_b64_tr_b16 v[90:91], v16 offset:25600
    v_add_u32 v16, 98304, v16
    v_mfma_f32_16x16x32_bf16 v[196:199], v[68:71], v[120:123], v[196:199]
    ds_read_b64_tr_b16 v[92:93], v17 offset:24576
    v_mfma_f32_16x16x32_bf16 v[228:231], v[68:71], v[124:127], v[228:231]
    ds_read_b64_tr_b16 v[94:95], v17 offset:25600
    v_add_u32 v17, 98304, v17
    buffer_load_dwordx4 v3, s[4:7], s31 offen offset:1024 lds
    s_waitcnt vmcnt(10)
    s_barrier
    s_waitcnt lgkmcnt(8)
    v_mfma_f32_16x16x32_bf16 v[200:203], v[72:75], v[120:123], v[200:203]
    ds_read_b64_tr_b16 v[64:65], v10 offset:32768
    v_mfma_f32_16x16x32_bf16 v[232:235], v[72:75], v[124:127], v[232:235]
    ds_read_b64_tr_b16 v[66:67], v10 offset:33792
    v_mfma_f32_16x16x32_bf16 v[204:207], v[76:79], v[120:123], v[204:207]
    ds_read_b64_tr_b16 v[68:69], v11 offset:32768
    buffer_load_dwordx4 v4, s[4:7], s31 offen offset:2048 lds
    v_mfma_f32_16x16x32_bf16 v[236:239], v[76:79], v[124:127], v[236:239]
    ds_read_b64_tr_b16 v[70:71], v11 offset:33792
    s_waitcnt lgkmcnt(8)
    v_mfma_f32_16x16x32_bf16 v[208:211], v[80:83], v[120:123], v[208:211]
    ds_read_b64_tr_b16 v[72:73], v12 offset:32768
    v_mfma_f32_16x16x32_bf16 v[240:243], v[80:83], v[124:127], v[240:243]
    ds_read_b64_tr_b16 v[74:75], v12 offset:33792
    v_mfma_f32_16x16x32_bf16 v[212:215], v[84:87], v[120:123], v[212:215]
    ds_read_b64_tr_b16 v[76:77], v13 offset:32768
    buffer_load_dwordx4 v[48:51], v6, s[8:11], s32 offen offset:3072 sc1
    v_mfma_f32_16x16x32_bf16 v[244:247], v[84:87], v[124:127], v[244:247]
    ds_read_b64_tr_b16 v[78:79], v13 offset:33792
    s_waitcnt lgkmcnt(8)
    v_mfma_f32_16x16x32_bf16 v[216:219], v[88:91], v[120:123], v[216:219]
    ds_read_b64_tr_b16 v[80:81], v14 offset:32768
    v_mfma_f32_16x16x32_bf16 v[248:251], v[88:91], v[124:127], v[248:251]
    ds_read_b64_tr_b16 v[82:83], v14 offset:33792
    v_mfma_f32_16x16x32_bf16 v[220:223], v[92:95], v[120:123], v[220:223]
    ds_read_b64_tr_b16 v[84:85], v15 offset:32768
    buffer_load_dwordx4 v[52:55], v7, s[8:11], s32 offen offset:3072 sc1
    v_mfma_f32_16x16x32_bf16 v[252:255], v[92:95], v[124:127], v[252:255]
    ds_read_b64_tr_b16 v[86:87], v15 offset:33792
    s_waitcnt lgkmcnt(8)
    s_waitcnt vmcnt(10)
    v_mfma_f32_16x16x32_bf16 v[192:195], v[64:67], v[24:27], v[192:195]
    ds_read_b64_tr_b16 v[88:89], v16 offset:32768
    v_mfma_f32_16x16x32_bf16 v[224:227], v[64:67], v[28:31], v[224:227]
    ds_read_b64_tr_b16 v[90:91], v16 offset:33792
    v_mfma_f32_16x16x32_bf16 v[196:199], v[68:71], v[24:27], v[196:199]
    ds_read_b64_tr_b16 v[92:93], v17 offset:32768
    buffer_load_dwordx4 v5, s[4:7], s31 offen offset:3072 lds
    v_mfma_f32_16x16x32_bf16 v[228:231], v[68:71], v[28:31], v[228:231]
    ds_read_b64_tr_b16 v[94:95], v17 offset:33792
    s_waitcnt lgkmcnt(8)
    v_mfma_f32_16x16x32_bf16 v[200:203], v[72:75], v[24:27], v[200:203]
    ds_read_b64_tr_b16 v[64:65], v10 offset:40960
    v_mfma_f32_16x16x32_bf16 v[232:235], v[72:75], v[28:31], v[232:235]
    ds_read_b64_tr_b16 v[66:67], v10 offset:41984
    v_mfma_f32_16x16x32_bf16 v[204:207], v[76:79], v[24:27], v[204:207]
    ds_read_b64_tr_b16 v[68:69], v11 offset:40960
    buffer_store_dwordx4 v[176:179], v58, s[16:19], s49 offen sc1
    v_mfma_f32_16x16x32_bf16 v[236:239], v[76:79], v[28:31], v[236:239]
    ds_read_b64_tr_b16 v[70:71], v11 offset:41984
    s_waitcnt lgkmcnt(8)
    v_mfma_f32_16x16x32_bf16 v[208:211], v[80:83], v[24:27], v[208:211]
    ds_read_b64_tr_b16 v[72:73], v12 offset:40960
    s_cmp_eq_u32 s28, 0
    s_cbranch_scc1 L_recurrent_scan__compressed_kv_cla__moe_arch_mod__prompt_kernel_rare_52
L_recurrent_scan__compressed_kv_cla__moe_arch_mod__prompt_kernel_back_53:
    v_mfma_f32_16x16x32_bf16 v[240:243], v[80:83], v[28:31], v[240:243]
    ds_read_b64_tr_b16 v[74:75], v12 offset:41984
    v_mfma_f32_16x16x32_bf16 v[212:215], v[84:87], v[24:27], v[212:215]
    ds_read_b64_tr_b16 v[76:77], v13 offset:40960
    v_mfma_f32_16x16x32_bf16 v[244:247], v[84:87], v[28:31], v[244:247]
    ds_read_b64_tr_b16 v[78:79], v13 offset:41984
    s_waitcnt lgkmcnt(8)
    v_mfma_f32_16x16x32_bf16 v[216:219], v[88:91], v[24:27], v[216:219]
    ds_read_b64_tr_b16 v[80:81], v14 offset:40960
    v_mfma_f32_16x16x32_bf16 v[248:251], v[88:91], v[28:31], v[248:251]
    ds_read_b64_tr_b16 v[82:83], v14 offset:41984
    v_mfma_f32_16x16x32_bf16 v[220:223], v[92:95], v[24:27], v[220:223]
    ds_read_b64_tr_b16 v[84:85], v15 offset:40960
    v_mfma_f32_16x16x32_bf16 v[252:255], v[92:95], v[28:31], v[252:255]
    ds_read_b64_tr_b16 v[86:87], v15 offset:41984
    s_waitcnt lgkmcnt(8)
    s_waitcnt vmcnt(10)
    v_mfma_f32_16x16x32_bf16 v[192:195], v[64:67], v[32:35], v[192:195]
    ds_read_b64_tr_b16 v[88:89], v16 offset:40960
    v_mfma_f32_16x16x32_bf16 v[224:227], v[64:67], v[36:39], v[224:227]
    ds_read_b64_tr_b16 v[90:91], v16 offset:41984
    s_mov_b32 s32, 28672
    buffer_load_dwordx4 v[96:99], v6, s[8:11], s32 offen offset:0 sc1
    v_mfma_f32_16x16x32_bf16 v[196:199], v[68:71], v[32:35], v[196:199]
    ds_read_b64_tr_b16 v[92:93], v17 offset:40960
    v_mfma_f32_16x16x32_bf16 v[228:231], v[68:71], v[36:39], v[228:231]
    ds_read_b64_tr_b16 v[94:95], v17 offset:41984
    s_waitcnt lgkmcnt(8)
    v_mfma_f32_16x16x32_bf16 v[200:203], v[72:75], v[32:35], v[200:203]
    ds_read_b64_tr_b16 v[64:65], v10 offset:49152
    v_mfma_f32_16x16x32_bf16 v[232:235], v[72:75], v[36:39], v[232:235]
    ds_read_b64_tr_b16 v[66:67], v10 offset:50176
    buffer_load_dwordx4 v[100:103], v7, s[8:11], s32 offen offset:0 sc1
    v_mfma_f32_16x16x32_bf16 v[204:207], v[76:79], v[32:35], v[204:207]
    ds_read_b64_tr_b16 v[68:69], v11 offset:49152
    v_mfma_f32_16x16x32_bf16 v[236:239], v[76:79], v[36:39], v[236:239]
    ds_read_b64_tr_b16 v[70:71], v11 offset:50176
    s_waitcnt lgkmcnt(8)
    v_mfma_f32_16x16x32_bf16 v[208:211], v[80:83], v[32:35], v[208:211]
    ds_read_b64_tr_b16 v[72:73], v12 offset:49152
    v_mfma_f32_16x16x32_bf16 v[240:243], v[80:83], v[36:39], v[240:243]
    ds_read_b64_tr_b16 v[74:75], v12 offset:50176
    buffer_load_dwordx4 v[104:107], v6, s[8:11], s32 offen offset:1024 sc1
    v_mfma_f32_16x16x32_bf16 v[212:215], v[84:87], v[32:35], v[212:215]
    ds_read_b64_tr_b16 v[76:77], v13 offset:49152
    v_mfma_f32_16x16x32_bf16 v[244:247], v[84:87], v[36:39], v[244:247]
    ds_read_b64_tr_b16 v[78:79], v13 offset:50176
    s_waitcnt lgkmcnt(8)
    v_mfma_f32_16x16x32_bf16 v[216:219], v[88:91], v[32:35], v[216:219]
    ds_read_b64_tr_b16 v[80:81], v14 offset:49152
    v_mfma_f32_16x16x32_bf16 v[248:251], v[88:91], v[36:39], v[248:251]
    ds_read_b64_tr_b16 v[82:83], v14 offset:50176
    buffer_load_dwordx4 v[108:111], v7, s[8:11], s32 offen offset:1024 sc1
    v_mfma_f32_16x16x32_bf16 v[220:223], v[92:95], v[32:35], v[220:223]
    ds_read_b64_tr_b16 v[84:85], v15 offset:49152
    v_mfma_f32_16x16x32_bf16 v[252:255], v[92:95], v[36:39], v[252:255]
    ds_read_b64_tr_b16 v[86:87], v15 offset:50176
    s_waitcnt lgkmcnt(8)
    s_waitcnt vmcnt(10)
    v_mfma_f32_16x16x32_bf16 v[192:195], v[64:67], v[40:43], v[192:195]
    ds_read_b64_tr_b16 v[88:89], v16 offset:49152
    v_mfma_f32_16x16x32_bf16 v[224:227], v[64:67], v[44:47], v[224:227]
    ds_read_b64_tr_b16 v[90:91], v16 offset:50176
    buffer_store_dwordx4 v[180:183], v59, s[16:19], s49 offen sc1
    v_mfma_f32_16x16x32_bf16 v[196:199], v[68:71], v[40:43], v[196:199]
    ds_read_b64_tr_b16 v[92:93], v17 offset:49152
    v_mfma_f32_16x16x32_bf16 v[228:231], v[68:71], v[44:47], v[228:231]
    ds_read_b64_tr_b16 v[94:95], v17 offset:50176
    s_waitcnt lgkmcnt(8)
    v_mfma_f32_16x16x32_bf16 v[200:203], v[72:75], v[40:43], v[200:203]
    ds_read_b64_tr_b16 v[64:65], v10 offset:57344
    v_mfma_f32_16x16x32_bf16 v[232:235], v[72:75], v[44:47], v[232:235]
    ds_read_b64_tr_b16 v[66:67], v10 offset:58368
    v_add_u32 v10, 4294868992, v10
    v_mfma_f32_16x16x32_bf16 v[204:207], v[76:79], v[40:43], v[204:207]
    ds_read_b64_tr_b16 v[68:69], v11 offset:57344
    v_mfma_f32_16x16x32_bf16 v[236:239], v[76:79], v[44:47], v[236:239]
    ds_read_b64_tr_b16 v[70:71], v11 offset:58368
    v_add_u32 v11, 4294868992, v11
    s_waitcnt lgkmcnt(8)
    v_mfma_f32_16x16x32_bf16 v[208:211], v[80:83], v[40:43], v[208:211]
    ds_read_b64_tr_b16 v[72:73], v12 offset:57344
    v_mfma_f32_16x16x32_bf16 v[240:243], v[80:83], v[44:47], v[240:243]
    ds_read_b64_tr_b16 v[74:75], v12 offset:58368
    v_add_u32 v12, 4294868992, v12
    v_mfma_f32_16x16x32_bf16 v[212:215], v[84:87], v[40:43], v[212:215]
    ds_read_b64_tr_b16 v[76:77], v13 offset:57344
    v_mfma_f32_16x16x32_bf16 v[244:247], v[84:87], v[44:47], v[244:247]
    ds_read_b64_tr_b16 v[78:79], v13 offset:58368
    v_add_u32 v13, 4294868992, v13
    s_waitcnt lgkmcnt(8)
    v_mfma_f32_16x16x32_bf16 v[216:219], v[88:91], v[40:43], v[216:219]
    ds_read_b64_tr_b16 v[80:81], v14 offset:57344
    buffer_load_dwordx4 v[112:115], v6, s[8:11], s32 offen offset:2048 sc1
    v_mfma_f32_16x16x32_bf16 v[248:251], v[88:91], v[44:47], v[248:251]
    ds_read_b64_tr_b16 v[82:83], v14 offset:58368
    v_add_u32 v14, 4294868992, v14
    v_mfma_f32_16x16x32_bf16 v[220:223], v[92:95], v[40:43], v[220:223]
    ds_read_b64_tr_b16 v[84:85], v15 offset:57344
    v_mfma_f32_16x16x32_bf16 v[252:255], v[92:95], v[44:47], v[252:255]
    ds_read_b64_tr_b16 v[86:87], v15 offset:58368
    v_add_u32 v15, 4294868992, v15
    s_waitcnt lgkmcnt(8)
    s_waitcnt vmcnt(8)
    v_mfma_f32_16x16x32_bf16 v[192:195], v[64:67], v[48:51], v[192:195]
    ds_read_b64_tr_b16 v[88:89], v16 offset:57344
    v_mfma_f32_16x16x32_bf16 v[224:227], v[64:67], v[52:55], v[224:227]
    ds_read_b64_tr_b16 v[90:91], v16 offset:58368
    v_add_u32 v16, 4294868992, v16
    buffer_load_dwordx4 v[116:119], v7, s[8:11], s32 offen offset:2048 sc1
    v_mfma_f32_16x16x32_bf16 v[196:199], v[68:71], v[48:51], v[196:199]
    ds_read_b64_tr_b16 v[92:93], v17 offset:57344
    v_mfma_f32_16x16x32_bf16 v[228:231], v[68:71], v[52:55], v[228:231]
    ds_read_b64_tr_b16 v[94:95], v17 offset:58368
    v_add_u32 v17, 4294868992, v17
    s_waitcnt vmcnt(8)
    s_cmp_eq_u32 s28, 0
    s_cbranch_scc1 L_recurrent_scan__compressed_kv_cla__moe_arch_mod__prompt_kernel_rare_48
L_recurrent_scan__compressed_kv_cla__moe_arch_mod__prompt_kernel_back_49:
    s_waitcnt lgkmcnt(0)
    s_barrier
    v_mfma_f32_16x16x32_bf16 v[200:203], v[72:75], v[48:51], v[200:203]
    ds_read_b64_tr_b16 v[64:65], v10 offset:32768
    v_mfma_f32_16x16x32_bf16 v[232:235], v[72:75], v[52:55], v[232:235]
    ds_read_b64_tr_b16 v[66:67], v10 offset:33792
    s_add_u32 m0, s33, 0
    s_add_u32 s31, s45, 0
    buffer_load_dwordx4 v8, s[12:15], s31 offen offset:0 sc1 lds
    v_mfma_f32_16x16x32_bf16 v[204:207], v[76:79], v[48:51], v[204:207]
    ds_read_b64_tr_b16 v[68:69], v11 offset:32768
    v_mfma_f32_16x16x32_bf16 v[236:239], v[76:79], v[52:55], v[236:239]
    ds_read_b64_tr_b16 v[70:71], v11 offset:33792
    v_mfma_f32_16x16x32_bf16 v[208:211], v[80:83], v[48:51], v[208:211]
    ds_read_b64_tr_b16 v[72:73], v12 offset:32768
    v_mfma_f32_16x16x32_bf16 v[240:243], v[80:83], v[52:55], v[240:243]
    ds_read_b64_tr_b16 v[74:75], v12 offset:33792
    buffer_load_dwordx4 v[120:123], v6, s[8:11], s32 offen offset:3072 sc1
    v_mfma_f32_16x16x32_bf16 v[212:215], v[84:87], v[48:51], v[212:215]
    ds_read_b64_tr_b16 v[76:77], v13 offset:32768
    v_mfma_f32_16x16x32_bf16 v[244:247], v[84:87], v[52:55], v[244:247]
    ds_read_b64_tr_b16 v[78:79], v13 offset:33792
    v_mfma_f32_16x16x32_bf16 v[216:219], v[88:91], v[48:51], v[216:219]
    ds_read_b64_tr_b16 v[80:81], v14 offset:32768
    v_mfma_f32_16x16x32_bf16 v[248:251], v[88:91], v[52:55], v[248:251]
    ds_read_b64_tr_b16 v[82:83], v14 offset:33792
    buffer_load_dwordx4 v[124:127], v7, s[8:11], s32 offen offset:3072 sc1
    v_mfma_f32_16x16x32_bf16 v[220:223], v[92:95], v[48:51], v[220:223]
    ds_read_b64_tr_b16 v[84:85], v15 offset:32768
    v_mfma_f32_16x16x32_bf16 v[252:255], v[92:95], v[52:55], v[252:255]
    ds_read_b64_tr_b16 v[86:87], v15 offset:33792
    s_waitcnt lgkmcnt(8)
    s_waitcnt vmcnt(8)
    v_mfma_f32_16x16x32_bf16 v[192:195], v[64:67], v[96:99], v[192:195]
    ds_read_b64_tr_b16 v[88:89], v16 offset:32768
    v_mfma_f32_16x16x32_bf16 v[224:227], v[64:67], v[100:103], v[224:227]
    ds_read_b64_tr_b16 v[90:91], v16 offset:33792
    buffer_store_dwordx4 v[184:187], v60, s[16:19], s49 offen sc1
    v_mfma_f32_16x16x32_bf16 v[196:199], v[68:71], v[96:99], v[196:199]
    ds_read_b64_tr_b16 v[92:93], v17 offset:32768
    v_mfma_f32_16x16x32_bf16 v[228:231], v[68:71], v[100:103], v[228:231]
    ds_read_b64_tr_b16 v[94:95], v17 offset:33792
    s_waitcnt lgkmcnt(8)
    v_mfma_f32_16x16x32_bf16 v[200:203], v[72:75], v[96:99], v[200:203]
    ds_read_b64_tr_b16 v[64:65], v10 offset:40960
    v_mfma_f32_16x16x32_bf16 v[232:235], v[72:75], v[100:103], v[232:235]
    ds_read_b64_tr_b16 v[66:67], v10 offset:41984
    v_mfma_f32_16x16x32_bf16 v[204:207], v[76:79], v[96:99], v[204:207]
    ds_read_b64_tr_b16 v[68:69], v11 offset:40960
    v_mfma_f32_16x16x32_bf16 v[236:239], v[76:79], v[100:103], v[236:239]
    ds_read_b64_tr_b16 v[70:71], v11 offset:41984
    s_waitcnt lgkmcnt(8)
    v_mfma_f32_16x16x32_bf16 v[208:211], v[80:83], v[96:99], v[208:211]
    ds_read_b64_tr_b16 v[72:73], v12 offset:40960
    v_mfma_f32_16x16x32_bf16 v[240:243], v[80:83], v[100:103], v[240:243]
    ds_read_b64_tr_b16 v[74:75], v12 offset:41984
    v_mfma_f32_16x16x32_bf16 v[212:215], v[84:87], v[96:99], v[212:215]
    ds_read_b64_tr_b16 v[76:77], v13 offset:40960
    v_mfma_f32_16x16x32_bf16 v[244:247], v[84:87], v[100:103], v[244:247]
    ds_read_b64_tr_b16 v[78:79], v13 offset:41984
    s_waitcnt lgkmcnt(8)
    v_mfma_f32_16x16x32_bf16 v[216:219], v[88:91], v[96:99], v[216:219]
    ds_read_b64_tr_b16 v[80:81], v14 offset:40960
    buffer_load_dwordx4 v8, s[12:15], s31 offen offset:1024 sc1 lds
    v_mfma_f32_16x16x32_bf16 v[248:251], v[88:91], v[100:103], v[248:251]
    ds_read_b64_tr_b16 v[82:83], v14 offset:41984
    v_mfma_f32_16x16x32_bf16 v[220:223], v[92:95], v[96:99], v[220:223]
    ds_read_b64_tr_b16 v[84:85], v15 offset:40960
    v_mfma_f32_16x16x32_bf16 v[252:255], v[92:95], v[100:103], v[252:255]
    ds_read_b64_tr_b16 v[86:87], v15 offset:41984
    s_waitcnt lgkmcnt(8)
    s_waitcnt vmcnt(8)
    v_mfma_f32_16x16x32_bf16 v[192:195], v[64:67], v[104:107], v[192:195]
    ds_read_b64_tr_b16 v[88:89], v16 offset:40960
    buffer_load_dwordx4 v8, s[12:15], s31 offen offset:2048 sc1 lds
    v_mfma_f32_16x16x32_bf16 v[224:227], v[64:67], v[108:111], v[224:227]
    ds_read_b64_tr_b16 v[90:91], v16 offset:41984
    v_mfma_f32_16x16x32_bf16 v[196:199], v[68:71], v[104:107], v[196:199]
    ds_read_b64_tr_b16 v[92:93], v17 offset:40960
    v_mfma_f32_16x16x32_bf16 v[228:231], v[68:71], v[108:111], v[228:231]
    ds_read_b64_tr_b16 v[94:95], v17 offset:41984
    s_waitcnt lgkmcnt(8)
    v_mfma_f32_16x16x32_bf16 v[200:203], v[72:75], v[104:107], v[200:203]
    ds_read_b64_tr_b16 v[64:65], v10 offset:49152
    v_mfma_f32_16x16x32_bf16 v[232:235], v[72:75], v[108:111], v[232:235]
    ds_read_b64_tr_b16 v[66:67], v10 offset:50176
    buffer_load_dwordx4 v8, s[12:15], s31 offen offset:3072 sc1 lds
    v_mfma_f32_16x16x32_bf16 v[204:207], v[76:79], v[104:107], v[204:207]
    ds_read_b64_tr_b16 v[68:69], v11 offset:49152
    v_mfma_f32_16x16x32_bf16 v[236:239], v[76:79], v[108:111], v[236:239]
    ds_read_b64_tr_b16 v[70:71], v11 offset:50176
    s_waitcnt lgkmcnt(8)
    v_mfma_f32_16x16x32_bf16 v[208:211], v[80:83], v[104:107], v[208:211]
    ds_read_b64_tr_b16 v[72:73], v12 offset:49152
    v_mfma_f32_16x16x32_bf16 v[240:243], v[80:83], v[108:111], v[240:243]
    ds_read_b64_tr_b16 v[74:75], v12 offset:50176
    s_add_u32 m0, s33, 65536
    s_add_u32 s31, s45, 32768
    buffer_load_dwordx4 v8, s[12:15], s31 offen offset:0 sc1 lds
    v_mfma_f32_16x16x32_bf16 v[212:215], v[84:87], v[104:107], v[212:215]
    ds_read_b64_tr_b16 v[76:77], v13 offset:49152
    v_mfma_f32_16x16x32_bf16 v[244:247], v[84:87], v[108:111], v[244:247]
    ds_read_b64_tr_b16 v[78:79], v13 offset:50176
    s_waitcnt lgkmcnt(8)
    v_mfma_f32_16x16x32_bf16 v[216:219], v[88:91], v[104:107], v[216:219]
    ds_read_b64_tr_b16 v[80:81], v14 offset:49152
    v_mfma_f32_16x16x32_bf16 v[248:251], v[88:91], v[108:111], v[248:251]
    ds_read_b64_tr_b16 v[82:83], v14 offset:50176
    buffer_store_dwordx4 v[188:191], v61, s[16:19], s49 offen sc1
    v_mfma_f32_16x16x32_bf16 v[220:223], v[92:95], v[104:107], v[220:223]
    ds_read_b64_tr_b16 v[84:85], v15 offset:49152
    v_mfma_f32_16x16x32_bf16 v[252:255], v[92:95], v[108:111], v[252:255]
    ds_read_b64_tr_b16 v[86:87], v15 offset:50176
    s_waitcnt lgkmcnt(8)
    s_waitcnt vmcnt(9)
    v_mfma_f32_16x16x32_bf16 v[192:195], v[64:67], v[112:115], v[192:195]
    ds_read_b64_tr_b16 v[88:89], v16 offset:49152
    v_mfma_f32_16x16x32_bf16 v[224:227], v[64:67], v[116:119], v[224:227]
    ds_read_b64_tr_b16 v[90:91], v16 offset:50176
    v_mfma_f32_16x16x32_bf16 v[196:199], v[68:71], v[112:115], v[196:199]
    ds_read_b64_tr_b16 v[92:93], v17 offset:49152
    v_mfma_f32_16x16x32_bf16 v[228:231], v[68:71], v[116:119], v[228:231]
    ds_read_b64_tr_b16 v[94:95], v17 offset:50176
    s_waitcnt lgkmcnt(8)
    v_mfma_f32_16x16x32_bf16 v[200:203], v[72:75], v[112:115], v[200:203]
    ds_read_b64_tr_b16 v[64:65], v10 offset:57344
    v_mfma_f32_16x16x32_bf16 v[232:235], v[72:75], v[116:119], v[232:235]
    ds_read_b64_tr_b16 v[66:67], v10 offset:58368
    v_mfma_f32_16x16x32_bf16 v[204:207], v[76:79], v[112:115], v[204:207]
    ds_read_b64_tr_b16 v[68:69], v11 offset:57344
    v_mfma_f32_16x16x32_bf16 v[236:239], v[76:79], v[116:119], v[236:239]
    ds_read_b64_tr_b16 v[70:71], v11 offset:58368
    s_waitcnt lgkmcnt(8)
    v_mfma_f32_16x16x32_bf16 v[208:211], v[80:83], v[112:115], v[208:211]
    ds_read_b64_tr_b16 v[72:73], v12 offset:57344
    buffer_load_dwordx4 v8, s[12:15], s31 offen offset:1024 sc1 lds
    v_mfma_f32_16x16x32_bf16 v[240:243], v[80:83], v[116:119], v[240:243]
    ds_read_b64_tr_b16 v[74:75], v12 offset:58368
    v_mfma_f32_16x16x32_bf16 v[212:215], v[84:87], v[112:115], v[212:215]
    ds_read_b64_tr_b16 v[76:77], v13 offset:57344
    v_mfma_f32_16x16x32_bf16 v[244:247], v[84:87], v[116:119], v[244:247]
    ds_read_b64_tr_b16 v[78:79], v13 offset:58368
    s_waitcnt lgkmcnt(8)
    v_mfma_f32_16x16x32_bf16 v[216:219], v[88:91], v[112:115], v[216:219]
    ds_read_b64_tr_b16 v[80:81], v14 offset:57344
    buffer_load_dwordx4 v8, s[12:15], s31 offen offset:2048 sc1 lds
    v_mfma_f32_16x16x32_bf16 v[248:251], v[88:91], v[116:119], v[248:251]
    ds_read_b64_tr_b16 v[82:83], v14 offset:58368
    v_mfma_f32_16x16x32_bf16 v[220:223], v[92:95], v[112:115], v[220:223]
    ds_read_b64_tr_b16 v[84:85], v15 offset:57344
    v_mfma_f32_16x16x32_bf16 v[252:255], v[92:95], v[116:119], v[252:255]
    ds_read_b64_tr_b16 v[86:87], v15 offset:58368
    s_waitcnt lgkmcnt(8)
    s_waitcnt vmcnt(8)
    v_mfma_f32_16x16x32_bf16 v[192:195], v[64:67], v[120:123], v[192:195]
    ds_read_b64_tr_b16 v[88:89], v16 offset:57344
    buffer_load_dwordx4 v8, s[12:15], s31 offen offset:3072 sc1 lds
    v_mfma_f32_16x16x32_bf16 v[224:227], v[64:67], v[124:127], v[224:227]
    ds_read_b64_tr_b16 v[90:91], v16 offset:58368
    v_mfma_f32_16x16x32_bf16 v[196:199], v[68:71], v[120:123], v[196:199]
    ds_read_b64_tr_b16 v[92:93], v17 offset:57344
    v_mfma_f32_16x16x32_bf16 v[228:231], v[68:71], v[124:127], v[228:231]
    ds_read_b64_tr_b16 v[94:95], v17 offset:58368
    s_waitcnt lgkmcnt(8)
    v_mfma_f32_16x16x32_bf16 v[200:203], v[72:75], v[120:123], v[200:203]
    v_mfma_f32_16x16x32_bf16 v[232:235], v[72:75], v[124:127], v[232:235]
    v_mfma_f32_16x16x32_bf16 v[204:207], v[76:79], v[120:123], v[204:207]
    v_mfma_f32_16x16x32_bf16 v[236:239], v[76:79], v[124:127], v[236:239]
    s_waitcnt lgkmcnt(4)
    v_mfma_f32_16x16x32_bf16 v[208:211], v[80:83], v[120:123], v[208:211]
    v_mfma_f32_16x16x32_bf16 v[240:243], v[80:83], v[124:127], v[240:243]
    v_mfma_f32_16x16x32_bf16 v[212:215], v[84:87], v[120:123], v[212:215]
    v_mfma_f32_16x16x32_bf16 v[244:247], v[84:87], v[124:127], v[244:247]
    s_waitcnt lgkmcnt(0)
    v_mfma_f32_16x16x32_bf16 v[216:219], v[88:91], v[120:123], v[216:219]
    v_mfma_f32_16x16x32_bf16 v[248:251], v[88:91], v[124:127], v[248:251]
    v_mfma_f32_16x16x32_bf16 v[220:223], v[92:95], v[120:123], v[220:223]
    v_mfma_f32_16x16x32_bf16 v[252:255], v[92:95], v[124:127], v[252:255]
    s_load_dwordx2 s[32:33], s[0:1], 40
    s_load_dwordx2 s[34:35], s[0:1], 80
    s_load_dwordx2 s[96:97], s[0:1], 0
    s_load_dwordx2 s[98:99], s[0:1], 88
    s_cmp_lt_u32 s28, 4
    s_cbranch_scc0 L_grp1
    v_mov_b32 v20, 1040356334
    v_mov_b32 v21, v20
    s_and_b32 s37, s28, 3
    s_lshl_b32 s37, s37, 13
    v_lshlrev_b32 v7, 4, v1
    v_add_u32 v4, s37, v7
    v_add_u32 v19, 131072, v4
    v_add_u32 v6, 4096, v4
    s_add_u32 s43, s37, 32768
    s_add_u32 s44, s37, 98304
    v_pk_mul_f32 v[192:193], v[192:193], v[20:21]
    v_pk_mul_f32 v[194:195], v[194:195], v[20:21]
    v_pk_mul_f32 v[196:197], v[196:197], v[20:21]
    v_pk_mul_f32 v[198:199], v[198:199], v[20:21]
    v_cvt_pk_bf16_f32 v128, v192, v193
    v_cvt_pk_bf16_f32 v129, v194, v195
    v_cvt_pk_bf16_f32 v130, v196, v197
    v_cvt_pk_bf16_f32 v131, v198, v199
    ds_write_b128 v19, v[128:131] offset:0
    v_pk_mul_f32 v[224:225], v[224:225], v[20:21]
    v_pk_mul_f32 v[226:227], v[226:227], v[20:21]
    v_pk_mul_f32 v[228:229], v[228:229], v[20:21]
    v_pk_mul_f32 v[230:231], v[230:231], v[20:21]
    v_cvt_pk_bf16_f32 v144, v224, v225
    v_cvt_pk_bf16_f32 v145, v226, v227
    v_cvt_pk_bf16_f32 v146, v228, v229
    v_cvt_pk_bf16_f32 v147, v230, v231
    ds_write_b128 v19, v[144:147] offset:4096
    v_pk_mul_f32 v[200:201], v[200:201], v[20:21]
    v_pk_mul_f32 v[202:203], v[202:203], v[20:21]
    v_pk_mul_f32 v[204:205], v[204:205], v[20:21]
    v_pk_mul_f32 v[206:207], v[206:207], v[20:21]
    v_cvt_pk_bf16_f32 v132, v200, v201
    v_cvt_pk_bf16_f32 v133, v202, v203
    v_cvt_pk_bf16_f32 v134, v204, v205
    v_cvt_pk_bf16_f32 v135, v206, v207
    ds_write_b128 v19, v[132:135] offset:1024
    v_pk_mul_f32 v[232:233], v[232:233], v[20:21]
    v_pk_mul_f32 v[234:235], v[234:235], v[20:21]
    v_pk_mul_f32 v[236:237], v[236:237], v[20:21]
    v_pk_mul_f32 v[238:239], v[238:239], v[20:21]
    v_cvt_pk_bf16_f32 v148, v232, v233
    v_cvt_pk_bf16_f32 v149, v234, v235
    v_cvt_pk_bf16_f32 v150, v236, v237
    v_cvt_pk_bf16_f32 v151, v238, v239
    ds_write_b128 v19, v[148:151] offset:5120
    v_pk_mul_f32 v[208:209], v[208:209], v[20:21]
    v_pk_mul_f32 v[210:211], v[210:211], v[20:21]
    v_pk_mul_f32 v[212:213], v[212:213], v[20:21]
    v_pk_mul_f32 v[214:215], v[214:215], v[20:21]
    v_cvt_pk_bf16_f32 v136, v208, v209
    v_cvt_pk_bf16_f32 v137, v210, v211
    v_cvt_pk_bf16_f32 v138, v212, v213
    v_cvt_pk_bf16_f32 v139, v214, v215
    ds_write_b128 v19, v[136:139] offset:2048
    v_pk_mul_f32 v[240:241], v[240:241], v[20:21]
    v_pk_mul_f32 v[242:243], v[242:243], v[20:21]
    v_pk_mul_f32 v[244:245], v[244:245], v[20:21]
    v_pk_mul_f32 v[246:247], v[246:247], v[20:21]
    v_cvt_pk_bf16_f32 v152, v240, v241
    v_cvt_pk_bf16_f32 v153, v242, v243
    v_cvt_pk_bf16_f32 v154, v244, v245
    v_cvt_pk_bf16_f32 v155, v246, v247
    ds_write_b128 v19, v[152:155] offset:6144
    v_pk_mul_f32 v[216:217], v[216:217], v[20:21]
    v_pk_mul_f32 v[218:219], v[218:219], v[20:21]
    v_pk_mul_f32 v[220:221], v[220:221], v[20:21]
    v_pk_mul_f32 v[222:223], v[222:223], v[20:21]
    v_cvt_pk_bf16_f32 v140, v216, v217
    v_cvt_pk_bf16_f32 v141, v218, v219
    v_cvt_pk_bf16_f32 v142, v220, v221
    v_cvt_pk_bf16_f32 v143, v222, v223
    ds_write_b128 v19, v[140:143] offset:3072
    v_pk_mul_f32 v[248:249], v[248:249], v[20:21]
    v_pk_mul_f32 v[250:251], v[250:251], v[20:21]
    v_pk_mul_f32 v[252:253], v[252:253], v[20:21]
    v_pk_mul_f32 v[254:255], v[254:255], v[20:21]
    v_cvt_pk_bf16_f32 v156, v248, v249
    v_cvt_pk_bf16_f32 v157, v250, v251
    v_cvt_pk_bf16_f32 v158, v252, v253
    v_cvt_pk_bf16_f32 v159, v254, v255
    ds_write_b128 v19, v[156:159] offset:7168
    v_mov_b32 v2, v7
    v_and_b32 v21, 15, v1
    v_lshrrev_b32 v22, 4, v1
    v_lshlrev_b32 v22, 2, v22
    v_sub_u32 v18, v21, v22
    s_mov_b32 s40, 0
    s_mov_b32 s41, 16384
    s_mov_b32 s49, 0xffff
    s_lshl_b32 s51, s30, 1
    s_add_u32 s51, s51, 1
    s_and_b32 s50, s28, 3
    s_lshl_b32 s50, s50, 5
    s_lshl_b32 s31, 1, s51
    s_or_b32 s31, s31, 0x8000
    s_add_u32 s36, s51, 1
    s_lshl_b32 s36, -1, s36
    s_or_b32 s48, s36, 0xaaaaaaab
    s_and_b32 s48, s48, 0x7fff
    s_or_b32 s39, s36, 0x55555555
    s_and_b32 s39, s39, 0xffff
    s_add_u32 s46, s45, 65536
    s_add_u32 s47, s45, 98304
    s_mov_b64 s[52:53], 0
    s_waitcnt vmcnt(3) lgkmcnt(0)
    s_barrier
    ds_read_b128 v[64:67], v2 offset:0
    ds_read_b128 v[68:71], v2 offset:1024
    ds_read_b128 v[72:75], v2 offset:2048
    ds_read_b128 v[76:79], v2 offset:3072
    ds_read_b128 v[80:83], v2 offset:4096
    ds_read_b128 v[84:87], v2 offset:5120
    ds_read_b128 v[88:91], v2 offset:6144
    ds_read_b128 v[92:95], v2 offset:7168
    v_mov_b32 v36, 0x3f803f80
    v_mov_b32 v37, 0x3f803f80
    v_mov_b32 v38, 0x3f803f80
    v_mov_b32 v39, 0x3f803f80
    s_add_u32 s16, s54, 41943040
    s_addc_u32 s17, s55, 0
    s_and_b32 s17, s17, 0xffff
    s_mov_b32 s18, 117440640
    s_mov_b32 s19, 0x20000
    s_mov_b32 s4, s92
    s_and_b32 s5, s93, 0xffff
    s_mov_b32 s6, 7340032
    s_mov_b32 s7, 0x20000
    s_mov_b32 s8, s94
    s_and_b32 s9, s95, 0xffff
    s_mov_b32 s10, 7340032
    s_mov_b32 s11, 0x20000
    s_and_b32 s60, s29, 3
    s_add_u32 s60, s60, 4
    s_sub_u32 s3, s2, 32
    s_cmp_eq_u32 s28, 0
    s_cselect_b32 s36, 0xad, 0x2d
    s_cselect_b32 s42, 14, 12
    s_cmp_lt_u32 s3, 224
    s_cselect_b32 s36, s36, 0
    s_lshl_b32 s36, s36, s60
    s_or_b32 s42, s42, s36
    s_waitcnt lgkmcnt(7)
    v_mfma_f32_16x16x32_bf16 v[96:99], v[64:67], v[128:131], 0
    v_mov_b64 v[192:193], 0
    v_mov_b64 v[194:195], 0
    v_mfma_f32_16x16x32_bf16 v[104:107], v[64:67], v[144:147], 0
    ds_read_b128 v[64:67], v2 offset:8192
    v_mov_b64 v[196:197], 0
    v_mov_b64 v[198:199], 0
    s_waitcnt lgkmcnt(7)
    v_mfma_f32_16x16x32_bf16 v[96:99], v[68:71], v[132:135], v[96:99]
    v_mov_b64 v[200:201], 0
    v_mov_b64 v[202:203], 0
    v_mfma_f32_16x16x32_bf16 v[104:107], v[68:71], v[148:151], v[104:107]
    ds_read_b128 v[68:71], v2 offset:9216
    v_mov_b64 v[204:205], 0
    v_mov_b64 v[206:207], 0
    s_waitcnt lgkmcnt(7)
    v_mfma_f32_16x16x32_bf16 v[96:99], v[72:75], v[136:139], v[96:99]
    v_mov_b64 v[208:209], 0
    v_mov_b64 v[210:211], 0
    v_mfma_f32_16x16x32_bf16 v[104:107], v[72:75], v[152:155], v[104:107]
    ds_read_b128 v[72:75], v2 offset:10240
    v_mov_b64 v[212:213], 0
    v_mov_b64 v[214:215], 0
    s_waitcnt lgkmcnt(7)
    v_mfma_f32_16x16x32_bf16 v[96:99], v[76:79], v[140:143], v[96:99]
    v_mov_b64 v[216:217], 0
    v_mov_b64 v[218:219], 0
    v_mfma_f32_16x16x32_bf16 v[104:107], v[76:79], v[156:159], v[104:107]
    ds_read_b128 v[76:79], v2 offset:11264
    v_mov_b64 v[220:221], 0
    s_waitcnt lgkmcnt(7)
    v_mfma_f32_16x16x32_bf16 v[100:103], v[80:83], v[128:131], 0
    v_mov_b64 v[222:223], 0
    v_mov_b64 v[224:225], 0
    v_mfma_f32_16x16x32_bf16 v[108:111], v[80:83], v[144:147], 0
    ds_read_b128 v[80:83], v2 offset:12288
    v_mov_b64 v[226:227], 0
    v_mov_b64 v[228:229], 0
    s_waitcnt lgkmcnt(7)
    v_mfma_f32_16x16x32_bf16 v[100:103], v[84:87], v[132:135], v[100:103]
    v_mov_b64 v[230:231], 0
    v_mov_b64 v[232:233], 0
    v_mfma_f32_16x16x32_bf16 v[108:111], v[84:87], v[148:151], v[108:111]
    ds_read_b128 v[84:87], v2 offset:13312
    v_mov_b64 v[234:235], 0
    v_mov_b64 v[236:237], 0
    s_waitcnt lgkmcnt(7)
    v_mfma_f32_16x16x32_bf16 v[100:103], v[88:91], v[136:139], v[100:103]
    v_mov_b64 v[238:239], 0
    v_mov_b64 v[240:241], 0
    v_mfma_f32_16x16x32_bf16 v[108:111], v[88:91], v[152:155], v[108:111]
    ds_read_b128 v[88:91], v2 offset:14336
    v_mov_b64 v[242:243], 0
    v_mov_b64 v[244:245], 0
    s_waitcnt lgkmcnt(7)
    v_mfma_f32_16x16x32_bf16 v[100:103], v[92:95], v[140:143], v[100:103]
    v_mov_b64 v[246:247], 0
    v_mfma_f32_16x16x32_bf16 v[108:111], v[92:95], v[156:159], v[108:111]
    ds_read_b128 v[92:95], v2 offset:15360
    v_mov_b64 v[248:249], 0
    v_mov_b64 v[250:251], 0
    v_mov_b64 v[252:253], 0
    v_mov_b64 v[254:255], 0
    v_mov_b64 v[28:29], 0
    v_mov_b64 v[30:31], 0
    v_mov_b64 v[32:33], 0
    v_mov_b64 v[34:35], 0
    v_max3_f32 v22, v96, v97, v98
    v_max3_f32 v23, v104, v105, v106
    v_max3_f32 v22, v22, v99, v100
    v_max3_f32 v23, v23, v107, v108
    v_max3_f32 v22, v22, v101, v102
    v_max3_f32 v23, v23, v109, v110
    v_max_f32 v22, v22, v103
    v_max_f32 v23, v23, v111
    v_mov_b32 v24, v22
    v_mov_b32 v25, v23
    s_nop 0
    v_permlane16_swap_b32 v22, v24
    v_permlane16_swap_b32 v23, v25
    s_nop 0
    v_max_f32 v22, v22, v24
    v_max_f32 v23, v23, v25
    v_mov_b32 v24, v22
    v_mov_b32 v25, v23
    s_nop 0
    v_permlane32_swap_b32 v22, v24
    v_permlane32_swap_b32 v23, v25
    s_nop 0
    v_max_f32 v22, v22, v24
    v_max_f32 v23, v23, v25
    v_sub_f32 v40, 0, v22
    v_sub_f32 v41, 0, v22
    v_sub_f32 v42, 0, v22
    v_sub_f32 v43, 0, v22
    v_sub_f32 v44, 0, v23
    v_sub_f32 v45, 0, v23
    v_sub_f32 v46, 0, v23
    v_sub_f32 v47, 0, v23
    v_add_f32 v96, v96, v40
    v_add_f32 v97, v97, v40
    s_waitcnt lgkmcnt(7)
    v_mfma_f32_16x16x32_bf16 v[112:115], v[64:67], v[128:131], v[40:43]
    v_exp_f32 v96, v96
    v_add_f32 v98, v98, v40
    v_mfma_f32_16x16x32_bf16 v[120:123], v[64:67], v[144:147], v[44:47]
    v_exp_f32 v97, v97
    v_add_f32 v99, v99, v40
    s_waitcnt lgkmcnt(6)
    v_mfma_f32_16x16x32_bf16 v[112:115], v[68:71], v[132:135], v[112:115]
    v_exp_f32 v98, v98
    v_add_f32 v104, v104, v44
    v_cvt_pk_bf16_f32 v48, v96, v97
    v_mfma_f32_16x16x32_bf16 v[120:123], v[68:71], v[148:151], v[120:123]
    ds_read_b128 v[64:67], v2 offset:16384
    v_exp_f32 v99, v99
    v_add_f32 v105, v105, v44
    s_waitcnt lgkmcnt(6)
    v_mfma_f32_16x16x32_bf16 v[112:115], v[72:75], v[136:139], v[112:115]
    v_exp_f32 v104, v104
    v_add_f32 v106, v106, v44
    v_cvt_pk_bf16_f32 v49, v98, v99
    v_mfma_f32_16x16x32_bf16 v[120:123], v[72:75], v[152:155], v[120:123]
    ds_read_b128 v[68:71], v2 offset:17408
    v_exp_f32 v105, v105
    v_add_f32 v107, v107, v44
    s_waitcnt lgkmcnt(6)
    v_mfma_f32_16x16x32_bf16 v[112:115], v[76:79], v[140:143], v[112:115]
    v_exp_f32 v106, v106
    v_add_f32 v100, v100, v40
    v_cvt_pk_bf16_f32 v52, v104, v105
    v_mfma_f32_16x16x32_bf16 v[120:123], v[76:79], v[156:159], v[120:123]
    ds_read_b128 v[72:75], v2 offset:18432
    v_exp_f32 v107, v107
    v_add_f32 v101, v101, v40
    s_waitcnt lgkmcnt(6)
    v_mfma_f32_16x16x32_bf16 v[116:119], v[80:83], v[128:131], v[40:43]
    v_exp_f32 v100, v100
    v_add_f32 v102, v102, v40
    v_cvt_pk_bf16_f32 v53, v106, v107
    v_mfma_f32_16x16x32_bf16 v[124:127], v[80:83], v[144:147], v[44:47]
    ds_read_b128 v[76:79], v2 offset:19456
    v_exp_f32 v101, v101
    v_add_f32 v103, v103, v40
    s_waitcnt lgkmcnt(6)
    v_mfma_f32_16x16x32_bf16 v[116:119], v[84:87], v[132:135], v[116:119]
    v_exp_f32 v102, v102
    v_add_f32 v108, v108, v44
    v_cvt_pk_bf16_f32 v50, v100, v101
    v_mfma_f32_16x16x32_bf16 v[124:127], v[84:87], v[148:151], v[124:127]
    ds_read_b128 v[80:83], v2 offset:20480
    v_exp_f32 v103, v103
    v_add_f32 v109, v109, v44
    s_waitcnt lgkmcnt(6)
    v_mfma_f32_16x16x32_bf16 v[116:119], v[88:91], v[136:139], v[116:119]
    v_exp_f32 v108, v108
    v_add_f32 v110, v110, v44
    v_cvt_pk_bf16_f32 v51, v102, v103
    v_mfma_f32_16x16x32_bf16 v[124:127], v[88:91], v[152:155], v[124:127]
    ds_read_b128 v[84:87], v2 offset:21504
    v_exp_f32 v109, v109
    v_add_f32 v111, v111, v44
    s_waitcnt lgkmcnt(6)
    v_mfma_f32_16x16x32_bf16 v[116:119], v[92:95], v[140:143], v[116:119]
    v_exp_f32 v110, v110
    v_cvt_pk_bf16_f32 v54, v108, v109
    v_mfma_f32_16x16x32_bf16 v[124:127], v[92:95], v[156:159], v[124:127]
    ds_read_b128 v[88:91], v2 offset:22528
    v_exp_f32 v111, v111
    v_add_u32 v3, 65536, v2
    v_add_u32 v2, s41, v2
    v_and_b32 v2, s49, v2
    v_cvt_pk_bf16_f32 v55, v110, v111
    s_waitcnt vmcnt(0)
    s_barrier
    s_cmp_eq_u32 s28, 0
    s_cbranch_scc1 L_recurrent_scan__compressed_kv_cla__moe_arch_mod__prompt_kernel_rare_56
L_recurrent_scan__compressed_kv_cla__moe_arch_mod__prompt_kernel_back_57:
    ds_write_b32 v19, v40
    ds_write_b32 v19, v44 offset:4
    .p2align 6
L_body00:
    s_waitcnt lgkmcnt(5)
    v_mfma_f32_16x16x32_bf16 v[96:99], v[64:67], v[128:131], v[40:43]
    v_exp_f32 v112, v112
    v_mfma_f32_16x16x32_bf16 v[104:107], v[64:67], v[144:147], v[44:47]
    ds_read_b128 v[92:95], v2 offset:7168
    s_bitcmp1_b32 s48, s40
    s_cbranch_scc0 L_recurrent_scan__compressed_kv_cla__moe_arch_mod__prompt_kernel_nodma_82
    s_add_u32 m0, s43, 0
    s_nop 0
    buffer_load_dwordx4 v4, s[12:15], s46 offen offset:0 sc1 lds
    buffer_load_dwordx4 v4, s[12:15], s46 offen offset:1024 sc1 lds
L_recurrent_scan__compressed_kv_cla__moe_arch_mod__prompt_kernel_nodma_82:
    v_mfma_f32_16x16x32_bf16 v[96:99], v[68:71], v[132:135], v[96:99]
    v_exp_f32 v113, v113
    v_mfma_f32_16x16x32_bf16 v[104:107], v[68:71], v[148:151], v[104:107]
    ds_read_b128 v[64:67], v3 offset:0
    s_waitcnt lgkmcnt(5)
    v_mfma_f32_16x16x32_bf16 v[96:99], v[72:75], v[136:139], v[96:99]
    v_exp_f32 v114, v114
    v_mfma_f32_16x16x32_bf16 v[104:107], v[72:75], v[152:155], v[104:107]
    ds_read_b128 v[68:71], v3 offset:1024
    v_cvt_pk_bf16_f32 v56, v112, v113
    s_bitcmp1_b32 s48, s40
    s_cbranch_scc0 L_recurrent_scan__compressed_kv_cla__moe_arch_mod__prompt_kernel_nodma_83
    s_add_u32 m0, s43, 0
    s_nop 0
    buffer_load_dwordx4 v4, s[12:15], s46 offen offset:2048 sc1 lds
    buffer_load_dwordx4 v4, s[12:15], s46 offen offset:3072 sc1 lds
L_recurrent_scan__compressed_kv_cla__moe_arch_mod__prompt_kernel_nodma_83:
    v_mfma_f32_16x16x32_bf16 v[96:99], v[76:79], v[140:143], v[96:99]
    v_exp_f32 v115, v115
    v_mfma_f32_16x16x32_bf16 v[104:107], v[76:79], v[156:159], v[104:107]
    ds_read_b128 v[72:75], v3 offset:2048
    s_waitcnt lgkmcnt(5)
    v_mfma_f32_16x16x32_bf16 v[100:103], v[80:83], v[128:131], v[40:43]
    v_exp_f32 v120, v120
    v_mfma_f32_16x16x32_bf16 v[108:111], v[80:83], v[144:147], v[44:47]
    ds_read_b128 v[76:79], v3 offset:3072
    v_cvt_pk_bf16_f32 v57, v114, v115
    v_mfma_f32_16x16x32_bf16 v[100:103], v[84:87], v[132:135], v[100:103]
    v_exp_f32 v121, v121
    v_mfma_f32_16x16x32_bf16 v[108:111], v[84:87], v[148:151], v[108:111]
    ds_read_b128 v[80:83], v3 offset:4096
    s_bitcmp1_b32 s48, s40
    s_cbranch_scc0 L_recurrent_scan__compressed_kv_cla__moe_arch_mod__prompt_kernel_nodma_84
    s_add_u32 m0, s43, 4096
    s_nop 0
    buffer_load_dwordx4 v6, s[12:15], s46 offen offset:0 sc1 lds
    buffer_load_dwordx4 v6, s[12:15], s46 offen offset:1024 sc1 lds
L_recurrent_scan__compressed_kv_cla__moe_arch_mod__prompt_kernel_nodma_84:
    s_waitcnt lgkmcnt(5)
    v_mfma_f32_16x16x32_bf16 v[100:103], v[88:91], v[136:139], v[100:103]
    v_exp_f32 v122, v122
    v_mfma_f32_16x16x32_bf16 v[108:111], v[88:91], v[152:155], v[108:111]
    ds_read_b128 v[84:87], v3 offset:5120
    v_cvt_pk_bf16_f32 v60, v120, v121
    v_mfma_f32_16x16x32_bf16 v[100:103], v[92:95], v[140:143], v[100:103]
    v_exp_f32 v123, v123
    v_mfma_f32_16x16x32_bf16 v[108:111], v[92:95], v[156:159], v[108:111]
    ds_read_b128 v[88:91], v3 offset:6144
    s_bitcmp1_b32 s48, s40
    s_cbranch_scc0 L_recurrent_scan__compressed_kv_cla__moe_arch_mod__prompt_kernel_nodma_85
    s_add_u32 m0, s43, 4096
    s_nop 0
    buffer_load_dwordx4 v6, s[12:15], s46 offen offset:2048 sc1 lds
    buffer_load_dwordx4 v6, s[12:15], s46 offen offset:3072 sc1 lds
    s_add_u32 s46, s46, 65536
    s_xor_b32 s43, s43, 32768
L_recurrent_scan__compressed_kv_cla__moe_arch_mod__prompt_kernel_nodma_85:
    s_waitcnt lgkmcnt(5)
    v_mfma_f32_16x16x32_bf16 v[192:195], v[64:67], v[48:51], v[192:195]
    v_exp_f32 v116, v116
    v_mfma_f32_16x16x32_bf16 v[224:227], v[64:67], v[52:55], v[224:227]
    ds_read_b128 v[92:95], v3 offset:7168
    v_cvt_pk_bf16_f32 v61, v122, v123
    v_mfma_f32_16x16x32_bf16 v[196:199], v[68:71], v[48:51], v[196:199]
    v_exp_f32 v117, v117
    v_mfma_f32_16x16x32_bf16 v[228:231], v[68:71], v[52:55], v[228:231]
    ds_read_b128 v[64:67], v2 offset:8192
    s_waitcnt lgkmcnt(5)
    v_mfma_f32_16x16x32_bf16 v[200:203], v[72:75], v[48:51], v[200:203]
    v_exp_f32 v118, v118
    v_mfma_f32_16x16x32_bf16 v[232:235], v[72:75], v[52:55], v[232:235]
    v_mfma_f32_16x16x32_bf16 v[28:31], v[36:39], v[48:51], v[28:31]
    ds_read_b128 v[68:71], v2 offset:9216
    v_cvt_pk_bf16_f32 v58, v116, v117
    s_bitcmp1_b32 s39, s40
    s_cbranch_scc0 L_recurrent_scan__compressed_kv_cla__moe_arch_mod__prompt_kernel_nodma_86
    s_add_u32 m0, s44, 0
    s_nop 0
    buffer_load_dwordx4 v4, s[12:15], s47 offen offset:0 sc1 lds
    buffer_load_dwordx4 v4, s[12:15], s47 offen offset:1024 sc1 lds
L_recurrent_scan__compressed_kv_cla__moe_arch_mod__prompt_kernel_nodma_86:
    v_mfma_f32_16x16x32_bf16 v[204:207], v[76:79], v[48:51], v[204:207]
    v_exp_f32 v119, v119
    v_mfma_f32_16x16x32_bf16 v[236:239], v[76:79], v[52:55], v[236:239]
    ds_read_b128 v[72:75], v2 offset:10240
    s_waitcnt lgkmcnt(5)
    v_mfma_f32_16x16x32_bf16 v[208:211], v[80:83], v[48:51], v[208:211]
    v_exp_f32 v124, v124
    v_mfma_f32_16x16x32_bf16 v[240:243], v[80:83], v[52:55], v[240:243]
    ds_read_b128 v[76:79], v2 offset:11264
    v_cvt_pk_bf16_f32 v59, v118, v119
    s_bitcmp1_b32 s39, s40
    s_cbranch_scc0 L_recurrent_scan__compressed_kv_cla__moe_arch_mod__prompt_kernel_nodma_87
    s_add_u32 m0, s44, 0
    s_nop 0
    buffer_load_dwordx4 v4, s[12:15], s47 offen offset:2048 sc1 lds
    buffer_load_dwordx4 v4, s[12:15], s47 offen offset:3072 sc1 lds
L_recurrent_scan__compressed_kv_cla__moe_arch_mod__prompt_kernel_nodma_87:
    v_mfma_f32_16x16x32_bf16 v[212:215], v[84:87], v[48:51], v[212:215]
    v_exp_f32 v125, v125
    v_mfma_f32_16x16x32_bf16 v[244:247], v[84:87], v[52:55], v[244:247]
    ds_read_b128 v[80:83], v2 offset:12288
    s_waitcnt lgkmcnt(5)
    v_mfma_f32_16x16x32_bf16 v[216:219], v[88:91], v[48:51], v[216:219]
    v_exp_f32 v126, v126
    v_mfma_f32_16x16x32_bf16 v[248:251], v[88:91], v[52:55], v[248:251]
    v_mfma_f32_16x16x32_bf16 v[32:35], v[36:39], v[52:55], v[32:35]
    ds_read_b128 v[84:87], v2 offset:13312
    v_cvt_pk_bf16_f32 v62, v124, v125
    v_mfma_f32_16x16x32_bf16 v[220:223], v[92:95], v[48:51], v[220:223]
    v_exp_f32 v127, v127
    v_mfma_f32_16x16x32_bf16 v[252:255], v[92:95], v[52:55], v[252:255]
    ds_read_b128 v[88:91], v2 offset:14336
    v_cvt_pk_bf16_f32 v63, v126, v127
    s_bitcmp1_b32 s39, s40
    s_cbranch_scc0 L_recurrent_scan__compressed_kv_cla__moe_arch_mod__prompt_kernel_nodma_88
    s_add_u32 m0, s44, 4096
    s_nop 0
    buffer_load_dwordx4 v6, s[12:15], s47 offen offset:0 sc1 lds
    buffer_load_dwordx4 v6, s[12:15], s47 offen offset:1024 sc1 lds
L_recurrent_scan__compressed_kv_cla__moe_arch_mod__prompt_kernel_nodma_88:
    s_bitcmp1_b32 s31, s40
    s_cbranch_scc1 L_recurrent_scan__compressed_kv_cla__moe_arch_mod__prompt_kernel_rare_64
L_recurrent_scan__compressed_kv_cla__moe_arch_mod__prompt_kernel_back_65:
    s_waitcnt lgkmcnt(5)
    v_mfma_f32_16x16x32_bf16 v[112:115], v[64:67], v[128:131], v[40:43]
    v_exp_f32 v96, v96
    v_mfma_f32_16x16x32_bf16 v[120:123], v[64:67], v[144:147], v[44:47]
    ds_read_b128 v[92:95], v2 offset:15360
    v_mfma_f32_16x16x32_bf16 v[112:115], v[68:71], v[132:135], v[112:115]
    v_exp_f32 v97, v97
    v_mfma_f32_16x16x32_bf16 v[120:123], v[68:71], v[148:151], v[120:123]
    ds_read_b128 v[64:67], v3 offset:8192
    s_bitcmp1_b32 s39, s40
    s_cbranch_scc0 L_recurrent_scan__compressed_kv_cla__moe_arch_mod__prompt_kernel_nodma_89
    s_add_u32 m0, s44, 4096
    s_nop 0
    buffer_load_dwordx4 v6, s[12:15], s47 offen offset:2048 sc1 lds
    buffer_load_dwordx4 v6, s[12:15], s47 offen offset:3072 sc1 lds
    s_add_u32 s47, s47, 65536
    s_xor_b32 s44, s44, 32768
L_recurrent_scan__compressed_kv_cla__moe_arch_mod__prompt_kernel_nodma_89:
    s_waitcnt lgkmcnt(5)
    v_mfma_f32_16x16x32_bf16 v[112:115], v[72:75], v[136:139], v[112:115]
    v_exp_f32 v98, v98
    v_mfma_f32_16x16x32_bf16 v[120:123], v[72:75], v[152:155], v[120:123]
    ds_read_b128 v[68:71], v3 offset:9216
    v_cvt_pk_bf16_f32 v48, v96, v97
    v_mfma_f32_16x16x32_bf16 v[112:115], v[76:79], v[140:143], v[112:115]
    v_exp_f32 v99, v99
    v_mfma_f32_16x16x32_bf16 v[120:123], v[76:79], v[156:159], v[120:123]
    ds_read_b128 v[72:75], v3 offset:10240
    s_waitcnt lgkmcnt(5)
    v_mfma_f32_16x16x32_bf16 v[116:119], v[80:83], v[128:131], v[40:43]
    v_exp_f32 v104, v104
    v_mfma_f32_16x16x32_bf16 v[124:127], v[80:83], v[144:147], v[44:47]
    ds_read_b128 v[76:79], v3 offset:11264
    v_cvt_pk_bf16_f32 v49, v98, v99
    v_mfma_f32_16x16x32_bf16 v[116:119], v[84:87], v[132:135], v[116:119]
    v_exp_f32 v105, v105
    v_mfma_f32_16x16x32_bf16 v[124:127], v[84:87], v[148:151], v[124:127]
    ds_read_b128 v[80:83], v3 offset:12288
    s_waitcnt lgkmcnt(5)
    v_mfma_f32_16x16x32_bf16 v[116:119], v[88:91], v[136:139], v[116:119]
    v_exp_f32 v106, v106
    v_mfma_f32_16x16x32_bf16 v[124:127], v[88:91], v[152:155], v[124:127]
    ds_read_b128 v[84:87], v3 offset:13312
    v_cvt_pk_bf16_f32 v52, v104, v105
    v_mfma_f32_16x16x32_bf16 v[116:119], v[92:95], v[140:143], v[116:119]
    v_exp_f32 v107, v107
    v_mfma_f32_16x16x32_bf16 v[124:127], v[92:95], v[156:159], v[124:127]
    ds_read_b128 v[88:91], v3 offset:14336
    s_waitcnt lgkmcnt(5)
    v_mfma_f32_16x16x32_bf16 v[192:195], v[64:67], v[56:59], v[192:195]
    v_exp_f32 v100, v100
    v_mfma_f32_16x16x32_bf16 v[224:227], v[64:67], v[60:63], v[224:227]
    ds_read_b128 v[92:95], v3 offset:15360
    v_cvt_pk_bf16_f32 v53, v106, v107
    v_mfma_f32_16x16x32_bf16 v[196:199], v[68:71], v[56:59], v[196:199]
    v_exp_f32 v101, v101
    v_mfma_f32_16x16x32_bf16 v[228:231], v[68:71], v[60:63], v[228:231]
    v_add_u32 v3, 65536, v2
    v_add_u32 v2, s41, v2
    s_waitcnt lgkmcnt(4)
    v_mfma_f32_16x16x32_bf16 v[200:203], v[72:75], v[56:59], v[200:203]
    v_exp_f32 v102, v102
    s_add_u32 s40, s40, 1
    v_and_b32 v2, s49, v2
    v_mfma_f32_16x16x32_bf16 v[232:235], v[72:75], v[60:63], v[232:235]
    v_mfma_f32_16x16x32_bf16 v[28:31], v[36:39], v[56:59], v[28:31]
    v_cvt_pk_bf16_f32 v50, v100, v101
    s_waitcnt vmcnt(8) lgkmcnt(0)
    s_cmp_le_u32 s40, s51
    s_cbranch_scc1 L_recurrent_scan__compressed_kv_cla__moe_arch_mod__prompt_kernel_rlx_66
    s_waitcnt vmcnt(0)
L_recurrent_scan__compressed_kv_cla__moe_arch_mod__prompt_kernel_rlx_66:
    s_bitcmp1_b32 s42, s40
    s_cbranch_scc1 L_recurrent_scan__compressed_kv_cla__moe_arch_mod__prompt_kernel_rare_80
L_recurrent_scan__compressed_kv_cla__moe_arch_mod__prompt_kernel_back_81:
    s_barrier
    v_mfma_f32_16x16x32_bf16 v[204:207], v[76:79], v[56:59], v[204:207]
    v_exp_f32 v103, v103
    v_mfma_f32_16x16x32_bf16 v[236:239], v[76:79], v[60:63], v[236:239]
    ds_read_b128 v[68:71], v2 offset:1024
    ds_read_b128 v[64:67], v2 offset:0
    v_mfma_f32_16x16x32_bf16 v[208:211], v[80:83], v[56:59], v[208:211]
    v_exp_f32 v108, v108
    v_mfma_f32_16x16x32_bf16 v[240:243], v[80:83], v[60:63], v[240:243]
    ds_read_b128 v[76:79], v2 offset:3072
    ds_read_b128 v[72:75], v2 offset:2048
    v_cvt_pk_bf16_f32 v51, v102, v103
    v_mfma_f32_16x16x32_bf16 v[212:215], v[84:87], v[56:59], v[212:215]
    v_exp_f32 v109, v109
    v_mfma_f32_16x16x32_bf16 v[244:247], v[84:87], v[60:63], v[244:247]
    ds_read_b128 v[80:83], v2 offset:4096
    v_mfma_f32_16x16x32_bf16 v[216:219], v[88:91], v[56:59], v[216:219]
    v_exp_f32 v110, v110
    v_mfma_f32_16x16x32_bf16 v[248:251], v[88:91], v[60:63], v[248:251]
    v_mfma_f32_16x16x32_bf16 v[32:35], v[36:39], v[60:63], v[32:35]
    ds_read_b128 v[84:87], v2 offset:5120
    v_cvt_pk_bf16_f32 v54, v108, v109
    v_mfma_f32_16x16x32_bf16 v[220:223], v[92:95], v[56:59], v[220:223]
    v_exp_f32 v111, v111
    v_mfma_f32_16x16x32_bf16 v[252:255], v[92:95], v[60:63], v[252:255]
    ds_read_b128 v[88:91], v2 offset:6144
    v_cvt_pk_bf16_f32 v55, v110, v111
    s_cmp_lg_u32 s40, 16
    s_cbranch_scc1 L_body00
    s_lshr_b32 s36, s2, 5
    s_add_u32 s36, s36, 48
    s_lshl_b32 s36, s36, 7
    v_mov_b32 v12, s36
    global_load_dword v11, v12, s[90:91] sc1
    s_sub_u32 s36, 32, s50
    s_cmp_lt_i32 s36, 0
    s_cbranch_scc0 L_recurrent_scan__compressed_kv_cla__moe_arch_mod__prompt_kernel_rare_92
L_recurrent_scan__compressed_kv_cla__moe_arch_mod__prompt_kernel_back_93:
    s_lshl_b32 s37, s28, 13
    v_add_u32 v5, s37, v7
    s_waitcnt lgkmcnt(5)
    v_mfma_f32_16x16x32_bf16 v[192:195], v[64:67], v[48:51], v[192:195]
    v_exp_f32 v112, v112
    v_mfma_f32_16x16x32_bf16 v[224:227], v[64:67], v[52:55], v[224:227]
    ds_read_b128 v[92:95], v3 offset:7168
    v_exp_f32 v113, v113
    v_mfma_f32_16x16x32_bf16 v[196:199], v[68:71], v[48:51], v[196:199]
    v_cvt_pk_bf16_f32 v56, v112, v113
    v_exp_f32 v114, v114
    v_mfma_f32_16x16x32_bf16 v[228:231], v[68:71], v[52:55], v[228:231]
    ds_read_b128 v[64:67], v3 offset:8192
    v_exp_f32 v115, v115
    s_waitcnt lgkmcnt(5)
    v_mfma_f32_16x16x32_bf16 v[200:203], v[72:75], v[48:51], v[200:203]
    v_cvt_pk_bf16_f32 v57, v114, v115
    v_exp_f32 v120, v120
    v_mfma_f32_16x16x32_bf16 v[232:235], v[72:75], v[52:55], v[232:235]
    v_mfma_f32_16x16x32_bf16 v[28:31], v[36:39], v[48:51], v[28:31]
    ds_read_b128 v[68:71], v3 offset:9216
    v_exp_f32 v121, v121
    v_mfma_f32_16x16x32_bf16 v[204:207], v[76:79], v[48:51], v[204:207]
    v_cvt_pk_bf16_f32 v60, v120, v121
    v_exp_f32 v122, v122
    v_mfma_f32_16x16x32_bf16 v[236:239], v[76:79], v[52:55], v[236:239]
    ds_read_b128 v[72:75], v3 offset:10240
    v_exp_f32 v123, v123
    s_waitcnt lgkmcnt(6)
    v_mfma_f32_16x16x32_bf16 v[208:211], v[80:83], v[48:51], v[208:211]
    v_cvt_pk_bf16_f32 v61, v122, v123
    v_exp_f32 v116, v116
    v_mfma_f32_16x16x32_bf16 v[240:243], v[80:83], v[52:55], v[240:243]
    ds_read_b128 v[76:79], v3 offset:11264
    v_exp_f32 v117, v117
    s_waitcnt lgkmcnt(6)
    v_mfma_f32_16x16x32_bf16 v[212:215], v[84:87], v[48:51], v[212:215]
    v_cvt_pk_bf16_f32 v58, v116, v117
    v_exp_f32 v118, v118
    v_mfma_f32_16x16x32_bf16 v[244:247], v[84:87], v[52:55], v[244:247]
    ds_read_b128 v[80:83], v3 offset:12288
    v_exp_f32 v119, v119
    s_waitcnt lgkmcnt(6)
    v_mfma_f32_16x16x32_bf16 v[216:219], v[88:91], v[48:51], v[216:219]
    v_cvt_pk_bf16_f32 v59, v118, v119
    v_exp_f32 v124, v124
    v_mfma_f32_16x16x32_bf16 v[248:251], v[88:91], v[52:55], v[248:251]
    v_mfma_f32_16x16x32_bf16 v[32:35], v[36:39], v[52:55], v[32:35]
    ds_read_b128 v[84:87], v3 offset:13312
    v_exp_f32 v125, v125
    s_waitcnt lgkmcnt(6)
    v_mfma_f32_16x16x32_bf16 v[220:223], v[92:95], v[48:51], v[220:223]
    v_cvt_pk_bf16_f32 v62, v124, v125
    v_exp_f32 v126, v126
    v_mfma_f32_16x16x32_bf16 v[252:255], v[92:95], v[52:55], v[252:255]
    ds_read_b128 v[88:91], v3 offset:14336
    v_exp_f32 v127, v127
    s_nop 0
    v_cvt_pk_bf16_f32 v63, v126, v127
    s_nop 1
    s_waitcnt lgkmcnt(6)
    v_mfma_f32_16x16x32_bf16 v[192:195], v[64:67], v[56:59], v[192:195]
    s_mov_b32 s4, s34
    s_and_b32 s5, s35, 0xffff
    s_mov_b32 s6, 7340032
    s_mov_b32 s7, 0x20000
    s_mov_b32 s8, s32
    v_mfma_f32_16x16x32_bf16 v[224:227], v[64:67], v[60:63], v[224:227]
    ds_read_b128 v[92:95], v3 offset:15360
    s_and_b32 s9, s33, 0xffff
    s_mov_b32 s10, 8388608
    s_mov_b32 s11, 0x20000
    s_lshr_b32 s38, s2, 4
    s_waitcnt lgkmcnt(6)
    v_mfma_f32_16x16x32_bf16 v[196:199], v[68:71], v[56:59], v[196:199]
    s_mul_i32 s38, s38, 224
    s_and_b32 s39, s2, 15
    s_lshl_b32 s39, s39, 7
    v_lshrrev_b32 v25, 3, v1
    s_lshl_b32 s36, s28, 5
    v_mfma_f32_16x16x32_bf16 v[228:231], v[68:71], v[60:63], v[228:231]
    s_add_u32 s36, s36, s38
    v_add_u32 v25, s36, v25
    v_mul_u32_u24 v25, 2048, v25
    v_add_u32 v25, s39, v25
    s_waitcnt lgkmcnt(5)
    v_mfma_f32_16x16x32_bf16 v[200:203], v[72:75], v[56:59], v[200:203]
    v_bfe_u32 v26, v1, 4, 1
    v_lshlrev_b32 v26, 1, v26
    v_and_b32 v27, 7, v1
    v_xor_b32 v26, v26, v27
    v_mfma_f32_16x16x32_bf16 v[232:235], v[72:75], v[60:63], v[232:235]
    v_mfma_f32_16x16x32_bf16 v[28:31], v[36:39], v[56:59], v[28:31]
    v_lshl_add_u32 v24, v26, 4, v25
    v_xor_b32 v26, 4, v26
    v_lshl_add_u32 v25, v26, 4, v25
    v_add_u32 v25, 15360, v25
    v_add_u32 v26, 30720, v24
    s_waitcnt lgkmcnt(4)
    v_mfma_f32_16x16x32_bf16 v[204:207], v[76:79], v[56:59], v[204:207]
    v_add_u32 v27, 30720, v25
    s_lshl_b32 s36, s28, 12
    s_add_u32 s36, s36, 131072
    s_cmp_lt_u32 s28, 7
    s_cselect_b32 m0, s36, 0x30000
    s_cselect_b32 s6, 7340032, 0
    v_mfma_f32_16x16x32_bf16 v[236:239], v[76:79], v[60:63], v[236:239]
    buffer_load_dwordx4 v24, s[4:7], 0 offen offset:0 lds
    buffer_load_dwordx4 v25, s[4:7], 0 offen offset:1024 lds
    buffer_load_dwordx4 v26, s[4:7], 0 offen offset:2048 lds
    buffer_load_dwordx4 v27, s[4:7], 0 offen offset:3072 lds
    s_waitcnt lgkmcnt(3)
    v_mfma_f32_16x16x32_bf16 v[208:211], v[80:83], v[56:59], v[208:211]
    v_mfma_f32_16x16x32_bf16 v[240:243], v[80:83], v[60:63], v[240:243]
    ds_write_b128 v5, v[224:227] offset:0
    s_waitcnt lgkmcnt(3)
    v_mfma_f32_16x16x32_bf16 v[212:215], v[84:87], v[56:59], v[212:215]
    v_mfma_f32_16x16x32_bf16 v[244:247], v[84:87], v[60:63], v[244:247]
    ds_write_b128 v5, v[228:231] offset:1024
    s_waitcnt lgkmcnt(3)
    v_mfma_f32_16x16x32_bf16 v[216:219], v[88:91], v[56:59], v[216:219]
    v_mfma_f32_16x16x32_bf16 v[248:251], v[88:91], v[60:63], v[248:251]
    v_mfma_f32_16x16x32_bf16 v[32:35], v[36:39], v[60:63], v[32:35]
    ds_write_b128 v5, v[232:235] offset:2048
    s_waitcnt lgkmcnt(3)
    v_mfma_f32_16x16x32_bf16 v[220:223], v[92:95], v[56:59], v[220:223]
    v_mfma_f32_16x16x32_bf16 v[252:255], v[92:95], v[60:63], v[252:255]
    ds_write_b128 v5, v[236:239] offset:3072
    ds_write_b128 v5, v[240:243] offset:4096
    ds_write_b128 v5, v[244:247] offset:5120
    v_xor_b32 v106, 32768, v5
    s_lshl_b32 s37, s28, 8
    s_add_u32 s37, s37, 159744
    v_lshl_add_u32 v107, v1, 2, s37
    v_xor_b32 v108, 1024, v107
    ds_write_b128 v5, v[248:251] offset:6144
    ds_write_b128 v5, v[252:255] offset:7168
    ds_write_b32 v107, v32
    s_mov_b32 s36, 0x5d800000
    v_cmp_nge_f32 vcc, s36, v28
    s_nop 0
    s_or_b64 s[52:53], s[52:53], vcc
    v_cmp_nge_f32 vcc, s36, v32
    s_nop 0
    s_or_b64 s[52:53], s[52:53], vcc
    s_or_b32 s36, s52, s53
    v_mov_b32 v110, s36
    s_lshl_b32 s37, s28, 2
    s_add_u32 s37, s37, 161792
    v_mov_b32 v111, s37
    ds_write_b32 v111, v110
    v_mov_b32 v112, 161856
    v_mov_b32 v114, s56
    v_mov_b32 v115, s57
    v_mov_b32 v116, s58
    v_mov_b32 v117, s59
    ds_write_b128 v112, v[114:117]
    v_and_b32 v111, 7, v1
    v_lshlrev_b32 v111, 2, v111
    v_add_u32 v111, 161792, v111
    v_mov_b32 v113, v7
    s_sub_u32 s36, 15, s30
    s_lshl_b32 s38, s36, 3
    s_and_b32 s37, s28, 3
    s_lshl_b32 s37, s37, 1
    s_add_u32 s38, s38, s37
    s_lshl_b32 s38, s38, 17
    s_lshl_b32 s37, s29, 12
    s_add_u32 s38, s38, s37
    s_waitcnt vmcnt(4)
    v_readfirstlane_b32 s36, v11
    s_nop 0
    s_cmp_lt_u32 s36, 28
    s_cbranch_scc1 L_recurrent_scan__compressed_kv_cla__moe_arch_mod__prompt_kernel_rare_96
L_recurrent_scan__compressed_kv_cla__moe_arch_mod__prompt_kernel_back_97:
    s_lshr_b32 s36, s2, 4
    s_mul_i32 s36, s36, 7
    s_min_u32 s37, s28, 6
    s_add_u32 s36, s36, s37
    s_lshl_b32 s36, s36, 11
    s_add_u32 s36, s36, 58720256
    v_and_b32 v11, 15, v1
    v_lshlrev_b32 v11, 4, v11
    v_lshrrev_b32 v12, 4, v1
    v_lshl_add_u32 v11, v12, 9, v11
    buffer_load_dwordx4 v[96:99], v11, s[24:27], s36 offen offset:0 sc1
    buffer_load_dwordx4 v[100:103], v11, s[24:27], s36 offen offset:256 sc1
    s_waitcnt lgkmcnt(0)
    s_barrier
    ds_read_b32 v110, v111
    ds_read_b32 v109, v108
    ds_read_b128 v[64:67], v106 offset:0
    ds_read_b128 v[68:71], v106 offset:1024
    ds_read_b128 v[72:75], v106 offset:2048
    ds_read_b128 v[76:79], v106 offset:3072
    ds_read_b128 v[80:83], v106 offset:4096
    ds_read_b128 v[84:87], v106 offset:5120
    ds_read_b128 v[88:91], v106 offset:6144
    ds_read_b128 v[92:95], v106 offset:7168
    s_waitcnt lgkmcnt(8)
    v_add_f32 v109, v109, v28
    v_cmp_ne_u32 s[52:53], 0, v110
    v_rcp_f32 v109, v109
    s_nop 0
    v_mov_b32 v108, v109
    s_waitcnt lgkmcnt(6)
    v_pk_add_f32 v[192:193], v[192:193], v[64:65]
    v_pk_add_f32 v[194:195], v[194:195], v[66:67]
    v_pk_add_f32 v[196:197], v[196:197], v[68:69]
    v_pk_add_f32 v[198:199], v[198:199], v[70:71]
    v_pk_mul_f32 v[192:193], v[192:193], v[108:109]
    v_pk_mul_f32 v[194:195], v[194:195], v[108:109]
    v_pk_mul_f32 v[196:197], v[196:197], v[108:109]
    v_pk_mul_f32 v[198:199], v[198:199], v[108:109]
    v_cvt_pk_bf16_f32 v48, v192, v193
    v_cvt_pk_bf16_f32 v49, v194, v195
    v_cvt_pk_bf16_f32 v50, v196, v197
    v_cvt_pk_bf16_f32 v51, v198, v199
    buffer_store_dwordx4 v[48:51], v113, s[16:19], s38 offen offset:0 sc1
    s_waitcnt lgkmcnt(4)
    v_pk_add_f32 v[200:201], v[200:201], v[72:73]
    v_pk_add_f32 v[202:203], v[202:203], v[74:75]
    v_pk_add_f32 v[204:205], v[204:205], v[76:77]
    v_pk_add_f32 v[206:207], v[206:207], v[78:79]
    v_pk_mul_f32 v[200:201], v[200:201], v[108:109]
    v_pk_mul_f32 v[202:203], v[202:203], v[108:109]
    v_pk_mul_f32 v[204:205], v[204:205], v[108:109]
    v_pk_mul_f32 v[206:207], v[206:207], v[108:109]
    v_cvt_pk_bf16_f32 v52, v200, v201
    v_cvt_pk_bf16_f32 v53, v202, v203
    v_cvt_pk_bf16_f32 v54, v204, v205
    v_cvt_pk_bf16_f32 v55, v206, v207
    buffer_store_dwordx4 v[52:55], v113, s[16:19], s38 offen offset:1024 sc1
    s_waitcnt lgkmcnt(2)
    v_pk_add_f32 v[208:209], v[208:209], v[80:81]
    v_pk_add_f32 v[210:211], v[210:211], v[82:83]
    v_pk_add_f32 v[212:213], v[212:213], v[84:85]
    v_pk_add_f32 v[214:215], v[214:215], v[86:87]
    v_pk_mul_f32 v[208:209], v[208:209], v[108:109]
    v_pk_mul_f32 v[210:211], v[210:211], v[108:109]
    v_pk_mul_f32 v[212:213], v[212:213], v[108:109]
    v_pk_mul_f32 v[214:215], v[214:215], v[108:109]
    v_cvt_pk_bf16_f32 v56, v208, v209
    v_cvt_pk_bf16_f32 v57, v210, v211
    v_cvt_pk_bf16_f32 v58, v212, v213
    v_cvt_pk_bf16_f32 v59, v214, v215
    buffer_store_dwordx4 v[56:59], v113, s[16:19], s38 offen offset:2048 sc1
    s_waitcnt lgkmcnt(0)
    v_pk_add_f32 v[216:217], v[216:217], v[88:89]
    v_pk_add_f32 v[218:219], v[218:219], v[90:91]
    v_pk_add_f32 v[220:221], v[220:221], v[92:93]
    v_pk_add_f32 v[222:223], v[222:223], v[94:95]
    v_pk_mul_f32 v[216:217], v[216:217], v[108:109]
    v_pk_mul_f32 v[218:219], v[218:219], v[108:109]
    v_pk_mul_f32 v[220:221], v[220:221], v[108:109]
    v_pk_mul_f32 v[222:223], v[222:223], v[108:109]
    v_cvt_pk_bf16_f32 v60, v216, v217
    v_cvt_pk_bf16_f32 v61, v218, v219
    v_cvt_pk_bf16_f32 v62, v220, v221
    v_cvt_pk_bf16_f32 v63, v222, v223
    buffer_store_dwordx4 v[60:63], v113, s[16:19], s38 offen offset:3072 sc1
    s_cmp_eq_u64 s[52:53], 0
    s_cbranch_scc1 L_p3_done
    s_waitcnt vmcnt(0)
    v_mov_b32 v112, v96
    v_mov_b32 v113, v97
    v_mov_b32 v114, v98
    v_mov_b32 v115, v99
    v_mov_b32 v116, v100
    v_mov_b32 v117, v101
    v_mov_b32 v118, v102
    v_mov_b32 v119, v103
    v_mov_b32 v192, 0
    v_mov_b32 v193, 0
    v_mov_b32 v194, 0
    v_mov_b32 v195, 0
    v_mov_b32 v196, 0
    v_mov_b32 v197, 0
    v_mov_b32 v198, 0
    v_mov_b32 v199, 0
    v_mov_b32 v200, 0
    v_mov_b32 v201, 0
    v_mov_b32 v202, 0
    v_mov_b32 v203, 0
    v_mov_b32 v204, 0
    v_mov_b32 v205, 0
    v_mov_b32 v206, 0
    v_mov_b32 v207, 0
    v_mov_b32 v208, 0
    v_mov_b32 v209, 0
    v_mov_b32 v210, 0
    v_mov_b32 v211, 0
    v_mov_b32 v212, 0
    v_mov_b32 v213, 0
    v_mov_b32 v214, 0
    v_mov_b32 v215, 0
    v_mov_b32 v216, 0
    v_mov_b32 v217, 0
    v_mov_b32 v218, 0
    v_mov_b32 v219, 0
    v_mov_b32 v220, 0
    v_mov_b32 v221, 0
    v_mov_b32 v222, 0
    v_mov_b32 v223, 0
    v_mov_b32 v224, 0
    v_mov_b32 v225, 0
    v_mov_b32 v226, 0
    v_mov_b32 v227, 0
    v_mov_b32 v228, 0
    v_mov_b32 v229, 0
    v_mov_b32 v230, 0
    v_mov_b32 v231, 0
    v_mov_b32 v232, 0
    v_mov_b32 v233, 0
    v_mov_b32 v234, 0
    v_mov_b32 v235, 0
    v_mov_b32 v236, 0
    v_mov_b32 v237, 0
    v_mov_b32 v238, 0
    v_mov_b32 v239, 0
    v_mov_b32 v240, 0
    v_mov_b32 v241, 0
    v_mov_b32 v242, 0
    v_mov_b32 v243, 0
    v_mov_b32 v244, 0
    v_mov_b32 v245, 0
    v_mov_b32 v246, 0
    v_mov_b32 v247, 0
    v_mov_b32 v248, 0
    v_mov_b32 v249, 0
    v_mov_b32 v250, 0
    v_mov_b32 v251, 0
    v_mov_b32 v252, 0
    v_mov_b32 v253, 0
    v_mov_b32 v254, 0
    v_mov_b32 v255, 0
    v_mov_b32 v28, 0
    v_mov_b32 v40, 4048155338
    v_mov_b32 v32, 0
    v_mov_b32 v41, 4048155338
    s_lshl_b32 s43, s28, 12
    v_add_u32 v4, s43, v7
    s_mov_b32 s46, s45
    s_sub_u32 s40, 16, s30
    s_sub_u32 s39, 15, s30
    s_lshl_b32 s37, s39, 7
    s_and_b32 s36, s28, 3
    s_lshl_b32 s36, s36, 5
    s_add_u32 s36, s36, s37
    s_sub_u32 s50, 0, s36
L_recurrent_scan__compressed_kv_cla__moe_arch_mod__prompt_kernel_stile_98:
    s_waitcnt vmcnt(0) lgkmcnt(0)
    s_barrier
    s_mov_b32 m0, s43
    s_add_u32 s47, s46, 32768
    buffer_load_dwordx4 v4, s[12:15], s46 offen offset:0 sc1 lds
    buffer_load_dwordx4 v4, s[12:15], s46 offen offset:1024 sc1 lds
    buffer_load_dwordx4 v4, s[12:15], s46 offen offset:2048 sc1 lds
    buffer_load_dwordx4 v4, s[12:15], s46 offen offset:3072 sc1 lds
    s_add_u32 m0, s43, 32768
    s_add_u32 s46, s46, 65536
    buffer_load_dwordx4 v4, s[12:15], s47 offen offset:0 sc1 lds
    buffer_load_dwordx4 v4, s[12:15], s47 offen offset:1024 sc1 lds
    buffer_load_dwordx4 v4, s[12:15], s47 offen offset:2048 sc1 lds
    buffer_load_dwordx4 v4, s[12:15], s47 offen offset:3072 sc1 lds
    v_mov_b32 v2, v7
    s_mov_b32 s41, 4
    s_waitcnt vmcnt(0)
    s_barrier
L_recurrent_scan__compressed_kv_cla__moe_arch_mod__prompt_kernel_sunit_99:
    s_cmp_gt_i32 s50, 0
    s_cbranch_scc1 L_recurrent_scan__compressed_kv_cla__moe_arch_mod__prompt_kernel_snext_100
    ds_read_b128 v[64:67], v2 offset:0
    ds_read_b128 v[68:71], v2 offset:1024
    ds_read_b128 v[72:75], v2 offset:2048
    ds_read_b128 v[76:79], v2 offset:3072
    ds_read_b128 v[80:83], v2 offset:4096
    ds_read_b128 v[84:87], v2 offset:5120
    ds_read_b128 v[88:91], v2 offset:6144
    ds_read_b128 v[92:95], v2 offset:7168
    s_waitcnt lgkmcnt(0)
    v_mfma_f32_16x16x32_bf16 v[96:99], v[64:67], v[128:131], 0
    v_mfma_f32_16x16x32_bf16 v[104:107], v[64:67], v[144:147], 0
    v_mfma_f32_16x16x32_bf16 v[96:99], v[68:71], v[132:135], v[96:99]
    v_mfma_f32_16x16x32_bf16 v[104:107], v[68:71], v[148:151], v[104:107]
    v_mfma_f32_16x16x32_bf16 v[96:99], v[72:75], v[136:139], v[96:99]
    v_mfma_f32_16x16x32_bf16 v[104:107], v[72:75], v[152:155], v[104:107]
    v_mfma_f32_16x16x32_bf16 v[96:99], v[76:79], v[140:143], v[96:99]
    v_mfma_f32_16x16x32_bf16 v[104:107], v[76:79], v[156:159], v[104:107]
    v_mfma_f32_16x16x32_bf16 v[100:103], v[80:83], v[128:131], 0
    v_mfma_f32_16x16x32_bf16 v[108:111], v[80:83], v[144:147], 0
    v_mfma_f32_16x16x32_bf16 v[100:103], v[84:87], v[132:135], v[100:103]
    v_mfma_f32_16x16x32_bf16 v[108:111], v[84:87], v[148:151], v[108:111]
    v_mfma_f32_16x16x32_bf16 v[100:103], v[88:91], v[136:139], v[100:103]
    v_mfma_f32_16x16x32_bf16 v[108:111], v[88:91], v[152:155], v[108:111]
    v_mfma_f32_16x16x32_bf16 v[100:103], v[92:95], v[140:143], v[100:103]
    v_mfma_f32_16x16x32_bf16 v[108:111], v[92:95], v[156:159], v[108:111]
    ds_read_b128 v[64:67], v2 offset:32768
    ds_read_b128 v[68:71], v2 offset:33792
    ds_read_b128 v[72:75], v2 offset:34816
    ds_read_b128 v[76:79], v2 offset:35840
    ds_read_b128 v[80:83], v2 offset:36864
    ds_read_b128 v[84:87], v2 offset:37888
    ds_read_b128 v[88:91], v2 offset:38912
    ds_read_b128 v[92:95], v2 offset:39936
    s_nop 1
    s_cmp_lt_i32 s50, 0
    s_cbranch_scc0 L_recurrent_scan__compressed_kv_cla__moe_arch_mod__prompt_kernel_rare_103
L_recurrent_scan__compressed_kv_cla__moe_arch_mod__prompt_kernel_back_104:
    v_max3_f32 v22, v96, v97, v98
    v_max3_f32 v22, v22, v99, v100
    v_max3_f32 v22, v22, v101, v102
    v_max3_f32 v22, v22, v103, v40
    v_mov_b32 v24, v22
    s_nop 1
    v_permlane16_swap_b32 v22, v24
    s_nop 1
    v_max_f32 v22, v22, v24
    v_mov_b32 v24, v22
    s_nop 1
    v_permlane32_swap_b32 v22, v24
    s_nop 1
    v_max_f32 v22, v22, v24
    v_sub_f32 v25, v40, v22
    v_exp_f32 v25, v25
    v_mov_b32 v40, v22
    v_mul_f32 v28, v28, v25
    v_mul_f32 v192, v192, v25
    v_mul_f32 v193, v193, v25
    v_mul_f32 v194, v194, v25
    v_mul_f32 v195, v195, v25
    v_mul_f32 v196, v196, v25
    v_mul_f32 v197, v197, v25
    v_mul_f32 v198, v198, v25
    v_mul_f32 v199, v199, v25
    v_mul_f32 v200, v200, v25
    v_mul_f32 v201, v201, v25
    v_mul_f32 v202, v202, v25
    v_mul_f32 v203, v203, v25
    v_mul_f32 v204, v204, v25
    v_mul_f32 v205, v205, v25
    v_mul_f32 v206, v206, v25
    v_mul_f32 v207, v207, v25
    v_mul_f32 v208, v208, v25
    v_mul_f32 v209, v209, v25
    v_mul_f32 v210, v210, v25
    v_mul_f32 v211, v211, v25
    v_mul_f32 v212, v212, v25
    v_mul_f32 v213, v213, v25
    v_mul_f32 v214, v214, v25
    v_mul_f32 v215, v215, v25
    v_mul_f32 v216, v216, v25
    v_mul_f32 v217, v217, v25
    v_mul_f32 v218, v218, v25
    v_mul_f32 v219, v219, v25
    v_mul_f32 v220, v220, v25
    v_mul_f32 v221, v221, v25
    v_mul_f32 v222, v222, v25
    v_mul_f32 v223, v223, v25
    v_sub_f32 v96, v96, v22
    v_sub_f32 v97, v97, v22
    v_sub_f32 v98, v98, v22
    v_sub_f32 v99, v99, v22
    v_sub_f32 v100, v100, v22
    v_sub_f32 v101, v101, v22
    v_sub_f32 v102, v102, v22
    v_sub_f32 v103, v103, v22
    v_max3_f32 v23, v104, v105, v106
    v_max3_f32 v23, v23, v107, v108
    v_max3_f32 v23, v23, v109, v110
    v_max3_f32 v23, v23, v111, v41
    v_mov_b32 v24, v23
    s_nop 1
    v_permlane16_swap_b32 v23, v24
    s_nop 1
    v_max_f32 v23, v23, v24
    v_mov_b32 v24, v23
    s_nop 1
    v_permlane32_swap_b32 v23, v24
    s_nop 1
    v_max_f32 v23, v23, v24
    v_sub_f32 v25, v41, v23
    v_exp_f32 v25, v25
    v_mov_b32 v41, v23
    v_mul_f32 v32, v32, v25
    v_mul_f32 v224, v224, v25
    v_mul_f32 v225, v225, v25
    v_mul_f32 v226, v226, v25
    v_mul_f32 v227, v227, v25
    v_mul_f32 v228, v228, v25
    v_mul_f32 v229, v229, v25
    v_mul_f32 v230, v230, v25
    v_mul_f32 v231, v231, v25
    v_mul_f32 v232, v232, v25
    v_mul_f32 v233, v233, v25
    v_mul_f32 v234, v234, v25
    v_mul_f32 v235, v235, v25
    v_mul_f32 v236, v236, v25
    v_mul_f32 v237, v237, v25
    v_mul_f32 v238, v238, v25
    v_mul_f32 v239, v239, v25
    v_mul_f32 v240, v240, v25
    v_mul_f32 v241, v241, v25
    v_mul_f32 v242, v242, v25
    v_mul_f32 v243, v243, v25
    v_mul_f32 v244, v244, v25
    v_mul_f32 v245, v245, v25
    v_mul_f32 v246, v246, v25
    v_mul_f32 v247, v247, v25
    v_mul_f32 v248, v248, v25
    v_mul_f32 v249, v249, v25
    v_mul_f32 v250, v250, v25
    v_mul_f32 v251, v251, v25
    v_mul_f32 v252, v252, v25
    v_mul_f32 v253, v253, v25
    v_mul_f32 v254, v254, v25
    v_mul_f32 v255, v255, v25
    v_sub_f32 v104, v104, v23
    v_sub_f32 v105, v105, v23
    v_sub_f32 v106, v106, v23
    v_sub_f32 v107, v107, v23
    v_sub_f32 v108, v108, v23
    v_sub_f32 v109, v109, v23
    v_sub_f32 v110, v110, v23
    v_sub_f32 v111, v111, v23
    v_exp_f32 v96, v96
    v_exp_f32 v97, v97
    v_exp_f32 v98, v98
    v_exp_f32 v99, v99
    v_exp_f32 v104, v104
    v_exp_f32 v105, v105
    v_exp_f32 v106, v106
    v_exp_f32 v107, v107
    v_exp_f32 v100, v100
    v_exp_f32 v101, v101
    v_exp_f32 v102, v102
    v_exp_f32 v103, v103
    v_exp_f32 v108, v108
    v_exp_f32 v109, v109
    v_exp_f32 v110, v110
    v_exp_f32 v111, v111
    v_add_f32 v28, v28, v96
    v_add_f32 v28, v28, v97
    v_cvt_pk_bf16_f32 v48, v96, v97
    v_add_f32 v28, v28, v98
    v_add_f32 v28, v28, v99
    v_cvt_pk_bf16_f32 v49, v98, v99
    v_add_f32 v32, v32, v104
    v_add_f32 v32, v32, v105
    v_cvt_pk_bf16_f32 v52, v104, v105
    v_add_f32 v32, v32, v106
    v_add_f32 v32, v32, v107
    v_cvt_pk_bf16_f32 v53, v106, v107
    v_add_f32 v28, v28, v100
    v_add_f32 v28, v28, v101
    v_cvt_pk_bf16_f32 v50, v100, v101
    v_add_f32 v28, v28, v102
    v_add_f32 v28, v28, v103
    v_cvt_pk_bf16_f32 v51, v102, v103
    v_add_f32 v32, v32, v108
    v_add_f32 v32, v32, v109
    v_cvt_pk_bf16_f32 v54, v108, v109
    v_add_f32 v32, v32, v110
    v_add_f32 v32, v32, v111
    v_cvt_pk_bf16_f32 v55, v110, v111
    s_waitcnt lgkmcnt(0)
    s_nop 0
    v_mfma_f32_16x16x32_bf16 v[192:195], v[64:67], v[48:51], v[192:195]
    v_mfma_f32_16x16x32_bf16 v[224:227], v[64:67], v[52:55], v[224:227]
    v_mfma_f32_16x16x32_bf16 v[196:199], v[68:71], v[48:51], v[196:199]
    v_mfma_f32_16x16x32_bf16 v[228:231], v[68:71], v[52:55], v[228:231]
    v_mfma_f32_16x16x32_bf16 v[200:203], v[72:75], v[48:51], v[200:203]
    v_mfma_f32_16x16x32_bf16 v[232:235], v[72:75], v[52:55], v[232:235]
    v_mfma_f32_16x16x32_bf16 v[204:207], v[76:79], v[48:51], v[204:207]
    v_mfma_f32_16x16x32_bf16 v[236:239], v[76:79], v[52:55], v[236:239]
    v_mfma_f32_16x16x32_bf16 v[208:211], v[80:83], v[48:51], v[208:211]
    v_mfma_f32_16x16x32_bf16 v[240:243], v[80:83], v[52:55], v[240:243]
    v_mfma_f32_16x16x32_bf16 v[212:215], v[84:87], v[48:51], v[212:215]
    v_mfma_f32_16x16x32_bf16 v[244:247], v[84:87], v[52:55], v[244:247]
    v_mfma_f32_16x16x32_bf16 v[216:219], v[88:91], v[48:51], v[216:219]
    v_mfma_f32_16x16x32_bf16 v[248:251], v[88:91], v[52:55], v[248:251]
    v_mfma_f32_16x16x32_bf16 v[220:223], v[92:95], v[48:51], v[220:223]
    v_mfma_f32_16x16x32_bf16 v[252:255], v[92:95], v[52:55], v[252:255]
L_recurrent_scan__compressed_kv_cla__moe_arch_mod__prompt_kernel_snext_100:
    v_add_u32 v2, 8192, v2
    s_add_u32 s50, s50, 32
    s_sub_u32 s41, s41, 1
    s_cmp_lg_u32 s41, 0
    s_cbranch_scc1 L_recurrent_scan__compressed_kv_cla__moe_arch_mod__prompt_kernel_sunit_99
    s_sub_u32 s40, s40, 1
    s_cmp_lg_u32 s40, 0
    s_cbranch_scc1 L_recurrent_scan__compressed_kv_cla__moe_arch_mod__prompt_kernel_stile_98
    v_mov_b32 v20, v28
    s_nop 1
    v_permlane16_swap_b32 v28, v20
    s_nop 1
    v_add_f32 v28, v28, v20
    v_mov_b32 v20, v28
    s_nop 1
    v_permlane32_swap_b32 v28, v20
    s_nop 1
    v_add_f32 v28, v28, v20
    v_mov_b32 v20, v32
    s_nop 1
    v_permlane16_swap_b32 v32, v20
    s_nop 1
    v_add_f32 v32, v32, v20
    v_mov_b32 v20, v32
    s_nop 1
    v_permlane32_swap_b32 v32, v20
    s_nop 1
    v_add_f32 v32, v32, v20
    s_mov_b32 s36, 0x5d800000
    v_cmp_nge_f32 vcc, s36, v28
    s_nop 0
    s_or_b64 s[52:53], s[52:53], vcc
    v_cmp_nge_f32 vcc, s36, v32
    s_nop 0
    s_or_b64 s[52:53], s[52:53], vcc
    v_rcp_f32 v20, v28
    v_rcp_f32 v22, v32
    s_lshl_b32 s38, s39, 3
    s_and_b32 s37, s28, 3
    s_lshl_b32 s37, s37, 1
    s_add_u32 s38, s38, s37
    s_lshl_b32 s38, s38, 17
    s_lshl_b32 s37, s29, 12
    s_add_u32 s38, s38, s37
    v_mov_b32 v21, v20
    v_mov_b32 v23, v22
    v_mov_b32 v24, v7
    v_pk_mul_f32 v[192:193], v[192:193], v[20:21]
    v_pk_mul_f32 v[194:195], v[194:195], v[20:21]
    v_pk_mul_f32 v[196:197], v[196:197], v[20:21]
    v_pk_mul_f32 v[198:199], v[198:199], v[20:21]
    v_cvt_pk_bf16_f32 v192, v192, v193
    v_cvt_pk_bf16_f32 v193, v194, v195
    v_cvt_pk_bf16_f32 v194, v196, v197
    v_cvt_pk_bf16_f32 v195, v198, v199
    buffer_store_dwordx4 v[192:195], v24, s[16:19], s38 offen offset:0 sc1
    v_pk_mul_f32 v[200:201], v[200:201], v[20:21]
    v_pk_mul_f32 v[202:203], v[202:203], v[20:21]
    v_pk_mul_f32 v[204:205], v[204:205], v[20:21]
    v_pk_mul_f32 v[206:207], v[206:207], v[20:21]
    v_cvt_pk_bf16_f32 v200, v200, v201
    v_cvt_pk_bf16_f32 v201, v202, v203
    v_cvt_pk_bf16_f32 v202, v204, v205
    v_cvt_pk_bf16_f32 v203, v206, v207
    buffer_store_dwordx4 v[200:203], v24, s[16:19], s38 offen offset:1024 sc1
    v_pk_mul_f32 v[208:209], v[208:209], v[20:21]
    v_pk_mul_f32 v[210:211], v[210:211], v[20:21]
    v_pk_mul_f32 v[212:213], v[212:213], v[20:21]
    v_pk_mul_f32 v[214:215], v[214:215], v[20:21]
    v_cvt_pk_bf16_f32 v208, v208, v209
    v_cvt_pk_bf16_f32 v209, v210, v211
    v_cvt_pk_bf16_f32 v210, v212, v213
    v_cvt_pk_bf16_f32 v211, v214, v215
    buffer_store_dwordx4 v[208:211], v24, s[16:19], s38 offen offset:2048 sc1
    v_pk_mul_f32 v[216:217], v[216:217], v[20:21]
    v_pk_mul_f32 v[218:219], v[218:219], v[20:21]
    v_pk_mul_f32 v[220:221], v[220:221], v[20:21]
    v_pk_mul_f32 v[222:223], v[222:223], v[20:21]
    v_cvt_pk_bf16_f32 v216, v216, v217
    v_cvt_pk_bf16_f32 v217, v218, v219
    v_cvt_pk_bf16_f32 v218, v220, v221
    v_cvt_pk_bf16_f32 v219, v222, v223
    buffer_store_dwordx4 v[216:219], v24, s[16:19], s38 offen offset:3072 sc1
    s_add_u32 s38, s38, 131072
    v_pk_mul_f32 v[224:225], v[224:225], v[22:23]
    v_pk_mul_f32 v[226:227], v[226:227], v[22:23]
    v_pk_mul_f32 v[228:229], v[228:229], v[22:23]
    v_pk_mul_f32 v[230:231], v[230:231], v[22:23]
    v_cvt_pk_bf16_f32 v224, v224, v225
    v_cvt_pk_bf16_f32 v225, v226, v227
    v_cvt_pk_bf16_f32 v226, v228, v229
    v_cvt_pk_bf16_f32 v227, v230, v231
    buffer_store_dwordx4 v[224:227], v24, s[16:19], s38 offen offset:0 sc1
    v_pk_mul_f32 v[232:233], v[232:233], v[22:23]
    v_pk_mul_f32 v[234:235], v[234:235], v[22:23]
    v_pk_mul_f32 v[236:237], v[236:237], v[22:23]
    v_pk_mul_f32 v[238:239], v[238:239], v[22:23]
    v_cvt_pk_bf16_f32 v232, v232, v233
    v_cvt_pk_bf16_f32 v233, v234, v235
    v_cvt_pk_bf16_f32 v234, v236, v237
    v_cvt_pk_bf16_f32 v235, v238, v239
    buffer_store_dwordx4 v[232:235], v24, s[16:19], s38 offen offset:1024 sc1
    v_pk_mul_f32 v[240:241], v[240:241], v[22:23]
    v_pk_mul_f32 v[242:243], v[242:243], v[22:23]
    v_pk_mul_f32 v[244:245], v[244:245], v[22:23]
    v_pk_mul_f32 v[246:247], v[246:247], v[22:23]
    v_cvt_pk_bf16_f32 v240, v240, v241
    v_cvt_pk_bf16_f32 v241, v242, v243
    v_cvt_pk_bf16_f32 v242, v244, v245
    v_cvt_pk_bf16_f32 v243, v246, v247
    buffer_store_dwordx4 v[240:243], v24, s[16:19], s38 offen offset:2048 sc1
    v_pk_mul_f32 v[248:249], v[248:249], v[22:23]
    v_pk_mul_f32 v[250:251], v[250:251], v[22:23]
    v_pk_mul_f32 v[252:253], v[252:253], v[22:23]
    v_pk_mul_f32 v[254:255], v[254:255], v[22:23]
    v_cvt_pk_bf16_f32 v248, v248, v249
    v_cvt_pk_bf16_f32 v249, v250, v251
    v_cvt_pk_bf16_f32 v250, v252, v253
    v_cvt_pk_bf16_f32 v251, v254, v255
    buffer_store_dwordx4 v[248:251], v24, s[16:19], s38 offen offset:3072 sc1
    v_mov_b32 v96, v112
    v_mov_b32 v97, v113
    v_mov_b32 v98, v114
    v_mov_b32 v99, v115
    v_mov_b32 v100, v116
    v_mov_b32 v101, v117
    v_mov_b32 v102, v118
    v_mov_b32 v103, v119
    s_branch L_p3_done
L_recurrent_scan__compressed_kv_cla__moe_arch_mod__prompt_kernel_rare_1:
    s_mul_i32 s36, s28, 12288
    s_add_u32 s36, s36, 61865984
    v_lshl_add_u32 v16, v1, 4, s36
    v_mov_b32 v108, 0
    v_mov_b32 v109, 0
    v_mov_b32 v110, 0
    v_mov_b32 v111, 0
    global_store_dwordx4 v16, v[108:111], s[90:91] sc1
    v_add_u32 v16, 1024, v16
    global_store_dwordx4 v16, v[108:111], s[90:91] sc1
    v_add_u32 v16, 1024, v16
    global_store_dwordx4 v16, v[108:111], s[90:91] sc1
    v_add_u32 v16, 1024, v16
    global_store_dwordx4 v16, v[108:111], s[90:91] sc1
    v_add_u32 v16, 1024, v16
    global_store_dwordx4 v16, v[108:111], s[90:91] sc1
    v_add_u32 v16, 1024, v16
    global_store_dwordx4 v16, v[108:111], s[90:91] sc1
    v_add_u32 v16, 1024, v16
    global_store_dwordx4 v16, v[108:111], s[90:91] sc1
    v_add_u32 v16, 1024, v16
    global_store_dwordx4 v16, v[108:111], s[90:91] sc1
    v_add_u32 v16, 1024, v16
    global_store_dwordx4 v16, v[108:111], s[90:91] sc1
    v_add_u32 v16, 1024, v16
    global_store_dwordx4 v16, v[108:111], s[90:91] sc1
    v_add_u32 v16, 1024, v16
    global_store_dwordx4 v16, v[108:111], s[90:91] sc1
    v_add_u32 v16, 1024, v16
    global_store_dwordx4 v16, v[108:111], s[90:91] sc1
    v_add_u32 v16, 1024, v16
    s_branch L_recurrent_scan__compressed_kv_cla__moe_arch_mod__prompt_kernel_back_2
L_recurrent_scan__compressed_kv_cla__moe_arch_mod__prompt_kernel_rare_3:
    v_mov_b32 v19, 1
    s_mov_b64 exec, 1
    global_store_dword v118, v19, s[88:89] sc1
    s_mov_b64 exec, -1
    s_branch L_recurrent_scan__compressed_kv_cla__moe_arch_mod__prompt_kernel_back_4
L_recurrent_scan__compressed_kv_cla__moe_arch_mod__prompt_kernel_rare_5:
    v_lshrrev_b32 v3, 4, v1
    s_lshl_b32 s37, s28, 4
    v_add_u32 v19, s37, v3
    v_lshlrev_b32 v19, 13, v19
    s_lshl_b32 s37, s29, 8
    v_add_u32 v19, s37, v19
    v_and_b32 v16, 15, v1
    v_lshlrev_b32 v3, 1, v3
    v_xor_b32 v16, v16, v3
    v_lshl_add_u32 v2, v16, 4, v19
    v_add_u32 v3, 31744, v2
    v_xor_b32 v16, 8, v16
    v_lshl_add_u32 v4, v16, 4, v19
    v_add_u32 v4, 63488, v4
    v_add_u32 v5, 31744, v4
    s_mov_b32 s4, s96
    s_and_b32 s5, s97, 0xffff
    s_mov_b32 s6, 8388608
    s_mov_b32 s7, 0x20000
    s_mov_b32 s31, 0
    s_mov_b32 s40, 1048576
    s_mov_b64 s[8:9], s[4:5]
    s_mov_b32 s10, s6
    s_mov_b32 s32, 3145728
    v_mov_b32 v6, v2
    v_mov_b32 v7, v3
    v_mov_b32 v8, v4
    v_mov_b32 v9, v5
    s_branch L_recurrent_scan__compressed_kv_cla__moe_arch_mod__prompt_kernel_back_6
L_recurrent_scan__compressed_kv_cla__moe_arch_mod__prompt_kernel_w0_7:
    s_cmp_eq_u32 s35, 0
    s_cbranch_scc0 L_recurrent_scan__compressed_kv_cla__moe_arch_mod__prompt_kernel_swn_10
    v_and_b32 v16, 7, v1
    v_lshrrev_b32 v18, 3, v1
    v_mul_u32_u24 v19, 2064, v16
    v_lshl_add_u32 v19, v18, 4, v19
    s_lshl_b32 s36, s28, 8
    s_add_u32 s36, s36, 131072
    v_add_u32 v19, s36, v19
    ds_read_b128 v[120:123], v19
    ds_read_b128 v[124:127], v19 offset:128
    v_lshlrev_b32 v16, 4, v16
    v_lshl_add_u32 v16, v18, 8, v16
    s_lshr_b32 s36, s2, 1
    s_lshl_b32 s36, s36, 15
    s_and_b32 s37, s2, 1
    s_lshl_b32 s37, s37, 7
    s_add_u32 s36, s36, s37
    s_lshl_b32 s37, s28, 12
    s_add_u32 s36, s36, s37
    s_waitcnt lgkmcnt(0)
    buffer_store_dwordx4 v[120:123], v16, s[24:27], s36 offen sc1
    buffer_store_dwordx4 v[124:127], v16, s[24:27], s36 offen offset:2048 sc1
    s_waitcnt vmcnt(2)
    s_branch L_recurrent_scan__compressed_kv_cla__moe_arch_mod__prompt_kernel_swend_9
L_recurrent_scan__compressed_kv_cla__moe_arch_mod__prompt_kernel_swn_10:
    s_waitcnt vmcnt(2)
L_recurrent_scan__compressed_kv_cla__moe_arch_mod__prompt_kernel_swend_9:
    s_branch L_recurrent_scan__compressed_kv_cla__moe_arch_mod__prompt_kernel_w0b_8
L_recurrent_scan__compressed_kv_cla__moe_arch_mod__prompt_kernel_rare_11:
    s_add_u32 m0, s33, 131072
    s_mov_b32 s36, 2097152
    buffer_load_dwordx4 v2, s[4:7], s36 offen offset:0 lds
    buffer_load_dwordx4 v3, s[4:7], s36 offen offset:1024 lds
    buffer_load_dwordx4 v4, s[4:7], s36 offen offset:2048 lds
    buffer_load_dwordx4 v5, s[4:7], s36 offen offset:3072 lds
    s_branch L_recurrent_scan__compressed_kv_cla__moe_arch_mod__prompt_kernel_back_12
L_recurrent_scan__compressed_kv_cla__moe_arch_mod__prompt_kernel_rare_15:
    s_cmp_eq_u32 s35, 0
    s_cbranch_scc0 L_recurrent_scan__compressed_kv_cla__moe_arch_mod__prompt_kernel_swn_14
    global_load_dword v116, v118, s[88:89] sc1
    s_branch L_recurrent_scan__compressed_kv_cla__moe_arch_mod__prompt_kernel_swend_13
L_recurrent_scan__compressed_kv_cla__moe_arch_mod__prompt_kernel_swn_14:
    v_and_b32 v117, 15, v1
    v_add_u32 v117, 112, v117
    v_lshlrev_b32 v117, 7, v117
    global_load_dword v116, v117, s[90:91] sc1
L_recurrent_scan__compressed_kv_cla__moe_arch_mod__prompt_kernel_swend_13:
    s_branch L_recurrent_scan__compressed_kv_cla__moe_arch_mod__prompt_kernel_back_16
L_recurrent_scan__compressed_kv_cla__moe_arch_mod__prompt_kernel_rare_21:
    s_mov_b32 s61, 0x40000
L_recurrent_scan__compressed_kv_cla__moe_arch_mod__prompt_kernel_spin_19:
    s_sub_u32 s61, s61, 1
    s_cbranch_scc1 L_recurrent_scan__compressed_kv_cla__moe_arch_mod__prompt_kernel_spinx_20
    s_sleep 8
    global_load_dword v116, v118, s[88:89] sc1
    s_waitcnt vmcnt(0)
    v_readfirstlane_b32 s36, v116
    s_nop 0
    s_cmp_lt_u32 s36, 1
    s_cbranch_scc1 L_recurrent_scan__compressed_kv_cla__moe_arch_mod__prompt_kernel_spin_19
L_recurrent_scan__compressed_kv_cla__moe_arch_mod__prompt_kernel_spinx_20:
    s_branch L_recurrent_scan__compressed_kv_cla__moe_arch_mod__prompt_kernel_back_22
L_recurrent_scan__compressed_kv_cla__moe_arch_mod__prompt_kernel_w0_17:
    s_waitcnt vmcnt(0)
    s_cmp_eq_u32 s35, 0
    s_cbranch_scc0 L_recurrent_scan__compressed_kv_cla__moe_arch_mod__prompt_kernel_swn_26
    v_readfirstlane_b32 s36, v116
    s_nop 0
    s_cmp_lt_u32 s36, 1
    s_cbranch_scc1 L_recurrent_scan__compressed_kv_cla__moe_arch_mod__prompt_kernel_rare_21
L_recurrent_scan__compressed_kv_cla__moe_arch_mod__prompt_kernel_back_22:
    s_branch L_recurrent_scan__compressed_kv_cla__moe_arch_mod__prompt_kernel_swend_25
L_recurrent_scan__compressed_kv_cla__moe_arch_mod__prompt_kernel_swn_26:
    s_mov_b32 s61, 0x40000
L_recurrent_scan__compressed_kv_cla__moe_arch_mod__prompt_kernel_lspin_23:
    v_cmp_gt_u32 vcc, 16, v116
    s_nop 0
    s_cmp_eq_u64 vcc, 0
    s_cbranch_scc1 L_recurrent_scan__compressed_kv_cla__moe_arch_mod__prompt_kernel_lspinx_24
    s_sub_u32 s61, s61, 1
    s_cbranch_scc1 L_recurrent_scan__compressed_kv_cla__moe_arch_mod__prompt_kernel_lspinx_24
    s_sleep 8
    global_load_dword v116, v117, s[90:91] sc1
    s_waitcnt vmcnt(0)
    s_branch L_recurrent_scan__compressed_kv_cla__moe_arch_mod__prompt_kernel_lspin_23
L_recurrent_scan__compressed_kv_cla__moe_arch_mod__prompt_kernel_lspinx_24:
L_recurrent_scan__compressed_kv_cla__moe_arch_mod__prompt_kernel_swend_25:
    s_branch L_recurrent_scan__compressed_kv_cla__moe_arch_mod__prompt_kernel_w0b_18
L_recurrent_scan__compressed_kv_cla__moe_arch_mod__prompt_kernel_rare_27:
    s_lshr_b32 s36, s2, 4
    s_add_u32 s36, s36, 112
    s_lshl_b32 s36, s36, 7
    v_mov_b32 v16, s36
    v_mov_b32 v19, 1
    s_mov_b64 exec, 1
    global_atomic_add v16, v19, s[90:91]
    s_mov_b64 exec, -1
    s_nop 3
    s_branch L_recurrent_scan__compressed_kv_cla__moe_arch_mod__prompt_kernel_back_28
L_recurrent_scan__compressed_kv_cla__moe_arch_mod__prompt_kernel_w0_29:
    s_cmp_eq_u32 s35, 0
    s_cbranch_scc0 L_recurrent_scan__compressed_kv_cla__moe_arch_mod__prompt_kernel_swn_32
    s_waitcnt vmcnt(2)
    s_branch L_recurrent_scan__compressed_kv_cla__moe_arch_mod__prompt_kernel_swend_31
L_recurrent_scan__compressed_kv_cla__moe_arch_mod__prompt_kernel_swn_32:
    s_waitcnt vmcnt(2)
L_recurrent_scan__compressed_kv_cla__moe_arch_mod__prompt_kernel_swend_31:
    s_branch L_recurrent_scan__compressed_kv_cla__moe_arch_mod__prompt_kernel_w0b_30
L_recurrent_scan__compressed_kv_cla__moe_arch_mod__prompt_kernel_rare_33:
    s_add_u32 m0, s33, 131072
    s_mov_b32 s36, 2097152
    buffer_load_dwordx4 v2, s[4:7], s36 offen offset:0 lds
    buffer_load_dwordx4 v3, s[4:7], s36 offen offset:1024 lds
    buffer_load_dwordx4 v4, s[4:7], s36 offen offset:2048 lds
    buffer_load_dwordx4 v5, s[4:7], s36 offen offset:3072 lds
    s_branch L_recurrent_scan__compressed_kv_cla__moe_arch_mod__prompt_kernel_back_34
L_recurrent_scan__compressed_kv_cla__moe_arch_mod__prompt_kernel_rare_36:
    v_and_b32 v16, 7, v1
    v_lshrrev_b32 v18, 3, v1
    v_mul_u32_u24 v19, 2064, v16
    v_lshl_add_u32 v19, v18, 4, v19
    s_lshl_b32 s36, s28, 8
    s_add_u32 s36, s36, 131072
    v_add_u32 v19, s36, v19
    ds_read_b128 v[120:123], v19
    ds_read_b128 v[124:127], v19 offset:128
    v_lshlrev_b32 v16, 4, v16
    v_lshl_add_u32 v16, v18, 8, v16
    s_lshr_b32 s36, s2, 1
    s_lshl_b32 s36, s36, 15
    s_and_b32 s37, s2, 1
    s_lshl_b32 s37, s37, 7
    s_add_u32 s36, s36, s37
    s_lshl_b32 s37, s28, 12
    s_add_u32 s36, s36, s37
    s_waitcnt lgkmcnt(0)
    buffer_store_dwordx4 v[120:123], v16, s[24:27], s36 offen sc1
    buffer_store_dwordx4 v[124:127], v16, s[24:27], s36 offen offset:2048 sc1
    s_cmp_eq_u32 s28, 7
    s_cbranch_scc0 L_recurrent_scan__compressed_kv_cla__moe_arch_mod__prompt_kernel_l7_35
    v_and_b32 v120, 7, v1
    v_lshlrev_b32 v120, 3, v120
    v_add_u32 v121, 147712, v120
    ds_read_b64 v[122:123], v121
    ds_read_b32 v124, v121 offset:64
    s_lshl_b32 s36, s2, 6
    s_add_u32 s36, s36, 4194304
    s_lshl_b32 s37, s2, 3
    s_add_u32 s37, s37, 4276224
    s_waitcnt lgkmcnt(0)
    v_mov_b32 v126, v124
    s_nop 1
    v_max_u32_dpp v126, v126, v126 quad_perm:[1,0,3,2] row_mask:0xf bank_mask:0xf
    s_nop 1
    v_max_u32_dpp v126, v126, v126 quad_perm:[2,3,0,1] row_mask:0xf bank_mask:0xf
    s_nop 1
    v_max_u32_dpp v126, v126, v126 row_half_mirror row_mask:0xf bank_mask:0xf
    v_cmp_eq_u32 vcc, v126, v124
    s_nop 1
    v_cndmask_b32 v127, v124, v118, vcc
    s_nop 1
    v_max_u32_dpp v127, v127, v127 quad_perm:[1,0,3,2] row_mask:0xf bank_mask:0xf
    s_nop 1
    v_max_u32_dpp v127, v127, v127 quad_perm:[2,3,0,1] row_mask:0xf bank_mask:0xf
    s_nop 1
    v_max_u32_dpp v127, v127, v127 row_half_mirror row_mask:0xf bank_mask:0xf
    s_mov_b64 exec, 0xff
    buffer_store_dwordx2 v[122:123], v120, s[24:27], s36 offen sc1
    s_mov_b64 exec, 1
    buffer_store_dwordx2 v[126:127], v120, s[24:27], s37 offen sc1
    s_mov_b64 exec, -1
    s_nop 3
L_recurrent_scan__compressed_kv_cla__moe_arch_mod__prompt_kernel_l7_35:
    s_branch L_recurrent_scan__compressed_kv_cla__moe_arch_mod__prompt_kernel_back_37
L_recurrent_scan__compressed_kv_cla__moe_arch_mod__prompt_kernel_rare_40:
    v_lshrrev_b32 v3, 4, v1
    s_lshl_b32 s37, s28, 4
    v_add_u32 v19, s37, v3
    v_lshlrev_b32 v19, 13, v19
    s_lshl_b32 s37, s29, 8
    v_add_u32 v19, s37, v19
    v_and_b32 v16, 15, v1
    v_lshlrev_b32 v3, 1, v3
    v_xor_b32 v16, v16, v3
    v_lshl_add_u32 v2, v16, 4, v19
    v_add_u32 v3, 31744, v2
    v_xor_b32 v16, 8, v16
    v_lshl_add_u32 v4, v16, 4, v19
    v_add_u32 v4, 63488, v4
    v_add_u32 v5, 31744, v4
    s_mov_b32 s4, s96
    s_and_b32 s5, s97, 0xffff
    s_mov_b32 s6, 8388608
    s_mov_b32 s7, 0x20000
    s_mov_b32 s31, 0
    s_mov_b32 s40, 1048576
    s_mov_b64 s[8:9], s[4:5]
    s_mov_b32 s10, s6
    s_mov_b32 s32, 3145728
    v_mov_b32 v6, v2
    v_mov_b32 v7, v3
    v_mov_b32 v8, v4
    v_mov_b32 v9, v5
    s_branch L_recurrent_scan__compressed_kv_cla__moe_arch_mod__prompt_kernel_back_41
L_recurrent_scan__compressed_kv_cla__moe_arch_mod__prompt_kernel_rare_44:
    s_mov_b32 s61, 0x40000
L_recurrent_scan__compressed_kv_cla__moe_arch_mod__prompt_kernel_spin_42:
    s_sub_u32 s61, s61, 1
    s_cbranch_scc1 L_recurrent_scan__compressed_kv_cla__moe_arch_mod__prompt_kernel_spinx_43
    s_sleep 8
    global_load_dword v56, v57, s[90:91] sc1
    s_waitcnt vmcnt(0)
    v_readfirstlane_b32 s36, v56
    s_nop 0
    s_cmp_lt_u32 s36, 1
    s_cbranch_scc1 L_recurrent_scan__compressed_kv_cla__moe_arch_mod__prompt_kernel_spin_42
L_recurrent_scan__compressed_kv_cla__moe_arch_mod__prompt_kernel_spinx_43:
    s_branch L_recurrent_scan__compressed_kv_cla__moe_arch_mod__prompt_kernel_back_45
L_recurrent_scan__compressed_kv_cla__moe_arch_mod__prompt_kernel_rare_46:
    s_branch L_recurrent_scan__compressed_kv_cla__moe_arch_mod__prompt_kernel_back_47
L_recurrent_scan__compressed_kv_cla__moe_arch_mod__prompt_kernel_rare_48:
    s_waitcnt vmcnt(7)
    v_readfirstlane_b32 s36, v56
    s_nop 0
    s_cmp_lt_u32 s36, 1
    s_cbranch_scc1 L_recurrent_scan__compressed_kv_cla__moe_arch_mod__prompt_kernel_rare_44
L_recurrent_scan__compressed_kv_cla__moe_arch_mod__prompt_kernel_back_45:
    s_branch L_recurrent_scan__compressed_kv_cla__moe_arch_mod__prompt_kernel_back_49
L_recurrent_scan__compressed_kv_cla__moe_arch_mod__prompt_kernel_rare_50:
    s_add_u32 s36, s29, 64
    s_lshl_b32 s36, s36, 7
    v_mov_b32 v62, s36
    v_mov_b32 v63, 1
    s_mov_b64 exec, 1
    global_atomic_add v62, v63, s[90:91]
    s_mov_b64 exec, -1
    s_nop 3
    s_branch L_recurrent_scan__compressed_kv_cla__moe_arch_mod__prompt_kernel_back_51
L_recurrent_scan__compressed_kv_cla__moe_arch_mod__prompt_kernel_rare_52:
    s_add_u32 s36, s29, 64
    s_lshl_b32 s36, s36, 7
    v_mov_b32 v57, s36
    global_load_dword v56, v57, s[90:91] sc1
    s_branch L_recurrent_scan__compressed_kv_cla__moe_arch_mod__prompt_kernel_back_53
L_recurrent_scan__compressed_kv_cla__moe_arch_mod__prompt_kernel_rare_54:
    buffer_store_dwordx4 v[160:163], v58, s[16:19], s48 offen sc1
    buffer_store_dwordx4 v[164:167], v59, s[16:19], s48 offen sc1
    buffer_store_dwordx4 v[168:171], v60, s[16:19], s48 offen sc1
    buffer_store_dwordx4 v[172:175], v61, s[16:19], s48 offen sc1
    buffer_store_dwordx4 v[176:179], v58, s[16:19], s49 offen sc1
    buffer_store_dwordx4 v[180:183], v59, s[16:19], s49 offen sc1
    buffer_store_dwordx4 v[184:187], v60, s[16:19], s49 offen sc1
    buffer_store_dwordx4 v[188:191], v61, s[16:19], s49 offen sc1
    s_branch L_recurrent_scan__compressed_kv_cla__moe_arch_mod__prompt_kernel_back_55
L_recurrent_scan__compressed_kv_cla__moe_arch_mod__prompt_kernel_rare_56:
    s_lshl_b32 s36, s29, 7
    v_mov_b32 v13, s36
    global_load_dword v14, v13, s[90:91] sc1
    s_branch L_recurrent_scan__compressed_kv_cla__moe_arch_mod__prompt_kernel_back_57
L_recurrent_scan__compressed_kv_cla__moe_arch_mod__prompt_kernel_rare_64:
    s_mov_b32 s41, 32768
    s_cmp_eq_u32 s40, 15
    s_cbranch_scc0 L_recurrent_scan__compressed_kv_cla__moe_arch_mod__prompt_kernel_r_58
    s_mov_b32 s41, 65536
    s_mov_b32 s49, 0x1ffff
    s_sub_u32 s36, 0, s50
    s_cmp_lt_i32 s36, 0
    s_cbranch_scc1 L_recurrent_scan__compressed_kv_cla__moe_arch_mod__prompt_kernel_nm_63
    v_mov_b32 v20, 4048155338
    s_cmp_gt_i32 s36, 0
    s_cbranch_scc1 L_recurrent_scan__compressed_kv_cla__moe_arch_mod__prompt_kernel_mf_61
    v_cmp_gt_i32 s[20:21], 0, v18
    v_cmp_gt_i32 s[22:23], 1, v18
    v_cmp_gt_i32 s[62:63], 2, v18
    v_cmp_gt_i32 vcc, 3, v18
    v_mov_b32 v100, v20
    v_mov_b32 v101, v20
    v_mov_b32 v102, v20
    v_mov_b32 v103, v20
    v_cndmask_b32 v96, v96, v20, s[20:21]
    v_cndmask_b32 v97, v97, v20, s[22:23]
    v_cndmask_b32 v98, v98, v20, s[62:63]
    v_cndmask_b32 v99, v99, v20, vcc
    v_cndmask_b32 v108, v108, v20, s[20:21]
    v_cndmask_b32 v109, v109, v20, s[22:23]
    v_cndmask_b32 v110, v110, v20, s[62:63]
    v_cndmask_b32 v111, v111, v20, vcc
    s_branch L_recurrent_scan__compressed_kv_cla__moe_arch_mod__prompt_kernel_me_62
L_recurrent_scan__compressed_kv_cla__moe_arch_mod__prompt_kernel_mf_61:
    v_mov_b32 v96, v20
    v_mov_b32 v97, v20
    v_mov_b32 v98, v20
    v_mov_b32 v99, v20
    v_mov_b32 v100, v20
    v_mov_b32 v101, v20
    v_mov_b32 v102, v20
    v_mov_b32 v103, v20
    v_mov_b32 v104, v20
    v_mov_b32 v105, v20
    v_mov_b32 v106, v20
    v_mov_b32 v107, v20
    v_mov_b32 v108, v20
    v_mov_b32 v109, v20
    v_mov_b32 v110, v20
    v_mov_b32 v111, v20
L_recurrent_scan__compressed_kv_cla__moe_arch_mod__prompt_kernel_me_62:
L_recurrent_scan__compressed_kv_cla__moe_arch_mod__prompt_kernel_nm_63:
L_recurrent_scan__compressed_kv_cla__moe_arch_mod__prompt_kernel_r_58:
    s_branch L_recurrent_scan__compressed_kv_cla__moe_arch_mod__prompt_kernel_back_65
L_recurrent_scan__compressed_kv_cla__moe_arch_mod__prompt_kernel_rare_74:
    s_mov_b32 s61, 0x40000
L_recurrent_scan__compressed_kv_cla__moe_arch_mod__prompt_kernel_spin_72:
    s_sub_u32 s61, s61, 1
    s_cbranch_scc1 L_recurrent_scan__compressed_kv_cla__moe_arch_mod__prompt_kernel_spinx_73
    s_sleep 8
    global_load_dword v14, v13, s[90:91] sc1
    s_waitcnt vmcnt(0)
    v_readfirstlane_b32 s36, v14
    s_nop 0
    s_cmp_lt_u32 s36, 7
    s_cbranch_scc1 L_recurrent_scan__compressed_kv_cla__moe_arch_mod__prompt_kernel_spin_72
L_recurrent_scan__compressed_kv_cla__moe_arch_mod__prompt_kernel_spinx_73:
    s_branch L_recurrent_scan__compressed_kv_cla__moe_arch_mod__prompt_kernel_back_75
L_recurrent_scan__compressed_kv_cla__moe_arch_mod__prompt_kernel_rare_80:
    s_cmp_eq_u32 s40, 1
    s_cbranch_scc0 L_recurrent_scan__compressed_kv_cla__moe_arch_mod__prompt_kernel_swn_77
    v_readfirstlane_b32 s36, v14
    s_nop 0
    s_cmp_lt_u32 s36, 7
    s_cbranch_scc1 L_recurrent_scan__compressed_kv_cla__moe_arch_mod__prompt_kernel_rare_74
L_recurrent_scan__compressed_kv_cla__moe_arch_mod__prompt_kernel_back_75:
    s_branch L_recurrent_scan__compressed_kv_cla__moe_arch_mod__prompt_kernel_swend_76
L_recurrent_scan__compressed_kv_cla__moe_arch_mod__prompt_kernel_swn_77:
    s_cmp_eq_u32 s40, 2
    s_cbranch_scc0 L_recurrent_scan__compressed_kv_cla__moe_arch_mod__prompt_kernel_swn_78
    s_mov_b32 s36, 4276224
    buffer_load_dwordx4 v[160:163], v7, s[24:27], s36 offen offset:0 sc1
    buffer_load_dwordx4 v[164:167], v7, s[24:27], s36 offen offset:1024 sc1
    s_branch L_recurrent_scan__compressed_kv_cla__moe_arch_mod__prompt_kernel_swend_76
L_recurrent_scan__compressed_kv_cla__moe_arch_mod__prompt_kernel_swn_78:
    s_cmp_eq_u32 s40, 3
    s_cbranch_scc0 L_recurrent_scan__compressed_kv_cla__moe_arch_mod__prompt_kernel_swn_79
    v_max_u32 v24, v160, v161
    v_min_u32 v25, v160, v161
    v_med3_u32 v25, v24, v25, v162
    v_max_u32 v24, v24, v162
    v_med3_u32 v25, v24, v25, v163
    v_max_u32 v24, v24, v163
    v_med3_u32 v25, v24, v25, v164
    v_max_u32 v24, v24, v164
    v_med3_u32 v25, v24, v25, v165
    v_max_u32 v24, v24, v165
    v_med3_u32 v25, v24, v25, v166
    v_max_u32 v24, v24, v166
    v_med3_u32 v25, v24, v25, v167
    v_max_u32 v24, v24, v167
    v_mov_b32 v26, v24
    s_nop 1
    v_max_u32_dpp v26, v26, v26 quad_perm:[1,0,3,2] row_mask:0xf bank_mask:0xf
    s_nop 1
    v_max_u32_dpp v26, v26, v26 quad_perm:[2,3,0,1] row_mask:0xf bank_mask:0xf
    s_nop 1
    v_max_u32_dpp v26, v26, v26 row_half_mirror row_mask:0xf bank_mask:0xf
    s_nop 1
    v_max_u32_dpp v26, v26, v26 row_mirror row_mask:0xf bank_mask:0xf
    s_nop 0
    v_readlane_b32 s20, v26, 0
    v_readlane_b32 s21, v26, 16
    v_readlane_b32 s22, v26, 32
    v_readlane_b32 s23, v26, 48
    s_max_u32 s20, s20, s21
    s_max_u32 s22, s22, s23
    s_max_u32 s20, s20, s22
    s_mov_b32 s58, s20
    v_cmp_eq_u32 vcc, s58, v24
    s_nop 1
    v_cndmask_b32 v26, v24, v25, vcc
    s_nop 1
    v_max_u32_dpp v26, v26, v26 quad_perm:[1,0,3,2] row_mask:0xf bank_mask:0xf
    s_nop 1
    v_max_u32_dpp v26, v26, v26 quad_perm:[2,3,0,1] row_mask:0xf bank_mask:0xf
    s_nop 1
    v_max_u32_dpp v26, v26, v26 row_half_mirror row_mask:0xf bank_mask:0xf
    s_nop 1
    v_max_u32_dpp v26, v26, v26 row_mirror row_mask:0xf bank_mask:0xf
    s_nop 0
    v_readlane_b32 s20, v26, 0
    v_readlane_b32 s21, v26, 16
    v_readlane_b32 s22, v26, 32
    v_readlane_b32 s23, v26, 48
    s_max_u32 s20, s20, s21
    s_max_u32 s22, s22, s23
    s_max_u32 s20, s20, s22
    s_mov_b32 s59, s20
    s_and_b32 s36, s58, 0xffff
    s_sub_u32 s56, 0xffff, s36
    s_and_b32 s36, s59, 0xffff
    s_sub_u32 s57, 0xffff, s36
    v_and_b32 v24, 1, v1
    v_mov_b32 v25, s56
    v_mov_b32 v26, s57
    v_cmp_eq_u32 vcc, 1, v24
    s_nop 1
    v_cndmask_b32 v25, v25, v26, vcc
    v_lshrrev_b32 v26, 4, v25
    v_lshlrev_b32 v26, 15, v26
    v_and_b32 v25, 15, v25
    v_lshl_add_u32 v26, v25, 4, v26
    v_lshrrev_b32 v27, 4, v1
    v_lshl_add_u32 v26, v27, 8, v26
    s_and_b32 s36, s3, 3
    s_lshl_b32 s36, s36, 13
    s_add_u32 s37, s36, 4096
    s_mov_b32 exec_lo, 0x00030003
    s_mov_b32 exec_hi, 0x00030003
    buffer_load_dwordx4 v[160:163], v26, s[24:27], s36 offen offset:0 sc1
    buffer_load_dwordx4 v[164:167], v26, s[24:27], s36 offen offset:1024 sc1
    buffer_load_dwordx4 v[168:171], v26, s[24:27], s36 offen offset:2048 sc1
    buffer_load_dwordx4 v[172:175], v26, s[24:27], s36 offen offset:3072 sc1
    buffer_load_dwordx4 v[176:179], v26, s[24:27], s37 offen offset:0 sc1
    buffer_load_dwordx4 v[180:183], v26, s[24:27], s37 offen offset:1024 sc1
    buffer_load_dwordx4 v[184:187], v26, s[24:27], s37 offen offset:2048 sc1
    buffer_load_dwordx4 v[188:191], v26, s[24:27], s37 offen offset:3072 sc1
    s_mov_b64 exec, -1
    s_branch L_recurrent_scan__compressed_kv_cla__moe_arch_mod__prompt_kernel_swend_76
L_recurrent_scan__compressed_kv_cla__moe_arch_mod__prompt_kernel_swn_79:
    s_sub_u32 s38, s40, s60
    s_cmp_eq_u32 s38, 0
    s_cbranch_scc0 L_recurrent_scan__compressed_kv_cla__moe_arch_mod__prompt_kernel_swn_68
    s_and_b32 s20, s3, 3
    s_lshl_b32 s20, s20, 8
    s_lshl_b32 s21, s28, 5
    s_add_u32 s20, s20, s21
    s_lshr_b32 s21, s3, 2
    s_lshl_b32 s21, s21, 7
    v_lshrrev_b32 v25, 3, v1
    s_lshl_b32 s36, s28, 5
    s_add_u32 s36, s36, s20
    v_add_u32 v25, s36, v25
    v_mul_u32_u24 v25, 7168, v25
    v_add_u32 v25, s21, v25
    v_bfe_u32 v26, v1, 4, 1
    v_lshlrev_b32 v26, 1, v26
    v_and_b32 v27, 7, v1
    v_xor_b32 v26, v26, v27
    v_lshl_add_u32 v24, v26, 4, v25
    v_xor_b32 v26, 4, v26
    v_lshl_add_u32 v25, v26, 4, v25
    v_add_u32 v25, 56320, v25
    v_add_u32 v26, 112640, v24
    v_add_u32 v27, 112640, v25
    s_lshl_b32 s36, s28, 13
    s_add_u32 m0, s36, 131072
    s_mov_b32 s37, 229376
    buffer_load_dwordx4 v24, s[4:7], 0 offen offset:0 nt lds
    buffer_load_dwordx4 v25, s[4:7], 0 offen offset:1024 nt lds
    buffer_load_dwordx4 v26, s[4:7], 0 offen offset:2048 nt lds
    buffer_load_dwordx4 v27, s[4:7], 0 offen offset:3072 nt lds
    s_add_u32 m0, s36, 135168
    s_nop 0
    buffer_load_dwordx4 v24, s[4:7], s37 offen offset:0 nt lds
    buffer_load_dwordx4 v25, s[4:7], s37 offen offset:1024 nt lds
    buffer_load_dwordx4 v26, s[4:7], s37 offen offset:2048 nt lds
    buffer_load_dwordx4 v27, s[4:7], s37 offen offset:3072 nt lds
    s_branch L_recurrent_scan__compressed_kv_cla__moe_arch_mod__prompt_kernel_swend_67
L_recurrent_scan__compressed_kv_cla__moe_arch_mod__prompt_kernel_swn_68:
    s_cmp_eq_u32 s38, 2
    s_cbranch_scc0 L_recurrent_scan__compressed_kv_cla__moe_arch_mod__prompt_kernel_swn_69
    v_lshrrev_b32 v8, 4, v1
    v_bfe_u32 v5, v1, 2, 2
    v_lshl_add_u32 v5, v8, 3, v5
    v_lshlrev_b32 v5, 7, v5
    v_and_b32 v9, 3, v1
    v_lshl_add_u32 v5, v9, 3, v5
    v_bfe_u32 v9, v1, 3, 2
    v_xor_b32 v9, s28, v9
    v_lshl_add_u32 v5, v9, 5, v5
    v_add_u32 v5, 131072, v5
    ds_read_b64_tr_b16 v[14:15], v5 offset:0
    ds_read_b64_tr_b16 v[16:17], v5 offset:512
    ds_read_b64_tr_b16 v[20:21], v5 offset:4096
    ds_read_b64_tr_b16 v[22:23], v5 offset:4608
    ds_read_b64_tr_b16 v[24:25], v5 offset:8192
    ds_read_b64_tr_b16 v[26:27], v5 offset:8704
    s_and_b32 s36, s3, 3
    s_lshl_b32 s36, s36, 6
    s_lshr_b32 s37, s3, 2
    s_lshl_b32 s37, s37, 12
    s_add_u32 s36, s36, s37
    s_lshl_b32 s37, s28, 10
    s_add_u32 s36, s36, s37
    s_add_u32 s36, s36, 58720256
    v_and_b32 v9, 1, v1
    v_lshlrev_b32 v9, 4, v9
    v_lshl_add_u32 v9, v8, 8, v9
    s_waitcnt lgkmcnt(4)
    v_mfma_f32_16x16x32_bf16 v[10:13], v[14:17], v[160:163], 0
    ds_read_b64_tr_b16 v[14:15], v5 offset:12288
    ds_read_b64_tr_b16 v[16:17], v5 offset:12800
    s_waitcnt lgkmcnt(4)
    v_mfma_f32_16x16x32_bf16 v[10:13], v[20:23], v[164:167], v[10:13]
    ds_read_b64_tr_b16 v[20:21], v5 offset:16384
    ds_read_b64_tr_b16 v[22:23], v5 offset:16896
    s_waitcnt lgkmcnt(4)
    v_mfma_f32_16x16x32_bf16 v[10:13], v[24:27], v[168:171], v[10:13]
    ds_read_b64_tr_b16 v[24:25], v5 offset:20480
    ds_read_b64_tr_b16 v[26:27], v5 offset:20992
    s_waitcnt lgkmcnt(4)
    v_mfma_f32_16x16x32_bf16 v[10:13], v[14:17], v[172:175], v[10:13]
    ds_read_b64_tr_b16 v[14:15], v5 offset:24576
    ds_read_b64_tr_b16 v[16:17], v5 offset:25088
    s_waitcnt lgkmcnt(4)
    v_mfma_f32_16x16x32_bf16 v[10:13], v[20:23], v[176:179], v[10:13]
    ds_read_b64_tr_b16 v[20:21], v5 offset:28672
    ds_read_b64_tr_b16 v[22:23], v5 offset:29184
    s_waitcnt lgkmcnt(4)
    v_mfma_f32_16x16x32_bf16 v[10:13], v[24:27], v[180:183], v[10:13]
    s_waitcnt lgkmcnt(2)
    v_mfma_f32_16x16x32_bf16 v[10:13], v[14:17], v[184:187], v[10:13]
    s_waitcnt lgkmcnt(0)
    v_mfma_f32_16x16x32_bf16 v[10:13], v[20:23], v[188:191], v[10:13]
    s_nop 5
    s_mov_b32 exec_lo, 0x00030003
    s_mov_b32 exec_hi, 0x00030003
    buffer_store_dwordx4 v[10:13], v9, s[24:27], s36 offen sc1
    s_mov_b64 exec, -1
    s_nop 1
    s_branch L_recurrent_scan__compressed_kv_cla__moe_arch_mod__prompt_kernel_swend_67
L_recurrent_scan__compressed_kv_cla__moe_arch_mod__prompt_kernel_swn_69:
    s_cmp_eq_u32 s38, 3
    s_cbranch_scc0 L_recurrent_scan__compressed_kv_cla__moe_arch_mod__prompt_kernel_swn_70
    s_and_b32 s20, s3, 3
    s_lshl_b32 s20, s20, 8
    s_lshl_b32 s21, s28, 5
    s_add_u32 s20, s20, s21
    s_lshr_b32 s21, s3, 2
    s_lshl_b32 s21, s21, 7
    v_lshrrev_b32 v25, 3, v1
    s_lshl_b32 s36, s28, 5
    s_add_u32 s36, s36, s20
    v_add_u32 v25, s36, v25
    v_mul_u32_u24 v25, 7168, v25
    v_add_u32 v25, s21, v25
    v_bfe_u32 v26, v1, 4, 1
    v_lshlrev_b32 v26, 1, v26
    v_and_b32 v27, 7, v1
    v_xor_b32 v26, v26, v27
    v_lshl_add_u32 v24, v26, 4, v25
    v_xor_b32 v26, 4, v26
    v_lshl_add_u32 v25, v26, 4, v25
    v_add_u32 v25, 56320, v25
    v_add_u32 v26, 112640, v24
    v_add_u32 v27, 112640, v25
    s_lshl_b32 s36, s28, 13
    s_add_u32 m0, s36, 131072
    s_mov_b32 s37, 229376
    buffer_load_dwordx4 v24, s[8:11], 0 offen offset:0 nt lds
    buffer_load_dwordx4 v25, s[8:11], 0 offen offset:1024 nt lds
    buffer_load_dwordx4 v26, s[8:11], 0 offen offset:2048 nt lds
    buffer_load_dwordx4 v27, s[8:11], 0 offen offset:3072 nt lds
    s_add_u32 m0, s36, 135168
    s_nop 0
    buffer_load_dwordx4 v24, s[8:11], s37 offen offset:0 nt lds
    buffer_load_dwordx4 v25, s[8:11], s37 offen offset:1024 nt lds
    buffer_load_dwordx4 v26, s[8:11], s37 offen offset:2048 nt lds
    buffer_load_dwordx4 v27, s[8:11], s37 offen offset:3072 nt lds
    s_branch L_recurrent_scan__compressed_kv_cla__moe_arch_mod__prompt_kernel_swend_67
L_recurrent_scan__compressed_kv_cla__moe_arch_mod__prompt_kernel_swn_70:
    s_cmp_eq_u32 s38, 5
    s_cbranch_scc0 L_recurrent_scan__compressed_kv_cla__moe_arch_mod__prompt_kernel_swn_71
    v_lshrrev_b32 v8, 4, v1
    v_bfe_u32 v5, v1, 2, 2
    v_lshl_add_u32 v5, v8, 3, v5
    v_lshlrev_b32 v5, 7, v5
    v_and_b32 v9, 3, v1
    v_lshl_add_u32 v5, v9, 3, v5
    v_bfe_u32 v9, v1, 3, 2
    v_xor_b32 v9, s28, v9
    v_lshl_add_u32 v5, v9, 5, v5
    v_add_u32 v5, 131072, v5
    ds_read_b64_tr_b16 v[14:15], v5 offset:0
    ds_read_b64_tr_b16 v[16:17], v5 offset:512
    ds_read_b64_tr_b16 v[20:21], v5 offset:4096
    ds_read_b64_tr_b16 v[22:23], v5 offset:4608
    ds_read_b64_tr_b16 v[24:25], v5 offset:8192
    ds_read_b64_tr_b16 v[26:27], v5 offset:8704
    s_and_b32 s36, s3, 3
    s_lshl_b32 s36, s36, 6
    s_lshr_b32 s37, s3, 2
    s_lshl_b32 s37, s37, 12
    s_add_u32 s36, s36, s37
    s_lshl_b32 s37, s28, 10
    s_add_u32 s36, s36, s37
    s_add_u32 s36, s36, 58720288
    v_and_b32 v9, 1, v1
    v_lshlrev_b32 v9, 4, v9
    v_lshl_add_u32 v9, v8, 8, v9
    s_waitcnt lgkmcnt(4)
    v_mfma_f32_16x16x32_bf16 v[10:13], v[14:17], v[160:163], 0
    ds_read_b64_tr_b16 v[14:15], v5 offset:12288
    ds_read_b64_tr_b16 v[16:17], v5 offset:12800
    s_waitcnt lgkmcnt(4)
    v_mfma_f32_16x16x32_bf16 v[10:13], v[20:23], v[164:167], v[10:13]
    ds_read_b64_tr_b16 v[20:21], v5 offset:16384
    ds_read_b64_tr_b16 v[22:23], v5 offset:16896
    s_waitcnt lgkmcnt(4)
    v_mfma_f32_16x16x32_bf16 v[10:13], v[24:27], v[168:171], v[10:13]
    ds_read_b64_tr_b16 v[24:25], v5 offset:20480
    ds_read_b64_tr_b16 v[26:27], v5 offset:20992
    s_waitcnt lgkmcnt(4)
    v_mfma_f32_16x16x32_bf16 v[10:13], v[14:17], v[172:175], v[10:13]
    ds_read_b64_tr_b16 v[14:15], v5 offset:24576
    ds_read_b64_tr_b16 v[16:17], v5 offset:25088
    s_waitcnt lgkmcnt(4)
    v_mfma_f32_16x16x32_bf16 v[10:13], v[20:23], v[176:179], v[10:13]
    ds_read_b64_tr_b16 v[20:21], v5 offset:28672
    ds_read_b64_tr_b16 v[22:23], v5 offset:29184
    s_waitcnt lgkmcnt(4)
    v_mfma_f32_16x16x32_bf16 v[10:13], v[24:27], v[180:183], v[10:13]
    s_waitcnt lgkmcnt(2)
    v_mfma_f32_16x16x32_bf16 v[10:13], v[14:17], v[184:187], v[10:13]
    s_waitcnt lgkmcnt(0)
    v_mfma_f32_16x16x32_bf16 v[10:13], v[20:23], v[188:191], v[10:13]
    s_nop 5
    s_mov_b32 exec_lo, 0x00030003
    s_mov_b32 exec_hi, 0x00030003
    buffer_store_dwordx4 v[10:13], v9, s[24:27], s36 offen sc1
    s_mov_b64 exec, -1
    s_nop 1
    s_branch L_recurrent_scan__compressed_kv_cla__moe_arch_mod__prompt_kernel_swend_67
L_recurrent_scan__compressed_kv_cla__moe_arch_mod__prompt_kernel_swn_71:
    s_mul_i32 s36, s3, 2341
    s_lshr_b32 s36, s36, 16
    s_add_u32 s36, s36, 48
    s_lshl_b32 s36, s36, 7
    v_mov_b32 v20, s36
    v_mov_b32 v21, 1
    s_mov_b64 exec, 1
    global_atomic_add v20, v21, s[90:91]
    s_mov_b64 exec, -1
    s_nop 3
L_recurrent_scan__compressed_kv_cla__moe_arch_mod__prompt_kernel_swend_67:
L_recurrent_scan__compressed_kv_cla__moe_arch_mod__prompt_kernel_swend_76:
    s_branch L_recurrent_scan__compressed_kv_cla__moe_arch_mod__prompt_kernel_back_81
L_recurrent_scan__compressed_kv_cla__moe_arch_mod__prompt_kernel_rare_92:
    v_mov_b32 v20, 4048155338
    s_cmp_gt_i32 s36, 0
    s_cbranch_scc1 L_recurrent_scan__compressed_kv_cla__moe_arch_mod__prompt_kernel_mf_90
    v_cmp_gt_i32 s[20:21], 0, v18
    v_cmp_gt_i32 s[22:23], 1, v18
    v_cmp_gt_i32 s[62:63], 2, v18
    v_cmp_gt_i32 vcc, 3, v18
    v_mov_b32 v116, v20
    v_mov_b32 v117, v20
    v_mov_b32 v118, v20
    v_mov_b32 v119, v20
    v_cndmask_b32 v112, v112, v20, s[20:21]
    v_cndmask_b32 v113, v113, v20, s[22:23]
    v_cndmask_b32 v114, v114, v20, s[62:63]
    v_cndmask_b32 v115, v115, v20, vcc
    v_cndmask_b32 v124, v124, v20, s[20:21]
    v_cndmask_b32 v125, v125, v20, s[22:23]
    v_cndmask_b32 v126, v126, v20, s[62:63]
    v_cndmask_b32 v127, v127, v20, vcc
    s_branch L_recurrent_scan__compressed_kv_cla__moe_arch_mod__prompt_kernel_me_91
L_recurrent_scan__compressed_kv_cla__moe_arch_mod__prompt_kernel_mf_90:
    v_mov_b32 v112, v20
    v_mov_b32 v113, v20
    v_mov_b32 v114, v20
    v_mov_b32 v115, v20
    v_mov_b32 v116, v20
    v_mov_b32 v117, v20
    v_mov_b32 v118, v20
    v_mov_b32 v119, v20
    v_mov_b32 v120, v20
    v_mov_b32 v121, v20
    v_mov_b32 v122, v20
    v_mov_b32 v123, v20
    v_mov_b32 v124, v20
    v_mov_b32 v125, v20
    v_mov_b32 v126, v20
    v_mov_b32 v127, v20
L_recurrent_scan__compressed_kv_cla__moe_arch_mod__prompt_kernel_me_91:
    s_branch L_recurrent_scan__compressed_kv_cla__moe_arch_mod__prompt_kernel_back_93
L_recurrent_scan__compressed_kv_cla__moe_arch_mod__prompt_kernel_rare_96:
    s_mov_b32 s61, 0x40000
L_recurrent_scan__compressed_kv_cla__moe_arch_mod__prompt_kernel_spin_94:
    s_sub_u32 s61, s61, 1
    s_cbranch_scc1 L_recurrent_scan__compressed_kv_cla__moe_arch_mod__prompt_kernel_spinx_95
    s_sleep 8
    global_load_dword v11, v12, s[90:91] sc1
    s_waitcnt vmcnt(0)
    v_readfirstlane_b32 s36, v11
    s_nop 0
    s_cmp_lt_u32 s36, 28
    s_cbranch_scc1 L_recurrent_scan__compressed_kv_cla__moe_arch_mod__prompt_kernel_spin_94
L_recurrent_scan__compressed_kv_cla__moe_arch_mod__prompt_kernel_spinx_95:
    s_branch L_recurrent_scan__compressed_kv_cla__moe_arch_mod__prompt_kernel_back_97
L_recurrent_scan__compressed_kv_cla__moe_arch_mod__prompt_kernel_rare_103:
    v_mov_b32 v20, 4048155338
    s_cmp_gt_i32 s50, 0
    s_cbranch_scc1 L_recurrent_scan__compressed_kv_cla__moe_arch_mod__prompt_kernel_mf_101
    v_cmp_gt_i32 s[20:21], 0, v18
    v_cmp_gt_i32 s[22:23], 1, v18
    v_cmp_gt_i32 s[62:63], 2, v18
    v_cmp_gt_i32 vcc, 3, v18
    v_mov_b32 v100, v20
    v_mov_b32 v101, v20
    v_mov_b32 v102, v20
    v_mov_b32 v103, v20
    v_cndmask_b32 v96, v96, v20, s[20:21]
    v_cndmask_b32 v97, v97, v20, s[22:23]
    v_cndmask_b32 v98, v98, v20, s[62:63]
    v_cndmask_b32 v99, v99, v20, vcc
    v_cndmask_b32 v108, v108, v20, s[20:21]
    v_cndmask_b32 v109, v109, v20, s[22:23]
    v_cndmask_b32 v110, v110, v20, s[62:63]
    v_cndmask_b32 v111, v111, v20, vcc
    s_branch L_recurrent_scan__compressed_kv_cla__moe_arch_mod__prompt_kernel_me_102
L_recurrent_scan__compressed_kv_cla__moe_arch_mod__prompt_kernel_mf_101:
    v_mov_b32 v96, v20
    v_mov_b32 v97, v20
    v_mov_b32 v98, v20
    v_mov_b32 v99, v20
    v_mov_b32 v100, v20
    v_mov_b32 v101, v20
    v_mov_b32 v102, v20
    v_mov_b32 v103, v20
    v_mov_b32 v104, v20
    v_mov_b32 v105, v20
    v_mov_b32 v106, v20
    v_mov_b32 v107, v20
    v_mov_b32 v108, v20
    v_mov_b32 v109, v20
    v_mov_b32 v110, v20
    v_mov_b32 v111, v20
L_recurrent_scan__compressed_kv_cla__moe_arch_mod__prompt_kernel_me_102:
    s_branch L_recurrent_scan__compressed_kv_cla__moe_arch_mod__prompt_kernel_back_104
L_grp1:
    v_mov_b32 v20, 1040356334
    v_mov_b32 v21, v20
    s_and_b32 s37, s28, 3
    s_lshl_b32 s37, s37, 13
    v_lshlrev_b32 v7, 4, v1
    v_add_u32 v4, s37, v7
    v_add_u32 v19, 131072, v4
    v_add_u32 v6, 4096, v4
    s_add_u32 s43, s37, 32768
    s_add_u32 s44, s37, 98304
    v_pk_mul_f32 v[192:193], v[192:193], v[20:21]
    v_pk_mul_f32 v[194:195], v[194:195], v[20:21]
    v_pk_mul_f32 v[196:197], v[196:197], v[20:21]
    v_pk_mul_f32 v[198:199], v[198:199], v[20:21]
    v_cvt_pk_bf16_f32 v128, v192, v193
    v_cvt_pk_bf16_f32 v129, v194, v195
    v_cvt_pk_bf16_f32 v130, v196, v197
    v_cvt_pk_bf16_f32 v131, v198, v199
    v_pk_mul_f32 v[224:225], v[224:225], v[20:21]
    v_pk_mul_f32 v[226:227], v[226:227], v[20:21]
    v_pk_mul_f32 v[228:229], v[228:229], v[20:21]
    v_pk_mul_f32 v[230:231], v[230:231], v[20:21]
    v_cvt_pk_bf16_f32 v144, v224, v225
    v_cvt_pk_bf16_f32 v145, v226, v227
    v_cvt_pk_bf16_f32 v146, v228, v229
    v_cvt_pk_bf16_f32 v147, v230, v231
    v_pk_mul_f32 v[200:201], v[200:201], v[20:21]
    v_pk_mul_f32 v[202:203], v[202:203], v[20:21]
    v_pk_mul_f32 v[204:205], v[204:205], v[20:21]
    v_pk_mul_f32 v[206:207], v[206:207], v[20:21]
    v_cvt_pk_bf16_f32 v132, v200, v201
    v_cvt_pk_bf16_f32 v133, v202, v203
    v_cvt_pk_bf16_f32 v134, v204, v205
    v_cvt_pk_bf16_f32 v135, v206, v207
    v_pk_mul_f32 v[232:233], v[232:233], v[20:21]
    v_pk_mul_f32 v[234:235], v[234:235], v[20:21]
    v_pk_mul_f32 v[236:237], v[236:237], v[20:21]
    v_pk_mul_f32 v[238:239], v[238:239], v[20:21]
    v_cvt_pk_bf16_f32 v148, v232, v233
    v_cvt_pk_bf16_f32 v149, v234, v235
    v_cvt_pk_bf16_f32 v150, v236, v237
    v_cvt_pk_bf16_f32 v151, v238, v239
    v_pk_mul_f32 v[208:209], v[208:209], v[20:21]
    v_pk_mul_f32 v[210:211], v[210:211], v[20:21]
    v_pk_mul_f32 v[212:213], v[212:213], v[20:21]
    v_pk_mul_f32 v[214:215], v[214:215], v[20:21]
    v_cvt_pk_bf16_f32 v136, v208, v209
    v_cvt_pk_bf16_f32 v137, v210, v211
    v_cvt_pk_bf16_f32 v138, v212, v213
    v_cvt_pk_bf16_f32 v139, v214, v215
    v_pk_mul_f32 v[240:241], v[240:241], v[20:21]
    v_pk_mul_f32 v[242:243], v[242:243], v[20:21]
    v_pk_mul_f32 v[244:245], v[244:245], v[20:21]
    v_pk_mul_f32 v[246:247], v[246:247], v[20:21]
    v_cvt_pk_bf16_f32 v152, v240, v241
    v_cvt_pk_bf16_f32 v153, v242, v243
    v_cvt_pk_bf16_f32 v154, v244, v245
    v_cvt_pk_bf16_f32 v155, v246, v247
    v_pk_mul_f32 v[216:217], v[216:217], v[20:21]
    v_pk_mul_f32 v[218:219], v[218:219], v[20:21]
    v_pk_mul_f32 v[220:221], v[220:221], v[20:21]
    v_pk_mul_f32 v[222:223], v[222:223], v[20:21]
    v_cvt_pk_bf16_f32 v140, v216, v217
    v_cvt_pk_bf16_f32 v141, v218, v219
    v_cvt_pk_bf16_f32 v142, v220, v221
    v_cvt_pk_bf16_f32 v143, v222, v223
    v_pk_mul_f32 v[248:249], v[248:249], v[20:21]
    v_pk_mul_f32 v[250:251], v[250:251], v[20:21]
    v_pk_mul_f32 v[252:253], v[252:253], v[20:21]
    v_pk_mul_f32 v[254:255], v[254:255], v[20:21]
    v_cvt_pk_bf16_f32 v156, v248, v249
    v_cvt_pk_bf16_f32 v157, v250, v251
    v_cvt_pk_bf16_f32 v158, v252, v253
    v_cvt_pk_bf16_f32 v159, v254, v255
    v_mov_b32 v2, v7
    v_and_b32 v21, 15, v1
    v_lshrrev_b32 v22, 4, v1
    v_lshlrev_b32 v22, 2, v22
    v_sub_u32 v18, v21, v22
    s_mov_b32 s40, 0
    s_mov_b32 s41, 16384
    s_mov_b32 s49, 0xffff
    s_lshl_b32 s51, s30, 1
    s_add_u32 s51, s51, 1
    s_and_b32 s50, s28, 3
    s_lshl_b32 s50, s50, 5
    s_lshl_b32 s42, 7, s51
    s_lshr_b32 s42, s42, 2
    s_or_b32 s42, s42, 0x8001
    s_mov_b64 s[52:53], 0
    s_waitcnt vmcnt(3) lgkmcnt(0)
    s_barrier
    ds_read_b128 v[64:67], v2 offset:0
    ds_read_b128 v[68:71], v2 offset:1024
    ds_read_b128 v[72:75], v2 offset:2048
    ds_read_b128 v[76:79], v2 offset:3072
    ds_read_b128 v[80:83], v2 offset:4096
    ds_read_b128 v[84:87], v2 offset:5120
    ds_read_b128 v[88:91], v2 offset:6144
    ds_read_b128 v[92:95], v2 offset:7168
    ds_read_b128 v[160:163], v19 offset:0
    ds_read_b128 v[164:167], v19 offset:1024
    ds_read_b128 v[168:171], v19 offset:2048
    ds_read_b128 v[172:175], v19 offset:3072
    ds_read_b128 v[176:179], v19 offset:4096
    ds_read_b128 v[180:183], v19 offset:5120
    ds_read_b128 v[184:187], v19 offset:6144
    ds_read_b128 v[188:191], v19 offset:7168
    v_mov_b32 v36, 0x3f803f80
    v_mov_b32 v37, 0x3f803f80
    v_mov_b32 v38, 0x3f803f80
    v_mov_b32 v39, 0x3f803f80
    s_add_u32 s16, s54, 41943040
    s_addc_u32 s17, s55, 0
    s_and_b32 s17, s17, 0xffff
    s_mov_b32 s18, 117440640
    s_mov_b32 s19, 0x20000
    s_cmp_eq_u32 s28, 4
    s_cbranch_scc1 L_recurrent_scan__compressed_kv_cla__moe_arch_mod__prompt_kernel_rare_143
L_recurrent_scan__compressed_kv_cla__moe_arch_mod__prompt_kernel_back_144:
    s_sub_u32 s36, s2, 160
    s_lshl_b32 s36, s36, 1
    s_and_b32 s37, s28, 1
    s_add_u32 s36, s36, s37
    s_min_u32 s36, s36, 1024
    s_mul_i32 s36, s36, 43776
    s_cmp_lt_u32 s28, 6
    s_cselect_b64 s[4:5], s[32:33], s[34:35]
    s_cselect_b32 s37, 32, 28
    s_lshl_b32 s37, s37, 18
    s_min_u32 s36, s36, s37
    s_sub_u32 s6, s37, s36
    s_min_u32 s6, s6, 43776
    s_add_u32 s4, s4, s36
    s_addc_u32 s5, s5, 0
    s_and_b32 s5, s5, 0xffff
    s_mov_b32 s7, 0x20000
    v_cmp_gt_u32 vcc, 32, v1
    v_lshlrev_b32 v13, 7, v1
    v_mov_b32 v12, 0x100000
    v_cndmask_b32 v13, v12, v13, vcc
    s_mov_b32 s48, 0
    s_cmp_eq_u32 s28, 5
    s_cselect_b32 s36, 0x1000, 0
    s_or_b32 s42, s42, s36
    s_waitcnt lgkmcnt(15)
    v_mfma_f32_16x16x32_bf16 v[96:99], v[64:67], v[128:131], 0
    v_mov_b64 v[192:193], 0
    v_mov_b64 v[194:195], 0
    v_mfma_f32_16x16x32_bf16 v[104:107], v[64:67], v[144:147], 0
    ds_read_b128 v[64:67], v2 offset:8192
    v_mov_b64 v[196:197], 0
    v_mov_b64 v[198:199], 0
    s_waitcnt lgkmcnt(15)
    v_mfma_f32_16x16x32_bf16 v[96:99], v[68:71], v[132:135], v[96:99]
    v_mov_b64 v[200:201], 0
    v_mov_b64 v[202:203], 0
    v_mfma_f32_16x16x32_bf16 v[104:107], v[68:71], v[148:151], v[104:107]
    ds_read_b128 v[68:71], v2 offset:9216
    v_mov_b64 v[204:205], 0
    v_mov_b64 v[206:207], 0
    s_waitcnt lgkmcnt(15)
    v_mfma_f32_16x16x32_bf16 v[96:99], v[72:75], v[136:139], v[96:99]
    v_mov_b64 v[208:209], 0
    v_mov_b64 v[210:211], 0
    v_mfma_f32_16x16x32_bf16 v[104:107], v[72:75], v[152:155], v[104:107]
    ds_read_b128 v[72:75], v2 offset:10240
    v_mov_b64 v[212:213], 0
    v_mov_b64 v[214:215], 0
    s_waitcnt lgkmcnt(15)
    v_mfma_f32_16x16x32_bf16 v[96:99], v[76:79], v[140:143], v[96:99]
    v_mov_b64 v[216:217], 0
    v_mov_b64 v[218:219], 0
    v_mfma_f32_16x16x32_bf16 v[104:107], v[76:79], v[156:159], v[104:107]
    ds_read_b128 v[76:79], v2 offset:11264
    v_mov_b64 v[220:221], 0
    s_waitcnt lgkmcnt(15)
    v_mfma_f32_16x16x32_bf16 v[100:103], v[80:83], v[128:131], 0
    v_mov_b64 v[222:223], 0
    v_mov_b64 v[224:225], 0
    v_mfma_f32_16x16x32_bf16 v[108:111], v[80:83], v[144:147], 0
    ds_read_b128 v[80:83], v2 offset:12288
    v_mov_b64 v[226:227], 0
    v_mov_b64 v[228:229], 0
    s_waitcnt lgkmcnt(15)
    v_mfma_f32_16x16x32_bf16 v[100:103], v[84:87], v[132:135], v[100:103]
    v_mov_b64 v[230:231], 0
    v_mov_b64 v[232:233], 0
    v_mfma_f32_16x16x32_bf16 v[108:111], v[84:87], v[148:151], v[108:111]
    ds_read_b128 v[84:87], v2 offset:13312
    v_mov_b64 v[234:235], 0
    v_mov_b64 v[236:237], 0
    s_waitcnt lgkmcnt(15)
    v_mfma_f32_16x16x32_bf16 v[100:103], v[88:91], v[136:139], v[100:103]
    v_mov_b64 v[238:239], 0
    v_mov_b64 v[240:241], 0
    v_mfma_f32_16x16x32_bf16 v[108:111], v[88:91], v[152:155], v[108:111]
    ds_read_b128 v[88:91], v2 offset:14336
    v_mov_b64 v[242:243], 0
    v_mov_b64 v[244:245], 0
    s_waitcnt lgkmcnt(15)
    v_mfma_f32_16x16x32_bf16 v[100:103], v[92:95], v[140:143], v[100:103]
    v_mov_b64 v[246:247], 0
    v_mfma_f32_16x16x32_bf16 v[108:111], v[92:95], v[156:159], v[108:111]
    ds_read_b128 v[92:95], v2 offset:15360
    v_mov_b64 v[248:249], 0
    v_mov_b64 v[250:251], 0
    v_mov_b64 v[252:253], 0
    v_mov_b64 v[254:255], 0
    v_mov_b64 v[28:29], 0
    v_mov_b64 v[30:31], 0
    v_mov_b64 v[32:33], 0
    v_mov_b64 v[34:35], 0
    s_add_u32 s36, s30, s50
    s_cmp_eq_u32 s36, 0
    s_cbranch_scc1 L_recurrent_scan__compressed_kv_cla__moe_arch_mod__prompt_kernel_rare_108
L_recurrent_scan__compressed_kv_cla__moe_arch_mod__prompt_kernel_back_109:
    v_max3_f32 v22, v96, v97, v98
    v_max3_f32 v23, v104, v105, v106
    v_max3_f32 v22, v22, v99, v100
    v_max3_f32 v23, v23, v107, v108
    v_max3_f32 v22, v22, v101, v102
    v_max3_f32 v23, v23, v109, v110
    v_max_f32 v22, v22, v103
    v_max_f32 v23, v23, v111
    v_mov_b32 v24, v22
    v_mov_b32 v25, v23
    s_nop 0
    v_permlane16_swap_b32 v22, v24
    v_permlane16_swap_b32 v23, v25
    s_nop 0
    v_max_f32 v22, v22, v24
    v_max_f32 v23, v23, v25
    v_mov_b32 v24, v22
    v_mov_b32 v25, v23
    s_nop 0
    v_permlane32_swap_b32 v22, v24
    v_permlane32_swap_b32 v23, v25
    s_nop 0
    v_max_f32 v22, v22, v24
    v_max_f32 v23, v23, v25
    v_sub_f32 v40, 0, v22
    v_sub_f32 v41, 0, v22
    v_sub_f32 v42, 0, v22
    v_sub_f32 v43, 0, v22
    v_sub_f32 v44, 0, v23
    v_sub_f32 v45, 0, v23
    v_sub_f32 v46, 0, v23
    v_sub_f32 v47, 0, v23
    v_add_f32 v96, v96, v40
    v_add_f32 v97, v97, v40
    s_waitcnt lgkmcnt(7)
    v_mfma_f32_16x16x32_bf16 v[112:115], v[64:67], v[128:131], v[40:43]
    v_exp_f32 v96, v96
    v_add_f32 v98, v98, v40
    v_mfma_f32_16x16x32_bf16 v[120:123], v[64:67], v[144:147], v[44:47]
    v_exp_f32 v97, v97
    v_add_f32 v99, v99, v40
    s_waitcnt lgkmcnt(6)
    v_mfma_f32_16x16x32_bf16 v[112:115], v[68:71], v[132:135], v[112:115]
    v_exp_f32 v98, v98
    v_add_f32 v104, v104, v44
    v_cvt_pk_bf16_f32 v48, v96, v97
    v_mfma_f32_16x16x32_bf16 v[120:123], v[68:71], v[148:151], v[120:123]
    ds_read_b128 v[64:67], v2 offset:16384
    v_exp_f32 v99, v99
    v_add_f32 v105, v105, v44
    s_waitcnt lgkmcnt(6)
    v_mfma_f32_16x16x32_bf16 v[112:115], v[72:75], v[136:139], v[112:115]
    v_exp_f32 v104, v104
    v_add_f32 v106, v106, v44
    v_cvt_pk_bf16_f32 v49, v98, v99
    v_mfma_f32_16x16x32_bf16 v[120:123], v[72:75], v[152:155], v[120:123]
    ds_read_b128 v[68:71], v2 offset:17408
    v_exp_f32 v105, v105
    v_add_f32 v107, v107, v44
    s_waitcnt lgkmcnt(6)
    v_mfma_f32_16x16x32_bf16 v[112:115], v[76:79], v[140:143], v[112:115]
    v_exp_f32 v106, v106
    v_add_f32 v100, v100, v40
    v_cvt_pk_bf16_f32 v52, v104, v105
    v_mfma_f32_16x16x32_bf16 v[120:123], v[76:79], v[156:159], v[120:123]
    ds_read_b128 v[72:75], v2 offset:18432
    v_exp_f32 v107, v107
    v_add_f32 v101, v101, v40
    s_waitcnt lgkmcnt(6)
    v_mfma_f32_16x16x32_bf16 v[116:119], v[80:83], v[128:131], v[40:43]
    v_exp_f32 v100, v100
    v_add_f32 v102, v102, v40
    v_cvt_pk_bf16_f32 v53, v106, v107
    v_mfma_f32_16x16x32_bf16 v[124:127], v[80:83], v[144:147], v[44:47]
    ds_read_b128 v[76:79], v2 offset:19456
    v_exp_f32 v101, v101
    v_add_f32 v103, v103, v40
    s_waitcnt lgkmcnt(6)
    v_mfma_f32_16x16x32_bf16 v[116:119], v[84:87], v[132:135], v[116:119]
    v_exp_f32 v102, v102
    v_add_f32 v108, v108, v44
    v_cvt_pk_bf16_f32 v50, v100, v101
    v_mfma_f32_16x16x32_bf16 v[124:127], v[84:87], v[148:151], v[124:127]
    ds_read_b128 v[80:83], v2 offset:20480
    v_exp_f32 v103, v103
    v_add_f32 v109, v109, v44
    s_waitcnt lgkmcnt(6)
    v_mfma_f32_16x16x32_bf16 v[116:119], v[88:91], v[136:139], v[116:119]
    v_exp_f32 v108, v108
    v_add_f32 v110, v110, v44
    v_cvt_pk_bf16_f32 v51, v102, v103
    v_mfma_f32_16x16x32_bf16 v[124:127], v[88:91], v[152:155], v[124:127]
    ds_read_b128 v[84:87], v2 offset:21504
    v_exp_f32 v109, v109
    v_add_f32 v111, v111, v44
    s_waitcnt lgkmcnt(6)
    v_mfma_f32_16x16x32_bf16 v[116:119], v[92:95], v[140:143], v[116:119]
    v_exp_f32 v110, v110
    v_cvt_pk_bf16_f32 v54, v108, v109
    v_mfma_f32_16x16x32_bf16 v[124:127], v[92:95], v[156:159], v[124:127]
    ds_read_b128 v[88:91], v2 offset:22528
    v_exp_f32 v111, v111
    v_add_u32 v3, 65536, v2
    v_add_u32 v2, s41, v2
    v_and_b32 v2, s49, v2
    v_cvt_pk_bf16_f32 v55, v110, v111
    s_waitcnt vmcnt(1)
    s_cmp_eq_u32 s28, 4
    s_cbranch_scc1 L_recurrent_scan__compressed_kv_cla__moe_arch_mod__prompt_kernel_pw_110
    s_waitcnt vmcnt(0)
L_recurrent_scan__compressed_kv_cla__moe_arch_mod__prompt_kernel_pw_110:
    s_barrier
    .p2align 6
L_body10:
    s_bitcmp1_b32 s42, s40
    s_cbranch_scc1 L_recurrent_scan__compressed_kv_cla__moe_arch_mod__prompt_kernel_rare_117
L_recurrent_scan__compressed_kv_cla__moe_arch_mod__prompt_kernel_back_118:
    s_waitcnt lgkmcnt(5)
    v_mfma_f32_16x16x32_bf16 v[96:99], v[64:67], v[128:131], v[40:43]
    v_exp_f32 v112, v112
    v_mfma_f32_16x16x32_bf16 v[104:107], v[64:67], v[144:147], v[44:47]
    ds_read_b128 v[92:95], v2 offset:7168
    v_mfma_f32_16x16x32_bf16 v[96:99], v[68:71], v[132:135], v[96:99]
    v_exp_f32 v113, v113
    v_mfma_f32_16x16x32_bf16 v[104:107], v[68:71], v[148:151], v[104:107]
    ds_read_b128 v[64:67], v3 offset:0
    s_waitcnt lgkmcnt(5)
    v_mfma_f32_16x16x32_bf16 v[96:99], v[72:75], v[136:139], v[96:99]
    v_exp_f32 v114, v114
    v_mfma_f32_16x16x32_bf16 v[104:107], v[72:75], v[152:155], v[104:107]
    ds_read_b128 v[68:71], v3 offset:1024
    v_cvt_pk_bf16_f32 v56, v112, v113
    v_mfma_f32_16x16x32_bf16 v[96:99], v[76:79], v[140:143], v[96:99]
    v_exp_f32 v115, v115
    v_mfma_f32_16x16x32_bf16 v[104:107], v[76:79], v[156:159], v[104:107]
    ds_read_b128 v[72:75], v3 offset:2048
    s_waitcnt lgkmcnt(5)
    v_mfma_f32_16x16x32_bf16 v[100:103], v[80:83], v[128:131], v[40:43]
    v_exp_f32 v120, v120
    v_mfma_f32_16x16x32_bf16 v[108:111], v[80:83], v[144:147], v[44:47]
    ds_read_b128 v[76:79], v3 offset:3072
    v_cvt_pk_bf16_f32 v57, v114, v115
    v_mfma_f32_16x16x32_bf16 v[100:103], v[84:87], v[132:135], v[100:103]
    v_exp_f32 v121, v121
    v_mfma_f32_16x16x32_bf16 v[108:111], v[84:87], v[148:151], v[108:111]
    ds_read_b128 v[80:83], v3 offset:4096
    s_waitcnt lgkmcnt(5)
    v_mfma_f32_16x16x32_bf16 v[100:103], v[88:91], v[136:139], v[100:103]
    v_exp_f32 v122, v122
    v_mfma_f32_16x16x32_bf16 v[108:111], v[88:91], v[152:155], v[108:111]
    ds_read_b128 v[84:87], v3 offset:5120
    v_cvt_pk_bf16_f32 v60, v120, v121
    v_mfma_f32_16x16x32_bf16 v[100:103], v[92:95], v[140:143], v[100:103]
    v_exp_f32 v123, v123
    v_mfma_f32_16x16x32_bf16 v[108:111], v[92:95], v[156:159], v[108:111]
    ds_read_b128 v[88:91], v3 offset:6144
    s_waitcnt lgkmcnt(5)
    v_mfma_f32_16x16x32_bf16 v[192:195], v[64:67], v[48:51], v[192:195]
    v_exp_f32 v116, v116
    v_mfma_f32_16x16x32_bf16 v[224:227], v[64:67], v[52:55], v[224:227]
    ds_read_b128 v[92:95], v3 offset:7168
    v_cvt_pk_bf16_f32 v61, v122, v123
    v_mfma_f32_16x16x32_bf16 v[196:199], v[68:71], v[48:51], v[196:199]
    v_exp_f32 v117, v117
    v_mfma_f32_16x16x32_bf16 v[228:231], v[68:71], v[52:55], v[228:231]
    ds_read_b128 v[64:67], v2 offset:8192
    s_waitcnt lgkmcnt(5)
    v_mfma_f32_16x16x32_bf16 v[200:203], v[72:75], v[48:51], v[200:203]
    v_exp_f32 v118, v118
    v_mfma_f32_16x16x32_bf16 v[232:235], v[72:75], v[52:55], v[232:235]
    v_mfma_f32_16x16x32_bf16 v[28:31], v[36:39], v[48:51], v[28:31]
    ds_read_b128 v[68:71], v2 offset:9216
    v_cvt_pk_bf16_f32 v58, v116, v117
    v_mfma_f32_16x16x32_bf16 v[204:207], v[76:79], v[48:51], v[204:207]
    v_exp_f32 v119, v119
    v_mfma_f32_16x16x32_bf16 v[236:239], v[76:79], v[52:55], v[236:239]
    ds_read_b128 v[72:75], v2 offset:10240
    s_waitcnt lgkmcnt(5)
    v_mfma_f32_16x16x32_bf16 v[208:211], v[80:83], v[48:51], v[208:211]
    v_exp_f32 v124, v124
    buffer_load_dword v0, v13, s[4:7], s48 offen
    s_add_u32 s48, s48, 4096
    v_mfma_f32_16x16x32_bf16 v[240:243], v[80:83], v[52:55], v[240:243]
    ds_read_b128 v[76:79], v2 offset:11264
    v_cvt_pk_bf16_f32 v59, v118, v119
    v_mfma_f32_16x16x32_bf16 v[212:215], v[84:87], v[48:51], v[212:215]
    v_exp_f32 v125, v125
    v_mfma_f32_16x16x32_bf16 v[244:247], v[84:87], v[52:55], v[244:247]
    ds_read_b128 v[80:83], v2 offset:12288
    s_waitcnt lgkmcnt(5)
    v_mfma_f32_16x16x32_bf16 v[216:219], v[88:91], v[48:51], v[216:219]
    v_exp_f32 v126, v126
    v_mfma_f32_16x16x32_bf16 v[248:251], v[88:91], v[52:55], v[248:251]
    v_mfma_f32_16x16x32_bf16 v[32:35], v[36:39], v[52:55], v[32:35]
    ds_read_b128 v[84:87], v2 offset:13312
    v_cvt_pk_bf16_f32 v62, v124, v125
    v_mfma_f32_16x16x32_bf16 v[220:223], v[92:95], v[48:51], v[220:223]
    v_exp_f32 v127, v127
    v_mfma_f32_16x16x32_bf16 v[252:255], v[92:95], v[52:55], v[252:255]
    ds_read_b128 v[88:91], v2 offset:14336
    v_cvt_pk_bf16_f32 v63, v126, v127
    s_bitcmp1_b32 s42, s40
    s_cbranch_scc1 L_recurrent_scan__compressed_kv_cla__moe_arch_mod__prompt_kernel_rare_122
L_recurrent_scan__compressed_kv_cla__moe_arch_mod__prompt_kernel_back_123:
    s_waitcnt lgkmcnt(5)
    v_mfma_f32_16x16x32_bf16 v[112:115], v[64:67], v[128:131], v[40:43]
    v_exp_f32 v96, v96
    v_mfma_f32_16x16x32_bf16 v[120:123], v[64:67], v[144:147], v[44:47]
    ds_read_b128 v[92:95], v2 offset:15360
    v_mfma_f32_16x16x32_bf16 v[112:115], v[68:71], v[132:135], v[112:115]
    v_exp_f32 v97, v97
    v_mfma_f32_16x16x32_bf16 v[120:123], v[68:71], v[148:151], v[120:123]
    ds_read_b128 v[64:67], v3 offset:8192
    s_waitcnt lgkmcnt(5)
    v_mfma_f32_16x16x32_bf16 v[112:115], v[72:75], v[136:139], v[112:115]
    v_exp_f32 v98, v98
    v_mfma_f32_16x16x32_bf16 v[120:123], v[72:75], v[152:155], v[120:123]
    ds_read_b128 v[68:71], v3 offset:9216
    v_cvt_pk_bf16_f32 v48, v96, v97
    v_mfma_f32_16x16x32_bf16 v[112:115], v[76:79], v[140:143], v[112:115]
    v_exp_f32 v99, v99
    v_mfma_f32_16x16x32_bf16 v[120:123], v[76:79], v[156:159], v[120:123]
    ds_read_b128 v[72:75], v3 offset:10240
    s_waitcnt lgkmcnt(5)
    v_mfma_f32_16x16x32_bf16 v[116:119], v[80:83], v[128:131], v[40:43]
    v_exp_f32 v104, v104
    v_mfma_f32_16x16x32_bf16 v[124:127], v[80:83], v[144:147], v[44:47]
    ds_read_b128 v[76:79], v3 offset:11264
    v_cvt_pk_bf16_f32 v49, v98, v99
    v_mfma_f32_16x16x32_bf16 v[116:119], v[84:87], v[132:135], v[116:119]
    v_exp_f32 v105, v105
    v_mfma_f32_16x16x32_bf16 v[124:127], v[84:87], v[148:151], v[124:127]
    ds_read_b128 v[80:83], v3 offset:12288
    s_waitcnt lgkmcnt(5)
    v_mfma_f32_16x16x32_bf16 v[116:119], v[88:91], v[136:139], v[116:119]
    v_exp_f32 v106, v106
    v_mfma_f32_16x16x32_bf16 v[124:127], v[88:91], v[152:155], v[124:127]
    ds_read_b128 v[84:87], v3 offset:13312
    v_cvt_pk_bf16_f32 v52, v104, v105
    v_mfma_f32_16x16x32_bf16 v[116:119], v[92:95], v[140:143], v[116:119]
    v_exp_f32 v107, v107
    v_mfma_f32_16x16x32_bf16 v[124:127], v[92:95], v[156:159], v[124:127]
    ds_read_b128 v[88:91], v3 offset:14336
    s_waitcnt lgkmcnt(5)
    v_mfma_f32_16x16x32_bf16 v[192:195], v[64:67], v[56:59], v[192:195]
    v_exp_f32 v100, v100
    v_mfma_f32_16x16x32_bf16 v[224:227], v[64:67], v[60:63], v[224:227]
    ds_read_b128 v[92:95], v3 offset:15360
    v_cvt_pk_bf16_f32 v53, v106, v107
    v_mfma_f32_16x16x32_bf16 v[196:199], v[68:71], v[56:59], v[196:199]
    v_exp_f32 v101, v101
    v_mfma_f32_16x16x32_bf16 v[228:231], v[68:71], v[60:63], v[228:231]
    v_add_u32 v3, 65536, v2
    v_add_u32 v2, s41, v2
    s_waitcnt lgkmcnt(4)
    v_mfma_f32_16x16x32_bf16 v[200:203], v[72:75], v[56:59], v[200:203]
    v_exp_f32 v102, v102
    v_and_b32 v2, s49, v2
    v_mfma_f32_16x16x32_bf16 v[232:235], v[72:75], v[60:63], v[232:235]
    v_mfma_f32_16x16x32_bf16 v[28:31], v[36:39], v[56:59], v[28:31]
    v_cvt_pk_bf16_f32 v50, v100, v101
    s_waitcnt lgkmcnt(0)
    s_barrier
    v_mfma_f32_16x16x32_bf16 v[204:207], v[76:79], v[56:59], v[204:207]
    v_exp_f32 v103, v103
    v_mfma_f32_16x16x32_bf16 v[236:239], v[76:79], v[60:63], v[236:239]
    ds_read_b128 v[68:71], v2 offset:1024
    ds_read_b128 v[64:67], v2 offset:0
    v_mfma_f32_16x16x32_bf16 v[208:211], v[80:83], v[56:59], v[208:211]
    v_exp_f32 v108, v108
    v_mfma_f32_16x16x32_bf16 v[240:243], v[80:83], v[60:63], v[240:243]
    ds_read_b128 v[76:79], v2 offset:3072
    ds_read_b128 v[72:75], v2 offset:2048
    v_cvt_pk_bf16_f32 v51, v102, v103
    v_mfma_f32_16x16x32_bf16 v[212:215], v[84:87], v[56:59], v[212:215]
    v_exp_f32 v109, v109
    v_mfma_f32_16x16x32_bf16 v[244:247], v[84:87], v[60:63], v[244:247]
    ds_read_b128 v[80:83], v2 offset:4096
    v_mfma_f32_16x16x32_bf16 v[216:219], v[88:91], v[56:59], v[216:219]
    v_exp_f32 v110, v110
    v_mfma_f32_16x16x32_bf16 v[248:251], v[88:91], v[60:63], v[248:251]
    v_mfma_f32_16x16x32_bf16 v[32:35], v[36:39], v[60:63], v[32:35]
    ds_read_b128 v[84:87], v2 offset:5120
    v_cvt_pk_bf16_f32 v54, v108, v109
    v_mfma_f32_16x16x32_bf16 v[220:223], v[92:95], v[56:59], v[220:223]
    v_exp_f32 v111, v111
    v_mfma_f32_16x16x32_bf16 v[252:255], v[92:95], v[60:63], v[252:255]
    ds_read_b128 v[88:91], v2 offset:6144
    v_cvt_pk_bf16_f32 v55, v110, v111
    s_bitcmp1_b32 s42, s40
    s_cbranch_scc1 L_recurrent_scan__compressed_kv_cla__moe_arch_mod__prompt_kernel_rare_150
L_recurrent_scan__compressed_kv_cla__moe_arch_mod__prompt_kernel_back_151:
    s_add_u32 s40, s40, 1
    s_cmp_lg_u32 s40, s51
    s_cbranch_scc1 L_body10
    v_mov_b32 v40, v14
    v_mov_b32 v41, v14
    v_mov_b32 v42, v14
    v_mov_b32 v43, v14
    v_mov_b32 v44, v15
    v_mov_b32 v45, v15
    v_mov_b32 v46, v15
    v_mov_b32 v47, v15
    s_nop 1
    .p2align 6
L_body11:
    s_bitcmp1_b32 s42, s40
    s_cbranch_scc1 L_recurrent_scan__compressed_kv_cla__moe_arch_mod__prompt_kernel_rare_135
L_recurrent_scan__compressed_kv_cla__moe_arch_mod__prompt_kernel_back_136:
    s_waitcnt lgkmcnt(5)
    v_mfma_f32_16x16x32_bf16 v[96:99], v[64:67], v[160:163], v[40:43]
    v_exp_f32 v112, v112
    v_mfma_f32_16x16x32_bf16 v[104:107], v[64:67], v[176:179], v[44:47]
    ds_read_b128 v[92:95], v2 offset:7168
    v_mfma_f32_16x16x32_bf16 v[96:99], v[68:71], v[164:167], v[96:99]
    v_exp_f32 v113, v113
    v_mfma_f32_16x16x32_bf16 v[104:107], v[68:71], v[180:183], v[104:107]
    ds_read_b128 v[64:67], v3 offset:0
    s_waitcnt lgkmcnt(5)
    v_mfma_f32_16x16x32_bf16 v[96:99], v[72:75], v[168:171], v[96:99]
    v_exp_f32 v114, v114
    v_mfma_f32_16x16x32_bf16 v[104:107], v[72:75], v[184:187], v[104:107]
    ds_read_b128 v[68:71], v3 offset:1024
    v_cvt_pk_bf16_f32 v56, v112, v113
    v_mfma_f32_16x16x32_bf16 v[96:99], v[76:79], v[172:175], v[96:99]
    v_exp_f32 v115, v115
    v_mfma_f32_16x16x32_bf16 v[104:107], v[76:79], v[188:191], v[104:107]
    ds_read_b128 v[72:75], v3 offset:2048
    s_waitcnt lgkmcnt(5)
    v_mfma_f32_16x16x32_bf16 v[100:103], v[80:83], v[160:163], v[40:43]
    v_exp_f32 v120, v120
    v_mfma_f32_16x16x32_bf16 v[108:111], v[80:83], v[176:179], v[44:47]
    ds_read_b128 v[76:79], v3 offset:3072
    v_cvt_pk_bf16_f32 v57, v114, v115
    v_mfma_f32_16x16x32_bf16 v[100:103], v[84:87], v[164:167], v[100:103]
    v_exp_f32 v121, v121
    v_mfma_f32_16x16x32_bf16 v[108:111], v[84:87], v[180:183], v[108:111]
    ds_read_b128 v[80:83], v3 offset:4096
    s_waitcnt lgkmcnt(5)
    v_mfma_f32_16x16x32_bf16 v[100:103], v[88:91], v[168:171], v[100:103]
    v_exp_f32 v122, v122
    v_mfma_f32_16x16x32_bf16 v[108:111], v[88:91], v[184:187], v[108:111]
    ds_read_b128 v[84:87], v3 offset:5120
    v_cvt_pk_bf16_f32 v60, v120, v121
    v_mfma_f32_16x16x32_bf16 v[100:103], v[92:95], v[172:175], v[100:103]
    v_exp_f32 v123, v123
    v_mfma_f32_16x16x32_bf16 v[108:111], v[92:95], v[188:191], v[108:111]
    ds_read_b128 v[88:91], v3 offset:6144
    s_waitcnt lgkmcnt(5)
    v_mfma_f32_16x16x32_bf16 v[192:195], v[64:67], v[48:51], v[192:195]
    v_exp_f32 v116, v116
    v_mfma_f32_16x16x32_bf16 v[224:227], v[64:67], v[52:55], v[224:227]
    ds_read_b128 v[92:95], v3 offset:7168
    v_cvt_pk_bf16_f32 v61, v122, v123
    v_mfma_f32_16x16x32_bf16 v[196:199], v[68:71], v[48:51], v[196:199]
    v_exp_f32 v117, v117
    v_mfma_f32_16x16x32_bf16 v[228:231], v[68:71], v[52:55], v[228:231]
    ds_read_b128 v[64:67], v2 offset:8192
    s_waitcnt lgkmcnt(5)
    v_mfma_f32_16x16x32_bf16 v[200:203], v[72:75], v[48:51], v[200:203]
    v_exp_f32 v118, v118
    v_mfma_f32_16x16x32_bf16 v[232:235], v[72:75], v[52:55], v[232:235]
    v_mfma_f32_16x16x32_bf16 v[28:31], v[36:39], v[48:51], v[28:31]
    ds_read_b128 v[68:71], v2 offset:9216
    v_cvt_pk_bf16_f32 v58, v116, v117
    v_mfma_f32_16x16x32_bf16 v[204:207], v[76:79], v[48:51], v[204:207]
    v_exp_f32 v119, v119
    v_mfma_f32_16x16x32_bf16 v[236:239], v[76:79], v[52:55], v[236:239]
    ds_read_b128 v[72:75], v2 offset:10240
    s_waitcnt lgkmcnt(5)
    v_mfma_f32_16x16x32_bf16 v[208:211], v[80:83], v[48:51], v[208:211]
    v_exp_f32 v124, v124
    buffer_load_dword v0, v13, s[4:7], s48 offen
    s_add_u32 s48, s48, 4096
    v_mfma_f32_16x16x32_bf16 v[240:243], v[80:83], v[52:55], v[240:243]
    ds_read_b128 v[76:79], v2 offset:11264
    v_cvt_pk_bf16_f32 v59, v118, v119
    v_mfma_f32_16x16x32_bf16 v[212:215], v[84:87], v[48:51], v[212:215]
    v_exp_f32 v125, v125
    v_mfma_f32_16x16x32_bf16 v[244:247], v[84:87], v[52:55], v[244:247]
    ds_read_b128 v[80:83], v2 offset:12288
    s_waitcnt lgkmcnt(5)
    v_mfma_f32_16x16x32_bf16 v[216:219], v[88:91], v[48:51], v[216:219]
    v_exp_f32 v126, v126
    v_mfma_f32_16x16x32_bf16 v[248:251], v[88:91], v[52:55], v[248:251]
    v_mfma_f32_16x16x32_bf16 v[32:35], v[36:39], v[52:55], v[32:35]
    ds_read_b128 v[84:87], v2 offset:13312
    v_cvt_pk_bf16_f32 v62, v124, v125
    v_mfma_f32_16x16x32_bf16 v[220:223], v[92:95], v[48:51], v[220:223]
    v_exp_f32 v127, v127
    v_mfma_f32_16x16x32_bf16 v[252:255], v[92:95], v[52:55], v[252:255]
    ds_read_b128 v[88:91], v2 offset:14336
    v_cvt_pk_bf16_f32 v63, v126, v127
    s_bitcmp1_b32 s42, s40
    s_cbranch_scc1 L_recurrent_scan__compressed_kv_cla__moe_arch_mod__prompt_kernel_rare_140
L_recurrent_scan__compressed_kv_cla__moe_arch_mod__prompt_kernel_back_141:
    s_waitcnt lgkmcnt(5)
    v_mfma_f32_16x16x32_bf16 v[112:115], v[64:67], v[160:163], v[40:43]
    v_exp_f32 v96, v96
    v_mfma_f32_16x16x32_bf16 v[120:123], v[64:67], v[176:179], v[44:47]
    ds_read_b128 v[92:95], v2 offset:15360
    v_mfma_f32_16x16x32_bf16 v[112:115], v[68:71], v[164:167], v[112:115]
    v_exp_f32 v97, v97
    v_mfma_f32_16x16x32_bf16 v[120:123], v[68:71], v[180:183], v[120:123]
    ds_read_b128 v[64:67], v3 offset:8192
    s_waitcnt lgkmcnt(5)
    v_mfma_f32_16x16x32_bf16 v[112:115], v[72:75], v[168:171], v[112:115]
    v_exp_f32 v98, v98
    v_mfma_f32_16x16x32_bf16 v[120:123], v[72:75], v[184:187], v[120:123]
    ds_read_b128 v[68:71], v3 offset:9216
    v_cvt_pk_bf16_f32 v48, v96, v97
    v_mfma_f32_16x16x32_bf16 v[112:115], v[76:79], v[172:175], v[112:115]
    v_exp_f32 v99, v99
    v_mfma_f32_16x16x32_bf16 v[120:123], v[76:79], v[188:191], v[120:123]
    ds_read_b128 v[72:75], v3 offset:10240
    s_waitcnt lgkmcnt(5)
    v_mfma_f32_16x16x32_bf16 v[116:119], v[80:83], v[160:163], v[40:43]
    v_exp_f32 v104, v104
    v_mfma_f32_16x16x32_bf16 v[124:127], v[80:83], v[176:179], v[44:47]
    ds_read_b128 v[76:79], v3 offset:11264
    v_cvt_pk_bf16_f32 v49, v98, v99
    v_mfma_f32_16x16x32_bf16 v[116:119], v[84:87], v[164:167], v[116:119]
    v_exp_f32 v105, v105
    v_mfma_f32_16x16x32_bf16 v[124:127], v[84:87], v[180:183], v[124:127]
    ds_read_b128 v[80:83], v3 offset:12288
    s_waitcnt lgkmcnt(5)
    v_mfma_f32_16x16x32_bf16 v[116:119], v[88:91], v[168:171], v[116:119]
    v_exp_f32 v106, v106
    v_mfma_f32_16x16x32_bf16 v[124:127], v[88:91], v[184:187], v[124:127]
    ds_read_b128 v[84:87], v3 offset:13312
    v_cvt_pk_bf16_f32 v52, v104, v105
    v_mfma_f32_16x16x32_bf16 v[116:119], v[92:95], v[172:175], v[116:119]
    v_exp_f32 v107, v107
    v_mfma_f32_16x16x32_bf16 v[124:127], v[92:95], v[188:191], v[124:127]
    ds_read_b128 v[88:91], v3 offset:14336
    s_waitcnt lgkmcnt(5)
    v_mfma_f32_16x16x32_bf16 v[192:195], v[64:67], v[56:59], v[192:195]
    v_exp_f32 v100, v100
    v_mfma_f32_16x16x32_bf16 v[224:227], v[64:67], v[60:63], v[224:227]
    ds_read_b128 v[92:95], v3 offset:15360
    v_cvt_pk_bf16_f32 v53, v106, v107
    v_mfma_f32_16x16x32_bf16 v[196:199], v[68:71], v[56:59], v[196:199]
    v_exp_f32 v101, v101
    v_mfma_f32_16x16x32_bf16 v[228:231], v[68:71], v[60:63], v[228:231]
    v_add_u32 v3, 65536, v2
    v_add_u32 v2, s41, v2
    s_waitcnt lgkmcnt(4)
    v_mfma_f32_16x16x32_bf16 v[200:203], v[72:75], v[56:59], v[200:203]
    v_exp_f32 v102, v102
    v_and_b32 v2, s49, v2
    v_mfma_f32_16x16x32_bf16 v[232:235], v[72:75], v[60:63], v[232:235]
    v_mfma_f32_16x16x32_bf16 v[28:31], v[36:39], v[56:59], v[28:31]
    v_cvt_pk_bf16_f32 v50, v100, v101
    s_waitcnt lgkmcnt(0)
    s_barrier
    v_mfma_f32_16x16x32_bf16 v[204:207], v[76:79], v[56:59], v[204:207]
    v_exp_f32 v103, v103
    v_mfma_f32_16x16x32_bf16 v[236:239], v[76:79], v[60:63], v[236:239]
    ds_read_b128 v[68:71], v2 offset:1024
    ds_read_b128 v[64:67], v2 offset:0
    v_mfma_f32_16x16x32_bf16 v[208:211], v[80:83], v[56:59], v[208:211]
    v_exp_f32 v108, v108
    v_mfma_f32_16x16x32_bf16 v[240:243], v[80:83], v[60:63], v[240:243]
    ds_read_b128 v[76:79], v2 offset:3072
    ds_read_b128 v[72:75], v2 offset:2048
    v_cvt_pk_bf16_f32 v51, v102, v103
    v_mfma_f32_16x16x32_bf16 v[212:215], v[84:87], v[56:59], v[212:215]
    v_exp_f32 v109, v109
    v_mfma_f32_16x16x32_bf16 v[244:247], v[84:87], v[60:63], v[244:247]
    ds_read_b128 v[80:83], v2 offset:4096
    v_mfma_f32_16x16x32_bf16 v[216:219], v[88:91], v[56:59], v[216:219]
    v_exp_f32 v110, v110
    v_mfma_f32_16x16x32_bf16 v[248:251], v[88:91], v[60:63], v[248:251]
    v_mfma_f32_16x16x32_bf16 v[32:35], v[36:39], v[60:63], v[32:35]
    ds_read_b128 v[84:87], v2 offset:5120
    v_cvt_pk_bf16_f32 v54, v108, v109
    v_mfma_f32_16x16x32_bf16 v[220:223], v[92:95], v[56:59], v[220:223]
    v_exp_f32 v111, v111
    v_mfma_f32_16x16x32_bf16 v[252:255], v[92:95], v[60:63], v[252:255]
    ds_read_b128 v[88:91], v2 offset:6144
    v_cvt_pk_bf16_f32 v55, v110, v111
    s_bitcmp1_b32 s42, s40
    s_cbranch_scc1 L_recurrent_scan__compressed_kv_cla__moe_arch_mod__prompt_kernel_rare_157
L_recurrent_scan__compressed_kv_cla__moe_arch_mod__prompt_kernel_back_158:
    s_add_u32 s40, s40, 1
    s_cmp_lg_u32 s40, 16
    s_cbranch_scc1 L_body11
    s_lshr_b32 s36, s2, 5
    s_add_u32 s36, s36, 48
    s_lshl_b32 s36, s36, 7
    v_mov_b32 v12, s36
    global_load_dword v11, v12, s[90:91] sc1
    s_sub_u32 s36, 96, s50
    s_cmp_lt_i32 s36, 0
    s_cbranch_scc0 L_recurrent_scan__compressed_kv_cla__moe_arch_mod__prompt_kernel_rare_127
L_recurrent_scan__compressed_kv_cla__moe_arch_mod__prompt_kernel_back_128:
    s_lshl_b32 s37, s28, 13
    v_add_u32 v5, s37, v7
    s_waitcnt lgkmcnt(5)
    v_mfma_f32_16x16x32_bf16 v[192:195], v[64:67], v[48:51], v[192:195]
    v_exp_f32 v112, v112
    v_mfma_f32_16x16x32_bf16 v[224:227], v[64:67], v[52:55], v[224:227]
    ds_read_b128 v[92:95], v3 offset:7168
    v_exp_f32 v113, v113
    v_mfma_f32_16x16x32_bf16 v[196:199], v[68:71], v[48:51], v[196:199]
    v_cvt_pk_bf16_f32 v56, v112, v113
    v_exp_f32 v114, v114
    v_mfma_f32_16x16x32_bf16 v[228:231], v[68:71], v[52:55], v[228:231]
    ds_read_b128 v[64:67], v3 offset:8192
    v_exp_f32 v115, v115
    s_waitcnt lgkmcnt(5)
    v_mfma_f32_16x16x32_bf16 v[200:203], v[72:75], v[48:51], v[200:203]
    v_cvt_pk_bf16_f32 v57, v114, v115
    v_exp_f32 v120, v120
    v_mfma_f32_16x16x32_bf16 v[232:235], v[72:75], v[52:55], v[232:235]
    v_mfma_f32_16x16x32_bf16 v[28:31], v[36:39], v[48:51], v[28:31]
    ds_read_b128 v[68:71], v3 offset:9216
    v_exp_f32 v121, v121
    v_mfma_f32_16x16x32_bf16 v[204:207], v[76:79], v[48:51], v[204:207]
    v_cvt_pk_bf16_f32 v60, v120, v121
    v_exp_f32 v122, v122
    v_mfma_f32_16x16x32_bf16 v[236:239], v[76:79], v[52:55], v[236:239]
    ds_read_b128 v[72:75], v3 offset:10240
    v_exp_f32 v123, v123
    s_waitcnt lgkmcnt(6)
    v_mfma_f32_16x16x32_bf16 v[208:211], v[80:83], v[48:51], v[208:211]
    v_cvt_pk_bf16_f32 v61, v122, v123
    v_exp_f32 v116, v116
    v_mfma_f32_16x16x32_bf16 v[240:243], v[80:83], v[52:55], v[240:243]
    ds_read_b128 v[76:79], v3 offset:11264
    v_exp_f32 v117, v117
    s_waitcnt lgkmcnt(6)
    v_mfma_f32_16x16x32_bf16 v[212:215], v[84:87], v[48:51], v[212:215]
    v_cvt_pk_bf16_f32 v58, v116, v117
    v_exp_f32 v118, v118
    v_mfma_f32_16x16x32_bf16 v[244:247], v[84:87], v[52:55], v[244:247]
    ds_read_b128 v[80:83], v3 offset:12288
    v_exp_f32 v119, v119
    s_waitcnt lgkmcnt(6)
    v_mfma_f32_16x16x32_bf16 v[216:219], v[88:91], v[48:51], v[216:219]
    v_cvt_pk_bf16_f32 v59, v118, v119
    v_exp_f32 v124, v124
    v_mfma_f32_16x16x32_bf16 v[248:251], v[88:91], v[52:55], v[248:251]
    v_mfma_f32_16x16x32_bf16 v[32:35], v[36:39], v[52:55], v[32:35]
    ds_read_b128 v[84:87], v3 offset:13312
    v_exp_f32 v125, v125
    s_waitcnt lgkmcnt(6)
    v_mfma_f32_16x16x32_bf16 v[220:223], v[92:95], v[48:51], v[220:223]
    v_cvt_pk_bf16_f32 v62, v124, v125
    v_exp_f32 v126, v126
    v_mfma_f32_16x16x32_bf16 v[252:255], v[92:95], v[52:55], v[252:255]
    ds_read_b128 v[88:91], v3 offset:14336
    v_exp_f32 v127, v127
    s_nop 0
    v_cvt_pk_bf16_f32 v63, v126, v127
    s_nop 1
    s_waitcnt lgkmcnt(6)
    v_mfma_f32_16x16x32_bf16 v[192:195], v[64:67], v[56:59], v[192:195]
    s_mov_b32 s4, s34
    s_and_b32 s5, s35, 0xffff
    s_mov_b32 s6, 7340032
    s_mov_b32 s7, 0x20000
    s_mov_b32 s8, s32
    v_mfma_f32_16x16x32_bf16 v[224:227], v[64:67], v[60:63], v[224:227]
    ds_read_b128 v[92:95], v3 offset:15360
    s_and_b32 s9, s33, 0xffff
    s_mov_b32 s10, 8388608
    s_mov_b32 s11, 0x20000
    s_lshr_b32 s38, s2, 4
    s_waitcnt lgkmcnt(6)
    v_mfma_f32_16x16x32_bf16 v[196:199], v[68:71], v[56:59], v[196:199]
    s_mul_i32 s38, s38, 224
    s_and_b32 s39, s2, 15
    s_lshl_b32 s39, s39, 7
    v_lshrrev_b32 v25, 3, v1
    s_lshl_b32 s36, s28, 5
    v_mfma_f32_16x16x32_bf16 v[228:231], v[68:71], v[60:63], v[228:231]
    s_add_u32 s36, s36, s38
    v_add_u32 v25, s36, v25
    v_mul_u32_u24 v25, 2048, v25
    v_add_u32 v25, s39, v25
    s_waitcnt lgkmcnt(5)
    v_mfma_f32_16x16x32_bf16 v[200:203], v[72:75], v[56:59], v[200:203]
    v_bfe_u32 v26, v1, 4, 1
    v_lshlrev_b32 v26, 1, v26
    v_and_b32 v27, 7, v1
    v_xor_b32 v26, v26, v27
    v_mfma_f32_16x16x32_bf16 v[232:235], v[72:75], v[60:63], v[232:235]
    v_mfma_f32_16x16x32_bf16 v[28:31], v[36:39], v[56:59], v[28:31]
    v_lshl_add_u32 v24, v26, 4, v25
    v_xor_b32 v26, 4, v26
    v_lshl_add_u32 v25, v26, 4, v25
    v_add_u32 v25, 15360, v25
    v_add_u32 v26, 30720, v24
    s_waitcnt lgkmcnt(4)
    v_mfma_f32_16x16x32_bf16 v[204:207], v[76:79], v[56:59], v[204:207]
    v_add_u32 v27, 30720, v25
    s_lshl_b32 s36, s28, 12
    s_add_u32 s36, s36, 131072
    s_cmp_lt_u32 s28, 7
    s_cselect_b32 m0, s36, 0x30000
    s_cselect_b32 s6, 7340032, 0
    v_mfma_f32_16x16x32_bf16 v[236:239], v[76:79], v[60:63], v[236:239]
    buffer_load_dwordx4 v24, s[4:7], 0 offen offset:0 lds
    buffer_load_dwordx4 v25, s[4:7], 0 offen offset:1024 lds
    buffer_load_dwordx4 v26, s[4:7], 0 offen offset:2048 lds
    buffer_load_dwordx4 v27, s[4:7], 0 offen offset:3072 lds
    s_waitcnt lgkmcnt(3)
    v_mfma_f32_16x16x32_bf16 v[208:211], v[80:83], v[56:59], v[208:211]
    v_mfma_f32_16x16x32_bf16 v[240:243], v[80:83], v[60:63], v[240:243]
    ds_write_b128 v5, v[192:195] offset:0
    s_waitcnt lgkmcnt(3)
    v_mfma_f32_16x16x32_bf16 v[212:215], v[84:87], v[56:59], v[212:215]
    v_mfma_f32_16x16x32_bf16 v[244:247], v[84:87], v[60:63], v[244:247]
    ds_write_b128 v5, v[196:199] offset:1024
    s_waitcnt lgkmcnt(3)
    v_mfma_f32_16x16x32_bf16 v[216:219], v[88:91], v[56:59], v[216:219]
    v_mfma_f32_16x16x32_bf16 v[248:251], v[88:91], v[60:63], v[248:251]
    v_mfma_f32_16x16x32_bf16 v[32:35], v[36:39], v[60:63], v[32:35]
    ds_write_b128 v5, v[200:203] offset:2048
    s_waitcnt lgkmcnt(3)
    v_mfma_f32_16x16x32_bf16 v[220:223], v[92:95], v[56:59], v[220:223]
    v_mfma_f32_16x16x32_bf16 v[252:255], v[92:95], v[60:63], v[252:255]
    ds_write_b128 v5, v[204:207] offset:3072
    ds_write_b128 v5, v[208:211] offset:4096
    ds_write_b128 v5, v[212:215] offset:5120
    v_xor_b32 v106, 32768, v5
    s_lshl_b32 s37, s28, 8
    s_add_u32 s37, s37, 159744
    v_lshl_add_u32 v107, v1, 2, s37
    v_xor_b32 v108, 1024, v107
    ds_write_b128 v5, v[216:219] offset:6144
    ds_write_b128 v5, v[220:223] offset:7168
    ds_write_b32 v107, v28
    s_mov_b32 s36, 0x5d800000
    v_cmp_nge_f32 vcc, s36, v28
    s_nop 0
    s_or_b64 s[52:53], s[52:53], vcc
    v_cmp_nge_f32 vcc, s36, v32
    s_nop 0
    s_or_b64 s[52:53], s[52:53], vcc
    s_or_b32 s36, s52, s53
    v_mov_b32 v110, s36
    s_lshl_b32 s37, s28, 2
    s_add_u32 s37, s37, 161792
    v_mov_b32 v111, s37
    ds_write_b32 v111, v110
    v_mov_b32 v112, 161856
    v_and_b32 v111, 7, v1
    v_lshlrev_b32 v111, 2, v111
    v_add_u32 v111, 161792, v111
    v_mov_b32 v113, v7
    s_sub_u32 s36, 15, s30
    s_lshl_b32 s38, s36, 3
    s_and_b32 s37, s28, 3
    s_lshl_b32 s37, s37, 1
    s_add_u32 s38, s38, s37
    s_add_u32 s38, s38, 1
    s_lshl_b32 s38, s38, 17
    s_lshl_b32 s37, s29, 12
    s_add_u32 s38, s38, s37
    s_waitcnt vmcnt(4)
    v_readfirstlane_b32 s36, v11
    s_nop 0
    s_cmp_lt_u32 s36, 28
    s_cbranch_scc1 L_recurrent_scan__compressed_kv_cla__moe_arch_mod__prompt_kernel_rare_161
L_recurrent_scan__compressed_kv_cla__moe_arch_mod__prompt_kernel_back_162:
    s_lshr_b32 s36, s2, 4
    s_mul_i32 s36, s36, 7
    s_min_u32 s37, s28, 6
    s_add_u32 s36, s36, s37
    s_lshl_b32 s36, s36, 11
    s_add_u32 s36, s36, 58720256
    v_and_b32 v11, 15, v1
    v_lshlrev_b32 v11, 4, v11
    v_lshrrev_b32 v12, 4, v1
    v_lshl_add_u32 v11, v12, 9, v11
    buffer_load_dwordx4 v[96:99], v11, s[24:27], s36 offen offset:0 sc1
    buffer_load_dwordx4 v[100:103], v11, s[24:27], s36 offen offset:256 sc1
    s_waitcnt lgkmcnt(0)
    s_barrier
    ds_read_b128 v[114:117], v112
    ds_read_b32 v110, v111
    ds_read_b32 v109, v108
    ds_read_b128 v[64:67], v106 offset:0
    ds_read_b128 v[68:71], v106 offset:1024
    ds_read_b128 v[72:75], v106 offset:2048
    ds_read_b128 v[76:79], v106 offset:3072
    ds_read_b128 v[80:83], v106 offset:4096
    ds_read_b128 v[84:87], v106 offset:5120
    ds_read_b128 v[88:91], v106 offset:6144
    ds_read_b128 v[92:95], v106 offset:7168
    s_waitcnt lgkmcnt(8)
    v_add_f32 v109, v109, v32
    v_cmp_ne_u32 s[52:53], 0, v110
    v_readfirstlane_b32 s56, v114
    v_readfirstlane_b32 s57, v115
    v_readfirstlane_b32 s58, v116
    v_readfirstlane_b32 s59, v117
    v_rcp_f32 v109, v109
    s_nop 0
    v_mov_b32 v108, v109
    s_waitcnt lgkmcnt(6)
    v_pk_add_f32 v[224:225], v[224:225], v[64:65]
    v_pk_add_f32 v[226:227], v[226:227], v[66:67]
    v_pk_add_f32 v[228:229], v[228:229], v[68:69]
    v_pk_add_f32 v[230:231], v[230:231], v[70:71]
    v_pk_mul_f32 v[224:225], v[224:225], v[108:109]
    v_pk_mul_f32 v[226:227], v[226:227], v[108:109]
    v_pk_mul_f32 v[228:229], v[228:229], v[108:109]
    v_pk_mul_f32 v[230:231], v[230:231], v[108:109]
    v_cvt_pk_bf16_f32 v48, v224, v225
    v_cvt_pk_bf16_f32 v49, v226, v227
    v_cvt_pk_bf16_f32 v50, v228, v229
    v_cvt_pk_bf16_f32 v51, v230, v231
    buffer_store_dwordx4 v[48:51], v113, s[16:19], s38 offen offset:0 sc1
    s_waitcnt lgkmcnt(4)
    v_pk_add_f32 v[232:233], v[232:233], v[72:73]
    v_pk_add_f32 v[234:235], v[234:235], v[74:75]
    v_pk_add_f32 v[236:237], v[236:237], v[76:77]
    v_pk_add_f32 v[238:239], v[238:239], v[78:79]
    v_pk_mul_f32 v[232:233], v[232:233], v[108:109]
    v_pk_mul_f32 v[234:235], v[234:235], v[108:109]
    v_pk_mul_f32 v[236:237], v[236:237], v[108:109]
    v_pk_mul_f32 v[238:239], v[238:239], v[108:109]
    v_cvt_pk_bf16_f32 v52, v232, v233
    v_cvt_pk_bf16_f32 v53, v234, v235
    v_cvt_pk_bf16_f32 v54, v236, v237
    v_cvt_pk_bf16_f32 v55, v238, v239
    buffer_store_dwordx4 v[52:55], v113, s[16:19], s38 offen offset:1024 sc1
    s_waitcnt lgkmcnt(2)
    v_pk_add_f32 v[240:241], v[240:241], v[80:81]
    v_pk_add_f32 v[242:243], v[242:243], v[82:83]
    v_pk_add_f32 v[244:245], v[244:245], v[84:85]
    v_pk_add_f32 v[246:247], v[246:247], v[86:87]
    v_pk_mul_f32 v[240:241], v[240:241], v[108:109]
    v_pk_mul_f32 v[242:243], v[242:243], v[108:109]
    v_pk_mul_f32 v[244:245], v[244:245], v[108:109]
    v_pk_mul_f32 v[246:247], v[246:247], v[108:109]
    v_cvt_pk_bf16_f32 v56, v240, v241
    v_cvt_pk_bf16_f32 v57, v242, v243
    v_cvt_pk_bf16_f32 v58, v244, v245
    v_cvt_pk_bf16_f32 v59, v246, v247
    buffer_store_dwordx4 v[56:59], v113, s[16:19], s38 offen offset:2048 sc1
    s_waitcnt lgkmcnt(0)
    v_pk_add_f32 v[248:249], v[248:249], v[88:89]
    v_pk_add_f32 v[250:251], v[250:251], v[90:91]
    v_pk_add_f32 v[252:253], v[252:253], v[92:93]
    v_pk_add_f32 v[254:255], v[254:255], v[94:95]
    v_pk_mul_f32 v[248:249], v[248:249], v[108:109]
    v_pk_mul_f32 v[250:251], v[250:251], v[108:109]
    v_pk_mul_f32 v[252:253], v[252:253], v[108:109]
    v_pk_mul_f32 v[254:255], v[254:255], v[108:109]
    v_cvt_pk_bf16_f32 v60, v248, v249
    v_cvt_pk_bf16_f32 v61, v250, v251
    v_cvt_pk_bf16_f32 v62, v252, v253
    v_cvt_pk_bf16_f32 v63, v254, v255
    buffer_store_dwordx4 v[60:63], v113, s[16:19], s38 offen offset:3072 sc1
    s_cmp_eq_u64 s[52:53], 0
    s_cbranch_scc1 L_p3_done
    s_waitcnt vmcnt(0)
    v_mov_b32 v112, v96
    v_mov_b32 v113, v97
    v_mov_b32 v114, v98
    v_mov_b32 v115, v99
    v_mov_b32 v116, v100
    v_mov_b32 v117, v101
    v_mov_b32 v118, v102
    v_mov_b32 v119, v103
    v_mov_b32 v192, 0
    v_mov_b32 v193, 0
    v_mov_b32 v194, 0
    v_mov_b32 v195, 0
    v_mov_b32 v196, 0
    v_mov_b32 v197, 0
    v_mov_b32 v198, 0
    v_mov_b32 v199, 0
    v_mov_b32 v200, 0
    v_mov_b32 v201, 0
    v_mov_b32 v202, 0
    v_mov_b32 v203, 0
    v_mov_b32 v204, 0
    v_mov_b32 v205, 0
    v_mov_b32 v206, 0
    v_mov_b32 v207, 0
    v_mov_b32 v208, 0
    v_mov_b32 v209, 0
    v_mov_b32 v210, 0
    v_mov_b32 v211, 0
    v_mov_b32 v212, 0
    v_mov_b32 v213, 0
    v_mov_b32 v214, 0
    v_mov_b32 v215, 0
    v_mov_b32 v216, 0
    v_mov_b32 v217, 0
    v_mov_b32 v218, 0
    v_mov_b32 v219, 0
    v_mov_b32 v220, 0
    v_mov_b32 v221, 0
    v_mov_b32 v222, 0
    v_mov_b32 v223, 0
    v_mov_b32 v224, 0
    v_mov_b32 v225, 0
    v_mov_b32 v226, 0
    v_mov_b32 v227, 0
    v_mov_b32 v228, 0
    v_mov_b32 v229, 0
    v_mov_b32 v230, 0
    v_mov_b32 v231, 0
    v_mov_b32 v232, 0
    v_mov_b32 v233, 0
    v_mov_b32 v234, 0
    v_mov_b32 v235, 0
    v_mov_b32 v236, 0
    v_mov_b32 v237, 0
    v_mov_b32 v238, 0
    v_mov_b32 v239, 0
    v_mov_b32 v240, 0
    v_mov_b32 v241, 0
    v_mov_b32 v242, 0
    v_mov_b32 v243, 0
    v_mov_b32 v244, 0
    v_mov_b32 v245, 0
    v_mov_b32 v246, 0
    v_mov_b32 v247, 0
    v_mov_b32 v248, 0
    v_mov_b32 v249, 0
    v_mov_b32 v250, 0
    v_mov_b32 v251, 0
    v_mov_b32 v252, 0
    v_mov_b32 v253, 0
    v_mov_b32 v254, 0
    v_mov_b32 v255, 0
    v_mov_b32 v28, 0
    v_mov_b32 v40, 4048155338
    v_mov_b32 v32, 0
    v_mov_b32 v41, 4048155338
    s_lshl_b32 s43, s28, 12
    v_add_u32 v4, s43, v7
    s_mov_b32 s46, s45
    s_sub_u32 s40, 16, s30
    s_mov_b32 s39, s30
    s_lshl_b32 s37, s39, 7
    s_and_b32 s36, s28, 3
    s_lshl_b32 s36, s36, 5
    s_add_u32 s36, s36, s37
    s_sub_u32 s50, 0, s36
L_recurrent_scan__compressed_kv_cla__moe_arch_mod__prompt_kernel_stile_163:
    s_waitcnt vmcnt(0) lgkmcnt(0)
    s_barrier
    s_mov_b32 m0, s43
    s_add_u32 s47, s46, 32768
    buffer_load_dwordx4 v4, s[12:15], s46 offen offset:0 sc1 lds
    buffer_load_dwordx4 v4, s[12:15], s46 offen offset:1024 sc1 lds
    buffer_load_dwordx4 v4, s[12:15], s46 offen offset:2048 sc1 lds
    buffer_load_dwordx4 v4, s[12:15], s46 offen offset:3072 sc1 lds
    s_add_u32 m0, s43, 32768
    s_add_u32 s46, s46, 65536
    buffer_load_dwordx4 v4, s[12:15], s47 offen offset:0 sc1 lds
    buffer_load_dwordx4 v4, s[12:15], s47 offen offset:1024 sc1 lds
    buffer_load_dwordx4 v4, s[12:15], s47 offen offset:2048 sc1 lds
    buffer_load_dwordx4 v4, s[12:15], s47 offen offset:3072 sc1 lds
    v_mov_b32 v2, v7
    s_mov_b32 s41, 4
    s_waitcnt vmcnt(0)
    s_barrier
L_recurrent_scan__compressed_kv_cla__moe_arch_mod__prompt_kernel_sunit_164:
    s_cmp_gt_i32 s50, 0
    s_cbranch_scc1 L_recurrent_scan__compressed_kv_cla__moe_arch_mod__prompt_kernel_snext_165
    ds_read_b128 v[64:67], v2 offset:0
    ds_read_b128 v[68:71], v2 offset:1024
    ds_read_b128 v[72:75], v2 offset:2048
    ds_read_b128 v[76:79], v2 offset:3072
    ds_read_b128 v[80:83], v2 offset:4096
    ds_read_b128 v[84:87], v2 offset:5120
    ds_read_b128 v[88:91], v2 offset:6144
    ds_read_b128 v[92:95], v2 offset:7168
    s_waitcnt lgkmcnt(0)
    v_mfma_f32_16x16x32_bf16 v[96:99], v[64:67], v[128:131], 0
    v_mfma_f32_16x16x32_bf16 v[104:107], v[64:67], v[144:147], 0
    v_mfma_f32_16x16x32_bf16 v[96:99], v[68:71], v[132:135], v[96:99]
    v_mfma_f32_16x16x32_bf16 v[104:107], v[68:71], v[148:151], v[104:107]
    v_mfma_f32_16x16x32_bf16 v[96:99], v[72:75], v[136:139], v[96:99]
    v_mfma_f32_16x16x32_bf16 v[104:107], v[72:75], v[152:155], v[104:107]
    v_mfma_f32_16x16x32_bf16 v[96:99], v[76:79], v[140:143], v[96:99]
    v_mfma_f32_16x16x32_bf16 v[104:107], v[76:79], v[156:159], v[104:107]
    v_mfma_f32_16x16x32_bf16 v[100:103], v[80:83], v[128:131], 0
    v_mfma_f32_16x16x32_bf16 v[108:111], v[80:83], v[144:147], 0
    v_mfma_f32_16x16x32_bf16 v[100:103], v[84:87], v[132:135], v[100:103]
    v_mfma_f32_16x16x32_bf16 v[108:111], v[84:87], v[148:151], v[108:111]
    v_mfma_f32_16x16x32_bf16 v[100:103], v[88:91], v[136:139], v[100:103]
    v_mfma_f32_16x16x32_bf16 v[108:111], v[88:91], v[152:155], v[108:111]
    v_mfma_f32_16x16x32_bf16 v[100:103], v[92:95], v[140:143], v[100:103]
    v_mfma_f32_16x16x32_bf16 v[108:111], v[92:95], v[156:159], v[108:111]
    ds_read_b128 v[64:67], v2 offset:32768
    ds_read_b128 v[68:71], v2 offset:33792
    ds_read_b128 v[72:75], v2 offset:34816
    ds_read_b128 v[76:79], v2 offset:35840
    ds_read_b128 v[80:83], v2 offset:36864
    ds_read_b128 v[84:87], v2 offset:37888
    ds_read_b128 v[88:91], v2 offset:38912
    ds_read_b128 v[92:95], v2 offset:39936
    s_nop 1
    s_cmp_lt_i32 s50, 0
    s_cbranch_scc0 L_recurrent_scan__compressed_kv_cla__moe_arch_mod__prompt_kernel_rare_168
L_recurrent_scan__compressed_kv_cla__moe_arch_mod__prompt_kernel_back_169:
    v_max3_f32 v22, v96, v97, v98
    v_max3_f32 v22, v22, v99, v100
    v_max3_f32 v22, v22, v101, v102
    v_max3_f32 v22, v22, v103, v40
    v_mov_b32 v24, v22
    s_nop 1
    v_permlane16_swap_b32 v22, v24
    s_nop 1
    v_max_f32 v22, v22, v24
    v_mov_b32 v24, v22
    s_nop 1
    v_permlane32_swap_b32 v22, v24
    s_nop 1
    v_max_f32 v22, v22, v24
    v_sub_f32 v25, v40, v22
    v_exp_f32 v25, v25
    v_mov_b32 v40, v22
    v_mul_f32 v28, v28, v25
    v_mul_f32 v192, v192, v25
    v_mul_f32 v193, v193, v25
    v_mul_f32 v194, v194, v25
    v_mul_f32 v195, v195, v25
    v_mul_f32 v196, v196, v25
    v_mul_f32 v197, v197, v25
    v_mul_f32 v198, v198, v25
    v_mul_f32 v199, v199, v25
    v_mul_f32 v200, v200, v25
    v_mul_f32 v201, v201, v25
    v_mul_f32 v202, v202, v25
    v_mul_f32 v203, v203, v25
    v_mul_f32 v204, v204, v25
    v_mul_f32 v205, v205, v25
    v_mul_f32 v206, v206, v25
    v_mul_f32 v207, v207, v25
    v_mul_f32 v208, v208, v25
    v_mul_f32 v209, v209, v25
    v_mul_f32 v210, v210, v25
    v_mul_f32 v211, v211, v25
    v_mul_f32 v212, v212, v25
    v_mul_f32 v213, v213, v25
    v_mul_f32 v214, v214, v25
    v_mul_f32 v215, v215, v25
    v_mul_f32 v216, v216, v25
    v_mul_f32 v217, v217, v25
    v_mul_f32 v218, v218, v25
    v_mul_f32 v219, v219, v25
    v_mul_f32 v220, v220, v25
    v_mul_f32 v221, v221, v25
    v_mul_f32 v222, v222, v25
    v_mul_f32 v223, v223, v25
    v_sub_f32 v96, v96, v22
    v_sub_f32 v97, v97, v22
    v_sub_f32 v98, v98, v22
    v_sub_f32 v99, v99, v22
    v_sub_f32 v100, v100, v22
    v_sub_f32 v101, v101, v22
    v_sub_f32 v102, v102, v22
    v_sub_f32 v103, v103, v22
    v_max3_f32 v23, v104, v105, v106
    v_max3_f32 v23, v23, v107, v108
    v_max3_f32 v23, v23, v109, v110
    v_max3_f32 v23, v23, v111, v41
    v_mov_b32 v24, v23
    s_nop 1
    v_permlane16_swap_b32 v23, v24
    s_nop 1
    v_max_f32 v23, v23, v24
    v_mov_b32 v24, v23
    s_nop 1
    v_permlane32_swap_b32 v23, v24
    s_nop 1
    v_max_f32 v23, v23, v24
    v_sub_f32 v25, v41, v23
    v_exp_f32 v25, v25
    v_mov_b32 v41, v23
    v_mul_f32 v32, v32, v25
    v_mul_f32 v224, v224, v25
    v_mul_f32 v225, v225, v25
    v_mul_f32 v226, v226, v25
    v_mul_f32 v227, v227, v25
    v_mul_f32 v228, v228, v25
    v_mul_f32 v229, v229, v25
    v_mul_f32 v230, v230, v25
    v_mul_f32 v231, v231, v25
    v_mul_f32 v232, v232, v25
    v_mul_f32 v233, v233, v25
    v_mul_f32 v234, v234, v25
    v_mul_f32 v235, v235, v25
    v_mul_f32 v236, v236, v25
    v_mul_f32 v237, v237, v25
    v_mul_f32 v238, v238, v25
    v_mul_f32 v239, v239, v25
    v_mul_f32 v240, v240, v25
    v_mul_f32 v241, v241, v25
    v_mul_f32 v242, v242, v25
    v_mul_f32 v243, v243, v25
    v_mul_f32 v244, v244, v25
    v_mul_f32 v245, v245, v25
    v_mul_f32 v246, v246, v25
    v_mul_f32 v247, v247, v25
    v_mul_f32 v248, v248, v25
    v_mul_f32 v249, v249, v25
    v_mul_f32 v250, v250, v25
    v_mul_f32 v251, v251, v25
    v_mul_f32 v252, v252, v25
    v_mul_f32 v253, v253, v25
    v_mul_f32 v254, v254, v25
    v_mul_f32 v255, v255, v25
    v_sub_f32 v104, v104, v23
    v_sub_f32 v105, v105, v23
    v_sub_f32 v106, v106, v23
    v_sub_f32 v107, v107, v23
    v_sub_f32 v108, v108, v23
    v_sub_f32 v109, v109, v23
    v_sub_f32 v110, v110, v23
    v_sub_f32 v111, v111, v23
    v_exp_f32 v96, v96
    v_exp_f32 v97, v97
    v_exp_f32 v98, v98
    v_exp_f32 v99, v99
    v_exp_f32 v104, v104
    v_exp_f32 v105, v105
    v_exp_f32 v106, v106
    v_exp_f32 v107, v107
    v_exp_f32 v100, v100
    v_exp_f32 v101, v101
    v_exp_f32 v102, v102
    v_exp_f32 v103, v103
    v_exp_f32 v108, v108
    v_exp_f32 v109, v109
    v_exp_f32 v110, v110
    v_exp_f32 v111, v111
    v_add_f32 v28, v28, v96
    v_add_f32 v28, v28, v97
    v_cvt_pk_bf16_f32 v48, v96, v97
    v_add_f32 v28, v28, v98
    v_add_f32 v28, v28, v99
    v_cvt_pk_bf16_f32 v49, v98, v99
    v_add_f32 v32, v32, v104
    v_add_f32 v32, v32, v105
    v_cvt_pk_bf16_f32 v52, v104, v105
    v_add_f32 v32, v32, v106
    v_add_f32 v32, v32, v107
    v_cvt_pk_bf16_f32 v53, v106, v107
    v_add_f32 v28, v28, v100
    v_add_f32 v28, v28, v101
    v_cvt_pk_bf16_f32 v50, v100, v101
    v_add_f32 v28, v28, v102
    v_add_f32 v28, v28, v103
    v_cvt_pk_bf16_f32 v51, v102, v103
    v_add_f32 v32, v32, v108
    v_add_f32 v32, v32, v109
    v_cvt_pk_bf16_f32 v54, v108, v109
    v_add_f32 v32, v32, v110
    v_add_f32 v32, v32, v111
    v_cvt_pk_bf16_f32 v55, v110, v111
    s_waitcnt lgkmcnt(0)
    s_nop 0
    v_mfma_f32_16x16x32_bf16 v[192:195], v[64:67], v[48:51], v[192:195]
    v_mfma_f32_16x16x32_bf16 v[224:227], v[64:67], v[52:55], v[224:227]
    v_mfma_f32_16x16x32_bf16 v[196:199], v[68:71], v[48:51], v[196:199]
    v_mfma_f32_16x16x32_bf16 v[228:231], v[68:71], v[52:55], v[228:231]
    v_mfma_f32_16x16x32_bf16 v[200:203], v[72:75], v[48:51], v[200:203]
    v_mfma_f32_16x16x32_bf16 v[232:235], v[72:75], v[52:55], v[232:235]
    v_mfma_f32_16x16x32_bf16 v[204:207], v[76:79], v[48:51], v[204:207]
    v_mfma_f32_16x16x32_bf16 v[236:239], v[76:79], v[52:55], v[236:239]
    v_mfma_f32_16x16x32_bf16 v[208:211], v[80:83], v[48:51], v[208:211]
    v_mfma_f32_16x16x32_bf16 v[240:243], v[80:83], v[52:55], v[240:243]
    v_mfma_f32_16x16x32_bf16 v[212:215], v[84:87], v[48:51], v[212:215]
    v_mfma_f32_16x16x32_bf16 v[244:247], v[84:87], v[52:55], v[244:247]
    v_mfma_f32_16x16x32_bf16 v[216:219], v[88:91], v[48:51], v[216:219]
    v_mfma_f32_16x16x32_bf16 v[248:251], v[88:91], v[52:55], v[248:251]
    v_mfma_f32_16x16x32_bf16 v[220:223], v[92:95], v[48:51], v[220:223]
    v_mfma_f32_16x16x32_bf16 v[252:255], v[92:95], v[52:55], v[252:255]
L_recurrent_scan__compressed_kv_cla__moe_arch_mod__prompt_kernel_snext_165:
    v_add_u32 v2, 8192, v2
    s_add_u32 s50, s50, 32
    s_sub_u32 s41, s41, 1
    s_cmp_lg_u32 s41, 0
    s_cbranch_scc1 L_recurrent_scan__compressed_kv_cla__moe_arch_mod__prompt_kernel_sunit_164
    s_sub_u32 s40, s40, 1
    s_cmp_lg_u32 s40, 0
    s_cbranch_scc1 L_recurrent_scan__compressed_kv_cla__moe_arch_mod__prompt_kernel_stile_163
    v_mov_b32 v20, v28
    s_nop 1
    v_permlane16_swap_b32 v28, v20
    s_nop 1
    v_add_f32 v28, v28, v20
    v_mov_b32 v20, v28
    s_nop 1
    v_permlane32_swap_b32 v28, v20
    s_nop 1
    v_add_f32 v28, v28, v20
    v_mov_b32 v20, v32
    s_nop 1
    v_permlane16_swap_b32 v32, v20
    s_nop 1
    v_add_f32 v32, v32, v20
    v_mov_b32 v20, v32
    s_nop 1
    v_permlane32_swap_b32 v32, v20
    s_nop 1
    v_add_f32 v32, v32, v20
    s_mov_b32 s36, 0x5d800000
    v_cmp_nge_f32 vcc, s36, v28
    s_nop 0
    s_or_b64 s[52:53], s[52:53], vcc
    v_cmp_nge_f32 vcc, s36, v32
    s_nop 0
    s_or_b64 s[52:53], s[52:53], vcc
    v_rcp_f32 v20, v28
    v_rcp_f32 v22, v32
    s_lshl_b32 s38, s39, 3
    s_and_b32 s37, s28, 3
    s_lshl_b32 s37, s37, 1
    s_add_u32 s38, s38, s37
    s_lshl_b32 s38, s38, 17
    s_lshl_b32 s37, s29, 12
    s_add_u32 s38, s38, s37
    v_mov_b32 v21, v20
    v_mov_b32 v23, v22
    v_mov_b32 v24, v7
    v_pk_mul_f32 v[192:193], v[192:193], v[20:21]
    v_pk_mul_f32 v[194:195], v[194:195], v[20:21]
    v_pk_mul_f32 v[196:197], v[196:197], v[20:21]
    v_pk_mul_f32 v[198:199], v[198:199], v[20:21]
    v_cvt_pk_bf16_f32 v192, v192, v193
    v_cvt_pk_bf16_f32 v193, v194, v195
    v_cvt_pk_bf16_f32 v194, v196, v197
    v_cvt_pk_bf16_f32 v195, v198, v199
    buffer_store_dwordx4 v[192:195], v24, s[16:19], s38 offen offset:0 sc1
    v_pk_mul_f32 v[200:201], v[200:201], v[20:21]
    v_pk_mul_f32 v[202:203], v[202:203], v[20:21]
    v_pk_mul_f32 v[204:205], v[204:205], v[20:21]
    v_pk_mul_f32 v[206:207], v[206:207], v[20:21]
    v_cvt_pk_bf16_f32 v200, v200, v201
    v_cvt_pk_bf16_f32 v201, v202, v203
    v_cvt_pk_bf16_f32 v202, v204, v205
    v_cvt_pk_bf16_f32 v203, v206, v207
    buffer_store_dwordx4 v[200:203], v24, s[16:19], s38 offen offset:1024 sc1
    v_pk_mul_f32 v[208:209], v[208:209], v[20:21]
    v_pk_mul_f32 v[210:211], v[210:211], v[20:21]
    v_pk_mul_f32 v[212:213], v[212:213], v[20:21]
    v_pk_mul_f32 v[214:215], v[214:215], v[20:21]
    v_cvt_pk_bf16_f32 v208, v208, v209
    v_cvt_pk_bf16_f32 v209, v210, v211
    v_cvt_pk_bf16_f32 v210, v212, v213
    v_cvt_pk_bf16_f32 v211, v214, v215
    buffer_store_dwordx4 v[208:211], v24, s[16:19], s38 offen offset:2048 sc1
    v_pk_mul_f32 v[216:217], v[216:217], v[20:21]
    v_pk_mul_f32 v[218:219], v[218:219], v[20:21]
    v_pk_mul_f32 v[220:221], v[220:221], v[20:21]
    v_pk_mul_f32 v[222:223], v[222:223], v[20:21]
    v_cvt_pk_bf16_f32 v216, v216, v217
    v_cvt_pk_bf16_f32 v217, v218, v219
    v_cvt_pk_bf16_f32 v218, v220, v221
    v_cvt_pk_bf16_f32 v219, v222, v223
    buffer_store_dwordx4 v[216:219], v24, s[16:19], s38 offen offset:3072 sc1
    s_add_u32 s38, s38, 131072
    v_pk_mul_f32 v[224:225], v[224:225], v[22:23]
    v_pk_mul_f32 v[226:227], v[226:227], v[22:23]
    v_pk_mul_f32 v[228:229], v[228:229], v[22:23]
    v_pk_mul_f32 v[230:231], v[230:231], v[22:23]
    v_cvt_pk_bf16_f32 v224, v224, v225
    v_cvt_pk_bf16_f32 v225, v226, v227
    v_cvt_pk_bf16_f32 v226, v228, v229
    v_cvt_pk_bf16_f32 v227, v230, v231
    buffer_store_dwordx4 v[224:227], v24, s[16:19], s38 offen offset:0 sc1
    v_pk_mul_f32 v[232:233], v[232:233], v[22:23]
    v_pk_mul_f32 v[234:235], v[234:235], v[22:23]
    v_pk_mul_f32 v[236:237], v[236:237], v[22:23]
    v_pk_mul_f32 v[238:239], v[238:239], v[22:23]
    v_cvt_pk_bf16_f32 v232, v232, v233
    v_cvt_pk_bf16_f32 v233, v234, v235
    v_cvt_pk_bf16_f32 v234, v236, v237
    v_cvt_pk_bf16_f32 v235, v238, v239
    buffer_store_dwordx4 v[232:235], v24, s[16:19], s38 offen offset:1024 sc1
    v_pk_mul_f32 v[240:241], v[240:241], v[22:23]
    v_pk_mul_f32 v[242:243], v[242:243], v[22:23]
    v_pk_mul_f32 v[244:245], v[244:245], v[22:23]
    v_pk_mul_f32 v[246:247], v[246:247], v[22:23]
    v_cvt_pk_bf16_f32 v240, v240, v241
    v_cvt_pk_bf16_f32 v241, v242, v243
    v_cvt_pk_bf16_f32 v242, v244, v245
    v_cvt_pk_bf16_f32 v243, v246, v247
    buffer_store_dwordx4 v[240:243], v24, s[16:19], s38 offen offset:2048 sc1
    v_pk_mul_f32 v[248:249], v[248:249], v[22:23]
    v_pk_mul_f32 v[250:251], v[250:251], v[22:23]
    v_pk_mul_f32 v[252:253], v[252:253], v[22:23]
    v_pk_mul_f32 v[254:255], v[254:255], v[22:23]
    v_cvt_pk_bf16_f32 v248, v248, v249
    v_cvt_pk_bf16_f32 v249, v250, v251
    v_cvt_pk_bf16_f32 v250, v252, v253
    v_cvt_pk_bf16_f32 v251, v254, v255
    buffer_store_dwordx4 v[248:251], v24, s[16:19], s38 offen offset:3072 sc1
    v_mov_b32 v96, v112
    v_mov_b32 v97, v113
    v_mov_b32 v98, v114
    v_mov_b32 v99, v115
    v_mov_b32 v100, v116
    v_mov_b32 v101, v117
    v_mov_b32 v102, v118
    v_mov_b32 v103, v119
    s_branch L_p3_done
L_recurrent_scan__compressed_kv_cla__moe_arch_mod__prompt_kernel_rare_108:
    s_cmp_lt_i32 s36, 0
    s_cbranch_scc1 L_recurrent_scan__compressed_kv_cla__moe_arch_mod__prompt_kernel_nm_107
    v_mov_b32 v20, 4048155338
    s_cmp_gt_i32 s36, 0
    s_cbranch_scc1 L_recurrent_scan__compressed_kv_cla__moe_arch_mod__prompt_kernel_mf_105
    v_cmp_gt_i32 s[20:21], 0, v18
    v_cmp_gt_i32 s[22:23], 1, v18
    v_cmp_gt_i32 s[62:63], 2, v18
    v_cmp_gt_i32 vcc, 3, v18
    v_mov_b32 v100, v20
    v_mov_b32 v101, v20
    v_mov_b32 v102, v20
    v_mov_b32 v103, v20
    v_cndmask_b32 v96, v96, v20, s[20:21]
    v_cndmask_b32 v97, v97, v20, s[22:23]
    v_cndmask_b32 v98, v98, v20, s[62:63]
    v_cndmask_b32 v99, v99, v20, vcc
    v_cndmask_b32 v108, v108, v20, s[20:21]
    v_cndmask_b32 v109, v109, v20, s[22:23]
    v_cndmask_b32 v110, v110, v20, s[62:63]
    v_cndmask_b32 v111, v111, v20, vcc
    s_branch L_recurrent_scan__compressed_kv_cla__moe_arch_mod__prompt_kernel_me_106
L_recurrent_scan__compressed_kv_cla__moe_arch_mod__prompt_kernel_mf_105:
    v_mov_b32 v96, v20
    v_mov_b32 v97, v20
    v_mov_b32 v98, v20
    v_mov_b32 v99, v20
    v_mov_b32 v100, v20
    v_mov_b32 v101, v20
    v_mov_b32 v102, v20
    v_mov_b32 v103, v20
    v_mov_b32 v104, v20
    v_mov_b32 v105, v20
    v_mov_b32 v106, v20
    v_mov_b32 v107, v20
    v_mov_b32 v108, v20
    v_mov_b32 v109, v20
    v_mov_b32 v110, v20
    v_mov_b32 v111, v20
L_recurrent_scan__compressed_kv_cla__moe_arch_mod__prompt_kernel_me_106:
L_recurrent_scan__compressed_kv_cla__moe_arch_mod__prompt_kernel_nm_107:
    s_branch L_recurrent_scan__compressed_kv_cla__moe_arch_mod__prompt_kernel_back_109
L_recurrent_scan__compressed_kv_cla__moe_arch_mod__prompt_kernel_rare_117:
    s_add_u32 s36, s40, 1
    s_sub_u32 s36, s36, s51
    s_cmp_lt_u32 s36, 2
    s_cbranch_scc0 L_recurrent_scan__compressed_kv_cla__moe_arch_mod__prompt_kernel_r_111
    s_lshl_b32 s36, s36, 6
    s_add_u32 s36, s36, 32
    s_sub_u32 s36, s36, s50
    s_cmp_lt_i32 s36, 0
    s_cbranch_scc1 L_recurrent_scan__compressed_kv_cla__moe_arch_mod__prompt_kernel_nm_116
    v_mov_b32 v20, 4048155338
    s_cmp_gt_i32 s36, 0
    s_cbranch_scc1 L_recurrent_scan__compressed_kv_cla__moe_arch_mod__prompt_kernel_mf_114
    v_cmp_gt_i32 s[20:21], 0, v18
    v_cmp_gt_i32 s[22:23], 1, v18
    v_cmp_gt_i32 s[62:63], 2, v18
    v_cmp_gt_i32 vcc, 3, v18
    v_mov_b32 v116, v20
    v_mov_b32 v117, v20
    v_mov_b32 v118, v20
    v_mov_b32 v119, v20
    v_cndmask_b32 v112, v112, v20, s[20:21]
    v_cndmask_b32 v113, v113, v20, s[22:23]
    v_cndmask_b32 v114, v114, v20, s[62:63]
    v_cndmask_b32 v115, v115, v20, vcc
    v_cndmask_b32 v124, v124, v20, s[20:21]
    v_cndmask_b32 v125, v125, v20, s[22:23]
    v_cndmask_b32 v126, v126, v20, s[62:63]
    v_cndmask_b32 v127, v127, v20, vcc
    s_branch L_recurrent_scan__compressed_kv_cla__moe_arch_mod__prompt_kernel_me_115
L_recurrent_scan__compressed_kv_cla__moe_arch_mod__prompt_kernel_mf_114:
    v_mov_b32 v112, v20
    v_mov_b32 v113, v20
    v_mov_b32 v114, v20
    v_mov_b32 v115, v20
    v_mov_b32 v116, v20
    v_mov_b32 v117, v20
    v_mov_b32 v118, v20
    v_mov_b32 v119, v20
    v_mov_b32 v120, v20
    v_mov_b32 v121, v20
    v_mov_b32 v122, v20
    v_mov_b32 v123, v20
    v_mov_b32 v124, v20
    v_mov_b32 v125, v20
    v_mov_b32 v126, v20
    v_mov_b32 v127, v20
L_recurrent_scan__compressed_kv_cla__moe_arch_mod__prompt_kernel_me_115:
L_recurrent_scan__compressed_kv_cla__moe_arch_mod__prompt_kernel_nm_116:
L_recurrent_scan__compressed_kv_cla__moe_arch_mod__prompt_kernel_r_111:
    s_branch L_recurrent_scan__compressed_kv_cla__moe_arch_mod__prompt_kernel_back_118
L_recurrent_scan__compressed_kv_cla__moe_arch_mod__prompt_kernel_rare_122:
    s_add_u32 s36, s40, 2
    s_sub_u32 s36, s36, s51
    s_cmp_eq_u32 s36, 1
    s_cselect_b32 s41, 0x8000, s41
    s_cmp_eq_u32 s40, 15
    s_cbranch_scc0 L_recurrent_scan__compressed_kv_cla__moe_arch_mod__prompt_kernel_r_112
    s_mov_b32 s41, 65536
    s_mov_b32 s49, 0x1ffff
    s_mov_b32 s36, 1
L_recurrent_scan__compressed_kv_cla__moe_arch_mod__prompt_kernel_r_112:
    s_cmp_lt_u32 s36, 2
    s_cbranch_scc0 L_recurrent_scan__compressed_kv_cla__moe_arch_mod__prompt_kernel_r_113
    s_lshl_b32 s36, s36, 6
    s_sub_u32 s36, s36, s50
    s_cmp_lt_i32 s36, 0
    s_cbranch_scc1 L_recurrent_scan__compressed_kv_cla__moe_arch_mod__prompt_kernel_nm_121
    v_mov_b32 v20, 4048155338
    s_cmp_gt_i32 s36, 0
    s_cbranch_scc1 L_recurrent_scan__compressed_kv_cla__moe_arch_mod__prompt_kernel_mf_119
    v_cmp_gt_i32 s[20:21], 0, v18
    v_cmp_gt_i32 s[22:23], 1, v18
    v_cmp_gt_i32 s[62:63], 2, v18
    v_cmp_gt_i32 vcc, 3, v18
    v_mov_b32 v100, v20
    v_mov_b32 v101, v20
    v_mov_b32 v102, v20
    v_mov_b32 v103, v20
    v_cndmask_b32 v96, v96, v20, s[20:21]
    v_cndmask_b32 v97, v97, v20, s[22:23]
    v_cndmask_b32 v98, v98, v20, s[62:63]
    v_cndmask_b32 v99, v99, v20, vcc
    v_cndmask_b32 v108, v108, v20, s[20:21]
    v_cndmask_b32 v109, v109, v20, s[22:23]
    v_cndmask_b32 v110, v110, v20, s[62:63]
    v_cndmask_b32 v111, v111, v20, vcc
    s_branch L_recurrent_scan__compressed_kv_cla__moe_arch_mod__prompt_kernel_me_120
L_recurrent_scan__compressed_kv_cla__moe_arch_mod__prompt_kernel_mf_119:
    v_mov_b32 v96, v20
    v_mov_b32 v97, v20
    v_mov_b32 v98, v20
    v_mov_b32 v99, v20
    v_mov_b32 v100, v20
    v_mov_b32 v101, v20
    v_mov_b32 v102, v20
    v_mov_b32 v103, v20
    v_mov_b32 v104, v20
    v_mov_b32 v105, v20
    v_mov_b32 v106, v20
    v_mov_b32 v107, v20
    v_mov_b32 v108, v20
    v_mov_b32 v109, v20
    v_mov_b32 v110, v20
    v_mov_b32 v111, v20
L_recurrent_scan__compressed_kv_cla__moe_arch_mod__prompt_kernel_me_120:
L_recurrent_scan__compressed_kv_cla__moe_arch_mod__prompt_kernel_nm_121:
L_recurrent_scan__compressed_kv_cla__moe_arch_mod__prompt_kernel_r_113:
    s_branch L_recurrent_scan__compressed_kv_cla__moe_arch_mod__prompt_kernel_back_123
L_recurrent_scan__compressed_kv_cla__moe_arch_mod__prompt_kernel_rare_127:
    v_mov_b32 v20, 4048155338
    s_cmp_gt_i32 s36, 0
    s_cbranch_scc1 L_recurrent_scan__compressed_kv_cla__moe_arch_mod__prompt_kernel_mf_125
    v_cmp_gt_i32 s[20:21], 0, v18
    v_cmp_gt_i32 s[22:23], 1, v18
    v_cmp_gt_i32 s[62:63], 2, v18
    v_cmp_gt_i32 vcc, 3, v18
    v_mov_b32 v116, v20
    v_mov_b32 v117, v20
    v_mov_b32 v118, v20
    v_mov_b32 v119, v20
    v_cndmask_b32 v112, v112, v20, s[20:21]
    v_cndmask_b32 v113, v113, v20, s[22:23]
    v_cndmask_b32 v114, v114, v20, s[62:63]
    v_cndmask_b32 v115, v115, v20, vcc
    v_cndmask_b32 v124, v124, v20, s[20:21]
    v_cndmask_b32 v125, v125, v20, s[22:23]
    v_cndmask_b32 v126, v126, v20, s[62:63]
    v_cndmask_b32 v127, v127, v20, vcc
    s_branch L_recurrent_scan__compressed_kv_cla__moe_arch_mod__prompt_kernel_me_126
L_recurrent_scan__compressed_kv_cla__moe_arch_mod__prompt_kernel_mf_125:
    v_mov_b32 v112, v20
    v_mov_b32 v113, v20
    v_mov_b32 v114, v20
    v_mov_b32 v115, v20
    v_mov_b32 v116, v20
    v_mov_b32 v117, v20
    v_mov_b32 v118, v20
    v_mov_b32 v119, v20
    v_mov_b32 v120, v20
    v_mov_b32 v121, v20
    v_mov_b32 v122, v20
    v_mov_b32 v123, v20
    v_mov_b32 v124, v20
    v_mov_b32 v125, v20
    v_mov_b32 v126, v20
    v_mov_b32 v127, v20
L_recurrent_scan__compressed_kv_cla__moe_arch_mod__prompt_kernel_me_126:
    s_branch L_recurrent_scan__compressed_kv_cla__moe_arch_mod__prompt_kernel_back_128
L_recurrent_scan__compressed_kv_cla__moe_arch_mod__prompt_kernel_rare_135:
    s_add_u32 s36, s40, 1
    s_sub_u32 s36, s36, s51
    s_cmp_lt_u32 s36, 2
    s_cbranch_scc0 L_recurrent_scan__compressed_kv_cla__moe_arch_mod__prompt_kernel_r_129
    s_lshl_b32 s36, s36, 6
    s_add_u32 s36, s36, 32
    s_sub_u32 s36, s36, s50
    s_cmp_lt_i32 s36, 0
    s_cbranch_scc1 L_recurrent_scan__compressed_kv_cla__moe_arch_mod__prompt_kernel_nm_134
    v_mov_b32 v20, 4048155338
    s_cmp_gt_i32 s36, 0
    s_cbranch_scc1 L_recurrent_scan__compressed_kv_cla__moe_arch_mod__prompt_kernel_mf_132
    v_cmp_gt_i32 s[20:21], 0, v18
    v_cmp_gt_i32 s[22:23], 1, v18
    v_cmp_gt_i32 s[62:63], 2, v18
    v_cmp_gt_i32 vcc, 3, v18
    v_mov_b32 v116, v20
    v_mov_b32 v117, v20
    v_mov_b32 v118, v20
    v_mov_b32 v119, v20
    v_cndmask_b32 v112, v112, v20, s[20:21]
    v_cndmask_b32 v113, v113, v20, s[22:23]
    v_cndmask_b32 v114, v114, v20, s[62:63]
    v_cndmask_b32 v115, v115, v20, vcc
    v_cndmask_b32 v124, v124, v20, s[20:21]
    v_cndmask_b32 v125, v125, v20, s[22:23]
    v_cndmask_b32 v126, v126, v20, s[62:63]
    v_cndmask_b32 v127, v127, v20, vcc
    s_branch L_recurrent_scan__compressed_kv_cla__moe_arch_mod__prompt_kernel_me_133
L_recurrent_scan__compressed_kv_cla__moe_arch_mod__prompt_kernel_mf_132:
    v_mov_b32 v112, v20
    v_mov_b32 v113, v20
    v_mov_b32 v114, v20
    v_mov_b32 v115, v20
    v_mov_b32 v116, v20
    v_mov_b32 v117, v20
    v_mov_b32 v118, v20
    v_mov_b32 v119, v20
    v_mov_b32 v120, v20
    v_mov_b32 v121, v20
    v_mov_b32 v122, v20
    v_mov_b32 v123, v20
    v_mov_b32 v124, v20
    v_mov_b32 v125, v20
    v_mov_b32 v126, v20
    v_mov_b32 v127, v20
L_recurrent_scan__compressed_kv_cla__moe_arch_mod__prompt_kernel_me_133:
L_recurrent_scan__compressed_kv_cla__moe_arch_mod__prompt_kernel_nm_134:
L_recurrent_scan__compressed_kv_cla__moe_arch_mod__prompt_kernel_r_129:
    s_branch L_recurrent_scan__compressed_kv_cla__moe_arch_mod__prompt_kernel_back_136
L_recurrent_scan__compressed_kv_cla__moe_arch_mod__prompt_kernel_rare_140:
    s_add_u32 s36, s40, 2
    s_sub_u32 s36, s36, s51
    s_cmp_eq_u32 s36, 1
    s_cselect_b32 s41, 0x8000, s41
    s_cmp_eq_u32 s40, 15
    s_cbranch_scc0 L_recurrent_scan__compressed_kv_cla__moe_arch_mod__prompt_kernel_r_130
    s_mov_b32 s41, 65536
    s_mov_b32 s49, 0x1ffff
    s_mov_b32 s36, 1
L_recurrent_scan__compressed_kv_cla__moe_arch_mod__prompt_kernel_r_130:
    s_cmp_lt_u32 s36, 2
    s_cbranch_scc0 L_recurrent_scan__compressed_kv_cla__moe_arch_mod__prompt_kernel_r_131
    s_lshl_b32 s36, s36, 6
    s_sub_u32 s36, s36, s50
    s_cmp_lt_i32 s36, 0
    s_cbranch_scc1 L_recurrent_scan__compressed_kv_cla__moe_arch_mod__prompt_kernel_nm_139
    v_mov_b32 v20, 4048155338
    s_cmp_gt_i32 s36, 0
    s_cbranch_scc1 L_recurrent_scan__compressed_kv_cla__moe_arch_mod__prompt_kernel_mf_137
    v_cmp_gt_i32 s[20:21], 0, v18
    v_cmp_gt_i32 s[22:23], 1, v18
    v_cmp_gt_i32 s[62:63], 2, v18
    v_cmp_gt_i32 vcc, 3, v18
    v_mov_b32 v100, v20
    v_mov_b32 v101, v20
    v_mov_b32 v102, v20
    v_mov_b32 v103, v20
    v_cndmask_b32 v96, v96, v20, s[20:21]
    v_cndmask_b32 v97, v97, v20, s[22:23]
    v_cndmask_b32 v98, v98, v20, s[62:63]
    v_cndmask_b32 v99, v99, v20, vcc
    v_cndmask_b32 v108, v108, v20, s[20:21]
    v_cndmask_b32 v109, v109, v20, s[22:23]
    v_cndmask_b32 v110, v110, v20, s[62:63]
    v_cndmask_b32 v111, v111, v20, vcc
    s_branch L_recurrent_scan__compressed_kv_cla__moe_arch_mod__prompt_kernel_me_138
L_recurrent_scan__compressed_kv_cla__moe_arch_mod__prompt_kernel_mf_137:
    v_mov_b32 v96, v20
    v_mov_b32 v97, v20
    v_mov_b32 v98, v20
    v_mov_b32 v99, v20
    v_mov_b32 v100, v20
    v_mov_b32 v101, v20
    v_mov_b32 v102, v20
    v_mov_b32 v103, v20
    v_mov_b32 v104, v20
    v_mov_b32 v105, v20
    v_mov_b32 v106, v20
    v_mov_b32 v107, v20
    v_mov_b32 v108, v20
    v_mov_b32 v109, v20
    v_mov_b32 v110, v20
    v_mov_b32 v111, v20
L_recurrent_scan__compressed_kv_cla__moe_arch_mod__prompt_kernel_me_138:
L_recurrent_scan__compressed_kv_cla__moe_arch_mod__prompt_kernel_nm_139:
L_recurrent_scan__compressed_kv_cla__moe_arch_mod__prompt_kernel_r_131:
    s_branch L_recurrent_scan__compressed_kv_cla__moe_arch_mod__prompt_kernel_back_141
L_recurrent_scan__compressed_kv_cla__moe_arch_mod__prompt_kernel_rare_143:
    s_lshl_b32 s36, s29, 7
    s_cmp_eq_u32 s30, 0
    s_cselect_b32 s37, 4, 0
    s_add_u32 s36, s36, s37
    v_mov_b32 v20, s36
    v_mov_b32 v21, 1
    s_mov_b64 exec, 1
    global_atomic_add v20, v21, s[90:91]
    s_mov_b64 exec, -1
    s_nop 3
    s_branch L_recurrent_scan__compressed_kv_cla__moe_arch_mod__prompt_kernel_back_144
L_recurrent_scan__compressed_kv_cla__moe_arch_mod__prompt_kernel_rare_150:
    s_cmp_eq_u32 s40, 12
    s_cbranch_scc0 L_recurrent_scan__compressed_kv_cla__moe_arch_mod__prompt_kernel_bh_148
    s_getpc_b64 s[36:37]
L_recurrent_scan__compressed_kv_cla__moe_arch_mod__prompt_kernel_pc_149:
    s_sub_u32 s36, s36, L_recurrent_scan__compressed_kv_cla__moe_arch_mod__prompt_kernel_pc_149-L_pc
    s_subb_u32 s37, s37, 0
    s_lshr_b32 s38, s2, 3
    s_lshl_b32 s38, s38, 7
    v_lshl_add_u32 v26, v1, 12, s38
    v_min_u32 v26, L_end-L_pc-4, v26
    v_mov_b32 v27, s37
    v_add_co_u32 v26, vcc, s36, v26
    s_mov_b64 exec, 0xffff
    s_nop 0
    v_addc_co_u32 v27, vcc, 0, v27, vcc
    global_load_dword v0, v[26:27], off
    s_mov_b64 exec, -1
    s_nop 1
L_recurrent_scan__compressed_kv_cla__moe_arch_mod__prompt_kernel_bh_148:
    s_cmp_eq_u32 s40, 0
    s_cbranch_scc0 L_recurrent_scan__compressed_kv_cla__moe_arch_mod__prompt_kernel_nm_145
    ds_read_b64 v[14:15], v19
    s_waitcnt lgkmcnt(0)
L_recurrent_scan__compressed_kv_cla__moe_arch_mod__prompt_kernel_nm_145:
    s_branch L_recurrent_scan__compressed_kv_cla__moe_arch_mod__prompt_kernel_back_151
L_recurrent_scan__compressed_kv_cla__moe_arch_mod__prompt_kernel_rare_157:
    s_cmp_eq_u32 s40, 12
    s_cbranch_scc0 L_recurrent_scan__compressed_kv_cla__moe_arch_mod__prompt_kernel_bh_155
    s_getpc_b64 s[36:37]
L_recurrent_scan__compressed_kv_cla__moe_arch_mod__prompt_kernel_pc_156:
    s_sub_u32 s36, s36, L_recurrent_scan__compressed_kv_cla__moe_arch_mod__prompt_kernel_pc_156-L_pc
    s_subb_u32 s37, s37, 0
    s_lshr_b32 s38, s2, 3
    s_lshl_b32 s38, s38, 7
    v_lshl_add_u32 v26, v1, 12, s38
    v_min_u32 v26, L_end-L_pc-4, v26
    v_mov_b32 v27, s37
    v_add_co_u32 v26, vcc, s36, v26
    s_mov_b64 exec, 0xffff
    s_nop 0
    v_addc_co_u32 v27, vcc, 0, v27, vcc
    global_load_dword v0, v[26:27], off
    s_mov_b64 exec, -1
    s_nop 1
L_recurrent_scan__compressed_kv_cla__moe_arch_mod__prompt_kernel_bh_155:
    s_cmp_eq_u32 s40, s51
    s_cbranch_scc0 L_recurrent_scan__compressed_kv_cla__moe_arch_mod__prompt_kernel_ne_154
    s_nop 4
    s_mov_b32 s36, 0x5d800000
    v_cmp_nge_f32 vcc, s36, v28
    s_nop 0
    s_or_b64 s[52:53], s[52:53], vcc
    v_cmp_nge_f32 vcc, s36, v32
    s_nop 0
    s_or_b64 s[52:53], s[52:53], vcc
    v_rcp_f32 v20, v28
    v_rcp_f32 v22, v32
    s_lshl_b32 s38, s30, 3
    s_and_b32 s37, s28, 3
    s_lshl_b32 s37, s37, 1
    s_add_u32 s38, s38, s37
    s_lshl_b32 s38, s38, 17
    s_lshl_b32 s37, s29, 12
    s_add_u32 s38, s38, s37
    v_mov_b32 v21, v20
    v_mov_b32 v23, v22
    v_mov_b32 v24, v7
    v_pk_mul_f32 v[192:193], v[192:193], v[20:21]
    v_pk_mul_f32 v[194:195], v[194:195], v[20:21]
    v_pk_mul_f32 v[196:197], v[196:197], v[20:21]
    v_pk_mul_f32 v[198:199], v[198:199], v[20:21]
    v_cvt_pk_bf16_f32 v192, v192, v193
    v_cvt_pk_bf16_f32 v193, v194, v195
    v_cvt_pk_bf16_f32 v194, v196, v197
    v_cvt_pk_bf16_f32 v195, v198, v199
    buffer_store_dwordx4 v[192:195], v24, s[16:19], s38 offen offset:0 sc1
    v_pk_mul_f32 v[200:201], v[200:201], v[20:21]
    v_pk_mul_f32 v[202:203], v[202:203], v[20:21]
    v_pk_mul_f32 v[204:205], v[204:205], v[20:21]
    v_pk_mul_f32 v[206:207], v[206:207], v[20:21]
    v_cvt_pk_bf16_f32 v200, v200, v201
    v_cvt_pk_bf16_f32 v201, v202, v203
    v_cvt_pk_bf16_f32 v202, v204, v205
    v_cvt_pk_bf16_f32 v203, v206, v207
    buffer_store_dwordx4 v[200:203], v24, s[16:19], s38 offen offset:1024 sc1
    v_pk_mul_f32 v[208:209], v[208:209], v[20:21]
    v_pk_mul_f32 v[210:211], v[210:211], v[20:21]
    v_pk_mul_f32 v[212:213], v[212:213], v[20:21]
    v_pk_mul_f32 v[214:215], v[214:215], v[20:21]
    v_cvt_pk_bf16_f32 v208, v208, v209
    v_cvt_pk_bf16_f32 v209, v210, v211
    v_cvt_pk_bf16_f32 v210, v212, v213
    v_cvt_pk_bf16_f32 v211, v214, v215
    buffer_store_dwordx4 v[208:211], v24, s[16:19], s38 offen offset:2048 sc1
    v_pk_mul_f32 v[216:217], v[216:217], v[20:21]
    v_pk_mul_f32 v[218:219], v[218:219], v[20:21]
    v_pk_mul_f32 v[220:221], v[220:221], v[20:21]
    v_pk_mul_f32 v[222:223], v[222:223], v[20:21]
    v_cvt_pk_bf16_f32 v216, v216, v217
    v_cvt_pk_bf16_f32 v217, v218, v219
    v_cvt_pk_bf16_f32 v218, v220, v221
    v_cvt_pk_bf16_f32 v219, v222, v223
    buffer_store_dwordx4 v[216:219], v24, s[16:19], s38 offen offset:3072 sc1
    s_add_u32 s38, s38, 131072
    v_pk_mul_f32 v[224:225], v[224:225], v[22:23]
    v_pk_mul_f32 v[226:227], v[226:227], v[22:23]
    v_pk_mul_f32 v[228:229], v[228:229], v[22:23]
    v_pk_mul_f32 v[230:231], v[230:231], v[22:23]
    v_cvt_pk_bf16_f32 v224, v224, v225
    v_cvt_pk_bf16_f32 v225, v226, v227
    v_cvt_pk_bf16_f32 v226, v228, v229
    v_cvt_pk_bf16_f32 v227, v230, v231
    buffer_store_dwordx4 v[224:227], v24, s[16:19], s38 offen offset:0 sc1
    v_pk_mul_f32 v[232:233], v[232:233], v[22:23]
    v_pk_mul_f32 v[234:235], v[234:235], v[22:23]
    v_pk_mul_f32 v[236:237], v[236:237], v[22:23]
    v_pk_mul_f32 v[238:239], v[238:239], v[22:23]
    v_cvt_pk_bf16_f32 v232, v232, v233
    v_cvt_pk_bf16_f32 v233, v234, v235
    v_cvt_pk_bf16_f32 v234, v236, v237
    v_cvt_pk_bf16_f32 v235, v238, v239
    buffer_store_dwordx4 v[232:235], v24, s[16:19], s38 offen offset:1024 sc1
    v_pk_mul_f32 v[240:241], v[240:241], v[22:23]
    v_pk_mul_f32 v[242:243], v[242:243], v[22:23]
    v_pk_mul_f32 v[244:245], v[244:245], v[22:23]
    v_pk_mul_f32 v[246:247], v[246:247], v[22:23]
    v_cvt_pk_bf16_f32 v240, v240, v241
    v_cvt_pk_bf16_f32 v241, v242, v243
    v_cvt_pk_bf16_f32 v242, v244, v245
    v_cvt_pk_bf16_f32 v243, v246, v247
    buffer_store_dwordx4 v[240:243], v24, s[16:19], s38 offen offset:2048 sc1
    v_pk_mul_f32 v[248:249], v[248:249], v[22:23]
    v_pk_mul_f32 v[250:251], v[250:251], v[22:23]
    v_pk_mul_f32 v[252:253], v[252:253], v[22:23]
    v_pk_mul_f32 v[254:255], v[254:255], v[22:23]
    v_cvt_pk_bf16_f32 v248, v248, v249
    v_cvt_pk_bf16_f32 v249, v250, v251
    v_cvt_pk_bf16_f32 v250, v252, v253
    v_cvt_pk_bf16_f32 v251, v254, v255
    buffer_store_dwordx4 v[248:251], v24, s[16:19], s38 offen offset:3072 sc1
    v_mov_b64 v[28:29], 0
    v_mov_b64 v[30:31], 0
    v_mov_b64 v[32:33], 0
    v_mov_b64 v[34:35], 0
    v_mov_b64 v[192:193], 0
    v_mov_b64 v[194:195], 0
    v_mov_b64 v[196:197], 0
    v_mov_b64 v[198:199], 0
    v_mov_b64 v[200:201], 0
    v_mov_b64 v[202:203], 0
    v_mov_b64 v[204:205], 0
    v_mov_b64 v[206:207], 0
    v_mov_b64 v[208:209], 0
    v_mov_b64 v[210:211], 0
    v_mov_b64 v[212:213], 0
    v_mov_b64 v[214:215], 0
    v_mov_b64 v[216:217], 0
    v_mov_b64 v[218:219], 0
    v_mov_b64 v[220:221], 0
    v_mov_b64 v[222:223], 0
    v_mov_b64 v[224:225], 0
    v_mov_b64 v[226:227], 0
    v_mov_b64 v[228:229], 0
    v_mov_b64 v[230:231], 0
    v_mov_b64 v[232:233], 0
    v_mov_b64 v[234:235], 0
    v_mov_b64 v[236:237], 0
    v_mov_b64 v[238:239], 0
    v_mov_b64 v[240:241], 0
    v_mov_b64 v[242:243], 0
    v_mov_b64 v[244:245], 0
    v_mov_b64 v[246:247], 0
    v_mov_b64 v[248:249], 0
    v_mov_b64 v[250:251], 0
    v_mov_b64 v[252:253], 0
    v_mov_b64 v[254:255], 0
L_recurrent_scan__compressed_kv_cla__moe_arch_mod__prompt_kernel_ne_154:
    s_branch L_recurrent_scan__compressed_kv_cla__moe_arch_mod__prompt_kernel_back_158
L_recurrent_scan__compressed_kv_cla__moe_arch_mod__prompt_kernel_rare_161:
    s_mov_b32 s61, 0x40000
L_recurrent_scan__compressed_kv_cla__moe_arch_mod__prompt_kernel_spin_159:
    s_sub_u32 s61, s61, 1
    s_cbranch_scc1 L_recurrent_scan__compressed_kv_cla__moe_arch_mod__prompt_kernel_spinx_160
    s_sleep 8
    global_load_dword v11, v12, s[90:91] sc1
    s_waitcnt vmcnt(0)
    v_readfirstlane_b32 s36, v11
    s_nop 0
    s_cmp_lt_u32 s36, 28
    s_cbranch_scc1 L_recurrent_scan__compressed_kv_cla__moe_arch_mod__prompt_kernel_spin_159
L_recurrent_scan__compressed_kv_cla__moe_arch_mod__prompt_kernel_spinx_160:
    s_branch L_recurrent_scan__compressed_kv_cla__moe_arch_mod__prompt_kernel_back_162
L_recurrent_scan__compressed_kv_cla__moe_arch_mod__prompt_kernel_rare_168:
    v_mov_b32 v20, 4048155338
    s_cmp_gt_i32 s50, 0
    s_cbranch_scc1 L_recurrent_scan__compressed_kv_cla__moe_arch_mod__prompt_kernel_mf_166
    v_cmp_gt_i32 s[20:21], 0, v18
    v_cmp_gt_i32 s[22:23], 1, v18
    v_cmp_gt_i32 s[62:63], 2, v18
    v_cmp_gt_i32 vcc, 3, v18
    v_mov_b32 v100, v20
    v_mov_b32 v101, v20
    v_mov_b32 v102, v20
    v_mov_b32 v103, v20
    v_cndmask_b32 v96, v96, v20, s[20:21]
    v_cndmask_b32 v97, v97, v20, s[22:23]
    v_cndmask_b32 v98, v98, v20, s[62:63]
    v_cndmask_b32 v99, v99, v20, vcc
    v_cndmask_b32 v108, v108, v20, s[20:21]
    v_cndmask_b32 v109, v109, v20, s[22:23]
    v_cndmask_b32 v110, v110, v20, s[62:63]
    v_cndmask_b32 v111, v111, v20, vcc
    s_branch L_recurrent_scan__compressed_kv_cla__moe_arch_mod__prompt_kernel_me_167
L_recurrent_scan__compressed_kv_cla__moe_arch_mod__prompt_kernel_mf_166:
    v_mov_b32 v96, v20
    v_mov_b32 v97, v20
    v_mov_b32 v98, v20
    v_mov_b32 v99, v20
    v_mov_b32 v100, v20
    v_mov_b32 v101, v20
    v_mov_b32 v102, v20
    v_mov_b32 v103, v20
    v_mov_b32 v104, v20
    v_mov_b32 v105, v20
    v_mov_b32 v106, v20
    v_mov_b32 v107, v20
    v_mov_b32 v108, v20
    v_mov_b32 v109, v20
    v_mov_b32 v110, v20
    v_mov_b32 v111, v20
L_recurrent_scan__compressed_kv_cla__moe_arch_mod__prompt_kernel_me_167:
    s_branch L_recurrent_scan__compressed_kv_cla__moe_arch_mod__prompt_kernel_back_169
L_p3_done:
    s_and_b32 s36, s29, 28
    s_sub_u32 s40, 47, s30
    s_lshl_b32 s40, s40, 7
    s_add_u32 s40, s40, s36
    s_add_u32 s41, s30, 32
    s_lshl_b32 s41, s41, 7
    s_add_u32 s41, s41, s36
    s_lshr_b32 s63, s29, 4
    s_lshl_b32 s36, s30, 2
    s_lshr_b32 s30, 0x76534210, s36
    s_and_b32 s30, s30, 7
    s_and_b32 s36, s30, 4
    s_add_u32 s43, s30, s36
    s_lshl_b32 s36, s63, 2
    s_add_u32 s30, s43, s36
    s_and_b32 s29, s29, 15
    s_and_b32 s36, s28, 3
    s_lshl_b32 s37, s29, 2
    s_add_u32 s36, s36, s37
    s_lshl_b32 s36, s36, 18
    s_lshr_b32 s37, s28, 2
    s_lshl_b32 s37, s37, 12
    s_add_u32 s36, s36, s37
    s_lshl_b32 s37, s63, 16
    s_add_u32 s36, s36, s37
    s_lshr_b32 s37, s28, 2
    s_lshl_b32 s37, s37, 17
    s_add_u32 s36, s36, s37
    v_lshl_add_u32 v2, v1, 4, s36
    v_xor_b32 v3, 131072, v2
    v_lshrrev_b32 v19, 4, v1
    s_lshr_b32 s36, s28, 2
    s_lshl_b32 s36, s36, 7
    s_and_b32 s37, s28, 3
    s_lshl_b32 s37, s37, 4
    s_add_u32 s36, s36, s37
    s_lshl_b32 s33, s36, 8
    s_lshl_b32 s37, s63, 11
    s_add_u32 s36, s36, s37
    v_add_u32 v18, s36, v19
    v_lshlrev_b32 v18, 11, v18
    s_lshl_b32 s36, s43, 7
    v_add_u32 v18, s36, v18
    v_lshlrev_b32 v20, 1, v19
    v_and_b32 v21, 7, v1
    v_xor_b32 v20, v20, v21
    v_lshl_add_u32 v18, v20, 4, v18
    v_and_b32 v21, 8, v1
    v_lshl_add_u32 v6, v21, 6, v18
    v_xor_b32 v21, 8, v21
    v_lshl_add_u32 v7, v21, 6, v18
    v_add_u32 v7, 7168, v7
    v_add_u32 v8, 14336, v6
    v_add_u32 v9, 14336, v7
    s_add_u32 s36, s2, 1
    s_mov_b32 s62, 0
    s_mov_b32 s31, 0
    s_mov_b32 s32, 0
    s_add_u32 s4, s54, 41943040
    s_addc_u32 s5, s55, 0
    s_and_b32 s5, s5, 0xffff
    s_mov_b32 s6, 117440640
    s_mov_b32 s7, 0x20000
    s_mov_b32 s16, s96
    s_and_b32 s17, s97, 0xffff
    s_mov_b32 s18, 4194304
    s_mov_b32 s19, 0x20000
    s_mov_b32 s20, s98
    s_and_b32 s21, s99, 0xffff
    s_mov_b32 s22, 4194304
    s_mov_b32 s23, 0x20000
    s_lshl_b32 s36, s29, 7
    s_and_b32 s37, s28, 3
    s_lshl_b32 s37, s37, 5
    s_add_u32 s36, s36, s37
    s_lshr_b32 s37, s28, 2
    s_lshl_b32 s37, s37, 4
    s_add_u32 s38, s36, s37
    v_and_b32 v63, 15, v1
    v_add_u32 v14, s38, v63
    v_lshlrev_b32 v16, 3, v14
    v_lshrrev_b32 v15, 3, v1
    v_add_u32 v15, s38, v15
    v_lshlrev_b32 v15, 11, v15
    v_and_b32 v4, 7, v1
    v_lshl_add_u32 v15, v4, 4, v15
    s_lshl_b32 s36, s30, 7
    v_add_u32 v15, s36, v15
    s_lshl_b32 s36, s28, 12
    s_add_u32 s42, s36, 131072
    v_lshl_add_u32 v63, v63, 7, s42
    v_lshl_add_u32 v63, v19, 3, v63
    v_bfe_u32 v20, v1, 2, 2
    v_lshl_add_u32 v18, v19, 2, v20
    v_and_b32 v20, 7, v18
    s_lshl_b32 s36, s63, 2
    s_xor_b32 s36, s36, 4
    v_xor_b32 v20, s36, v20
    v_lshlrev_b32 v18, 8, v18
    s_lshr_b32 s36, s28, 2
    s_lshl_b32 s36, s36, 15
    s_add_u32 s36, s36, 65536
    v_add_u32 v18, s36, v18
    v_and_b32 v21, 3, v1
    v_lshl_add_u32 v18, v21, 3, v18
    v_xor_b32 v21, 0, v20
    v_lshl_add_u32 v50, v21, 5, v18
    v_xor_b32 v21, 1, v20
    v_lshl_add_u32 v51, v21, 5, v18
    v_xor_b32 v21, 2, v20
    v_lshl_add_u32 v52, v21, 5, v18
    v_xor_b32 v21, 3, v20
    v_lshl_add_u32 v53, v21, 5, v18
    v_xor_b32 v21, 4, v20
    v_lshl_add_u32 v54, v21, 5, v18
    v_xor_b32 v21, 5, v20
    v_lshl_add_u32 v55, v21, 5, v18
    v_xor_b32 v21, 6, v20
    v_lshl_add_u32 v56, v21, 5, v18
    v_xor_b32 v21, 7, v20
    v_lshl_add_u32 v57, v21, 5, v18
    s_waitcnt vmcnt(0)
    s_barrier
    s_cmp_eq_u32 s28, 0
    s_cbranch_scc1 L_recurrent_scan__compressed_kv_cla__moe_arch_mod__prompt_kernel_rare_170
L_recurrent_scan__compressed_kv_cla__moe_arch_mod__prompt_kernel_back_171:
    s_bitcmp1_b32 0x70, s28
    s_cbranch_scc1 L_recurrent_scan__compressed_kv_cla__moe_arch_mod__prompt_kernel_f2m_198
L_recurrent_scan__compressed_kv_cla__moe_arch_mod__prompt_kernel_f2a_199:
    s_add_u32 m0, s33, 65536
    s_mov_b32 s32, 0
    buffer_load_dwordx4 v6, s[8:11], s32 offen offset:0 lds
    buffer_load_dwordx4 v7, s[8:11], s32 offen offset:1024 lds
    buffer_load_dwordx4 v8, s[8:11], s32 offen offset:2048 lds
    buffer_load_dwordx4 v9, s[8:11], s32 offen offset:3072 lds
    s_add_u32 m0, s33, 81920
    s_mov_b32 s32, 131072
    buffer_load_dwordx4 v6, s[8:11], s32 offen offset:0 lds
    buffer_load_dwordx4 v7, s[8:11], s32 offen offset:1024 lds
    buffer_load_dwordx4 v8, s[8:11], s32 offen offset:2048 lds
    buffer_load_dwordx4 v9, s[8:11], s32 offen offset:3072 lds
    s_add_u32 m0, s33, 0
    s_mov_b32 s32, 524288
    buffer_load_dwordx4 v6, s[8:11], s32 offen offset:0 lds
    buffer_load_dwordx4 v7, s[8:11], s32 offen offset:1024 lds
    buffer_load_dwordx4 v8, s[8:11], s32 offen offset:2048 lds
    buffer_load_dwordx4 v9, s[8:11], s32 offen offset:3072 lds
    s_add_u32 m0, s33, 16384
    s_mov_b32 s32, 655360
    buffer_load_dwordx4 v6, s[8:11], s32 offen offset:0 lds
    buffer_load_dwordx4 v7, s[8:11], s32 offen offset:1024 lds
    buffer_load_dwordx4 v8, s[8:11], s32 offen offset:2048 lds
    buffer_load_dwordx4 v9, s[8:11], s32 offen offset:3072 lds
    s_cmp_lt_u32 s28, 4
    s_cbranch_scc1 L_recurrent_scan__compressed_kv_cla__moe_arch_mod__prompt_kernel_f2m_198
L_recurrent_scan__compressed_kv_cla__moe_arch_mod__prompt_kernel_f2b_200:
    s_mov_b32 s60, 31
    s_cmp_eq_u32 s28, 3
    s_cbranch_scc0 L_recurrent_scan__compressed_kv_cla__moe_arch_mod__prompt_kernel_w7j_201
    v_min_u32 v58, 3, v1
    s_lshl_b32 s36, s63, 2
    v_add_u32 v58, s36, v58
    s_add_u32 s36, s29, 32
    s_lshl_b32 s36, s36, 7
    v_lshl_add_u32 v58, v58, 2, s36
    s_mov_b32 s44, 3
    s_mov_b32 s61, 0x40000
L_recurrent_scan__compressed_kv_cla__moe_arch_mod__prompt_kernel_cspin_202:
    s_sub_u32 s61, s61, 1
    s_cbranch_scc1 L_recurrent_scan__compressed_kv_cla__moe_arch_mod__prompt_kernel_cspinx_203
    global_load_dword v59, v58, s[90:91] sc1
    s_waitcnt vmcnt(0)
L_recurrent_scan__compressed_kv_cla__moe_arch_mod__prompt_kernel_cchk_204:
    v_cmp_le_u32 vcc, 4, v59
    s_nop 0
    s_and_b32 s60, vcc_lo, 31
    s_and_b32 s36, s60, s44
    s_cmp_eq_u32 s36, s44
    s_cbranch_scc1 L_recurrent_scan__compressed_kv_cla__moe_arch_mod__prompt_kernel_cspinx_203
    s_sleep 6
    s_branch L_recurrent_scan__compressed_kv_cla__moe_arch_mod__prompt_kernel_cspin_202
L_recurrent_scan__compressed_kv_cla__moe_arch_mod__prompt_kernel_cspinx_203:
    s_lshl_b32 s44, s44, 1
    s_or_b32 s44, s44, 1
    s_and_b32 s44, s44, 31
L_recurrent_scan__compressed_kv_cla__moe_arch_mod__prompt_kernel_w7j_201:
    s_waitcnt vmcnt(12)
    s_waitcnt lgkmcnt(0)
    s_barrier
    s_mov_b32 s31, 0
    buffer_load_dwordx4 v[128:131], v2, s[4:7], s31 offen offset:0 sc1
    buffer_load_dwordx4 v[132:135], v3, s[4:7], s31 offen offset:0 sc1
    buffer_load_dwordx4 v[136:139], v2, s[4:7], s31 offen offset:1024 sc1
    buffer_load_dwordx4 v[140:143], v3, s[4:7], s31 offen offset:1024 sc1
    buffer_load_dwordx4 v[144:147], v2, s[4:7], s31 offen offset:2048 sc1
    buffer_load_dwordx4 v[148:151], v3, s[4:7], s31 offen offset:2048 sc1
    buffer_load_dwordx4 v[152:155], v2, s[4:7], s31 offen offset:3072 sc1
    buffer_load_dwordx4 v[156:159], v3, s[4:7], s31 offen offset:3072 sc1
    s_mov_b32 s31, 8192
    s_cmp_lt_u32 s28, 4
    s_cbranch_scc0 L_recurrent_scan__compressed_kv_cla__moe_arch_mod__prompt_kernel_g_172
    s_lshl_b32 s36, s28, 10
    s_add_u32 s36, s36, 131072
    v_lshl_add_u32 v28, v1, 4, s36
    ds_read_b128 v[96:99], v28 offset:0
    ds_read_b128 v[100:103], v28 offset:4096
    ds_read_b128 v[104:107], v28 offset:8192
    ds_read_b128 v[108:111], v28 offset:12288
    ds_read_b128 v[112:115], v28 offset:16384
    ds_read_b128 v[116:119], v28 offset:20480
    ds_read_b128 v[120:123], v28 offset:24576
    s_lshr_b32 s36, s2, 4
    s_lshl_b32 s36, s36, 13
    s_and_b32 s37, s2, 15
    s_lshl_b32 s37, s37, 8
    s_add_u32 s36, s36, s37
    s_lshl_b32 s37, s28, 6
    s_add_u32 s36, s36, s37
    s_add_u32 s36, s36, 59768832
    v_and_b32 v28, 1, v1
    v_lshlrev_b32 v28, 12, v28
    v_lshl_add_u32 v28, v19, 4, v28
    s_waitcnt lgkmcnt(0)
    v_add_f32 v96, v96, v100
    v_add_f32 v97, v97, v101
    v_add_f32 v98, v98, v102
    v_add_f32 v99, v99, v103
    v_add_f32 v96, v96, v104
    v_add_f32 v97, v97, v105
    v_add_f32 v98, v98, v106
    v_add_f32 v99, v99, v107
    v_add_f32 v96, v96, v108
    v_add_f32 v97, v97, v109
    v_add_f32 v98, v98, v110
    v_add_f32 v99, v99, v111
    v_add_f32 v96, v96, v112
    v_add_f32 v97, v97, v113
    v_add_f32 v98, v98, v114
    v_add_f32 v99, v99, v115
    v_add_f32 v96, v96, v116
    v_add_f32 v97, v97, v117
    v_add_f32 v98, v98, v118
    v_add_f32 v99, v99, v119
    v_add_f32 v96, v96, v120
    v_add_f32 v97, v97, v121
    v_add_f32 v98, v98, v122
    v_add_f32 v99, v99, v123
    s_mov_b32 exec_lo, 0x00030003
    s_mov_b32 exec_hi, 0x00030003
    buffer_store_dwordx4 v[96:99], v28, s[24:27], s36 offen sc1
    s_mov_b64 exec, -1
    s_nop 3
L_recurrent_scan__compressed_kv_cla__moe_arch_mod__prompt_kernel_g_172:
    v_lshlrev_b32 v22, 4, v1
    v_mov_b32 v18, v22
    v_add_u32 v20, s42, v22
    v_xor_b32 v21, 16384, v20
    s_lshl_b32 s36, s2, 15
    s_lshl_b32 s37, s28, 12
    s_add_u32 s36, s36, s37
    s_add_u32 s36, s36, 67108864
    s_mov_b32 s41, s36
    s_xor_b32 s39, s36, 131072
    s_add_u32 s40, s2, 128
    s_lshl_b32 s40, s40, 7
    ds_read_b64_tr_b16 v[64:65], v50 offset:0
    ds_read_b64_tr_b16 v[66:67], v50 offset:4096
    ds_read_b64_tr_b16 v[68:69], v51 offset:0
    ds_read_b64_tr_b16 v[70:71], v51 offset:4096
    ds_read_b64_tr_b16 v[72:73], v52 offset:0
    ds_read_b64_tr_b16 v[74:75], v52 offset:4096
    ds_read_b64_tr_b16 v[76:77], v53 offset:0
    ds_read_b64_tr_b16 v[78:79], v53 offset:4096
    ds_read_b64_tr_b16 v[80:81], v54 offset:0
    ds_read_b64_tr_b16 v[82:83], v54 offset:4096
    ds_read_b64_tr_b16 v[84:85], v55 offset:0
    ds_read_b64_tr_b16 v[86:87], v55 offset:4096
    s_waitcnt vmcnt(6)
    buffer_load_dwordx4 v[160:163], v2, s[4:7], s31 offen offset:0 sc1
    buffer_load_dwordx4 v[164:167], v3, s[4:7], s31 offen offset:0 sc1
    buffer_load_dwordx4 v[168:171], v2, s[4:7], s31 offen offset:1024 sc1
    buffer_load_dwordx4 v[172:175], v3, s[4:7], s31 offen offset:1024 sc1
    s_waitcnt lgkmcnt(8)
    v_mfma_f32_16x16x32_bf16 v[192:195], v[64:67], v[128:131], 0
    ds_read_b64_tr_b16 v[88:89], v56 offset:0
    buffer_load_dwordx4 v[176:179], v2, s[4:7], s31 offen offset:2048 sc1
    v_mfma_f32_16x16x32_bf16 v[224:227], v[64:67], v[132:135], 0
    ds_read_b64_tr_b16 v[90:91], v56 offset:4096
    v_mfma_f32_16x16x32_bf16 v[196:199], v[68:71], v[128:131], 0
    ds_read_b64_tr_b16 v[92:93], v57 offset:0
    v_mfma_f32_16x16x32_bf16 v[228:231], v[68:71], v[132:135], 0
    ds_read_b64_tr_b16 v[94:95], v57 offset:4096
    s_waitcnt lgkmcnt(8)
    v_mfma_f32_16x16x32_bf16 v[200:203], v[72:75], v[128:131], 0
    ds_read_b64_tr_b16 v[64:65], v50 offset:8192
    buffer_load_dwordx4 v[180:183], v3, s[4:7], s31 offen offset:2048 sc1
    v_mfma_f32_16x16x32_bf16 v[232:235], v[72:75], v[132:135], 0
    ds_read_b64_tr_b16 v[66:67], v50 offset:12288
    v_mfma_f32_16x16x32_bf16 v[204:207], v[76:79], v[128:131], 0
    ds_read_b64_tr_b16 v[68:69], v51 offset:8192
    v_mfma_f32_16x16x32_bf16 v[236:239], v[76:79], v[132:135], 0
    ds_read_b64_tr_b16 v[70:71], v51 offset:12288
    s_waitcnt lgkmcnt(8)
    v_mfma_f32_16x16x32_bf16 v[208:211], v[80:83], v[128:131], 0
    ds_read_b64_tr_b16 v[72:73], v52 offset:8192
    buffer_load_dwordx4 v[184:187], v2, s[4:7], s31 offen offset:3072 sc1
    v_mfma_f32_16x16x32_bf16 v[240:243], v[80:83], v[132:135], 0
    ds_read_b64_tr_b16 v[74:75], v52 offset:12288
    v_mfma_f32_16x16x32_bf16 v[212:215], v[84:87], v[128:131], 0
    ds_read_b64_tr_b16 v[76:77], v53 offset:8192
    v_mfma_f32_16x16x32_bf16 v[244:247], v[84:87], v[132:135], 0
    ds_read_b64_tr_b16 v[78:79], v53 offset:12288
    s_waitcnt lgkmcnt(8)
    v_mfma_f32_16x16x32_bf16 v[216:219], v[88:91], v[128:131], 0
    ds_read_b64_tr_b16 v[80:81], v54 offset:8192
    buffer_load_dwordx4 v[188:191], v3, s[4:7], s31 offen offset:3072 sc1
    v_mfma_f32_16x16x32_bf16 v[248:251], v[88:91], v[132:135], 0
    ds_read_b64_tr_b16 v[82:83], v54 offset:12288
    v_mfma_f32_16x16x32_bf16 v[220:223], v[92:95], v[128:131], 0
    ds_read_b64_tr_b16 v[84:85], v55 offset:8192
    v_mfma_f32_16x16x32_bf16 v[252:255], v[92:95], v[132:135], 0
    ds_read_b64_tr_b16 v[86:87], v55 offset:12288
    s_waitcnt lgkmcnt(8)
    s_waitcnt vmcnt(12)
    v_mfma_f32_16x16x32_bf16 v[192:195], v[64:67], v[136:139], v[192:195]
    ds_read_b64_tr_b16 v[88:89], v56 offset:8192
    v_mfma_f32_16x16x32_bf16 v[224:227], v[64:67], v[140:143], v[224:227]
    ds_read_b64_tr_b16 v[90:91], v56 offset:12288
    s_mov_b32 s31, 16384
    buffer_load_dwordx4 v[128:131], v2, s[4:7], s31 offen offset:0 sc1
    v_mfma_f32_16x16x32_bf16 v[196:199], v[68:71], v[136:139], v[196:199]
    ds_read_b64_tr_b16 v[92:93], v57 offset:8192
    v_mfma_f32_16x16x32_bf16 v[228:231], v[68:71], v[140:143], v[228:231]
    ds_read_b64_tr_b16 v[94:95], v57 offset:12288
    s_waitcnt lgkmcnt(8)
    v_mfma_f32_16x16x32_bf16 v[200:203], v[72:75], v[136:139], v[200:203]
    v_mfma_f32_16x16x32_bf16 v[232:235], v[72:75], v[140:143], v[232:235]
    buffer_load_dwordx4 v[132:135], v3, s[4:7], s31 offen offset:0 sc1
    v_mfma_f32_16x16x32_bf16 v[204:207], v[76:79], v[136:139], v[204:207]
    v_mfma_f32_16x16x32_bf16 v[236:239], v[76:79], v[140:143], v[236:239]
    s_waitcnt lgkmcnt(0)
    s_barrier
    v_mfma_f32_16x16x32_bf16 v[208:211], v[80:83], v[136:139], v[208:211]
    ds_read_b64_tr_b16 v[64:65], v50 offset:16384
    ds_read_b64_tr_b16 v[66:67], v50 offset:20480
    v_mfma_f32_16x16x32_bf16 v[240:243], v[80:83], v[140:143], v[240:243]
    ds_read_b64_tr_b16 v[68:69], v51 offset:16384
    ds_read_b64_tr_b16 v[70:71], v51 offset:20480
    s_add_u32 m0, s33, 65536
    s_mov_b32 s32, 1048576
    buffer_load_dwordx4 v6, s[8:11], s32 offen offset:0 lds
    v_mfma_f32_16x16x32_bf16 v[212:215], v[84:87], v[136:139], v[212:215]
    ds_read_b64_tr_b16 v[72:73], v52 offset:16384
    ds_read_b64_tr_b16 v[74:75], v52 offset:20480
    v_mfma_f32_16x16x32_bf16 v[244:247], v[84:87], v[140:143], v[244:247]
    ds_read_b64_tr_b16 v[76:77], v53 offset:16384
    ds_read_b64_tr_b16 v[78:79], v53 offset:20480
    v_mfma_f32_16x16x32_bf16 v[216:219], v[88:91], v[136:139], v[216:219]
    ds_read_b64_tr_b16 v[80:81], v54 offset:16384
    ds_read_b64_tr_b16 v[82:83], v54 offset:20480
    v_mfma_f32_16x16x32_bf16 v[248:251], v[88:91], v[140:143], v[248:251]
    buffer_load_dwordx4 v7, s[8:11], s32 offen offset:1024 lds
    v_mfma_f32_16x16x32_bf16 v[220:223], v[92:95], v[136:139], v[220:223]
    ds_read_b64_tr_b16 v[84:85], v55 offset:16384
    ds_read_b64_tr_b16 v[86:87], v55 offset:20480
    v_mfma_f32_16x16x32_bf16 v[252:255], v[92:95], v[140:143], v[252:255]
    s_waitcnt lgkmcnt(8)
    s_waitcnt vmcnt(14)
    v_mfma_f32_16x16x32_bf16 v[192:195], v[64:67], v[144:147], v[192:195]
    ds_read_b64_tr_b16 v[88:89], v56 offset:16384
    v_mfma_f32_16x16x32_bf16 v[224:227], v[64:67], v[148:151], v[224:227]
    ds_read_b64_tr_b16 v[90:91], v56 offset:20480
    v_mfma_f32_16x16x32_bf16 v[196:199], v[68:71], v[144:147], v[196:199]
    ds_read_b64_tr_b16 v[92:93], v57 offset:16384
    buffer_load_dwordx4 v8, s[8:11], s32 offen offset:2048 lds
    v_mfma_f32_16x16x32_bf16 v[228:231], v[68:71], v[148:151], v[228:231]
    ds_read_b64_tr_b16 v[94:95], v57 offset:20480
    s_waitcnt lgkmcnt(8)
    v_mfma_f32_16x16x32_bf16 v[200:203], v[72:75], v[144:147], v[200:203]
    ds_read_b64_tr_b16 v[64:65], v50 offset:24576
    v_mfma_f32_16x16x32_bf16 v[232:235], v[72:75], v[148:151], v[232:235]
    ds_read_b64_tr_b16 v[66:67], v50 offset:28672
    v_xor_b32 v50, 65536, v50
    v_mfma_f32_16x16x32_bf16 v[204:207], v[76:79], v[144:147], v[204:207]
    ds_read_b64_tr_b16 v[68:69], v51 offset:24576
    buffer_load_dwordx4 v9, s[8:11], s32 offen offset:3072 lds
    v_mfma_f32_16x16x32_bf16 v[236:239], v[76:79], v[148:151], v[236:239]
    ds_read_b64_tr_b16 v[70:71], v51 offset:28672
    v_xor_b32 v51, 65536, v51
    s_waitcnt lgkmcnt(8)
    v_mfma_f32_16x16x32_bf16 v[208:211], v[80:83], v[144:147], v[208:211]
    ds_read_b64_tr_b16 v[72:73], v52 offset:24576
    v_mfma_f32_16x16x32_bf16 v[240:243], v[80:83], v[148:151], v[240:243]
    ds_read_b64_tr_b16 v[74:75], v52 offset:28672
    v_xor_b32 v52, 65536, v52
    v_mfma_f32_16x16x32_bf16 v[212:215], v[84:87], v[144:147], v[212:215]
    ds_read_b64_tr_b16 v[76:77], v53 offset:24576
    buffer_load_dwordx4 v[136:139], v2, s[4:7], s31 offen offset:1024 sc1
    v_mfma_f32_16x16x32_bf16 v[244:247], v[84:87], v[148:151], v[244:247]
    ds_read_b64_tr_b16 v[78:79], v53 offset:28672
    v_xor_b32 v53, 65536, v53
    s_waitcnt lgkmcnt(8)
    v_mfma_f32_16x16x32_bf16 v[216:219], v[88:91], v[144:147], v[216:219]
    ds_read_b64_tr_b16 v[80:81], v54 offset:24576
    v_mfma_f32_16x16x32_bf16 v[248:251], v[88:91], v[148:151], v[248:251]
    ds_read_b64_tr_b16 v[82:83], v54 offset:28672
    v_xor_b32 v54, 65536, v54
    v_mfma_f32_16x16x32_bf16 v[220:223], v[92:95], v[144:147], v[220:223]
    ds_read_b64_tr_b16 v[84:85], v55 offset:24576
    buffer_load_dwordx4 v[140:143], v3, s[4:7], s31 offen offset:1024 sc1
    v_mfma_f32_16x16x32_bf16 v[252:255], v[92:95], v[148:151], v[252:255]
    ds_read_b64_tr_b16 v[86:87], v55 offset:28672
    v_xor_b32 v55, 65536, v55
    s_waitcnt lgkmcnt(8)
    s_waitcnt vmcnt(16)
    v_mfma_f32_16x16x32_bf16 v[192:195], v[64:67], v[152:155], v[192:195]
    ds_read_b64_tr_b16 v[88:89], v56 offset:24576
    v_mfma_f32_16x16x32_bf16 v[224:227], v[64:67], v[156:159], v[224:227]
    ds_read_b64_tr_b16 v[90:91], v56 offset:28672
    v_xor_b32 v56, 65536, v56
    v_mfma_f32_16x16x32_bf16 v[196:199], v[68:71], v[152:155], v[196:199]
    ds_read_b64_tr_b16 v[92:93], v57 offset:24576
    v_mfma_f32_16x16x32_bf16 v[228:231], v[68:71], v[156:159], v[228:231]
    ds_read_b64_tr_b16 v[94:95], v57 offset:28672
    v_xor_b32 v57, 65536, v57
    buffer_load_dwordx4 v[144:147], v2, s[4:7], s31 offen offset:2048 sc1
    s_waitcnt lgkmcnt(8)
    v_mfma_f32_16x16x32_bf16 v[200:203], v[72:75], v[152:155], v[200:203]
    v_mfma_f32_16x16x32_bf16 v[232:235], v[72:75], v[156:159], v[232:235]
    v_mfma_f32_16x16x32_bf16 v[204:207], v[76:79], v[152:155], v[204:207]
    v_mfma_f32_16x16x32_bf16 v[236:239], v[76:79], v[156:159], v[236:239]
    buffer_load_dwordx4 v[148:151], v3, s[4:7], s31 offen offset:2048 sc1
    s_waitcnt lgkmcnt(0)
    s_barrier
    v_mfma_f32_16x16x32_bf16 v[208:211], v[80:83], v[152:155], v[208:211]
    ds_read_b64_tr_b16 v[64:65], v50 offset:0
    ds_read_b64_tr_b16 v[66:67], v50 offset:4096
    v_mfma_f32_16x16x32_bf16 v[240:243], v[80:83], v[156:159], v[240:243]
    ds_read_b64_tr_b16 v[68:69], v51 offset:0
    ds_read_b64_tr_b16 v[70:71], v51 offset:4096
    v_mfma_f32_16x16x32_bf16 v[212:215], v[84:87], v[152:155], v[212:215]
    ds_read_b64_tr_b16 v[72:73], v52 offset:0
    ds_read_b64_tr_b16 v[74:75], v52 offset:4096
    v_mfma_f32_16x16x32_bf16 v[244:247], v[84:87], v[156:159], v[244:247]
    ds_read_b64_tr_b16 v[76:77], v53 offset:0
    ds_read_b64_tr_b16 v[78:79], v53 offset:4096
    s_add_u32 m0, s33, 81920
    s_mov_b32 s32, 1179648
    buffer_load_dwordx4 v6, s[8:11], s32 offen offset:0 lds
    v_mfma_f32_16x16x32_bf16 v[216:219], v[88:91], v[152:155], v[216:219]
    ds_read_b64_tr_b16 v[80:81], v54 offset:0
    ds_read_b64_tr_b16 v[82:83], v54 offset:4096
    v_mfma_f32_16x16x32_bf16 v[248:251], v[88:91], v[156:159], v[248:251]
    v_mfma_f32_16x16x32_bf16 v[220:223], v[92:95], v[152:155], v[220:223]
    ds_read_b64_tr_b16 v[84:85], v55 offset:0
    ds_read_b64_tr_b16 v[86:87], v55 offset:4096
    v_mfma_f32_16x16x32_bf16 v[252:255], v[92:95], v[156:159], v[252:255]
    buffer_load_dwordx4 v7, s[8:11], s32 offen offset:1024 lds
    s_waitcnt lgkmcnt(8)
    s_waitcnt vmcnt(18)
    v_mfma_f32_16x16x32_bf16 v[192:195], v[64:67], v[160:163], v[192:195]
    ds_read_b64_tr_b16 v[88:89], v56 offset:0
    v_mfma_f32_16x16x32_bf16 v[224:227], v[64:67], v[164:167], v[224:227]
    ds_read_b64_tr_b16 v[90:91], v56 offset:4096
    v_mfma_f32_16x16x32_bf16 v[196:199], v[68:71], v[160:163], v[196:199]
    ds_read_b64_tr_b16 v[92:93], v57 offset:0
    v_mfma_f32_16x16x32_bf16 v[228:231], v[68:71], v[164:167], v[228:231]
    ds_read_b64_tr_b16 v[94:95], v57 offset:4096
    s_waitcnt lgkmcnt(8)
    v_mfma_f32_16x16x32_bf16 v[200:203], v[72:75], v[160:163], v[200:203]
    ds_read_b64_tr_b16 v[64:65], v50 offset:8192
    buffer_load_dwordx4 v8, s[8:11], s32 offen offset:2048 lds
    v_mfma_f32_16x16x32_bf16 v[232:235], v[72:75], v[164:167], v[232:235]
    ds_read_b64_tr_b16 v[66:67], v50 offset:12288
    v_mfma_f32_16x16x32_bf16 v[204:207], v[76:79], v[160:163], v[204:207]
    ds_read_b64_tr_b16 v[68:69], v51 offset:8192
    v_mfma_f32_16x16x32_bf16 v[236:239], v[76:79], v[164:167], v[236:239]
    ds_read_b64_tr_b16 v[70:71], v51 offset:12288
    s_waitcnt lgkmcnt(8)
    v_mfma_f32_16x16x32_bf16 v[208:211], v[80:83], v[160:163], v[208:211]
    ds_read_b64_tr_b16 v[72:73], v52 offset:8192
    buffer_load_dwordx4 v9, s[8:11], s32 offen offset:3072 lds
    v_mfma_f32_16x16x32_bf16 v[240:243], v[80:83], v[164:167], v[240:243]
    ds_read_b64_tr_b16 v[74:75], v52 offset:12288
    v_mfma_f32_16x16x32_bf16 v[212:215], v[84:87], v[160:163], v[212:215]
    ds_read_b64_tr_b16 v[76:77], v53 offset:8192
    v_mfma_f32_16x16x32_bf16 v[244:247], v[84:87], v[164:167], v[244:247]
    ds_read_b64_tr_b16 v[78:79], v53 offset:12288
    s_waitcnt lgkmcnt(8)
    v_mfma_f32_16x16x32_bf16 v[216:219], v[88:91], v[160:163], v[216:219]
    ds_read_b64_tr_b16 v[80:81], v54 offset:8192
    buffer_load_dwordx4 v[152:155], v2, s[4:7], s31 offen offset:3072 sc1
    v_mfma_f32_16x16x32_bf16 v[248:251], v[88:91], v[164:167], v[248:251]
    ds_read_b64_tr_b16 v[82:83], v54 offset:12288
    v_mfma_f32_16x16x32_bf16 v[220:223], v[92:95], v[160:163], v[220:223]
    ds_read_b64_tr_b16 v[84:85], v55 offset:8192
    v_mfma_f32_16x16x32_bf16 v[252:255], v[92:95], v[164:167], v[252:255]
    ds_read_b64_tr_b16 v[86:87], v55 offset:12288
    s_waitcnt lgkmcnt(8)
    s_waitcnt vmcnt(19)
    v_mfma_f32_16x16x32_bf16 v[192:195], v[64:67], v[168:171], v[192:195]
    ds_read_b64_tr_b16 v[88:89], v56 offset:8192
    buffer_load_dwordx4 v[156:159], v3, s[4:7], s31 offen offset:3072 sc1
    v_mfma_f32_16x16x32_bf16 v[224:227], v[64:67], v[172:175], v[224:227]
    ds_read_b64_tr_b16 v[90:91], v56 offset:12288
    v_mfma_f32_16x16x32_bf16 v[196:199], v[68:71], v[168:171], v[196:199]
    ds_read_b64_tr_b16 v[92:93], v57 offset:8192
    v_mfma_f32_16x16x32_bf16 v[228:231], v[68:71], v[172:175], v[228:231]
    ds_read_b64_tr_b16 v[94:95], v57 offset:12288
    s_waitcnt lgkmcnt(8)
    v_mfma_f32_16x16x32_bf16 v[200:203], v[72:75], v[168:171], v[200:203]
    v_mfma_f32_16x16x32_bf16 v[232:235], v[72:75], v[172:175], v[232:235]
    s_mov_b32 s31, 24576
    buffer_load_dwordx4 v[160:163], v2, s[4:7], s31 offen offset:0 sc1
    v_mfma_f32_16x16x32_bf16 v[204:207], v[76:79], v[168:171], v[204:207]
    v_mfma_f32_16x16x32_bf16 v[236:239], v[76:79], v[172:175], v[236:239]
    s_waitcnt lgkmcnt(0)
    s_barrier
    v_mfma_f32_16x16x32_bf16 v[208:211], v[80:83], v[168:171], v[208:211]
    ds_read_b64_tr_b16 v[64:65], v50 offset:16384
    ds_read_b64_tr_b16 v[66:67], v50 offset:20480
    v_mfma_f32_16x16x32_bf16 v[240:243], v[80:83], v[172:175], v[240:243]
    ds_read_b64_tr_b16 v[68:69], v51 offset:16384
    ds_read_b64_tr_b16 v[70:71], v51 offset:20480
    s_add_u32 m0, s33, 0
    s_mov_b32 s32, 1572864
    buffer_load_dwordx4 v6, s[8:11], s32 offen offset:0 lds
    v_mfma_f32_16x16x32_bf16 v[212:215], v[84:87], v[168:171], v[212:215]
    ds_read_b64_tr_b16 v[72:73], v52 offset:16384
    ds_read_b64_tr_b16 v[74:75], v52 offset:20480
    s_cmp_eq_u32 s28, 0
    s_cbranch_scc1 L_recurrent_scan__compressed_kv_cla__moe_arch_mod__prompt_kernel_rare_174
L_recurrent_scan__compressed_kv_cla__moe_arch_mod__prompt_kernel_back_175:
    v_mfma_f32_16x16x32_bf16 v[244:247], v[84:87], v[172:175], v[244:247]
    ds_read_b64_tr_b16 v[76:77], v53 offset:16384
    ds_read_b64_tr_b16 v[78:79], v53 offset:20480
    v_mfma_f32_16x16x32_bf16 v[216:219], v[88:91], v[168:171], v[216:219]
    ds_read_b64_tr_b16 v[80:81], v54 offset:16384
    ds_read_b64_tr_b16 v[82:83], v54 offset:20480
    v_mfma_f32_16x16x32_bf16 v[248:251], v[88:91], v[172:175], v[248:251]
    buffer_load_dwordx4 v7, s[8:11], s32 offen offset:1024 lds
    v_mfma_f32_16x16x32_bf16 v[220:223], v[92:95], v[168:171], v[220:223]
    ds_read_b64_tr_b16 v[84:85], v55 offset:16384
    ds_read_b64_tr_b16 v[86:87], v55 offset:20480
    v_mfma_f32_16x16x32_bf16 v[252:255], v[92:95], v[172:175], v[252:255]
    s_waitcnt lgkmcnt(8)
    s_waitcnt vmcnt(21)
    v_mfma_f32_16x16x32_bf16 v[192:195], v[64:67], v[176:179], v[192:195]
    ds_read_b64_tr_b16 v[88:89], v56 offset:16384
    v_mfma_f32_16x16x32_bf16 v[224:227], v[64:67], v[180:183], v[224:227]
    ds_read_b64_tr_b16 v[90:91], v56 offset:20480
    buffer_load_dwordx4 v8, s[8:11], s32 offen offset:2048 lds
    v_mfma_f32_16x16x32_bf16 v[196:199], v[68:71], v[176:179], v[196:199]
    ds_read_b64_tr_b16 v[92:93], v57 offset:16384
    v_mfma_f32_16x16x32_bf16 v[228:231], v[68:71], v[180:183], v[228:231]
    ds_read_b64_tr_b16 v[94:95], v57 offset:20480
    s_waitcnt lgkmcnt(8)
    v_mfma_f32_16x16x32_bf16 v[200:203], v[72:75], v[176:179], v[200:203]
    ds_read_b64_tr_b16 v[64:65], v50 offset:24576
    v_mfma_f32_16x16x32_bf16 v[232:235], v[72:75], v[180:183], v[232:235]
    ds_read_b64_tr_b16 v[66:67], v50 offset:28672
    v_xor_b32 v50, 65536, v50
    v_mfma_f32_16x16x32_bf16 v[204:207], v[76:79], v[176:179], v[204:207]
    ds_read_b64_tr_b16 v[68:69], v51 offset:24576
    buffer_load_dwordx4 v9, s[8:11], s32 offen offset:3072 lds
    v_mfma_f32_16x16x32_bf16 v[236:239], v[76:79], v[180:183], v[236:239]
    ds_read_b64_tr_b16 v[70:71], v51 offset:28672
    v_xor_b32 v51, 65536, v51
    s_waitcnt lgkmcnt(8)
    v_mfma_f32_16x16x32_bf16 v[208:211], v[80:83], v[176:179], v[208:211]
    ds_read_b64_tr_b16 v[72:73], v52 offset:24576
    v_mfma_f32_16x16x32_bf16 v[240:243], v[80:83], v[180:183], v[240:243]
    ds_read_b64_tr_b16 v[74:75], v52 offset:28672
    v_xor_b32 v52, 65536, v52
    v_mfma_f32_16x16x32_bf16 v[212:215], v[84:87], v[176:179], v[212:215]
    ds_read_b64_tr_b16 v[76:77], v53 offset:24576
    buffer_load_dwordx4 v[164:167], v3, s[4:7], s31 offen offset:0 sc1
    v_mfma_f32_16x16x32_bf16 v[244:247], v[84:87], v[180:183], v[244:247]
    ds_read_b64_tr_b16 v[78:79], v53 offset:28672
    v_xor_b32 v53, 65536, v53
    s_waitcnt lgkmcnt(8)
    v_mfma_f32_16x16x32_bf16 v[216:219], v[88:91], v[176:179], v[216:219]
    ds_read_b64_tr_b16 v[80:81], v54 offset:24576
    v_mfma_f32_16x16x32_bf16 v[248:251], v[88:91], v[180:183], v[248:251]
    ds_read_b64_tr_b16 v[82:83], v54 offset:28672
    v_xor_b32 v54, 65536, v54
    v_mfma_f32_16x16x32_bf16 v[220:223], v[92:95], v[176:179], v[220:223]
    ds_read_b64_tr_b16 v[84:85], v55 offset:24576
    buffer_load_dwordx4 v[168:171], v2, s[4:7], s31 offen offset:1024 sc1
    v_mfma_f32_16x16x32_bf16 v[252:255], v[92:95], v[180:183], v[252:255]
    ds_read_b64_tr_b16 v[86:87], v55 offset:28672
    v_xor_b32 v55, 65536, v55
    s_waitcnt lgkmcnt(8)
    s_waitcnt vmcnt(23)
    v_mfma_f32_16x16x32_bf16 v[192:195], v[64:67], v[184:187], v[192:195]
    ds_read_b64_tr_b16 v[88:89], v56 offset:24576
    v_mfma_f32_16x16x32_bf16 v[224:227], v[64:67], v[188:191], v[224:227]
    ds_read_b64_tr_b16 v[90:91], v56 offset:28672
    v_xor_b32 v56, 65536, v56
    v_mfma_f32_16x16x32_bf16 v[196:199], v[68:71], v[184:187], v[196:199]
    ds_read_b64_tr_b16 v[92:93], v57 offset:24576
    v_mfma_f32_16x16x32_bf16 v[228:231], v[68:71], v[188:191], v[228:231]
    ds_read_b64_tr_b16 v[94:95], v57 offset:28672
    v_xor_b32 v57, 65536, v57
    buffer_load_dwordx4 v[172:175], v3, s[4:7], s31 offen offset:1024 sc1
    s_waitcnt lgkmcnt(8)
    v_mfma_f32_16x16x32_bf16 v[200:203], v[72:75], v[184:187], v[200:203]
    v_mfma_f32_16x16x32_bf16 v[232:235], v[72:75], v[188:191], v[232:235]
    v_mfma_f32_16x16x32_bf16 v[204:207], v[76:79], v[184:187], v[204:207]
    v_mfma_f32_16x16x32_bf16 v[236:239], v[76:79], v[188:191], v[236:239]
    buffer_load_dwordx4 v[176:179], v2, s[4:7], s31 offen offset:2048 sc1
    s_waitcnt lgkmcnt(0)
    s_waitcnt vmcnt(19)
    s_barrier
    v_mfma_f32_16x16x32_bf16 v[208:211], v[80:83], v[184:187], v[208:211]
    ds_read_b64_tr_b16 v[64:65], v50 offset:0
    ds_read_b64_tr_b16 v[66:67], v50 offset:4096
    v_mfma_f32_16x16x32_bf16 v[240:243], v[80:83], v[188:191], v[240:243]
    ds_read_b64_tr_b16 v[68:69], v51 offset:0
    ds_read_b64_tr_b16 v[70:71], v51 offset:4096
    s_cmp_lt_u32 s60, 31
    s_cbranch_scc1 L_recurrent_scan__compressed_kv_cla__moe_arch_mod__prompt_kernel_rare_176
L_recurrent_scan__compressed_kv_cla__moe_arch_mod__prompt_kernel_back_177:
    v_mfma_f32_16x16x32_bf16 v[212:215], v[84:87], v[184:187], v[212:215]
    ds_read_b64_tr_b16 v[72:73], v52 offset:0
    ds_read_b64_tr_b16 v[74:75], v52 offset:4096
    v_mfma_f32_16x16x32_bf16 v[244:247], v[84:87], v[188:191], v[244:247]
    ds_read_b64_tr_b16 v[76:77], v53 offset:0
    ds_read_b64_tr_b16 v[78:79], v53 offset:4096
    s_add_u32 m0, s33, 16384
    s_mov_b32 s32, 1703936
    buffer_load_dwordx4 v6, s[8:11], s32 offen offset:0 lds
    v_mfma_f32_16x16x32_bf16 v[216:219], v[88:91], v[184:187], v[216:219]
    ds_read_b64_tr_b16 v[80:81], v54 offset:0
    ds_read_b64_tr_b16 v[82:83], v54 offset:4096
    v_mfma_f32_16x16x32_bf16 v[248:251], v[88:91], v[188:191], v[248:251]
    v_mfma_f32_16x16x32_bf16 v[220:223], v[92:95], v[184:187], v[220:223]
    ds_read_b64_tr_b16 v[84:85], v55 offset:0
    ds_read_b64_tr_b16 v[86:87], v55 offset:4096
    v_mfma_f32_16x16x32_bf16 v[252:255], v[92:95], v[188:191], v[252:255]
    buffer_load_dwordx4 v7, s[8:11], s32 offen offset:1024 lds
    s_waitcnt lgkmcnt(8)
    v_mfma_f32_16x16x32_bf16 v[192:195], v[64:67], v[128:131], v[192:195]
    ds_read_b64_tr_b16 v[88:89], v56 offset:0
    v_mfma_f32_16x16x32_bf16 v[224:227], v[64:67], v[132:135], v[224:227]
    ds_read_b64_tr_b16 v[90:91], v56 offset:4096
    v_mfma_f32_16x16x32_bf16 v[196:199], v[68:71], v[128:131], v[196:199]
    ds_read_b64_tr_b16 v[92:93], v57 offset:0
    v_mfma_f32_16x16x32_bf16 v[228:231], v[68:71], v[132:135], v[228:231]
    ds_read_b64_tr_b16 v[94:95], v57 offset:4096
    s_waitcnt lgkmcnt(8)
    v_mfma_f32_16x16x32_bf16 v[200:203], v[72:75], v[128:131], v[200:203]
    ds_read_b64_tr_b16 v[64:65], v50 offset:8192
    buffer_load_dwordx4 v8, s[8:11], s32 offen offset:2048 lds
    v_mfma_f32_16x16x32_bf16 v[232:235], v[72:75], v[132:135], v[232:235]
    ds_read_b64_tr_b16 v[66:67], v50 offset:12288
    v_mfma_f32_16x16x32_bf16 v[204:207], v[76:79], v[128:131], v[204:207]
    ds_read_b64_tr_b16 v[68:69], v51 offset:8192
    v_mfma_f32_16x16x32_bf16 v[236:239], v[76:79], v[132:135], v[236:239]
    ds_read_b64_tr_b16 v[70:71], v51 offset:12288
    s_waitcnt lgkmcnt(8)
    v_mfma_f32_16x16x32_bf16 v[208:211], v[80:83], v[128:131], v[208:211]
    ds_read_b64_tr_b16 v[72:73], v52 offset:8192
    buffer_load_dwordx4 v9, s[8:11], s32 offen offset:3072 lds
    v_mfma_f32_16x16x32_bf16 v[240:243], v[80:83], v[132:135], v[240:243]
    ds_read_b64_tr_b16 v[74:75], v52 offset:12288
    v_mfma_f32_16x16x32_bf16 v[212:215], v[84:87], v[128:131], v[212:215]
    ds_read_b64_tr_b16 v[76:77], v53 offset:8192
    v_mfma_f32_16x16x32_bf16 v[244:247], v[84:87], v[132:135], v[244:247]
    ds_read_b64_tr_b16 v[78:79], v53 offset:12288
    s_waitcnt lgkmcnt(8)
    v_mfma_f32_16x16x32_bf16 v[216:219], v[88:91], v[128:131], v[216:219]
    ds_read_b64_tr_b16 v[80:81], v54 offset:8192
    buffer_load_dwordx4 v[180:183], v3, s[4:7], s31 offen offset:2048 sc1
    v_mfma_f32_16x16x32_bf16 v[248:251], v[88:91], v[132:135], v[248:251]
    ds_read_b64_tr_b16 v[82:83], v54 offset:12288
    v_mfma_f32_16x16x32_bf16 v[220:223], v[92:95], v[128:131], v[220:223]
    ds_read_b64_tr_b16 v[84:85], v55 offset:8192
    v_mfma_f32_16x16x32_bf16 v[252:255], v[92:95], v[132:135], v[252:255]
    ds_read_b64_tr_b16 v[86:87], v55 offset:12288
    s_waitcnt lgkmcnt(8)
    s_waitcnt vmcnt(22)
    v_mfma_f32_16x16x32_bf16 v[192:195], v[64:67], v[136:139], v[192:195]
    ds_read_b64_tr_b16 v[88:89], v56 offset:8192
    buffer_load_dwordx4 v[184:187], v2, s[4:7], s31 offen offset:3072 sc1
    v_mfma_f32_16x16x32_bf16 v[224:227], v[64:67], v[140:143], v[224:227]
    ds_read_b64_tr_b16 v[90:91], v56 offset:12288
    v_mfma_f32_16x16x32_bf16 v[196:199], v[68:71], v[136:139], v[196:199]
    ds_read_b64_tr_b16 v[92:93], v57 offset:8192
    v_mfma_f32_16x16x32_bf16 v[228:231], v[68:71], v[140:143], v[228:231]
    ds_read_b64_tr_b16 v[94:95], v57 offset:12288
    s_waitcnt lgkmcnt(8)
    v_mfma_f32_16x16x32_bf16 v[200:203], v[72:75], v[136:139], v[200:203]
    v_mfma_f32_16x16x32_bf16 v[232:235], v[72:75], v[140:143], v[232:235]
    buffer_load_dwordx4 v[188:191], v3, s[4:7], s31 offen offset:3072 sc1
    v_mfma_f32_16x16x32_bf16 v[204:207], v[76:79], v[136:139], v[204:207]
    v_mfma_f32_16x16x32_bf16 v[236:239], v[76:79], v[140:143], v[236:239]
    s_cmp_lt_u32 s60, 31
    s_cbranch_scc1 L_recurrent_scan__compressed_kv_cla__moe_arch_mod__prompt_kernel_rare_181
L_recurrent_scan__compressed_kv_cla__moe_arch_mod__prompt_kernel_back_182:
    s_waitcnt lgkmcnt(0)
    s_waitcnt vmcnt(18)
    s_barrier
    v_mfma_f32_16x16x32_bf16 v[208:211], v[80:83], v[136:139], v[208:211]
    ds_read_b64_tr_b16 v[64:65], v50 offset:16384
    ds_read_b64_tr_b16 v[66:67], v50 offset:20480
    v_mfma_f32_16x16x32_bf16 v[240:243], v[80:83], v[140:143], v[240:243]
    ds_read_b64_tr_b16 v[68:69], v51 offset:16384
    ds_read_b64_tr_b16 v[70:71], v51 offset:20480
    s_add_u32 m0, s33, 65536
    s_mov_b32 s32, 2097152
    buffer_load_dwordx4 v6, s[8:11], s32 offen offset:0 lds
    v_mfma_f32_16x16x32_bf16 v[212:215], v[84:87], v[136:139], v[212:215]
    ds_read_b64_tr_b16 v[72:73], v52 offset:16384
    ds_read_b64_tr_b16 v[74:75], v52 offset:20480
    v_mfma_f32_16x16x32_bf16 v[244:247], v[84:87], v[140:143], v[244:247]
    ds_read_b64_tr_b16 v[76:77], v53 offset:16384
    ds_read_b64_tr_b16 v[78:79], v53 offset:20480
    v_mfma_f32_16x16x32_bf16 v[216:219], v[88:91], v[136:139], v[216:219]
    ds_read_b64_tr_b16 v[80:81], v54 offset:16384
    ds_read_b64_tr_b16 v[82:83], v54 offset:20480
    v_mfma_f32_16x16x32_bf16 v[248:251], v[88:91], v[140:143], v[248:251]
    buffer_load_dwordx4 v7, s[8:11], s32 offen offset:1024 lds
    v_mfma_f32_16x16x32_bf16 v[220:223], v[92:95], v[136:139], v[220:223]
    ds_read_b64_tr_b16 v[84:85], v55 offset:16384
    ds_read_b64_tr_b16 v[86:87], v55 offset:20480
    v_mfma_f32_16x16x32_bf16 v[252:255], v[92:95], v[140:143], v[252:255]
    s_waitcnt lgkmcnt(8)
    v_mfma_f32_16x16x32_bf16 v[192:195], v[64:67], v[144:147], v[192:195]
    ds_read_b64_tr_b16 v[88:89], v56 offset:16384
    v_mfma_f32_16x16x32_bf16 v[224:227], v[64:67], v[148:151], v[224:227]
    ds_read_b64_tr_b16 v[90:91], v56 offset:20480
    buffer_load_dwordx4 v8, s[8:11], s32 offen offset:2048 lds
    v_mfma_f32_16x16x32_bf16 v[196:199], v[68:71], v[144:147], v[196:199]
    ds_read_b64_tr_b16 v[92:93], v57 offset:16384
    v_mfma_f32_16x16x32_bf16 v[228:231], v[68:71], v[148:151], v[228:231]
    ds_read_b64_tr_b16 v[94:95], v57 offset:20480
    s_waitcnt lgkmcnt(8)
    v_mfma_f32_16x16x32_bf16 v[200:203], v[72:75], v[144:147], v[200:203]
    ds_read_b64_tr_b16 v[64:65], v50 offset:24576
    v_mfma_f32_16x16x32_bf16 v[232:235], v[72:75], v[148:151], v[232:235]
    ds_read_b64_tr_b16 v[66:67], v50 offset:28672
    v_xor_b32 v50, 65536, v50
    v_mfma_f32_16x16x32_bf16 v[204:207], v[76:79], v[144:147], v[204:207]
    ds_read_b64_tr_b16 v[68:69], v51 offset:24576
    buffer_load_dwordx4 v9, s[8:11], s32 offen offset:3072 lds
    v_mfma_f32_16x16x32_bf16 v[236:239], v[76:79], v[148:151], v[236:239]
    ds_read_b64_tr_b16 v[70:71], v51 offset:28672
    v_xor_b32 v51, 65536, v51
    s_waitcnt lgkmcnt(8)
    v_mfma_f32_16x16x32_bf16 v[208:211], v[80:83], v[144:147], v[208:211]
    ds_read_b64_tr_b16 v[72:73], v52 offset:24576
    v_mfma_f32_16x16x32_bf16 v[240:243], v[80:83], v[148:151], v[240:243]
    ds_read_b64_tr_b16 v[74:75], v52 offset:28672
    v_xor_b32 v52, 65536, v52
    v_mfma_f32_16x16x32_bf16 v[212:215], v[84:87], v[144:147], v[212:215]
    ds_read_b64_tr_b16 v[76:77], v53 offset:24576
    s_mov_b32 s31, 32768
    buffer_load_dwordx4 v[128:131], v2, s[4:7], s31 offen offset:0 sc1
    v_mfma_f32_16x16x32_bf16 v[244:247], v[84:87], v[148:151], v[244:247]
    ds_read_b64_tr_b16 v[78:79], v53 offset:28672
    v_xor_b32 v53, 65536, v53
    s_waitcnt lgkmcnt(8)
    v_mfma_f32_16x16x32_bf16 v[216:219], v[88:91], v[144:147], v[216:219]
    ds_read_b64_tr_b16 v[80:81], v54 offset:24576
    v_mfma_f32_16x16x32_bf16 v[248:251], v[88:91], v[148:151], v[248:251]
    ds_read_b64_tr_b16 v[82:83], v54 offset:28672
    v_xor_b32 v54, 65536, v54
    v_mfma_f32_16x16x32_bf16 v[220:223], v[92:95], v[144:147], v[220:223]
    ds_read_b64_tr_b16 v[84:85], v55 offset:24576
    buffer_load_dwordx4 v[132:135], v3, s[4:7], s31 offen offset:0 sc1
    v_mfma_f32_16x16x32_bf16 v[252:255], v[92:95], v[148:151], v[252:255]
    ds_read_b64_tr_b16 v[86:87], v55 offset:28672
    v_xor_b32 v55, 65536, v55
    s_waitcnt lgkmcnt(8)
    s_waitcnt vmcnt(22)
    v_mfma_f32_16x16x32_bf16 v[192:195], v[64:67], v[152:155], v[192:195]
    ds_read_b64_tr_b16 v[88:89], v56 offset:24576
    v_mfma_f32_16x16x32_bf16 v[224:227], v[64:67], v[156:159], v[224:227]
    ds_read_b64_tr_b16 v[90:91], v56 offset:28672
    v_xor_b32 v56, 65536, v56
    v_mfma_f32_16x16x32_bf16 v[196:199], v[68:71], v[152:155], v[196:199]
    ds_read_b64_tr_b16 v[92:93], v57 offset:24576
    buffer_load_dwordx4 v[136:139], v2, s[4:7], s31 offen offset:1024 sc1
    v_mfma_f32_16x16x32_bf16 v[228:231], v[68:71], v[156:159], v[228:231]
    ds_read_b64_tr_b16 v[94:95], v57 offset:28672
    v_xor_b32 v57, 65536, v57
    s_waitcnt lgkmcnt(8)
    v_mfma_f32_16x16x32_bf16 v[200:203], v[72:75], v[152:155], v[200:203]
    v_mfma_f32_16x16x32_bf16 v[232:235], v[72:75], v[156:159], v[232:235]
    v_mfma_f32_16x16x32_bf16 v[204:207], v[76:79], v[152:155], v[204:207]
    v_mfma_f32_16x16x32_bf16 v[236:239], v[76:79], v[156:159], v[236:239]
    buffer_load_dwordx4 v[140:143], v3, s[4:7], s31 offen offset:1024 sc1
    s_waitcnt lgkmcnt(0)
    s_waitcnt vmcnt(19)
    s_barrier
    v_mfma_f32_16x16x32_bf16 v[208:211], v[80:83], v[152:155], v[208:211]
    ds_read_b64_tr_b16 v[64:65], v50 offset:0
    ds_read_b64_tr_b16 v[66:67], v50 offset:4096
    v_mfma_f32_16x16x32_bf16 v[240:243], v[80:83], v[156:159], v[240:243]
    ds_read_b64_tr_b16 v[68:69], v51 offset:0
    ds_read_b64_tr_b16 v[70:71], v51 offset:4096
    v_mfma_f32_16x16x32_bf16 v[212:215], v[84:87], v[152:155], v[212:215]
    ds_read_b64_tr_b16 v[72:73], v52 offset:0
    ds_read_b64_tr_b16 v[74:75], v52 offset:4096
    v_mfma_f32_16x16x32_bf16 v[244:247], v[84:87], v[156:159], v[244:247]
    ds_read_b64_tr_b16 v[76:77], v53 offset:0
    ds_read_b64_tr_b16 v[78:79], v53 offset:4096
    s_add_u32 m0, s33, 81920
    s_mov_b32 s32, 2228224
    buffer_load_dwordx4 v6, s[8:11], s32 offen offset:0 lds
    v_mfma_f32_16x16x32_bf16 v[216:219], v[88:91], v[152:155], v[216:219]
    ds_read_b64_tr_b16 v[80:81], v54 offset:0
    ds_read_b64_tr_b16 v[82:83], v54 offset:4096
    v_mfma_f32_16x16x32_bf16 v[248:251], v[88:91], v[156:159], v[248:251]
    v_mfma_f32_16x16x32_bf16 v[220:223], v[92:95], v[152:155], v[220:223]
    ds_read_b64_tr_b16 v[84:85], v55 offset:0
    ds_read_b64_tr_b16 v[86:87], v55 offset:4096
    v_mfma_f32_16x16x32_bf16 v[252:255], v[92:95], v[156:159], v[252:255]
    buffer_load_dwordx4 v7, s[8:11], s32 offen offset:1024 lds
    s_waitcnt lgkmcnt(8)
    s_waitcnt vmcnt(20)
    v_mfma_f32_16x16x32_bf16 v[192:195], v[64:67], v[160:163], v[192:195]
    ds_read_b64_tr_b16 v[88:89], v56 offset:0
    v_mfma_f32_16x16x32_bf16 v[224:227], v[64:67], v[164:167], v[224:227]
    ds_read_b64_tr_b16 v[90:91], v56 offset:4096
    v_mfma_f32_16x16x32_bf16 v[196:199], v[68:71], v[160:163], v[196:199]
    ds_read_b64_tr_b16 v[92:93], v57 offset:0
    v_mfma_f32_16x16x32_bf16 v[228:231], v[68:71], v[164:167], v[228:231]
    ds_read_b64_tr_b16 v[94:95], v57 offset:4096
    buffer_load_dwordx4 v8, s[8:11], s32 offen offset:2048 lds
    s_waitcnt lgkmcnt(8)
    v_mfma_f32_16x16x32_bf16 v[200:203], v[72:75], v[160:163], v[200:203]
    ds_read_b64_tr_b16 v[64:65], v50 offset:8192
    v_mfma_f32_16x16x32_bf16 v[232:235], v[72:75], v[164:167], v[232:235]
    ds_read_b64_tr_b16 v[66:67], v50 offset:12288
    v_mfma_f32_16x16x32_bf16 v[204:207], v[76:79], v[160:163], v[204:207]
    ds_read_b64_tr_b16 v[68:69], v51 offset:8192
    v_mfma_f32_16x16x32_bf16 v[236:239], v[76:79], v[164:167], v[236:239]
    ds_read_b64_tr_b16 v[70:71], v51 offset:12288
    s_waitcnt lgkmcnt(8)
    v_mfma_f32_16x16x32_bf16 v[208:211], v[80:83], v[160:163], v[208:211]
    ds_read_b64_tr_b16 v[72:73], v52 offset:8192
    buffer_load_dwordx4 v9, s[8:11], s32 offen offset:3072 lds
    v_mfma_f32_16x16x32_bf16 v[240:243], v[80:83], v[164:167], v[240:243]
    ds_read_b64_tr_b16 v[74:75], v52 offset:12288
    v_mfma_f32_16x16x32_bf16 v[212:215], v[84:87], v[160:163], v[212:215]
    ds_read_b64_tr_b16 v[76:77], v53 offset:8192
    v_mfma_f32_16x16x32_bf16 v[244:247], v[84:87], v[164:167], v[244:247]
    ds_read_b64_tr_b16 v[78:79], v53 offset:12288
    s_waitcnt lgkmcnt(8)
    v_mfma_f32_16x16x32_bf16 v[216:219], v[88:91], v[160:163], v[216:219]
    ds_read_b64_tr_b16 v[80:81], v54 offset:8192
    buffer_load_dwordx4 v[144:147], v2, s[4:7], s31 offen offset:2048 sc1
    v_mfma_f32_16x16x32_bf16 v[248:251], v[88:91], v[164:167], v[248:251]
    ds_read_b64_tr_b16 v[82:83], v54 offset:12288
    v_mfma_f32_16x16x32_bf16 v[220:223], v[92:95], v[160:163], v[220:223]
    ds_read_b64_tr_b16 v[84:85], v55 offset:8192
    v_mfma_f32_16x16x32_bf16 v[252:255], v[92:95], v[164:167], v[252:255]
    ds_read_b64_tr_b16 v[86:87], v55 offset:12288
    s_waitcnt lgkmcnt(8)
    s_waitcnt vmcnt(21)
    v_mfma_f32_16x16x32_bf16 v[192:195], v[64:67], v[168:171], v[192:195]
    ds_read_b64_tr_b16 v[88:89], v56 offset:8192
    buffer_load_dwordx4 v[148:151], v3, s[4:7], s31 offen offset:2048 sc1
    v_mfma_f32_16x16x32_bf16 v[224:227], v[64:67], v[172:175], v[224:227]
    ds_read_b64_tr_b16 v[90:91], v56 offset:12288
    v_mfma_f32_16x16x32_bf16 v[196:199], v[68:71], v[168:171], v[196:199]
    ds_read_b64_tr_b16 v[92:93], v57 offset:8192
    v_mfma_f32_16x16x32_bf16 v[228:231], v[68:71], v[172:175], v[228:231]
    ds_read_b64_tr_b16 v[94:95], v57 offset:12288
    s_waitcnt lgkmcnt(8)
    v_mfma_f32_16x16x32_bf16 v[200:203], v[72:75], v[168:171], v[200:203]
    buffer_load_dwordx4 v[152:155], v2, s[4:7], s31 offen offset:3072 sc1
    v_mfma_f32_16x16x32_bf16 v[232:235], v[72:75], v[172:175], v[232:235]
    v_mfma_f32_16x16x32_bf16 v[204:207], v[76:79], v[168:171], v[204:207]
    v_mfma_f32_16x16x32_bf16 v[236:239], v[76:79], v[172:175], v[236:239]
    s_waitcnt lgkmcnt(0)
    s_waitcnt vmcnt(18)
    s_barrier
    v_mfma_f32_16x16x32_bf16 v[208:211], v[80:83], v[168:171], v[208:211]
    ds_read_b64_tr_b16 v[64:65], v50 offset:16384
    ds_read_b64_tr_b16 v[66:67], v50 offset:20480
    v_mfma_f32_16x16x32_bf16 v[240:243], v[80:83], v[172:175], v[240:243]
    ds_read_b64_tr_b16 v[68:69], v51 offset:16384
    ds_read_b64_tr_b16 v[70:71], v51 offset:20480
    s_add_u32 m0, s33, 0
    s_mov_b32 s32, 2621440
    buffer_load_dwordx4 v6, s[8:11], s32 offen offset:0 lds
    v_mfma_f32_16x16x32_bf16 v[212:215], v[84:87], v[168:171], v[212:215]
    ds_read_b64_tr_b16 v[72:73], v52 offset:16384
    ds_read_b64_tr_b16 v[74:75], v52 offset:20480
    v_mfma_f32_16x16x32_bf16 v[244:247], v[84:87], v[172:175], v[244:247]
    ds_read_b64_tr_b16 v[76:77], v53 offset:16384
    ds_read_b64_tr_b16 v[78:79], v53 offset:20480
    v_mfma_f32_16x16x32_bf16 v[216:219], v[88:91], v[168:171], v[216:219]
    ds_read_b64_tr_b16 v[80:81], v54 offset:16384
    ds_read_b64_tr_b16 v[82:83], v54 offset:20480
    v_mfma_f32_16x16x32_bf16 v[248:251], v[88:91], v[172:175], v[248:251]
    buffer_load_dwordx4 v[156:159], v3, s[4:7], s31 offen offset:3072 sc1
    v_mfma_f32_16x16x32_bf16 v[220:223], v[92:95], v[168:171], v[220:223]
    ds_read_b64_tr_b16 v[84:85], v55 offset:16384
    ds_read_b64_tr_b16 v[86:87], v55 offset:20480
    v_mfma_f32_16x16x32_bf16 v[252:255], v[92:95], v[172:175], v[252:255]
    s_waitcnt lgkmcnt(8)
    s_waitcnt vmcnt(19)
    v_mfma_f32_16x16x32_bf16 v[192:195], v[64:67], v[176:179], v[192:195]
    ds_read_b64_tr_b16 v[88:89], v56 offset:16384
    v_mfma_f32_16x16x32_bf16 v[224:227], v[64:67], v[180:183], v[224:227]
    ds_read_b64_tr_b16 v[90:91], v56 offset:20480
    buffer_load_dwordx4 v7, s[8:11], s32 offen offset:1024 lds
    v_mfma_f32_16x16x32_bf16 v[196:199], v[68:71], v[176:179], v[196:199]
    ds_read_b64_tr_b16 v[92:93], v57 offset:16384
    v_mfma_f32_16x16x32_bf16 v[228:231], v[68:71], v[180:183], v[228:231]
    ds_read_b64_tr_b16 v[94:95], v57 offset:20480
    s_waitcnt lgkmcnt(8)
    v_mfma_f32_16x16x32_bf16 v[200:203], v[72:75], v[176:179], v[200:203]
    ds_read_b64_tr_b16 v[64:65], v50 offset:24576
    v_mfma_f32_16x16x32_bf16 v[232:235], v[72:75], v[180:183], v[232:235]
    ds_read_b64_tr_b16 v[66:67], v50 offset:28672
    v_xor_b32 v50, 65536, v50
    v_mfma_f32_16x16x32_bf16 v[204:207], v[76:79], v[176:179], v[204:207]
    ds_read_b64_tr_b16 v[68:69], v51 offset:24576
    buffer_load_dwordx4 v8, s[8:11], s32 offen offset:2048 lds
    v_mfma_f32_16x16x32_bf16 v[236:239], v[76:79], v[180:183], v[236:239]
    ds_read_b64_tr_b16 v[70:71], v51 offset:28672
    v_xor_b32 v51, 65536, v51
    s_waitcnt lgkmcnt(8)
    v_mfma_f32_16x16x32_bf16 v[208:211], v[80:83], v[176:179], v[208:211]
    ds_read_b64_tr_b16 v[72:73], v52 offset:24576
    v_mfma_f32_16x16x32_bf16 v[240:243], v[80:83], v[180:183], v[240:243]
    ds_read_b64_tr_b16 v[74:75], v52 offset:28672
    v_xor_b32 v52, 65536, v52
    v_mfma_f32_16x16x32_bf16 v[212:215], v[84:87], v[176:179], v[212:215]
    ds_read_b64_tr_b16 v[76:77], v53 offset:24576
    buffer_load_dwordx4 v9, s[8:11], s32 offen offset:3072 lds
    v_mfma_f32_16x16x32_bf16 v[244:247], v[84:87], v[180:183], v[244:247]
    ds_read_b64_tr_b16 v[78:79], v53 offset:28672
    v_xor_b32 v53, 65536, v53
    s_waitcnt lgkmcnt(8)
    v_mfma_f32_16x16x32_bf16 v[216:219], v[88:91], v[176:179], v[216:219]
    ds_read_b64_tr_b16 v[80:81], v54 offset:24576
    v_mfma_f32_16x16x32_bf16 v[248:251], v[88:91], v[180:183], v[248:251]
    ds_read_b64_tr_b16 v[82:83], v54 offset:28672
    v_xor_b32 v54, 65536, v54
    v_mfma_f32_16x16x32_bf16 v[220:223], v[92:95], v[176:179], v[220:223]
    ds_read_b64_tr_b16 v[84:85], v55 offset:24576
    s_mov_b32 s31, 40960
    buffer_load_dwordx4 v[160:163], v2, s[4:7], s31 offen offset:0 sc1
    v_mfma_f32_16x16x32_bf16 v[252:255], v[92:95], v[180:183], v[252:255]
    ds_read_b64_tr_b16 v[86:87], v55 offset:28672
    v_xor_b32 v55, 65536, v55
    s_waitcnt lgkmcnt(8)
    s_waitcnt vmcnt(21)
    v_mfma_f32_16x16x32_bf16 v[192:195], v[64:67], v[184:187], v[192:195]
    ds_read_b64_tr_b16 v[88:89], v56 offset:24576
    v_mfma_f32_16x16x32_bf16 v[224:227], v[64:67], v[188:191], v[224:227]
    ds_read_b64_tr_b16 v[90:91], v56 offset:28672
    v_xor_b32 v56, 65536, v56
    v_mfma_f32_16x16x32_bf16 v[196:199], v[68:71], v[184:187], v[196:199]
    ds_read_b64_tr_b16 v[92:93], v57 offset:24576
    buffer_load_dwordx4 v[164:167], v3, s[4:7], s31 offen offset:0 sc1
    v_mfma_f32_16x16x32_bf16 v[228:231], v[68:71], v[188:191], v[228:231]
    ds_read_b64_tr_b16 v[94:95], v57 offset:28672
    v_xor_b32 v57, 65536, v57
    s_waitcnt lgkmcnt(8)
    v_mfma_f32_16x16x32_bf16 v[200:203], v[72:75], v[184:187], v[200:203]
    v_mfma_f32_16x16x32_bf16 v[232:235], v[72:75], v[188:191], v[232:235]
    v_mfma_f32_16x16x32_bf16 v[204:207], v[76:79], v[184:187], v[204:207]
    v_mfma_f32_16x16x32_bf16 v[236:239], v[76:79], v[188:191], v[236:239]
    buffer_load_dwordx4 v[168:171], v2, s[4:7], s31 offen offset:1024 sc1
    s_waitcnt lgkmcnt(0)
    s_waitcnt vmcnt(19)
    s_barrier
    v_mfma_f32_16x16x32_bf16 v[208:211], v[80:83], v[184:187], v[208:211]
    ds_read_b64_tr_b16 v[64:65], v50 offset:0
    ds_read_b64_tr_b16 v[66:67], v50 offset:4096
    v_mfma_f32_16x16x32_bf16 v[240:243], v[80:83], v[188:191], v[240:243]
    ds_read_b64_tr_b16 v[68:69], v51 offset:0
    ds_read_b64_tr_b16 v[70:71], v51 offset:4096
    s_cmp_lt_u32 s60, 31
    s_cbranch_scc1 L_recurrent_scan__compressed_kv_cla__moe_arch_mod__prompt_kernel_rare_183
L_recurrent_scan__compressed_kv_cla__moe_arch_mod__prompt_kernel_back_184:
    v_mfma_f32_16x16x32_bf16 v[212:215], v[84:87], v[184:187], v[212:215]
    ds_read_b64_tr_b16 v[72:73], v52 offset:0
    ds_read_b64_tr_b16 v[74:75], v52 offset:4096
    s_sub_u32 s36, s56, s38
    s_sub_u32 s37, s57, s38
    s_min_u32 s36, s36, s37
    s_cmp_lt_u32 s36, 16
    s_cbranch_scc1 L_recurrent_scan__compressed_kv_cla__moe_arch_mod__prompt_kernel_rare_190
L_recurrent_scan__compressed_kv_cla__moe_arch_mod__prompt_kernel_back_191:
    v_mfma_f32_16x16x32_bf16 v[244:247], v[84:87], v[188:191], v[244:247]
    ds_read_b64_tr_b16 v[76:77], v53 offset:0
    ds_read_b64_tr_b16 v[78:79], v53 offset:4096
    s_add_u32 m0, s33, 16384
    s_mov_b32 s32, 2752512
    buffer_load_dwordx4 v6, s[8:11], s32 offen offset:0 lds
    v_mfma_f32_16x16x32_bf16 v[216:219], v[88:91], v[184:187], v[216:219]
    ds_read_b64_tr_b16 v[80:81], v54 offset:0
    ds_read_b64_tr_b16 v[82:83], v54 offset:4096
    v_mfma_f32_16x16x32_bf16 v[248:251], v[88:91], v[188:191], v[248:251]
    v_mfma_f32_16x16x32_bf16 v[220:223], v[92:95], v[184:187], v[220:223]
    ds_read_b64_tr_b16 v[84:85], v55 offset:0
    ds_read_b64_tr_b16 v[86:87], v55 offset:4096
    v_mfma_f32_16x16x32_bf16 v[252:255], v[92:95], v[188:191], v[252:255]
    buffer_load_dwordx4 v[172:175], v3, s[4:7], s31 offen offset:1024 sc1
    s_waitcnt lgkmcnt(8)
    s_waitcnt vmcnt(19)
    v_mfma_f32_16x16x32_bf16 v[192:195], v[64:67], v[128:131], v[192:195]
    ds_read_b64_tr_b16 v[88:89], v56 offset:0
    v_mfma_f32_16x16x32_bf16 v[224:227], v[64:67], v[132:135], v[224:227]
    ds_read_b64_tr_b16 v[90:91], v56 offset:4096
    v_mfma_f32_16x16x32_bf16 v[196:199], v[68:71], v[128:131], v[196:199]
    ds_read_b64_tr_b16 v[92:93], v57 offset:0
    v_mfma_f32_16x16x32_bf16 v[228:231], v[68:71], v[132:135], v[228:231]
    ds_read_b64_tr_b16 v[94:95], v57 offset:4096
    buffer_load_dwordx4 v7, s[8:11], s32 offen offset:1024 lds
    s_waitcnt lgkmcnt(8)
    v_mfma_f32_16x16x32_bf16 v[200:203], v[72:75], v[128:131], v[200:203]
    ds_read_b64_tr_b16 v[64:65], v50 offset:8192
    v_mfma_f32_16x16x32_bf16 v[232:235], v[72:75], v[132:135], v[232:235]
    ds_read_b64_tr_b16 v[66:67], v50 offset:12288
    v_mfma_f32_16x16x32_bf16 v[204:207], v[76:79], v[128:131], v[204:207]
    ds_read_b64_tr_b16 v[68:69], v51 offset:8192
    v_mfma_f32_16x16x32_bf16 v[236:239], v[76:79], v[132:135], v[236:239]
    ds_read_b64_tr_b16 v[70:71], v51 offset:12288
    s_waitcnt lgkmcnt(8)
    v_mfma_f32_16x16x32_bf16 v[208:211], v[80:83], v[128:131], v[208:211]
    ds_read_b64_tr_b16 v[72:73], v52 offset:8192
    buffer_load_dwordx4 v8, s[8:11], s32 offen offset:2048 lds
    v_mfma_f32_16x16x32_bf16 v[240:243], v[80:83], v[132:135], v[240:243]
    ds_read_b64_tr_b16 v[74:75], v52 offset:12288
    v_mfma_f32_16x16x32_bf16 v[212:215], v[84:87], v[128:131], v[212:215]
    ds_read_b64_tr_b16 v[76:77], v53 offset:8192
    v_mfma_f32_16x16x32_bf16 v[244:247], v[84:87], v[132:135], v[244:247]
    ds_read_b64_tr_b16 v[78:79], v53 offset:12288
    s_waitcnt lgkmcnt(8)
    v_mfma_f32_16x16x32_bf16 v[216:219], v[88:91], v[128:131], v[216:219]
    ds_read_b64_tr_b16 v[80:81], v54 offset:8192
    buffer_load_dwordx4 v9, s[8:11], s32 offen offset:3072 lds
    v_mfma_f32_16x16x32_bf16 v[248:251], v[88:91], v[132:135], v[248:251]
    ds_read_b64_tr_b16 v[82:83], v54 offset:12288
    v_mfma_f32_16x16x32_bf16 v[220:223], v[92:95], v[128:131], v[220:223]
    ds_read_b64_tr_b16 v[84:85], v55 offset:8192
    v_mfma_f32_16x16x32_bf16 v[252:255], v[92:95], v[132:135], v[252:255]
    ds_read_b64_tr_b16 v[86:87], v55 offset:12288
    s_waitcnt lgkmcnt(8)
    s_waitcnt vmcnt(20)
    v_mfma_f32_16x16x32_bf16 v[192:195], v[64:67], v[136:139], v[192:195]
    ds_read_b64_tr_b16 v[88:89], v56 offset:8192
    buffer_load_dwordx4 v[176:179], v2, s[4:7], s31 offen offset:2048 sc1
    v_mfma_f32_16x16x32_bf16 v[224:227], v[64:67], v[140:143], v[224:227]
    ds_read_b64_tr_b16 v[90:91], v56 offset:12288
    v_mfma_f32_16x16x32_bf16 v[196:199], v[68:71], v[136:139], v[196:199]
    ds_read_b64_tr_b16 v[92:93], v57 offset:8192
    v_mfma_f32_16x16x32_bf16 v[228:231], v[68:71], v[140:143], v[228:231]
    ds_read_b64_tr_b16 v[94:95], v57 offset:12288
    s_waitcnt lgkmcnt(8)
    v_mfma_f32_16x16x32_bf16 v[200:203], v[72:75], v[136:139], v[200:203]
    buffer_load_dwordx4 v[180:183], v3, s[4:7], s31 offen offset:2048 sc1
    v_mfma_f32_16x16x32_bf16 v[232:235], v[72:75], v[140:143], v[232:235]
    v_mfma_f32_16x16x32_bf16 v[204:207], v[76:79], v[136:139], v[204:207]
    v_mfma_f32_16x16x32_bf16 v[236:239], v[76:79], v[140:143], v[236:239]
    s_cmp_lt_u32 s60, 31
    s_cbranch_scc1 L_recurrent_scan__compressed_kv_cla__moe_arch_mod__prompt_kernel_rare_188
L_recurrent_scan__compressed_kv_cla__moe_arch_mod__prompt_kernel_back_189:
    s_waitcnt lgkmcnt(0)
    s_waitcnt vmcnt(18)
    s_barrier
    v_mfma_f32_16x16x32_bf16 v[208:211], v[80:83], v[136:139], v[208:211]
    ds_read_b64_tr_b16 v[64:65], v50 offset:16384
    ds_read_b64_tr_b16 v[66:67], v50 offset:20480
    v_mfma_f32_16x16x32_bf16 v[240:243], v[80:83], v[140:143], v[240:243]
    s_mov_b32 m0, s42
    s_mov_b32 s36, 15360
    buffer_load_dwordx4 v15, s[16:19], 0 offen lds
    buffer_load_dwordx4 v15, s[16:19], s36 offen offset:1024 lds
    s_mov_b32 s36, 4194304
    buffer_load_dwordx2 v[48:49], v16, s[24:27], s36 offen sc1
    ds_read_b64_tr_b16 v[68:69], v51 offset:16384
    ds_read_b64_tr_b16 v[70:71], v51 offset:20480
    s_add_u32 m0, s33, 65536
    s_mov_b32 s32, 3145728
    buffer_load_dwordx4 v6, s[8:11], s32 offen offset:0 lds
    v_mfma_f32_16x16x32_bf16 v[212:215], v[84:87], v[136:139], v[212:215]
    ds_read_b64_tr_b16 v[72:73], v52 offset:16384
    ds_read_b64_tr_b16 v[74:75], v52 offset:20480
    v_mfma_f32_16x16x32_bf16 v[244:247], v[84:87], v[140:143], v[244:247]
    ds_read_b64_tr_b16 v[76:77], v53 offset:16384
    ds_read_b64_tr_b16 v[78:79], v53 offset:20480
    v_mfma_f32_16x16x32_bf16 v[216:219], v[88:91], v[136:139], v[216:219]
    ds_read_b64_tr_b16 v[80:81], v54 offset:16384
    ds_read_b64_tr_b16 v[82:83], v54 offset:20480
    v_mfma_f32_16x16x32_bf16 v[248:251], v[88:91], v[140:143], v[248:251]
    buffer_load_dwordx4 v[184:187], v2, s[4:7], s31 offen offset:3072 sc1
    v_mfma_f32_16x16x32_bf16 v[220:223], v[92:95], v[136:139], v[220:223]
    ds_read_b64_tr_b16 v[84:85], v55 offset:16384
    ds_read_b64_tr_b16 v[86:87], v55 offset:20480
    v_mfma_f32_16x16x32_bf16 v[252:255], v[92:95], v[140:143], v[252:255]
    s_waitcnt lgkmcnt(8)
    s_waitcnt vmcnt(21)
    v_mfma_f32_16x16x32_bf16 v[192:195], v[64:67], v[144:147], v[192:195]
    ds_read_b64_tr_b16 v[88:89], v56 offset:16384
    v_mfma_f32_16x16x32_bf16 v[224:227], v[64:67], v[148:151], v[224:227]
    ds_read_b64_tr_b16 v[90:91], v56 offset:20480
    buffer_load_dwordx4 v[188:191], v3, s[4:7], s31 offen offset:3072 sc1
    v_mfma_f32_16x16x32_bf16 v[196:199], v[68:71], v[144:147], v[196:199]
    ds_read_b64_tr_b16 v[92:93], v57 offset:16384
    v_mfma_f32_16x16x32_bf16 v[228:231], v[68:71], v[148:151], v[228:231]
    ds_read_b64_tr_b16 v[94:95], v57 offset:20480
    s_waitcnt lgkmcnt(8)
    v_mfma_f32_16x16x32_bf16 v[200:203], v[72:75], v[144:147], v[200:203]
    ds_read_b64_tr_b16 v[64:65], v50 offset:24576
    v_mfma_f32_16x16x32_bf16 v[232:235], v[72:75], v[148:151], v[232:235]
    ds_read_b64_tr_b16 v[66:67], v50 offset:28672
    v_xor_b32 v50, 65536, v50
    buffer_load_dwordx4 v7, s[8:11], s32 offen offset:1024 lds
    v_mfma_f32_16x16x32_bf16 v[204:207], v[76:79], v[144:147], v[204:207]
    ds_read_b64_tr_b16 v[68:69], v51 offset:24576
    v_mfma_f32_16x16x32_bf16 v[236:239], v[76:79], v[148:151], v[236:239]
    ds_read_b64_tr_b16 v[70:71], v51 offset:28672
    v_xor_b32 v51, 65536, v51
    s_waitcnt lgkmcnt(8)
    v_mfma_f32_16x16x32_bf16 v[208:211], v[80:83], v[144:147], v[208:211]
    ds_read_b64_tr_b16 v[72:73], v52 offset:24576
    v_mfma_f32_16x16x32_bf16 v[240:243], v[80:83], v[148:151], v[240:243]
    ds_read_b64_tr_b16 v[74:75], v52 offset:28672
    v_xor_b32 v52, 65536, v52
    v_mfma_f32_16x16x32_bf16 v[212:215], v[84:87], v[144:147], v[212:215]
    ds_read_b64_tr_b16 v[76:77], v53 offset:24576
    buffer_load_dwordx4 v8, s[8:11], s32 offen offset:2048 lds
    v_mfma_f32_16x16x32_bf16 v[244:247], v[84:87], v[148:151], v[244:247]
    ds_read_b64_tr_b16 v[78:79], v53 offset:28672
    v_xor_b32 v53, 65536, v53
    s_waitcnt lgkmcnt(8)
    v_mfma_f32_16x16x32_bf16 v[216:219], v[88:91], v[144:147], v[216:219]
    ds_read_b64_tr_b16 v[80:81], v54 offset:24576
    s_cmp_eq_u32 s28, 0
    s_cbranch_scc0 L_recurrent_scan__compressed_kv_cla__moe_arch_mod__prompt_kernel_g_197
    s_mov_b32 s43, s38
    s_getpc_b64 s[36:37]
L_recurrent_scan__compressed_kv_cla__moe_arch_mod__prompt_kernel_pc_196:
    s_sub_u32 s36, s36, L_recurrent_scan__compressed_kv_cla__moe_arch_mod__prompt_kernel_pc_196-L_pc
    s_subb_u32 s37, s37, 0
    s_lshr_b32 s38, s2, 3
    s_lshl_b32 s38, s38, 7
    v_lshl_add_u32 v4, v1, 12, s38
    v_min_u32 v4, L_end-L_pc-4, v4
    v_mov_b32 v5, s37
    v_add_co_u32 v4, vcc, s36, v4
    s_mov_b64 exec, 0xffff
    s_nop 0
    v_addc_co_u32 v5, vcc, 0, v5, vcc
    global_load_dword v0, v[4:5], off
    s_mov_b64 exec, -1
    s_nop 1
    s_mov_b32 s38, s43
L_recurrent_scan__compressed_kv_cla__moe_arch_mod__prompt_kernel_g_197:
    v_mfma_f32_16x16x32_bf16 v[248:251], v[88:91], v[148:151], v[248:251]
    ds_read_b64_tr_b16 v[82:83], v54 offset:28672
    v_xor_b32 v54, 65536, v54
    v_mfma_f32_16x16x32_bf16 v[220:223], v[92:95], v[144:147], v[220:223]
    ds_read_b64_tr_b16 v[84:85], v55 offset:24576
    buffer_load_dwordx4 v9, s[8:11], s32 offen offset:3072 lds
    v_mfma_f32_16x16x32_bf16 v[252:255], v[92:95], v[148:151], v[252:255]
    ds_read_b64_tr_b16 v[86:87], v55 offset:28672
    v_xor_b32 v55, 65536, v55
    s_waitcnt lgkmcnt(8)
    s_waitcnt vmcnt(22)
    v_mfma_f32_16x16x32_bf16 v[192:195], v[64:67], v[152:155], v[192:195]
    ds_read_b64_tr_b16 v[88:89], v56 offset:24576
    v_mfma_f32_16x16x32_bf16 v[224:227], v[64:67], v[156:159], v[224:227]
    ds_read_b64_tr_b16 v[90:91], v56 offset:28672
    v_xor_b32 v56, 65536, v56
    v_mfma_f32_16x16x32_bf16 v[196:199], v[68:71], v[152:155], v[196:199]
    ds_read_b64_tr_b16 v[92:93], v57 offset:24576
    s_mov_b32 s31, 49152
    buffer_load_dwordx4 v[128:131], v2, s[4:7], s31 offen offset:0 sc1
    v_mfma_f32_16x16x32_bf16 v[228:231], v[68:71], v[156:159], v[228:231]
    ds_read_b64_tr_b16 v[94:95], v57 offset:28672
    v_xor_b32 v57, 65536, v57
    s_waitcnt lgkmcnt(8)
    v_mfma_f32_16x16x32_bf16 v[200:203], v[72:75], v[152:155], v[200:203]
    v_mfma_f32_16x16x32_bf16 v[232:235], v[72:75], v[156:159], v[232:235]
    v_mfma_f32_16x16x32_bf16 v[204:207], v[76:79], v[152:155], v[204:207]
    buffer_load_dwordx4 v[132:135], v3, s[4:7], s31 offen offset:0 sc1
    s_sub_u32 s36, s56, s38
    s_sub_u32 s37, s57, s38
    s_min_u32 s36, s36, s37
    s_cmp_lt_u32 s36, 16
    s_cbranch_scc1 L_recurrent_scan__compressed_kv_cla__moe_arch_mod__prompt_kernel_rare_192
L_recurrent_scan__compressed_kv_cla__moe_arch_mod__prompt_kernel_back_193:
    v_mfma_f32_16x16x32_bf16 v[236:239], v[76:79], v[156:159], v[236:239]
    s_waitcnt lgkmcnt(0)
    s_waitcnt vmcnt(21)
    s_barrier
    v_mfma_f32_16x16x32_bf16 v[208:211], v[80:83], v[152:155], v[208:211]
    ds_read_b64_tr_b16 v[64:65], v50 offset:0
    ds_read_b64_tr_b16 v[66:67], v50 offset:4096
    v_mfma_f32_16x16x32_bf16 v[240:243], v[80:83], v[156:159], v[240:243]
    ds_read_b64_tr_b16 v[68:69], v51 offset:0
    ds_read_b64_tr_b16 v[70:71], v51 offset:4096
    v_mfma_f32_16x16x32_bf16 v[212:215], v[84:87], v[152:155], v[212:215]
    ds_read_b64_tr_b16 v[72:73], v52 offset:0
    ds_read_b64_tr_b16 v[74:75], v52 offset:4096
    v_mfma_f32_16x16x32_bf16 v[244:247], v[84:87], v[156:159], v[244:247]
    ds_read_b64_tr_b16 v[76:77], v53 offset:0
    ds_read_b64_tr_b16 v[78:79], v53 offset:4096
    s_add_u32 m0, s33, 81920
    s_mov_b32 s32, 3276800
    buffer_load_dwordx4 v6, s[8:11], s32 offen offset:0 lds
    v_mfma_f32_16x16x32_bf16 v[216:219], v[88:91], v[152:155], v[216:219]
    ds_read_b64_tr_b16 v[80:81], v54 offset:0
    ds_read_b64_tr_b16 v[82:83], v54 offset:4096
    v_mfma_f32_16x16x32_bf16 v[248:251], v[88:91], v[156:159], v[248:251]
    v_mfma_f32_16x16x32_bf16 v[220:223], v[92:95], v[152:155], v[220:223]
    ds_read_b64_tr_b16 v[84:85], v55 offset:0
    ds_read_b64_tr_b16 v[86:87], v55 offset:4096
    v_mfma_f32_16x16x32_bf16 v[252:255], v[92:95], v[156:159], v[252:255]
    buffer_load_dwordx4 v7, s[8:11], s32 offen offset:1024 lds
    s_waitcnt lgkmcnt(8)
    s_waitcnt vmcnt(21)
    v_mfma_f32_16x16x32_bf16 v[192:195], v[64:67], v[160:163], v[192:195]
    ds_read_b64_tr_b16 v[88:89], v56 offset:0
    v_mfma_f32_16x16x32_bf16 v[224:227], v[64:67], v[164:167], v[224:227]
    ds_read_b64_tr_b16 v[90:91], v56 offset:4096
    v_mfma_f32_16x16x32_bf16 v[196:199], v[68:71], v[160:163], v[196:199]
    ds_read_b64_tr_b16 v[92:93], v57 offset:0
    v_mfma_f32_16x16x32_bf16 v[228:231], v[68:71], v[164:167], v[228:231]
    ds_read_b64_tr_b16 v[94:95], v57 offset:4096
    buffer_load_dwordx4 v[136:139], v2, s[4:7], s31 offen offset:1024 sc1
    s_waitcnt lgkmcnt(8)
    v_mfma_f32_16x16x32_bf16 v[200:203], v[72:75], v[160:163], v[200:203]
    ds_read_b64_tr_b16 v[64:65], v50 offset:8192
    v_mfma_f32_16x16x32_bf16 v[232:235], v[72:75], v[164:167], v[232:235]
    ds_read_b64_tr_b16 v[66:67], v50 offset:12288
    v_mfma_f32_16x16x32_bf16 v[204:207], v[76:79], v[160:163], v[204:207]
    ds_read_b64_tr_b16 v[68:69], v51 offset:8192
    v_mfma_f32_16x16x32_bf16 v[236:239], v[76:79], v[164:167], v[236:239]
    ds_read_b64_tr_b16 v[70:71], v51 offset:12288
    s_waitcnt lgkmcnt(8)
    v_mfma_f32_16x16x32_bf16 v[208:211], v[80:83], v[160:163], v[208:211]
    ds_read_b64_tr_b16 v[72:73], v52 offset:8192
    buffer_load_dwordx4 v[140:143], v3, s[4:7], s31 offen offset:1024 sc1
    v_mfma_f32_16x16x32_bf16 v[240:243], v[80:83], v[164:167], v[240:243]
    ds_read_b64_tr_b16 v[74:75], v52 offset:12288
    v_mfma_f32_16x16x32_bf16 v[212:215], v[84:87], v[160:163], v[212:215]
    ds_read_b64_tr_b16 v[76:77], v53 offset:8192
    v_mfma_f32_16x16x32_bf16 v[244:247], v[84:87], v[164:167], v[244:247]
    ds_read_b64_tr_b16 v[78:79], v53 offset:12288
    s_waitcnt lgkmcnt(8)
    v_mfma_f32_16x16x32_bf16 v[216:219], v[88:91], v[160:163], v[216:219]
    ds_read_b64_tr_b16 v[80:81], v54 offset:8192
    buffer_load_dwordx4 v8, s[8:11], s32 offen offset:2048 lds
    v_mfma_f32_16x16x32_bf16 v[248:251], v[88:91], v[164:167], v[248:251]
    ds_read_b64_tr_b16 v[82:83], v54 offset:12288
    v_mfma_f32_16x16x32_bf16 v[220:223], v[92:95], v[160:163], v[220:223]
    ds_read_b64_tr_b16 v[84:85], v55 offset:8192
    v_mfma_f32_16x16x32_bf16 v[252:255], v[92:95], v[164:167], v[252:255]
    ds_read_b64_tr_b16 v[86:87], v55 offset:12288
    s_waitcnt lgkmcnt(8)
    s_waitcnt vmcnt(21)
    v_mfma_f32_16x16x32_bf16 v[192:195], v[64:67], v[168:171], v[192:195]
    ds_read_b64_tr_b16 v[88:89], v56 offset:8192
    buffer_load_dwordx4 v9, s[8:11], s32 offen offset:3072 lds
    v_mfma_f32_16x16x32_bf16 v[224:227], v[64:67], v[172:175], v[224:227]
    ds_read_b64_tr_b16 v[90:91], v56 offset:12288
    v_mfma_f32_16x16x32_bf16 v[196:199], v[68:71], v[168:171], v[196:199]
    ds_read_b64_tr_b16 v[92:93], v57 offset:8192
    v_mfma_f32_16x16x32_bf16 v[228:231], v[68:71], v[172:175], v[228:231]
    ds_read_b64_tr_b16 v[94:95], v57 offset:12288
    s_waitcnt lgkmcnt(8)
    v_mfma_f32_16x16x32_bf16 v[200:203], v[72:75], v[168:171], v[200:203]
    buffer_load_dwordx4 v[144:147], v2, s[4:7], s31 offen offset:2048 sc1
    v_mfma_f32_16x16x32_bf16 v[232:235], v[72:75], v[172:175], v[232:235]
    v_mfma_f32_16x16x32_bf16 v[204:207], v[76:79], v[168:171], v[204:207]
    v_mfma_f32_16x16x32_bf16 v[236:239], v[76:79], v[172:175], v[236:239]
    s_waitcnt lgkmcnt(0)
    s_waitcnt vmcnt(20)
    s_barrier
    v_mfma_f32_16x16x32_bf16 v[208:211], v[80:83], v[168:171], v[208:211]
    ds_read_b64_tr_b16 v[64:65], v50 offset:16384
    ds_read_b64_tr_b16 v[66:67], v50 offset:20480
    v_mfma_f32_16x16x32_bf16 v[240:243], v[80:83], v[172:175], v[240:243]
    ds_read_b64_tr_b16 v[68:69], v51 offset:16384
    ds_read_b64_tr_b16 v[70:71], v51 offset:20480
    s_add_u32 m0, s33, 0
    s_mov_b32 s32, 3670016
    buffer_load_dwordx4 v6, s[8:11], s32 offen offset:0 lds
    v_mfma_f32_16x16x32_bf16 v[212:215], v[84:87], v[168:171], v[212:215]
    ds_read_b64_tr_b16 v[72:73], v52 offset:16384
    ds_read_b64_tr_b16 v[74:75], v52 offset:20480
    v_mfma_f32_16x16x32_bf16 v[244:247], v[84:87], v[172:175], v[244:247]
    ds_read_b64_tr_b16 v[76:77], v53 offset:16384
    ds_read_b64_tr_b16 v[78:79], v53 offset:20480
    v_mfma_f32_16x16x32_bf16 v[216:219], v[88:91], v[168:171], v[216:219]
    ds_read_b64_tr_b16 v[80:81], v54 offset:16384
    ds_read_b64_tr_b16 v[82:83], v54 offset:20480
    v_mfma_f32_16x16x32_bf16 v[248:251], v[88:91], v[172:175], v[248:251]
    buffer_load_dwordx4 v7, s[8:11], s32 offen offset:1024 lds
    v_mfma_f32_16x16x32_bf16 v[220:223], v[92:95], v[168:171], v[220:223]
    ds_read_b64_tr_b16 v[84:85], v55 offset:16384
    ds_read_b64_tr_b16 v[86:87], v55 offset:20480
    v_mfma_f32_16x16x32_bf16 v[252:255], v[92:95], v[172:175], v[252:255]
    s_waitcnt lgkmcnt(8)
    s_waitcnt vmcnt(20)
    v_mfma_f32_16x16x32_bf16 v[192:195], v[64:67], v[176:179], v[192:195]
    ds_read_b64_tr_b16 v[88:89], v56 offset:16384
    v_mfma_f32_16x16x32_bf16 v[224:227], v[64:67], v[180:183], v[224:227]
    ds_read_b64_tr_b16 v[90:91], v56 offset:20480
    buffer_load_dwordx4 v[148:151], v3, s[4:7], s31 offen offset:2048 sc1
    v_mfma_f32_16x16x32_bf16 v[196:199], v[68:71], v[176:179], v[196:199]
    ds_read_b64_tr_b16 v[92:93], v57 offset:16384
    v_mfma_f32_16x16x32_bf16 v[228:231], v[68:71], v[180:183], v[228:231]
    ds_read_b64_tr_b16 v[94:95], v57 offset:20480
    s_waitcnt lgkmcnt(8)
    v_mfma_f32_16x16x32_bf16 v[200:203], v[72:75], v[176:179], v[200:203]
    ds_read_b64_tr_b16 v[64:65], v50 offset:24576
    v_mfma_f32_16x16x32_bf16 v[232:235], v[72:75], v[180:183], v[232:235]
    ds_read_b64_tr_b16 v[66:67], v50 offset:28672
    v_xor_b32 v50, 65536, v50
    buffer_load_dwordx4 v8, s[8:11], s32 offen offset:2048 lds
    v_mfma_f32_16x16x32_bf16 v[204:207], v[76:79], v[176:179], v[204:207]
    ds_read_b64_tr_b16 v[68:69], v51 offset:24576
    v_mfma_f32_16x16x32_bf16 v[236:239], v[76:79], v[180:183], v[236:239]
    ds_read_b64_tr_b16 v[70:71], v51 offset:28672
    v_xor_b32 v51, 65536, v51
    s_waitcnt lgkmcnt(8)
    v_mfma_f32_16x16x32_bf16 v[208:211], v[80:83], v[176:179], v[208:211]
    ds_read_b64_tr_b16 v[72:73], v52 offset:24576
    v_mfma_f32_16x16x32_bf16 v[240:243], v[80:83], v[180:183], v[240:243]
    ds_read_b64_tr_b16 v[74:75], v52 offset:28672
    v_xor_b32 v52, 65536, v52
    v_mfma_f32_16x16x32_bf16 v[212:215], v[84:87], v[176:179], v[212:215]
    ds_read_b64_tr_b16 v[76:77], v53 offset:24576
    buffer_load_dwordx4 v9, s[8:11], s32 offen offset:3072 lds
    v_mfma_f32_16x16x32_bf16 v[244:247], v[84:87], v[180:183], v[244:247]
    ds_read_b64_tr_b16 v[78:79], v53 offset:28672
    v_xor_b32 v53, 65536, v53
    s_waitcnt lgkmcnt(8)
    v_mfma_f32_16x16x32_bf16 v[216:219], v[88:91], v[176:179], v[216:219]
    ds_read_b64_tr_b16 v[80:81], v54 offset:24576
    v_mfma_f32_16x16x32_bf16 v[248:251], v[88:91], v[180:183], v[248:251]
    ds_read_b64_tr_b16 v[82:83], v54 offset:28672
    v_xor_b32 v54, 65536, v54
    v_mfma_f32_16x16x32_bf16 v[220:223], v[92:95], v[176:179], v[220:223]
    ds_read_b64_tr_b16 v[84:85], v55 offset:24576
    buffer_load_dwordx4 v[152:155], v2, s[4:7], s31 offen offset:3072 sc1
    v_mfma_f32_16x16x32_bf16 v[252:255], v[92:95], v[180:183], v[252:255]
    ds_read_b64_tr_b16 v[86:87], v55 offset:28672
    v_xor_b32 v55, 65536, v55
    s_waitcnt lgkmcnt(8)
    s_waitcnt vmcnt(18)
    v_mfma_f32_16x16x32_bf16 v[192:195], v[64:67], v[184:187], v[192:195]
    ds_read_b64_tr_b16 v[88:89], v56 offset:24576
    v_mfma_f32_16x16x32_bf16 v[224:227], v[64:67], v[188:191], v[224:227]
    ds_read_b64_tr_b16 v[90:91], v56 offset:28672
    v_xor_b32 v56, 65536, v56
    v_mfma_f32_16x16x32_bf16 v[196:199], v[68:71], v[184:187], v[196:199]
    ds_read_b64_tr_b16 v[92:93], v57 offset:24576
    buffer_load_dwordx4 v[156:159], v3, s[4:7], s31 offen offset:3072 sc1
    v_mfma_f32_16x16x32_bf16 v[228:231], v[68:71], v[188:191], v[228:231]
    ds_read_b64_tr_b16 v[94:95], v57 offset:28672
    v_xor_b32 v57, 65536, v57
    s_waitcnt lgkmcnt(8)
    v_mfma_f32_16x16x32_bf16 v[200:203], v[72:75], v[184:187], v[200:203]
    s_sub_u32 s36, s56, s38
    s_sub_u32 s37, s57, s38
    s_min_u32 s36, s36, s37
    s_cmp_lt_u32 s36, 16
    s_cbranch_scc1 L_recurrent_scan__compressed_kv_cla__moe_arch_mod__prompt_kernel_rare_194
L_recurrent_scan__compressed_kv_cla__moe_arch_mod__prompt_kernel_back_195:
    v_mfma_f32_16x16x32_bf16 v[232:235], v[72:75], v[188:191], v[232:235]
    v_mfma_f32_16x16x32_bf16 v[204:207], v[76:79], v[184:187], v[204:207]
    s_mov_b32 s31, 57344
    buffer_load_dwordx4 v[160:163], v2, s[4:7], s31 offen offset:0 sc1
    v_mfma_f32_16x16x32_bf16 v[236:239], v[76:79], v[188:191], v[236:239]
    s_waitcnt lgkmcnt(0)
    s_waitcnt vmcnt(17)
    s_barrier
    v_mfma_f32_16x16x32_bf16 v[208:211], v[80:83], v[184:187], v[208:211]
    ds_read_b64_tr_b16 v[64:65], v50 offset:0
    ds_read_b64_tr_b16 v[66:67], v50 offset:4096
    v_mfma_f32_16x16x32_bf16 v[240:243], v[80:83], v[188:191], v[240:243]
    ds_read_b64_tr_b16 v[68:69], v51 offset:0
    ds_read_b64_tr_b16 v[70:71], v51 offset:4096
    v_mfma_f32_16x16x32_bf16 v[212:215], v[84:87], v[184:187], v[212:215]
    ds_read_b64_tr_b16 v[72:73], v52 offset:0
    ds_read_b64_tr_b16 v[74:75], v52 offset:4096
    v_mfma_f32_16x16x32_bf16 v[244:247], v[84:87], v[188:191], v[244:247]
    ds_read_b64_tr_b16 v[76:77], v53 offset:0
    ds_read_b64_tr_b16 v[78:79], v53 offset:4096
    s_add_u32 m0, s33, 16384
    s_mov_b32 s32, 3801088
    buffer_load_dwordx4 v6, s[8:11], s32 offen offset:0 lds
    v_mfma_f32_16x16x32_bf16 v[216:219], v[88:91], v[184:187], v[216:219]
    ds_read_b64_tr_b16 v[80:81], v54 offset:0
    ds_read_b64_tr_b16 v[82:83], v54 offset:4096
    v_mfma_f32_16x16x32_bf16 v[248:251], v[88:91], v[188:191], v[248:251]
    v_mfma_f32_16x16x32_bf16 v[220:223], v[92:95], v[184:187], v[220:223]
    ds_read_b64_tr_b16 v[84:85], v55 offset:0
    ds_read_b64_tr_b16 v[86:87], v55 offset:4096
    v_mfma_f32_16x16x32_bf16 v[252:255], v[92:95], v[188:191], v[252:255]
    buffer_load_dwordx4 v7, s[8:11], s32 offen offset:1024 lds
    s_waitcnt lgkmcnt(8)
    s_waitcnt vmcnt(17)
    v_mfma_f32_16x16x32_bf16 v[192:195], v[64:67], v[128:131], v[192:195]
    ds_read_b64_tr_b16 v[88:89], v56 offset:0
    v_mfma_f32_16x16x32_bf16 v[224:227], v[64:67], v[132:135], v[224:227]
    ds_read_b64_tr_b16 v[90:91], v56 offset:4096
    v_mfma_f32_16x16x32_bf16 v[196:199], v[68:71], v[128:131], v[196:199]
    ds_read_b64_tr_b16 v[92:93], v57 offset:0
    v_mfma_f32_16x16x32_bf16 v[228:231], v[68:71], v[132:135], v[228:231]
    ds_read_b64_tr_b16 v[94:95], v57 offset:4096
    buffer_load_dwordx4 v[164:167], v3, s[4:7], s31 offen offset:0 sc1
    s_waitcnt lgkmcnt(8)
    v_mfma_f32_16x16x32_bf16 v[200:203], v[72:75], v[128:131], v[200:203]
    ds_read_b64_tr_b16 v[64:65], v50 offset:8192
    v_mfma_f32_16x16x32_bf16 v[232:235], v[72:75], v[132:135], v[232:235]
    ds_read_b64_tr_b16 v[66:67], v50 offset:12288
    v_mfma_f32_16x16x32_bf16 v[204:207], v[76:79], v[128:131], v[204:207]
    ds_read_b64_tr_b16 v[68:69], v51 offset:8192
    v_mfma_f32_16x16x32_bf16 v[236:239], v[76:79], v[132:135], v[236:239]
    ds_read_b64_tr_b16 v[70:71], v51 offset:12288
    buffer_load_dwordx4 v8, s[8:11], s32 offen offset:2048 lds
    s_waitcnt lgkmcnt(8)
    v_mfma_f32_16x16x32_bf16 v[208:211], v[80:83], v[128:131], v[208:211]
    ds_read_b64_tr_b16 v[72:73], v52 offset:8192
    v_mfma_f32_16x16x32_bf16 v[240:243], v[80:83], v[132:135], v[240:243]
    ds_read_b64_tr_b16 v[74:75], v52 offset:12288
    v_mfma_f32_16x16x32_bf16 v[212:215], v[84:87], v[128:131], v[212:215]
    ds_read_b64_tr_b16 v[76:77], v53 offset:8192
    v_mfma_f32_16x16x32_bf16 v[244:247], v[84:87], v[132:135], v[244:247]
    ds_read_b64_tr_b16 v[78:79], v53 offset:12288
    s_waitcnt lgkmcnt(8)
    v_mfma_f32_16x16x32_bf16 v[216:219], v[88:91], v[128:131], v[216:219]
    ds_read_b64_tr_b16 v[80:81], v54 offset:8192
    buffer_load_dwordx4 v9, s[8:11], s32 offen offset:3072 lds
    v_mfma_f32_16x16x32_bf16 v[248:251], v[88:91], v[132:135], v[248:251]
    ds_read_b64_tr_b16 v[82:83], v54 offset:12288
    v_mfma_f32_16x16x32_bf16 v[220:223], v[92:95], v[128:131], v[220:223]
    ds_read_b64_tr_b16 v[84:85], v55 offset:8192
    v_mfma_f32_16x16x32_bf16 v[252:255], v[92:95], v[132:135], v[252:255]
    ds_read_b64_tr_b16 v[86:87], v55 offset:12288
    s_waitcnt lgkmcnt(8)
    s_waitcnt vmcnt(16)
    v_mfma_f32_16x16x32_bf16 v[192:195], v[64:67], v[136:139], v[192:195]
    ds_read_b64_tr_b16 v[88:89], v56 offset:8192
    buffer_load_dwordx4 v[168:171], v2, s[4:7], s31 offen offset:1024 sc1
    v_mfma_f32_16x16x32_bf16 v[224:227], v[64:67], v[140:143], v[224:227]
    ds_read_b64_tr_b16 v[90:91], v56 offset:12288
    v_mfma_f32_16x16x32_bf16 v[196:199], v[68:71], v[136:139], v[196:199]
    ds_read_b64_tr_b16 v[92:93], v57 offset:8192
    v_mfma_f32_16x16x32_bf16 v[228:231], v[68:71], v[140:143], v[228:231]
    ds_read_b64_tr_b16 v[94:95], v57 offset:12288
    s_waitcnt vmcnt(15)
    s_barrier
    s_waitcnt lgkmcnt(8)
    v_mfma_f32_16x16x32_bf16 v[200:203], v[72:75], v[136:139], v[200:203]
    ds_read_b64_tr_b16 v[64:65], v50 offset:16384
    buffer_load_dwordx4 v[172:175], v3, s[4:7], s31 offen offset:1024 sc1
    v_mfma_f32_16x16x32_bf16 v[232:235], v[72:75], v[140:143], v[232:235]
    ds_read_b64_tr_b16 v[66:67], v50 offset:20480
    v_mfma_f32_16x16x32_bf16 v[204:207], v[76:79], v[136:139], v[204:207]
    ds_read_b64_tr_b16 v[68:69], v51 offset:16384
    v_mfma_f32_16x16x32_bf16 v[236:239], v[76:79], v[140:143], v[236:239]
    ds_read_b64_tr_b16 v[70:71], v51 offset:20480
    s_waitcnt lgkmcnt(8)
    v_mfma_f32_16x16x32_bf16 v[208:211], v[80:83], v[136:139], v[208:211]
    ds_read_b64_tr_b16 v[72:73], v52 offset:16384
    buffer_load_dwordx4 v[176:179], v2, s[4:7], s31 offen offset:2048 sc1
    v_mfma_f32_16x16x32_bf16 v[240:243], v[80:83], v[140:143], v[240:243]
    ds_read_b64_tr_b16 v[74:75], v52 offset:20480
    v_mfma_f32_16x16x32_bf16 v[212:215], v[84:87], v[136:139], v[212:215]
    ds_read_b64_tr_b16 v[76:77], v53 offset:16384
    v_mfma_f32_16x16x32_bf16 v[244:247], v[84:87], v[140:143], v[244:247]
    ds_read_b64_tr_b16 v[78:79], v53 offset:20480
    s_waitcnt lgkmcnt(8)
    v_mfma_f32_16x16x32_bf16 v[216:219], v[88:91], v[136:139], v[216:219]
    ds_read_b64_tr_b16 v[80:81], v50 offset:24576
    v_mfma_f32_16x16x32_bf16 v[248:251], v[88:91], v[140:143], v[248:251]
    ds_read_b64_tr_b16 v[82:83], v50 offset:28672
    v_xor_b32 v50, 65536, v50
    buffer_load_dwordx4 v[180:183], v3, s[4:7], s31 offen offset:2048 sc1
    v_mfma_f32_16x16x32_bf16 v[220:223], v[92:95], v[136:139], v[220:223]
    ds_read_b64_tr_b16 v[84:85], v51 offset:24576
    v_mfma_f32_16x16x32_bf16 v[252:255], v[92:95], v[140:143], v[252:255]
    ds_read_b64_tr_b16 v[86:87], v51 offset:28672
    v_xor_b32 v51, 65536, v51
    s_waitcnt lgkmcnt(8)
    s_waitcnt vmcnt(14)
    v_mfma_f32_16x16x32_bf16 v[192:195], v[64:67], v[144:147], v[192:195]
    ds_read_b64_tr_b16 v[88:89], v52 offset:24576
    v_mfma_f32_16x16x32_bf16 v[224:227], v[64:67], v[148:151], v[224:227]
    ds_read_b64_tr_b16 v[90:91], v52 offset:28672
    v_xor_b32 v52, 65536, v52
    buffer_load_dwordx4 v[184:187], v2, s[4:7], s31 offen offset:3072 sc1
    v_mfma_f32_16x16x32_bf16 v[196:199], v[68:71], v[144:147], v[196:199]
    ds_read_b64_tr_b16 v[92:93], v53 offset:24576
    v_mfma_f32_16x16x32_bf16 v[228:231], v[68:71], v[148:151], v[228:231]
    ds_read_b64_tr_b16 v[94:95], v53 offset:28672
    v_xor_b32 v53, 65536, v53
    s_waitcnt vmcnt(13)
    s_barrier
    s_waitcnt lgkmcnt(8)
    v_mfma_f32_16x16x32_bf16 v[200:203], v[72:75], v[144:147], v[200:203]
    ds_read_b64_tr_b16 v[64:65], v50 offset:0
    v_mfma_f32_16x16x32_bf16 v[232:235], v[72:75], v[148:151], v[232:235]
    ds_read_b64_tr_b16 v[66:67], v50 offset:4096
    buffer_load_dwordx4 v[188:191], v3, s[4:7], s31 offen offset:3072 sc1
    v_mfma_f32_16x16x32_bf16 v[204:207], v[76:79], v[144:147], v[204:207]
    ds_read_b64_tr_b16 v[68:69], v51 offset:0
    v_mfma_f32_16x16x32_bf16 v[236:239], v[76:79], v[148:151], v[236:239]
    ds_read_b64_tr_b16 v[70:71], v51 offset:4096
    s_waitcnt lgkmcnt(8)
    s_waitcnt vmcnt(12)
    v_mfma_f32_16x16x32_bf16 v[192:195], v[80:83], v[152:155], v[192:195]
    ds_read_b64_tr_b16 v[72:73], v52 offset:0
    v_mfma_f32_16x16x32_bf16 v[224:227], v[80:83], v[156:159], v[224:227]
    ds_read_b64_tr_b16 v[74:75], v52 offset:4096
    v_mfma_f32_16x16x32_bf16 v[196:199], v[84:87], v[152:155], v[196:199]
    ds_read_b64_tr_b16 v[76:77], v53 offset:0
    v_mfma_f32_16x16x32_bf16 v[228:231], v[84:87], v[156:159], v[228:231]
    ds_read_b64_tr_b16 v[78:79], v53 offset:4096
    s_waitcnt lgkmcnt(8)
    v_mfma_f32_16x16x32_bf16 v[200:203], v[88:91], v[152:155], v[200:203]
    ds_read_b64_tr_b16 v[80:81], v50 offset:8192
    v_mfma_f32_16x16x32_bf16 v[232:235], v[88:91], v[156:159], v[232:235]
    ds_read_b64_tr_b16 v[82:83], v50 offset:12288
    v_mfma_f32_16x16x32_bf16 v[204:207], v[92:95], v[152:155], v[204:207]
    ds_read_b64_tr_b16 v[84:85], v51 offset:8192
    v_mfma_f32_16x16x32_bf16 v[236:239], v[92:95], v[156:159], v[236:239]
    ds_read_b64_tr_b16 v[86:87], v51 offset:12288
    s_waitcnt lgkmcnt(8)
    s_waitcnt vmcnt(8)
    v_mfma_f32_16x16x32_bf16 v[192:195], v[64:67], v[160:163], v[192:195]
    ds_read_b64_tr_b16 v[88:89], v52 offset:8192
    v_mfma_f32_16x16x32_bf16 v[224:227], v[64:67], v[164:167], v[224:227]
    ds_read_b64_tr_b16 v[90:91], v52 offset:12288
    v_mfma_f32_16x16x32_bf16 v[196:199], v[68:71], v[160:163], v[196:199]
    ds_read_b64_tr_b16 v[92:93], v53 offset:8192
    v_mfma_f32_16x16x32_bf16 v[228:231], v[68:71], v[164:167], v[228:231]
    ds_read_b64_tr_b16 v[94:95], v53 offset:12288
    s_waitcnt vmcnt(6)
    s_barrier
    s_waitcnt lgkmcnt(8)
    v_mfma_f32_16x16x32_bf16 v[200:203], v[72:75], v[160:163], v[200:203]
    ds_read_b64_tr_b16 v[64:65], v50 offset:16384
    v_mfma_f32_16x16x32_bf16 v[232:235], v[72:75], v[164:167], v[232:235]
    ds_read_b64_tr_b16 v[66:67], v50 offset:20480
    v_mfma_f32_16x16x32_bf16 v[204:207], v[76:79], v[160:163], v[204:207]
    ds_read_b64_tr_b16 v[68:69], v51 offset:16384
    v_mfma_f32_16x16x32_bf16 v[236:239], v[76:79], v[164:167], v[236:239]
    ds_read_b64_tr_b16 v[70:71], v51 offset:20480
    s_waitcnt lgkmcnt(8)
    s_waitcnt vmcnt(4)
    v_mfma_f32_16x16x32_bf16 v[192:195], v[80:83], v[168:171], v[192:195]
    ds_read_b64_tr_b16 v[72:73], v52 offset:16384
    v_mfma_f32_16x16x32_bf16 v[224:227], v[80:83], v[172:175], v[224:227]
    ds_read_b64_tr_b16 v[74:75], v52 offset:20480
    v_mfma_f32_16x16x32_bf16 v[196:199], v[84:87], v[168:171], v[196:199]
    ds_read_b64_tr_b16 v[76:77], v53 offset:16384
    v_mfma_f32_16x16x32_bf16 v[228:231], v[84:87], v[172:175], v[228:231]
    ds_read_b64_tr_b16 v[78:79], v53 offset:20480
    s_waitcnt lgkmcnt(8)
    v_mfma_f32_16x16x32_bf16 v[200:203], v[88:91], v[168:171], v[200:203]
    ds_read_b64_tr_b16 v[80:81], v50 offset:24576
    s_xor_b32 s37, s40, 512
    v_mov_b32 v5, s37
    ds_read_b64 v[40:41], v63 offset:0
    ds_read_b64 v[42:43], v63 offset:32
    ds_read_b64 v[44:45], v63 offset:64
    ds_read_b64 v[46:47], v63 offset:96
    v_mfma_f32_16x16x32_bf16 v[232:235], v[88:91], v[172:175], v[232:235]
    ds_read_b64_tr_b16 v[82:83], v50 offset:28672
    v_mfma_f32_16x16x32_bf16 v[204:207], v[92:95], v[168:171], v[204:207]
    ds_read_b64_tr_b16 v[84:85], v51 offset:24576
    v_mfma_f32_16x16x32_bf16 v[236:239], v[92:95], v[172:175], v[236:239]
    ds_read_b64_tr_b16 v[86:87], v51 offset:28672
    s_waitcnt lgkmcnt(12)
    s_waitcnt vmcnt(2)
    v_mfma_f32_16x16x32_bf16 v[192:195], v[64:67], v[176:179], v[192:195]
    ds_read_b64_tr_b16 v[88:89], v52 offset:24576
    v_mfma_f32_16x16x32_bf16 v[224:227], v[64:67], v[180:183], v[224:227]
    ds_read_b64_tr_b16 v[90:91], v52 offset:28672
    v_mfma_f32_16x16x32_bf16 v[196:199], v[68:71], v[176:179], v[196:199]
    ds_read_b64_tr_b16 v[92:93], v53 offset:24576
    v_mfma_f32_16x16x32_bf16 v[228:231], v[68:71], v[180:183], v[228:231]
    ds_read_b64_tr_b16 v[94:95], v53 offset:28672
    s_waitcnt lgkmcnt(12)
    v_mfma_f32_16x16x32_bf16 v[200:203], v[72:75], v[176:179], v[200:203]
    ds_read_b64_tr_b16 v[64:65], v54 offset:16384
    v_mfma_f32_16x16x32_bf16 v[232:235], v[72:75], v[180:183], v[232:235]
    ds_read_b64_tr_b16 v[66:67], v54 offset:20480
    v_mfma_f32_16x16x32_bf16 v[204:207], v[76:79], v[176:179], v[204:207]
    ds_read_b64_tr_b16 v[68:69], v55 offset:16384
    v_mfma_f32_16x16x32_bf16 v[236:239], v[76:79], v[180:183], v[236:239]
    ds_read_b64_tr_b16 v[70:71], v55 offset:20480
    s_waitcnt lgkmcnt(8)
    s_waitcnt vmcnt(0)
    v_mfma_f32_16x16x32_bf16 v[192:195], v[80:83], v[184:187], v[192:195]
    ds_read_b64_tr_b16 v[72:73], v56 offset:16384
    v_mfma_f32_16x16x32_bf16 v[224:227], v[80:83], v[188:191], v[224:227]
    ds_read_b64_tr_b16 v[74:75], v56 offset:20480
    v_mfma_f32_16x16x32_bf16 v[196:199], v[84:87], v[184:187], v[196:199]
    ds_read_b64_tr_b16 v[76:77], v57 offset:16384
    v_mfma_f32_16x16x32_bf16 v[228:231], v[84:87], v[188:191], v[228:231]
    ds_read_b64_tr_b16 v[78:79], v57 offset:20480
    s_waitcnt lgkmcnt(8)
    v_mfma_f32_16x16x32_bf16 v[200:203], v[88:91], v[184:187], v[200:203]
    ds_read_b64_tr_b16 v[80:81], v54 offset:24576
    v_mfma_f32_16x16x32_bf16 v[232:235], v[88:91], v[188:191], v[232:235]
    ds_read_b64_tr_b16 v[82:83], v54 offset:28672
    v_xor_b32 v54, 65536, v54
    v_mfma_f32_16x16x32_bf16 v[204:207], v[92:95], v[184:187], v[204:207]
    ds_read_b64_tr_b16 v[84:85], v55 offset:24576
    v_mfma_f32_16x16x32_bf16 v[236:239], v[92:95], v[188:191], v[236:239]
    ds_read_b64_tr_b16 v[86:87], v55 offset:28672
    v_xor_b32 v55, 65536, v55
    s_waitcnt lgkmcnt(8)
    v_mfma_f32_16x16x32_bf16 v[208:211], v[64:67], v[144:147], v[208:211]
    ds_read_b64_tr_b16 v[88:89], v56 offset:24576
    v_mfma_f32_16x16x32_bf16 v[240:243], v[64:67], v[148:151], v[240:243]
    ds_read_b64_tr_b16 v[90:91], v56 offset:28672
    v_xor_b32 v56, 65536, v56
    v_mfma_f32_16x16x32_bf16 v[212:215], v[68:71], v[144:147], v[212:215]
    ds_read_b64_tr_b16 v[92:93], v57 offset:24576
    ds_write_b128 v20, v[224:227] offset:0
    v_mfma_f32_16x16x32_bf16 v[244:247], v[68:71], v[148:151], v[244:247]
    ds_read_b64_tr_b16 v[94:95], v57 offset:28672
    v_xor_b32 v57, 65536, v57
    ds_write_b128 v20, v[228:231] offset:1024
    s_waitcnt lgkmcnt(10)
    v_mfma_f32_16x16x32_bf16 v[216:219], v[72:75], v[144:147], v[216:219]
    ds_read_b64_tr_b16 v[64:65], v54 offset:0
    ds_write_b128 v20, v[232:235] offset:2048
    v_mfma_f32_16x16x32_bf16 v[248:251], v[72:75], v[148:151], v[248:251]
    ds_read_b64_tr_b16 v[66:67], v54 offset:4096
    ds_write_b128 v20, v[236:239] offset:3072
    v_mfma_f32_16x16x32_bf16 v[220:223], v[76:79], v[144:147], v[220:223]
    ds_read_b64_tr_b16 v[68:69], v55 offset:0
    v_mfma_f32_16x16x32_bf16 v[252:255], v[76:79], v[148:151], v[252:255]
    ds_read_b64_tr_b16 v[70:71], v55 offset:4096
    s_waitcnt lgkmcnt(12)
    v_mfma_f32_16x16x32_bf16 v[208:211], v[80:83], v[152:155], v[208:211]
    ds_read_b64_tr_b16 v[72:73], v56 offset:0
    v_mfma_f32_16x16x32_bf16 v[240:243], v[80:83], v[156:159], v[240:243]
    ds_read_b64_tr_b16 v[74:75], v56 offset:4096
    v_mfma_f32_16x16x32_bf16 v[212:215], v[84:87], v[152:155], v[212:215]
    ds_read_b64_tr_b16 v[76:77], v57 offset:0
    s_waitcnt lgkmcnt(5)
    s_barrier
    v_mfma_f32_16x16x32_bf16 v[244:247], v[84:87], v[156:159], v[244:247]
    ds_read_b64_tr_b16 v[78:79], v57 offset:4096
    ds_read_b128 v[224:227], v21 offset:0
    ds_read_b128 v[228:231], v21 offset:1024
    v_mfma_f32_16x16x32_bf16 v[216:219], v[88:91], v[152:155], v[216:219]
    ds_read_b64_tr_b16 v[80:81], v54 offset:8192
    ds_read_b128 v[232:235], v21 offset:2048
    ds_read_b128 v[236:239], v21 offset:3072
    v_mfma_f32_16x16x32_bf16 v[248:251], v[88:91], v[156:159], v[248:251]
    ds_read_b64_tr_b16 v[82:83], v54 offset:12288
    v_mfma_f32_16x16x32_bf16 v[220:223], v[92:95], v[152:155], v[220:223]
    ds_read_b64_tr_b16 v[84:85], v55 offset:8192
    v_mfma_f32_16x16x32_bf16 v[252:255], v[92:95], v[156:159], v[252:255]
    ds_read_b64_tr_b16 v[86:87], v55 offset:12288
    s_waitcnt lgkmcnt(12)
    v_mfma_f32_16x16x32_bf16 v[208:211], v[64:67], v[160:163], v[208:211]
    ds_read_b64_tr_b16 v[88:89], v56 offset:8192
    s_waitcnt lgkmcnt(8)
    v_add_f32 v192, v192, v224
    v_add_f32 v193, v193, v225
    v_mfma_f32_16x16x32_bf16 v[240:243], v[64:67], v[164:167], v[240:243]
    ds_read_b64_tr_b16 v[90:91], v56 offset:12288
    v_add_f32 v194, v194, v226
    v_add_f32 v195, v195, v227
    buffer_store_dwordx4 v[192:195], v18, s[24:27], s41 offen offset:0 sc1
    v_mfma_f32_16x16x32_bf16 v[212:215], v[68:71], v[160:163], v[212:215]
    ds_read_b64_tr_b16 v[92:93], v57 offset:8192
    s_waitcnt lgkmcnt(9)
    v_add_f32 v196, v196, v228
    v_add_f32 v197, v197, v229
    v_mfma_f32_16x16x32_bf16 v[244:247], v[68:71], v[164:167], v[244:247]
    ds_read_b64_tr_b16 v[94:95], v57 offset:12288
    v_add_f32 v198, v198, v230
    v_add_f32 v199, v199, v231
    buffer_store_dwordx4 v[196:199], v18, s[24:27], s41 offen offset:1024 sc1
    v_mfma_f32_16x16x32_bf16 v[216:219], v[72:75], v[160:163], v[216:219]
    ds_read_b64_tr_b16 v[64:65], v54 offset:16384
    s_waitcnt lgkmcnt(9)
    v_add_f32 v200, v200, v232
    v_add_f32 v201, v201, v233
    v_mfma_f32_16x16x32_bf16 v[248:251], v[72:75], v[164:167], v[248:251]
    ds_read_b64_tr_b16 v[66:67], v54 offset:20480
    v_add_f32 v202, v202, v234
    v_add_f32 v203, v203, v235
    buffer_store_dwordx4 v[200:203], v18, s[24:27], s41 offen offset:2048 sc1
    v_mfma_f32_16x16x32_bf16 v[220:223], v[76:79], v[160:163], v[220:223]
    ds_read_b64_tr_b16 v[68:69], v55 offset:16384
    s_waitcnt lgkmcnt(10)
    v_add_f32 v204, v204, v236
    v_add_f32 v205, v205, v237
    v_mfma_f32_16x16x32_bf16 v[252:255], v[76:79], v[164:167], v[252:255]
    ds_read_b64_tr_b16 v[70:71], v55 offset:20480
    v_add_f32 v206, v206, v238
    v_add_f32 v207, v207, v239
    buffer_store_dwordx4 v[204:207], v18, s[24:27], s41 offen offset:3072 sc1
    s_waitcnt lgkmcnt(8)
    v_mfma_f32_16x16x32_bf16 v[208:211], v[80:83], v[168:171], v[208:211]
    ds_read_b64_tr_b16 v[72:73], v56 offset:16384
    v_mfma_f32_16x16x32_bf16 v[240:243], v[80:83], v[172:175], v[240:243]
    ds_read_b64_tr_b16 v[74:75], v56 offset:20480
    v_mfma_f32_16x16x32_bf16 v[212:215], v[84:87], v[168:171], v[212:215]
    ds_read_b64_tr_b16 v[76:77], v57 offset:16384
    v_mfma_f32_16x16x32_bf16 v[244:247], v[84:87], v[172:175], v[244:247]
    ds_read_b64_tr_b16 v[78:79], v57 offset:20480
    s_waitcnt lgkmcnt(8)
    v_mfma_f32_16x16x32_bf16 v[216:219], v[88:91], v[168:171], v[216:219]
    ds_read_b64_tr_b16 v[80:81], v54 offset:24576
    v_mfma_f32_16x16x32_bf16 v[248:251], v[88:91], v[172:175], v[248:251]
    ds_read_b64_tr_b16 v[82:83], v54 offset:28672
    v_mfma_f32_16x16x32_bf16 v[220:223], v[92:95], v[168:171], v[220:223]
    ds_read_b64_tr_b16 v[84:85], v55 offset:24576
    v_mfma_f32_16x16x32_bf16 v[252:255], v[92:95], v[172:175], v[252:255]
    ds_read_b64_tr_b16 v[86:87], v55 offset:28672
    s_waitcnt lgkmcnt(8)
    v_mfma_f32_16x16x32_bf16 v[208:211], v[64:67], v[176:179], v[208:211]
    ds_read_b64_tr_b16 v[88:89], v56 offset:24576
    v_mfma_f32_16x16x32_bf16 v[240:243], v[64:67], v[180:183], v[240:243]
    ds_read_b64_tr_b16 v[90:91], v56 offset:28672
    v_mfma_f32_16x16x32_bf16 v[212:215], v[68:71], v[176:179], v[212:215]
    ds_read_b64_tr_b16 v[92:93], v57 offset:24576
    v_mfma_f32_16x16x32_bf16 v[244:247], v[68:71], v[180:183], v[244:247]
    ds_read_b64_tr_b16 v[94:95], v57 offset:28672
    s_waitcnt lgkmcnt(8)
    v_mfma_f32_16x16x32_bf16 v[216:219], v[72:75], v[176:179], v[216:219]
    v_mfma_f32_16x16x32_bf16 v[248:251], v[72:75], v[180:183], v[248:251]
    v_mfma_f32_16x16x32_bf16 v[220:223], v[76:79], v[176:179], v[220:223]
    v_mfma_f32_16x16x32_bf16 v[252:255], v[76:79], v[180:183], v[252:255]
    s_waitcnt lgkmcnt(4)
    v_mfma_f32_16x16x32_bf16 v[208:211], v[80:83], v[184:187], v[208:211]
    v_mfma_f32_16x16x32_bf16 v[240:243], v[80:83], v[188:191], v[240:243]
    v_mfma_f32_16x16x32_bf16 v[212:215], v[84:87], v[184:187], v[212:215]
    s_lshr_b32 s36, s28, 2
    s_lshl_b32 s36, s36, 15
    s_and_b32 s37, s28, 3
    v_mfma_f32_16x16x32_bf16 v[244:247], v[84:87], v[188:191], v[244:247]
    s_lshl_b32 s37, s37, 12
    s_add_u32 s36, s36, s37
    s_add_u32 s36, s36, 65536
    s_waitcnt lgkmcnt(0)
    v_mfma_f32_16x16x32_bf16 v[216:219], v[88:91], v[184:187], v[216:219]
    v_add_u32 v20, s36, v22
    v_xor_b32 v21, 32768, v20
    v_mfma_f32_16x16x32_bf16 v[248:251], v[88:91], v[188:191], v[248:251]
    v_mfma_f32_16x16x32_bf16 v[220:223], v[92:95], v[184:187], v[220:223]
    v_mfma_f32_16x16x32_bf16 v[252:255], v[92:95], v[188:191], v[252:255]
    s_waitcnt vmcnt(0)
    v_mov_b32 v4, s40
    v_mov_b32 v13, 1
    s_mov_b64 exec, 1
    global_atomic_add v4, v13, s[90:91]
    s_mov_b64 exec, -1
    s_nop 3
    s_nop 4
    ds_write_b128 v20, v[240:243] offset:0
    ds_write_b128 v20, v[244:247] offset:1024
    ds_write_b128 v20, v[248:251] offset:2048
    ds_write_b128 v20, v[252:255] offset:3072
    v_lshlrev_b32 v96, 16, v40
    v_and_b32 v97, 0xffff0000, v40
    v_sub_f32 v112, v96, v48
    v_sub_f32 v113, v97, v48
    v_cvt_pk_bf16_f32 v10, v112, v113
    v_lshlrev_b32 v112, 16, v10
    v_and_b32 v113, 0xffff0000, v10
    v_mul_f32 v112, v112, v49
    v_mul_f32 v113, v113, v49
    v_cvt_pk_bf16_f32 v10, v112, v113
    v_lshlrev_b32 v112, 16, v10
    v_and_b32 v113, 0xffff0000, v10
    v_mul_f32 v11, 0xbfb8aa3b, v112
    v_mul_f32 v12, 0xbfb8aa3b, v113
    v_exp_f32 v11, v11
    v_exp_f32 v12, v12
    s_nop 0
    v_add_f32 v11, 1.0, v11
    v_add_f32 v12, 1.0, v12
    v_rcp_f32 v11, v11
    v_rcp_f32 v12, v12
    s_nop 0
    v_mul_f32 v112, v112, v11
    v_mul_f32 v113, v113, v12
    v_cvt_pk_bf16_f32 v10, v112, v113
    v_lshlrev_b32 v112, 16, v10
    v_and_b32 v113, 0xffff0000, v10
    v_lshlrev_b32 v98, 16, v41
    v_and_b32 v99, 0xffff0000, v41
    v_sub_f32 v114, v98, v48
    v_sub_f32 v115, v99, v48
    v_cvt_pk_bf16_f32 v10, v114, v115
    v_lshlrev_b32 v114, 16, v10
    v_and_b32 v115, 0xffff0000, v10
    v_mul_f32 v114, v114, v49
    v_mul_f32 v115, v115, v49
    v_cvt_pk_bf16_f32 v10, v114, v115
    v_lshlrev_b32 v114, 16, v10
    v_and_b32 v115, 0xffff0000, v10
    v_mul_f32 v11, 0xbfb8aa3b, v114
    v_mul_f32 v12, 0xbfb8aa3b, v115
    v_exp_f32 v11, v11
    v_exp_f32 v12, v12
    s_nop 0
    v_add_f32 v11, 1.0, v11
    v_add_f32 v12, 1.0, v12
    v_rcp_f32 v11, v11
    v_rcp_f32 v12, v12
    s_nop 0
    v_mul_f32 v114, v114, v11
    v_mul_f32 v115, v115, v12
    v_cvt_pk_bf16_f32 v10, v114, v115
    v_lshlrev_b32 v114, 16, v10
    v_and_b32 v115, 0xffff0000, v10
    v_lshlrev_b32 v100, 16, v42
    v_and_b32 v101, 0xffff0000, v42
    v_sub_f32 v116, v100, v48
    v_sub_f32 v117, v101, v48
    v_cvt_pk_bf16_f32 v10, v116, v117
    v_lshlrev_b32 v116, 16, v10
    v_and_b32 v117, 0xffff0000, v10
    v_mul_f32 v116, v116, v49
    v_mul_f32 v117, v117, v49
    v_cvt_pk_bf16_f32 v10, v116, v117
    v_lshlrev_b32 v116, 16, v10
    v_and_b32 v117, 0xffff0000, v10
    v_mul_f32 v11, 0xbfb8aa3b, v116
    v_mul_f32 v12, 0xbfb8aa3b, v117
    v_exp_f32 v11, v11
    v_exp_f32 v12, v12
    s_nop 0
    v_add_f32 v11, 1.0, v11
    v_add_f32 v12, 1.0, v12
    v_rcp_f32 v11, v11
    v_rcp_f32 v12, v12
    s_nop 0
    v_mul_f32 v116, v116, v11
    v_mul_f32 v117, v117, v12
    v_cvt_pk_bf16_f32 v10, v116, v117
    v_lshlrev_b32 v116, 16, v10
    v_and_b32 v117, 0xffff0000, v10
    v_lshlrev_b32 v102, 16, v43
    v_and_b32 v103, 0xffff0000, v43
    v_sub_f32 v118, v102, v48
    v_sub_f32 v119, v103, v48
    v_cvt_pk_bf16_f32 v10, v118, v119
    v_lshlrev_b32 v118, 16, v10
    v_and_b32 v119, 0xffff0000, v10
    v_mul_f32 v118, v118, v49
    v_mul_f32 v119, v119, v49
    v_cvt_pk_bf16_f32 v10, v118, v119
    v_lshlrev_b32 v118, 16, v10
    v_and_b32 v119, 0xffff0000, v10
    v_mul_f32 v11, 0xbfb8aa3b, v118
    v_mul_f32 v12, 0xbfb8aa3b, v119
    v_exp_f32 v11, v11
    v_exp_f32 v12, v12
    s_nop 0
    v_add_f32 v11, 1.0, v11
    v_add_f32 v12, 1.0, v12
    v_rcp_f32 v11, v11
    v_rcp_f32 v12, v12
    s_nop 0
    v_mul_f32 v118, v118, v11
    v_mul_f32 v119, v119, v12
    v_cvt_pk_bf16_f32 v10, v118, v119
    v_lshlrev_b32 v118, 16, v10
    v_and_b32 v119, 0xffff0000, v10
    s_cmp_eq_u32 s28, 3
    s_cbranch_scc1 L_recurrent_scan__compressed_kv_cla__moe_arch_mod__prompt_kernel_rare_207
L_recurrent_scan__compressed_kv_cla__moe_arch_mod__prompt_kernel_back_208:
    s_waitcnt lgkmcnt(0)
    s_barrier
    buffer_load_dwordx4 v[64:67], v18, s[24:27], s39 offen offset:0 sc1
    buffer_load_dwordx4 v[68:71], v18, s[24:27], s39 offen offset:1024 sc1
    buffer_load_dwordx4 v[72:75], v18, s[24:27], s39 offen offset:2048 sc1
    buffer_load_dwordx4 v[76:79], v18, s[24:27], s39 offen offset:3072 sc1
    ds_read_b128 v[128:131], v21 offset:0
    ds_read_b128 v[132:135], v21 offset:1024
    ds_read_b128 v[136:139], v21 offset:2048
    ds_read_b128 v[140:143], v21 offset:3072
    s_waitcnt lgkmcnt(3)
    v_pk_add_f32 v[128:129], v[128:129], v[208:209]
    v_pk_add_f32 v[130:131], v[130:131], v[210:211]
    s_waitcnt lgkmcnt(2)
    v_pk_add_f32 v[132:133], v[132:133], v[212:213]
    v_pk_add_f32 v[134:135], v[134:135], v[214:215]
    s_waitcnt lgkmcnt(1)
    v_pk_add_f32 v[136:137], v[136:137], v[216:217]
    v_pk_add_f32 v[138:139], v[138:139], v[218:219]
    s_waitcnt lgkmcnt(0)
    v_pk_add_f32 v[140:141], v[140:141], v[220:221]
    v_pk_add_f32 v[142:143], v[142:143], v[222:223]
    v_lshlrev_b32 v104, 16, v44
    v_and_b32 v105, 0xffff0000, v44
    v_sub_f32 v120, v104, v48
    v_sub_f32 v121, v105, v48
    v_cvt_pk_bf16_f32 v10, v120, v121
    v_lshlrev_b32 v120, 16, v10
    v_and_b32 v121, 0xffff0000, v10
    v_mul_f32 v120, v120, v49
    v_mul_f32 v121, v121, v49
    v_cvt_pk_bf16_f32 v10, v120, v121
    v_lshlrev_b32 v120, 16, v10
    v_and_b32 v121, 0xffff0000, v10
    v_mul_f32 v11, 0xbfb8aa3b, v120
    v_mul_f32 v12, 0xbfb8aa3b, v121
    v_exp_f32 v11, v11
    v_exp_f32 v12, v12
    s_nop 0
    v_add_f32 v11, 1.0, v11
    v_add_f32 v12, 1.0, v12
    v_rcp_f32 v11, v11
    v_rcp_f32 v12, v12
    s_nop 0
    v_mul_f32 v120, v120, v11
    v_mul_f32 v121, v121, v12
    v_cvt_pk_bf16_f32 v10, v120, v121
    v_lshlrev_b32 v120, 16, v10
    v_and_b32 v121, 0xffff0000, v10
    v_lshlrev_b32 v106, 16, v45
    v_and_b32 v107, 0xffff0000, v45
    v_sub_f32 v122, v106, v48
    v_sub_f32 v123, v107, v48
    v_cvt_pk_bf16_f32 v10, v122, v123
    v_lshlrev_b32 v122, 16, v10
    v_and_b32 v123, 0xffff0000, v10
    v_mul_f32 v122, v122, v49
    v_mul_f32 v123, v123, v49
    v_cvt_pk_bf16_f32 v10, v122, v123
    v_lshlrev_b32 v122, 16, v10
    v_and_b32 v123, 0xffff0000, v10
    v_mul_f32 v11, 0xbfb8aa3b, v122
    v_mul_f32 v12, 0xbfb8aa3b, v123
    v_exp_f32 v11, v11
    v_exp_f32 v12, v12
    s_nop 0
    v_add_f32 v11, 1.0, v11
    v_add_f32 v12, 1.0, v12
    v_rcp_f32 v11, v11
    v_rcp_f32 v12, v12
    s_nop 0
    v_mul_f32 v122, v122, v11
    v_mul_f32 v123, v123, v12
    v_cvt_pk_bf16_f32 v10, v122, v123
    v_lshlrev_b32 v122, 16, v10
    v_and_b32 v123, 0xffff0000, v10
    v_lshlrev_b32 v108, 16, v46
    v_and_b32 v109, 0xffff0000, v46
    v_sub_f32 v124, v108, v48
    v_sub_f32 v125, v109, v48
    v_cvt_pk_bf16_f32 v10, v124, v125
    v_lshlrev_b32 v124, 16, v10
    v_and_b32 v125, 0xffff0000, v10
    v_mul_f32 v124, v124, v49
    v_mul_f32 v125, v125, v49
    v_cvt_pk_bf16_f32 v10, v124, v125
    v_lshlrev_b32 v124, 16, v10
    v_and_b32 v125, 0xffff0000, v10
    v_mul_f32 v11, 0xbfb8aa3b, v124
    v_mul_f32 v12, 0xbfb8aa3b, v125
    v_exp_f32 v11, v11
    v_exp_f32 v12, v12
    s_nop 0
    v_add_f32 v11, 1.0, v11
    v_add_f32 v12, 1.0, v12
    v_rcp_f32 v11, v11
    v_rcp_f32 v12, v12
    s_nop 0
    v_mul_f32 v124, v124, v11
    v_mul_f32 v125, v125, v12
    v_cvt_pk_bf16_f32 v10, v124, v125
    v_lshlrev_b32 v124, 16, v10
    v_and_b32 v125, 0xffff0000, v10
    v_lshlrev_b32 v110, 16, v47
    v_and_b32 v111, 0xffff0000, v47
    v_sub_f32 v126, v110, v48
    v_sub_f32 v127, v111, v48
    v_cvt_pk_bf16_f32 v10, v126, v127
    v_lshlrev_b32 v126, 16, v10
    v_and_b32 v127, 0xffff0000, v10
    v_mul_f32 v126, v126, v49
    v_mul_f32 v127, v127, v49
    v_cvt_pk_bf16_f32 v10, v126, v127
    v_lshlrev_b32 v126, 16, v10
    v_and_b32 v127, 0xffff0000, v10
    v_mul_f32 v11, 0xbfb8aa3b, v126
    v_mul_f32 v12, 0xbfb8aa3b, v127
    v_exp_f32 v11, v11
    v_exp_f32 v12, v12
    s_nop 0
    v_add_f32 v11, 1.0, v11
    v_add_f32 v12, 1.0, v12
    v_rcp_f32 v11, v11
    v_rcp_f32 v12, v12
    s_nop 0
    v_mul_f32 v126, v126, v11
    v_mul_f32 v127, v127, v12
    v_cvt_pk_bf16_f32 v10, v126, v127
    v_lshlrev_b32 v126, 16, v10
    v_and_b32 v127, 0xffff0000, v10
    s_sub_u32 s36, s56, s38
    s_sub_u32 s37, s57, s38
    s_min_u32 s36, s36, s37
    s_cmp_lt_u32 s36, 16
    s_cbranch_scc1 L_recurrent_scan__compressed_kv_cla__moe_arch_mod__prompt_kernel_rare_209
L_recurrent_scan__compressed_kv_cla__moe_arch_mod__prompt_kernel_back_210:
    s_waitcnt vmcnt(3)
    v_pk_add_f32 v[128:129], v[128:129], v[64:65]
    v_cvt_pk_bf16_f32 v23, v128, v129
    v_lshlrev_b32 v128, 16, v23
    v_and_b32 v129, 0xffff0000, v23
    v_pk_mul_f32 v[128:129], v[128:129], v[112:113]
    v_cvt_pk_bf16_f32 v23, v128, v129
    v_lshlrev_b32 v128, 16, v23
    v_and_b32 v129, 0xffff0000, v23
    v_pk_add_f32 v[128:129], v[128:129], v[96:97]
    v_cvt_pk_bf16_f32 v80, v128, v129
    v_pk_add_f32 v[130:131], v[130:131], v[66:67]
    v_cvt_pk_bf16_f32 v23, v130, v131
    v_lshlrev_b32 v130, 16, v23
    v_and_b32 v131, 0xffff0000, v23
    v_pk_mul_f32 v[130:131], v[130:131], v[114:115]
    v_cvt_pk_bf16_f32 v23, v130, v131
    v_lshlrev_b32 v130, 16, v23
    v_and_b32 v131, 0xffff0000, v23
    v_pk_add_f32 v[130:131], v[130:131], v[98:99]
    v_cvt_pk_bf16_f32 v81, v130, v131
    ds_write_b64 v63, v[80:81] offset:0
    s_waitcnt vmcnt(2)
    v_pk_add_f32 v[132:133], v[132:133], v[68:69]
    v_cvt_pk_bf16_f32 v23, v132, v133
    v_lshlrev_b32 v132, 16, v23
    v_and_b32 v133, 0xffff0000, v23
    v_pk_mul_f32 v[132:133], v[132:133], v[116:117]
    v_cvt_pk_bf16_f32 v23, v132, v133
    v_lshlrev_b32 v132, 16, v23
    v_and_b32 v133, 0xffff0000, v23
    v_pk_add_f32 v[132:133], v[132:133], v[100:101]
    v_cvt_pk_bf16_f32 v82, v132, v133
    v_pk_add_f32 v[134:135], v[134:135], v[70:71]
    v_cvt_pk_bf16_f32 v23, v134, v135
    v_lshlrev_b32 v134, 16, v23
    v_and_b32 v135, 0xffff0000, v23
    v_pk_mul_f32 v[134:135], v[134:135], v[118:119]
    v_cvt_pk_bf16_f32 v23, v134, v135
    v_lshlrev_b32 v134, 16, v23
    v_and_b32 v135, 0xffff0000, v23
    v_pk_add_f32 v[134:135], v[134:135], v[102:103]
    v_cvt_pk_bf16_f32 v83, v134, v135
    ds_write_b64 v63, v[82:83] offset:32
    s_waitcnt vmcnt(1)
    v_pk_add_f32 v[136:137], v[136:137], v[72:73]
    v_cvt_pk_bf16_f32 v23, v136, v137
    v_lshlrev_b32 v136, 16, v23
    v_and_b32 v137, 0xffff0000, v23
    v_pk_mul_f32 v[136:137], v[136:137], v[120:121]
    v_cvt_pk_bf16_f32 v23, v136, v137
    v_lshlrev_b32 v136, 16, v23
    v_and_b32 v137, 0xffff0000, v23
    v_pk_add_f32 v[136:137], v[136:137], v[104:105]
    v_cvt_pk_bf16_f32 v84, v136, v137
    v_pk_add_f32 v[138:139], v[138:139], v[74:75]
    v_cvt_pk_bf16_f32 v23, v138, v139
    v_lshlrev_b32 v138, 16, v23
    v_and_b32 v139, 0xffff0000, v23
    v_pk_mul_f32 v[138:139], v[138:139], v[122:123]
    v_cvt_pk_bf16_f32 v23, v138, v139
    v_lshlrev_b32 v138, 16, v23
    v_and_b32 v139, 0xffff0000, v23
    v_pk_add_f32 v[138:139], v[138:139], v[106:107]
    v_cvt_pk_bf16_f32 v85, v138, v139
    ds_write_b64 v63, v[84:85] offset:64
    s_waitcnt vmcnt(0)
    v_pk_add_f32 v[140:141], v[140:141], v[76:77]
    v_cvt_pk_bf16_f32 v23, v140, v141
    v_lshlrev_b32 v140, 16, v23
    v_and_b32 v141, 0xffff0000, v23
    v_pk_mul_f32 v[140:141], v[140:141], v[124:125]
    v_cvt_pk_bf16_f32 v23, v140, v141
    v_lshlrev_b32 v140, 16, v23
    v_and_b32 v141, 0xffff0000, v23
    v_pk_add_f32 v[140:141], v[140:141], v[108:109]
    v_cvt_pk_bf16_f32 v86, v140, v141
    v_pk_add_f32 v[142:143], v[142:143], v[78:79]
    v_cvt_pk_bf16_f32 v23, v142, v143
    v_lshlrev_b32 v142, 16, v23
    v_and_b32 v143, 0xffff0000, v23
    v_pk_mul_f32 v[142:143], v[142:143], v[126:127]
    v_cvt_pk_bf16_f32 v23, v142, v143
    v_lshlrev_b32 v142, 16, v23
    v_and_b32 v143, 0xffff0000, v23
    v_pk_add_f32 v[142:143], v[142:143], v[110:111]
    v_cvt_pk_bf16_f32 v87, v142, v143
    ds_write_b64 v63, v[86:87] offset:96
    v_add_u32 v22, s42, v22
    s_mov_b32 s36, 16384
    s_waitcnt lgkmcnt(0)
    ds_read_b128 v[64:67], v22
    ds_read_b128 v[68:71], v22 offset:1024
    s_waitcnt lgkmcnt(1)
    buffer_store_dwordx4 v[64:67], v15, s[20:23], 0 offen sc1
    s_waitcnt lgkmcnt(0)
    buffer_store_dwordx4 v[68:71], v15, s[20:23], s36 offen sc1
    s_endpgm
L_recurrent_scan__compressed_kv_cla__moe_arch_mod__prompt_kernel_rare_170:
    v_mov_b32 v26, s40
    v_mov_b32 v28, 1
    v_writelane_b32 v26, s41, 1
    s_mov_b64 exec, 3
    global_atomic_add v26, v28, s[90:91]
    s_mov_b64 exec, -1
    s_branch L_recurrent_scan__compressed_kv_cla__moe_arch_mod__prompt_kernel_back_171
L_recurrent_scan__compressed_kv_cla__moe_arch_mod__prompt_kernel_rare_174:
    s_and_b32 s36, s2, 15
    s_add_u32 s36, s36, 96
    s_lshl_b32 s36, s36, 7
    v_mov_b32 v26, s36
    v_mov_b32 v27, 1
    s_mov_b64 exec, 1
    global_atomic_add v26, v27, s[90:91]
    s_mov_b64 exec, -1
    s_nop 3
    s_branch L_recurrent_scan__compressed_kv_cla__moe_arch_mod__prompt_kernel_back_175
L_recurrent_scan__compressed_kv_cla__moe_arch_mod__prompt_kernel_rare_176:
    global_load_dword v59, v58, s[90:91] sc1
    s_branch L_recurrent_scan__compressed_kv_cla__moe_arch_mod__prompt_kernel_back_177
L_recurrent_scan__compressed_kv_cla__moe_arch_mod__prompt_kernel_rare_181:
    s_mov_b32 s61, 0x40000
    s_waitcnt vmcnt(7)
    s_branch L_recurrent_scan__compressed_kv_cla__moe_arch_mod__prompt_kernel_cchk_180
L_recurrent_scan__compressed_kv_cla__moe_arch_mod__prompt_kernel_cspin_178:
    s_sub_u32 s61, s61, 1
    s_cbranch_scc1 L_recurrent_scan__compressed_kv_cla__moe_arch_mod__prompt_kernel_cspinx_179
    global_load_dword v59, v58, s[90:91] sc1
    s_waitcnt vmcnt(0)
L_recurrent_scan__compressed_kv_cla__moe_arch_mod__prompt_kernel_cchk_180:
    v_cmp_le_u32 vcc, 4, v59
    s_nop 0
    s_and_b32 s60, vcc_lo, 31
    s_and_b32 s36, s60, s44
    s_cmp_eq_u32 s36, s44
    s_cbranch_scc1 L_recurrent_scan__compressed_kv_cla__moe_arch_mod__prompt_kernel_cspinx_179
    s_sleep 6
    s_branch L_recurrent_scan__compressed_kv_cla__moe_arch_mod__prompt_kernel_cspin_178
L_recurrent_scan__compressed_kv_cla__moe_arch_mod__prompt_kernel_cspinx_179:
    s_lshl_b32 s44, s44, 1
    s_or_b32 s44, s44, 1
    s_and_b32 s44, s44, 31
    s_branch L_recurrent_scan__compressed_kv_cla__moe_arch_mod__prompt_kernel_back_182
L_recurrent_scan__compressed_kv_cla__moe_arch_mod__prompt_kernel_rare_183:
    global_load_dword v59, v58, s[90:91] sc1
    s_branch L_recurrent_scan__compressed_kv_cla__moe_arch_mod__prompt_kernel_back_184
L_recurrent_scan__compressed_kv_cla__moe_arch_mod__prompt_kernel_rare_188:
    s_mov_b32 s61, 0x40000
    s_waitcnt vmcnt(7)
    s_branch L_recurrent_scan__compressed_kv_cla__moe_arch_mod__prompt_kernel_cchk_187
L_recurrent_scan__compressed_kv_cla__moe_arch_mod__prompt_kernel_cspin_185:
    s_sub_u32 s61, s61, 1
    s_cbranch_scc1 L_recurrent_scan__compressed_kv_cla__moe_arch_mod__prompt_kernel_cspinx_186
    global_load_dword v59, v58, s[90:91] sc1
    s_waitcnt vmcnt(0)
L_recurrent_scan__compressed_kv_cla__moe_arch_mod__prompt_kernel_cchk_187:
    v_cmp_le_u32 vcc, 4, v59
    s_nop 0
    s_and_b32 s60, vcc_lo, 31
    s_and_b32 s36, s60, s44
    s_cmp_eq_u32 s36, s44
    s_cbranch_scc1 L_recurrent_scan__compressed_kv_cla__moe_arch_mod__prompt_kernel_cspinx_186
    s_sleep 6
    s_branch L_recurrent_scan__compressed_kv_cla__moe_arch_mod__prompt_kernel_cspin_185
L_recurrent_scan__compressed_kv_cla__moe_arch_mod__prompt_kernel_cspinx_186:
    s_lshl_b32 s44, s44, 1
    s_or_b32 s44, s44, 1
    s_and_b32 s44, s44, 31
    s_branch L_recurrent_scan__compressed_kv_cla__moe_arch_mod__prompt_kernel_back_189
L_recurrent_scan__compressed_kv_cla__moe_arch_mod__prompt_kernel_rare_190:
    s_add_u32 s36, s30, 96
    s_lshl_b32 s36, s36, 7
    v_mov_b32 v60, s36
    global_load_dword v61, v60, s[90:91] sc1
    s_branch L_recurrent_scan__compressed_kv_cla__moe_arch_mod__prompt_kernel_back_191
L_recurrent_scan__compressed_kv_cla__moe_arch_mod__prompt_kernel_rt1_rare_3:
    s_mov_b32 s61, 0x40000
L_recurrent_scan__compressed_kv_cla__moe_arch_mod__prompt_kernel_rt1_spin_1:
    s_sub_u32 s61, s61, 1
    s_cbranch_scc1 L_recurrent_scan__compressed_kv_cla__moe_arch_mod__prompt_kernel_rt1_spinx_2
    s_sleep 1
    global_load_dword v61, v60, s[90:91] sc1
    s_waitcnt vmcnt(0)
    v_readfirstlane_b32 s36, v61
    s_nop 0
    s_cmp_lt_u32 s36, 16
    s_cbranch_scc1 L_recurrent_scan__compressed_kv_cla__moe_arch_mod__prompt_kernel_rt1_spin_1
L_recurrent_scan__compressed_kv_cla__moe_arch_mod__prompt_kernel_rt1_spinx_2:
    s_branch L_recurrent_scan__compressed_kv_cla__moe_arch_mod__prompt_kernel_rt1_back_4
L_recurrent_scan__compressed_kv_cla__moe_arch_mod__prompt_kernel_rare_192:
    s_waitcnt vmcnt(14)
    v_readfirstlane_b32 s36, v61
    s_nop 0
    s_cmp_lt_u32 s36, 16
    s_cbranch_scc1 L_recurrent_scan__compressed_kv_cla__moe_arch_mod__prompt_kernel_rt1_rare_3
L_recurrent_scan__compressed_kv_cla__moe_arch_mod__prompt_kernel_rt1_back_4:
    s_lshl_b32 s37, s30, 8
    s_add_u32 s36, s37, 59768832
    s_add_u32 s37, s36, 4096
    v_and_b32 v60, 15, v1
    v_lshlrev_b32 v60, 13, v60
    v_lshl_add_u32 v60, v19, 4, v60
    buffer_load_dwordx4 v[96:99], v60, s[24:27], s36 offen offset:0 sc1
    buffer_load_dwordx4 v[100:103], v60, s[24:27], s36 offen offset:64 sc1
    buffer_load_dwordx4 v[104:107], v60, s[24:27], s36 offen offset:128 sc1
    buffer_load_dwordx4 v[108:111], v60, s[24:27], s36 offen offset:192 sc1
    buffer_load_dwordx4 v[112:115], v60, s[24:27], s37 offen offset:0 sc1
    buffer_load_dwordx4 v[116:119], v60, s[24:27], s37 offen offset:64 sc1
    buffer_load_dwordx4 v[120:123], v60, s[24:27], s37 offen offset:128 sc1
    buffer_load_dwordx4 v[124:127], v60, s[24:27], s37 offen offset:192 sc1
    s_branch L_recurrent_scan__compressed_kv_cla__moe_arch_mod__prompt_kernel_back_193
L_recurrent_scan__compressed_kv_cla__moe_arch_mod__prompt_kernel_rare_194:
    v_mov_b64 v[24:25], 0
    v_mov_b64 v[26:27], 0
    v_mov_b64 v[28:29], 0
    v_mov_b64 v[30:31], 0
    v_mov_b64 v[32:33], 0
    v_mov_b64 v[34:35], 0
    v_mov_b64 v[36:37], 0
    v_mov_b64 v[38:39], 0
    s_waitcnt vmcnt(14)
    s_sub_u32 s36, s56, s38
    s_cmp_lt_u32 s36, 16
    s_cbranch_scc0 L_recurrent_scan__compressed_kv_cla__moe_arch_mod__prompt_kernel_rt2_noy_1
    s_and_b32 s36, s58, 0xffff0000
    s_cmp_lt_i32 s36, 0
    s_cselect_b32 s37, 0x80000000, -1
    s_xor_b32 s36, s36, s37
    s_and_b32 s36, s36, 0xffff0000
    v_mov_b32 v62, s36
    v_mul_f32 v62, 0xbfb8aa3b, v62
    v_exp_f32 v62, v62
    s_nop 0
    v_add_f32 v62, 1.0, v62
    v_rcp_f32 v62, v62
    s_nop 0
    v_cvt_pk_bf16_f32 v62, v62, v62
    v_lshlrev_b32 v62, 16, v62
    v_add_f32_dpp v96, v96, v96 quad_perm:[1,0,3,2] row_mask:0xf bank_mask:0xf
    v_add_f32_dpp v97, v97, v97 quad_perm:[1,0,3,2] row_mask:0xf bank_mask:0xf
    v_add_f32_dpp v98, v98, v98 quad_perm:[1,0,3,2] row_mask:0xf bank_mask:0xf
    v_add_f32_dpp v99, v99, v99 quad_perm:[1,0,3,2] row_mask:0xf bank_mask:0xf
    v_add_f32_dpp v100, v100, v100 quad_perm:[1,0,3,2] row_mask:0xf bank_mask:0xf
    v_add_f32_dpp v101, v101, v101 quad_perm:[1,0,3,2] row_mask:0xf bank_mask:0xf
    v_add_f32_dpp v102, v102, v102 quad_perm:[1,0,3,2] row_mask:0xf bank_mask:0xf
    v_add_f32_dpp v103, v103, v103 quad_perm:[1,0,3,2] row_mask:0xf bank_mask:0xf
    v_add_f32_dpp v104, v104, v104 quad_perm:[1,0,3,2] row_mask:0xf bank_mask:0xf
    v_add_f32_dpp v105, v105, v105 quad_perm:[1,0,3,2] row_mask:0xf bank_mask:0xf
    v_add_f32_dpp v106, v106, v106 quad_perm:[1,0,3,2] row_mask:0xf bank_mask:0xf
    v_add_f32_dpp v107, v107, v107 quad_perm:[1,0,3,2] row_mask:0xf bank_mask:0xf
    v_add_f32_dpp v108, v108, v108 quad_perm:[1,0,3,2] row_mask:0xf bank_mask:0xf
    v_add_f32_dpp v109, v109, v109 quad_perm:[1,0,3,2] row_mask:0xf bank_mask:0xf
    v_add_f32_dpp v110, v110, v110 quad_perm:[1,0,3,2] row_mask:0xf bank_mask:0xf
    v_add_f32_dpp v111, v111, v111 quad_perm:[1,0,3,2] row_mask:0xf bank_mask:0xf
    v_add_f32_dpp v96, v96, v96 quad_perm:[2,3,0,1] row_mask:0xf bank_mask:0xf
    v_add_f32_dpp v97, v97, v97 quad_perm:[2,3,0,1] row_mask:0xf bank_mask:0xf
    v_add_f32_dpp v98, v98, v98 quad_perm:[2,3,0,1] row_mask:0xf bank_mask:0xf
    v_add_f32_dpp v99, v99, v99 quad_perm:[2,3,0,1] row_mask:0xf bank_mask:0xf
    v_add_f32_dpp v100, v100, v100 quad_perm:[2,3,0,1] row_mask:0xf bank_mask:0xf
    v_add_f32_dpp v101, v101, v101 quad_perm:[2,3,0,1] row_mask:0xf bank_mask:0xf
    v_add_f32_dpp v102, v102, v102 quad_perm:[2,3,0,1] row_mask:0xf bank_mask:0xf
    v_add_f32_dpp v103, v103, v103 quad_perm:[2,3,0,1] row_mask:0xf bank_mask:0xf
    v_add_f32_dpp v104, v104, v104 quad_perm:[2,3,0,1] row_mask:0xf bank_mask:0xf
    v_add_f32_dpp v105, v105, v105 quad_perm:[2,3,0,1] row_mask:0xf bank_mask:0xf
    v_add_f32_dpp v106, v106, v106 quad_perm:[2,3,0,1] row_mask:0xf bank_mask:0xf
    v_add_f32_dpp v107, v107, v107 quad_perm:[2,3,0,1] row_mask:0xf bank_mask:0xf
    v_add_f32_dpp v108, v108, v108 quad_perm:[2,3,0,1] row_mask:0xf bank_mask:0xf
    v_add_f32_dpp v109, v109, v109 quad_perm:[2,3,0,1] row_mask:0xf bank_mask:0xf
    v_add_f32_dpp v110, v110, v110 quad_perm:[2,3,0,1] row_mask:0xf bank_mask:0xf
    v_add_f32_dpp v111, v111, v111 quad_perm:[2,3,0,1] row_mask:0xf bank_mask:0xf
    v_add_f32_dpp v96, v96, v96 row_half_mirror row_mask:0xf bank_mask:0xf
    v_add_f32_dpp v97, v97, v97 row_half_mirror row_mask:0xf bank_mask:0xf
    v_add_f32_dpp v98, v98, v98 row_half_mirror row_mask:0xf bank_mask:0xf
    v_add_f32_dpp v99, v99, v99 row_half_mirror row_mask:0xf bank_mask:0xf
    v_add_f32_dpp v100, v100, v100 row_half_mirror row_mask:0xf bank_mask:0xf
    v_add_f32_dpp v101, v101, v101 row_half_mirror row_mask:0xf bank_mask:0xf
    v_add_f32_dpp v102, v102, v102 row_half_mirror row_mask:0xf bank_mask:0xf
    v_add_f32_dpp v103, v103, v103 row_half_mirror row_mask:0xf bank_mask:0xf
    v_add_f32_dpp v104, v104, v104 row_half_mirror row_mask:0xf bank_mask:0xf
    v_add_f32_dpp v105, v105, v105 row_half_mirror row_mask:0xf bank_mask:0xf
    v_add_f32_dpp v106, v106, v106 row_half_mirror row_mask:0xf bank_mask:0xf
    v_add_f32_dpp v107, v107, v107 row_half_mirror row_mask:0xf bank_mask:0xf
    v_add_f32_dpp v108, v108, v108 row_half_mirror row_mask:0xf bank_mask:0xf
    v_add_f32_dpp v109, v109, v109 row_half_mirror row_mask:0xf bank_mask:0xf
    v_add_f32_dpp v110, v110, v110 row_half_mirror row_mask:0xf bank_mask:0xf
    v_add_f32_dpp v111, v111, v111 row_half_mirror row_mask:0xf bank_mask:0xf
    v_add_f32_dpp v96, v96, v96 row_mirror row_mask:0xf bank_mask:0xf
    v_add_f32_dpp v97, v97, v97 row_mirror row_mask:0xf bank_mask:0xf
    v_add_f32_dpp v98, v98, v98 row_mirror row_mask:0xf bank_mask:0xf
    v_add_f32_dpp v99, v99, v99 row_mirror row_mask:0xf bank_mask:0xf
    v_add_f32_dpp v100, v100, v100 row_mirror row_mask:0xf bank_mask:0xf
    v_add_f32_dpp v101, v101, v101 row_mirror row_mask:0xf bank_mask:0xf
    v_add_f32_dpp v102, v102, v102 row_mirror row_mask:0xf bank_mask:0xf
    v_add_f32_dpp v103, v103, v103 row_mirror row_mask:0xf bank_mask:0xf
    v_add_f32_dpp v104, v104, v104 row_mirror row_mask:0xf bank_mask:0xf
    v_add_f32_dpp v105, v105, v105 row_mirror row_mask:0xf bank_mask:0xf
    v_add_f32_dpp v106, v106, v106 row_mirror row_mask:0xf bank_mask:0xf
    v_add_f32_dpp v107, v107, v107 row_mirror row_mask:0xf bank_mask:0xf
    v_add_f32_dpp v108, v108, v108 row_mirror row_mask:0xf bank_mask:0xf
    v_add_f32_dpp v109, v109, v109 row_mirror row_mask:0xf bank_mask:0xf
    v_add_f32_dpp v110, v110, v110 row_mirror row_mask:0xf bank_mask:0xf
    v_add_f32_dpp v111, v111, v111 row_mirror row_mask:0xf bank_mask:0xf
    v_cmp_eq_u32 vcc, s56, v14
    v_cvt_pk_bf16_f32 v61, v96, v97
    v_lshlrev_b32 v96, 16, v61
    v_and_b32 v97, 0xffff0000, v61
    v_mul_f32 v96, v62, v96
    v_mul_f32 v97, v62, v97
    v_cvt_pk_bf16_f32 v61, v96, v97
    v_lshlrev_b32 v96, 16, v61
    v_and_b32 v97, 0xffff0000, v61
    v_cndmask_b32 v24, v24, v96, vcc
    v_cndmask_b32 v25, v25, v97, vcc
    v_cvt_pk_bf16_f32 v61, v98, v99
    v_lshlrev_b32 v98, 16, v61
    v_and_b32 v99, 0xffff0000, v61
    v_mul_f32 v98, v62, v98
    v_mul_f32 v99, v62, v99
    v_cvt_pk_bf16_f32 v61, v98, v99
    v_lshlrev_b32 v98, 16, v61
    v_and_b32 v99, 0xffff0000, v61
    v_cndmask_b32 v26, v26, v98, vcc
    v_cndmask_b32 v27, v27, v99, vcc
    v_cvt_pk_bf16_f32 v61, v100, v101
    v_lshlrev_b32 v100, 16, v61
    v_and_b32 v101, 0xffff0000, v61
    v_mul_f32 v100, v62, v100
    v_mul_f32 v101, v62, v101
    v_cvt_pk_bf16_f32 v61, v100, v101
    v_lshlrev_b32 v100, 16, v61
    v_and_b32 v101, 0xffff0000, v61
    v_cndmask_b32 v28, v28, v100, vcc
    v_cndmask_b32 v29, v29, v101, vcc
    v_cvt_pk_bf16_f32 v61, v102, v103
    v_lshlrev_b32 v102, 16, v61
    v_and_b32 v103, 0xffff0000, v61
    v_mul_f32 v102, v62, v102
    v_mul_f32 v103, v62, v103
    v_cvt_pk_bf16_f32 v61, v102, v103
    v_lshlrev_b32 v102, 16, v61
    v_and_b32 v103, 0xffff0000, v61
    v_cndmask_b32 v30, v30, v102, vcc
    v_cndmask_b32 v31, v31, v103, vcc
    v_cvt_pk_bf16_f32 v61, v104, v105
    v_lshlrev_b32 v104, 16, v61
    v_and_b32 v105, 0xffff0000, v61
    v_mul_f32 v104, v62, v104
    v_mul_f32 v105, v62, v105
    v_cvt_pk_bf16_f32 v61, v104, v105
    v_lshlrev_b32 v104, 16, v61
    v_and_b32 v105, 0xffff0000, v61
    v_cndmask_b32 v32, v32, v104, vcc
    v_cndmask_b32 v33, v33, v105, vcc
    v_cvt_pk_bf16_f32 v61, v106, v107
    v_lshlrev_b32 v106, 16, v61
    v_and_b32 v107, 0xffff0000, v61
    v_mul_f32 v106, v62, v106
    v_mul_f32 v107, v62, v107
    v_cvt_pk_bf16_f32 v61, v106, v107
    v_lshlrev_b32 v106, 16, v61
    v_and_b32 v107, 0xffff0000, v61
    v_cndmask_b32 v34, v34, v106, vcc
    v_cndmask_b32 v35, v35, v107, vcc
    v_cvt_pk_bf16_f32 v61, v108, v109
    v_lshlrev_b32 v108, 16, v61
    v_and_b32 v109, 0xffff0000, v61
    v_mul_f32 v108, v62, v108
    v_mul_f32 v109, v62, v109
    v_cvt_pk_bf16_f32 v61, v108, v109
    v_lshlrev_b32 v108, 16, v61
    v_and_b32 v109, 0xffff0000, v61
    v_cndmask_b32 v36, v36, v108, vcc
    v_cndmask_b32 v37, v37, v109, vcc
    v_cvt_pk_bf16_f32 v61, v110, v111
    v_lshlrev_b32 v110, 16, v61
    v_and_b32 v111, 0xffff0000, v61
    v_mul_f32 v110, v62, v110
    v_mul_f32 v111, v62, v111
    v_cvt_pk_bf16_f32 v61, v110, v111
    v_lshlrev_b32 v110, 16, v61
    v_and_b32 v111, 0xffff0000, v61
    v_cndmask_b32 v38, v38, v110, vcc
    v_cndmask_b32 v39, v39, v111, vcc
L_recurrent_scan__compressed_kv_cla__moe_arch_mod__prompt_kernel_rt2_noy_1:
    s_sub_u32 s36, s57, s38
    s_cmp_lt_u32 s36, 16
    s_cbranch_scc0 L_recurrent_scan__compressed_kv_cla__moe_arch_mod__prompt_kernel_rt2_noy_2
    s_and_b32 s36, s59, 0xffff0000
    s_cmp_lt_i32 s36, 0
    s_cselect_b32 s37, 0x80000000, -1
    s_xor_b32 s36, s36, s37
    s_and_b32 s36, s36, 0xffff0000
    v_mov_b32 v62, s36
    v_mul_f32 v62, 0xbfb8aa3b, v62
    v_exp_f32 v62, v62
    s_nop 0
    v_add_f32 v62, 1.0, v62
    v_rcp_f32 v62, v62
    s_nop 0
    v_cvt_pk_bf16_f32 v62, v62, v62
    v_lshlrev_b32 v62, 16, v62
    v_add_f32_dpp v112, v112, v112 quad_perm:[1,0,3,2] row_mask:0xf bank_mask:0xf
    v_add_f32_dpp v113, v113, v113 quad_perm:[1,0,3,2] row_mask:0xf bank_mask:0xf
    v_add_f32_dpp v114, v114, v114 quad_perm:[1,0,3,2] row_mask:0xf bank_mask:0xf
    v_add_f32_dpp v115, v115, v115 quad_perm:[1,0,3,2] row_mask:0xf bank_mask:0xf
    v_add_f32_dpp v116, v116, v116 quad_perm:[1,0,3,2] row_mask:0xf bank_mask:0xf
    v_add_f32_dpp v117, v117, v117 quad_perm:[1,0,3,2] row_mask:0xf bank_mask:0xf
    v_add_f32_dpp v118, v118, v118 quad_perm:[1,0,3,2] row_mask:0xf bank_mask:0xf
    v_add_f32_dpp v119, v119, v119 quad_perm:[1,0,3,2] row_mask:0xf bank_mask:0xf
    v_add_f32_dpp v120, v120, v120 quad_perm:[1,0,3,2] row_mask:0xf bank_mask:0xf
    v_add_f32_dpp v121, v121, v121 quad_perm:[1,0,3,2] row_mask:0xf bank_mask:0xf
    v_add_f32_dpp v122, v122, v122 quad_perm:[1,0,3,2] row_mask:0xf bank_mask:0xf
    v_add_f32_dpp v123, v123, v123 quad_perm:[1,0,3,2] row_mask:0xf bank_mask:0xf
    v_add_f32_dpp v124, v124, v124 quad_perm:[1,0,3,2] row_mask:0xf bank_mask:0xf
    v_add_f32_dpp v125, v125, v125 quad_perm:[1,0,3,2] row_mask:0xf bank_mask:0xf
    v_add_f32_dpp v126, v126, v126 quad_perm:[1,0,3,2] row_mask:0xf bank_mask:0xf
    v_add_f32_dpp v127, v127, v127 quad_perm:[1,0,3,2] row_mask:0xf bank_mask:0xf
    v_add_f32_dpp v112, v112, v112 quad_perm:[2,3,0,1] row_mask:0xf bank_mask:0xf
    v_add_f32_dpp v113, v113, v113 quad_perm:[2,3,0,1] row_mask:0xf bank_mask:0xf
    v_add_f32_dpp v114, v114, v114 quad_perm:[2,3,0,1] row_mask:0xf bank_mask:0xf
    v_add_f32_dpp v115, v115, v115 quad_perm:[2,3,0,1] row_mask:0xf bank_mask:0xf
    v_add_f32_dpp v116, v116, v116 quad_perm:[2,3,0,1] row_mask:0xf bank_mask:0xf
    v_add_f32_dpp v117, v117, v117 quad_perm:[2,3,0,1] row_mask:0xf bank_mask:0xf
    v_add_f32_dpp v118, v118, v118 quad_perm:[2,3,0,1] row_mask:0xf bank_mask:0xf
    v_add_f32_dpp v119, v119, v119 quad_perm:[2,3,0,1] row_mask:0xf bank_mask:0xf
    v_add_f32_dpp v120, v120, v120 quad_perm:[2,3,0,1] row_mask:0xf bank_mask:0xf
    v_add_f32_dpp v121, v121, v121 quad_perm:[2,3,0,1] row_mask:0xf bank_mask:0xf
    v_add_f32_dpp v122, v122, v122 quad_perm:[2,3,0,1] row_mask:0xf bank_mask:0xf
    v_add_f32_dpp v123, v123, v123 quad_perm:[2,3,0,1] row_mask:0xf bank_mask:0xf
    v_add_f32_dpp v124, v124, v124 quad_perm:[2,3,0,1] row_mask:0xf bank_mask:0xf
    v_add_f32_dpp v125, v125, v125 quad_perm:[2,3,0,1] row_mask:0xf bank_mask:0xf
    v_add_f32_dpp v126, v126, v126 quad_perm:[2,3,0,1] row_mask:0xf bank_mask:0xf
    v_add_f32_dpp v127, v127, v127 quad_perm:[2,3,0,1] row_mask:0xf bank_mask:0xf
    v_add_f32_dpp v112, v112, v112 row_half_mirror row_mask:0xf bank_mask:0xf
    v_add_f32_dpp v113, v113, v113 row_half_mirror row_mask:0xf bank_mask:0xf
    v_add_f32_dpp v114, v114, v114 row_half_mirror row_mask:0xf bank_mask:0xf
    v_add_f32_dpp v115, v115, v115 row_half_mirror row_mask:0xf bank_mask:0xf
    v_add_f32_dpp v116, v116, v116 row_half_mirror row_mask:0xf bank_mask:0xf
    v_add_f32_dpp v117, v117, v117 row_half_mirror row_mask:0xf bank_mask:0xf
    v_add_f32_dpp v118, v118, v118 row_half_mirror row_mask:0xf bank_mask:0xf
    v_add_f32_dpp v119, v119, v119 row_half_mirror row_mask:0xf bank_mask:0xf
    v_add_f32_dpp v120, v120, v120 row_half_mirror row_mask:0xf bank_mask:0xf
    v_add_f32_dpp v121, v121, v121 row_half_mirror row_mask:0xf bank_mask:0xf
    v_add_f32_dpp v122, v122, v122 row_half_mirror row_mask:0xf bank_mask:0xf
    v_add_f32_dpp v123, v123, v123 row_half_mirror row_mask:0xf bank_mask:0xf
    v_add_f32_dpp v124, v124, v124 row_half_mirror row_mask:0xf bank_mask:0xf
    v_add_f32_dpp v125, v125, v125 row_half_mirror row_mask:0xf bank_mask:0xf
    v_add_f32_dpp v126, v126, v126 row_half_mirror row_mask:0xf bank_mask:0xf
    v_add_f32_dpp v127, v127, v127 row_half_mirror row_mask:0xf bank_mask:0xf
    v_add_f32_dpp v112, v112, v112 row_mirror row_mask:0xf bank_mask:0xf
    v_add_f32_dpp v113, v113, v113 row_mirror row_mask:0xf bank_mask:0xf
    v_add_f32_dpp v114, v114, v114 row_mirror row_mask:0xf bank_mask:0xf
    v_add_f32_dpp v115, v115, v115 row_mirror row_mask:0xf bank_mask:0xf
    v_add_f32_dpp v116, v116, v116 row_mirror row_mask:0xf bank_mask:0xf
    v_add_f32_dpp v117, v117, v117 row_mirror row_mask:0xf bank_mask:0xf
    v_add_f32_dpp v118, v118, v118 row_mirror row_mask:0xf bank_mask:0xf
    v_add_f32_dpp v119, v119, v119 row_mirror row_mask:0xf bank_mask:0xf
    v_add_f32_dpp v120, v120, v120 row_mirror row_mask:0xf bank_mask:0xf
    v_add_f32_dpp v121, v121, v121 row_mirror row_mask:0xf bank_mask:0xf
    v_add_f32_dpp v122, v122, v122 row_mirror row_mask:0xf bank_mask:0xf
    v_add_f32_dpp v123, v123, v123 row_mirror row_mask:0xf bank_mask:0xf
    v_add_f32_dpp v124, v124, v124 row_mirror row_mask:0xf bank_mask:0xf
    v_add_f32_dpp v125, v125, v125 row_mirror row_mask:0xf bank_mask:0xf
    v_add_f32_dpp v126, v126, v126 row_mirror row_mask:0xf bank_mask:0xf
    v_add_f32_dpp v127, v127, v127 row_mirror row_mask:0xf bank_mask:0xf
    v_cmp_eq_u32 vcc, s57, v14
    v_cvt_pk_bf16_f32 v61, v112, v113
    v_lshlrev_b32 v112, 16, v61
    v_and_b32 v113, 0xffff0000, v61
    v_mul_f32 v112, v62, v112
    v_mul_f32 v113, v62, v113
    v_cvt_pk_bf16_f32 v61, v112, v113
    v_lshlrev_b32 v112, 16, v61
    v_and_b32 v113, 0xffff0000, v61
    v_cndmask_b32 v24, v24, v112, vcc
    v_cndmask_b32 v25, v25, v113, vcc
    v_cvt_pk_bf16_f32 v61, v114, v115
    v_lshlrev_b32 v114, 16, v61
    v_and_b32 v115, 0xffff0000, v61
    v_mul_f32 v114, v62, v114
    v_mul_f32 v115, v62, v115
    v_cvt_pk_bf16_f32 v61, v114, v115
    v_lshlrev_b32 v114, 16, v61
    v_and_b32 v115, 0xffff0000, v61
    v_cndmask_b32 v26, v26, v114, vcc
    v_cndmask_b32 v27, v27, v115, vcc
    v_cvt_pk_bf16_f32 v61, v116, v117
    v_lshlrev_b32 v116, 16, v61
    v_and_b32 v117, 0xffff0000, v61
    v_mul_f32 v116, v62, v116
    v_mul_f32 v117, v62, v117
    v_cvt_pk_bf16_f32 v61, v116, v117
    v_lshlrev_b32 v116, 16, v61
    v_and_b32 v117, 0xffff0000, v61
    v_cndmask_b32 v28, v28, v116, vcc
    v_cndmask_b32 v29, v29, v117, vcc
    v_cvt_pk_bf16_f32 v61, v118, v119
    v_lshlrev_b32 v118, 16, v61
    v_and_b32 v119, 0xffff0000, v61
    v_mul_f32 v118, v62, v118
    v_mul_f32 v119, v62, v119
    v_cvt_pk_bf16_f32 v61, v118, v119
    v_lshlrev_b32 v118, 16, v61
    v_and_b32 v119, 0xffff0000, v61
    v_cndmask_b32 v30, v30, v118, vcc
    v_cndmask_b32 v31, v31, v119, vcc
    v_cvt_pk_bf16_f32 v61, v120, v121
    v_lshlrev_b32 v120, 16, v61
    v_and_b32 v121, 0xffff0000, v61
    v_mul_f32 v120, v62, v120
    v_mul_f32 v121, v62, v121
    v_cvt_pk_bf16_f32 v61, v120, v121
    v_lshlrev_b32 v120, 16, v61
    v_and_b32 v121, 0xffff0000, v61
    v_cndmask_b32 v32, v32, v120, vcc
    v_cndmask_b32 v33, v33, v121, vcc
    v_cvt_pk_bf16_f32 v61, v122, v123
    v_lshlrev_b32 v122, 16, v61
    v_and_b32 v123, 0xffff0000, v61
    v_mul_f32 v122, v62, v122
    v_mul_f32 v123, v62, v123
    v_cvt_pk_bf16_f32 v61, v122, v123
    v_lshlrev_b32 v122, 16, v61
    v_and_b32 v123, 0xffff0000, v61
    v_cndmask_b32 v34, v34, v122, vcc
    v_cndmask_b32 v35, v35, v123, vcc
    v_cvt_pk_bf16_f32 v61, v124, v125
    v_lshlrev_b32 v124, 16, v61
    v_and_b32 v125, 0xffff0000, v61
    v_mul_f32 v124, v62, v124
    v_mul_f32 v125, v62, v125
    v_cvt_pk_bf16_f32 v61, v124, v125
    v_lshlrev_b32 v124, 16, v61
    v_and_b32 v125, 0xffff0000, v61
    v_cndmask_b32 v36, v36, v124, vcc
    v_cndmask_b32 v37, v37, v125, vcc
    v_cvt_pk_bf16_f32 v61, v126, v127
    v_lshlrev_b32 v126, 16, v61
    v_and_b32 v127, 0xffff0000, v61
    v_mul_f32 v126, v62, v126
    v_mul_f32 v127, v62, v127
    v_cvt_pk_bf16_f32 v61, v126, v127
    v_lshlrev_b32 v126, 16, v61
    v_and_b32 v127, 0xffff0000, v61
    v_cndmask_b32 v38, v38, v126, vcc
    v_cndmask_b32 v39, v39, v127, vcc
L_recurrent_scan__compressed_kv_cla__moe_arch_mod__prompt_kernel_rt2_noy_2:
    s_branch L_recurrent_scan__compressed_kv_cla__moe_arch_mod__prompt_kernel_back_195
L_recurrent_scan__compressed_kv_cla__moe_arch_mod__prompt_kernel_f2m_198:
    v_lshrrev_b32 v28, 4, v1
    v_bfe_u32 v26, v1, 2, 2
    v_lshl_add_u32 v26, v28, 3, v26
    v_lshlrev_b32 v26, 7, v26
    v_and_b32 v27, 3, v1
    v_lshl_add_u32 v26, v27, 3, v26
    v_bfe_u32 v27, v1, 3, 2
    s_lshl_b32 s36, s28, 12
    s_add_u32 s36, s36, 131072
    v_add_u32 v26, s36, v26
    v_xor_b32 v28, 0, v27
    v_lshl_add_u32 v28, v28, 5, v26
    ds_read_b64_tr_b16 v[112:113], v28 offset:0
    ds_read_b64_tr_b16 v[114:115], v28 offset:512
    v_xor_b32 v28, 1, v27
    v_lshl_add_u32 v28, v28, 5, v26
    ds_read_b64_tr_b16 v[116:117], v28 offset:0
    ds_read_b64_tr_b16 v[118:119], v28 offset:512
    v_xor_b32 v28, 2, v27
    v_lshl_add_u32 v28, v28, 5, v26
    ds_read_b64_tr_b16 v[120:121], v28 offset:0
    ds_read_b64_tr_b16 v[122:123], v28 offset:512
    v_xor_b32 v28, 3, v27
    v_lshl_add_u32 v28, v28, 5, v26
    ds_read_b64_tr_b16 v[124:125], v28 offset:0
    ds_read_b64_tr_b16 v[126:127], v28 offset:512
    v_add_f32_dpp v96, v96, v96 row_ror:4 row_mask:0xf bank_mask:0xf
    v_add_f32_dpp v97, v97, v97 row_ror:4 row_mask:0xf bank_mask:0xf
    v_add_f32_dpp v98, v98, v98 row_ror:4 row_mask:0xf bank_mask:0xf
    v_add_f32_dpp v99, v99, v99 row_ror:4 row_mask:0xf bank_mask:0xf
    v_add_f32_dpp v100, v100, v100 row_ror:4 row_mask:0xf bank_mask:0xf
    v_add_f32_dpp v101, v101, v101 row_ror:4 row_mask:0xf bank_mask:0xf
    v_add_f32_dpp v102, v102, v102 row_ror:4 row_mask:0xf bank_mask:0xf
    v_add_f32_dpp v103, v103, v103 row_ror:4 row_mask:0xf bank_mask:0xf
    v_add_f32_dpp v96, v96, v96 row_ror:8 row_mask:0xf bank_mask:0xf
    v_add_f32_dpp v97, v97, v97 row_ror:8 row_mask:0xf bank_mask:0xf
    v_add_f32_dpp v98, v98, v98 row_ror:8 row_mask:0xf bank_mask:0xf
    v_add_f32_dpp v99, v99, v99 row_ror:8 row_mask:0xf bank_mask:0xf
    v_add_f32_dpp v100, v100, v100 row_ror:8 row_mask:0xf bank_mask:0xf
    v_add_f32_dpp v101, v101, v101 row_ror:8 row_mask:0xf bank_mask:0xf
    v_add_f32_dpp v102, v102, v102 row_ror:8 row_mask:0xf bank_mask:0xf
    v_add_f32_dpp v103, v103, v103 row_ror:8 row_mask:0xf bank_mask:0xf
    v_cvt_pk_bf16_f32 v29, v96, v97
    v_lshlrev_b32 v96, 16, v29
    v_and_b32 v97, 0xffff0000, v29
    v_cvt_pk_bf16_f32 v29, v98, v99
    v_lshlrev_b32 v98, 16, v29
    v_and_b32 v99, 0xffff0000, v29
    v_cvt_pk_bf16_f32 v29, v100, v101
    v_lshlrev_b32 v100, 16, v29
    v_and_b32 v101, 0xffff0000, v29
    v_cvt_pk_bf16_f32 v29, v102, v103
    v_lshlrev_b32 v102, 16, v29
    v_and_b32 v103, 0xffff0000, v29
    v_mul_f32 v104, 0xbfb8aa3b, v96
    v_mul_f32 v105, 0xbfb8aa3b, v97
    v_mul_f32 v106, 0xbfb8aa3b, v98
    v_mul_f32 v107, 0xbfb8aa3b, v99
    v_mul_f32 v108, 0xbfb8aa3b, v100
    v_mul_f32 v109, 0xbfb8aa3b, v101
    v_mul_f32 v110, 0xbfb8aa3b, v102
    v_mul_f32 v111, 0xbfb8aa3b, v103
    v_exp_f32 v104, v104
    v_exp_f32 v105, v105
    v_exp_f32 v106, v106
    v_exp_f32 v107, v107
    v_exp_f32 v108, v108
    v_exp_f32 v109, v109
    v_exp_f32 v110, v110
    v_exp_f32 v111, v111
    v_add_f32 v104, 1.0, v104
    v_add_f32 v105, 1.0, v105
    v_add_f32 v106, 1.0, v106
    v_add_f32 v107, 1.0, v107
    v_add_f32 v108, 1.0, v108
    v_add_f32 v109, 1.0, v109
    v_add_f32 v110, 1.0, v110
    v_add_f32 v111, 1.0, v111
    v_rcp_f32 v104, v104
    v_rcp_f32 v105, v105
    v_rcp_f32 v106, v106
    v_rcp_f32 v107, v107
    v_rcp_f32 v108, v108
    v_rcp_f32 v109, v109
    v_rcp_f32 v110, v110
    v_rcp_f32 v111, v111
    v_mul_f32 v104, v96, v104
    v_mul_f32 v105, v97, v105
    v_mul_f32 v106, v98, v106
    v_mul_f32 v107, v99, v107
    v_mul_f32 v108, v100, v108
    v_mul_f32 v109, v101, v109
    v_mul_f32 v110, v102, v110
    v_mul_f32 v111, v103, v111
    v_cvt_pk_bf16_f32 v29, v104, v105
    v_lshlrev_b32 v104, 16, v29
    v_and_b32 v105, 0xffff0000, v29
    v_cvt_pk_bf16_f32 v29, v106, v107
    v_lshlrev_b32 v106, 16, v29
    v_and_b32 v107, 0xffff0000, v29
    v_cvt_pk_bf16_f32 v29, v108, v109
    v_lshlrev_b32 v108, 16, v29
    v_and_b32 v109, 0xffff0000, v29
    v_cvt_pk_bf16_f32 v29, v110, v111
    v_lshlrev_b32 v110, 16, v29
    v_and_b32 v111, 0xffff0000, v29
    v_mul_f32_dpp v96, v96, v104 quad_perm:[2,3,0,1] row_mask:0xf bank_mask:0xf
    v_mul_f32_dpp v97, v97, v105 quad_perm:[2,3,0,1] row_mask:0xf bank_mask:0xf
    v_mul_f32_dpp v98, v98, v106 quad_perm:[2,3,0,1] row_mask:0xf bank_mask:0xf
    v_mul_f32_dpp v99, v99, v107 quad_perm:[2,3,0,1] row_mask:0xf bank_mask:0xf
    v_mul_f32_dpp v100, v100, v108 quad_perm:[2,3,0,1] row_mask:0xf bank_mask:0xf
    v_mul_f32_dpp v101, v101, v109 quad_perm:[2,3,0,1] row_mask:0xf bank_mask:0xf
    v_mul_f32_dpp v102, v102, v110 quad_perm:[2,3,0,1] row_mask:0xf bank_mask:0xf
    v_mul_f32_dpp v103, v103, v111 quad_perm:[2,3,0,1] row_mask:0xf bank_mask:0xf
    v_cvt_pk_bf16_f32 v36, v96, v97
    v_cvt_pk_bf16_f32 v37, v98, v99
    v_cvt_pk_bf16_f32 v38, v100, v101
    v_cvt_pk_bf16_f32 v39, v102, v103
    s_waitcnt lgkmcnt(0)
    v_lshl_add_u32 v28, v1, 4, s36
    v_mfma_f32_16x16x32_bf16 v[96:99], v[112:115], v[36:39], 0
    v_mfma_f32_16x16x32_bf16 v[100:103], v[116:119], v[36:39], 0
    v_mfma_f32_16x16x32_bf16 v[104:107], v[120:123], v[36:39], 0
    v_mfma_f32_16x16x32_bf16 v[108:111], v[124:127], v[36:39], 0
    s_nop 7
    ds_write_b128 v28, v[96:99] offset:0
    ds_write_b128 v28, v[100:103] offset:1024
    ds_write_b128 v28, v[104:107] offset:2048
    ds_write_b128 v28, v[108:111] offset:3072
    s_cmp_lt_u32 s28, 4
    s_cbranch_scc1 L_recurrent_scan__compressed_kv_cla__moe_arch_mod__prompt_kernel_f2b_200
    s_branch L_recurrent_scan__compressed_kv_cla__moe_arch_mod__prompt_kernel_f2a_199
L_recurrent_scan__compressed_kv_cla__moe_arch_mod__prompt_kernel_rare_207:
    s_mov_b32 s61, 0x40000
L_recurrent_scan__compressed_kv_cla__moe_arch_mod__prompt_kernel_spin_205:
    s_sub_u32 s61, s61, 1
    s_cbranch_scc1 L_recurrent_scan__compressed_kv_cla__moe_arch_mod__prompt_kernel_spinx_206
    s_sleep 1
    global_load_dword v23, v5, s[90:91] sc1
    s_waitcnt vmcnt(0)
    v_readfirstlane_b32 s36, v23
    s_nop 0
    s_cmp_lt_u32 s36, 8
    s_cbranch_scc1 L_recurrent_scan__compressed_kv_cla__moe_arch_mod__prompt_kernel_spin_205
L_recurrent_scan__compressed_kv_cla__moe_arch_mod__prompt_kernel_spinx_206:
    s_branch L_recurrent_scan__compressed_kv_cla__moe_arch_mod__prompt_kernel_back_208
L_recurrent_scan__compressed_kv_cla__moe_arch_mod__prompt_kernel_rare_209:
    v_lshlrev_b32 v96, 16, v40
    v_and_b32 v97, 0xffff0000, v40
    v_sub_f32 v112, v96, v48
    v_sub_f32 v113, v97, v48
    v_cvt_pk_bf16_f32 v10, v112, v113
    v_lshlrev_b32 v112, 16, v10
    v_and_b32 v113, 0xffff0000, v10
    v_mul_f32 v112, v112, v49
    v_mul_f32 v113, v113, v49
    v_cvt_pk_bf16_f32 v10, v112, v113
    v_lshlrev_b32 v112, 16, v10
    v_and_b32 v113, 0xffff0000, v10
    v_add_f32 v112, v112, v24
    v_add_f32 v113, v113, v25
    v_cvt_pk_bf16_f32 v10, v112, v113
    v_lshlrev_b32 v112, 16, v10
    v_and_b32 v113, 0xffff0000, v10
    v_mul_f32 v11, 0xbfb8aa3b, v112
    v_mul_f32 v12, 0xbfb8aa3b, v113
    v_exp_f32 v11, v11
    v_exp_f32 v12, v12
    s_nop 0
    v_add_f32 v11, 1.0, v11
    v_add_f32 v12, 1.0, v12
    v_rcp_f32 v11, v11
    v_rcp_f32 v12, v12
    s_nop 0
    v_mul_f32 v112, v112, v11
    v_mul_f32 v113, v113, v12
    v_cvt_pk_bf16_f32 v10, v112, v113
    v_lshlrev_b32 v112, 16, v10
    v_and_b32 v113, 0xffff0000, v10
    v_lshlrev_b32 v98, 16, v41
    v_and_b32 v99, 0xffff0000, v41
    v_sub_f32 v114, v98, v48
    v_sub_f32 v115, v99, v48
    v_cvt_pk_bf16_f32 v10, v114, v115
    v_lshlrev_b32 v114, 16, v10
    v_and_b32 v115, 0xffff0000, v10
    v_mul_f32 v114, v114, v49
    v_mul_f32 v115, v115, v49
    v_cvt_pk_bf16_f32 v10, v114, v115
    v_lshlrev_b32 v114, 16, v10
    v_and_b32 v115, 0xffff0000, v10
    v_add_f32 v114, v114, v26
    v_add_f32 v115, v115, v27
    v_cvt_pk_bf16_f32 v10, v114, v115
    v_lshlrev_b32 v114, 16, v10
    v_and_b32 v115, 0xffff0000, v10
    v_mul_f32 v11, 0xbfb8aa3b, v114
    v_mul_f32 v12, 0xbfb8aa3b, v115
    v_exp_f32 v11, v11
    v_exp_f32 v12, v12
    s_nop 0
    v_add_f32 v11, 1.0, v11
    v_add_f32 v12, 1.0, v12
    v_rcp_f32 v11, v11
    v_rcp_f32 v12, v12
    s_nop 0
    v_mul_f32 v114, v114, v11
    v_mul_f32 v115, v115, v12
    v_cvt_pk_bf16_f32 v10, v114, v115
    v_lshlrev_b32 v114, 16, v10
    v_and_b32 v115, 0xffff0000, v10
    v_lshlrev_b32 v100, 16, v42
    v_and_b32 v101, 0xffff0000, v42
    v_sub_f32 v116, v100, v48
    v_sub_f32 v117, v101, v48
    v_cvt_pk_bf16_f32 v10, v116, v117
    v_lshlrev_b32 v116, 16, v10
    v_and_b32 v117, 0xffff0000, v10
    v_mul_f32 v116, v116, v49
    v_mul_f32 v117, v117, v49
    v_cvt_pk_bf16_f32 v10, v116, v117
    v_lshlrev_b32 v116, 16, v10
    v_and_b32 v117, 0xffff0000, v10
    v_add_f32 v116, v116, v28
    v_add_f32 v117, v117, v29
    v_cvt_pk_bf16_f32 v10, v116, v117
    v_lshlrev_b32 v116, 16, v10
    v_and_b32 v117, 0xffff0000, v10
    v_mul_f32 v11, 0xbfb8aa3b, v116
    v_mul_f32 v12, 0xbfb8aa3b, v117
    v_exp_f32 v11, v11
    v_exp_f32 v12, v12
    s_nop 0
    v_add_f32 v11, 1.0, v11
    v_add_f32 v12, 1.0, v12
    v_rcp_f32 v11, v11
    v_rcp_f32 v12, v12
    s_nop 0
    v_mul_f32 v116, v116, v11
    v_mul_f32 v117, v117, v12
    v_cvt_pk_bf16_f32 v10, v116, v117
    v_lshlrev_b32 v116, 16, v10
    v_and_b32 v117, 0xffff0000, v10
    v_lshlrev_b32 v102, 16, v43
    v_and_b32 v103, 0xffff0000, v43
    v_sub_f32 v118, v102, v48
    v_sub_f32 v119, v103, v48
    v_cvt_pk_bf16_f32 v10, v118, v119
    v_lshlrev_b32 v118, 16, v10
    v_and_b32 v119, 0xffff0000, v10
    v_mul_f32 v118, v118, v49
    v_mul_f32 v119, v119, v49
    v_cvt_pk_bf16_f32 v10, v118, v119
    v_lshlrev_b32 v118, 16, v10
    v_and_b32 v119, 0xffff0000, v10
    v_add_f32 v118, v118, v30
    v_add_f32 v119, v119, v31
    v_cvt_pk_bf16_f32 v10, v118, v119
    v_lshlrev_b32 v118, 16, v10
    v_and_b32 v119, 0xffff0000, v10
    v_mul_f32 v11, 0xbfb8aa3b, v118
    v_mul_f32 v12, 0xbfb8aa3b, v119
    v_exp_f32 v11, v11
    v_exp_f32 v12, v12
    s_nop 0
    v_add_f32 v11, 1.0, v11
    v_add_f32 v12, 1.0, v12
    v_rcp_f32 v11, v11
    v_rcp_f32 v12, v12
    s_nop 0
    v_mul_f32 v118, v118, v11
    v_mul_f32 v119, v119, v12
    v_cvt_pk_bf16_f32 v10, v118, v119
    v_lshlrev_b32 v118, 16, v10
    v_and_b32 v119, 0xffff0000, v10
    v_lshlrev_b32 v104, 16, v44
    v_and_b32 v105, 0xffff0000, v44
    v_sub_f32 v120, v104, v48
    v_sub_f32 v121, v105, v48
    v_cvt_pk_bf16_f32 v10, v120, v121
    v_lshlrev_b32 v120, 16, v10
    v_and_b32 v121, 0xffff0000, v10
    v_mul_f32 v120, v120, v49
    v_mul_f32 v121, v121, v49
    v_cvt_pk_bf16_f32 v10, v120, v121
    v_lshlrev_b32 v120, 16, v10
    v_and_b32 v121, 0xffff0000, v10
    v_add_f32 v120, v120, v32
    v_add_f32 v121, v121, v33
    v_cvt_pk_bf16_f32 v10, v120, v121
    v_lshlrev_b32 v120, 16, v10
    v_and_b32 v121, 0xffff0000, v10
    v_mul_f32 v11, 0xbfb8aa3b, v120
    v_mul_f32 v12, 0xbfb8aa3b, v121
    v_exp_f32 v11, v11
    v_exp_f32 v12, v12
    s_nop 0
    v_add_f32 v11, 1.0, v11
    v_add_f32 v12, 1.0, v12
    v_rcp_f32 v11, v11
    v_rcp_f32 v12, v12
    s_nop 0
    v_mul_f32 v120, v120, v11
    v_mul_f32 v121, v121, v12
    v_cvt_pk_bf16_f32 v10, v120, v121
    v_lshlrev_b32 v120, 16, v10
    v_and_b32 v121, 0xffff0000, v10
    v_lshlrev_b32 v106, 16, v45
    v_and_b32 v107, 0xffff0000, v45
    v_sub_f32 v122, v106, v48
    v_sub_f32 v123, v107, v48
    v_cvt_pk_bf16_f32 v10, v122, v123
    v_lshlrev_b32 v122, 16, v10
    v_and_b32 v123, 0xffff0000, v10
    v_mul_f32 v122, v122, v49
    v_mul_f32 v123, v123, v49
    v_cvt_pk_bf16_f32 v10, v122, v123
    v_lshlrev_b32 v122, 16, v10
    v_and_b32 v123, 0xffff0000, v10
    v_add_f32 v122, v122, v34
    v_add_f32 v123, v123, v35
    v_cvt_pk_bf16_f32 v10, v122, v123
    v_lshlrev_b32 v122, 16, v10
    v_and_b32 v123, 0xffff0000, v10
    v_mul_f32 v11, 0xbfb8aa3b, v122
    v_mul_f32 v12, 0xbfb8aa3b, v123
    v_exp_f32 v11, v11
    v_exp_f32 v12, v12
    s_nop 0
    v_add_f32 v11, 1.0, v11
    v_add_f32 v12, 1.0, v12
    v_rcp_f32 v11, v11
    v_rcp_f32 v12, v12
    s_nop 0
    v_mul_f32 v122, v122, v11
    v_mul_f32 v123, v123, v12
    v_cvt_pk_bf16_f32 v10, v122, v123
    v_lshlrev_b32 v122, 16, v10
    v_and_b32 v123, 0xffff0000, v10
    v_lshlrev_b32 v108, 16, v46
    v_and_b32 v109, 0xffff0000, v46
    v_sub_f32 v124, v108, v48
    v_sub_f32 v125, v109, v48
    v_cvt_pk_bf16_f32 v10, v124, v125
    v_lshlrev_b32 v124, 16, v10
    v_and_b32 v125, 0xffff0000, v10
    v_mul_f32 v124, v124, v49
    v_mul_f32 v125, v125, v49
    v_cvt_pk_bf16_f32 v10, v124, v125
    v_lshlrev_b32 v124, 16, v10
    v_and_b32 v125, 0xffff0000, v10
    v_add_f32 v124, v124, v36
    v_add_f32 v125, v125, v37
    v_cvt_pk_bf16_f32 v10, v124, v125
    v_lshlrev_b32 v124, 16, v10
    v_and_b32 v125, 0xffff0000, v10
    v_mul_f32 v11, 0xbfb8aa3b, v124
    v_mul_f32 v12, 0xbfb8aa3b, v125
    v_exp_f32 v11, v11
    v_exp_f32 v12, v12
    s_nop 0
    v_add_f32 v11, 1.0, v11
    v_add_f32 v12, 1.0, v12
    v_rcp_f32 v11, v11
    v_rcp_f32 v12, v12
    s_nop 0
    v_mul_f32 v124, v124, v11
    v_mul_f32 v125, v125, v12
    v_cvt_pk_bf16_f32 v10, v124, v125
    v_lshlrev_b32 v124, 16, v10
    v_and_b32 v125, 0xffff0000, v10
    v_lshlrev_b32 v110, 16, v47
    v_and_b32 v111, 0xffff0000, v47
    v_sub_f32 v126, v110, v48
    v_sub_f32 v127, v111, v48
    v_cvt_pk_bf16_f32 v10, v126, v127
    v_lshlrev_b32 v126, 16, v10
    v_and_b32 v127, 0xffff0000, v10
    v_mul_f32 v126, v126, v49
    v_mul_f32 v127, v127, v49
    v_cvt_pk_bf16_f32 v10, v126, v127
    v_lshlrev_b32 v126, 16, v10
    v_and_b32 v127, 0xffff0000, v10
    v_add_f32 v126, v126, v38
    v_add_f32 v127, v127, v39
    v_cvt_pk_bf16_f32 v10, v126, v127
    v_lshlrev_b32 v126, 16, v10
    v_and_b32 v127, 0xffff0000, v10
    v_mul_f32 v11, 0xbfb8aa3b, v126
    v_mul_f32 v12, 0xbfb8aa3b, v127
    v_exp_f32 v11, v11
    v_exp_f32 v12, v12
    s_nop 0
    v_add_f32 v11, 1.0, v11
    v_add_f32 v12, 1.0, v12
    v_rcp_f32 v11, v11
    v_rcp_f32 v12, v12
    s_nop 0
    v_mul_f32 v126, v126, v11
    v_mul_f32 v127, v127, v12
    v_cvt_pk_bf16_f32 v10, v126, v127
    v_lshlrev_b32 v126, 16, v10
    v_and_b32 v127, 0xffff0000, v10
    s_branch L_recurrent_scan__compressed_kv_cla__moe_arch_mod__prompt_kernel_back_210
L_end:
    s_endpgm
.section .rodata,"a"
.p2align 6
.amdhsa_kernel recurrent_scan__compressed_kv_cla__moe_arch_mod__prompt_kernel
  .amdhsa_next_free_vgpr 256
  .amdhsa_next_free_sgpr 102
  .amdhsa_accum_offset 256
  .amdhsa_group_segment_fixed_size 0
  .amdhsa_kernarg_size 112
  .amdhsa_user_sgpr_count 2
  .amdhsa_user_sgpr_kernarg_segment_ptr 1
  .amdhsa_system_sgpr_workgroup_id_x 1
.end_amdhsa_kernel
```

```asm
; @launch kernel=recurrent_scan__compressed_kv_cla__moe_arch_mod__prompt_kernel grid=(256,1,1) block=(512,1,1) lds=163840
.amdgcn_target "amdgcn-amd-amdhsa--gfx950"
.text
.globl recurrent_scan__compressed_kv_cla__moe_arch_mod__prompt_kernel
.p2align 8
.type recurrent_scan__compressed_kv_cla__moe_arch_mod__prompt_kernel,@function
recurrent_scan__compressed_kv_cla__moe_arch_mod__prompt_kernel:
    s_cmp_ge_u32 s2, 256
    s_cbranch_scc1 L_end
    s_load_dwordx4 s[44:47], s[0:1], 0
    s_load_dwordx2 s[52:53], s[0:1], 56
    s_load_dwordx4 s[48:51], s[0:1], 24
    s_getpc_b64 s[36:37]
L_pc:
    s_lshr_b32 s38, s2, 3
    s_lshl_b32 s38, s38, 7
    v_lshl_add_u32 v16, v0, 12, s38
    v_cmp_gt_u32 vcc, L_end-L_pc-4, v16
    v_mov_b32 v17, s37
    s_and_b64 exec, exec, vcc
    s_cbranch_execz L_nocpf
    v_add_co_u32 v16, vcc, s36, v16
    s_nop 1
    v_addc_co_u32 v17, vcc, 0, v17, vcc
    global_load_dword v119, v[16:17], off
L_nocpf:
    s_mov_b64 exec, -1
    v_lshrrev_b32 v16, 6, v0
    v_and_b32 v1, 63, v0
    v_readfirstlane_b32 s28, v16
    v_lshlrev_b32 v116, 4, v1
    s_lshl_b32 s42, s2, 3
    s_cmp_lt_u32 s28, 4
    s_cbranch_scc1 L_nox
    s_add_u32 s43, s42, s28
    s_sub_u32 s42, s43, 4
    v_lshl_add_u32 v18, s42, 11, v116
    v_add_u32 v19, 8192, v18
    s_waitcnt lgkmcnt(0)
    global_load_dwordx4 v[20:23], v18, s[44:45]
    global_load_dwordx4 v[24:27], v18, s[44:45] offset:1024
    global_load_dwordx4 v[28:31], v19, s[44:45]
    global_load_dwordx4 v[32:35], v19, s[44:45] offset:1024
    global_load_dwordx4 v[36:39], v116, s[52:53]
    global_load_dwordx4 v[40:43], v116, s[52:53] offset:1024
    s_barrier
L_nox:
    s_load_dwordx4 s[88:91], s[0:1], 96
    s_load_dwordx4 s[92:95], s[0:1], 64
    s_load_dwordx2 s[96:97], s[0:1], 16
    s_and_b32 s29, s2, 7
    s_lshl_b32 s29, s29, 2
    s_lshr_b32 s29, 0x75643120, s29
    s_and_b32 s29, s29, 7
    s_lshl_b32 s29, s29, 2
    s_bfe_u32 s36, s2, 0x20003
    s_add_u32 s29, s29, s36
    s_lshr_b32 s30, s2, 5
    v_lshrrev_b32 v16, 3, v1
    s_lshl_b32 s36, s30, 8
    s_lshl_b32 s37, s28, 5
    s_add_u32 s36, s36, s37
    v_add_u32 v16, s36, v16
    v_lshlrev_b32 v16, 10, v16
    v_lshrrev_b32 v18, 4, v1
    v_and_b32 v19, 7, v1
    v_xor_b32 v19, v19, v18
    v_lshl_add_u32 v2, v19, 4, v16
    v_xor_b32 v19, 4, v19
    v_lshl_add_u32 v3, v19, 4, v16
    v_add_u32 v3, 7168, v3
    v_add_u32 v4, 14336, v2
    v_add_u32 v5, 14336, v3
    s_and_b32 s36, s28, 3
    s_lshl_b32 s37, s36, 4
    v_add_u32 v16, s37, v18
    v_lshlrev_b32 v16, 13, v16
    s_lshl_b32 s37, s29, 8
    v_add_u32 v16, s37, v16
    v_and_b32 v19, 15, v1
    v_lshlrev_b32 v18, 1, v18
    v_xor_b32 v19, v19, v18
    v_lshl_add_u32 v6, v19, 4, v16
    v_add_u32 v7, 31744, v6
    v_xor_b32 v19, 8, v19
    v_lshl_add_u32 v8, v19, 4, v16
    v_add_u32 v8, 63488, v8
    v_add_u32 v9, 31744, v8
    s_lshl_b32 s33, s28, 12
    s_add_u32 s34, s33, 65536
    s_mov_b32 s31, 0
    s_mov_b32 s32, 0
    s_mov_b32 s40, 128
    s_mov_b32 s41, 524288
    s_waitcnt lgkmcnt(0)
    s_mov_b32 s4, s46
    s_and_b32 s5, s47, 0xffff
    s_mov_b32 s6, 2097152
    s_mov_b32 s7, 0x20000
    s_mov_b32 s8, s48
    s_and_b32 s9, s49, 0xffff
    s_mov_b32 s10, 4194304
    s_mov_b32 s11, 0x20000
    s_mov_b32 s20, s50
    s_and_b32 s21, s51, 0xffff
    s_mov_b32 s22, 4194304
    s_mov_b32 s23, 0x20000
    s_cmp_lt_u32 s28, 4
    s_cbranch_scc0 L_pro_s
    s_barrier
    s_cmp_eq_u32 s2, 0
    s_cbranch_scc1 L_recurrent_scan__compressed_kv_cla__moe_arch_mod__prompt_kernel_rare_1
L_recurrent_scan__compressed_kv_cla__moe_arch_mod__prompt_kernel_back_2:
    s_add_u32 m0, s33, 0
    s_add_u32 s36, s31, 131072
    buffer_load_dwordx4 v2, s[4:7], s31 offen offset:0 lds
    buffer_load_dwordx4 v3, s[4:7], s31 offen offset:1024 lds
    buffer_load_dwordx4 v4, s[4:7], s31 offen offset:2048 lds
    buffer_load_dwordx4 v5, s[4:7], s31 offen offset:3072 lds
    s_add_u32 m0, s34, 0
    s_nop 0
    buffer_load_dwordx4 v6, s[8:11], s32 offen offset:0 nt lds
    buffer_load_dwordx4 v7, s[8:11], s32 offen offset:1024 nt lds
    buffer_load_dwordx4 v8, s[8:11], s32 offen offset:2048 nt lds
    buffer_load_dwordx4 v9, s[8:11], s32 offen offset:3072 nt lds
    s_add_u32 m0, s33, 16384
    s_nop 0
    buffer_load_dwordx4 v2, s[4:7], s36 offen offset:0 lds
    buffer_load_dwordx4 v3, s[4:7], s36 offen offset:1024 lds
    buffer_load_dwordx4 v4, s[4:7], s36 offen offset:2048 lds
    buffer_load_dwordx4 v5, s[4:7], s36 offen offset:3072 lds
    s_add_u32 m0, s34, 16384
    s_nop 0
    buffer_load_dwordx4 v6, s[20:23], s32 offen offset:0 nt lds
    buffer_load_dwordx4 v7, s[20:23], s32 offen offset:1024 nt lds
    buffer_load_dwordx4 v8, s[20:23], s32 offen offset:2048 nt lds
    buffer_load_dwordx4 v9, s[20:23], s32 offen offset:3072 nt lds
    s_add_u32 s31, s31, s40
    s_add_u32 s32, s32, s41
L_pro_s:
    s_add_u32 s54, s90, 0
    s_addc_u32 s55, s91, 0
    s_add_u32 s12, s54, 8388608
    s_addc_u32 s13, s55, 0
    s_and_b32 s13, s13, 0xffff
    s_mov_b32 s14, 134217856
    s_mov_b32 s15, 0x20000
    s_mov_b32 s24, s54
    s_and_b32 s25, s55, 0xffff
    s_mov_b32 s26, 184549504
    s_mov_b32 s27, 0x20000
    s_add_u32 s90, s54, 61865984
    s_addc_u32 s91, s55, 0
    v_and_b32 v16, 15, v1
    v_lshrrev_b32 v17, 4, v1
    s_bfe_u32 s36, s28, 0x10001
    s_lshl_b32 s36, s36, 14
    v_lshl_add_u32 v18, v16, 7, s36
    v_lshrrev_b32 v19, 1, v16
    v_xor_b32 v19, v19, v17
    v_lshl_add_u32 v10, v19, 4, v18
    v_xor_b32 v19, 4, v19
    v_lshl_add_u32 v11, v19, 4, v18
    v_lshrrev_b32 v16, 2, v16
    v_lshl_add_u32 v18, v17, 3, v16
    v_lshlrev_b32 v18, 8, v18
    s_lshr_b32 s36, s28, 2
    s_lshl_b32 s36, s36, 14
    s_add_u32 s36, s36, 65536
    v_add_u32 v18, s36, v18
    v_and_b32 v19, 3, v1
    v_lshl_add_u32 v18, v19, 3, v18
    v_and_b32 v17, 1, v17
    v_lshl_add_u32 v16, v17, 2, v16
    s_and_b32 s36, s28, 1
    s_lshl_b32 s36, s36, 2
    s_add_u32 s37, s36, 0
    v_xor_b32 v19, s37, v16
    v_lshl_add_u32 v12, v19, 5, v18
    s_add_u32 s37, s36, 1
    v_xor_b32 v19, s37, v16
    v_lshl_add_u32 v13, v19, 5, v18
    s_add_u32 s37, s36, 2
    v_xor_b32 v19, s37, v16
    v_lshl_add_u32 v14, v19, 5, v18
    s_add_u32 s37, s36, 3
    v_xor_b32 v19, s37, v16
    v_lshl_add_u32 v15, v19, 5, v18
    v_mov_b64 v[128:129], 0
    v_mov_b64 v[130:131], 0
    v_mov_b64 v[132:133], 0
    v_mov_b64 v[134:135], 0
    v_mov_b64 v[136:137], 0
    v_mov_b64 v[138:139], 0
    v_mov_b64 v[140:141], 0
    v_mov_b64 v[142:143], 0
    v_mov_b64 v[144:145], 0
    v_mov_b64 v[146:147], 0
    v_mov_b64 v[148:149], 0
    v_mov_b64 v[150:151], 0
    v_mov_b64 v[152:153], 0
    v_mov_b64 v[154:155], 0
    v_mov_b64 v[156:157], 0
    v_mov_b64 v[158:159], 0
    v_mov_b64 v[160:161], 0
    v_mov_b64 v[162:163], 0
    v_mov_b64 v[164:165], 0
    v_mov_b64 v[166:167], 0
    v_mov_b64 v[168:169], 0
    v_mov_b64 v[170:171], 0
    v_mov_b64 v[172:173], 0
    v_mov_b64 v[174:175], 0
    v_mov_b64 v[176:177], 0
    v_mov_b64 v[178:179], 0
    v_mov_b64 v[180:181], 0
    v_mov_b64 v[182:183], 0
    v_mov_b64 v[184:185], 0
    v_mov_b64 v[186:187], 0
    v_mov_b64 v[188:189], 0
    v_mov_b64 v[190:191], 0
    v_mov_b64 v[192:193], 0
    v_mov_b64 v[194:195], 0
    v_mov_b64 v[196:197], 0
    v_mov_b64 v[198:199], 0
    v_mov_b64 v[200:201], 0
    v_mov_b64 v[202:203], 0
    v_mov_b64 v[204:205], 0
    v_mov_b64 v[206:207], 0
    v_mov_b64 v[208:209], 0
    v_mov_b64 v[210:211], 0
    v_mov_b64 v[212:213], 0
    v_mov_b64 v[214:215], 0
    v_mov_b64 v[216:217], 0
    v_mov_b64 v[218:219], 0
    v_mov_b64 v[220:221], 0
    v_mov_b64 v[222:223], 0
    v_mov_b64 v[224:225], 0
    v_mov_b64 v[226:227], 0
    v_mov_b64 v[228:229], 0
    v_mov_b64 v[230:231], 0
    v_mov_b64 v[232:233], 0
    v_mov_b64 v[234:235], 0
    v_mov_b64 v[236:237], 0
    v_mov_b64 v[238:239], 0
    v_mov_b64 v[240:241], 0
    v_mov_b64 v[242:243], 0
    v_mov_b64 v[244:245], 0
    v_mov_b64 v[246:247], 0
    v_mov_b64 v[248:249], 0
    v_mov_b64 v[250:251], 0
    v_mov_b64 v[252:253], 0
    v_mov_b64 v[254:255], 0
    v_mov_b32 v118, 0
    v_mov_b32 v117, 0
    s_lshr_b32 s36, s2, 3
    s_lshl_b32 s36, s36, 5
    s_lshl_b32 s37, s28, 2
    s_add_u32 s36, s36, s37
    s_lshl_b32 s36, s36, 13
    s_and_b32 s37, s29, 28
    s_lshl_b32 s37, s37, 8
    s_add_u32 s36, s36, s37
    s_add_u32 s16, s96, s36
    s_addc_u32 s17, s97, 0
    s_and_b32 s17, s17, 0xffff
    s_mov_b32 s18, 25600
    s_mov_b32 s19, 0x20000
    v_cmp_gt_u32 vcc, 8, v1
    v_lshlrev_b32 v17, 7, v1
    v_mov_b32 v19, 0x100000
    v_cndmask_b32 v17, v19, v17, vcc
    s_mov_b32 s45, 0
    s_cmp_lt_u32 s28, 4
    s_cbranch_scc0 L_pro_b
    s_add_u32 m0, s33, 32768
    s_add_u32 s36, s31, 131072
    buffer_load_dwordx4 v2, s[4:7], s31 offen offset:0 lds
    buffer_load_dwordx4 v3, s[4:7], s31 offen offset:1024 lds
    buffer_load_dwordx4 v4, s[4:7], s31 offen offset:2048 lds
    buffer_load_dwordx4 v5, s[4:7], s31 offen offset:3072 lds
    s_add_u32 m0, s34, 32768
    s_nop 0
    buffer_load_dwordx4 v6, s[8:11], s32 offen offset:0 nt lds
    buffer_load_dwordx4 v7, s[8:11], s32 offen offset:1024 nt lds
    buffer_load_dwordx4 v8, s[8:11], s32 offen offset:2048 nt lds
    buffer_load_dwordx4 v9, s[8:11], s32 offen offset:3072 nt lds
    s_add_u32 m0, s33, 49152
    s_nop 0
    buffer_load_dwordx4 v2, s[4:7], s36 offen offset:0 lds
    buffer_load_dwordx4 v3, s[4:7], s36 offen offset:1024 lds
    buffer_load_dwordx4 v4, s[4:7], s36 offen offset:2048 lds
    buffer_load_dwordx4 v5, s[4:7], s36 offen offset:3072 lds
    s_add_u32 m0, s34, 49152
    s_nop 0
    buffer_load_dwordx4 v6, s[20:23], s32 offen offset:0 nt lds
    buffer_load_dwordx4 v7, s[20:23], s32 offen offset:1024 nt lds
    buffer_load_dwordx4 v8, s[20:23], s32 offen offset:2048 nt lds
    buffer_load_dwordx4 v9, s[20:23], s32 offen offset:3072 nt lds
    s_add_u32 s31, s31, s40
    s_add_u32 s32, s32, s41
    s_waitcnt vmcnt(16)
    s_branch L_pro_j
L_pro_b:
    s_mov_b64 s[8:9], s[20:21]
    s_mov_b32 s31, 256
    s_mov_b32 s32, 1048576
    s_and_b32 s60, s28, 3
    s_waitcnt vmcnt(0)
    s_mov_b32 s3, 0
L_ln:
    v_lshlrev_b32 v44, 16, v36
    v_and_b32 v45, 0xffff0000, v36
    v_lshlrev_b32 v46, 16, v37
    v_and_b32 v47, 0xffff0000, v37
    v_lshlrev_b32 v48, 16, v38
    v_and_b32 v49, 0xffff0000, v38
    v_lshlrev_b32 v50, 16, v39
    v_and_b32 v51, 0xffff0000, v39
    v_lshlrev_b32 v52, 16, v40
    v_and_b32 v53, 0xffff0000, v40
    v_lshlrev_b32 v54, 16, v41
    v_and_b32 v55, 0xffff0000, v41
    v_lshlrev_b32 v56, 16, v42
    v_and_b32 v57, 0xffff0000, v42
    v_lshlrev_b32 v58, 16, v43
    v_and_b32 v59, 0xffff0000, v43
    v_lshlrev_b32 v60, 16, v20
    v_lshlrev_b32 v76, 16, v28
    v_and_b32 v61, 0xffff0000, v20
    v_and_b32 v77, 0xffff0000, v28
    v_lshlrev_b32 v62, 16, v21
    v_lshlrev_b32 v78, 16, v29
    v_and_b32 v63, 0xffff0000, v21
    v_and_b32 v79, 0xffff0000, v29
    v_lshlrev_b32 v64, 16, v22
    v_lshlrev_b32 v80, 16, v30
    v_and_b32 v65, 0xffff0000, v22
    v_and_b32 v81, 0xffff0000, v30
    v_lshlrev_b32 v66, 16, v23
    v_lshlrev_b32 v82, 16, v31
    v_and_b32 v67, 0xffff0000, v23
    v_and_b32 v83, 0xffff0000, v31
    v_lshlrev_b32 v68, 16, v24
    v_lshlrev_b32 v84, 16, v32
    v_and_b32 v69, 0xffff0000, v24
    v_and_b32 v85, 0xffff0000, v32
    v_lshlrev_b32 v70, 16, v25
    v_lshlrev_b32 v86, 16, v33
    v_and_b32 v71, 0xffff0000, v25
    v_and_b32 v87, 0xffff0000, v33
    v_lshlrev_b32 v72, 16, v26
    v_lshlrev_b32 v88, 16, v34
    v_and_b32 v73, 0xffff0000, v26
    v_and_b32 v89, 0xffff0000, v34
    v_lshlrev_b32 v74, 16, v27
    v_lshlrev_b32 v90, 16, v35
    v_and_b32 v75, 0xffff0000, v27
    v_and_b32 v91, 0xffff0000, v35
    v_pk_add_f32 v[92:93], v[60:61], v[62:63]
    v_pk_add_f32 v[100:101], v[76:77], v[78:79]
    v_pk_add_f32 v[92:93], v[92:93], v[64:65]
    v_pk_add_f32 v[100:101], v[100:101], v[80:81]
    v_pk_add_f32 v[92:93], v[92:93], v[66:67]
    v_pk_add_f32 v[100:101], v[100:101], v[82:83]
    v_pk_add_f32 v[92:93], v[92:93], v[68:69]
    v_pk_add_f32 v[100:101], v[100:101], v[84:85]
    v_pk_add_f32 v[92:93], v[92:93], v[70:71]
    v_pk_add_f32 v[100:101], v[100:101], v[86:87]
    v_pk_add_f32 v[92:93], v[92:93], v[72:73]
    v_pk_add_f32 v[100:101], v[100:101], v[88:89]
    v_pk_add_f32 v[92:93], v[92:93], v[74:75]
    v_pk_add_f32 v[100:101], v[100:101], v[90:91]
    v_add_f32 v92, v92, v93
    v_add_f32 v100, v100, v101
    s_nop 0
    v_add_f32_dpp v92, v92, v92 quad_perm:[1,0,3,2] row_mask:0xf bank_mask:0xf
    v_add_f32_dpp v100, v100, v100 quad_perm:[1,0,3,2] row_mask:0xf bank_mask:0xf
    s_nop 0
    v_add_f32_dpp v92, v92, v92 quad_perm:[2,3,0,1] row_mask:0xf bank_mask:0xf
    v_add_f32_dpp v100, v100, v100 quad_perm:[2,3,0,1] row_mask:0xf bank_mask:0xf
    s_nop 0
    v_add_f32_dpp v92, v92, v92 row_half_mirror row_mask:0xf bank_mask:0xf
    v_add_f32_dpp v100, v100, v100 row_half_mirror row_mask:0xf bank_mask:0xf
    s_nop 0
    v_add_f32_dpp v92, v92, v92 row_mirror row_mask:0xf bank_mask:0xf
    v_add_f32_dpp v100, v100, v100 row_mirror row_mask:0xf bank_mask:0xf
    v_readlane_b32 s36, v92, 0
    v_readlane_b32 s56, v100, 0
    v_readlane_b32 s37, v92, 16
    v_readlane_b32 s57, v100, 16
    v_readlane_b32 s38, v92, 32
    v_readlane_b32 s58, v100, 32
    v_readlane_b32 s39, v92, 48
    v_readlane_b32 s59, v100, 48
    v_mov_b32 v96, s36
    v_mov_b32 v104, s56
    v_add_f32 v96, s37, v96
    v_add_f32 v104, s57, v104
    v_add_f32 v96, s38, v96
    v_add_f32 v104, s58, v104
    v_add_f32 v96, s39, v96
    v_add_f32 v104, s59, v104
    v_mul_f32 v96, 0xba800000, v96
    v_mul_f32 v104, 0xba800000, v104
    v_mov_b32 v97, v96
    v_mov_b32 v105, v104
    v_pk_add_f32 v[94:95], v[60:61], v[96:97]
    v_pk_add_f32 v[102:103], v[76:77], v[104:105]
    v_pk_mul_f32 v[92:93], v[94:95], v[94:95]
    v_pk_mul_f32 v[100:101], v[102:103], v[102:103]
    v_pk_add_f32 v[94:95], v[62:63], v[96:97]
    v_pk_add_f32 v[102:103], v[78:79], v[104:105]
    v_pk_fma_f32 v[92:93], v[94:95], v[94:95], v[92:93]
    v_pk_fma_f32 v[100:101], v[102:103], v[102:103], v[100:101]
    v_pk_add_f32 v[94:95], v[64:65], v[96:97]
    v_pk_add_f32 v[102:103], v[80:81], v[104:105]
    v_pk_fma_f32 v[92:93], v[94:95], v[94:95], v[92:93]
    v_pk_fma_f32 v[100:101], v[102:103], v[102:103], v[100:101]
    v_pk_add_f32 v[94:95], v[66:67], v[96:97]
    v_pk_add_f32 v[102:103], v[82:83], v[104:105]
    v_pk_fma_f32 v[92:93], v[94:95], v[94:95], v[92:93]
    v_pk_fma_f32 v[100:101], v[102:103], v[102:103], v[100:101]
    v_pk_add_f32 v[94:95], v[68:69], v[96:97]
    v_pk_add_f32 v[102:103], v[84:85], v[104:105]
    v_pk_fma_f32 v[92:93], v[94:95], v[94:95], v[92:93]
    v_pk_fma_f32 v[100:101], v[102:103], v[102:103], v[100:101]
    v_pk_add_f32 v[94:95], v[70:71], v[96:97]
    v_pk_add_f32 v[102:103], v[86:87], v[104:105]
    v_pk_fma_f32 v[92:93], v[94:95], v[94:95], v[92:93]
    v_pk_fma_f32 v[100:101], v[102:103], v[102:103], v[100:101]
    v_pk_add_f32 v[94:95], v[72:73], v[96:97]
    v_pk_add_f32 v[102:103], v[88:89], v[104:105]
    v_pk_fma_f32 v[92:93], v[94:95], v[94:95], v[92:93]
    v_pk_fma_f32 v[100:101], v[102:103], v[102:103], v[100:101]
    v_pk_add_f32 v[94:95], v[74:75], v[96:97]
    v_pk_add_f32 v[102:103], v[90:91], v[104:105]
    v_pk_fma_f32 v[92:93], v[94:95], v[94:95], v[92:93]
    v_pk_fma_f32 v[100:101], v[102:103], v[102:103], v[100:101]
    v_add_f32 v92, v92, v93
    v_add_f32 v100, v100, v101
    s_nop 0
    v_add_f32_dpp v92, v92, v92 quad_perm:[1,0,3,2] row_mask:0xf bank_mask:0xf
    v_add_f32_dpp v100, v100, v100 quad_perm:[1,0,3,2] row_mask:0xf bank_mask:0xf
    s_nop 0
    v_add_f32_dpp v92, v92, v92 quad_perm:[2,3,0,1] row_mask:0xf bank_mask:0xf
    v_add_f32_dpp v100, v100, v100 quad_perm:[2,3,0,1] row_mask:0xf bank_mask:0xf
    s_nop 0
    v_add_f32_dpp v92, v92, v92 row_half_mirror row_mask:0xf bank_mask:0xf
    v_add_f32_dpp v100, v100, v100 row_half_mirror row_mask:0xf bank_mask:0xf
    s_nop 0
    v_add_f32_dpp v92, v92, v92 row_mirror row_mask:0xf bank_mask:0xf
    v_add_f32_dpp v100, v100, v100 row_mirror row_mask:0xf bank_mask:0xf
    v_readlane_b32 s36, v92, 0
    v_readlane_b32 s56, v100, 0
    v_readlane_b32 s37, v92, 16
    v_readlane_b32 s57, v100, 16
    v_readlane_b32 s38, v92, 32
    v_readlane_b32 s58, v100, 32
    v_readlane_b32 s39, v92, 48
    v_readlane_b32 s59, v100, 48
    v_mov_b32 v94, s36
    v_mov_b32 v102, s56
    v_add_f32 v94, s37, v94
    v_add_f32 v102, s57, v102
    v_add_f32 v94, s38, v94
    v_add_f32 v102, s58, v102
    v_add_f32 v94, s39, v94
    v_add_f32 v102, s59, v102
    v_mul_f32 v94, 0x3a800000, v94
    v_mul_f32 v102, 0x3a800000, v102
    v_cvt_pk_bf16_f32 v95, v96, v94
    v_cvt_pk_bf16_f32 v103, v104, v102
    v_lshlrev_b32 v96, 16, v95
    v_lshlrev_b32 v104, 16, v103
    v_and_b32 v94, 0xffff0000, v95
    v_and_b32 v102, 0xffff0000, v103
    v_add_f32 v94, 0x3727c5ac, v94
    v_add_f32 v102, 0x3727c5ac, v102
    v_cvt_pk_bf16_f32 v94, v94, v94
    v_cvt_pk_bf16_f32 v102, v102, v102
    v_lshlrev_b32 v94, 16, v94
    v_lshlrev_b32 v102, 16, v102
    v_sqrt_f32 v94, v94
    v_sqrt_f32 v102, v102
    v_mov_b32 v97, v96
    v_mov_b32 v105, v104
    v_cvt_pk_bf16_f32 v94, v94, v94
    v_cvt_pk_bf16_f32 v102, v102, v102
    v_lshlrev_b32 v94, 16, v94
    v_lshlrev_b32 v102, 16, v102
    v_rcp_f32 v99, v94
    v_rcp_f32 v107, v102
    v_fma_f32 v95, -v94, v99, 1.0
    v_fma_f32 v103, -v102, v107, 1.0
    v_fma_f32 v99, v95, v99, v99
    v_fma_f32 v107, v103, v107, v107
    v_mov_b32 v98, v99
    v_mov_b32 v106, v107
    v_pk_add_f32 v[60:61], v[60:61], v[96:97]
    v_pk_add_f32 v[76:77], v[76:77], v[104:105]
    v_cvt_pk_bf16_f32 v94, v60, v61
    v_cvt_pk_bf16_f32 v102, v76, v77
    v_lshlrev_b32 v60, 16, v94
    v_lshlrev_b32 v76, 16, v102
    v_and_b32 v61, 0xffff0000, v94
    v_and_b32 v77, 0xffff0000, v102
    v_pk_mul_f32 v[60:61], v[60:61], v[98:99]
    v_pk_mul_f32 v[76:77], v[76:77], v[106:107]
    v_cvt_pk_bf16_f32 v108, v60, v61
    v_cvt_pk_bf16_f32 v120, v76, v77
    v_lshlrev_b32 v60, 16, v108
    v_lshlrev_b32 v76, 16, v120
    v_and_b32 v61, 0xffff0000, v108
    v_and_b32 v77, 0xffff0000, v120
    v_pk_mul_f32 v[92:93], v[60:61], v[44:45]
    v_pk_mul_f32 v[100:101], v[76:77], v[44:45]
    v_pk_add_f32 v[62:63], v[62:63], v[96:97]
    v_pk_add_f32 v[78:79], v[78:79], v[104:105]
    v_cvt_pk_bf16_f32 v94, v62, v63
    v_cvt_pk_bf16_f32 v102, v78, v79
    v_lshlrev_b32 v62, 16, v94
    v_lshlrev_b32 v78, 16, v102
    v_and_b32 v63, 0xffff0000, v94
    v_and_b32 v79, 0xffff0000, v102
    v_pk_mul_f32 v[62:63], v[62:63], v[98:99]
    v_pk_mul_f32 v[78:79], v[78:79], v[106:107]
    v_cvt_pk_bf16_f32 v109, v62, v63
    v_cvt_pk_bf16_f32 v121, v78, v79
    v_lshlrev_b32 v62, 16, v109
    v_lshlrev_b32 v78, 16, v121
    v_and_b32 v63, 0xffff0000, v109
    v_and_b32 v79, 0xffff0000, v121
    v_pk_fma_f32 v[92:93], v[62:63], v[46:47], v[92:93]
    v_pk_fma_f32 v[100:101], v[78:79], v[46:47], v[100:101]
    v_pk_add_f32 v[64:65], v[64:65], v[96:97]
    v_pk_add_f32 v[80:81], v[80:81], v[104:105]
    v_cvt_pk_bf16_f32 v94, v64, v65
    v_cvt_pk_bf16_f32 v102, v80, v81
    v_lshlrev_b32 v64, 16, v94
    v_lshlrev_b32 v80, 16, v102
    v_and_b32 v65, 0xffff0000, v94
    v_and_b32 v81, 0xffff0000, v102
    v_pk_mul_f32 v[64:65], v[64:65], v[98:99]
    v_pk_mul_f32 v[80:81], v[80:81], v[106:107]
    v_cvt_pk_bf16_f32 v110, v64, v65
    v_cvt_pk_bf16_f32 v122, v80, v81
    v_lshlrev_b32 v64, 16, v110
    v_lshlrev_b32 v80, 16, v122
    v_and_b32 v65, 0xffff0000, v110
    v_and_b32 v81, 0xffff0000, v122
    v_pk_fma_f32 v[92:93], v[64:65], v[48:49], v[92:93]
    v_pk_fma_f32 v[100:101], v[80:81], v[48:49], v[100:101]
    v_pk_add_f32 v[66:67], v[66:67], v[96:97]
    v_pk_add_f32 v[82:83], v[82:83], v[104:105]
    v_cvt_pk_bf16_f32 v94, v66, v67
    v_cvt_pk_bf16_f32 v102, v82, v83
    v_lshlrev_b32 v66, 16, v94
    v_lshlrev_b32 v82, 16, v102
    v_and_b32 v67, 0xffff0000, v94
    v_and_b32 v83, 0xffff0000, v102
    v_pk_mul_f32 v[66:67], v[66:67], v[98:99]
    v_pk_mul_f32 v[82:83], v[82:83], v[106:107]
    v_cvt_pk_bf16_f32 v111, v66, v67
    v_cvt_pk_bf16_f32 v123, v82, v83
    v_lshlrev_b32 v66, 16, v111
    v_lshlrev_b32 v82, 16, v123
    v_and_b32 v67, 0xffff0000, v111
    v_and_b32 v83, 0xffff0000, v123
    v_pk_fma_f32 v[92:93], v[66:67], v[50:51], v[92:93]
    v_pk_fma_f32 v[100:101], v[82:83], v[50:51], v[100:101]
    v_pk_add_f32 v[68:69], v[68:69], v[96:97]
    v_pk_add_f32 v[84:85], v[84:85], v[104:105]
    v_cvt_pk_bf16_f32 v94, v68, v69
    v_cvt_pk_bf16_f32 v102, v84, v85
    v_lshlrev_b32 v68, 16, v94
    v_lshlrev_b32 v84, 16, v102
    v_and_b32 v69, 0xffff0000, v94
    v_and_b32 v85, 0xffff0000, v102
    v_pk_mul_f32 v[68:69], v[68:69], v[98:99]
    v_pk_mul_f32 v[84:85], v[84:85], v[106:107]
    v_cvt_pk_bf16_f32 v112, v68, v69
    v_cvt_pk_bf16_f32 v124, v84, v85
    v_lshlrev_b32 v68, 16, v112
    v_lshlrev_b32 v84, 16, v124
    v_and_b32 v69, 0xffff0000, v112
    v_and_b32 v85, 0xffff0000, v124
    v_pk_fma_f32 v[92:93], v[68:69], v[52:53], v[92:93]
    v_pk_fma_f32 v[100:101], v[84:85], v[52:53], v[100:101]
    v_pk_add_f32 v[70:71], v[70:71], v[96:97]
    v_pk_add_f32 v[86:87], v[86:87], v[104:105]
    v_cvt_pk_bf16_f32 v94, v70, v71
    v_cvt_pk_bf16_f32 v102, v86, v87
    v_lshlrev_b32 v70, 16, v94
    v_lshlrev_b32 v86, 16, v102
    v_and_b32 v71, 0xffff0000, v94
    v_and_b32 v87, 0xffff0000, v102
    v_pk_mul_f32 v[70:71], v[70:71], v[98:99]
    v_pk_mul_f32 v[86:87], v[86:87], v[106:107]
    v_cvt_pk_bf16_f32 v113, v70, v71
    v_cvt_pk_bf16_f32 v125, v86, v87
    v_lshlrev_b32 v70, 16, v113
    v_lshlrev_b32 v86, 16, v125
    v_and_b32 v71, 0xffff0000, v113
    v_and_b32 v87, 0xffff0000, v125
    v_pk_fma_f32 v[92:93], v[70:71], v[54:55], v[92:93]
    v_pk_fma_f32 v[100:101], v[86:87], v[54:55], v[100:101]
    v_pk_add_f32 v[72:73], v[72:73], v[96:97]
    v_pk_add_f32 v[88:89], v[88:89], v[104:105]
    v_cvt_pk_bf16_f32 v94, v72, v73
    v_cvt_pk_bf16_f32 v102, v88, v89
    v_lshlrev_b32 v72, 16, v94
    v_lshlrev_b32 v88, 16, v102
    v_and_b32 v73, 0xffff0000, v94
    v_and_b32 v89, 0xffff0000, v102
    v_pk_mul_f32 v[72:73], v[72:73], v[98:99]
    v_pk_mul_f32 v[88:89], v[88:89], v[106:107]
    v_cvt_pk_bf16_f32 v114, v72, v73
    v_cvt_pk_bf16_f32 v126, v88, v89
    v_lshlrev_b32 v72, 16, v114
    v_lshlrev_b32 v88, 16, v126
    v_and_b32 v73, 0xffff0000, v114
    v_and_b32 v89, 0xffff0000, v126
    v_pk_fma_f32 v[92:93], v[72:73], v[56:57], v[92:93]
    v_pk_fma_f32 v[100:101], v[88:89], v[56:57], v[100:101]
    v_pk_add_f32 v[74:75], v[74:75], v[96:97]
    v_pk_add_f32 v[90:91], v[90:91], v[104:105]
    v_cvt_pk_bf16_f32 v94, v74, v75
    v_cvt_pk_bf16_f32 v102, v90, v91
    v_lshlrev_b32 v74, 16, v94
    v_lshlrev_b32 v90, 16, v102
    v_and_b32 v75, 0xffff0000, v94
    v_and_b32 v91, 0xffff0000, v102
    v_pk_mul_f32 v[74:75], v[74:75], v[98:99]
    v_pk_mul_f32 v[90:91], v[90:91], v[106:107]
    v_cvt_pk_bf16_f32 v115, v74, v75
    v_cvt_pk_bf16_f32 v127, v90, v91
    v_lshlrev_b32 v74, 16, v115
    v_lshlrev_b32 v90, 16, v127
    v_and_b32 v75, 0xffff0000, v115
    v_and_b32 v91, 0xffff0000, v127
    v_pk_fma_f32 v[92:93], v[74:75], v[58:59], v[92:93]
    v_pk_fma_f32 v[100:101], v[90:91], v[58:59], v[100:101]
    v_add_f32 v92, v92, v93
    v_add_f32 v100, v100, v101
    v_xor_b32 v98, 0x80000000, v96
    v_xor_b32 v106, 0x80000000, v104
    s_mul_i32 s36, s60, 2064
    s_mul_i32 s56, s28, 2064
    s_add_u32 s36, s36, 131072
    s_add_u32 s56, s56, 131072
    v_lshl_add_u32 v95, v1, 4, s36
    v_lshl_add_u32 v103, v1, 4, s56
    ds_write_b128 v95, v[108:111]
    ds_write_b128 v103, v[120:123]
    ds_write_b128 v95, v[112:115] offset:1024
    ds_write_b128 v103, v[124:127] offset:1024
    s_nop 0
    v_add_f32_dpp v92, v92, v92 quad_perm:[1,0,3,2] row_mask:0xf bank_mask:0xf
    v_add_f32_dpp v100, v100, v100 quad_perm:[1,0,3,2] row_mask:0xf bank_mask:0xf
    s_nop 0
    v_add_f32_dpp v92, v92, v92 quad_perm:[2,3,0,1] row_mask:0xf bank_mask:0xf
    v_add_f32_dpp v100, v100, v100 quad_perm:[2,3,0,1] row_mask:0xf bank_mask:0xf
    s_nop 0
    v_add_f32_dpp v92, v92, v92 row_half_mirror row_mask:0xf bank_mask:0xf
    v_add_f32_dpp v100, v100, v100 row_half_mirror row_mask:0xf bank_mask:0xf
    s_nop 0
    v_add_f32_dpp v92, v92, v92 row_mirror row_mask:0xf bank_mask:0xf
    v_add_f32_dpp v100, v100, v100 row_mirror row_mask:0xf bank_mask:0xf
    v_readlane_b32 s36, v92, 0
    v_readlane_b32 s56, v100, 0
    v_readlane_b32 s37, v92, 16
    v_readlane_b32 s57, v100, 16
    v_readlane_b32 s38, v92, 32
    v_readlane_b32 s58, v100, 32
    v_readlane_b32 s39, v92, 48
    v_readlane_b32 s59, v100, 48
    v_mov_b32 v93, s36
    v_mov_b32 v101, s56
    v_add_f32 v93, s37, v93
    v_add_f32 v101, s57, v101
    v_add_f32 v93, s38, v93
    v_add_f32 v101, s58, v101
    v_add_f32 v93, s39, v93
    v_add_f32 v101, s59, v101
    v_cvt_pk_bf16_f32 v93, v93, v93
    v_cvt_pk_bf16_f32 v101, v101, v101
    v_lshlrev_b32 v93, 16, v93
    v_lshlrev_b32 v101, 16, v101
    v_ashrrev_i32 v95, 31, v93
    v_ashrrev_i32 v103, 31, v101
    v_or_b32 v95, 0x80000000, v95
    v_or_b32 v103, 0x80000000, v103
    v_xor_b32 v95, v93, v95
    v_xor_b32 v103, v101, v103
    v_and_b32 v95, 0xffff0000, v95
    v_and_b32 v103, 0xffff0000, v103
    s_sub_u32 s36, 0xffff, s42
    s_sub_u32 s56, 0xffff, s43
    v_or_b32 v95, s36, v95
    v_or_b32 v103, s56, v103
    s_lshl_b32 s37, s60, 3
    s_lshl_b32 s57, s28, 3
    s_add_u32 s37, s37, 147712
    s_add_u32 s57, s57, 147712
    v_mov_b32 v94, s37
    v_mov_b32 v102, s57
    ds_write_b64 v94, v[98:99]
    ds_write_b64 v102, v[106:107]
    ds_write_b32 v94, v95 offset:64
    ds_write_b32 v102, v103 offset:64
    s_lshl_b32 s36, s2, 13
    s_lshl_b32 s37, s60, 11
    s_add_u32 s36, s36, s37
    v_lshl_add_u32 v16, v1, 7, s36
    s_cmp_lt_u32 s60, 2
    s_cselect_b64 s[38:39], s[48:49], s[50:51]
    s_lshr_b32 s36, s2, 3
    s_lshl_b32 s36, s36, 1
    s_and_b32 s37, s60, 1
    s_add_u32 s36, s36, s37
    s_lshl_b32 s36, s36, 16
    s_and_b32 s37, s29, 28
    s_lshl_b32 s37, s37, 8
    s_add_u32 s36, s36, s37
    s_sub_u32 s37, 256, s38
    s_and_b32 s37, s37, 0x300
    s_add_u32 s36, s36, s37
    v_lshrrev_b32 v18, 1, v1
    v_lshl_add_u32 v18, v18, 13, s36
    v_and_b32 v19, 1, v1
    v_lshl_add_u32 v18, v19, 7, v18
    s_mov_b64 exec, 0xffff
    global_load_dword v0, v16, s[46:47]
    global_load_dword v0, v18, s[38:39]
    s_mov_b64 exec, -1
    s_waitcnt lgkmcnt(0)
    s_cmp_eq_u32 s3, 0
    s_mov_b32 s3, 0
    s_cbranch_scc0 L_ln
L_pro_j:
    s_barrier
    ds_read_b128 v[20:23], v10 offset:0
    ds_read_b64_tr_b16 v[52:53], v12 offset:0
    ds_read_b64_tr_b16 v[54:55], v12 offset:1024
    ds_read_b64_tr_b16 v[56:57], v13 offset:0
    ds_read_b64_tr_b16 v[58:59], v13 offset:1024
    ds_read_b64_tr_b16 v[60:61], v14 offset:0
    ds_read_b64_tr_b16 v[62:63], v14 offset:1024
    ds_read_b64_tr_b16 v[64:65], v15 offset:0
    ds_read_b64_tr_b16 v[66:67], v15 offset:1024
    ds_read_b128 v[24:27], v10 offset:2048
    ds_read_b128 v[28:31], v10 offset:4096
    ds_read_b128 v[32:35], v10 offset:6144
    ds_read_b128 v[36:39], v10 offset:8192
    ds_read_b128 v[40:43], v10 offset:10240
    ds_read_b128 v[44:47], v10 offset:12288
    ds_read_b128 v[48:51], v10 offset:14336
    s_add_u32 s36, s2, s28
    s_cmp_eq_u32 s36, 0
    s_cbranch_scc1 L_recurrent_scan__compressed_kv_cla__moe_arch_mod__prompt_kernel_rare_3
L_recurrent_scan__compressed_kv_cla__moe_arch_mod__prompt_kernel_back_4:
    s_mov_b32 s35, 0
    s_cmp_eq_u32 s28, 0
    s_cselect_b32 s43, 9, 0
    s_cselect_b32 s44, 2, 1
    s_cmp_lt_u32 s28, 4
    s_cbranch_scc0 L_kv_vloop
    .p2align 6
L_kv_kloop:
    s_waitcnt lgkmcnt(0)
    v_mfma_f32_16x16x32_bf16 v[128:131], v[52:55], v[20:23], v[128:131]
    ds_read_b128 v[68:71], v11 offset:0
    v_mfma_f32_16x16x32_bf16 v[132:135], v[56:59], v[20:23], v[132:135]
    ds_read_b64_tr_b16 v[100:101], v12 offset:8192
    v_mfma_f32_16x16x32_bf16 v[136:139], v[60:63], v[20:23], v[136:139]
    ds_read_b64_tr_b16 v[102:103], v12 offset:9216
    v_mfma_f32_16x16x32_bf16 v[140:143], v[64:67], v[20:23], v[140:143]
    ds_read_b64_tr_b16 v[104:105], v13 offset:8192
    v_mfma_f32_16x16x32_bf16 v[144:147], v[52:55], v[24:27], v[144:147]
    ds_read_b64_tr_b16 v[106:107], v13 offset:9216
    v_mfma_f32_16x16x32_bf16 v[148:151], v[56:59], v[24:27], v[148:151]
    ds_read_b64_tr_b16 v[108:109], v14 offset:8192
    v_mfma_f32_16x16x32_bf16 v[152:155], v[60:63], v[24:27], v[152:155]
    ds_read_b64_tr_b16 v[110:111], v14 offset:9216
    v_mfma_f32_16x16x32_bf16 v[156:159], v[64:67], v[24:27], v[156:159]
    ds_read_b64_tr_b16 v[112:113], v15 offset:8192
    v_mfma_f32_16x16x32_bf16 v[160:163], v[52:55], v[28:31], v[160:163]
    ds_read_b64_tr_b16 v[114:115], v15 offset:9216
    v_mfma_f32_16x16x32_bf16 v[164:167], v[56:59], v[28:31], v[164:167]
    ds_read_b128 v[72:75], v11 offset:2048
    v_mfma_f32_16x16x32_bf16 v[168:171], v[60:63], v[28:31], v[168:171]
    ds_read_b128 v[76:79], v11 offset:4096
    v_mfma_f32_16x16x32_bf16 v[172:175], v[64:67], v[28:31], v[172:175]
    ds_read_b128 v[80:83], v11 offset:6144
    v_mfma_f32_16x16x32_bf16 v[176:179], v[52:55], v[32:35], v[176:179]
    ds_read_b128 v[84:87], v11 offset:8192
    v_mfma_f32_16x16x32_bf16 v[180:183], v[56:59], v[32:35], v[180:183]
    ds_read_b128 v[88:91], v11 offset:10240
    v_mfma_f32_16x16x32_bf16 v[184:187], v[60:63], v[32:35], v[184:187]
    ds_read_b128 v[92:95], v11 offset:12288
    v_mfma_f32_16x16x32_bf16 v[188:191], v[64:67], v[32:35], v[188:191]
    ds_read_b128 v[96:99], v11 offset:14336
    v_mfma_f32_16x16x32_bf16 v[192:195], v[52:55], v[36:39], v[192:195]
    v_mfma_f32_16x16x32_bf16 v[196:199], v[56:59], v[36:39], v[196:199]
    v_mfma_f32_16x16x32_bf16 v[200:203], v[60:63], v[36:39], v[200:203]
    v_mfma_f32_16x16x32_bf16 v[204:207], v[64:67], v[36:39], v[204:207]
    v_mfma_f32_16x16x32_bf16 v[208:211], v[52:55], v[40:43], v[208:211]
    v_mfma_f32_16x16x32_bf16 v[212:215], v[56:59], v[40:43], v[212:215]
    v_mfma_f32_16x16x32_bf16 v[216:219], v[60:63], v[40:43], v[216:219]
    v_mfma_f32_16x16x32_bf16 v[220:223], v[64:67], v[40:43], v[220:223]
    v_mfma_f32_16x16x32_bf16 v[224:227], v[52:55], v[44:47], v[224:227]
    v_mfma_f32_16x16x32_bf16 v[228:231], v[56:59], v[44:47], v[228:231]
    v_mfma_f32_16x16x32_bf16 v[232:235], v[60:63], v[44:47], v[232:235]
    v_mfma_f32_16x16x32_bf16 v[236:239], v[64:67], v[44:47], v[236:239]
    v_mfma_f32_16x16x32_bf16 v[240:243], v[52:55], v[48:51], v[240:243]
    v_mfma_f32_16x16x32_bf16 v[244:247], v[56:59], v[48:51], v[244:247]
    v_mfma_f32_16x16x32_bf16 v[248:251], v[60:63], v[48:51], v[248:251]
    v_mfma_f32_16x16x32_bf16 v[252:255], v[64:67], v[48:51], v[252:255]
    s_cmp_eq_u32 s35, 3
    s_cbranch_scc1 L_recurrent_scan__compressed_kv_cla__moe_arch_mod__prompt_kernel_rare_5
L_recurrent_scan__compressed_kv_cla__moe_arch_mod__prompt_kernel_back_6:
    s_cmp_lt_u32 s35, s44
    s_cbranch_scc1 L_recurrent_scan__compressed_kv_cla__moe_arch_mod__prompt_kernel_w0_7
    s_waitcnt vmcnt(1)
L_recurrent_scan__compressed_kv_cla__moe_arch_mod__prompt_kernel_w0b_8:
    s_waitcnt lgkmcnt(0)
    s_barrier
    v_mfma_f32_16x16x32_bf16 v[128:131], v[100:103], v[68:71], v[128:131]
    ds_read_b128 v[20:23], v10 offset:32768
    s_add_u32 m0, s33, 0
    v_mfma_f32_16x16x32_bf16 v[132:135], v[104:107], v[68:71], v[132:135]
    ds_read_b64_tr_b16 v[52:53], v12 offset:32768
    buffer_load_dwordx4 v2, s[4:7], s31 offen offset:0 lds
    v_mfma_f32_16x16x32_bf16 v[136:139], v[108:111], v[68:71], v[136:139]
    ds_read_b64_tr_b16 v[54:55], v12 offset:33792
    v_mfma_f32_16x16x32_bf16 v[140:143], v[112:115], v[68:71], v[140:143]
    ds_read_b64_tr_b16 v[56:57], v13 offset:32768
    v_mfma_f32_16x16x32_bf16 v[144:147], v[100:103], v[72:75], v[144:147]
    ds_read_b64_tr_b16 v[58:59], v13 offset:33792
    buffer_load_dwordx4 v3, s[4:7], s31 offen offset:1024 lds
    v_mfma_f32_16x16x32_bf16 v[148:151], v[104:107], v[72:75], v[148:151]
    ds_read_b64_tr_b16 v[60:61], v14 offset:32768
    v_mfma_f32_16x16x32_bf16 v[152:155], v[108:111], v[72:75], v[152:155]
    ds_read_b64_tr_b16 v[62:63], v14 offset:33792
    v_mfma_f32_16x16x32_bf16 v[156:159], v[112:115], v[72:75], v[156:159]
    ds_read_b64_tr_b16 v[64:65], v15 offset:32768
    buffer_load_dwordx4 v4, s[4:7], s31 offen offset:2048 lds
    v_mfma_f32_16x16x32_bf16 v[160:163], v[100:103], v[76:79], v[160:163]
    ds_read_b64_tr_b16 v[66:67], v15 offset:33792
    v_mfma_f32_16x16x32_bf16 v[164:167], v[104:107], v[76:79], v[164:167]
    ds_read_b128 v[24:27], v10 offset:34816
    v_mfma_f32_16x16x32_bf16 v[168:171], v[108:111], v[76:79], v[168:171]
    ds_read_b128 v[28:31], v10 offset:36864
    buffer_load_dwordx4 v5, s[4:7], s31 offen offset:3072 lds
    v_mfma_f32_16x16x32_bf16 v[172:175], v[112:115], v[76:79], v[172:175]
    ds_read_b128 v[32:35], v10 offset:38912
    v_mfma_f32_16x16x32_bf16 v[176:179], v[100:103], v[80:83], v[176:179]
    ds_read_b128 v[36:39], v10 offset:40960
    s_add_u32 m0, s34, 0
    v_mfma_f32_16x16x32_bf16 v[180:183], v[104:107], v[80:83], v[180:183]
    ds_read_b128 v[40:43], v10 offset:43008
    buffer_load_dwordx4 v6, s[8:11], s32 offen offset:0 nt lds
    v_mfma_f32_16x16x32_bf16 v[184:187], v[108:111], v[80:83], v[184:187]
    ds_read_b128 v[44:47], v10 offset:45056
    v_mfma_f32_16x16x32_bf16 v[188:191], v[112:115], v[80:83], v[188:191]
    ds_read_b128 v[48:51], v10 offset:47104
    v_mfma_f32_16x16x32_bf16 v[192:195], v[100:103], v[84:87], v[192:195]
    buffer_load_dwordx4 v7, s[8:11], s32 offen offset:1024 nt lds
    v_mfma_f32_16x16x32_bf16 v[196:199], v[104:107], v[84:87], v[196:199]
    v_mfma_f32_16x16x32_bf16 v[200:203], v[108:111], v[84:87], v[200:203]
    v_mfma_f32_16x16x32_bf16 v[204:207], v[112:115], v[84:87], v[204:207]
    buffer_load_dwordx4 v8, s[8:11], s32 offen offset:2048 nt lds
    v_mfma_f32_16x16x32_bf16 v[208:211], v[100:103], v[88:91], v[208:211]
    v_mfma_f32_16x16x32_bf16 v[212:215], v[104:107], v[88:91], v[212:215]
    v_mfma_f32_16x16x32_bf16 v[216:219], v[108:111], v[88:91], v[216:219]
    buffer_load_dwordx4 v9, s[8:11], s32 offen offset:3072 nt lds
    v_mfma_f32_16x16x32_bf16 v[220:223], v[112:115], v[88:91], v[220:223]
    v_mfma_f32_16x16x32_bf16 v[224:227], v[100:103], v[92:95], v[224:227]
    v_mfma_f32_16x16x32_bf16 v[228:231], v[104:107], v[92:95], v[228:231]
    v_mfma_f32_16x16x32_bf16 v[232:235], v[108:111], v[92:95], v[232:235]
    s_cmp_eq_u32 s35, 3
    s_cbranch_scc1 L_recurrent_scan__compressed_kv_cla__moe_arch_mod__prompt_kernel_rare_11
L_recurrent_scan__compressed_kv_cla__moe_arch_mod__prompt_kernel_back_12:
    v_mfma_f32_16x16x32_bf16 v[236:239], v[112:115], v[92:95], v[236:239]
    v_mfma_f32_16x16x32_bf16 v[240:243], v[100:103], v[96:99], v[240:243]
    v_mfma_f32_16x16x32_bf16 v[244:247], v[104:107], v[96:99], v[244:247]
    v_mfma_f32_16x16x32_bf16 v[248:251], v[108:111], v[96:99], v[248:251]
    v_mfma_f32_16x16x32_bf16 v[252:255], v[112:115], v[96:99], v[252:255]
    buffer_load_dword v0, v17, s[16:19], s45 offen
    s_add_u32 s45, s45, 8192
    s_add_u32 s31, s31, s40
    s_add_u32 s32, s32, s41
    s_waitcnt lgkmcnt(0)
    v_mfma_f32_16x16x32_bf16 v[128:131], v[52:55], v[20:23], v[128:131]
    ds_read_b128 v[68:71], v11 offset:32768
    v_mfma_f32_16x16x32_bf16 v[132:135], v[56:59], v[20:23], v[132:135]
    ds_read_b64_tr_b16 v[100:101], v12 offset:40960
    v_mfma_f32_16x16x32_bf16 v[136:139], v[60:63], v[20:23], v[136:139]
    ds_read_b64_tr_b16 v[102:103], v12 offset:41984
    v_mfma_f32_16x16x32_bf16 v[140:143], v[64:67], v[20:23], v[140:143]
    ds_read_b64_tr_b16 v[104:105], v13 offset:40960
    v_mfma_f32_16x16x32_bf16 v[144:147], v[52:55], v[24:27], v[144:147]
    ds_read_b64_tr_b16 v[106:107], v13 offset:41984
    v_mfma_f32_16x16x32_bf16 v[148:151], v[56:59], v[24:27], v[148:151]
    ds_read_b64_tr_b16 v[108:109], v14 offset:40960
    v_mfma_f32_16x16x32_bf16 v[152:155], v[60:63], v[24:27], v[152:155]
    ds_read_b64_tr_b16 v[110:111], v14 offset:41984
    v_mfma_f32_16x16x32_bf16 v[156:159], v[64:67], v[24:27], v[156:159]
    ds_read_b64_tr_b16 v[112:113], v15 offset:40960
    v_mfma_f32_16x16x32_bf16 v[160:163], v[52:55], v[28:31], v[160:163]
    ds_read_b64_tr_b16 v[114:115], v15 offset:41984
    v_mfma_f32_16x16x32_bf16 v[164:167], v[56:59], v[28:31], v[164:167]
    ds_read_b128 v[72:75], v11 offset:34816
    v_mfma_f32_16x16x32_bf16 v[168:171], v[60:63], v[28:31], v[168:171]
    ds_read_b128 v[76:79], v11 offset:36864
    v_mfma_f32_16x16x32_bf16 v[172:175], v[64:67], v[28:31], v[172:175]
    ds_read_b128 v[80:83], v11 offset:38912
    v_mfma_f32_16x16x32_bf16 v[176:179], v[52:55], v[32:35], v[176:179]
    ds_read_b128 v[84:87], v11 offset:40960
    v_mfma_f32_16x16x32_bf16 v[180:183], v[56:59], v[32:35], v[180:183]
    ds_read_b128 v[88:91], v11 offset:43008
    v_mfma_f32_16x16x32_bf16 v[184:187], v[60:63], v[32:35], v[184:187]
    ds_read_b128 v[92:95], v11 offset:45056
    v_mfma_f32_16x16x32_bf16 v[188:191], v[64:67], v[32:35], v[188:191]
    ds_read_b128 v[96:99], v11 offset:47104
    v_mfma_f32_16x16x32_bf16 v[192:195], v[52:55], v[36:39], v[192:195]
    v_mfma_f32_16x16x32_bf16 v[196:199], v[56:59], v[36:39], v[196:199]
    v_mfma_f32_16x16x32_bf16 v[200:203], v[60:63], v[36:39], v[200:203]
    v_mfma_f32_16x16x32_bf16 v[204:207], v[64:67], v[36:39], v[204:207]
    v_mfma_f32_16x16x32_bf16 v[208:211], v[52:55], v[40:43], v[208:211]
    s_bitcmp1_b32 s43, s35
    s_cbranch_scc1 L_recurrent_scan__compressed_kv_cla__moe_arch_mod__prompt_kernel_rare_15
L_recurrent_scan__compressed_kv_cla__moe_arch_mod__prompt_kernel_back_16:
    v_mfma_f32_16x16x32_bf16 v[212:215], v[56:59], v[40:43], v[212:215]
    v_mfma_f32_16x16x32_bf16 v[216:219], v[60:63], v[40:43], v[216:219]
    v_mfma_f32_16x16x32_bf16 v[220:223], v[64:67], v[40:43], v[220:223]
    v_mfma_f32_16x16x32_bf16 v[224:227], v[52:55], v[44:47], v[224:227]
    v_mfma_f32_16x16x32_bf16 v[228:231], v[56:59], v[44:47], v[228:231]
    v_mfma_f32_16x16x32_bf16 v[232:235], v[60:63], v[44:47], v[232:235]
    v_mfma_f32_16x16x32_bf16 v[236:239], v[64:67], v[44:47], v[236:239]
    v_mfma_f32_16x16x32_bf16 v[240:243], v[52:55], v[48:51], v[240:243]
    v_mfma_f32_16x16x32_bf16 v[244:247], v[56:59], v[48:51], v[244:247]
    v_mfma_f32_16x16x32_bf16 v[248:251], v[60:63], v[48:51], v[248:251]
    v_mfma_f32_16x16x32_bf16 v[252:255], v[64:67], v[48:51], v[252:255]
    s_bitcmp1_b32 s43, s35
    s_cbranch_scc1 L_recurrent_scan__compressed_kv_cla__moe_arch_mod__prompt_kernel_w0_17
    s_waitcnt vmcnt(1)
L_recurrent_scan__compressed_kv_cla__moe_arch_mod__prompt_kernel_w0b_18:
    s_waitcnt lgkmcnt(0)
    s_cmp_eq_u32 s35, 3
    s_barrier
    s_cbranch_scc1 L_p1_fin0
    v_mfma_f32_16x16x32_bf16 v[128:131], v[100:103], v[68:71], v[128:131]
    ds_read_b128 v[20:23], v10 offset:0
    s_add_u32 m0, s33, 32768
    v_mfma_f32_16x16x32_bf16 v[132:135], v[104:107], v[68:71], v[132:135]
    ds_read_b64_tr_b16 v[52:53], v12 offset:0
    buffer_load_dwordx4 v2, s[4:7], s31 offen offset:0 lds
    v_mfma_f32_16x16x32_bf16 v[136:139], v[108:111], v[68:71], v[136:139]
    ds_read_b64_tr_b16 v[54:55], v12 offset:1024
    v_mfma_f32_16x16x32_bf16 v[140:143], v[112:115], v[68:71], v[140:143]
    ds_read_b64_tr_b16 v[56:57], v13 offset:0
    v_mfma_f32_16x16x32_bf16 v[144:147], v[100:103], v[72:75], v[144:147]
    ds_read_b64_tr_b16 v[58:59], v13 offset:1024
    buffer_load_dwordx4 v3, s[4:7], s31 offen offset:1024 lds
    v_mfma_f32_16x16x32_bf16 v[148:151], v[104:107], v[72:75], v[148:151]
    ds_read_b64_tr_b16 v[60:61], v14 offset:0
    v_mfma_f32_16x16x32_bf16 v[152:155], v[108:111], v[72:75], v[152:155]
    ds_read_b64_tr_b16 v[62:63], v14 offset:1024
    v_mfma_f32_16x16x32_bf16 v[156:159], v[112:115], v[72:75], v[156:159]
    ds_read_b64_tr_b16 v[64:65], v15 offset:0
    buffer_load_dwordx4 v4, s[4:7], s31 offen offset:2048 lds
    v_mfma_f32_16x16x32_bf16 v[160:163], v[100:103], v[76:79], v[160:163]
    ds_read_b64_tr_b16 v[66:67], v15 offset:1024
    v_mfma_f32_16x16x32_bf16 v[164:167], v[104:107], v[76:79], v[164:167]
    ds_read_b128 v[24:27], v10 offset:2048
    v_mfma_f32_16x16x32_bf16 v[168:171], v[108:111], v[76:79], v[168:171]
    ds_read_b128 v[28:31], v10 offset:4096
    buffer_load_dwordx4 v5, s[4:7], s31 offen offset:3072 lds
    v_mfma_f32_16x16x32_bf16 v[172:175], v[112:115], v[76:79], v[172:175]
    ds_read_b128 v[32:35], v10 offset:6144
    v_mfma_f32_16x16x32_bf16 v[176:179], v[100:103], v[80:83], v[176:179]
    ds_read_b128 v[36:39], v10 offset:8192
    s_add_u32 m0, s34, 32768
    v_mfma_f32_16x16x32_bf16 v[180:183], v[104:107], v[80:83], v[180:183]
    ds_read_b128 v[40:43], v10 offset:10240
    buffer_load_dwordx4 v6, s[8:11], s32 offen offset:0 nt lds
    v_mfma_f32_16x16x32_bf16 v[184:187], v[108:111], v[80:83], v[184:187]
    ds_read_b128 v[44:47], v10 offset:12288
    v_mfma_f32_16x16x32_bf16 v[188:191], v[112:115], v[80:83], v[188:191]
    ds_read_b128 v[48:51], v10 offset:14336
    v_mfma_f32_16x16x32_bf16 v[192:195], v[100:103], v[84:87], v[192:195]
    buffer_load_dwordx4 v7, s[8:11], s32 offen offset:1024 nt lds
    v_mfma_f32_16x16x32_bf16 v[196:199], v[104:107], v[84:87], v[196:199]
    v_mfma_f32_16x16x32_bf16 v[200:203], v[108:111], v[84:87], v[200:203]
    v_mfma_f32_16x16x32_bf16 v[204:207], v[112:115], v[84:87], v[204:207]
    buffer_load_dwordx4 v8, s[8:11], s32 offen offset:2048 nt lds
    v_mfma_f32_16x16x32_bf16 v[208:211], v[100:103], v[88:91], v[208:211]
    v_mfma_f32_16x16x32_bf16 v[212:215], v[104:107], v[88:91], v[212:215]
    v_mfma_f32_16x16x32_bf16 v[216:219], v[108:111], v[88:91], v[216:219]
    buffer_load_dwordx4 v9, s[8:11], s32 offen offset:3072 nt lds
    v_mfma_f32_16x16x32_bf16 v[220:223], v[112:115], v[88:91], v[220:223]
    v_mfma_f32_16x16x32_bf16 v[224:227], v[100:103], v[92:95], v[224:227]
    v_mfma_f32_16x16x32_bf16 v[228:231], v[104:107], v[92:95], v[228:231]
    v_mfma_f32_16x16x32_bf16 v[232:235], v[108:111], v[92:95], v[232:235]
    v_mfma_f32_16x16x32_bf16 v[236:239], v[112:115], v[92:95], v[236:239]
    v_mfma_f32_16x16x32_bf16 v[240:243], v[100:103], v[96:99], v[240:243]
    v_mfma_f32_16x16x32_bf16 v[244:247], v[104:107], v[96:99], v[244:247]
    v_mfma_f32_16x16x32_bf16 v[248:251], v[108:111], v[96:99], v[248:251]
    s_add_u32 s36, s35, s28
    s_cmp_eq_u32 s36, 0
    s_cbranch_scc1 L_recurrent_scan__compressed_kv_cla__moe_arch_mod__prompt_kernel_rare_27
L_recurrent_scan__compressed_kv_cla__moe_arch_mod__prompt_kernel_back_28:
    v_mfma_f32_16x16x32_bf16 v[252:255], v[112:115], v[96:99], v[252:255]
    buffer_load_dword v0, v17, s[16:19], s45 offen
    s_add_u32 s45, s45, 8192
    s_add_u32 s31, s31, s40
    s_add_u32 s32, s32, s41
    s_add_u32 s35, s35, 1
    s_branch L_kv_kloop
L_p1_fin0:
    v_mfma_f32_16x16x32_bf16 v[128:131], v[100:103], v[68:71], v[128:131]
    s_and_b32 s36, s28, 3
    s_sub_u32 s37, 15, s30
    s_cmp_lt_u32 s28, 4
    s_cselect_b32 s37, s37, s30
    s_lshl_b32 s37, s37, 2
    s_add_u32 s37, s37, s36
    s_lshl_b32 s37, s37, 16
    v_lshl_add_u32 v6, v1, 4, s37
    v_add_u32 v7, 32768, v6
    s_mov_b32 s32, 0
    s_mov_b32 s8, s54
    s_and_b32 s9, s55, 0xffff
    s_mov_b32 s10, 104857728
    s_mov_b32 s11, 0x20000
    v_mfma_f32_16x16x32_bf16 v[132:135], v[104:107], v[68:71], v[132:135]
    buffer_load_dwordx4 v[24:27], v6, s[8:11], s32 offen offset:0 sc1
    v_mfma_f32_16x16x32_bf16 v[136:139], v[108:111], v[68:71], v[136:139]
    v_lshrrev_b32 v18, 4, v1
    v_mfma_f32_16x16x32_bf16 v[140:143], v[112:115], v[68:71], v[140:143]
    v_bfe_u32 v20, v1, 2, 2
    v_mfma_f32_16x16x32_bf16 v[144:147], v[100:103], v[72:75], v[144:147]
    buffer_load_dwordx4 v[28:31], v7, s[8:11], s32 offen offset:0 sc1
    v_lshl_add_u32 v19, v18, 3, v20
    v_mfma_f32_16x16x32_bf16 v[148:151], v[104:107], v[72:75], v[148:151]
    v_lshlrev_b32 v19, 8, v19
    v_mfma_f32_16x16x32_bf16 v[152:155], v[108:111], v[72:75], v[152:155]
    v_and_b32 v21, 3, v1
    v_mfma_f32_16x16x32_bf16 v[156:159], v[112:115], v[72:75], v[156:159]
    buffer_load_dwordx4 v[32:35], v6, s[8:11], s32 offen offset:1024 sc1
    v_lshl_add_u32 v19, v21, 3, v19
    v_mfma_f32_16x16x32_bf16 v[160:163], v[100:103], v[76:79], v[160:163]
    v_and_b32 v21, 1, v18
    v_mfma_f32_16x16x32_bf16 v[164:167], v[104:107], v[76:79], v[164:167]
    v_lshl_add_u32 v20, v21, 2, v20
    v_mfma_f32_16x16x32_bf16 v[168:171], v[108:111], v[76:79], v[168:171]
    buffer_load_dwordx4 v[36:39], v7, s[8:11], s32 offen offset:1024 sc1
    v_xor_b32 v21, 0, v20
    v_mfma_f32_16x16x32_bf16 v[172:175], v[112:115], v[76:79], v[172:175]
    v_lshl_add_u32 v10, v21, 5, v19
    v_mfma_f32_16x16x32_bf16 v[176:179], v[100:103], v[80:83], v[176:179]
    v_xor_b32 v21, 1, v20
    v_mfma_f32_16x16x32_bf16 v[180:183], v[104:107], v[80:83], v[180:183]
    buffer_load_dwordx4 v[40:43], v6, s[8:11], s32 offen offset:2048 sc1
    v_lshl_add_u32 v11, v21, 5, v19
    v_mfma_f32_16x16x32_bf16 v[184:187], v[108:111], v[80:83], v[184:187]
    v_xor_b32 v21, 2, v20
    v_mfma_f32_16x16x32_bf16 v[188:191], v[112:115], v[80:83], v[188:191]
    v_lshl_add_u32 v12, v21, 5, v19
    v_mfma_f32_16x16x32_bf16 v[192:195], v[100:103], v[84:87], v[192:195]
    buffer_load_dwordx4 v[44:47], v7, s[8:11], s32 offen offset:2048 sc1
    v_xor_b32 v21, 3, v20
    v_mfma_f32_16x16x32_bf16 v[196:199], v[104:107], v[84:87], v[196:199]
    v_lshl_add_u32 v13, v21, 5, v19
    v_mfma_f32_16x16x32_bf16 v[200:203], v[108:111], v[84:87], v[200:203]
    v_xor_b32 v21, 4, v20
    v_mfma_f32_16x16x32_bf16 v[204:207], v[112:115], v[84:87], v[204:207]
    buffer_load_dwordx4 v[48:51], v6, s[8:11], s32 offen offset:3072 sc1
    v_lshl_add_u32 v14, v21, 5, v19
    v_mfma_f32_16x16x32_bf16 v[208:211], v[100:103], v[88:91], v[208:211]
    v_xor_b32 v21, 5, v20
    v_mfma_f32_16x16x32_bf16 v[212:215], v[104:107], v[88:91], v[212:215]
    v_lshl_add_u32 v15, v21, 5, v19
    v_mfma_f32_16x16x32_bf16 v[216:219], v[108:111], v[88:91], v[216:219]
    buffer_load_dwordx4 v[52:55], v7, s[8:11], s32 offen offset:3072 sc1
    v_xor_b32 v21, 6, v20
    v_mfma_f32_16x16x32_bf16 v[220:223], v[112:115], v[88:91], v[220:223]
    v_lshl_add_u32 v16, v21, 5, v19
    v_mfma_f32_16x16x32_bf16 v[224:227], v[100:103], v[92:95], v[224:227]
    v_xor_b32 v21, 7, v20
    v_mfma_f32_16x16x32_bf16 v[228:231], v[104:107], v[92:95], v[228:231]
    v_lshl_add_u32 v17, v21, 5, v19
    v_mfma_f32_16x16x32_bf16 v[232:235], v[108:111], v[92:95], v[232:235]
    s_lshl_b32 s45, s29, 20
    v_mfma_f32_16x16x32_bf16 v[236:239], v[112:115], v[92:95], v[236:239]
    v_mfma_f32_16x16x32_bf16 v[240:243], v[100:103], v[96:99], v[240:243]
    v_mfma_f32_16x16x32_bf16 v[244:247], v[104:107], v[96:99], v[244:247]
    v_mfma_f32_16x16x32_bf16 v[248:251], v[108:111], v[96:99], v[248:251]
    v_mfma_f32_16x16x32_bf16 v[252:255], v[112:115], v[96:99], v[252:255]
    s_branch L_p1_done
    .p2align 6
L_kv_vloop:
    s_waitcnt lgkmcnt(0)
    v_mfma_f32_16x16x32_bf16 v[128:131], v[20:23], v[52:55], v[128:131]
    ds_read_b128 v[68:71], v11 offset:0
    v_mfma_f32_16x16x32_bf16 v[160:163], v[20:23], v[56:59], v[160:163]
    ds_read_b64_tr_b16 v[100:101], v12 offset:8192
    v_mfma_f32_16x16x32_bf16 v[192:195], v[20:23], v[60:63], v[192:195]
    ds_read_b64_tr_b16 v[102:103], v12 offset:9216
    v_mfma_f32_16x16x32_bf16 v[224:227], v[20:23], v[64:67], v[224:227]
    ds_read_b64_tr_b16 v[104:105], v13 offset:8192
    v_mfma_f32_16x16x32_bf16 v[132:135], v[24:27], v[52:55], v[132:135]
    ds_read_b64_tr_b16 v[106:107], v13 offset:9216
    v_mfma_f32_16x16x32_bf16 v[164:167], v[24:27], v[56:59], v[164:167]
    ds_read_b64_tr_b16 v[108:109], v14 offset:8192
    v_mfma_f32_16x16x32_bf16 v[196:199], v[24:27], v[60:63], v[196:199]
    ds_read_b64_tr_b16 v[110:111], v14 offset:9216
    v_mfma_f32_16x16x32_bf16 v[228:231], v[24:27], v[64:67], v[228:231]
    ds_read_b64_tr_b16 v[112:113], v15 offset:8192
    v_mfma_f32_16x16x32_bf16 v[136:139], v[28:31], v[52:55], v[136:139]
    ds_read_b64_tr_b16 v[114:115], v15 offset:9216
    v_mfma_f32_16x16x32_bf16 v[168:171], v[28:31], v[56:59], v[168:171]
    ds_read_b128 v[72:75], v11 offset:2048
    v_mfma_f32_16x16x32_bf16 v[200:203], v[28:31], v[60:63], v[200:203]
    ds_read_b128 v[76:79], v11 offset:4096
    v_mfma_f32_16x16x32_bf16 v[232:235], v[28:31], v[64:67], v[232:235]
    ds_read_b128 v[80:83], v11 offset:6144
    v_mfma_f32_16x16x32_bf16 v[140:143], v[32:35], v[52:55], v[140:143]
    ds_read_b128 v[84:87], v11 offset:8192
    v_mfma_f32_16x16x32_bf16 v[172:175], v[32:35], v[56:59], v[172:175]
    ds_read_b128 v[88:91], v11 offset:10240
    v_mfma_f32_16x16x32_bf16 v[204:207], v[32:35], v[60:63], v[204:207]
    ds_read_b128 v[92:95], v11 offset:12288
    v_mfma_f32_16x16x32_bf16 v[236:239], v[32:35], v[64:67], v[236:239]
    ds_read_b128 v[96:99], v11 offset:14336
    v_mfma_f32_16x16x32_bf16 v[144:147], v[36:39], v[52:55], v[144:147]
    v_mfma_f32_16x16x32_bf16 v[176:179], v[36:39], v[56:59], v[176:179]
    v_mfma_f32_16x16x32_bf16 v[208:211], v[36:39], v[60:63], v[208:211]
    v_mfma_f32_16x16x32_bf16 v[240:243], v[36:39], v[64:67], v[240:243]
    v_mfma_f32_16x16x32_bf16 v[148:151], v[40:43], v[52:55], v[148:151]
    v_mfma_f32_16x16x32_bf16 v[180:183], v[40:43], v[56:59], v[180:183]
    v_mfma_f32_16x16x32_bf16 v[212:215], v[40:43], v[60:63], v[212:215]
    v_mfma_f32_16x16x32_bf16 v[244:247], v[40:43], v[64:67], v[244:247]
    v_mfma_f32_16x16x32_bf16 v[152:155], v[44:47], v[52:55], v[152:155]
    v_mfma_f32_16x16x32_bf16 v[184:187], v[44:47], v[56:59], v[184:187]
    v_mfma_f32_16x16x32_bf16 v[216:219], v[44:47], v[60:63], v[216:219]
    v_mfma_f32_16x16x32_bf16 v[248:251], v[44:47], v[64:67], v[248:251]
    v_mfma_f32_16x16x32_bf16 v[156:159], v[48:51], v[52:55], v[156:159]
    v_mfma_f32_16x16x32_bf16 v[188:191], v[48:51], v[56:59], v[188:191]
    v_mfma_f32_16x16x32_bf16 v[220:223], v[48:51], v[60:63], v[220:223]
    v_mfma_f32_16x16x32_bf16 v[252:255], v[48:51], v[64:67], v[252:255]
    s_cmp_lt_u32 s35, s44
    s_cbranch_scc1 L_recurrent_scan__compressed_kv_cla__moe_arch_mod__prompt_kernel_w0_29
    s_waitcnt vmcnt(1)
L_recurrent_scan__compressed_kv_cla__moe_arch_mod__prompt_kernel_w0b_30:
    s_waitcnt lgkmcnt(0)
    s_barrier
    s_add_u32 m0, s33, 0
    s_nop 0
    buffer_load_dwordx4 v2, s[4:7], s31 offen offset:0 lds
    buffer_load_dwordx4 v3, s[4:7], s31 offen offset:1024 lds
    buffer_load_dwordx4 v4, s[4:7], s31 offen offset:2048 lds
    buffer_load_dwordx4 v5, s[4:7], s31 offen offset:3072 lds
    s_add_u32 m0, s34, 0
    s_nop 0
    buffer_load_dwordx4 v6, s[8:11], s32 offen offset:0 nt lds
    buffer_load_dwordx4 v7, s[8:11], s32 offen offset:1024 nt lds
    buffer_load_dwordx4 v8, s[8:11], s32 offen offset:2048 nt lds
    buffer_load_dwordx4 v9, s[8:11], s32 offen offset:3072 nt lds
    s_add_u32 s31, s31, s40
    s_add_u32 s32, s32, s41
    s_cmp_eq_u32 s35, 0
    s_cbranch_scc1 L_recurrent_scan__compressed_kv_cla__moe_arch_mod__prompt_kernel_rare_36
L_recurrent_scan__compressed_kv_cla__moe_arch_mod__prompt_kernel_back_37:
    v_mfma_f32_16x16x32_bf16 v[128:131], v[68:71], v[100:103], v[128:131]
    ds_read_b128 v[20:23], v10 offset:32768
    v_mfma_f32_16x16x32_bf16 v[160:163], v[68:71], v[104:107], v[160:163]
    ds_read_b64_tr_b16 v[52:53], v12 offset:32768
    v_mfma_f32_16x16x32_bf16 v[192:195], v[68:71], v[108:111], v[192:195]
    ds_read_b64_tr_b16 v[54:55], v12 offset:33792
    v_mfma_f32_16x16x32_bf16 v[224:227], v[68:71], v[112:115], v[224:227]
    ds_read_b64_tr_b16 v[56:57], v13 offset:32768
    v_mfma_f32_16x16x32_bf16 v[132:135], v[72:75], v[100:103], v[132:135]
    ds_read_b64_tr_b16 v[58:59], v13 offset:33792
    v_mfma_f32_16x16x32_bf16 v[164:167], v[72:75], v[104:107], v[164:167]
    ds_read_b64_tr_b16 v[60:61], v14 offset:32768
    v_mfma_f32_16x16x32_bf16 v[196:199], v[72:75], v[108:111], v[196:199]
    ds_read_b64_tr_b16 v[62:63], v14 offset:33792
    v_mfma_f32_16x16x32_bf16 v[228:231], v[72:75], v[112:115], v[228:231]
    ds_read_b64_tr_b16 v[64:65], v15 offset:32768
    v_mfma_f32_16x16x32_bf16 v[136:139], v[76:79], v[100:103], v[136:139]
    ds_read_b64_tr_b16 v[66:67], v15 offset:33792
    v_mfma_f32_16x16x32_bf16 v[168:171], v[76:79], v[104:107], v[168:171]
    ds_read_b128 v[24:27], v10 offset:34816
    v_mfma_f32_16x16x32_bf16 v[200:203], v[76:79], v[108:111], v[200:203]
    ds_read_b128 v[28:31], v10 offset:36864
    v_mfma_f32_16x16x32_bf16 v[232:235], v[76:79], v[112:115], v[232:235]
    ds_read_b128 v[32:35], v10 offset:38912
    v_mfma_f32_16x16x32_bf16 v[140:143], v[80:83], v[100:103], v[140:143]
    ds_read_b128 v[36:39], v10 offset:40960
    v_mfma_f32_16x16x32_bf16 v[172:175], v[80:83], v[104:107], v[172:175]
    ds_read_b128 v[40:43], v10 offset:43008
    v_mfma_f32_16x16x32_bf16 v[204:207], v[80:83], v[108:111], v[204:207]
    ds_read_b128 v[44:47], v10 offset:45056
    v_mfma_f32_16x16x32_bf16 v[236:239], v[80:83], v[112:115], v[236:239]
    ds_read_b128 v[48:51], v10 offset:47104
    v_mfma_f32_16x16x32_bf16 v[144:147], v[84:87], v[100:103], v[144:147]
    v_mfma_f32_16x16x32_bf16 v[176:179], v[84:87], v[104:107], v[176:179]
    v_mfma_f32_16x16x32_bf16 v[208:211], v[84:87], v[108:111], v[208:211]
    v_mfma_f32_16x16x32_bf16 v[240:243], v[84:87], v[112:115], v[240:243]
    v_mfma_f32_16x16x32_bf16 v[148:151], v[88:91], v[100:103], v[148:151]
    v_mfma_f32_16x16x32_bf16 v[180:183], v[88:91], v[104:107], v[180:183]
    v_mfma_f32_16x16x32_bf16 v[212:215], v[88:91], v[108:111], v[212:215]
    v_mfma_f32_16x16x32_bf16 v[244:247], v[88:91], v[112:115], v[244:247]
    v_mfma_f32_16x16x32_bf16 v[152:155], v[92:95], v[100:103], v[152:155]
    v_mfma_f32_16x16x32_bf16 v[184:187], v[92:95], v[104:107], v[184:187]
    v_mfma_f32_16x16x32_bf16 v[216:219], v[92:95], v[108:111], v[216:219]
    s_cmp_eq_u32 s35, 3
    s_cbranch_scc1 L_recurrent_scan__compressed_kv_cla__moe_arch_mod__prompt_kernel_rare_33
L_recurrent_scan__compressed_kv_cla__moe_arch_mod__prompt_kernel_back_34:
    v_mfma_f32_16x16x32_bf16 v[248:251], v[92:95], v[112:115], v[248:251]
    v_mfma_f32_16x16x32_bf16 v[156:159], v[96:99], v[100:103], v[156:159]
    v_mfma_f32_16x16x32_bf16 v[188:191], v[96:99], v[104:107], v[188:191]
    v_mfma_f32_16x16x32_bf16 v[220:223], v[96:99], v[108:111], v[220:223]
    v_mfma_f32_16x16x32_bf16 v[252:255], v[96:99], v[112:115], v[252:255]
    buffer_load_dword v0, v17, s[16:19], s45 offen
    s_add_u32 s45, s45, 8192
    s_waitcnt lgkmcnt(0)
    v_mfma_f32_16x16x32_bf16 v[128:131], v[20:23], v[52:55], v[128:131]
    ds_read_b128 v[68:71], v11 offset:32768
    v_mfma_f32_16x16x32_bf16 v[160:163], v[20:23], v[56:59], v[160:163]
    ds_read_b64_tr_b16 v[100:101], v12 offset:40960
    v_mfma_f32_16x16x32_bf16 v[192:195], v[20:23], v[60:63], v[192:195]
    ds_read_b64_tr_b16 v[102:103], v12 offset:41984
    v_mfma_f32_16x16x32_bf16 v[224:227], v[20:23], v[64:67], v[224:227]
    ds_read_b64_tr_b16 v[104:105], v13 offset:40960
    v_mfma_f32_16x16x32_bf16 v[132:135], v[24:27], v[52:55], v[132:135]
    ds_read_b64_tr_b16 v[106:107], v13 offset:41984
    v_mfma_f32_16x16x32_bf16 v[164:167], v[24:27], v[56:59], v[164:167]
    ds_read_b64_tr_b16 v[108:109], v14 offset:40960
    v_mfma_f32_16x16x32_bf16 v[196:199], v[24:27], v[60:63], v[196:199]
    ds_read_b64_tr_b16 v[110:111], v14 offset:41984
    v_mfma_f32_16x16x32_bf16 v[228:231], v[24:27], v[64:67], v[228:231]
    ds_read_b64_tr_b16 v[112:113], v15 offset:40960
    v_mfma_f32_16x16x32_bf16 v[136:139], v[28:31], v[52:55], v[136:139]
    ds_read_b64_tr_b16 v[114:115], v15 offset:41984
    v_mfma_f32_16x16x32_bf16 v[168:171], v[28:31], v[56:59], v[168:171]
    ds_read_b128 v[72:75], v11 offset:34816
    v_mfma_f32_16x16x32_bf16 v[200:203], v[28:31], v[60:63], v[200:203]
    ds_read_b128 v[76:79], v11 offset:36864
    v_mfma_f32_16x16x32_bf16 v[232:235], v[28:31], v[64:67], v[232:235]
    ds_read_b128 v[80:83], v11 offset:38912
    v_mfma_f32_16x16x32_bf16 v[140:143], v[32:35], v[52:55], v[140:143]
    ds_read_b128 v[84:87], v11 offset:40960
    v_mfma_f32_16x16x32_bf16 v[172:175], v[32:35], v[56:59], v[172:175]
    ds_read_b128 v[88:91], v11 offset:43008
    v_mfma_f32_16x16x32_bf16 v[204:207], v[32:35], v[60:63], v[204:207]
    ds_read_b128 v[92:95], v11 offset:45056
    v_mfma_f32_16x16x32_bf16 v[236:239], v[32:35], v[64:67], v[236:239]
    ds_read_b128 v[96:99], v11 offset:47104
    v_mfma_f32_16x16x32_bf16 v[144:147], v[36:39], v[52:55], v[144:147]
    v_mfma_f32_16x16x32_bf16 v[176:179], v[36:39], v[56:59], v[176:179]
    v_mfma_f32_16x16x32_bf16 v[208:211], v[36:39], v[60:63], v[208:211]
    v_mfma_f32_16x16x32_bf16 v[240:243], v[36:39], v[64:67], v[240:243]
    v_mfma_f32_16x16x32_bf16 v[148:151], v[40:43], v[52:55], v[148:151]
    v_mfma_f32_16x16x32_bf16 v[180:183], v[40:43], v[56:59], v[180:183]
    v_mfma_f32_16x16x32_bf16 v[212:215], v[40:43], v[60:63], v[212:215]
    v_mfma_f32_16x16x32_bf16 v[244:247], v[40:43], v[64:67], v[244:247]
    v_mfma_f32_16x16x32_bf16 v[152:155], v[44:47], v[52:55], v[152:155]
    v_mfma_f32_16x16x32_bf16 v[184:187], v[44:47], v[56:59], v[184:187]
    v_mfma_f32_16x16x32_bf16 v[216:219], v[44:47], v[60:63], v[216:219]
    v_mfma_f32_16x16x32_bf16 v[248:251], v[44:47], v[64:67], v[248:251]
    v_mfma_f32_16x16x32_bf16 v[156:159], v[48:51], v[52:55], v[156:159]
    v_mfma_f32_16x16x32_bf16 v[188:191], v[48:51], v[56:59], v[188:191]
    v_mfma_f32_16x16x32_bf16 v[220:223], v[48:51], v[60:63], v[220:223]
    v_mfma_f32_16x16x32_bf16 v[252:255], v[48:51], v[64:67], v[252:255]
    s_waitcnt vmcnt(1) lgkmcnt(0)
    s_cmp_eq_u32 s35, 3
    s_barrier
    s_cbranch_scc1 L_p1_fin1
    s_add_u32 m0, s33, 32768
    s_nop 0
    buffer_load_dwordx4 v2, s[4:7], s31 offen offset:0 lds
    buffer_load_dwordx4 v3, s[4:7], s31 offen offset:1024 lds
    buffer_load_dwordx4 v4, s[4:7], s31 offen offset:2048 lds
    buffer_load_dwordx4 v5, s[4:7], s31 offen offset:3072 lds
    s_add_u32 m0, s34, 32768
    s_nop 0
    buffer_load_dwordx4 v6, s[8:11], s32 offen offset:0 nt lds
    buffer_load_dwordx4 v7, s[8:11], s32 offen offset:1024 nt lds
    buffer_load_dwordx4 v8, s[8:11], s32 offen offset:2048 nt lds
    buffer_load_dwordx4 v9, s[8:11], s32 offen offset:3072 nt lds
    s_add_u32 s31, s31, s40
    s_add_u32 s32, s32, s41
    s_cmp_eq_u32 s35, 2
    s_cbranch_scc1 L_recurrent_scan__compressed_kv_cla__moe_arch_mod__prompt_kernel_rare_40
L_recurrent_scan__compressed_kv_cla__moe_arch_mod__prompt_kernel_back_41:
    v_mfma_f32_16x16x32_bf16 v[128:131], v[68:71], v[100:103], v[128:131]
    ds_read_b128 v[20:23], v10 offset:0
    v_mfma_f32_16x16x32_bf16 v[160:163], v[68:71], v[104:107], v[160:163]
    ds_read_b64_tr_b16 v[52:53], v12 offset:0
    v_mfma_f32_16x16x32_bf16 v[192:195], v[68:71], v[108:111], v[192:195]
    ds_read_b64_tr_b16 v[54:55], v12 offset:1024
    v_mfma_f32_16x16x32_bf16 v[224:227], v[68:71], v[112:115], v[224:227]
    ds_read_b64_tr_b16 v[56:57], v13 offset:0
    v_mfma_f32_16x16x32_bf16 v[132:135], v[72:75], v[100:103], v[132:135]
    ds_read_b64_tr_b16 v[58:59], v13 offset:1024
    v_mfma_f32_16x16x32_bf16 v[164:167], v[72:75], v[104:107], v[164:167]
    ds_read_b64_tr_b16 v[60:61], v14 offset:0
    v_mfma_f32_16x16x32_bf16 v[196:199], v[72:75], v[108:111], v[196:199]
    ds_read_b64_tr_b16 v[62:63], v14 offset:1024
    v_mfma_f32_16x16x32_bf16 v[228:231], v[72:75], v[112:115], v[228:231]
    ds_read_b64_tr_b16 v[64:65], v15 offset:0
    v_mfma_f32_16x16x32_bf16 v[136:139], v[76:79], v[100:103], v[136:139]
    ds_read_b64_tr_b16 v[66:67], v15 offset:1024
    v_mfma_f32_16x16x32_bf16 v[168:171], v[76:79], v[104:107], v[168:171]
    ds_read_b128 v[24:27], v10 offset:2048
    v_mfma_f32_16x16x32_bf16 v[200:203], v[76:79], v[108:111], v[200:203]
    ds_read_b128 v[28:31], v10 offset:4096
    v_mfma_f32_16x16x32_bf16 v[232:235], v[76:79], v[112:115], v[232:235]
    ds_read_b128 v[32:35], v10 offset:6144
    v_mfma_f32_16x16x32_bf16 v[140:143], v[80:83], v[100:103], v[140:143]
    ds_read_b128 v[36:39], v10 offset:8192
    v_mfma_f32_16x16x32_bf16 v[172:175], v[80:83], v[104:107], v[172:175]
    ds_read_b128 v[40:43], v10 offset:10240
    v_mfma_f32_16x16x32_bf16 v[204:207], v[80:83], v[108:111], v[204:207]
    ds_read_b128 v[44:47], v10 offset:12288
    v_mfma_f32_16x16x32_bf16 v[236:239], v[80:83], v[112:115], v[236:239]
    ds_read_b128 v[48:51], v10 offset:14336
    v_mfma_f32_16x16x32_bf16 v[144:147], v[84:87], v[100:103], v[144:147]
    v_mfma_f32_16x16x32_bf16 v[176:179], v[84:87], v[104:107], v[176:179]
    v_mfma_f32_16x16x32_bf16 v[208:211], v[84:87], v[108:111], v[208:211]
    v_mfma_f32_16x16x32_bf16 v[240:243], v[84:87], v[112:115], v[240:243]
    v_mfma_f32_16x16x32_bf16 v[148:151], v[88:91], v[100:103], v[148:151]
    v_mfma_f32_16x16x32_bf16 v[180:183], v[88:91], v[104:107], v[180:183]
    v_mfma_f32_16x16x32_bf16 v[212:215], v[88:91], v[108:111], v[212:215]
    v_mfma_f32_16x16x32_bf16 v[244:247], v[88:91], v[112:115], v[244:247]
    v_mfma_f32_16x16x32_bf16 v[152:155], v[92:95], v[100:103], v[152:155]
    v_mfma_f32_16x16x32_bf16 v[184:187], v[92:95], v[104:107], v[184:187]
    v_mfma_f32_16x16x32_bf16 v[216:219], v[92:95], v[108:111], v[216:219]
    v_mfma_f32_16x16x32_bf16 v[248:251], v[92:95], v[112:115], v[248:251]
    v_mfma_f32_16x16x32_bf16 v[156:159], v[96:99], v[100:103], v[156:159]
    v_mfma_f32_16x16x32_bf16 v[188:191], v[96:99], v[104:107], v[188:191]
    v_mfma_f32_16x16x32_bf16 v[220:223], v[96:99], v[108:111], v[220:223]
    v_mfma_f32_16x16x32_bf16 v[252:255], v[96:99], v[112:115], v[252:255]
    buffer_load_dword v0, v17, s[16:19], s45 offen
    s_add_u32 s45, s45, 8192
    s_add_u32 s35, s35, 1
    s_branch L_kv_vloop
L_p1_fin1:
    s_and_b32 s36, s28, 3
    s_sub_u32 s37, 15, s30
    s_cmp_lt_u32 s28, 4
    s_cselect_b32 s37, s37, s30
    s_lshl_b32 s37, s37, 2
    s_add_u32 s37, s37, s36
    s_lshl_b32 s37, s37, 16
    v_lshl_add_u32 v6, v1, 4, s37
    v_add_u32 v7, 32768, v6
    s_mov_b32 s32, 0
    s_mov_b32 s8, s54
    s_and_b32 s9, s55, 0xffff
    s_mov_b32 s10, 104857728
    s_mov_b32 s11, 0x20000
    v_mfma_f32_16x16x32_bf16 v[128:131], v[68:71], v[100:103], v[128:131]
    v_mfma_f32_16x16x32_bf16 v[160:163], v[68:71], v[104:107], v[160:163]
    buffer_load_dwordx4 v[24:27], v6, s[8:11], s32 offen offset:0 sc1
    v_mfma_f32_16x16x32_bf16 v[192:195], v[68:71], v[108:111], v[192:195]
    v_lshrrev_b32 v18, 4, v1
    v_mfma_f32_16x16x32_bf16 v[224:227], v[68:71], v[112:115], v[224:227]
    v_bfe_u32 v20, v1, 2, 2
    v_mfma_f32_16x16x32_bf16 v[132:135], v[72:75], v[100:103], v[132:135]
    buffer_load_dwordx4 v[28:31], v7, s[8:11], s32 offen offset:0 sc1
    v_lshl_add_u32 v19, v18, 3, v20
    v_mfma_f32_16x16x32_bf16 v[164:167], v[72:75], v[104:107], v[164:167]
    v_lshlrev_b32 v19, 8, v19
    v_mfma_f32_16x16x32_bf16 v[196:199], v[72:75], v[108:111], v[196:199]
    v_and_b32 v21, 3, v1
    v_mfma_f32_16x16x32_bf16 v[228:231], v[72:75], v[112:115], v[228:231]
    buffer_load_dwordx4 v[32:35], v6, s[8:11], s32 offen offset:1024 sc1
    v_lshl_add_u32 v19, v21, 3, v19
    v_mfma_f32_16x16x32_bf16 v[136:139], v[76:79], v[100:103], v[136:139]
    v_and_b32 v21, 1, v18
    v_mfma_f32_16x16x32_bf16 v[168:171], v[76:79], v[104:107], v[168:171]
    v_lshl_add_u32 v20, v21, 2, v20
    v_mfma_f32_16x16x32_bf16 v[200:203], v[76:79], v[108:111], v[200:203]
    buffer_load_dwordx4 v[36:39], v7, s[8:11], s32 offen offset:1024 sc1
    v_xor_b32 v21, 0, v20
    v_mfma_f32_16x16x32_bf16 v[232:235], v[76:79], v[112:115], v[232:235]
    v_lshl_add_u32 v10, v21, 5, v19
    v_mfma_f32_16x16x32_bf16 v[140:143], v[80:83], v[100:103], v[140:143]
    v_xor_b32 v21, 1, v20
    v_mfma_f32_16x16x32_bf16 v[172:175], v[80:83], v[104:107], v[172:175]
    buffer_load_dwordx4 v[40:43], v6, s[8:11], s32 offen offset:2048 sc1
    v_lshl_add_u32 v11, v21, 5, v19
    v_mfma_f32_16x16x32_bf16 v[204:207], v[80:83], v[108:111], v[204:207]
    v_xor_b32 v21, 2, v20
    v_mfma_f32_16x16x32_bf16 v[236:239], v[80:83], v[112:115], v[236:239]
    v_lshl_add_u32 v12, v21, 5, v19
    v_mfma_f32_16x16x32_bf16 v[144:147], v[84:87], v[100:103], v[144:147]
    buffer_load_dwordx4 v[44:47], v7, s[8:11], s32 offen offset:2048 sc1
    v_xor_b32 v21, 3, v20
    v_mfma_f32_16x16x32_bf16 v[176:179], v[84:87], v[104:107], v[176:179]
    v_lshl_add_u32 v13, v21, 5, v19
    v_mfma_f32_16x16x32_bf16 v[208:211], v[84:87], v[108:111], v[208:211]
    v_xor_b32 v21, 4, v20
    v_mfma_f32_16x16x32_bf16 v[240:243], v[84:87], v[112:115], v[240:243]
    buffer_load_dwordx4 v[48:51], v6, s[8:11], s32 offen offset:3072 sc1
    v_lshl_add_u32 v14, v21, 5, v19
    v_mfma_f32_16x16x32_bf16 v[148:151], v[88:91], v[100:103], v[148:151]
    v_xor_b32 v21, 5, v20
    v_mfma_f32_16x16x32_bf16 v[180:183], v[88:91], v[104:107], v[180:183]
    v_lshl_add_u32 v15, v21, 5, v19
    v_mfma_f32_16x16x32_bf16 v[212:215], v[88:91], v[108:111], v[212:215]
    buffer_load_dwordx4 v[52:55], v7, s[8:11], s32 offen offset:3072 sc1
    v_xor_b32 v21, 6, v20
    v_mfma_f32_16x16x32_bf16 v[244:247], v[88:91], v[112:115], v[244:247]
    v_lshl_add_u32 v16, v21, 5, v19
    v_mfma_f32_16x16x32_bf16 v[152:155], v[92:95], v[100:103], v[152:155]
    v_xor_b32 v21, 7, v20
    v_mfma_f32_16x16x32_bf16 v[184:187], v[92:95], v[104:107], v[184:187]
    v_lshl_add_u32 v17, v21, 5, v19
    v_mfma_f32_16x16x32_bf16 v[216:219], v[92:95], v[108:111], v[216:219]
    s_lshl_b32 s45, s29, 20
    v_mfma_f32_16x16x32_bf16 v[248:251], v[92:95], v[112:115], v[248:251]
    v_mfma_f32_16x16x32_bf16 v[156:159], v[96:99], v[100:103], v[156:159]
    v_mfma_f32_16x16x32_bf16 v[188:191], v[96:99], v[104:107], v[188:191]
    v_mfma_f32_16x16x32_bf16 v[220:223], v[96:99], v[108:111], v[220:223]
    v_mfma_f32_16x16x32_bf16 v[252:255], v[96:99], v[112:115], v[252:255]
L_p1_done:
    ds_read_b64_tr_b16 v[64:65], v10 offset:0
    ds_read_b64_tr_b16 v[66:67], v10 offset:1024
    ds_read_b64_tr_b16 v[68:69], v11 offset:0
    ds_read_b64_tr_b16 v[70:71], v11 offset:1024
    ds_read_b64_tr_b16 v[72:73], v12 offset:0
    ds_read_b64_tr_b16 v[74:75], v12 offset:1024
    ds_read_b64_tr_b16 v[76:77], v13 offset:0
    ds_read_b64_tr_b16 v[78:79], v13 offset:1024
    ds_read_b64_tr_b16 v[80:81], v14 offset:0
    ds_read_b64_tr_b16 v[82:83], v14 offset:1024
    ds_read_b64_tr_b16 v[84:85], v15 offset:0
    ds_read_b64_tr_b16 v[86:87], v15 offset:1024
    s_add_u32 m0, s33, 32768
    s_add_u32 s32, s32, 4096
    v_cvt_pk_bf16_f32 v128, v128, v129
    v_cvt_pk_bf16_f32 v129, v130, v131
    v_cvt_pk_bf16_f32 v130, v132, v133
    v_cvt_pk_bf16_f32 v131, v134, v135
    v_cvt_pk_bf16_f32 v132, v136, v137
    v_cvt_pk_bf16_f32 v133, v138, v139
    v_cvt_pk_bf16_f32 v134, v140, v141
    v_cvt_pk_bf16_f32 v135, v142, v143
    v_cvt_pk_bf16_f32 v136, v144, v145
    v_cvt_pk_bf16_f32 v137, v146, v147
    v_cvt_pk_bf16_f32 v138, v148, v149
    v_cvt_pk_bf16_f32 v139, v150, v151
    buffer_load_dwordx4 v2, s[4:7], s31 offen offset:0 lds
    v_cvt_pk_bf16_f32 v140, v152, v153
    v_cvt_pk_bf16_f32 v141, v154, v155
    v_cvt_pk_bf16_f32 v142, v156, v157
    v_cvt_pk_bf16_f32 v143, v158, v159
    v_cvt_pk_bf16_f32 v144, v160, v161
    v_cvt_pk_bf16_f32 v145, v162, v163
    v_cvt_pk_bf16_f32 v146, v164, v165
    v_cvt_pk_bf16_f32 v147, v166, v167
    v_cvt_pk_bf16_f32 v148, v168, v169
    v_cvt_pk_bf16_f32 v149, v170, v171
    v_cvt_pk_bf16_f32 v150, v172, v173
    v_cvt_pk_bf16_f32 v151, v174, v175
    buffer_load_dwordx4 v3, s[4:7], s31 offen offset:1024 lds
    v_cvt_pk_bf16_f32 v152, v176, v177
    v_cvt_pk_bf16_f32 v153, v178, v179
    v_cvt_pk_bf16_f32 v154, v180, v181
    v_cvt_pk_bf16_f32 v155, v182, v183
    v_cvt_pk_bf16_f32 v156, v184, v185
    v_cvt_pk_bf16_f32 v157, v186, v187
    v_cvt_pk_bf16_f32 v158, v188, v189
    v_cvt_pk_bf16_f32 v159, v190, v191
    v_cvt_pk_bf16_f32 v160, v192, v193
    v_cvt_pk_bf16_f32 v161, v194, v195
    v_cvt_pk_bf16_f32 v162, v196, v197
    v_cvt_pk_bf16_f32 v163, v198, v199
    buffer_load_dwordx4 v4, s[4:7], s31 offen offset:2048 lds
    v_cvt_pk_bf16_f32 v164, v200, v201
    v_cvt_pk_bf16_f32 v165, v202, v203
    v_cvt_pk_bf16_f32 v166, v204, v205
    v_cvt_pk_bf16_f32 v167, v206, v207
    v_cvt_pk_bf16_f32 v168, v208, v209
    v_cvt_pk_bf16_f32 v169, v210, v211
    v_cvt_pk_bf16_f32 v170, v212, v213
    v_cvt_pk_bf16_f32 v171, v214, v215
    v_cvt_pk_bf16_f32 v172, v216, v217
    v_cvt_pk_bf16_f32 v173, v218, v219
    v_cvt_pk_bf16_f32 v174, v220, v221
    v_cvt_pk_bf16_f32 v175, v222, v223
    buffer_load_dwordx4 v5, s[4:7], s31 offen offset:3072 lds
    v_cvt_pk_bf16_f32 v176, v224, v225
    v_cvt_pk_bf16_f32 v177, v226, v227
    v_cvt_pk_bf16_f32 v178, v228, v229
    v_cvt_pk_bf16_f32 v179, v230, v231
    v_cvt_pk_bf16_f32 v180, v232, v233
    v_cvt_pk_bf16_f32 v181, v234, v235
    v_cvt_pk_bf16_f32 v182, v236, v237
    v_cvt_pk_bf16_f32 v183, v238, v239
    v_cvt_pk_bf16_f32 v184, v240, v241
    v_cvt_pk_bf16_f32 v185, v242, v243
    v_cvt_pk_bf16_f32 v186, v244, v245
    v_cvt_pk_bf16_f32 v187, v246, v247
    v_cvt_pk_bf16_f32 v188, v248, v249
    v_cvt_pk_bf16_f32 v189, v250, v251
    v_cvt_pk_bf16_f32 v190, v252, v253
    v_cvt_pk_bf16_f32 v191, v254, v255
    s_lshl_b32 s38, s29, 20
    s_lshl_b32 s37, s30, 17
    s_add_u32 s38, s38, s37
    s_bfe_u32 s37, s28, 0x10001
    s_lshl_b32 s37, s37, 16
    s_add_u32 s38, s38, s37
    s_lshr_b32 s36, s28, 2
    s_lshl_b32 s37, s36, 15
    s_add_u32 s38, s38, s37
    s_and_b32 s37, s28, 1
    s_add_u32 s36, s36, 11
    s_lshl_b32 s37, s37, s36
    s_add_u32 s38, s38, s37
    s_cmp_lt_u32 s28, 4
    s_cselect_b32 s36, 4, 32
    s_cselect_b32 s37, 16, 64
    s_cselect_b32 s39, 32, 4
    s_lshl_b32 s36, s36, 8
    s_lshl_b32 s37, s37, 8
    s_lshl_b32 s39, s39, 8
    s_mov_b64 s[16:17], s[12:13]
    s_mov_b64 s[18:19], s[14:15]
    s_mov_b32 s46, s38
    s_add_u32 s47, s46, s39
    s_add_u32 s48, s47, s39
    s_add_u32 s49, s48, s39
    v_lshlrev_b32 v58, 4, v1
    v_add_u32 v59, s36, v58
    v_add_u32 v60, s37, v58
    v_add_u32 v61, s36, v60
    v_add_u32 v8, s33, v58
    s_waitcnt vmcnt(8)
    s_cmp_eq_u32 s30, 0
    s_cbranch_scc1 L_recurrent_scan__compressed_kv_cla__moe_arch_mod__prompt_kernel_rare_54
L_recurrent_scan__compressed_kv_cla__moe_arch_mod__prompt_kernel_back_55:
    s_waitcnt lgkmcnt(8)
    v_mfma_f32_16x16x32_bf16 v[192:195], v[64:67], v[24:27], 0
    ds_read_b64_tr_b16 v[88:89], v16 offset:0
    v_mfma_f32_16x16x32_bf16 v[224:227], v[64:67], v[28:31], 0
    ds_read_b64_tr_b16 v[90:91], v16 offset:1024
    buffer_load_dwordx4 v[96:99], v6, s[8:11], s32 offen offset:0 sc1
    v_mfma_f32_16x16x32_bf16 v[196:199], v[68:71], v[24:27], 0
    ds_read_b64_tr_b16 v[92:93], v17 offset:0
    v_mfma_f32_16x16x32_bf16 v[228:231], v[68:71], v[28:31], 0
    ds_read_b64_tr_b16 v[94:95], v17 offset:1024
    s_waitcnt lgkmcnt(8)
    v_mfma_f32_16x16x32_bf16 v[200:203], v[72:75], v[24:27], 0
    ds_read_b64_tr_b16 v[64:65], v10 offset:8192
    v_mfma_f32_16x16x32_bf16 v[232:235], v[72:75], v[28:31], 0
    ds_read_b64_tr_b16 v[66:67], v10 offset:9216
    buffer_load_dwordx4 v[100:103], v7, s[8:11], s32 offen offset:0 sc1
    v_mfma_f32_16x16x32_bf16 v[204:207], v[76:79], v[24:27], 0
    ds_read_b64_tr_b16 v[68:69], v11 offset:8192
    v_mfma_f32_16x16x32_bf16 v[236:239], v[76:79], v[28:31], 0
    ds_read_b64_tr_b16 v[70:71], v11 offset:9216
    s_waitcnt lgkmcnt(8)
    v_mfma_f32_16x16x32_bf16 v[208:211], v[80:83], v[24:27], 0
    ds_read_b64_tr_b16 v[72:73], v12 offset:8192
    v_mfma_f32_16x16x32_bf16 v[240:243], v[80:83], v[28:31], 0
    ds_read_b64_tr_b16 v[74:75], v12 offset:9216
    buffer_load_dwordx4 v[104:107], v6, s[8:11], s32 offen offset:1024 sc1
    v_mfma_f32_16x16x32_bf16 v[212:215], v[84:87], v[24:27], 0
    ds_read_b64_tr_b16 v[76:77], v13 offset:8192
    v_mfma_f32_16x16x32_bf16 v[244:247], v[84:87], v[28:31], 0
    ds_read_b64_tr_b16 v[78:79], v13 offset:9216
    s_waitcnt lgkmcnt(8)
    v_mfma_f32_16x16x32_bf16 v[216:219], v[88:91], v[24:27], 0
    ds_read_b64_tr_b16 v[80:81], v14 offset:8192
    v_mfma_f32_16x16x32_bf16 v[248:251], v[88:91], v[28:31], 0
    ds_read_b64_tr_b16 v[82:83], v14 offset:9216
    buffer_load_dwordx4 v[108:111], v7, s[8:11], s32 offen offset:1024 sc1
    v_mfma_f32_16x16x32_bf16 v[220:223], v[92:95], v[24:27], 0
    ds_read_b64_tr_b16 v[84:85], v15 offset:8192
    v_mfma_f32_16x16x32_bf16 v[252:255], v[92:95], v[28:31], 0
    ds_read_b64_tr_b16 v[86:87], v15 offset:9216
    s_waitcnt lgkmcnt(8)
    v_mfma_f32_16x16x32_bf16 v[192:195], v[64:67], v[32:35], v[192:195]
    ds_read_b64_tr_b16 v[88:89], v16 offset:8192
    v_mfma_f32_16x16x32_bf16 v[224:227], v[64:67], v[36:39], v[224:227]
    ds_read_b64_tr_b16 v[90:91], v16 offset:9216
    buffer_store_dwordx4 v[128:131], v58, s[16:19], s46 offen sc1
    v_mfma_f32_16x16x32_bf16 v[196:199], v[68:71], v[32:35], v[196:199]
    ds_read_b64_tr_b16 v[92:93], v17 offset:8192
    v_mfma_f32_16x16x32_bf16 v[228:231], v[68:71], v[36:39], v[228:231]
    ds_read_b64_tr_b16 v[94:95], v17 offset:9216
    s_waitcnt lgkmcnt(8)
    v_mfma_f32_16x16x32_bf16 v[200:203], v[72:75], v[32:35], v[200:203]
    ds_read_b64_tr_b16 v[64:65], v10 offset:16384
    v_mfma_f32_16x16x32_bf16 v[232:235], v[72:75], v[36:39], v[232:235]
    ds_read_b64_tr_b16 v[66:67], v10 offset:17408
    v_mfma_f32_16x16x32_bf16 v[204:207], v[76:79], v[32:35], v[204:207]
    ds_read_b64_tr_b16 v[68:69], v11 offset:16384
    v_mfma_f32_16x16x32_bf16 v[236:239], v[76:79], v[36:39], v[236:239]
    ds_read_b64_tr_b16 v[70:71], v11 offset:17408
    s_waitcnt lgkmcnt(8)
    v_mfma_f32_16x16x32_bf16 v[208:211], v[80:83], v[32:35], v[208:211]
    ds_read_b64_tr_b16 v[72:73], v12 offset:16384
    v_mfma_f32_16x16x32_bf16 v[240:243], v[80:83], v[36:39], v[240:243]
    ds_read_b64_tr_b16 v[74:75], v12 offset:17408
    v_mfma_f32_16x16x32_bf16 v[212:215], v[84:87], v[32:35], v[212:215]
    ds_read_b64_tr_b16 v[76:77], v13 offset:16384
    v_mfma_f32_16x16x32_bf16 v[244:247], v[84:87], v[36:39], v[244:247]
    ds_read_b64_tr_b16 v[78:79], v13 offset:17408
    s_waitcnt lgkmcnt(8)
    v_mfma_f32_16x16x32_bf16 v[216:219], v[88:91], v[32:35], v[216:219]
    ds_read_b64_tr_b16 v[80:81], v14 offset:16384
    buffer_load_dwordx4 v[112:115], v6, s[8:11], s32 offen offset:2048 sc1
    v_mfma_f32_16x16x32_bf16 v[248:251], v[88:91], v[36:39], v[248:251]
    ds_read_b64_tr_b16 v[82:83], v14 offset:17408
    v_mfma_f32_16x16x32_bf16 v[220:223], v[92:95], v[32:35], v[220:223]
    ds_read_b64_tr_b16 v[84:85], v15 offset:16384
    v_mfma_f32_16x16x32_bf16 v[252:255], v[92:95], v[36:39], v[252:255]
    ds_read_b64_tr_b16 v[86:87], v15 offset:17408
    s_waitcnt lgkmcnt(8)
    s_waitcnt vmcnt(12)
    v_mfma_f32_16x16x32_bf16 v[192:195], v[64:67], v[40:43], v[192:195]
    ds_read_b64_tr_b16 v[88:89], v16 offset:16384
    buffer_load_dwordx4 v[116:119], v7, s[8:11], s32 offen offset:2048 sc1
    v_mfma_f32_16x16x32_bf16 v[224:227], v[64:67], v[44:47], v[224:227]
    ds_read_b64_tr_b16 v[90:91], v16 offset:17408
    v_mfma_f32_16x16x32_bf16 v[196:199], v[68:71], v[40:43], v[196:199]
    ds_read_b64_tr_b16 v[92:93], v17 offset:16384
    v_mfma_f32_16x16x32_bf16 v[228:231], v[68:71], v[44:47], v[228:231]
    ds_read_b64_tr_b16 v[94:95], v17 offset:17408
    s_waitcnt lgkmcnt(8)
    v_mfma_f32_16x16x32_bf16 v[200:203], v[72:75], v[40:43], v[200:203]
    ds_read_b64_tr_b16 v[64:65], v10 offset:24576
    v_mfma_f32_16x16x32_bf16 v[232:235], v[72:75], v[44:47], v[232:235]
    ds_read_b64_tr_b16 v[66:67], v10 offset:25600
    buffer_load_dwordx4 v[120:123], v6, s[8:11], s32 offen offset:3072 sc1
    v_mfma_f32_16x16x32_bf16 v[204:207], v[76:79], v[40:43], v[204:207]
    ds_read_b64_tr_b16 v[68:69], v11 offset:24576
    v_mfma_f32_16x16x32_bf16 v[236:239], v[76:79], v[44:47], v[236:239]
    ds_read_b64_tr_b16 v[70:71], v11 offset:25600
    s_waitcnt lgkmcnt(8)
    v_mfma_f32_16x16x32_bf16 v[208:211], v[80:83], v[40:43], v[208:211]
    ds_read_b64_tr_b16 v[72:73], v12 offset:24576
    v_mfma_f32_16x16x32_bf16 v[240:243], v[80:83], v[44:47], v[240:243]
    ds_read_b64_tr_b16 v[74:75], v12 offset:25600
    buffer_load_dwordx4 v[124:127], v7, s[8:11], s32 offen offset:3072 sc1
    v_mfma_f32_16x16x32_bf16 v[212:215], v[84:87], v[40:43], v[212:215]
    ds_read_b64_tr_b16 v[76:77], v13 offset:24576
    v_mfma_f32_16x16x32_bf16 v[244:247], v[84:87], v[44:47], v[244:247]
    ds_read_b64_tr_b16 v[78:79], v13 offset:25600
    s_waitcnt lgkmcnt(8)
    v_mfma_f32_16x16x32_bf16 v[216:219], v[88:91], v[40:43], v[216:219]
    ds_read_b64_tr_b16 v[80:81], v14 offset:24576
    v_mfma_f32_16x16x32_bf16 v[248:251], v[88:91], v[44:47], v[248:251]
    ds_read_b64_tr_b16 v[82:83], v14 offset:25600
    buffer_store_dwordx4 v[132:135], v59, s[16:19], s46 offen sc1
    v_mfma_f32_16x16x32_bf16 v[220:223], v[92:95], v[40:43], v[220:223]
    ds_read_b64_tr_b16 v[84:85], v15 offset:24576
    v_mfma_f32_16x16x32_bf16 v[252:255], v[92:95], v[44:47], v[252:255]
    ds_read_b64_tr_b16 v[86:87], v15 offset:25600
    s_waitcnt lgkmcnt(8)
    s_waitcnt vmcnt(14)
    v_mfma_f32_16x16x32_bf16 v[192:195], v[64:67], v[48:51], v[192:195]
    ds_read_b64_tr_b16 v[88:89], v16 offset:24576
    v_mfma_f32_16x16x32_bf16 v[224:227], v[64:67], v[52:55], v[224:227]
    ds_read_b64_tr_b16 v[90:91], v16 offset:25600
    v_mfma_f32_16x16x32_bf16 v[196:199], v[68:71], v[48:51], v[196:199]
    ds_read_b64_tr_b16 v[92:93], v17 offset:24576
    v_mfma_f32_16x16x32_bf16 v[228:231], v[68:71], v[52:55], v[228:231]
    ds_read_b64_tr_b16 v[94:95], v17 offset:25600
    s_waitcnt vmcnt(10)
    s_barrier
    s_waitcnt lgkmcnt(8)
    v_mfma_f32_16x16x32_bf16 v[200:203], v[72:75], v[48:51], v[200:203]
    ds_read_b64_tr_b16 v[64:65], v10 offset:32768
    v_mfma_f32_16x16x32_bf16 v[232:235], v[72:75], v[52:55], v[232:235]
    ds_read_b64_tr_b16 v[66:67], v10 offset:33792
    v_mfma_f32_16x16x32_bf16 v[204:207], v[76:79], v[48:51], v[204:207]
    ds_read_b64_tr_b16 v[68:69], v11 offset:32768
    v_mfma_f32_16x16x32_bf16 v[236:239], v[76:79], v[52:55], v[236:239]
    ds_read_b64_tr_b16 v[70:71], v11 offset:33792
    s_waitcnt lgkmcnt(8)
    v_mfma_f32_16x16x32_bf16 v[208:211], v[80:83], v[48:51], v[208:211]
    ds_read_b64_tr_b16 v[72:73], v12 offset:32768
    s_mov_b32 s32, 8192
    buffer_load_dwordx4 v[24:27], v6, s[8:11], s32 offen offset:0 sc1
    v_mfma_f32_16x16x32_bf16 v[240:243], v[80:83], v[52:55], v[240:243]
    ds_read_b64_tr_b16 v[74:75], v12 offset:33792
    v_mfma_f32_16x16x32_bf16 v[212:215], v[84:87], v[48:51], v[212:215]
    ds_read_b64_tr_b16 v[76:77], v13 offset:32768
    v_mfma_f32_16x16x32_bf16 v[244:247], v[84:87], v[52:55], v[244:247]
    ds_read_b64_tr_b16 v[78:79], v13 offset:33792
    s_waitcnt lgkmcnt(8)
    v_mfma_f32_16x16x32_bf16 v[216:219], v[88:91], v[48:51], v[216:219]
    ds_read_b64_tr_b16 v[80:81], v14 offset:32768
    buffer_load_dwordx4 v[28:31], v7, s[8:11], s32 offen offset:0 sc1
    v_mfma_f32_16x16x32_bf16 v[248:251], v[88:91], v[52:55], v[248:251]
    ds_read_b64_tr_b16 v[82:83], v14 offset:33792
    v_mfma_f32_16x16x32_bf16 v[220:223], v[92:95], v[48:51], v[220:223]
    ds_read_b64_tr_b16 v[84:85], v15 offset:32768
    v_mfma_f32_16x16x32_bf16 v[252:255], v[92:95], v[52:55], v[252:255]
    ds_read_b64_tr_b16 v[86:87], v15 offset:33792
    s_waitcnt lgkmcnt(8)
    s_waitcnt vmcnt(10)
    v_mfma_f32_16x16x32_bf16 v[192:195], v[64:67], v[96:99], v[192:195]
    ds_read_b64_tr_b16 v[88:89], v16 offset:32768
    buffer_load_dwordx4 v[32:35], v6, s[8:11], s32 offen offset:1024 sc1
    v_mfma_f32_16x16x32_bf16 v[224:227], v[64:67], v[100:103], v[224:227]
    ds_read_b64_tr_b16 v[90:91], v16 offset:33792
    v_mfma_f32_16x16x32_bf16 v[196:199], v[68:71], v[96:99], v[196:199]
    ds_read_b64_tr_b16 v[92:93], v17 offset:32768
    v_mfma_f32_16x16x32_bf16 v[228:231], v[68:71], v[100:103], v[228:231]
    ds_read_b64_tr_b16 v[94:95], v17 offset:33792
    s_waitcnt lgkmcnt(8)
    v_mfma_f32_16x16x32_bf16 v[200:203], v[72:75], v[96:99], v[200:203]
    ds_read_b64_tr_b16 v[64:65], v10 offset:40960
    buffer_load_dwordx4 v[36:39], v7, s[8:11], s32 offen offset:1024 sc1
    v_mfma_f32_16x16x32_bf16 v[232:235], v[72:75], v[100:103], v[232:235]
    ds_read_b64_tr_b16 v[66:67], v10 offset:41984
    v_mfma_f32_16x16x32_bf16 v[204:207], v[76:79], v[96:99], v[204:207]
    ds_read_b64_tr_b16 v[68:69], v11 offset:40960
    v_mfma_f32_16x16x32_bf16 v[236:239], v[76:79], v[100:103], v[236:239]
    ds_read_b64_tr_b16 v[70:71], v11 offset:41984
    s_waitcnt lgkmcnt(8)
    v_mfma_f32_16x16x32_bf16 v[208:211], v[80:83], v[96:99], v[208:211]
    ds_read_b64_tr_b16 v[72:73], v12 offset:40960
    v_mfma_f32_16x16x32_bf16 v[240:243], v[80:83], v[100:103], v[240:243]
    ds_read_b64_tr_b16 v[74:75], v12 offset:41984
    buffer_store_dwordx4 v[136:139], v60, s[16:19], s46 offen sc1
    v_mfma_f32_16x16x32_bf16 v[212:215], v[84:87], v[96:99], v[212:215]
    ds_read_b64_tr_b16 v[76:77], v13 offset:40960
    v_mfma_f32_16x16x32_bf16 v[244:247], v[84:87], v[100:103], v[244:247]
    ds_read_b64_tr_b16 v[78:79], v13 offset:41984
    s_waitcnt lgkmcnt(8)
    v_mfma_f32_16x16x32_bf16 v[216:219], v[88:91], v[96:99], v[216:219]
    ds_read_b64_tr_b16 v[80:81], v14 offset:40960
    v_mfma_f32_16x16x32_bf16 v[248:251], v[88:91], v[100:103], v[248:251]
    ds_read_b64_tr_b16 v[82:83], v14 offset:41984
    v_mfma_f32_16x16x32_bf16 v[220:223], v[92:95], v[96:99], v[220:223]
    ds_read_b64_tr_b16 v[84:85], v15 offset:40960
    v_mfma_f32_16x16x32_bf16 v[252:255], v[92:95], v[100:103], v[252:255]
    ds_read_b64_tr_b16 v[86:87], v15 offset:41984
    s_waitcnt lgkmcnt(8)
    s_waitcnt vmcnt(11)
    v_mfma_f32_16x16x32_bf16 v[192:195], v[64:67], v[104:107], v[192:195]
    ds_read_b64_tr_b16 v[88:89], v16 offset:40960
    v_mfma_f32_16x16x32_bf16 v[224:227], v[64:67], v[108:111], v[224:227]
    ds_read_b64_tr_b16 v[90:91], v16 offset:41984
    v_mfma_f32_16x16x32_bf16 v[196:199], v[68:71], v[104:107], v[196:199]
    ds_read_b64_tr_b16 v[92:93], v17 offset:40960
    v_mfma_f32_16x16x32_bf16 v[228:231], v[68:71], v[108:111], v[228:231]
    ds_read_b64_tr_b16 v[94:95], v17 offset:41984
    s_waitcnt lgkmcnt(8)
    v_mfma_f32_16x16x32_bf16 v[200:203], v[72:75], v[104:107], v[200:203]
    ds_read_b64_tr_b16 v[64:65], v10 offset:49152
    buffer_load_dwordx4 v[40:43], v6, s[8:11], s32 offen offset:2048 sc1
    v_mfma_f32_16x16x32_bf16 v[232:235], v[72:75], v[108:111], v[232:235]
    ds_read_b64_tr_b16 v[66:67], v10 offset:50176
    v_mfma_f32_16x16x32_bf16 v[204:207], v[76:79], v[104:107], v[204:207]
    ds_read_b64_tr_b16 v[68:69], v11 offset:49152
    v_mfma_f32_16x16x32_bf16 v[236:239], v[76:79], v[108:111], v[236:239]
    ds_read_b64_tr_b16 v[70:71], v11 offset:50176
    s_waitcnt lgkmcnt(8)
    v_mfma_f32_16x16x32_bf16 v[208:211], v[80:83], v[104:107], v[208:211]
    ds_read_b64_tr_b16 v[72:73], v12 offset:49152
    buffer_load_dwordx4 v[44:47], v7, s[8:11], s32 offen offset:2048 sc1
    v_mfma_f32_16x16x32_bf16 v[240:243], v[80:83], v[108:111], v[240:243]
    ds_read_b64_tr_b16 v[74:75], v12 offset:50176
    v_mfma_f32_16x16x32_bf16 v[212:215], v[84:87], v[104:107], v[212:215]
    ds_read_b64_tr_b16 v[76:77], v13 offset:49152
    v_mfma_f32_16x16x32_bf16 v[244:247], v[84:87], v[108:111], v[244:247]
    ds_read_b64_tr_b16 v[78:79], v13 offset:50176
    s_waitcnt lgkmcnt(8)
    v_mfma_f32_16x16x32_bf16 v[216:219], v[88:91], v[104:107], v[216:219]
    ds_read_b64_tr_b16 v[80:81], v14 offset:49152
    buffer_store_dwordx4 v[140:143], v61, s[16:19], s46 offen sc1
    v_mfma_f32_16x16x32_bf16 v[248:251], v[88:91], v[108:111], v[248:251]
    ds_read_b64_tr_b16 v[82:83], v14 offset:50176
    v_mfma_f32_16x16x32_bf16 v[220:223], v[92:95], v[104:107], v[220:223]
    ds_read_b64_tr_b16 v[84:85], v15 offset:49152
    v_mfma_f32_16x16x32_bf16 v[252:255], v[92:95], v[108:111], v[252:255]
    ds_read_b64_tr_b16 v[86:87], v15 offset:50176
    s_waitcnt lgkmcnt(8)
    s_waitcnt vmcnt(11)
    v_mfma_f32_16x16x32_bf16 v[192:195], v[64:67], v[112:115], v[192:195]
    ds_read_b64_tr_b16 v[88:89], v16 offset:49152
    v_mfma_f32_16x16x32_bf16 v[224:227], v[64:67], v[116:119], v[224:227]
    ds_read_b64_tr_b16 v[90:91], v16 offset:50176
    v_mfma_f32_16x16x32_bf16 v[196:199], v[68:71], v[112:115], v[196:199]
    ds_read_b64_tr_b16 v[92:93], v17 offset:49152
    v_mfma_f32_16x16x32_bf16 v[228:231], v[68:71], v[116:119], v[228:231]
    ds_read_b64_tr_b16 v[94:95], v17 offset:50176
    s_waitcnt lgkmcnt(8)
    v_mfma_f32_16x16x32_bf16 v[200:203], v[72:75], v[112:115], v[200:203]
    ds_read_b64_tr_b16 v[64:65], v10 offset:57344
    v_mfma_f32_16x16x32_bf16 v[232:235], v[72:75], v[116:119], v[232:235]
    ds_read_b64_tr_b16 v[66:67], v10 offset:58368
    v_add_u32 v10, 98304, v10
    v_mfma_f32_16x16x32_bf16 v[204:207], v[76:79], v[112:115], v[204:207]
    ds_read_b64_tr_b16 v[68:69], v11 offset:57344
    v_mfma_f32_16x16x32_bf16 v[236:239], v[76:79], v[116:119], v[236:239]
    ds_read_b64_tr_b16 v[70:71], v11 offset:58368
    v_add_u32 v11, 98304, v11
    buffer_load_dwordx4 v[48:51], v6, s[8:11], s32 offen offset:3072 sc1
    s_waitcnt lgkmcnt(8)
    v_mfma_f32_16x16x32_bf16 v[208:211], v[80:83], v[112:115], v[208:211]
    ds_read_b64_tr_b16 v[72:73], v12 offset:57344
    v_mfma_f32_16x16x32_bf16 v[240:243], v[80:83], v[116:119], v[240:243]
    ds_read_b64_tr_b16 v[74:75], v12 offset:58368
    v_add_u32 v12, 98304, v12
    v_mfma_f32_16x16x32_bf16 v[212:215], v[84:87], v[112:115], v[212:215]
    ds_read_b64_tr_b16 v[76:77], v13 offset:57344
    v_mfma_f32_16x16x32_bf16 v[244:247], v[84:87], v[116:119], v[244:247]
    ds_read_b64_tr_b16 v[78:79], v13 offset:58368
    v_add_u32 v13, 98304, v13
    buffer_load_dwordx4 v[52:55], v7, s[8:11], s32 offen offset:3072 sc1
    s_waitcnt lgkmcnt(8)
    v_mfma_f32_16x16x32_bf16 v[216:219], v[88:91], v[112:115], v[216:219]
    ds_read_b64_tr_b16 v[80:81], v14 offset:57344
    v_mfma_f32_16x16x32_bf16 v[248:251], v[88:91], v[116:119], v[248:251]
    ds_read_b64_tr_b16 v[82:83], v14 offset:58368
    v_add_u32 v14, 98304, v14
    v_mfma_f32_16x16x32_bf16 v[220:223], v[92:95], v[112:115], v[220:223]
    ds_read_b64_tr_b16 v[84:85], v15 offset:57344
    v_mfma_f32_16x16x32_bf16 v[252:255], v[92:95], v[116:119], v[252:255]
    ds_read_b64_tr_b16 v[86:87], v15 offset:58368
    v_add_u32 v15, 98304, v15
    s_mov_b32 s32, 12288
    buffer_load_dwordx4 v[96:99], v6, s[8:11], s32 offen offset:0 sc1
    s_waitcnt lgkmcnt(8)
    s_waitcnt vmcnt(12)
    v_mfma_f32_16x16x32_bf16 v[192:195], v[64:67], v[120:123], v[192:195]
    ds_read_b64_tr_b16 v[88:89], v16 offset:57344
    v_mfma_f32_16x16x32_bf16 v[224:227], v[64:67], v[124:127], v[224:227]
    ds_read_b64_tr_b16 v[90:91], v16 offset:58368
    v_add_u32 v16, 98304, v16
    v_mfma_f32_16x16x32_bf16 v[196:199], v[68:71], v[120:123], v[196:199]
    ds_read_b64_tr_b16 v[92:93], v17 offset:57344
    v_mfma_f32_16x16x32_bf16 v[228:231], v[68:71], v[124:127], v[228:231]
    ds_read_b64_tr_b16 v[94:95], v17 offset:58368
    v_add_u32 v17, 98304, v17
    buffer_load_dwordx4 v[100:103], v7, s[8:11], s32 offen offset:0 sc1
    s_barrier
    s_waitcnt lgkmcnt(8)
    v_mfma_f32_16x16x32_bf16 v[200:203], v[72:75], v[120:123], v[200:203]
    ds_read_b64_tr_b16 v[64:65], v10 offset:32768
    v_mfma_f32_16x16x32_bf16 v[232:235], v[72:75], v[124:127], v[232:235]
    ds_read_b64_tr_b16 v[66:67], v10 offset:33792
    v_mfma_f32_16x16x32_bf16 v[204:207], v[76:79], v[120:123], v[204:207]
    ds_read_b64_tr_b16 v[68:69], v11 offset:32768
    v_mfma_f32_16x16x32_bf16 v[236:239], v[76:79], v[124:127], v[236:239]
    ds_read_b64_tr_b16 v[70:71], v11 offset:33792
    s_waitcnt lgkmcnt(8)
    v_mfma_f32_16x16x32_bf16 v[208:211], v[80:83], v[120:123], v[208:211]
    ds_read_b64_tr_b16 v[72:73], v12 offset:32768
    buffer_store_dwordx4 v[144:147], v58, s[16:19], s47 offen sc1
    v_mfma_f32_16x16x32_bf16 v[240:243], v[80:83], v[124:127], v[240:243]
    ds_read_b64_tr_b16 v[74:75], v12 offset:33792
    v_mfma_f32_16x16x32_bf16 v[212:215], v[84:87], v[120:123], v[212:215]
    ds_read_b64_tr_b16 v[76:77], v13 offset:32768
    v_mfma_f32_16x16x32_bf16 v[244:247], v[84:87], v[124:127], v[244:247]
    ds_read_b64_tr_b16 v[78:79], v13 offset:33792
    s_waitcnt lgkmcnt(8)
    v_mfma_f32_16x16x32_bf16 v[216:219], v[88:91], v[120:123], v[216:219]
    ds_read_b64_tr_b16 v[80:81], v14 offset:32768
    v_mfma_f32_16x16x32_bf16 v[248:251], v[88:91], v[124:127], v[248:251]
    ds_read_b64_tr_b16 v[82:83], v14 offset:33792
    v_mfma_f32_16x16x32_bf16 v[220:223], v[92:95], v[120:123], v[220:223]
    ds_read_b64_tr_b16 v[84:85], v15 offset:32768
    v_mfma_f32_16x16x32_bf16 v[252:255], v[92:95], v[124:127], v[252:255]
    ds_read_b64_tr_b16 v[86:87], v15 offset:33792
    s_waitcnt lgkmcnt(8)
    s_waitcnt vmcnt(11)
    v_mfma_f32_16x16x32_bf16 v[192:195], v[64:67], v[24:27], v[192:195]
    ds_read_b64_tr_b16 v[88:89], v16 offset:32768
    v_mfma_f32_16x16x32_bf16 v[224:227], v[64:67], v[28:31], v[224:227]
    ds_read_b64_tr_b16 v[90:91], v16 offset:33792
    v_mfma_f32_16x16x32_bf16 v[196:199], v[68:71], v[24:27], v[196:199]
    ds_read_b64_tr_b16 v[92:93], v17 offset:32768
    v_mfma_f32_16x16x32_bf16 v[228:231], v[68:71], v[28:31], v[228:231]
    ds_read_b64_tr_b16 v[94:95], v17 offset:33792
    buffer_load_dwordx4 v[104:107], v6, s[8:11], s32 offen offset:1024 sc1
    s_waitcnt lgkmcnt(8)
    v_mfma_f32_16x16x32_bf16 v[200:203], v[72:75], v[24:27], v[200:203]
    ds_read_b64_tr_b16 v[64:65], v10 offset:40960
    v_mfma_f32_16x16x32_bf16 v[232:235], v[72:75], v[28:31], v[232:235]
    ds_read_b64_tr_b16 v[66:67], v10 offset:41984
    v_mfma_f32_16x16x32_bf16 v[204:207], v[76:79], v[24:27], v[204:207]
    ds_read_b64_tr_b16 v[68:69], v11 offset:40960
    v_mfma_f32_16x16x32_bf16 v[236:239], v[76:79], v[28:31], v[236:239]
    ds_read_b64_tr_b16 v[70:71], v11 offset:41984
    buffer_load_dwordx4 v[108:111], v7, s[8:11], s32 offen offset:1024 sc1
    s_waitcnt lgkmcnt(8)
    v_mfma_f32_16x16x32_bf16 v[208:211], v[80:83], v[24:27], v[208:211]
    ds_read_b64_tr_b16 v[72:73], v12 offset:40960
    v_mfma_f32_16x16x32_bf16 v[240:243], v[80:83], v[28:31], v[240:243]
    ds_read_b64_tr_b16 v[74:75], v12 offset:41984
    v_mfma_f32_16x16x32_bf16 v[212:215], v[84:87], v[24:27], v[212:215]
    ds_read_b64_tr_b16 v[76:77], v13 offset:40960
    v_mfma_f32_16x16x32_bf16 v[244:247], v[84:87], v[28:31], v[244:247]
    ds_read_b64_tr_b16 v[78:79], v13 offset:41984
    s_add_u32 m0, s33, 98304
    s_mov_b32 s31, 4194304
    buffer_load_dwordx4 v2, s[4:7], s31 offen offset:0 lds
    s_waitcnt lgkmcnt(8)
    v_mfma_f32_16x16x32_bf16 v[216:219], v[88:91], v[24:27], v[216:219]
    ds_read_b64_tr_b16 v[80:81], v14 offset:40960
    v_mfma_f32_16x16x32_bf16 v[248:251], v[88:91], v[28:31], v[248:251]
    ds_read_b64_tr_b16 v[82:83], v14 offset:41984
    v_mfma_f32_16x16x32_bf16 v[220:223], v[92:95], v[24:27], v[220:223]
    ds_read_b64_tr_b16 v[84:85], v15 offset:40960
    buffer_load_dwordx4 v[112:115], v6, s[8:11], s32 offen offset:2048 sc1
    v_mfma_f32_16x16x32_bf16 v[252:255], v[92:95], v[28:31], v[252:255]
    ds_read_b64_tr_b16 v[86:87], v15 offset:41984
    s_waitcnt lgkmcnt(8)
    s_waitcnt vmcnt(13)
    v_mfma_f32_16x16x32_bf16 v[192:195], v[64:67], v[32:35], v[192:195]
    ds_read_b64_tr_b16 v[88:89], v16 offset:40960
    v_mfma_f32_16x16x32_bf16 v[224:227], v[64:67], v[36:39], v[224:227]
    ds_read_b64_tr_b16 v[90:91], v16 offset:41984
    v_mfma_f32_16x16x32_bf16 v[196:199], v[68:71], v[32:35], v[196:199]
    ds_read_b64_tr_b16 v[92:93], v17 offset:40960
    v_mfma_f32_16x16x32_bf16 v[228:231], v[68:71], v[36:39], v[228:231]
    ds_read_b64_tr_b16 v[94:95], v17 offset:41984
    buffer_load_dwordx4 v[116:119], v7, s[8:11], s32 offen offset:2048 sc1
    s_waitcnt lgkmcnt(8)
    v_mfma_f32_16x16x32_bf16 v[200:203], v[72:75], v[32:35], v[200:203]
    ds_read_b64_tr_b16 v[64:65], v10 offset:49152
    v_mfma_f32_16x16x32_bf16 v[232:235], v[72:75], v[36:39], v[232:235]
    ds_read_b64_tr_b16 v[66:67], v10 offset:50176
    v_mfma_f32_16x16x32_bf16 v[204:207], v[76:79], v[32:35], v[204:207]
    ds_read_b64_tr_b16 v[68:69], v11 offset:49152
    v_mfma_f32_16x16x32_bf16 v[236:239], v[76:79], v[36:39], v[236:239]
    ds_read_b64_tr_b16 v[70:71], v11 offset:50176
    buffer_load_dwordx4 v3, s[4:7], s31 offen offset:1024 lds
    s_waitcnt lgkmcnt(8)
    v_mfma_f32_16x16x32_bf16 v[208:211], v[80:83], v[32:35], v[208:211]
    ds_read_b64_tr_b16 v[72:73], v12 offset:49152
    v_mfma_f32_16x16x32_bf16 v[240:243], v[80:83], v[36:39], v[240:243]
    ds_read_b64_tr_b16 v[74:75], v12 offset:50176
    v_mfma_f32_16x16x32_bf16 v[212:215], v[84:87], v[32:35], v[212:215]
    ds_read_b64_tr_b16 v[76:77], v13 offset:49152
    buffer_store_dwordx4 v[148:151], v59, s[16:19], s47 offen sc1
    v_mfma_f32_16x16x32_bf16 v[244:247], v[84:87], v[36:39], v[244:247]
    ds_read_b64_tr_b16 v[78:79], v13 offset:50176
    s_waitcnt lgkmcnt(8)
    v_mfma_f32_16x16x32_bf16 v[216:219], v[88:91], v[32:35], v[216:219]
    ds_read_b64_tr_b16 v[80:81], v14 offset:49152
    v_mfma_f32_16x16x32_bf16 v[248:251], v[88:91], v[36:39], v[248:251]
    ds_read_b64_tr_b16 v[82:83], v14 offset:50176
    v_mfma_f32_16x16x32_bf16 v[220:223], v[92:95], v[32:35], v[220:223]
    ds_read_b64_tr_b16 v[84:85], v15 offset:49152
    v_mfma_f32_16x16x32_bf16 v[252:255], v[92:95], v[36:39], v[252:255]
    ds_read_b64_tr_b16 v[86:87], v15 offset:50176
    s_waitcnt lgkmcnt(8)
    s_waitcnt vmcnt(13)
    v_mfma_f32_16x16x32_bf16 v[192:195], v[64:67], v[40:43], v[192:195]
    ds_read_b64_tr_b16 v[88:89], v16 offset:49152
    v_mfma_f32_16x16x32_bf16 v[224:227], v[64:67], v[44:47], v[224:227]
    ds_read_b64_tr_b16 v[90:91], v16 offset:50176
    v_mfma_f32_16x16x32_bf16 v[196:199], v[68:71], v[40:43], v[196:199]
    ds_read_b64_tr_b16 v[92:93], v17 offset:49152
    v_mfma_f32_16x16x32_bf16 v[228:231], v[68:71], v[44:47], v[228:231]
    ds_read_b64_tr_b16 v[94:95], v17 offset:50176
    s_waitcnt lgkmcnt(8)
    v_mfma_f32_16x16x32_bf16 v[200:203], v[72:75], v[40:43], v[200:203]
    ds_read_b64_tr_b16 v[64:65], v10 offset:57344
    v_mfma_f32_16x16x32_bf16 v[232:235], v[72:75], v[44:47], v[232:235]
    ds_read_b64_tr_b16 v[66:67], v10 offset:58368
    v_add_u32 v10, 4294934528, v10
    buffer_load_dwordx4 v4, s[4:7], s31 offen offset:2048 lds
    v_mfma_f32_16x16x32_bf16 v[204:207], v[76:79], v[40:43], v[204:207]
    ds_read_b64_tr_b16 v[68:69], v11 offset:57344
    v_mfma_f32_16x16x32_bf16 v[236:239], v[76:79], v[44:47], v[236:239]
    ds_read_b64_tr_b16 v[70:71], v11 offset:58368
    v_add_u32 v11, 4294934528, v11
    s_waitcnt lgkmcnt(8)
    v_mfma_f32_16x16x32_bf16 v[208:211], v[80:83], v[40:43], v[208:211]
    ds_read_b64_tr_b16 v[72:73], v12 offset:57344
    v_mfma_f32_16x16x32_bf16 v[240:243], v[80:83], v[44:47], v[240:243]
    ds_read_b64_tr_b16 v[74:75], v12 offset:58368
    v_add_u32 v12, 4294934528, v12
    buffer_load_dwordx4 v[120:123], v6, s[8:11], s32 offen offset:3072 sc1
    v_mfma_f32_16x16x32_bf16 v[212:215], v[84:87], v[40:43], v[212:215]
    ds_read_b64_tr_b16 v[76:77], v13 offset:57344
    v_mfma_f32_16x16x32_bf16 v[244:247], v[84:87], v[44:47], v[244:247]
    ds_read_b64_tr_b16 v[78:79], v13 offset:58368
    v_add_u32 v13, 4294934528, v13
    s_waitcnt lgkmcnt(8)
    v_mfma_f32_16x16x32_bf16 v[216:219], v[88:91], v[40:43], v[216:219]
    ds_read_b64_tr_b16 v[80:81], v14 offset:57344
    v_mfma_f32_16x16x32_bf16 v[248:251], v[88:91], v[44:47], v[248:251]
    ds_read_b64_tr_b16 v[82:83], v14 offset:58368
    v_add_u32 v14, 4294934528, v14
    buffer_load_dwordx4 v[124:127], v7, s[8:11], s32 offen offset:3072 sc1
    v_mfma_f32_16x16x32_bf16 v[220:223], v[92:95], v[40:43], v[220:223]
    ds_read_b64_tr_b16 v[84:85], v15 offset:57344
    v_mfma_f32_16x16x32_bf16 v[252:255], v[92:95], v[44:47], v[252:255]
    ds_read_b64_tr_b16 v[86:87], v15 offset:58368
    v_add_u32 v15, 4294934528, v15
    s_waitcnt lgkmcnt(8)
    s_waitcnt vmcnt(13)
    v_mfma_f32_16x16x32_bf16 v[192:195], v[64:67], v[48:51], v[192:195]
    ds_read_b64_tr_b16 v[88:89], v16 offset:57344
    v_mfma_f32_16x16x32_bf16 v[224:227], v[64:67], v[52:55], v[224:227]
    ds_read_b64_tr_b16 v[90:91], v16 offset:58368
    v_add_u32 v16, 4294934528, v16
    buffer_load_dwordx4 v5, s[4:7], s31 offen offset:3072 lds
    v_mfma_f32_16x16x32_bf16 v[196:199], v[68:71], v[48:51], v[196:199]
    ds_read_b64_tr_b16 v[92:93], v17 offset:57344
    v_mfma_f32_16x16x32_bf16 v[228:231], v[68:71], v[52:55], v[228:231]
    ds_read_b64_tr_b16 v[94:95], v17 offset:58368
    v_add_u32 v17, 4294934528, v17
    s_barrier
    s_waitcnt lgkmcnt(8)
    v_mfma_f32_16x16x32_bf16 v[200:203], v[72:75], v[48:51], v[200:203]
    ds_read_b64_tr_b16 v[64:65], v10 offset:0
    v_mfma_f32_16x16x32_bf16 v[232:235], v[72:75], v[52:55], v[232:235]
    ds_read_b64_tr_b16 v[66:67], v10 offset:1024
    s_mov_b32 s32, 16384
    buffer_load_dwordx4 v[24:27], v6, s[8:11], s32 offen offset:0 sc1
    v_mfma_f32_16x16x32_bf16 v[204:207], v[76:79], v[48:51], v[204:207]
    ds_read_b64_tr_b16 v[68:69], v11 offset:0
    v_mfma_f32_16x16x32_bf16 v[236:239], v[76:79], v[52:55], v[236:239]
    ds_read_b64_tr_b16 v[70:71], v11 offset:1024
    s_waitcnt lgkmcnt(8)
    v_mfma_f32_16x16x32_bf16 v[208:211], v[80:83], v[48:51], v[208:211]
    ds_read_b64_tr_b16 v[72:73], v12 offset:0
    v_mfma_f32_16x16x32_bf16 v[240:243], v[80:83], v[52:55], v[240:243]
    ds_read_b64_tr_b16 v[74:75], v12 offset:1024
    buffer_load_dwordx4 v[28:31], v7, s[8:11], s32 offen offset:0 sc1
    v_mfma_f32_16x16x32_bf16 v[212:215], v[84:87], v[48:51], v[212:215]
    ds_read_b64_tr_b16 v[76:77], v13 offset:0
    v_mfma_f32_16x16x32_bf16 v[244:247], v[84:87], v[52:55], v[244:247]
    ds_read_b64_tr_b16 v[78:79], v13 offset:1024
    s_waitcnt lgkmcnt(8)
    v_mfma_f32_16x16x32_bf16 v[216:219], v[88:91], v[48:51], v[216:219]
    ds_read_b64_tr_b16 v[80:81], v14 offset:0
    v_mfma_f32_16x16x32_bf16 v[248:251], v[88:91], v[52:55], v[248:251]
    ds_read_b64_tr_b16 v[82:83], v14 offset:1024
    buffer_store_dwordx4 v[152:155], v60, s[16:19], s47 offen sc1
    v_mfma_f32_16x16x32_bf16 v[220:223], v[92:95], v[48:51], v[220:223]
    ds_read_b64_tr_b16 v[84:85], v15 offset:0
    v_mfma_f32_16x16x32_bf16 v[252:255], v[92:95], v[52:55], v[252:255]
    ds_read_b64_tr_b16 v[86:87], v15 offset:1024
    s_waitcnt lgkmcnt(8)
    s_waitcnt vmcnt(15)
    v_mfma_f32_16x16x32_bf16 v[192:195], v[64:67], v[96:99], v[192:195]
    ds_read_b64_tr_b16 v[88:89], v16 offset:0
    v_mfma_f32_16x16x32_bf16 v[224:227], v[64:67], v[100:103], v[224:227]
    ds_read_b64_tr_b16 v[90:91], v16 offset:1024
    v_mfma_f32_16x16x32_bf16 v[196:199], v[68:71], v[96:99], v[196:199]
    ds_read_b64_tr_b16 v[92:93], v17 offset:0
    v_mfma_f32_16x16x32_bf16 v[228:231], v[68:71], v[100:103], v[228:231]
    ds_read_b64_tr_b16 v[94:95], v17 offset:1024
    s_waitcnt lgkmcnt(8)
    v_mfma_f32_16x16x32_bf16 v[200:203], v[72:75], v[96:99], v[200:203]
    ds_read_b64_tr_b16 v[64:65], v10 offset:8192
    v_mfma_f32_16x16x32_bf16 v[232:235], v[72:75], v[100:103], v[232:235]
    ds_read_b64_tr_b16 v[66:67], v10 offset:9216
    v_mfma_f32_16x16x32_bf16 v[204:207], v[76:79], v[96:99], v[204:207]
    ds_read_b64_tr_b16 v[68:69], v11 offset:8192
    v_mfma_f32_16x16x32_bf16 v[236:239], v[76:79], v[100:103], v[236:239]
    ds_read_b64_tr_b16 v[70:71], v11 offset:9216
    s_waitcnt lgkmcnt(8)
    v_mfma_f32_16x16x32_bf16 v[208:211], v[80:83], v[96:99], v[208:211]
    ds_read_b64_tr_b16 v[72:73], v12 offset:8192
    buffer_load_dwordx4 v[32:35], v6, s[8:11], s32 offen offset:1024 sc1
    v_mfma_f32_16x16x32_bf16 v[240:243], v[80:83], v[100:103], v[240:243]
    ds_read_b64_tr_b16 v[74:75], v12 offset:9216
    v_mfma_f32_16x16x32_bf16 v[212:215], v[84:87], v[96:99], v[212:215]
    ds_read_b64_tr_b16 v[76:77], v13 offset:8192
    v_mfma_f32_16x16x32_bf16 v[244:247], v[84:87], v[100:103], v[244:247]
    ds_read_b64_tr_b16 v[78:79], v13 offset:9216
    s_waitcnt lgkmcnt(8)
    v_mfma_f32_16x16x32_bf16 v[216:219], v[88:91], v[96:99], v[216:219]
    ds_read_b64_tr_b16 v[80:81], v14 offset:8192
    buffer_load_dwordx4 v[36:39], v7, s[8:11], s32 offen offset:1024 sc1
    v_mfma_f32_16x16x32_bf16 v[248:251], v[88:91], v[100:103], v[248:251]
    ds_read_b64_tr_b16 v[82:83], v14 offset:9216
    v_mfma_f32_16x16x32_bf16 v[220:223], v[92:95], v[96:99], v[220:223]
    ds_read_b64_tr_b16 v[84:85], v15 offset:8192
    v_mfma_f32_16x16x32_bf16 v[252:255], v[92:95], v[100:103], v[252:255]
    ds_read_b64_tr_b16 v[86:87], v15 offset:9216
    s_waitcnt lgkmcnt(8)
    s_waitcnt vmcnt(14)
    v_mfma_f32_16x16x32_bf16 v[192:195], v[64:67], v[104:107], v[192:195]
    ds_read_b64_tr_b16 v[88:89], v16 offset:8192
    v_mfma_f32_16x16x32_bf16 v[224:227], v[64:67], v[108:111], v[224:227]
    ds_read_b64_tr_b16 v[90:91], v16 offset:9216
    s_add_u32 m0, s33, 0
    s_mov_b32 s31, 5242880
    buffer_load_dwordx4 v2, s[4:7], s31 offen offset:0 lds
    v_mfma_f32_16x16x32_bf16 v[196:199], v[68:71], v[104:107], v[196:199]
    ds_read_b64_tr_b16 v[92:93], v17 offset:8192
    v_mfma_f32_16x16x32_bf16 v[228:231], v[68:71], v[108:111], v[228:231]
    ds_read_b64_tr_b16 v[94:95], v17 offset:9216
    s_waitcnt lgkmcnt(8)
    v_mfma_f32_16x16x32_bf16 v[200:203], v[72:75], v[104:107], v[200:203]
    ds_read_b64_tr_b16 v[64:65], v10 offset:16384
    buffer_load_dwordx4 v[40:43], v6, s[8:11], s32 offen offset:2048 sc1
    v_mfma_f32_16x16x32_bf16 v[232:235], v[72:75], v[108:111], v[232:235]
    ds_read_b64_tr_b16 v[66:67], v10 offset:17408
    v_mfma_f32_16x16x32_bf16 v[204:207], v[76:79], v[104:107], v[204:207]
    ds_read_b64_tr_b16 v[68:69], v11 offset:16384
    v_mfma_f32_16x16x32_bf16 v[236:239], v[76:79], v[108:111], v[236:239]
    ds_read_b64_tr_b16 v[70:71], v11 offset:17408
    s_waitcnt lgkmcnt(8)
    v_mfma_f32_16x16x32_bf16 v[208:211], v[80:83], v[104:107], v[208:211]
    ds_read_b64_tr_b16 v[72:73], v12 offset:16384
    buffer_load_dwordx4 v[44:47], v7, s[8:11], s32 offen offset:2048 sc1
    v_mfma_f32_16x16x32_bf16 v[240:243], v[80:83], v[108:111], v[240:243]
    ds_read_b64_tr_b16 v[74:75], v12 offset:17408
    v_mfma_f32_16x16x32_bf16 v[212:215], v[84:87], v[104:107], v[212:215]
    ds_read_b64_tr_b16 v[76:77], v13 offset:16384
    v_mfma_f32_16x16x32_bf16 v[244:247], v[84:87], v[108:111], v[244:247]
    ds_read_b64_tr_b16 v[78:79], v13 offset:17408
    s_waitcnt lgkmcnt(8)
    v_mfma_f32_16x16x32_bf16 v[216:219], v[88:91], v[104:107], v[216:219]
    ds_read_b64_tr_b16 v[80:81], v14 offset:16384
    v_mfma_f32_16x16x32_bf16 v[248:251], v[88:91], v[108:111], v[248:251]
    ds_read_b64_tr_b16 v[82:83], v14 offset:17408
    buffer_store_dwordx4 v[156:159], v61, s[16:19], s47 offen sc1
    v_mfma_f32_16x16x32_bf16 v[220:223], v[92:95], v[104:107], v[220:223]
    ds_read_b64_tr_b16 v[84:85], v15 offset:16384
    v_mfma_f32_16x16x32_bf16 v[252:255], v[92:95], v[108:111], v[252:255]
    ds_read_b64_tr_b16 v[86:87], v15 offset:17408
    s_waitcnt lgkmcnt(8)
    s_waitcnt vmcnt(15)
    v_mfma_f32_16x16x32_bf16 v[192:195], v[64:67], v[112:115], v[192:195]
    ds_read_b64_tr_b16 v[88:89], v16 offset:16384
    v_mfma_f32_16x16x32_bf16 v[224:227], v[64:67], v[116:119], v[224:227]
    ds_read_b64_tr_b16 v[90:91], v16 offset:17408
    v_mfma_f32_16x16x32_bf16 v[196:199], v[68:71], v[112:115], v[196:199]
    ds_read_b64_tr_b16 v[92:93], v17 offset:16384
    v_mfma_f32_16x16x32_bf16 v[228:231], v[68:71], v[116:119], v[228:231]
    ds_read_b64_tr_b16 v[94:95], v17 offset:17408
    s_waitcnt lgkmcnt(8)
    v_mfma_f32_16x16x32_bf16 v[200:203], v[72:75], v[112:115], v[200:203]
    ds_read_b64_tr_b16 v[64:65], v10 offset:24576
    v_mfma_f32_16x16x32_bf16 v[232:235], v[72:75], v[116:119], v[232:235]
    ds_read_b64_tr_b16 v[66:67], v10 offset:25600
    v_mfma_f32_16x16x32_bf16 v[204:207], v[76:79], v[112:115], v[204:207]
    ds_read_b64_tr_b16 v[68:69], v11 offset:24576
    v_mfma_f32_16x16x32_bf16 v[236:239], v[76:79], v[116:119], v[236:239]
    ds_read_b64_tr_b16 v[70:71], v11 offset:25600
    buffer_load_dwordx4 v3, s[4:7], s31 offen offset:1024 lds
    s_waitcnt lgkmcnt(8)
    v_mfma_f32_16x16x32_bf16 v[208:211], v[80:83], v[112:115], v[208:211]
    ds_read_b64_tr_b16 v[72:73], v12 offset:24576
    v_mfma_f32_16x16x32_bf16 v[240:243], v[80:83], v[116:119], v[240:243]
    ds_read_b64_tr_b16 v[74:75], v12 offset:25600
    v_mfma_f32_16x16x32_bf16 v[212:215], v[84:87], v[112:115], v[212:215]
    ds_read_b64_tr_b16 v[76:77], v13 offset:24576
    v_mfma_f32_16x16x32_bf16 v[244:247], v[84:87], v[116:119], v[244:247]
    ds_read_b64_tr_b16 v[78:79], v13 offset:25600
    buffer_load_dwordx4 v4, s[4:7], s31 offen offset:2048 lds
    s_waitcnt lgkmcnt(8)
    v_mfma_f32_16x16x32_bf16 v[216:219], v[88:91], v[112:115], v[216:219]
    ds_read_b64_tr_b16 v[80:81], v14 offset:24576
    v_mfma_f32_16x16x32_bf16 v[248:251], v[88:91], v[116:119], v[248:251]
    ds_read_b64_tr_b16 v[82:83], v14 offset:25600
    v_mfma_f32_16x16x32_bf16 v[220:223], v[92:95], v[112:115], v[220:223]
    ds_read_b64_tr_b16 v[84:85], v15 offset:24576
    v_mfma_f32_16x16x32_bf16 v[252:255], v[92:95], v[116:119], v[252:255]
    ds_read_b64_tr_b16 v[86:87], v15 offset:25600
    buffer_load_dwordx4 v[48:51], v6, s[8:11], s32 offen offset:3072 sc1
    s_waitcnt lgkmcnt(8)
    s_waitcnt vmcnt(13)
    v_mfma_f32_16x16x32_bf16 v[192:195], v[64:67], v[120:123], v[192:195]
    ds_read_b64_tr_b16 v[88:89], v16 offset:24576
    v_mfma_f32_16x16x32_bf16 v[224:227], v[64:67], v[124:127], v[224:227]
    ds_read_b64_tr_b16 v[90:91], v16 offset:25600
    v_mfma_f32_16x16x32_bf16 v[196:199], v[68:71], v[120:123], v[196:199]
    ds_read_b64_tr_b16 v[92:93], v17 offset:24576
    v_mfma_f32_16x16x32_bf16 v[228:231], v[68:71], v[124:127], v[228:231]
    ds_read_b64_tr_b16 v[94:95], v17 offset:25600
    buffer_load_dwordx4 v[52:55], v7, s[8:11], s32 offen offset:3072 sc1
    s_waitcnt vmcnt(13)
    s_barrier
    s_waitcnt lgkmcnt(8)
    v_mfma_f32_16x16x32_bf16 v[200:203], v[72:75], v[120:123], v[200:203]
    ds_read_b64_tr_b16 v[64:65], v10 offset:32768
    v_mfma_f32_16x16x32_bf16 v[232:235], v[72:75], v[124:127], v[232:235]
    ds_read_b64_tr_b16 v[66:67], v10 offset:33792
    v_mfma_f32_16x16x32_bf16 v[204:207], v[76:79], v[120:123], v[204:207]
    ds_read_b64_tr_b16 v[68:69], v11 offset:32768
    v_mfma_f32_16x16x32_bf16 v[236:239], v[76:79], v[124:127], v[236:239]
    ds_read_b64_tr_b16 v[70:71], v11 offset:33792
    buffer_load_dwordx4 v5, s[4:7], s31 offen offset:3072 lds
    s_waitcnt lgkmcnt(8)
    v_mfma_f32_16x16x32_bf16 v[208:211], v[80:83], v[120:123], v[208:211]
    ds_read_b64_tr_b16 v[72:73], v12 offset:32768
    v_mfma_f32_16x16x32_bf16 v[240:243], v[80:83], v[124:127], v[240:243]
    ds_read_b64_tr_b16 v[74:75], v12 offset:33792
    v_mfma_f32_16x16x32_bf16 v[212:215], v[84:87], v[120:123], v[212:215]
    ds_read_b64_tr_b16 v[76:77], v13 offset:32768
    v_mfma_f32_16x16x32_bf16 v[244:247], v[84:87], v[124:127], v[244:247]
    ds_read_b64_tr_b16 v[78:79], v13 offset:33792
    s_mov_b32 s32, 20480
    buffer_load_dwordx4 v[96:99], v6, s[8:11], s32 offen offset:0 sc1
    s_waitcnt lgkmcnt(8)
    v_mfma_f32_16x16x32_bf16 v[216:219], v[88:91], v[120:123], v[216:219]
    ds_read_b64_tr_b16 v[80:81], v14 offset:32768
    v_mfma_f32_16x16x32_bf16 v[248:251], v[88:91], v[124:127], v[248:251]
    ds_read_b64_tr_b16 v[82:83], v14 offset:33792
    v_mfma_f32_16x16x32_bf16 v[220:223], v[92:95], v[120:123], v[220:223]
    ds_read_b64_tr_b16 v[84:85], v15 offset:32768
    v_mfma_f32_16x16x32_bf16 v[252:255], v[92:95], v[124:127], v[252:255]
    ds_read_b64_tr_b16 v[86:87], v15 offset:33792
    buffer_load_dwordx4 v[100:103], v7, s[8:11], s32 offen offset:0 sc1
    s_waitcnt lgkmcnt(8)
    s_waitcnt vmcnt(14)
    v_mfma_f32_16x16x32_bf16 v[192:195], v[64:67], v[24:27], v[192:195]
    ds_read_b64_tr_b16 v[88:89], v16 offset:32768
    v_mfma_f32_16x16x32_bf16 v[224:227], v[64:67], v[28:31], v[224:227]
    ds_read_b64_tr_b16 v[90:91], v16 offset:33792
    v_mfma_f32_16x16x32_bf16 v[196:199], v[68:71], v[24:27], v[196:199]
    ds_read_b64_tr_b16 v[92:93], v17 offset:32768
    v_mfma_f32_16x16x32_bf16 v[228:231], v[68:71], v[28:31], v[228:231]
    ds_read_b64_tr_b16 v[94:95], v17 offset:33792
    s_cmp_eq_u32 s30, 0
    s_cselect_b32 s18, 0, s18
    buffer_store_dwordx4 v[160:163], v58, s[16:19], s48 offen sc1
    s_waitcnt lgkmcnt(8)
    v_mfma_f32_16x16x32_bf16 v[200:203], v[72:75], v[24:27], v[200:203]
    ds_read_b64_tr_b16 v[64:65], v10 offset:40960
    v_mfma_f32_16x16x32_bf16 v[232:235], v[72:75], v[28:31], v[232:235]
    ds_read_b64_tr_b16 v[66:67], v10 offset:41984
    v_mfma_f32_16x16x32_bf16 v[204:207], v[76:79], v[24:27], v[204:207]
    ds_read_b64_tr_b16 v[68:69], v11 offset:40960
    v_mfma_f32_16x16x32_bf16 v[236:239], v[76:79], v[28:31], v[236:239]
    ds_read_b64_tr_b16 v[70:71], v11 offset:41984
    s_waitcnt lgkmcnt(8)
    v_mfma_f32_16x16x32_bf16 v[208:211], v[80:83], v[24:27], v[208:211]
    ds_read_b64_tr_b16 v[72:73], v12 offset:40960
    v_mfma_f32_16x16x32_bf16 v[240:243], v[80:83], v[28:31], v[240:243]
    ds_read_b64_tr_b16 v[74:75], v12 offset:41984
    v_mfma_f32_16x16x32_bf16 v[212:215], v[84:87], v[24:27], v[212:215]
    ds_read_b64_tr_b16 v[76:77], v13 offset:40960
    v_mfma_f32_16x16x32_bf16 v[244:247], v[84:87], v[28:31], v[244:247]
    ds_read_b64_tr_b16 v[78:79], v13 offset:41984
    s_waitcnt lgkmcnt(8)
    v_mfma_f32_16x16x32_bf16 v[216:219], v[88:91], v[24:27], v[216:219]
    ds_read_b64_tr_b16 v[80:81], v14 offset:40960
    v_mfma_f32_16x16x32_bf16 v[248:251], v[88:91], v[28:31], v[248:251]
    ds_read_b64_tr_b16 v[82:83], v14 offset:41984
    v_mfma_f32_16x16x32_bf16 v[220:223], v[92:95], v[24:27], v[220:223]
    ds_read_b64_tr_b16 v[84:85], v15 offset:40960
    buffer_load_dwordx4 v[104:107], v6, s[8:11], s32 offen offset:1024 sc1
    v_mfma_f32_16x16x32_bf16 v[252:255], v[92:95], v[28:31], v[252:255]
    ds_read_b64_tr_b16 v[86:87], v15 offset:41984
    s_waitcnt lgkmcnt(8)
    s_waitcnt vmcnt(13)
    v_mfma_f32_16x16x32_bf16 v[192:195], v[64:67], v[32:35], v[192:195]
    ds_read_b64_tr_b16 v[88:89], v16 offset:40960
    v_mfma_f32_16x16x32_bf16 v[224:227], v[64:67], v[36:39], v[224:227]
    ds_read_b64_tr_b16 v[90:91], v16 offset:41984
    v_mfma_f32_16x16x32_bf16 v[196:199], v[68:71], v[32:35], v[196:199]
    ds_read_b64_tr_b16 v[92:93], v17 offset:40960
    buffer_load_dwordx4 v[108:111], v7, s[8:11], s32 offen offset:1024 sc1
    v_mfma_f32_16x16x32_bf16 v[228:231], v[68:71], v[36:39], v[228:231]
    ds_read_b64_tr_b16 v[94:95], v17 offset:41984
    s_waitcnt lgkmcnt(8)
    v_mfma_f32_16x16x32_bf16 v[200:203], v[72:75], v[32:35], v[200:203]
    ds_read_b64_tr_b16 v[64:65], v10 offset:49152
    v_mfma_f32_16x16x32_bf16 v[232:235], v[72:75], v[36:39], v[232:235]
    ds_read_b64_tr_b16 v[66:67], v10 offset:50176
    v_mfma_f32_16x16x32_bf16 v[204:207], v[76:79], v[32:35], v[204:207]
    ds_read_b64_tr_b16 v[68:69], v11 offset:49152
    s_add_u32 m0, s33, 131072
    s_mov_b32 s31, 6291456
    buffer_load_dwordx4 v2, s[4:7], s31 offen offset:0 lds
    v_mfma_f32_16x16x32_bf16 v[236:239], v[76:79], v[36:39], v[236:239]
    ds_read_b64_tr_b16 v[70:71], v11 offset:50176
    s_waitcnt lgkmcnt(8)
    v_mfma_f32_16x16x32_bf16 v[208:211], v[80:83], v[32:35], v[208:211]
    ds_read_b64_tr_b16 v[72:73], v12 offset:49152
    v_mfma_f32_16x16x32_bf16 v[240:243], v[80:83], v[36:39], v[240:243]
    ds_read_b64_tr_b16 v[74:75], v12 offset:50176
    v_mfma_f32_16x16x32_bf16 v[212:215], v[84:87], v[32:35], v[212:215]
    ds_read_b64_tr_b16 v[76:77], v13 offset:49152
    buffer_store_dwordx4 v[164:167], v59, s[16:19], s48 offen sc1
    v_mfma_f32_16x16x32_bf16 v[244:247], v[84:87], v[36:39], v[244:247]
    ds_read_b64_tr_b16 v[78:79], v13 offset:50176
    s_waitcnt lgkmcnt(8)
    v_mfma_f32_16x16x32_bf16 v[216:219], v[88:91], v[32:35], v[216:219]
    ds_read_b64_tr_b16 v[80:81], v14 offset:49152
    v_mfma_f32_16x16x32_bf16 v[248:251], v[88:91], v[36:39], v[248:251]
    ds_read_b64_tr_b16 v[82:83], v14 offset:50176
    v_mfma_f32_16x16x32_bf16 v[220:223], v[92:95], v[32:35], v[220:223]
    ds_read_b64_tr_b16 v[84:85], v15 offset:49152
    v_mfma_f32_16x16x32_bf16 v[252:255], v[92:95], v[36:39], v[252:255]
    ds_read_b64_tr_b16 v[86:87], v15 offset:50176
    s_waitcnt lgkmcnt(8)
    s_waitcnt vmcnt(13)
    v_mfma_f32_16x16x32_bf16 v[192:195], v[64:67], v[40:43], v[192:195]
    ds_read_b64_tr_b16 v[88:89], v16 offset:49152
    v_mfma_f32_16x16x32_bf16 v[224:227], v[64:67], v[44:47], v[224:227]
    ds_read_b64_tr_b16 v[90:91], v16 offset:50176
    v_mfma_f32_16x16x32_bf16 v[196:199], v[68:71], v[40:43], v[196:199]
    ds_read_b64_tr_b16 v[92:93], v17 offset:49152
    v_mfma_f32_16x16x32_bf16 v[228:231], v[68:71], v[44:47], v[228:231]
    ds_read_b64_tr_b16 v[94:95], v17 offset:50176
    s_waitcnt lgkmcnt(8)
    v_mfma_f32_16x16x32_bf16 v[200:203], v[72:75], v[40:43], v[200:203]
    ds_read_b64_tr_b16 v[64:65], v10 offset:57344
    v_mfma_f32_16x16x32_bf16 v[232:235], v[72:75], v[44:47], v[232:235]
    ds_read_b64_tr_b16 v[66:67], v10 offset:58368
    v_add_u32 v10, 4294901760, v10
    buffer_load_dwordx4 v[112:115], v6, s[8:11], s32 offen offset:2048 sc1
    v_mfma_f32_16x16x32_bf16 v[204:207], v[76:79], v[40:43], v[204:207]
    ds_read_b64_tr_b16 v[68:69], v11 offset:57344
    v_mfma_f32_16x16x32_bf16 v[236:239], v[76:79], v[44:47], v[236:239]
    ds_read_b64_tr_b16 v[70:71], v11 offset:58368
    v_add_u32 v11, 4294901760, v11
    s_waitcnt lgkmcnt(8)
    v_mfma_f32_16x16x32_bf16 v[208:211], v[80:83], v[40:43], v[208:211]
    ds_read_b64_tr_b16 v[72:73], v12 offset:57344
    v_mfma_f32_16x16x32_bf16 v[240:243], v[80:83], v[44:47], v[240:243]
    ds_read_b64_tr_b16 v[74:75], v12 offset:58368
    v_add_u32 v12, 4294901760, v12
    buffer_load_dwordx4 v[116:119], v7, s[8:11], s32 offen offset:2048 sc1
    v_mfma_f32_16x16x32_bf16 v[212:215], v[84:87], v[40:43], v[212:215]
    ds_read_b64_tr_b16 v[76:77], v13 offset:57344
    v_mfma_f32_16x16x32_bf16 v[244:247], v[84:87], v[44:47], v[244:247]
    ds_read_b64_tr_b16 v[78:79], v13 offset:58368
    v_add_u32 v13, 4294901760, v13
    s_waitcnt lgkmcnt(8)
    v_mfma_f32_16x16x32_bf16 v[216:219], v[88:91], v[40:43], v[216:219]
    ds_read_b64_tr_b16 v[80:81], v14 offset:57344
    v_mfma_f32_16x16x32_bf16 v[248:251], v[88:91], v[44:47], v[248:251]
    ds_read_b64_tr_b16 v[82:83], v14 offset:58368
    v_add_u32 v14, 4294901760, v14
    buffer_load_dwordx4 v3, s[4:7], s31 offen offset:1024 lds
    v_mfma_f32_16x16x32_bf16 v[220:223], v[92:95], v[40:43], v[220:223]
    ds_read_b64_tr_b16 v[84:85], v15 offset:57344
    v_mfma_f32_16x16x32_bf16 v[252:255], v[92:95], v[44:47], v[252:255]
    ds_read_b64_tr_b16 v[86:87], v15 offset:58368
    v_add_u32 v15, 4294901760, v15
    s_waitcnt lgkmcnt(8)
    s_waitcnt vmcnt(11)
    v_mfma_f32_16x16x32_bf16 v[192:195], v[64:67], v[48:51], v[192:195]
    ds_read_b64_tr_b16 v[88:89], v16 offset:57344
    v_mfma_f32_16x16x32_bf16 v[224:227], v[64:67], v[52:55], v[224:227]
    ds_read_b64_tr_b16 v[90:91], v16 offset:58368
    v_add_u32 v16, 4294901760, v16
    buffer_load_dwordx4 v4, s[4:7], s31 offen offset:2048 lds
    v_mfma_f32_16x16x32_bf16 v[196:199], v[68:71], v[48:51], v[196:199]
    ds_read_b64_tr_b16 v[92:93], v17 offset:57344
    v_mfma_f32_16x16x32_bf16 v[228:231], v[68:71], v[52:55], v[228:231]
    ds_read_b64_tr_b16 v[94:95], v17 offset:58368
    v_add_u32 v17, 4294901760, v17
    s_waitcnt vmcnt(11)
    s_cmp_eq_u32 s30, 0
    s_cbranch_scc1 L_recurrent_scan__compressed_kv_cla__moe_arch_mod__prompt_kernel_rare_46
L_recurrent_scan__compressed_kv_cla__moe_arch_mod__prompt_kernel_back_47:
    s_barrier
    s_waitcnt lgkmcnt(8)
    v_mfma_f32_16x16x32_bf16 v[200:203], v[72:75], v[48:51], v[200:203]
    ds_read_b64_tr_b16 v[64:65], v10 offset:0
    buffer_load_dwordx4 v[120:123], v6, s[8:11], s32 offen offset:3072 sc1
    v_mfma_f32_16x16x32_bf16 v[232:235], v[72:75], v[52:55], v[232:235]
    ds_read_b64_tr_b16 v[66:67], v10 offset:1024
    s_lshl_b32 s36, s30, 3
    s_add_u32 s36, s28, s36
    s_cmp_eq_u32 s36, 4
    s_cbranch_scc1 L_recurrent_scan__compressed_kv_cla__moe_arch_mod__prompt_kernel_rare_50
L_recurrent_scan__compressed_kv_cla__moe_arch_mod__prompt_kernel_back_51:
    v_mfma_f32_16x16x32_bf16 v[204:207], v[76:79], v[48:51], v[204:207]
    ds_read_b64_tr_b16 v[68:69], v11 offset:0
    v_mfma_f32_16x16x32_bf16 v[236:239], v[76:79], v[52:55], v[236:239]
    ds_read_b64_tr_b16 v[70:71], v11 offset:1024
    s_waitcnt lgkmcnt(8)
    v_mfma_f32_16x16x32_bf16 v[208:211], v[80:83], v[48:51], v[208:211]
    ds_read_b64_tr_b16 v[72:73], v12 offset:0
    buffer_load_dwordx4 v[124:127], v7, s[8:11], s32 offen offset:3072 sc1
    v_mfma_f32_16x16x32_bf16 v[240:243], v[80:83], v[52:55], v[240:243]
    ds_read_b64_tr_b16 v[74:75], v12 offset:1024
    v_mfma_f32_16x16x32_bf16 v[212:215], v[84:87], v[48:51], v[212:215]
    ds_read_b64_tr_b16 v[76:77], v13 offset:0
    v_mfma_f32_16x16x32_bf16 v[244:247], v[84:87], v[52:55], v[244:247]
    ds_read_b64_tr_b16 v[78:79], v13 offset:1024
    s_waitcnt lgkmcnt(8)
    v_mfma_f32_16x16x32_bf16 v[216:219], v[88:91], v[48:51], v[216:219]
    ds_read_b64_tr_b16 v[80:81], v14 offset:0
    v_mfma_f32_16x16x32_bf16 v[248:251], v[88:91], v[52:55], v[248:251]
    ds_read_b64_tr_b16 v[82:83], v14 offset:1024
    buffer_load_dwordx4 v5, s[4:7], s31 offen offset:3072 lds
    v_mfma_f32_16x16x32_bf16 v[220:223], v[92:95], v[48:51], v[220:223]
    ds_read_b64_tr_b16 v[84:85], v15 offset:0
    v_mfma_f32_16x16x32_bf16 v[252:255], v[92:95], v[52:55], v[252:255]
    ds_read_b64_tr_b16 v[86:87], v15 offset:1024
    s_waitcnt lgkmcnt(8)
    s_waitcnt vmcnt(12)
    v_mfma_f32_16x16x32_bf16 v[192:195], v[64:67], v[96:99], v[192:195]
    ds_read_b64_tr_b16 v[88:89], v16 offset:0
    buffer_store_dwordx4 v[168:171], v60, s[16:19], s48 offen sc1
    v_mfma_f32_16x16x32_bf16 v[224:227], v[64:67], v[100:103], v[224:227]
    ds_read_b64_tr_b16 v[90:91], v16 offset:1024
    v_mfma_f32_16x16x32_bf16 v[196:199], v[68:71], v[96:99], v[196:199]
    ds_read_b64_tr_b16 v[92:93], v17 offset:0
    v_mfma_f32_16x16x32_bf16 v[228:231], v[68:71], v[100:103], v[228:231]
    ds_read_b64_tr_b16 v[94:95], v17 offset:1024
    s_waitcnt lgkmcnt(8)
    v_mfma_f32_16x16x32_bf16 v[200:203], v[72:75], v[96:99], v[200:203]
    ds_read_b64_tr_b16 v[64:65], v10 offset:8192
    v_mfma_f32_16x16x32_bf16 v[232:235], v[72:75], v[100:103], v[232:235]
    ds_read_b64_tr_b16 v[66:67], v10 offset:9216
    v_mfma_f32_16x16x32_bf16 v[204:207], v[76:79], v[96:99], v[204:207]
    ds_read_b64_tr_b16 v[68:69], v11 offset:8192
    v_mfma_f32_16x16x32_bf16 v[236:239], v[76:79], v[100:103], v[236:239]
    ds_read_b64_tr_b16 v[70:71], v11 offset:9216
    s_waitcnt lgkmcnt(8)
    v_mfma_f32_16x16x32_bf16 v[208:211], v[80:83], v[96:99], v[208:211]
    ds_read_b64_tr_b16 v[72:73], v12 offset:8192
    v_mfma_f32_16x16x32_bf16 v[240:243], v[80:83], v[100:103], v[240:243]
    ds_read_b64_tr_b16 v[74:75], v12 offset:9216
    v_mfma_f32_16x16x32_bf16 v[212:215], v[84:87], v[96:99], v[212:215]
    ds_read_b64_tr_b16 v[76:77], v13 offset:8192
    v_mfma_f32_16x16x32_bf16 v[244:247], v[84:87], v[100:103], v[244:247]
    ds_read_b64_tr_b16 v[78:79], v13 offset:9216
    s_mov_b32 s32, 24576
    buffer_load_dwordx4 v[24:27], v6, s[8:11], s32 offen offset:0 sc1
    s_waitcnt lgkmcnt(8)
    v_mfma_f32_16x16x32_bf16 v[216:219], v[88:91], v[96:99], v[216:219]
    ds_read_b64_tr_b16 v[80:81], v14 offset:8192
    v_mfma_f32_16x16x32_bf16 v[248:251], v[88:91], v[100:103], v[248:251]
    ds_read_b64_tr_b16 v[82:83], v14 offset:9216
    v_mfma_f32_16x16x32_bf16 v[220:223], v[92:95], v[96:99], v[220:223]
    ds_read_b64_tr_b16 v[84:85], v15 offset:8192
    v_mfma_f32_16x16x32_bf16 v[252:255], v[92:95], v[100:103], v[252:255]
    ds_read_b64_tr_b16 v[86:87], v15 offset:9216
    buffer_load_dwordx4 v[28:31], v7, s[8:11], s32 offen offset:0 sc1
    s_waitcnt lgkmcnt(8)
    s_waitcnt vmcnt(12)
    v_mfma_f32_16x16x32_bf16 v[192:195], v[64:67], v[104:107], v[192:195]
    ds_read_b64_tr_b16 v[88:89], v16 offset:8192
    v_mfma_f32_16x16x32_bf16 v[224:227], v[64:67], v[108:111], v[224:227]
    ds_read_b64_tr_b16 v[90:91], v16 offset:9216
    v_mfma_f32_16x16x32_bf16 v[196:199], v[68:71], v[104:107], v[196:199]
    ds_read_b64_tr_b16 v[92:93], v17 offset:8192
    v_mfma_f32_16x16x32_bf16 v[228:231], v[68:71], v[108:111], v[228:231]
    ds_read_b64_tr_b16 v[94:95], v17 offset:9216
    buffer_load_dwordx4 v[32:35], v6, s[8:11], s32 offen offset:1024 sc1
    s_waitcnt lgkmcnt(8)
    v_mfma_f32_16x16x32_bf16 v[200:203], v[72:75], v[104:107], v[200:203]
    ds_read_b64_tr_b16 v[64:65], v10 offset:16384
    v_mfma_f32_16x16x32_bf16 v[232:235], v[72:75], v[108:111], v[232:235]
    ds_read_b64_tr_b16 v[66:67], v10 offset:17408
    v_mfma_f32_16x16x32_bf16 v[204:207], v[76:79], v[104:107], v[204:207]
    ds_read_b64_tr_b16 v[68:69], v11 offset:16384
    v_mfma_f32_16x16x32_bf16 v[236:239], v[76:79], v[108:111], v[236:239]
    ds_read_b64_tr_b16 v[70:71], v11 offset:17408
    s_waitcnt lgkmcnt(8)
    v_mfma_f32_16x16x32_bf16 v[208:211], v[80:83], v[104:107], v[208:211]
    ds_read_b64_tr_b16 v[72:73], v12 offset:16384
    buffer_load_dwordx4 v[36:39], v7, s[8:11], s32 offen offset:1024 sc1
    v_mfma_f32_16x16x32_bf16 v[240:243], v[80:83], v[108:111], v[240:243]
    ds_read_b64_tr_b16 v[74:75], v12 offset:17408
    v_mfma_f32_16x16x32_bf16 v[212:215], v[84:87], v[104:107], v[212:215]
    ds_read_b64_tr_b16 v[76:77], v13 offset:16384
    v_mfma_f32_16x16x32_bf16 v[244:247], v[84:87], v[108:111], v[244:247]
    ds_read_b64_tr_b16 v[78:79], v13 offset:17408
    s_waitcnt lgkmcnt(8)
    v_mfma_f32_16x16x32_bf16 v[216:219], v[88:91], v[104:107], v[216:219]
    ds_read_b64_tr_b16 v[80:81], v14 offset:16384
    buffer_store_dwordx4 v[172:175], v61, s[16:19], s48 offen sc1
    v_mfma_f32_16x16x32_bf16 v[248:251], v[88:91], v[108:111], v[248:251]
    ds_read_b64_tr_b16 v[82:83], v14 offset:17408
    v_mfma_f32_16x16x32_bf16 v[220:223], v[92:95], v[104:107], v[220:223]
    ds_read_b64_tr_b16 v[84:85], v15 offset:16384
    v_mfma_f32_16x16x32_bf16 v[252:255], v[92:95], v[108:111], v[252:255]
    ds_read_b64_tr_b16 v[86:87], v15 offset:17408
    s_waitcnt lgkmcnt(8)
    s_waitcnt vmcnt(11)
    v_mfma_f32_16x16x32_bf16 v[192:195], v[64:67], v[112:115], v[192:195]
    ds_read_b64_tr_b16 v[88:89], v16 offset:16384
    v_mfma_f32_16x16x32_bf16 v[224:227], v[64:67], v[116:119], v[224:227]
    ds_read_b64_tr_b16 v[90:91], v16 offset:17408
    v_mfma_f32_16x16x32_bf16 v[196:199], v[68:71], v[112:115], v[196:199]
    ds_read_b64_tr_b16 v[92:93], v17 offset:16384
    v_mfma_f32_16x16x32_bf16 v[228:231], v[68:71], v[116:119], v[228:231]
    ds_read_b64_tr_b16 v[94:95], v17 offset:17408
    s_waitcnt lgkmcnt(8)
    v_mfma_f32_16x16x32_bf16 v[200:203], v[72:75], v[112:115], v[200:203]
    ds_read_b64_tr_b16 v[64:65], v10 offset:24576
    v_mfma_f32_16x16x32_bf16 v[232:235], v[72:75], v[116:119], v[232:235]
    ds_read_b64_tr_b16 v[66:67], v10 offset:25600
    v_add_u32 v10, 98304, v10
    v_mfma_f32_16x16x32_bf16 v[204:207], v[76:79], v[112:115], v[204:207]
    ds_read_b64_tr_b16 v[68:69], v11 offset:24576
    v_mfma_f32_16x16x32_bf16 v[236:239], v[76:79], v[116:119], v[236:239]
    ds_read_b64_tr_b16 v[70:71], v11 offset:25600
    v_add_u32 v11, 98304, v11
    s_add_u32 m0, s33, 32768
    s_mov_b32 s31, 7340032
    buffer_load_dwordx4 v2, s[4:7], s31 offen offset:0 lds
    s_waitcnt lgkmcnt(8)
    v_mfma_f32_16x16x32_bf16 v[208:211], v[80:83], v[112:115], v[208:211]
    ds_read_b64_tr_b16 v[72:73], v12 offset:24576
    v_mfma_f32_16x16x32_bf16 v[240:243], v[80:83], v[116:119], v[240:243]
    ds_read_b64_tr_b16 v[74:75], v12 offset:25600
    v_add_u32 v12, 98304, v12
    v_mfma_f32_16x16x32_bf16 v[212:215], v[84:87], v[112:115], v[212:215]
    ds_read_b64_tr_b16 v[76:77], v13 offset:24576
    buffer_load_dwordx4 v[40:43], v6, s[8:11], s32 offen offset:2048 sc1
    v_mfma_f32_16x16x32_bf16 v[244:247], v[84:87], v[116:119], v[244:247]
    ds_read_b64_tr_b16 v[78:79], v13 offset:25600
    v_add_u32 v13, 98304, v13
    s_waitcnt lgkmcnt(8)
    v_mfma_f32_16x16x32_bf16 v[216:219], v[88:91], v[112:115], v[216:219]
    ds_read_b64_tr_b16 v[80:81], v14 offset:24576
    v_mfma_f32_16x16x32_bf16 v[248:251], v[88:91], v[116:119], v[248:251]
    ds_read_b64_tr_b16 v[82:83], v14 offset:25600
    v_add_u32 v14, 98304, v14
    v_mfma_f32_16x16x32_bf16 v[220:223], v[92:95], v[112:115], v[220:223]
    ds_read_b64_tr_b16 v[84:85], v15 offset:24576
    buffer_load_dwordx4 v[44:47], v7, s[8:11], s32 offen offset:2048 sc1
    v_mfma_f32_16x16x32_bf16 v[252:255], v[92:95], v[116:119], v[252:255]
    ds_read_b64_tr_b16 v[86:87], v15 offset:25600
    v_add_u32 v15, 98304, v15
    s_waitcnt lgkmcnt(8)
    s_waitcnt vmcnt(10)
    v_mfma_f32_16x16x32_bf16 v[192:195], v[64:67], v[120:123], v[192:195]
    ds_read_b64_tr_b16 v[88:89], v16 offset:24576
    v_mfma_f32_16x16x32_bf16 v[224:227], v[64:67], v[124:127], v[224:227]
    ds_read_b64_tr_b16 v[90:91], v16 offset:25600
    v_add_u32 v16, 98304, v16
    v_mfma_f32_16x16x32_bf16 v[196:199], v[68:71], v[120:123], v[196:199]
    ds_read_b64_tr_b16 v[92:93], v17 offset:24576
    v_mfma_f32_16x16x32_bf16 v[228:231], v[68:71], v[124:127], v[228:231]
    ds_read_b64_tr_b16 v[94:95], v17 offset:25600
    v_add_u32 v17, 98304, v17
    buffer_load_dwordx4 v3, s[4:7], s31 offen offset:1024 lds
    s_waitcnt vmcnt(10)
    s_barrier
    s_waitcnt lgkmcnt(8)
    v_mfma_f32_16x16x32_bf16 v[200:203], v[72:75], v[120:123], v[200:203]
    ds_read_b64_tr_b16 v[64:65], v10 offset:32768
    v_mfma_f32_16x16x32_bf16 v[232:235], v[72:75], v[124:127], v[232:235]
    ds_read_b64_tr_b16 v[66:67], v10 offset:33792
    v_mfma_f32_16x16x32_bf16 v[204:207], v[76:79], v[120:123], v[204:207]
    ds_read_b64_tr_b16 v[68:69], v11 offset:32768
    buffer_load_dwordx4 v4, s[4:7], s31 offen offset:2048 lds
    v_mfma_f32_16x16x32_bf16 v[236:239], v[76:79], v[124:127], v[236:239]
    ds_read_b64_tr_b16 v[70:71], v11 offset:33792
    s_waitcnt lgkmcnt(8)
    v_mfma_f32_16x16x32_bf16 v[208:211], v[80:83], v[120:123], v[208:211]
    ds_read_b64_tr_b16 v[72:73], v12 offset:32768
    v_mfma_f32_16x16x32_bf16 v[240:243], v[80:83], v[124:127], v[240:243]
    ds_read_b64_tr_b16 v[74:75], v12 offset:33792
    v_mfma_f32_16x16x32_bf16 v[212:215], v[84:87], v[120:123], v[212:215]
    ds_read_b64_tr_b16 v[76:77], v13 offset:32768
    buffer_load_dwordx4 v[48:51], v6, s[8:11], s32 offen offset:3072 sc1
    v_mfma_f32_16x16x32_bf16 v[244:247], v[84:87], v[124:127], v[244:247]
    ds_read_b64_tr_b16 v[78:79], v13 offset:33792
    s_waitcnt lgkmcnt(8)
    v_mfma_f32_16x16x32_bf16 v[216:219], v[88:91], v[120:123], v[216:219]
    ds_read_b64_tr_b16 v[80:81], v14 offset:32768
    v_mfma_f32_16x16x32_bf16 v[248:251], v[88:91], v[124:127], v[248:251]
    ds_read_b64_tr_b16 v[82:83], v14 offset:33792
    v_mfma_f32_16x16x32_bf16 v[220:223], v[92:95], v[120:123], v[220:223]
    ds_read_b64_tr_b16 v[84:85], v15 offset:32768
    buffer_load_dwordx4 v[52:55], v7, s[8:11], s32 offen offset:3072 sc1
    v_mfma_f32_16x16x32_bf16 v[252:255], v[92:95], v[124:127], v[252:255]
    ds_read_b64_tr_b16 v[86:87], v15 offset:33792
    s_waitcnt lgkmcnt(8)
    s_waitcnt vmcnt(10)
    v_mfma_f32_16x16x32_bf16 v[192:195], v[64:67], v[24:27], v[192:195]
    ds_read_b64_tr_b16 v[88:89], v16 offset:32768
    v_mfma_f32_16x16x32_bf16 v[224:227], v[64:67], v[28:31], v[224:227]
    ds_read_b64_tr_b16 v[90:91], v16 offset:33792
    v_mfma_f32_16x16x32_bf16 v[196:199], v[68:71], v[24:27], v[196:199]
    ds_read_b64_tr_b16 v[92:93], v17 offset:32768
    buffer_load_dwordx4 v5, s[4:7], s31 offen offset:3072 lds
    v_mfma_f32_16x16x32_bf16 v[228:231], v[68:71], v[28:31], v[228:231]
    ds_read_b64_tr_b16 v[94:95], v17 offset:33792
    s_waitcnt lgkmcnt(8)
    v_mfma_f32_16x16x32_bf16 v[200:203], v[72:75], v[24:27], v[200:203]
    ds_read_b64_tr_b16 v[64:65], v10 offset:40960
    v_mfma_f32_16x16x32_bf16 v[232:235], v[72:75], v[28:31], v[232:235]
    ds_read_b64_tr_b16 v[66:67], v10 offset:41984
    v_mfma_f32_16x16x32_bf16 v[204:207], v[76:79], v[24:27], v[204:207]
    ds_read_b64_tr_b16 v[68:69], v11 offset:40960
    buffer_store_dwordx4 v[176:179], v58, s[16:19], s49 offen sc1
    v_mfma_f32_16x16x32_bf16 v[236:239], v[76:79], v[28:31], v[236:239]
    ds_read_b64_tr_b16 v[70:71], v11 offset:41984
    s_waitcnt lgkmcnt(8)
    v_mfma_f32_16x16x32_bf16 v[208:211], v[80:83], v[24:27], v[208:211]
    ds_read_b64_tr_b16 v[72:73], v12 offset:40960
    s_cmp_eq_u32 s28, 0
    s_cbranch_scc1 L_recurrent_scan__compressed_kv_cla__moe_arch_mod__prompt_kernel_rare_52
L_recurrent_scan__compressed_kv_cla__moe_arch_mod__prompt_kernel_back_53:
    v_mfma_f32_16x16x32_bf16 v[240:243], v[80:83], v[28:31], v[240:243]
    ds_read_b64_tr_b16 v[74:75], v12 offset:41984
    v_mfma_f32_16x16x32_bf16 v[212:215], v[84:87], v[24:27], v[212:215]
    ds_read_b64_tr_b16 v[76:77], v13 offset:40960
    v_mfma_f32_16x16x32_bf16 v[244:247], v[84:87], v[28:31], v[244:247]
    ds_read_b64_tr_b16 v[78:79], v13 offset:41984
    s_waitcnt lgkmcnt(8)
    v_mfma_f32_16x16x32_bf16 v[216:219], v[88:91], v[24:27], v[216:219]
    ds_read_b64_tr_b16 v[80:81], v14 offset:40960
    v_mfma_f32_16x16x32_bf16 v[248:251], v[88:91], v[28:31], v[248:251]
    ds_read_b64_tr_b16 v[82:83], v14 offset:41984
    v_mfma_f32_16x16x32_bf16 v[220:223], v[92:95], v[24:27], v[220:223]
    ds_read_b64_tr_b16 v[84:85], v15 offset:40960
    v_mfma_f32_16x16x32_bf16 v[252:255], v[92:95], v[28:31], v[252:255]
    ds_read_b64_tr_b16 v[86:87], v15 offset:41984
    s_waitcnt lgkmcnt(8)
    s_waitcnt vmcnt(10)
    v_mfma_f32_16x16x32_bf16 v[192:195], v[64:67], v[32:35], v[192:195]
    ds_read_b64_tr_b16 v[88:89], v16 offset:40960
    v_mfma_f32_16x16x32_bf16 v[224:227], v[64:67], v[36:39], v[224:227]
    ds_read_b64_tr_b16 v[90:91], v16 offset:41984
    s_mov_b32 s32, 28672
    buffer_load_dwordx4 v[96:99], v6, s[8:11], s32 offen offset:0 sc1
    v_mfma_f32_16x16x32_bf16 v[196:199], v[68:71], v[32:35], v[196:199]
    ds_read_b64_tr_b16 v[92:93], v17 offset:40960
    v_mfma_f32_16x16x32_bf16 v[228:231], v[68:71], v[36:39], v[228:231]
    ds_read_b64_tr_b16 v[94:95], v17 offset:41984
    s_waitcnt lgkmcnt(8)
    v_mfma_f32_16x16x32_bf16 v[200:203], v[72:75], v[32:35], v[200:203]
    ds_read_b64_tr_b16 v[64:65], v10 offset:49152
    v_mfma_f32_16x16x32_bf16 v[232:235], v[72:75], v[36:39], v[232:235]
    ds_read_b64_tr_b16 v[66:67], v10 offset:50176
    buffer_load_dwordx4 v[100:103], v7, s[8:11], s32 offen offset:0 sc1
    v_mfma_f32_16x16x32_bf16 v[204:207], v[76:79], v[32:35], v[204:207]
    ds_read_b64_tr_b16 v[68:69], v11 offset:49152
    v_mfma_f32_16x16x32_bf16 v[236:239], v[76:79], v[36:39], v[236:239]
    ds_read_b64_tr_b16 v[70:71], v11 offset:50176
    s_waitcnt lgkmcnt(8)
    v_mfma_f32_16x16x32_bf16 v[208:211], v[80:83], v[32:35], v[208:211]
    ds_read_b64_tr_b16 v[72:73], v12 offset:49152
    v_mfma_f32_16x16x32_bf16 v[240:243], v[80:83], v[36:39], v[240:243]
    ds_read_b64_tr_b16 v[74:75], v12 offset:50176
    buffer_load_dwordx4 v[104:107], v6, s[8:11], s32 offen offset:1024 sc1
    v_mfma_f32_16x16x32_bf16 v[212:215], v[84:87], v[32:35], v[212:215]
    ds_read_b64_tr_b16 v[76:77], v13 offset:49152
    v_mfma_f32_16x16x32_bf16 v[244:247], v[84:87], v[36:39], v[244:247]
    ds_read_b64_tr_b16 v[78:79], v13 offset:50176
    s_waitcnt lgkmcnt(8)
    v_mfma_f32_16x16x32_bf16 v[216:219], v[88:91], v[32:35], v[216:219]
    ds_read_b64_tr_b16 v[80:81], v14 offset:49152
    v_mfma_f32_16x16x32_bf16 v[248:251], v[88:91], v[36:39], v[248:251]
    ds_read_b64_tr_b16 v[82:83], v14 offset:50176
    buffer_load_dwordx4 v[108:111], v7, s[8:11], s32 offen offset:1024 sc1
    v_mfma_f32_16x16x32_bf16 v[220:223], v[92:95], v[32:35], v[220:223]
    ds_read_b64_tr_b16 v[84:85], v15 offset:49152
    v_mfma_f32_16x16x32_bf16 v[252:255], v[92:95], v[36:39], v[252:255]
    ds_read_b64_tr_b16 v[86:87], v15 offset:50176
    s_waitcnt lgkmcnt(8)
    s_waitcnt vmcnt(10)
    v_mfma_f32_16x16x32_bf16 v[192:195], v[64:67], v[40:43], v[192:195]
    ds_read_b64_tr_b16 v[88:89], v16 offset:49152
    v_mfma_f32_16x16x32_bf16 v[224:227], v[64:67], v[44:47], v[224:227]
    ds_read_b64_tr_b16 v[90:91], v16 offset:50176
    buffer_store_dwordx4 v[180:183], v59, s[16:19], s49 offen sc1
    v_mfma_f32_16x16x32_bf16 v[196:199], v[68:71], v[40:43], v[196:199]
    ds_read_b64_tr_b16 v[92:93], v17 offset:49152
    v_mfma_f32_16x16x32_bf16 v[228:231], v[68:71], v[44:47], v[228:231]
    ds_read_b64_tr_b16 v[94:95], v17 offset:50176
    s_waitcnt lgkmcnt(8)
    v_mfma_f32_16x16x32_bf16 v[200:203], v[72:75], v[40:43], v[200:203]
    ds_read_b64_tr_b16 v[64:65], v10 offset:57344
    v_mfma_f32_16x16x32_bf16 v[232:235], v[72:75], v[44:47], v[232:235]
    ds_read_b64_tr_b16 v[66:67], v10 offset:58368
    v_add_u32 v10, 4294868992, v10
    v_mfma_f32_16x16x32_bf16 v[204:207], v[76:79], v[40:43], v[204:207]
    ds_read_b64_tr_b16 v[68:69], v11 offset:57344
    v_mfma_f32_16x16x32_bf16 v[236:239], v[76:79], v[44:47], v[236:239]
    ds_read_b64_tr_b16 v[70:71], v11 offset:58368
    v_add_u32 v11, 4294868992, v11
    s_waitcnt lgkmcnt(8)
    v_mfma_f32_16x16x32_bf16 v[208:211], v[80:83], v[40:43], v[208:211]
    ds_read_b64_tr_b16 v[72:73], v12 offset:57344
    v_mfma_f32_16x16x32_bf16 v[240:243], v[80:83], v[44:47], v[240:243]
    ds_read_b64_tr_b16 v[74:75], v12 offset:58368
    v_add_u32 v12, 4294868992, v12
    v_mfma_f32_16x16x32_bf16 v[212:215], v[84:87], v[40:43], v[212:215]
    ds_read_b64_tr_b16 v[76:77], v13 offset:57344
    v_mfma_f32_16x16x32_bf16 v[244:247], v[84:87], v[44:47], v[244:247]
    ds_read_b64_tr_b16 v[78:79], v13 offset:58368
    v_add_u32 v13, 4294868992, v13
    s_waitcnt lgkmcnt(8)
    v_mfma_f32_16x16x32_bf16 v[216:219], v[88:91], v[40:43], v[216:219]
    ds_read_b64_tr_b16 v[80:81], v14 offset:57344
    buffer_load_dwordx4 v[112:115], v6, s[8:11], s32 offen offset:2048 sc1
    v_mfma_f32_16x16x32_bf16 v[248:251], v[88:91], v[44:47], v[248:251]
    ds_read_b64_tr_b16 v[82:83], v14 offset:58368
    v_add_u32 v14, 4294868992, v14
    v_mfma_f32_16x16x32_bf16 v[220:223], v[92:95], v[40:43], v[220:223]
    ds_read_b64_tr_b16 v[84:85], v15 offset:57344
    v_mfma_f32_16x16x32_bf16 v[252:255], v[92:95], v[44:47], v[252:255]
    ds_read_b64_tr_b16 v[86:87], v15 offset:58368
    v_add_u32 v15, 4294868992, v15
    s_waitcnt lgkmcnt(8)
    s_waitcnt vmcnt(8)
    v_mfma_f32_16x16x32_bf16 v[192:195], v[64:67], v[48:51], v[192:195]
    ds_read_b64_tr_b16 v[88:89], v16 offset:57344
    v_mfma_f32_16x16x32_bf16 v[224:227], v[64:67], v[52:55], v[224:227]
    ds_read_b64_tr_b16 v[90:91], v16 offset:58368
    v_add_u32 v16, 4294868992, v16
    buffer_load_dwordx4 v[116:119], v7, s[8:11], s32 offen offset:2048 sc1
    v_mfma_f32_16x16x32_bf16 v[196:199], v[68:71], v[48:51], v[196:199]
    ds_read_b64_tr_b16 v[92:93], v17 offset:57344
    v_mfma_f32_16x16x32_bf16 v[228:231], v[68:71], v[52:55], v[228:231]
    ds_read_b64_tr_b16 v[94:95], v17 offset:58368
    v_add_u32 v17, 4294868992, v17
    s_waitcnt vmcnt(8)
    s_cmp_eq_u32 s28, 0
    s_cbranch_scc1 L_recurrent_scan__compressed_kv_cla__moe_arch_mod__prompt_kernel_rare_48
L_recurrent_scan__compressed_kv_cla__moe_arch_mod__prompt_kernel_back_49:
    s_waitcnt lgkmcnt(0)
    s_barrier
    v_mfma_f32_16x16x32_bf16 v[200:203], v[72:75], v[48:51], v[200:203]
    ds_read_b64_tr_b16 v[64:65], v10 offset:32768
    v_mfma_f32_16x16x32_bf16 v[232:235], v[72:75], v[52:55], v[232:235]
    ds_read_b64_tr_b16 v[66:67], v10 offset:33792
    s_add_u32 m0, s33, 0
    s_add_u32 s31, s45, 0
    buffer_load_dwordx4 v8, s[12:15], s31 offen offset:0 sc1 lds
    v_mfma_f32_16x16x32_bf16 v[204:207], v[76:79], v[48:51], v[204:207]
    ds_read_b64_tr_b16 v[68:69], v11 offset:32768
    v_mfma_f32_16x16x32_bf16 v[236:239], v[76:79], v[52:55], v[236:239]
    ds_read_b64_tr_b16 v[70:71], v11 offset:33792
    v_mfma_f32_16x16x32_bf16 v[208:211], v[80:83], v[48:51], v[208:211]
    ds_read_b64_tr_b16 v[72:73], v12 offset:32768
    v_mfma_f32_16x16x32_bf16 v[240:243], v[80:83], v[52:55], v[240:243]
    ds_read_b64_tr_b16 v[74:75], v12 offset:33792
    buffer_load_dwordx4 v[120:123], v6, s[8:11], s32 offen offset:3072 sc1
    v_mfma_f32_16x16x32_bf16 v[212:215], v[84:87], v[48:51], v[212:215]
    ds_read_b64_tr_b16 v[76:77], v13 offset:32768
    v_mfma_f32_16x16x32_bf16 v[244:247], v[84:87], v[52:55], v[244:247]
    ds_read_b64_tr_b16 v[78:79], v13 offset:33792
    v_mfma_f32_16x16x32_bf16 v[216:219], v[88:91], v[48:51], v[216:219]
    ds_read_b64_tr_b16 v[80:81], v14 offset:32768
    v_mfma_f32_16x16x32_bf16 v[248:251], v[88:91], v[52:55], v[248:251]
    ds_read_b64_tr_b16 v[82:83], v14 offset:33792
    buffer_load_dwordx4 v[124:127], v7, s[8:11], s32 offen offset:3072 sc1
    v_mfma_f32_16x16x32_bf16 v[220:223], v[92:95], v[48:51], v[220:223]
    ds_read_b64_tr_b16 v[84:85], v15 offset:32768
    v_mfma_f32_16x16x32_bf16 v[252:255], v[92:95], v[52:55], v[252:255]
    ds_read_b64_tr_b16 v[86:87], v15 offset:33792
    s_waitcnt lgkmcnt(8)
    s_waitcnt vmcnt(8)
    v_mfma_f32_16x16x32_bf16 v[192:195], v[64:67], v[96:99], v[192:195]
    ds_read_b64_tr_b16 v[88:89], v16 offset:32768
    v_mfma_f32_16x16x32_bf16 v[224:227], v[64:67], v[100:103], v[224:227]
    ds_read_b64_tr_b16 v[90:91], v16 offset:33792
    buffer_store_dwordx4 v[184:187], v60, s[16:19], s49 offen sc1
    v_mfma_f32_16x16x32_bf16 v[196:199], v[68:71], v[96:99], v[196:199]
    ds_read_b64_tr_b16 v[92:93], v17 offset:32768
    v_mfma_f32_16x16x32_bf16 v[228:231], v[68:71], v[100:103], v[228:231]
    ds_read_b64_tr_b16 v[94:95], v17 offset:33792
    s_waitcnt lgkmcnt(8)
    v_mfma_f32_16x16x32_bf16 v[200:203], v[72:75], v[96:99], v[200:203]
    ds_read_b64_tr_b16 v[64:65], v10 offset:40960
    v_mfma_f32_16x16x32_bf16 v[232:235], v[72:75], v[100:103], v[232:235]
    ds_read_b64_tr_b16 v[66:67], v10 offset:41984
    v_mfma_f32_16x16x32_bf16 v[204:207], v[76:79], v[96:99], v[204:207]
    ds_read_b64_tr_b16 v[68:69], v11 offset:40960
    v_mfma_f32_16x16x32_bf16 v[236:239], v[76:79], v[100:103], v[236:239]
    ds_read_b64_tr_b16 v[70:71], v11 offset:41984
    s_waitcnt lgkmcnt(8)
    v_mfma_f32_16x16x32_bf16 v[208:211], v[80:83], v[96:99], v[208:211]
    ds_read_b64_tr_b16 v[72:73], v12 offset:40960
    v_mfma_f32_16x16x32_bf16 v[240:243], v[80:83], v[100:103], v[240:243]
    ds_read_b64_tr_b16 v[74:75], v12 offset:41984
    v_mfma_f32_16x16x32_bf16 v[212:215], v[84:87], v[96:99], v[212:215]
    ds_read_b64_tr_b16 v[76:77], v13 offset:40960
    v_mfma_f32_16x16x32_bf16 v[244:247], v[84:87], v[100:103], v[244:247]
    ds_read_b64_tr_b16 v[78:79], v13 offset:41984
    s_waitcnt lgkmcnt(8)
    v_mfma_f32_16x16x32_bf16 v[216:219], v[88:91], v[96:99], v[216:219]
    ds_read_b64_tr_b16 v[80:81], v14 offset:40960
    buffer_load_dwordx4 v8, s[12:15], s31 offen offset:1024 sc1 lds
    v_mfma_f32_16x16x32_bf16 v[248:251], v[88:91], v[100:103], v[248:251]
    ds_read_b64_tr_b16 v[82:83], v14 offset:41984
    v_mfma_f32_16x16x32_bf16 v[220:223], v[92:95], v[96:99], v[220:223]
    ds_read_b64_tr_b16 v[84:85], v15 offset:40960
    v_mfma_f32_16x16x32_bf16 v[252:255], v[92:95], v[100:103], v[252:255]
    ds_read_b64_tr_b16 v[86:87], v15 offset:41984
    s_waitcnt lgkmcnt(8)
    s_waitcnt vmcnt(8)
    v_mfma_f32_16x16x32_bf16 v[192:195], v[64:67], v[104:107], v[192:195]
    ds_read_b64_tr_b16 v[88:89], v16 offset:40960
    buffer_load_dwordx4 v8, s[12:15], s31 offen offset:2048 sc1 lds
    v_mfma_f32_16x16x32_bf16 v[224:227], v[64:67], v[108:111], v[224:227]
    ds_read_b64_tr_b16 v[90:91], v16 offset:41984
    v_mfma_f32_16x16x32_bf16 v[196:199], v[68:71], v[104:107], v[196:199]
    ds_read_b64_tr_b16 v[92:93], v17 offset:40960
    v_mfma_f32_16x16x32_bf16 v[228:231], v[68:71], v[108:111], v[228:231]
    ds_read_b64_tr_b16 v[94:95], v17 offset:41984
    s_waitcnt lgkmcnt(8)
    v_mfma_f32_16x16x32_bf16 v[200:203], v[72:75], v[104:107], v[200:203]
    ds_read_b64_tr_b16 v[64:65], v10 offset:49152
    v_mfma_f32_16x16x32_bf16 v[232:235], v[72:75], v[108:111], v[232:235]
    ds_read_b64_tr_b16 v[66:67], v10 offset:50176
    buffer_load_dwordx4 v8, s[12:15], s31 offen offset:3072 sc1 lds
    v_mfma_f32_16x16x32_bf16 v[204:207], v[76:79], v[104:107], v[204:207]
    ds_read_b64_tr_b16 v[68:69], v11 offset:49152
    v_mfma_f32_16x16x32_bf16 v[236:239], v[76:79], v[108:111], v[236:239]
    ds_read_b64_tr_b16 v[70:71], v11 offset:50176
    s_waitcnt lgkmcnt(8)
    v_mfma_f32_16x16x32_bf16 v[208:211], v[80:83], v[104:107], v[208:211]
    ds_read_b64_tr_b16 v[72:73], v12 offset:49152
    v_mfma_f32_16x16x32_bf16 v[240:243], v[80:83], v[108:111], v[240:243]
    ds_read_b64_tr_b16 v[74:75], v12 offset:50176
    s_add_u32 m0, s33, 65536
    s_add_u32 s31, s45, 32768
    buffer_load_dwordx4 v8, s[12:15], s31 offen offset:0 sc1 lds
    v_mfma_f32_16x16x32_bf16 v[212:215], v[84:87], v[104:107], v[212:215]
    ds_read_b64_tr_b16 v[76:77], v13 offset:49152
    v_mfma_f32_16x16x32_bf16 v[244:247], v[84:87], v[108:111], v[244:247]
    ds_read_b64_tr_b16 v[78:79], v13 offset:50176
    s_waitcnt lgkmcnt(8)
    v_mfma_f32_16x16x32_bf16 v[216:219], v[88:91], v[104:107], v[216:219]
    ds_read_b64_tr_b16 v[80:81], v14 offset:49152
    v_mfma_f32_16x16x32_bf16 v[248:251], v[88:91], v[108:111], v[248:251]
    ds_read_b64_tr_b16 v[82:83], v14 offset:50176
    buffer_store_dwordx4 v[188:191], v61, s[16:19], s49 offen sc1
    v_mfma_f32_16x16x32_bf16 v[220:223], v[92:95], v[104:107], v[220:223]
    ds_read_b64_tr_b16 v[84:85], v15 offset:49152
    v_mfma_f32_16x16x32_bf16 v[252:255], v[92:95], v[108:111], v[252:255]
    ds_read_b64_tr_b16 v[86:87], v15 offset:50176
    s_waitcnt lgkmcnt(8)
    s_waitcnt vmcnt(9)
    v_mfma_f32_16x16x32_bf16 v[192:195], v[64:67], v[112:115], v[192:195]
    ds_read_b64_tr_b16 v[88:89], v16 offset:49152
    v_mfma_f32_16x16x32_bf16 v[224:227], v[64:67], v[116:119], v[224:227]
    ds_read_b64_tr_b16 v[90:91], v16 offset:50176
    v_mfma_f32_16x16x32_bf16 v[196:199], v[68:71], v[112:115], v[196:199]
    ds_read_b64_tr_b16 v[92:93], v17 offset:49152
    v_mfma_f32_16x16x32_bf16 v[228:231], v[68:71], v[116:119], v[228:231]
    ds_read_b64_tr_b16 v[94:95], v17 offset:50176
    s_waitcnt lgkmcnt(8)
    v_mfma_f32_16x16x32_bf16 v[200:203], v[72:75], v[112:115], v[200:203]
    ds_read_b64_tr_b16 v[64:65], v10 offset:57344
    v_mfma_f32_16x16x32_bf16 v[232:235], v[72:75], v[116:119], v[232:235]
    ds_read_b64_tr_b16 v[66:67], v10 offset:58368
    v_mfma_f32_16x16x32_bf16 v[204:207], v[76:79], v[112:115], v[204:207]
    ds_read_b64_tr_b16 v[68:69], v11 offset:57344
    v_mfma_f32_16x16x32_bf16 v[236:239], v[76:79], v[116:119], v[236:239]
    ds_read_b64_tr_b16 v[70:71], v11 offset:58368
    s_waitcnt lgkmcnt(8)
    v_mfma_f32_16x16x32_bf16 v[208:211], v[80:83], v[112:115], v[208:211]
    ds_read_b64_tr_b16 v[72:73], v12 offset:57344
    buffer_load_dwordx4 v8, s[12:15], s31 offen offset:1024 sc1 lds
    v_mfma_f32_16x16x32_bf16 v[240:243], v[80:83], v[116:119], v[240:243]
    ds_read_b64_tr_b16 v[74:75], v12 offset:58368
    v_mfma_f32_16x16x32_bf16 v[212:215], v[84:87], v[112:115], v[212:215]
    ds_read_b64_tr_b16 v[76:77], v13 offset:57344
    v_mfma_f32_16x16x32_bf16 v[244:247], v[84:87], v[116:119], v[244:247]
    ds_read_b64_tr_b16 v[78:79], v13 offset:58368
    s_waitcnt lgkmcnt(8)
    v_mfma_f32_16x16x32_bf16 v[216:219], v[88:91], v[112:115], v[216:219]
    ds_read_b64_tr_b16 v[80:81], v14 offset:57344
    buffer_load_dwordx4 v8, s[12:15], s31 offen offset:2048 sc1 lds
    v_mfma_f32_16x16x32_bf16 v[248:251], v[88:91], v[116:119], v[248:251]
    ds_read_b64_tr_b16 v[82:83], v14 offset:58368
    v_mfma_f32_16x16x32_bf16 v[220:223], v[92:95], v[112:115], v[220:223]
    ds_read_b64_tr_b16 v[84:85], v15 offset:57344
    v_mfma_f32_16x16x32_bf16 v[252:255], v[92:95], v[116:119], v[252:255]
    ds_read_b64_tr_b16 v[86:87], v15 offset:58368
    s_waitcnt lgkmcnt(8)
    s_waitcnt vmcnt(8)
    v_mfma_f32_16x16x32_bf16 v[192:195], v[64:67], v[120:123], v[192:195]
    ds_read_b64_tr_b16 v[88:89], v16 offset:57344
    buffer_load_dwordx4 v8, s[12:15], s31 offen offset:3072 sc1 lds
    v_mfma_f32_16x16x32_bf16 v[224:227], v[64:67], v[124:127], v[224:227]
    ds_read_b64_tr_b16 v[90:91], v16 offset:58368
    v_mfma_f32_16x16x32_bf16 v[196:199], v[68:71], v[120:123], v[196:199]
    ds_read_b64_tr_b16 v[92:93], v17 offset:57344
    v_mfma_f32_16x16x32_bf16 v[228:231], v[68:71], v[124:127], v[228:231]
    ds_read_b64_tr_b16 v[94:95], v17 offset:58368
    s_waitcnt lgkmcnt(8)
    v_mfma_f32_16x16x32_bf16 v[200:203], v[72:75], v[120:123], v[200:203]
    v_mfma_f32_16x16x32_bf16 v[232:235], v[72:75], v[124:127], v[232:235]
    v_mfma_f32_16x16x32_bf16 v[204:207], v[76:79], v[120:123], v[204:207]
    v_mfma_f32_16x16x32_bf16 v[236:239], v[76:79], v[124:127], v[236:239]
    s_waitcnt lgkmcnt(4)
    v_mfma_f32_16x16x32_bf16 v[208:211], v[80:83], v[120:123], v[208:211]
    v_mfma_f32_16x16x32_bf16 v[240:243], v[80:83], v[124:127], v[240:243]
    v_mfma_f32_16x16x32_bf16 v[212:215], v[84:87], v[120:123], v[212:215]
    v_mfma_f32_16x16x32_bf16 v[244:247], v[84:87], v[124:127], v[244:247]
    s_waitcnt lgkmcnt(0)
    v_mfma_f32_16x16x32_bf16 v[216:219], v[88:91], v[120:123], v[216:219]
    v_mfma_f32_16x16x32_bf16 v[248:251], v[88:91], v[124:127], v[248:251]
    v_mfma_f32_16x16x32_bf16 v[220:223], v[92:95], v[120:123], v[220:223]
    v_mfma_f32_16x16x32_bf16 v[252:255], v[92:95], v[124:127], v[252:255]
    s_load_dwordx2 s[32:33], s[0:1], 40
    s_load_dwordx2 s[34:35], s[0:1], 80
    s_load_dwordx2 s[96:97], s[0:1], 0
    s_load_dwordx2 s[98:99], s[0:1], 88
    s_cmp_lt_u32 s28, 4
    s_cbranch_scc0 L_grp1
    v_mov_b32 v20, 1040356334
    v_mov_b32 v21, v20
    s_and_b32 s37, s28, 3
    s_lshl_b32 s37, s37, 13
    v_lshlrev_b32 v7, 4, v1
    v_add_u32 v4, s37, v7
    v_add_u32 v19, 131072, v4
    v_add_u32 v6, 4096, v4
    s_add_u32 s43, s37, 32768
    s_add_u32 s44, s37, 98304
    v_pk_mul_f32 v[192:193], v[192:193], v[20:21]
    v_pk_mul_f32 v[194:195], v[194:195], v[20:21]
    v_pk_mul_f32 v[196:197], v[196:197], v[20:21]
    v_pk_mul_f32 v[198:199], v[198:199], v[20:21]
    v_cvt_pk_bf16_f32 v128, v192, v193
    v_cvt_pk_bf16_f32 v129, v194, v195
    v_cvt_pk_bf16_f32 v130, v196, v197
    v_cvt_pk_bf16_f32 v131, v198, v199
    ds_write_b128 v19, v[128:131] offset:0
    v_pk_mul_f32 v[224:225], v[224:225], v[20:21]
    v_pk_mul_f32 v[226:227], v[226:227], v[20:21]
    v_pk_mul_f32 v[228:229], v[228:229], v[20:21]
    v_pk_mul_f32 v[230:231], v[230:231], v[20:21]
    v_cvt_pk_bf16_f32 v144, v224, v225
    v_cvt_pk_bf16_f32 v145, v226, v227
    v_cvt_pk_bf16_f32 v146, v228, v229
    v_cvt_pk_bf16_f32 v147, v230, v231
    ds_write_b128 v19, v[144:147] offset:4096
    v_pk_mul_f32 v[200:201], v[200:201], v[20:21]
    v_pk_mul_f32 v[202:203], v[202:203], v[20:21]
    v_pk_mul_f32 v[204:205], v[204:205], v[20:21]
    v_pk_mul_f32 v[206:207], v[206:207], v[20:21]
    v_cvt_pk_bf16_f32 v132, v200, v201
    v_cvt_pk_bf16_f32 v133, v202, v203
    v_cvt_pk_bf16_f32 v134, v204, v205
    v_cvt_pk_bf16_f32 v135, v206, v207
    ds_write_b128 v19, v[132:135] offset:1024
    v_pk_mul_f32 v[232:233], v[232:233], v[20:21]
    v_pk_mul_f32 v[234:235], v[234:235], v[20:21]
    v_pk_mul_f32 v[236:237], v[236:237], v[20:21]
    v_pk_mul_f32 v[238:239], v[238:239], v[20:21]
    v_cvt_pk_bf16_f32 v148, v232, v233
    v_cvt_pk_bf16_f32 v149, v234, v235
    v_cvt_pk_bf16_f32 v150, v236, v237
    v_cvt_pk_bf16_f32 v151, v238, v239
    ds_write_b128 v19, v[148:151] offset:5120
    v_pk_mul_f32 v[208:209], v[208:209], v[20:21]
    v_pk_mul_f32 v[210:211], v[210:211], v[20:21]
    v_pk_mul_f32 v[212:213], v[212:213], v[20:21]
    v_pk_mul_f32 v[214:215], v[214:215], v[20:21]
    v_cvt_pk_bf16_f32 v136, v208, v209
    v_cvt_pk_bf16_f32 v137, v210, v211
    v_cvt_pk_bf16_f32 v138, v212, v213
    v_cvt_pk_bf16_f32 v139, v214, v215
    ds_write_b128 v19, v[136:139] offset:2048
    v_pk_mul_f32 v[240:241], v[240:241], v[20:21]
    v_pk_mul_f32 v[242:243], v[242:243], v[20:21]
    v_pk_mul_f32 v[244:245], v[244:245], v[20:21]
    v_pk_mul_f32 v[246:247], v[246:247], v[20:21]
    v_cvt_pk_bf16_f32 v152, v240, v241
    v_cvt_pk_bf16_f32 v153, v242, v243
    v_cvt_pk_bf16_f32 v154, v244, v245
    v_cvt_pk_bf16_f32 v155, v246, v247
    ds_write_b128 v19, v[152:155] offset:6144
    v_pk_mul_f32 v[216:217], v[216:217], v[20:21]
    v_pk_mul_f32 v[218:219], v[218:219], v[20:21]
    v_pk_mul_f32 v[220:221], v[220:221], v[20:21]
    v_pk_mul_f32 v[222:223], v[222:223], v[20:21]
    v_cvt_pk_bf16_f32 v140, v216, v217
    v_cvt_pk_bf16_f32 v141, v218, v219
    v_cvt_pk_bf16_f32 v142, v220, v221
    v_cvt_pk_bf16_f32 v143, v222, v223
    ds_write_b128 v19, v[140:143] offset:3072
    v_pk_mul_f32 v[248:249], v[248:249], v[20:21]
    v_pk_mul_f32 v[250:251], v[250:251], v[20:21]
    v_pk_mul_f32 v[252:253], v[252:253], v[20:21]
    v_pk_mul_f32 v[254:255], v[254:255], v[20:21]
    v_cvt_pk_bf16_f32 v156, v248, v249
    v_cvt_pk_bf16_f32 v157, v250, v251
    v_cvt_pk_bf16_f32 v158, v252, v253
    v_cvt_pk_bf16_f32 v159, v254, v255
    ds_write_b128 v19, v[156:159] offset:7168
    v_mov_b32 v2, v7
    v_and_b32 v21, 15, v1
    v_lshrrev_b32 v22, 4, v1
    v_lshlrev_b32 v22, 2, v22
    v_sub_u32 v18, v21, v22
    s_mov_b32 s40, 0
    s_mov_b32 s41, 16384
    s_mov_b32 s49, 0xffff
    s_lshl_b32 s51, s30, 1
    s_add_u32 s51, s51, 1
    s_and_b32 s50, s28, 3
    s_lshl_b32 s50, s50, 5
    s_lshl_b32 s31, 1, s51
    s_or_b32 s31, s31, 0x8000
    s_add_u32 s36, s51, 1
    s_lshl_b32 s36, -1, s36
    s_or_b32 s48, s36, 0xaaaaaaab
    s_and_b32 s48, s48, 0x7fff
    s_or_b32 s39, s36, 0x55555555
    s_and_b32 s39, s39, 0xffff
    s_add_u32 s46, s45, 65536
    s_add_u32 s47, s45, 98304
    s_mov_b64 s[52:53], 0
    s_waitcnt vmcnt(3) lgkmcnt(0)
    s_barrier
    ds_read_b128 v[64:67], v2 offset:0
    ds_read_b128 v[68:71], v2 offset:1024
    ds_read_b128 v[72:75], v2 offset:2048
    ds_read_b128 v[76:79], v2 offset:3072
    ds_read_b128 v[80:83], v2 offset:4096
    ds_read_b128 v[84:87], v2 offset:5120
    ds_read_b128 v[88:91], v2 offset:6144
    ds_read_b128 v[92:95], v2 offset:7168
    v_mov_b32 v36, 0x3f803f80
    v_mov_b32 v37, 0x3f803f80
    v_mov_b32 v38, 0x3f803f80
    v_mov_b32 v39, 0x3f803f80
    s_add_u32 s16, s54, 41943040
    s_addc_u32 s17, s55, 0
    s_and_b32 s17, s17, 0xffff
    s_mov_b32 s18, 117440640
    s_mov_b32 s19, 0x20000
    s_mov_b32 s4, s92
    s_and_b32 s5, s93, 0xffff
    s_mov_b32 s6, 7340032
    s_mov_b32 s7, 0x20000
    s_mov_b32 s8, s94
    s_and_b32 s9, s95, 0xffff
    s_mov_b32 s10, 7340032
    s_mov_b32 s11, 0x20000
    s_and_b32 s60, s29, 3
    s_add_u32 s60, s60, 4
    s_sub_u32 s3, s2, 32
    s_cmp_eq_u32 s28, 0
    s_cselect_b32 s36, 0xad, 0x2d
    s_cselect_b32 s42, 14, 12
    s_cmp_lt_u32 s3, 224
    s_cselect_b32 s36, s36, 0
    s_lshl_b32 s36, s36, s60
    s_or_b32 s42, s42, s36
    s_waitcnt lgkmcnt(7)
    v_mfma_f32_16x16x32_bf16 v[96:99], v[64:67], v[128:131], 0
    v_mov_b64 v[192:193], 0
    v_mov_b64 v[194:195], 0
    v_mfma_f32_16x16x32_bf16 v[104:107], v[64:67], v[144:147], 0
    ds_read_b128 v[64:67], v2 offset:8192
    v_mov_b64 v[196:197], 0
    v_mov_b64 v[198:199], 0
    s_waitcnt lgkmcnt(7)
    v_mfma_f32_16x16x32_bf16 v[96:99], v[68:71], v[132:135], v[96:99]
    v_mov_b64 v[200:201], 0
    v_mov_b64 v[202:203], 0
    v_mfma_f32_16x16x32_bf16 v[104:107], v[68:71], v[148:151], v[104:107]
    ds_read_b128 v[68:71], v2 offset:9216
    v_mov_b64 v[204:205], 0
    v_mov_b64 v[206:207], 0
    s_waitcnt lgkmcnt(7)
    v_mfma_f32_16x16x32_bf16 v[96:99], v[72:75], v[136:139], v[96:99]
    v_mov_b64 v[208:209], 0
    v_mov_b64 v[210:211], 0
    v_mfma_f32_16x16x32_bf16 v[104:107], v[72:75], v[152:155], v[104:107]
    ds_read_b128 v[72:75], v2 offset:10240
    v_mov_b64 v[212:213], 0
    v_mov_b64 v[214:215], 0
    s_waitcnt lgkmcnt(7)
    v_mfma_f32_16x16x32_bf16 v[96:99], v[76:79], v[140:143], v[96:99]
    v_mov_b64 v[216:217], 0
    v_mov_b64 v[218:219], 0
    v_mfma_f32_16x16x32_bf16 v[104:107], v[76:79], v[156:159], v[104:107]
    ds_read_b128 v[76:79], v2 offset:11264
    v_mov_b64 v[220:221], 0
    s_waitcnt lgkmcnt(7)
    v_mfma_f32_16x16x32_bf16 v[100:103], v[80:83], v[128:131], 0
    v_mov_b64 v[222:223], 0
    v_mov_b64 v[224:225], 0
    v_mfma_f32_16x16x32_bf16 v[108:111], v[80:83], v[144:147], 0
    ds_read_b128 v[80:83], v2 offset:12288
    v_mov_b64 v[226:227], 0
    v_mov_b64 v[228:229], 0
    s_waitcnt lgkmcnt(7)
    v_mfma_f32_16x16x32_bf16 v[100:103], v[84:87], v[132:135], v[100:103]
    v_mov_b64 v[230:231], 0
    v_mov_b64 v[232:233], 0
    v_mfma_f32_16x16x32_bf16 v[108:111], v[84:87], v[148:151], v[108:111]
    ds_read_b128 v[84:87], v2 offset:13312
    v_mov_b64 v[234:235], 0
    v_mov_b64 v[236:237], 0
    s_waitcnt lgkmcnt(7)
    v_mfma_f32_16x16x32_bf16 v[100:103], v[88:91], v[136:139], v[100:103]
    v_mov_b64 v[238:239], 0
    v_mov_b64 v[240:241], 0
    v_mfma_f32_16x16x32_bf16 v[108:111], v[88:91], v[152:155], v[108:111]
    ds_read_b128 v[88:91], v2 offset:14336
    v_mov_b64 v[242:243], 0
    v_mov_b64 v[244:245], 0
    s_waitcnt lgkmcnt(7)
    v_mfma_f32_16x16x32_bf16 v[100:103], v[92:95], v[140:143], v[100:103]
    v_mov_b64 v[246:247], 0
    v_mfma_f32_16x16x32_bf16 v[108:111], v[92:95], v[156:159], v[108:111]
    ds_read_b128 v[92:95], v2 offset:15360
    v_mov_b64 v[248:249], 0
    v_mov_b64 v[250:251], 0
    v_mov_b64 v[252:253], 0
    v_mov_b64 v[254:255], 0
    v_mov_b64 v[28:29], 0
    v_mov_b64 v[30:31], 0
    v_mov_b64 v[32:33], 0
    v_mov_b64 v[34:35], 0
    v_max3_f32 v22, v96, v97, v98
    v_max3_f32 v23, v104, v105, v106
    v_max3_f32 v22, v22, v99, v100
    v_max3_f32 v23, v23, v107, v108
    v_max3_f32 v22, v22, v101, v102
    v_max3_f32 v23, v23, v109, v110
    v_max_f32 v22, v22, v103
    v_max_f32 v23, v23, v111
    v_mov_b32 v24, v22
    v_mov_b32 v25, v23
    s_nop 0
    v_permlane16_swap_b32 v22, v24
    v_permlane16_swap_b32 v23, v25
    s_nop 0
    v_max_f32 v22, v22, v24
    v_max_f32 v23, v23, v25
    v_mov_b32 v24, v22
    v_mov_b32 v25, v23
    s_nop 0
    v_permlane32_swap_b32 v22, v24
    v_permlane32_swap_b32 v23, v25
    s_nop 0
    v_max_f32 v22, v22, v24
    v_max_f32 v23, v23, v25
    v_sub_f32 v40, 0, v22
    v_sub_f32 v41, 0, v22
    v_sub_f32 v42, 0, v22
    v_sub_f32 v43, 0, v22
    v_sub_f32 v44, 0, v23
    v_sub_f32 v45, 0, v23
    v_sub_f32 v46, 0, v23
    v_sub_f32 v47, 0, v23
    v_add_f32 v96, v96, v40
    v_add_f32 v97, v97, v40
    s_waitcnt lgkmcnt(7)
    v_mfma_f32_16x16x32_bf16 v[112:115], v[64:67], v[128:131], v[40:43]
    v_exp_f32 v96, v96
    v_add_f32 v98, v98, v40
    v_mfma_f32_16x16x32_bf16 v[120:123], v[64:67], v[144:147], v[44:47]
    v_exp_f32 v97, v97
    v_add_f32 v99, v99, v40
    s_waitcnt lgkmcnt(6)
    v_mfma_f32_16x16x32_bf16 v[112:115], v[68:71], v[132:135], v[112:115]
    v_exp_f32 v98, v98
    v_add_f32 v104, v104, v44
    v_cvt_pk_bf16_f32 v48, v96, v97
    v_mfma_f32_16x16x32_bf16 v[120:123], v[68:71], v[148:151], v[120:123]
    ds_read_b128 v[64:67], v2 offset:16384
    v_exp_f32 v99, v99
    v_add_f32 v105, v105, v44
    s_waitcnt lgkmcnt(6)
    v_mfma_f32_16x16x32_bf16 v[112:115], v[72:75], v[136:139], v[112:115]
    v_exp_f32 v104, v104
    v_add_f32 v106, v106, v44
    v_cvt_pk_bf16_f32 v49, v98, v99
    v_mfma_f32_16x16x32_bf16 v[120:123], v[72:75], v[152:155], v[120:123]
    ds_read_b128 v[68:71], v2 offset:17408
    v_exp_f32 v105, v105
    v_add_f32 v107, v107, v44
    s_waitcnt lgkmcnt(6)
    v_mfma_f32_16x16x32_bf16 v[112:115], v[76:79], v[140:143], v[112:115]
    v_exp_f32 v106, v106
    v_add_f32 v100, v100, v40
    v_cvt_pk_bf16_f32 v52, v104, v105
    v_mfma_f32_16x16x32_bf16 v[120:123], v[76:79], v[156:159], v[120:123]
    ds_read_b128 v[72:75], v2 offset:18432
    v_exp_f32 v107, v107
    v_add_f32 v101, v101, v40
    s_waitcnt lgkmcnt(6)
    v_mfma_f32_16x16x32_bf16 v[116:119], v[80:83], v[128:131], v[40:43]
    v_exp_f32 v100, v100
    v_add_f32 v102, v102, v40
    v_cvt_pk_bf16_f32 v53, v106, v107
    v_mfma_f32_16x16x32_bf16 v[124:127], v[80:83], v[144:147], v[44:47]
    ds_read_b128 v[76:79], v2 offset:19456
    v_exp_f32 v101, v101
    v_add_f32 v103, v103, v40
    s_waitcnt lgkmcnt(6)
    v_mfma_f32_16x16x32_bf16 v[116:119], v[84:87], v[132:135], v[116:119]
    v_exp_f32 v102, v102
    v_add_f32 v108, v108, v44
    v_cvt_pk_bf16_f32 v50, v100, v101
    v_mfma_f32_16x16x32_bf16 v[124:127], v[84:87], v[148:151], v[124:127]
    ds_read_b128 v[80:83], v2 offset:20480
    v_exp_f32 v103, v103
    v_add_f32 v109, v109, v44
    s_waitcnt lgkmcnt(6)
    v_mfma_f32_16x16x32_bf16 v[116:119], v[88:91], v[136:139], v[116:119]
    v_exp_f32 v108, v108
    v_add_f32 v110, v110, v44
    v_cvt_pk_bf16_f32 v51, v102, v103
    v_mfma_f32_16x16x32_bf16 v[124:127], v[88:91], v[152:155], v[124:127]
    ds_read_b128 v[84:87], v2 offset:21504
    v_exp_f32 v109, v109
    v_add_f32 v111, v111, v44
    s_waitcnt lgkmcnt(6)
    v_mfma_f32_16x16x32_bf16 v[116:119], v[92:95], v[140:143], v[116:119]
    v_exp_f32 v110, v110
    v_cvt_pk_bf16_f32 v54, v108, v109
    v_mfma_f32_16x16x32_bf16 v[124:127], v[92:95], v[156:159], v[124:127]
    ds_read_b128 v[88:91], v2 offset:22528
    v_exp_f32 v111, v111
    v_add_u32 v3, 65536, v2
    v_add_u32 v2, s41, v2
    v_and_b32 v2, s49, v2
    v_cvt_pk_bf16_f32 v55, v110, v111
    s_waitcnt vmcnt(0)
    s_barrier
    s_cmp_eq_u32 s28, 0
    s_cbranch_scc1 L_recurrent_scan__compressed_kv_cla__moe_arch_mod__prompt_kernel_rare_56
L_recurrent_scan__compressed_kv_cla__moe_arch_mod__prompt_kernel_back_57:
    ds_write_b32 v19, v40
    ds_write_b32 v19, v44 offset:4
    .p2align 6
L_body00:
    s_waitcnt lgkmcnt(5)
    v_mfma_f32_16x16x32_bf16 v[96:99], v[64:67], v[128:131], v[40:43]
    v_exp_f32 v112, v112
    v_mfma_f32_16x16x32_bf16 v[104:107], v[64:67], v[144:147], v[44:47]
    ds_read_b128 v[92:95], v2 offset:7168
    s_bitcmp1_b32 s48, s40
    s_cbranch_scc0 L_recurrent_scan__compressed_kv_cla__moe_arch_mod__prompt_kernel_nodma_82
    s_add_u32 m0, s43, 0
    s_nop 0
    buffer_load_dwordx4 v4, s[12:15], s46 offen offset:0 sc1 lds
    buffer_load_dwordx4 v4, s[12:15], s46 offen offset:1024 sc1 lds
L_recurrent_scan__compressed_kv_cla__moe_arch_mod__prompt_kernel_nodma_82:
    v_mfma_f32_16x16x32_bf16 v[96:99], v[68:71], v[132:135], v[96:99]
    v_exp_f32 v113, v113
    v_mfma_f32_16x16x32_bf16 v[104:107], v[68:71], v[148:151], v[104:107]
    ds_read_b128 v[64:67], v3 offset:0
    s_waitcnt lgkmcnt(5)
    v_mfma_f32_16x16x32_bf16 v[96:99], v[72:75], v[136:139], v[96:99]
    v_exp_f32 v114, v114
    v_mfma_f32_16x16x32_bf16 v[104:107], v[72:75], v[152:155], v[104:107]
    ds_read_b128 v[68:71], v3 offset:1024
    v_cvt_pk_bf16_f32 v56, v112, v113
    s_bitcmp1_b32 s48, s40
    s_cbranch_scc0 L_recurrent_scan__compressed_kv_cla__moe_arch_mod__prompt_kernel_nodma_83
    s_add_u32 m0, s43, 0
    s_nop 0
    buffer_load_dwordx4 v4, s[12:15], s46 offen offset:2048 sc1 lds
    buffer_load_dwordx4 v4, s[12:15], s46 offen offset:3072 sc1 lds
L_recurrent_scan__compressed_kv_cla__moe_arch_mod__prompt_kernel_nodma_83:
    v_mfma_f32_16x16x32_bf16 v[96:99], v[76:79], v[140:143], v[96:99]
    v_exp_f32 v115, v115
    v_mfma_f32_16x16x32_bf16 v[104:107], v[76:79], v[156:159], v[104:107]
    ds_read_b128 v[72:75], v3 offset:2048
    s_waitcnt lgkmcnt(5)
    v_mfma_f32_16x16x32_bf16 v[100:103], v[80:83], v[128:131], v[40:43]
    v_exp_f32 v120, v120
    v_mfma_f32_16x16x32_bf16 v[108:111], v[80:83], v[144:147], v[44:47]
    ds_read_b128 v[76:79], v3 offset:3072
    v_cvt_pk_bf16_f32 v57, v114, v115
    v_mfma_f32_16x16x32_bf16 v[100:103], v[84:87], v[132:135], v[100:103]
    v_exp_f32 v121, v121
    v_mfma_f32_16x16x32_bf16 v[108:111], v[84:87], v[148:151], v[108:111]
    ds_read_b128 v[80:83], v3 offset:4096
    s_bitcmp1_b32 s48, s40
    s_cbranch_scc0 L_recurrent_scan__compressed_kv_cla__moe_arch_mod__prompt_kernel_nodma_84
    s_add_u32 m0, s43, 4096
    s_nop 0
    buffer_load_dwordx4 v6, s[12:15], s46 offen offset:0 sc1 lds
    buffer_load_dwordx4 v6, s[12:15], s46 offen offset:1024 sc1 lds
L_recurrent_scan__compressed_kv_cla__moe_arch_mod__prompt_kernel_nodma_84:
    s_waitcnt lgkmcnt(5)
    v_mfma_f32_16x16x32_bf16 v[100:103], v[88:91], v[136:139], v[100:103]
    v_exp_f32 v122, v122
    v_mfma_f32_16x16x32_bf16 v[108:111], v[88:91], v[152:155], v[108:111]
    ds_read_b128 v[84:87], v3 offset:5120
    v_cvt_pk_bf16_f32 v60, v120, v121
    v_mfma_f32_16x16x32_bf16 v[100:103], v[92:95], v[140:143], v[100:103]
    v_exp_f32 v123, v123
    v_mfma_f32_16x16x32_bf16 v[108:111], v[92:95], v[156:159], v[108:111]
    ds_read_b128 v[88:91], v3 offset:6144
    s_bitcmp1_b32 s48, s40
    s_cbranch_scc0 L_recurrent_scan__compressed_kv_cla__moe_arch_mod__prompt_kernel_nodma_85
    s_add_u32 m0, s43, 4096
    s_nop 0
    buffer_load_dwordx4 v6, s[12:15], s46 offen offset:2048 sc1 lds
    buffer_load_dwordx4 v6, s[12:15], s46 offen offset:3072 sc1 lds
    s_add_u32 s46, s46, 65536
    s_xor_b32 s43, s43, 32768
L_recurrent_scan__compressed_kv_cla__moe_arch_mod__prompt_kernel_nodma_85:
    s_waitcnt lgkmcnt(5)
    v_mfma_f32_16x16x32_bf16 v[192:195], v[64:67], v[48:51], v[192:195]
    v_exp_f32 v116, v116
    v_mfma_f32_16x16x32_bf16 v[224:227], v[64:67], v[52:55], v[224:227]
    ds_read_b128 v[92:95], v3 offset:7168
    v_cvt_pk_bf16_f32 v61, v122, v123
    v_mfma_f32_16x16x32_bf16 v[196:199], v[68:71], v[48:51], v[196:199]
    v_exp_f32 v117, v117
    v_mfma_f32_16x16x32_bf16 v[228:231], v[68:71], v[52:55], v[228:231]
    ds_read_b128 v[64:67], v2 offset:8192
    s_waitcnt lgkmcnt(5)
    v_mfma_f32_16x16x32_bf16 v[200:203], v[72:75], v[48:51], v[200:203]
    v_exp_f32 v118, v118
    v_mfma_f32_16x16x32_bf16 v[232:235], v[72:75], v[52:55], v[232:235]
    v_mfma_f32_16x16x32_bf16 v[28:31], v[36:39], v[48:51], v[28:31]
    ds_read_b128 v[68:71], v2 offset:9216
    v_cvt_pk_bf16_f32 v58, v116, v117
    s_bitcmp1_b32 s39, s40
    s_cbranch_scc0 L_recurrent_scan__compressed_kv_cla__moe_arch_mod__prompt_kernel_nodma_86
    s_add_u32 m0, s44, 0
    s_nop 0
    buffer_load_dwordx4 v4, s[12:15], s47 offen offset:0 sc1 lds
    buffer_load_dwordx4 v4, s[12:15], s47 offen offset:1024 sc1 lds
L_recurrent_scan__compressed_kv_cla__moe_arch_mod__prompt_kernel_nodma_86:
    v_mfma_f32_16x16x32_bf16 v[204:207], v[76:79], v[48:51], v[204:207]
    v_exp_f32 v119, v119
    v_mfma_f32_16x16x32_bf16 v[236:239], v[76:79], v[52:55], v[236:239]
    ds_read_b128 v[72:75], v2 offset:10240
    s_waitcnt lgkmcnt(5)
    v_mfma_f32_16x16x32_bf16 v[208:211], v[80:83], v[48:51], v[208:211]
    v_exp_f32 v124, v124
    v_mfma_f32_16x16x32_bf16 v[240:243], v[80:83], v[52:55], v[240:243]
    ds_read_b128 v[76:79], v2 offset:11264
    v_cvt_pk_bf16_f32 v59, v118, v119
    s_bitcmp1_b32 s39, s40
    s_cbranch_scc0 L_recurrent_scan__compressed_kv_cla__moe_arch_mod__prompt_kernel_nodma_87
    s_add_u32 m0, s44, 0
    s_nop 0
    buffer_load_dwordx4 v4, s[12:15], s47 offen offset:2048 sc1 lds
    buffer_load_dwordx4 v4, s[12:15], s47 offen offset:3072 sc1 lds
L_recurrent_scan__compressed_kv_cla__moe_arch_mod__prompt_kernel_nodma_87:
    v_mfma_f32_16x16x32_bf16 v[212:215], v[84:87], v[48:51], v[212:215]
    v_exp_f32 v125, v125
    v_mfma_f32_16x16x32_bf16 v[244:247], v[84:87], v[52:55], v[244:247]
    ds_read_b128 v[80:83], v2 offset:12288
    s_waitcnt lgkmcnt(5)
    v_mfma_f32_16x16x32_bf16 v[216:219], v[88:91], v[48:51], v[216:219]
    v_exp_f32 v126, v126
    v_mfma_f32_16x16x32_bf16 v[248:251], v[88:91], v[52:55], v[248:251]
    v_mfma_f32_16x16x32_bf16 v[32:35], v[36:39], v[52:55], v[32:35]
    ds_read_b128 v[84:87], v2 offset:13312
    v_cvt_pk_bf16_f32 v62, v124, v125
    v_mfma_f32_16x16x32_bf16 v[220:223], v[92:95], v[48:51], v[220:223]
    v_exp_f32 v127, v127
    v_mfma_f32_16x16x32_bf16 v[252:255], v[92:95], v[52:55], v[252:255]
    ds_read_b128 v[88:91], v2 offset:14336
    v_cvt_pk_bf16_f32 v63, v126, v127
    s_bitcmp1_b32 s39, s40
    s_cbranch_scc0 L_recurrent_scan__compressed_kv_cla__moe_arch_mod__prompt_kernel_nodma_88
    s_add_u32 m0, s44, 4096
    s_nop 0
    buffer_load_dwordx4 v6, s[12:15], s47 offen offset:0 sc1 lds
    buffer_load_dwordx4 v6, s[12:15], s47 offen offset:1024 sc1 lds
L_recurrent_scan__compressed_kv_cla__moe_arch_mod__prompt_kernel_nodma_88:
    s_bitcmp1_b32 s31, s40
    s_cbranch_scc1 L_recurrent_scan__compressed_kv_cla__moe_arch_mod__prompt_kernel_rare_64
L_recurrent_scan__compressed_kv_cla__moe_arch_mod__prompt_kernel_back_65:
    s_waitcnt lgkmcnt(5)
    v_mfma_f32_16x16x32_bf16 v[112:115], v[64:67], v[128:131], v[40:43]
    v_exp_f32 v96, v96
    v_mfma_f32_16x16x32_bf16 v[120:123], v[64:67], v[144:147], v[44:47]
    ds_read_b128 v[92:95], v2 offset:15360
    v_mfma_f32_16x16x32_bf16 v[112:115], v[68:71], v[132:135], v[112:115]
    v_exp_f32 v97, v97
    v_mfma_f32_16x16x32_bf16 v[120:123], v[68:71], v[148:151], v[120:123]
    ds_read_b128 v[64:67], v3 offset:8192
    s_bitcmp1_b32 s39, s40
    s_cbranch_scc0 L_recurrent_scan__compressed_kv_cla__moe_arch_mod__prompt_kernel_nodma_89
    s_add_u32 m0, s44, 4096
    s_nop 0
    buffer_load_dwordx4 v6, s[12:15], s47 offen offset:2048 sc1 lds
    buffer_load_dwordx4 v6, s[12:15], s47 offen offset:3072 sc1 lds
    s_add_u32 s47, s47, 65536
    s_xor_b32 s44, s44, 32768
L_recurrent_scan__compressed_kv_cla__moe_arch_mod__prompt_kernel_nodma_89:
    s_waitcnt lgkmcnt(5)
    v_mfma_f32_16x16x32_bf16 v[112:115], v[72:75], v[136:139], v[112:115]
    v_exp_f32 v98, v98
    v_mfma_f32_16x16x32_bf16 v[120:123], v[72:75], v[152:155], v[120:123]
    ds_read_b128 v[68:71], v3 offset:9216
    v_cvt_pk_bf16_f32 v48, v96, v97
    v_mfma_f32_16x16x32_bf16 v[112:115], v[76:79], v[140:143], v[112:115]
    v_exp_f32 v99, v99
    v_mfma_f32_16x16x32_bf16 v[120:123], v[76:79], v[156:159], v[120:123]
    ds_read_b128 v[72:75], v3 offset:10240
    s_waitcnt lgkmcnt(5)
    v_mfma_f32_16x16x32_bf16 v[116:119], v[80:83], v[128:131], v[40:43]
    v_exp_f32 v104, v104
    v_mfma_f32_16x16x32_bf16 v[124:127], v[80:83], v[144:147], v[44:47]
    ds_read_b128 v[76:79], v3 offset:11264
    v_cvt_pk_bf16_f32 v49, v98, v99
    v_mfma_f32_16x16x32_bf16 v[116:119], v[84:87], v[132:135], v[116:119]
    v_exp_f32 v105, v105
    v_mfma_f32_16x16x32_bf16 v[124:127], v[84:87], v[148:151], v[124:127]
    ds_read_b128 v[80:83], v3 offset:12288
    s_waitcnt lgkmcnt(5)
    v_mfma_f32_16x16x32_bf16 v[116:119], v[88:91], v[136:139], v[116:119]
    v_exp_f32 v106, v106
    v_mfma_f32_16x16x32_bf16 v[124:127], v[88:91], v[152:155], v[124:127]
    ds_read_b128 v[84:87], v3 offset:13312
    v_cvt_pk_bf16_f32 v52, v104, v105
    v_mfma_f32_16x16x32_bf16 v[116:119], v[92:95], v[140:143], v[116:119]
    v_exp_f32 v107, v107
    v_mfma_f32_16x16x32_bf16 v[124:127], v[92:95], v[156:159], v[124:127]
    ds_read_b128 v[88:91], v3 offset:14336
    s_waitcnt lgkmcnt(5)
    v_mfma_f32_16x16x32_bf16 v[192:195], v[64:67], v[56:59], v[192:195]
    v_exp_f32 v100, v100
    v_mfma_f32_16x16x32_bf16 v[224:227], v[64:67], v[60:63], v[224:227]
    ds_read_b128 v[92:95], v3 offset:15360
    v_cvt_pk_bf16_f32 v53, v106, v107
    v_mfma_f32_16x16x32_bf16 v[196:199], v[68:71], v[56:59], v[196:199]
    v_exp_f32 v101, v101
    v_mfma_f32_16x16x32_bf16 v[228:231], v[68:71], v[60:63], v[228:231]
    v_add_u32 v3, 65536, v2
    v_add_u32 v2, s41, v2
    s_waitcnt lgkmcnt(4)
    v_mfma_f32_16x16x32_bf16 v[200:203], v[72:75], v[56:59], v[200:203]
    v_exp_f32 v102, v102
    s_add_u32 s40, s40, 1
    v_and_b32 v2, s49, v2
    v_mfma_f32_16x16x32_bf16 v[232:235], v[72:75], v[60:63], v[232:235]
    v_mfma_f32_16x16x32_bf16 v[28:31], v[36:39], v[56:59], v[28:31]
    v_cvt_pk_bf16_f32 v50, v100, v101
    s_waitcnt vmcnt(8) lgkmcnt(0)
    s_cmp_le_u32 s40, s51
    s_cbranch_scc1 L_recurrent_scan__compressed_kv_cla__moe_arch_mod__prompt_kernel_rlx_66
    s_waitcnt vmcnt(0)
L_recurrent_scan__compressed_kv_cla__moe_arch_mod__prompt_kernel_rlx_66:
    s_bitcmp1_b32 s42, s40
    s_cbranch_scc1 L_recurrent_scan__compressed_kv_cla__moe_arch_mod__prompt_kernel_rare_80
L_recurrent_scan__compressed_kv_cla__moe_arch_mod__prompt_kernel_back_81:
    s_barrier
    v_mfma_f32_16x16x32_bf16 v[204:207], v[76:79], v[56:59], v[204:207]
    v_exp_f32 v103, v103
    v_mfma_f32_16x16x32_bf16 v[236:239], v[76:79], v[60:63], v[236:239]
    ds_read_b128 v[68:71], v2 offset:1024
    ds_read_b128 v[64:67], v2 offset:0
    v_mfma_f32_16x16x32_bf16 v[208:211], v[80:83], v[56:59], v[208:211]
    v_exp_f32 v108, v108
    v_mfma_f32_16x16x32_bf16 v[240:243], v[80:83], v[60:63], v[240:243]
    ds_read_b128 v[76:79], v2 offset:3072
    ds_read_b128 v[72:75], v2 offset:2048
    v_cvt_pk_bf16_f32 v51, v102, v103
    v_mfma_f32_16x16x32_bf16 v[212:215], v[84:87], v[56:59], v[212:215]
    v_exp_f32 v109, v109
    v_mfma_f32_16x16x32_bf16 v[244:247], v[84:87], v[60:63], v[244:247]
    ds_read_b128 v[80:83], v2 offset:4096
    v_mfma_f32_16x16x32_bf16 v[216:219], v[88:91], v[56:59], v[216:219]
    v_exp_f32 v110, v110
    v_mfma_f32_16x16x32_bf16 v[248:251], v[88:91], v[60:63], v[248:251]
    v_mfma_f32_16x16x32_bf16 v[32:35], v[36:39], v[60:63], v[32:35]
    ds_read_b128 v[84:87], v2 offset:5120
    v_cvt_pk_bf16_f32 v54, v108, v109
    v_mfma_f32_16x16x32_bf16 v[220:223], v[92:95], v[56:59], v[220:223]
    v_exp_f32 v111, v111
    v_mfma_f32_16x16x32_bf16 v[252:255], v[92:95], v[60:63], v[252:255]
    ds_read_b128 v[88:91], v2 offset:6144
    v_cvt_pk_bf16_f32 v55, v110, v111
    s_cmp_lg_u32 s40, 16
    s_cbranch_scc1 L_body00
    s_lshr_b32 s36, s2, 5
    s_add_u32 s36, s36, 48
    s_lshl_b32 s36, s36, 7
    v_mov_b32 v12, s36
    global_load_dword v11, v12, s[90:91] sc1
    s_sub_u32 s36, 32, s50
    s_cmp_lt_i32 s36, 0
    s_cbranch_scc0 L_recurrent_scan__compressed_kv_cla__moe_arch_mod__prompt_kernel_rare_92
L_recurrent_scan__compressed_kv_cla__moe_arch_mod__prompt_kernel_back_93:
    s_lshl_b32 s37, s28, 13
    v_add_u32 v5, s37, v7
    s_waitcnt lgkmcnt(5)
    v_mfma_f32_16x16x32_bf16 v[192:195], v[64:67], v[48:51], v[192:195]
    v_exp_f32 v112, v112
    v_mfma_f32_16x16x32_bf16 v[224:227], v[64:67], v[52:55], v[224:227]
    ds_read_b128 v[92:95], v3 offset:7168
    v_exp_f32 v113, v113
    v_mfma_f32_16x16x32_bf16 v[196:199], v[68:71], v[48:51], v[196:199]
    v_cvt_pk_bf16_f32 v56, v112, v113
    v_exp_f32 v114, v114
    v_mfma_f32_16x16x32_bf16 v[228:231], v[68:71], v[52:55], v[228:231]
    ds_read_b128 v[64:67], v3 offset:8192
    v_exp_f32 v115, v115
    s_waitcnt lgkmcnt(5)
    v_mfma_f32_16x16x32_bf16 v[200:203], v[72:75], v[48:51], v[200:203]
    v_cvt_pk_bf16_f32 v57, v114, v115
    v_exp_f32 v120, v120
    v_mfma_f32_16x16x32_bf16 v[232:235], v[72:75], v[52:55], v[232:235]
    v_mfma_f32_16x16x32_bf16 v[28:31], v[36:39], v[48:51], v[28:31]
    ds_read_b128 v[68:71], v3 offset:9216
    v_exp_f32 v121, v121
    v_mfma_f32_16x16x32_bf16 v[204:207], v[76:79], v[48:51], v[204:207]
    v_cvt_pk_bf16_f32 v60, v120, v121
    v_exp_f32 v122, v122
    v_mfma_f32_16x16x32_bf16 v[236:239], v[76:79], v[52:55], v[236:239]
    ds_read_b128 v[72:75], v3 offset:10240
    v_exp_f32 v123, v123
    s_waitcnt lgkmcnt(6)
    v_mfma_f32_16x16x32_bf16 v[208:211], v[80:83], v[48:51], v[208:211]
    v_cvt_pk_bf16_f32 v61, v122, v123
    v_exp_f32 v116, v116
    v_mfma_f32_16x16x32_bf16 v[240:243], v[80:83], v[52:55], v[240:243]
    ds_read_b128 v[76:79], v3 offset:11264
    v_exp_f32 v117, v117
    s_waitcnt lgkmcnt(6)
    v_mfma_f32_16x16x32_bf16 v[212:215], v[84:87], v[48:51], v[212:215]
    v_cvt_pk_bf16_f32 v58, v116, v117
    v_exp_f32 v118, v118
    v_mfma_f32_16x16x32_bf16 v[244:247], v[84:87], v[52:55], v[244:247]
    ds_read_b128 v[80:83], v3 offset:12288
    v_exp_f32 v119, v119
    s_waitcnt lgkmcnt(6)
    v_mfma_f32_16x16x32_bf16 v[216:219], v[88:91], v[48:51], v[216:219]
    v_cvt_pk_bf16_f32 v59, v118, v119
    v_exp_f32 v124, v124
    v_mfma_f32_16x16x32_bf16 v[248:251], v[88:91], v[52:55], v[248:251]
    v_mfma_f32_16x16x32_bf16 v[32:35], v[36:39], v[52:55], v[32:35]
    ds_read_b128 v[84:87], v3 offset:13312
    v_exp_f32 v125, v125
    s_waitcnt lgkmcnt(6)
    v_mfma_f32_16x16x32_bf16 v[220:223], v[92:95], v[48:51], v[220:223]
    v_cvt_pk_bf16_f32 v62, v124, v125
    v_exp_f32 v126, v126
    v_mfma_f32_16x16x32_bf16 v[252:255], v[92:95], v[52:55], v[252:255]
    ds_read_b128 v[88:91], v3 offset:14336
    v_exp_f32 v127, v127
    s_nop 0
    v_cvt_pk_bf16_f32 v63, v126, v127
    s_nop 1
    s_waitcnt lgkmcnt(6)
    v_mfma_f32_16x16x32_bf16 v[192:195], v[64:67], v[56:59], v[192:195]
    s_mov_b32 s4, s34
    s_and_b32 s5, s35, 0xffff
    s_mov_b32 s6, 7340032
    s_mov_b32 s7, 0x20000
    s_mov_b32 s8, s32
    v_mfma_f32_16x16x32_bf16 v[224:227], v[64:67], v[60:63], v[224:227]
    ds_read_b128 v[92:95], v3 offset:15360
    s_and_b32 s9, s33, 0xffff
    s_mov_b32 s10, 8388608
    s_mov_b32 s11, 0x20000
    s_lshr_b32 s38, s2, 4
    s_waitcnt lgkmcnt(6)
    v_mfma_f32_16x16x32_bf16 v[196:199], v[68:71], v[56:59], v[196:199]
    s_mul_i32 s38, s38, 224
    s_and_b32 s39, s2, 15
    s_lshl_b32 s39, s39, 7
    v_lshrrev_b32 v25, 3, v1
    s_lshl_b32 s36, s28, 5
    v_mfma_f32_16x16x32_bf16 v[228:231], v[68:71], v[60:63], v[228:231]
    s_add_u32 s36, s36, s38
    v_add_u32 v25, s36, v25
    v_mul_u32_u24 v25, 2048, v25
    v_add_u32 v25, s39, v25
    s_waitcnt lgkmcnt(5)
    v_mfma_f32_16x16x32_bf16 v[200:203], v[72:75], v[56:59], v[200:203]
    v_bfe_u32 v26, v1, 4, 1
    v_lshlrev_b32 v26, 1, v26
    v_and_b32 v27, 7, v1
    v_xor_b32 v26, v26, v27
    v_mfma_f32_16x16x32_bf16 v[232:235], v[72:75], v[60:63], v[232:235]
    v_mfma_f32_16x16x32_bf16 v[28:31], v[36:39], v[56:59], v[28:31]
    v_lshl_add_u32 v24, v26, 4, v25
    v_xor_b32 v26, 4, v26
    v_lshl_add_u32 v25, v26, 4, v25
    v_add_u32 v25, 15360, v25
    v_add_u32 v26, 30720, v24
    s_waitcnt lgkmcnt(4)
    v_mfma_f32_16x16x32_bf16 v[204:207], v[76:79], v[56:59], v[204:207]
    v_add_u32 v27, 30720, v25
    s_lshl_b32 s36, s28, 12
    s_add_u32 s36, s36, 131072
    s_cmp_lt_u32 s28, 7
    s_cselect_b32 m0, s36, 0x30000
    s_cselect_b32 s6, 7340032, 0
    v_mfma_f32_16x16x32_bf16 v[236:239], v[76:79], v[60:63], v[236:239]
    buffer_load_dwordx4 v24, s[4:7], 0 offen offset:0 lds
    buffer_load_dwordx4 v25, s[4:7], 0 offen offset:1024 lds
    buffer_load_dwordx4 v26, s[4:7], 0 offen offset:2048 lds
    buffer_load_dwordx4 v27, s[4:7], 0 offen offset:3072 lds
    s_waitcnt lgkmcnt(3)
    v_mfma_f32_16x16x32_bf16 v[208:211], v[80:83], v[56:59], v[208:211]
    v_mfma_f32_16x16x32_bf16 v[240:243], v[80:83], v[60:63], v[240:243]
    ds_write_b128 v5, v[224:227] offset:0
    s_waitcnt lgkmcnt(3)
    v_mfma_f32_16x16x32_bf16 v[212:215], v[84:87], v[56:59], v[212:215]
    v_mfma_f32_16x16x32_bf16 v[244:247], v[84:87], v[60:63], v[244:247]
    ds_write_b128 v5, v[228:231] offset:1024
    s_waitcnt lgkmcnt(3)
    v_mfma_f32_16x16x32_bf16 v[216:219], v[88:91], v[56:59], v[216:219]
    v_mfma_f32_16x16x32_bf16 v[248:251], v[88:91], v[60:63], v[248:251]
    v_mfma_f32_16x16x32_bf16 v[32:35], v[36:39], v[60:63], v[32:35]
    ds_write_b128 v5, v[232:235] offset:2048
    s_waitcnt lgkmcnt(3)
    v_mfma_f32_16x16x32_bf16 v[220:223], v[92:95], v[56:59], v[220:223]
    v_mfma_f32_16x16x32_bf16 v[252:255], v[92:95], v[60:63], v[252:255]
    ds_write_b128 v5, v[236:239] offset:3072
    ds_write_b128 v5, v[240:243] offset:4096
    ds_write_b128 v5, v[244:247] offset:5120
    v_xor_b32 v106, 32768, v5
    s_lshl_b32 s37, s28, 8
    s_add_u32 s37, s37, 159744
    v_lshl_add_u32 v107, v1, 2, s37
    v_xor_b32 v108, 1024, v107
    ds_write_b128 v5, v[248:251] offset:6144
    ds_write_b128 v5, v[252:255] offset:7168
    ds_write_b32 v107, v32
    s_mov_b32 s36, 0x5d800000
    v_cmp_nge_f32 vcc, s36, v28
    s_nop 0
    s_or_b64 s[52:53], s[52:53], vcc
    v_cmp_nge_f32 vcc, s36, v32
    s_nop 0
    s_or_b64 s[52:53], s[52:53], vcc
    s_or_b32 s36, s52, s53
    v_mov_b32 v110, s36
    s_lshl_b32 s37, s28, 2
    s_add_u32 s37, s37, 161792
    v_mov_b32 v111, s37
    ds_write_b32 v111, v110
    v_mov_b32 v112, 161856
    v_mov_b32 v114, s56
    v_mov_b32 v115, s57
    v_mov_b32 v116, s58
    v_mov_b32 v117, s59
    ds_write_b128 v112, v[114:117]
    v_and_b32 v111, 7, v1
    v_lshlrev_b32 v111, 2, v111
    v_add_u32 v111, 161792, v111
    v_mov_b32 v113, v7
    s_sub_u32 s36, 15, s30
    s_lshl_b32 s38, s36, 3
    s_and_b32 s37, s28, 3
    s_lshl_b32 s37, s37, 1
    s_add_u32 s38, s38, s37
    s_lshl_b32 s38, s38, 17
    s_lshl_b32 s37, s29, 12
    s_add_u32 s38, s38, s37
    s_waitcnt vmcnt(4)
    v_readfirstlane_b32 s36, v11
    s_nop 0
    s_cmp_lt_u32 s36, 28
    s_cbranch_scc1 L_recurrent_scan__compressed_kv_cla__moe_arch_mod__prompt_kernel_rare_96
L_recurrent_scan__compressed_kv_cla__moe_arch_mod__prompt_kernel_back_97:
    s_lshr_b32 s36, s2, 4
    s_mul_i32 s36, s36, 7
    s_min_u32 s37, s28, 6
    s_add_u32 s36, s36, s37
    s_lshl_b32 s36, s36, 11
    s_add_u32 s36, s36, 58720256
    v_and_b32 v11, 15, v1
    v_lshlrev_b32 v11, 4, v11
    v_lshrrev_b32 v12, 4, v1
    v_lshl_add_u32 v11, v12, 9, v11
    buffer_load_dwordx4 v[96:99], v11, s[24:27], s36 offen offset:0 sc1
    buffer_load_dwordx4 v[100:103], v11, s[24:27], s36 offen offset:256 sc1
    s_waitcnt lgkmcnt(0)
    s_barrier
    ds_read_b32 v110, v111
    ds_read_b32 v109, v108
    ds_read_b128 v[64:67], v106 offset:0
    ds_read_b128 v[68:71], v106 offset:1024
    ds_read_b128 v[72:75], v106 offset:2048
    ds_read_b128 v[76:79], v106 offset:3072
    ds_read_b128 v[80:83], v106 offset:4096
    ds_read_b128 v[84:87], v106 offset:5120
    ds_read_b128 v[88:91], v106 offset:6144
    ds_read_b128 v[92:95], v106 offset:7168
    s_waitcnt lgkmcnt(8)
    v_add_f32 v109, v109, v28
    v_cmp_ne_u32 s[52:53], 0, v110
    v_rcp_f32 v109, v109
    s_nop 0
    v_mov_b32 v108, v109
    s_waitcnt lgkmcnt(6)
    v_pk_add_f32 v[192:193], v[192:193], v[64:65]
    v_pk_add_f32 v[194:195], v[194:195], v[66:67]
    v_pk_add_f32 v[196:197], v[196:197], v[68:69]
    v_pk_add_f32 v[198:199], v[198:199], v[70:71]
    v_pk_mul_f32 v[192:193], v[192:193], v[108:109]
    v_pk_mul_f32 v[194:195], v[194:195], v[108:109]
    v_pk_mul_f32 v[196:197], v[196:197], v[108:109]
    v_pk_mul_f32 v[198:199], v[198:199], v[108:109]
    v_cvt_pk_bf16_f32 v48, v192, v193
    v_cvt_pk_bf16_f32 v49, v194, v195
    v_cvt_pk_bf16_f32 v50, v196, v197
    v_cvt_pk_bf16_f32 v51, v198, v199
    buffer_store_dwordx4 v[48:51], v113, s[16:19], s38 offen offset:0 sc1
    s_waitcnt lgkmcnt(4)
    v_pk_add_f32 v[200:201], v[200:201], v[72:73]
    v_pk_add_f32 v[202:203], v[202:203], v[74:75]
    v_pk_add_f32 v[204:205], v[204:205], v[76:77]
    v_pk_add_f32 v[206:207], v[206:207], v[78:79]
    v_pk_mul_f32 v[200:201], v[200:201], v[108:109]
    v_pk_mul_f32 v[202:203], v[202:203], v[108:109]
    v_pk_mul_f32 v[204:205], v[204:205], v[108:109]
    v_pk_mul_f32 v[206:207], v[206:207], v[108:109]
    v_cvt_pk_bf16_f32 v52, v200, v201
    v_cvt_pk_bf16_f32 v53, v202, v203
    v_cvt_pk_bf16_f32 v54, v204, v205
    v_cvt_pk_bf16_f32 v55, v206, v207
    buffer_store_dwordx4 v[52:55], v113, s[16:19], s38 offen offset:1024 sc1
    s_waitcnt lgkmcnt(2)
    v_pk_add_f32 v[208:209], v[208:209], v[80:81]
    v_pk_add_f32 v[210:211], v[210:211], v[82:83]
    v_pk_add_f32 v[212:213], v[212:213], v[84:85]
    v_pk_add_f32 v[214:215], v[214:215], v[86:87]
    v_pk_mul_f32 v[208:209], v[208:209], v[108:109]
    v_pk_mul_f32 v[210:211], v[210:211], v[108:109]
    v_pk_mul_f32 v[212:213], v[212:213], v[108:109]
    v_pk_mul_f32 v[214:215], v[214:215], v[108:109]
    v_cvt_pk_bf16_f32 v56, v208, v209
    v_cvt_pk_bf16_f32 v57, v210, v211
    v_cvt_pk_bf16_f32 v58, v212, v213
    v_cvt_pk_bf16_f32 v59, v214, v215
    buffer_store_dwordx4 v[56:59], v113, s[16:19], s38 offen offset:2048 sc1
    s_waitcnt lgkmcnt(0)
    v_pk_add_f32 v[216:217], v[216:217], v[88:89]
    v_pk_add_f32 v[218:219], v[218:219], v[90:91]
    v_pk_add_f32 v[220:221], v[220:221], v[92:93]
    v_pk_add_f32 v[222:223], v[222:223], v[94:95]
    v_pk_mul_f32 v[216:217], v[216:217], v[108:109]
    v_pk_mul_f32 v[218:219], v[218:219], v[108:109]
    v_pk_mul_f32 v[220:221], v[220:221], v[108:109]
    v_pk_mul_f32 v[222:223], v[222:223], v[108:109]
    v_cvt_pk_bf16_f32 v60, v216, v217
    v_cvt_pk_bf16_f32 v61, v218, v219
    v_cvt_pk_bf16_f32 v62, v220, v221
    v_cvt_pk_bf16_f32 v63, v222, v223
    buffer_store_dwordx4 v[60:63], v113, s[16:19], s38 offen offset:3072 sc1
    s_cmp_eq_u64 s[52:53], 0
    s_cbranch_scc1 L_p3_done
    s_waitcnt vmcnt(0)
    v_mov_b32 v112, v96
    v_mov_b32 v113, v97
    v_mov_b32 v114, v98
    v_mov_b32 v115, v99
    v_mov_b32 v116, v100
    v_mov_b32 v117, v101
    v_mov_b32 v118, v102
    v_mov_b32 v119, v103
    v_mov_b32 v192, 0
    v_mov_b32 v193, 0
    v_mov_b32 v194, 0
    v_mov_b32 v195, 0
    v_mov_b32 v196, 0
    v_mov_b32 v197, 0
    v_mov_b32 v198, 0
    v_mov_b32 v199, 0
    v_mov_b32 v200, 0
    v_mov_b32 v201, 0
    v_mov_b32 v202, 0
    v_mov_b32 v203, 0
    v_mov_b32 v204, 0
    v_mov_b32 v205, 0
    v_mov_b32 v206, 0
    v_mov_b32 v207, 0
    v_mov_b32 v208, 0
    v_mov_b32 v209, 0
    v_mov_b32 v210, 0
    v_mov_b32 v211, 0
    v_mov_b32 v212, 0
    v_mov_b32 v213, 0
    v_mov_b32 v214, 0
    v_mov_b32 v215, 0
    v_mov_b32 v216, 0
    v_mov_b32 v217, 0
    v_mov_b32 v218, 0
    v_mov_b32 v219, 0
    v_mov_b32 v220, 0
    v_mov_b32 v221, 0
    v_mov_b32 v222, 0
    v_mov_b32 v223, 0
    v_mov_b32 v224, 0
    v_mov_b32 v225, 0
    v_mov_b32 v226, 0
    v_mov_b32 v227, 0
    v_mov_b32 v228, 0
    v_mov_b32 v229, 0
    v_mov_b32 v230, 0
    v_mov_b32 v231, 0
    v_mov_b32 v232, 0
    v_mov_b32 v233, 0
    v_mov_b32 v234, 0
    v_mov_b32 v235, 0
    v_mov_b32 v236, 0
    v_mov_b32 v237, 0
    v_mov_b32 v238, 0
    v_mov_b32 v239, 0
    v_mov_b32 v240, 0
    v_mov_b32 v241, 0
    v_mov_b32 v242, 0
    v_mov_b32 v243, 0
    v_mov_b32 v244, 0
    v_mov_b32 v245, 0
    v_mov_b32 v246, 0
    v_mov_b32 v247, 0
    v_mov_b32 v248, 0
    v_mov_b32 v249, 0
    v_mov_b32 v250, 0
    v_mov_b32 v251, 0
    v_mov_b32 v252, 0
    v_mov_b32 v253, 0
    v_mov_b32 v254, 0
    v_mov_b32 v255, 0
    v_mov_b32 v28, 0
    v_mov_b32 v40, 4048155338
    v_mov_b32 v32, 0
    v_mov_b32 v41, 4048155338
    s_lshl_b32 s43, s28, 12
    v_add_u32 v4, s43, v7
    s_mov_b32 s46, s45
    s_sub_u32 s40, 16, s30
    s_sub_u32 s39, 15, s30
    s_lshl_b32 s37, s39, 7
    s_and_b32 s36, s28, 3
    s_lshl_b32 s36, s36, 5
    s_add_u32 s36, s36, s37
    s_sub_u32 s50, 0, s36
L_recurrent_scan__compressed_kv_cla__moe_arch_mod__prompt_kernel_stile_98:
    s_waitcnt vmcnt(0) lgkmcnt(0)
    s_barrier
    s_mov_b32 m0, s43
    s_add_u32 s47, s46, 32768
    buffer_load_dwordx4 v4, s[12:15], s46 offen offset:0 sc1 lds
    buffer_load_dwordx4 v4, s[12:15], s46 offen offset:1024 sc1 lds
    buffer_load_dwordx4 v4, s[12:15], s46 offen offset:2048 sc1 lds
    buffer_load_dwordx4 v4, s[12:15], s46 offen offset:3072 sc1 lds
    s_add_u32 m0, s43, 32768
    s_add_u32 s46, s46, 65536
    buffer_load_dwordx4 v4, s[12:15], s47 offen offset:0 sc1 lds
    buffer_load_dwordx4 v4, s[12:15], s47 offen offset:1024 sc1 lds
    buffer_load_dwordx4 v4, s[12:15], s47 offen offset:2048 sc1 lds
    buffer_load_dwordx4 v4, s[12:15], s47 offen offset:3072 sc1 lds
    v_mov_b32 v2, v7
    s_mov_b32 s41, 4
    s_waitcnt vmcnt(0)
    s_barrier
L_recurrent_scan__compressed_kv_cla__moe_arch_mod__prompt_kernel_sunit_99:
    s_cmp_gt_i32 s50, 0
    s_cbranch_scc1 L_recurrent_scan__compressed_kv_cla__moe_arch_mod__prompt_kernel_snext_100
    ds_read_b128 v[64:67], v2 offset:0
    ds_read_b128 v[68:71], v2 offset:1024
    ds_read_b128 v[72:75], v2 offset:2048
    ds_read_b128 v[76:79], v2 offset:3072
    ds_read_b128 v[80:83], v2 offset:4096
    ds_read_b128 v[84:87], v2 offset:5120
    ds_read_b128 v[88:91], v2 offset:6144
    ds_read_b128 v[92:95], v2 offset:7168
    s_waitcnt lgkmcnt(0)
    v_mfma_f32_16x16x32_bf16 v[96:99], v[64:67], v[128:131], 0
    v_mfma_f32_16x16x32_bf16 v[104:107], v[64:67], v[144:147], 0
    v_mfma_f32_16x16x32_bf16 v[96:99], v[68:71], v[132:135], v[96:99]
    v_mfma_f32_16x16x32_bf16 v[104:107], v[68:71], v[148:151], v[104:107]
    v_mfma_f32_16x16x32_bf16 v[96:99], v[72:75], v[136:139], v[96:99]
    v_mfma_f32_16x16x32_bf16 v[104:107], v[72:75], v[152:155], v[104:107]
    v_mfma_f32_16x16x32_bf16 v[96:99], v[76:79], v[140:143], v[96:99]
    v_mfma_f32_16x16x32_bf16 v[104:107], v[76:79], v[156:159], v[104:107]
    v_mfma_f32_16x16x32_bf16 v[100:103], v[80:83], v[128:131], 0
    v_mfma_f32_16x16x32_bf16 v[108:111], v[80:83], v[144:147], 0
    v_mfma_f32_16x16x32_bf16 v[100:103], v[84:87], v[132:135], v[100:103]
    v_mfma_f32_16x16x32_bf16 v[108:111], v[84:87], v[148:151], v[108:111]
    v_mfma_f32_16x16x32_bf16 v[100:103], v[88:91], v[136:139], v[100:103]
    v_mfma_f32_16x16x32_bf16 v[108:111], v[88:91], v[152:155], v[108:111]
    v_mfma_f32_16x16x32_bf16 v[100:103], v[92:95], v[140:143], v[100:103]
    v_mfma_f32_16x16x32_bf16 v[108:111], v[92:95], v[156:159], v[108:111]
    ds_read_b128 v[64:67], v2 offset:32768
    ds_read_b128 v[68:71], v2 offset:33792
    ds_read_b128 v[72:75], v2 offset:34816
    ds_read_b128 v[76:79], v2 offset:35840
    ds_read_b128 v[80:83], v2 offset:36864
    ds_read_b128 v[84:87], v2 offset:37888
    ds_read_b128 v[88:91], v2 offset:38912
    ds_read_b128 v[92:95], v2 offset:39936
    s_nop 1
    s_cmp_lt_i32 s50, 0
    s_cbranch_scc0 L_recurrent_scan__compressed_kv_cla__moe_arch_mod__prompt_kernel_rare_103
L_recurrent_scan__compressed_kv_cla__moe_arch_mod__prompt_kernel_back_104:
    v_max3_f32 v22, v96, v97, v98
    v_max3_f32 v22, v22, v99, v100
    v_max3_f32 v22, v22, v101, v102
    v_max3_f32 v22, v22, v103, v40
    v_mov_b32 v24, v22
    s_nop 1
    v_permlane16_swap_b32 v22, v24
    s_nop 1
    v_max_f32 v22, v22, v24
    v_mov_b32 v24, v22
    s_nop 1
    v_permlane32_swap_b32 v22, v24
    s_nop 1
    v_max_f32 v22, v22, v24
    v_sub_f32 v25, v40, v22
    v_exp_f32 v25, v25
    v_mov_b32 v40, v22
    v_mul_f32 v28, v28, v25
    v_mul_f32 v192, v192, v25
    v_mul_f32 v193, v193, v25
    v_mul_f32 v194, v194, v25
    v_mul_f32 v195, v195, v25
    v_mul_f32 v196, v196, v25
    v_mul_f32 v197, v197, v25
    v_mul_f32 v198, v198, v25
    v_mul_f32 v199, v199, v25
    v_mul_f32 v200, v200, v25
    v_mul_f32 v201, v201, v25
    v_mul_f32 v202, v202, v25
    v_mul_f32 v203, v203, v25
    v_mul_f32 v204, v204, v25
    v_mul_f32 v205, v205, v25
    v_mul_f32 v206, v206, v25
    v_mul_f32 v207, v207, v25
    v_mul_f32 v208, v208, v25
    v_mul_f32 v209, v209, v25
    v_mul_f32 v210, v210, v25
    v_mul_f32 v211, v211, v25
    v_mul_f32 v212, v212, v25
    v_mul_f32 v213, v213, v25
    v_mul_f32 v214, v214, v25
    v_mul_f32 v215, v215, v25
    v_mul_f32 v216, v216, v25
    v_mul_f32 v217, v217, v25
    v_mul_f32 v218, v218, v25
    v_mul_f32 v219, v219, v25
    v_mul_f32 v220, v220, v25
    v_mul_f32 v221, v221, v25
    v_mul_f32 v222, v222, v25
    v_mul_f32 v223, v223, v25
    v_sub_f32 v96, v96, v22
    v_sub_f32 v97, v97, v22
    v_sub_f32 v98, v98, v22
    v_sub_f32 v99, v99, v22
    v_sub_f32 v100, v100, v22
    v_sub_f32 v101, v101, v22
    v_sub_f32 v102, v102, v22
    v_sub_f32 v103, v103, v22
    v_max3_f32 v23, v104, v105, v106
    v_max3_f32 v23, v23, v107, v108
    v_max3_f32 v23, v23, v109, v110
    v_max3_f32 v23, v23, v111, v41
    v_mov_b32 v24, v23
    s_nop 1
    v_permlane16_swap_b32 v23, v24
    s_nop 1
    v_max_f32 v23, v23, v24
    v_mov_b32 v24, v23
    s_nop 1
    v_permlane32_swap_b32 v23, v24
    s_nop 1
    v_max_f32 v23, v23, v24
    v_sub_f32 v25, v41, v23
    v_exp_f32 v25, v25
    v_mov_b32 v41, v23
    v_mul_f32 v32, v32, v25
    v_mul_f32 v224, v224, v25
    v_mul_f32 v225, v225, v25
    v_mul_f32 v226, v226, v25
    v_mul_f32 v227, v227, v25
    v_mul_f32 v228, v228, v25
    v_mul_f32 v229, v229, v25
    v_mul_f32 v230, v230, v25
    v_mul_f32 v231, v231, v25
    v_mul_f32 v232, v232, v25
    v_mul_f32 v233, v233, v25
    v_mul_f32 v234, v234, v25
    v_mul_f32 v235, v235, v25
    v_mul_f32 v236, v236, v25
    v_mul_f32 v237, v237, v25
    v_mul_f32 v238, v238, v25
    v_mul_f32 v239, v239, v25
    v_mul_f32 v240, v240, v25
    v_mul_f32 v241, v241, v25
    v_mul_f32 v242, v242, v25
    v_mul_f32 v243, v243, v25
    v_mul_f32 v244, v244, v25
    v_mul_f32 v245, v245, v25
    v_mul_f32 v246, v246, v25
    v_mul_f32 v247, v247, v25
    v_mul_f32 v248, v248, v25
    v_mul_f32 v249, v249, v25
    v_mul_f32 v250, v250, v25
    v_mul_f32 v251, v251, v25
    v_mul_f32 v252, v252, v25
    v_mul_f32 v253, v253, v25
    v_mul_f32 v254, v254, v25
    v_mul_f32 v255, v255, v25
    v_sub_f32 v104, v104, v23
    v_sub_f32 v105, v105, v23
    v_sub_f32 v106, v106, v23
    v_sub_f32 v107, v107, v23
    v_sub_f32 v108, v108, v23
    v_sub_f32 v109, v109, v23
    v_sub_f32 v110, v110, v23
    v_sub_f32 v111, v111, v23
    v_exp_f32 v96, v96
    v_exp_f32 v97, v97
    v_exp_f32 v98, v98
    v_exp_f32 v99, v99
    v_exp_f32 v104, v104
    v_exp_f32 v105, v105
    v_exp_f32 v106, v106
    v_exp_f32 v107, v107
    v_exp_f32 v100, v100
    v_exp_f32 v101, v101
    v_exp_f32 v102, v102
    v_exp_f32 v103, v103
    v_exp_f32 v108, v108
    v_exp_f32 v109, v109
    v_exp_f32 v110, v110
    v_exp_f32 v111, v111
    v_add_f32 v28, v28, v96
    v_add_f32 v28, v28, v97
    v_cvt_pk_bf16_f32 v48, v96, v97
    v_add_f32 v28, v28, v98
    v_add_f32 v28, v28, v99
    v_cvt_pk_bf16_f32 v49, v98, v99
    v_add_f32 v32, v32, v104
    v_add_f32 v32, v32, v105
    v_cvt_pk_bf16_f32 v52, v104, v105
    v_add_f32 v32, v32, v106
    v_add_f32 v32, v32, v107
    v_cvt_pk_bf16_f32 v53, v106, v107
    v_add_f32 v28, v28, v100
    v_add_f32 v28, v28, v101
    v_cvt_pk_bf16_f32 v50, v100, v101
    v_add_f32 v28, v28, v102
    v_add_f32 v28, v28, v103
    v_cvt_pk_bf16_f32 v51, v102, v103
    v_add_f32 v32, v32, v108
    v_add_f32 v32, v32, v109
    v_cvt_pk_bf16_f32 v54, v108, v109
    v_add_f32 v32, v32, v110
    v_add_f32 v32, v32, v111
    v_cvt_pk_bf16_f32 v55, v110, v111
    s_waitcnt lgkmcnt(0)
    s_nop 0
    v_mfma_f32_16x16x32_bf16 v[192:195], v[64:67], v[48:51], v[192:195]
    v_mfma_f32_16x16x32_bf16 v[224:227], v[64:67], v[52:55], v[224:227]
    v_mfma_f32_16x16x32_bf16 v[196:199], v[68:71], v[48:51], v[196:199]
    v_mfma_f32_16x16x32_bf16 v[228:231], v[68:71], v[52:55], v[228:231]
    v_mfma_f32_16x16x32_bf16 v[200:203], v[72:75], v[48:51], v[200:203]
    v_mfma_f32_16x16x32_bf16 v[232:235], v[72:75], v[52:55], v[232:235]
    v_mfma_f32_16x16x32_bf16 v[204:207], v[76:79], v[48:51], v[204:207]
    v_mfma_f32_16x16x32_bf16 v[236:239], v[76:79], v[52:55], v[236:239]
    v_mfma_f32_16x16x32_bf16 v[208:211], v[80:83], v[48:51], v[208:211]
    v_mfma_f32_16x16x32_bf16 v[240:243], v[80:83], v[52:55], v[240:243]
    v_mfma_f32_16x16x32_bf16 v[212:215], v[84:87], v[48:51], v[212:215]
    v_mfma_f32_16x16x32_bf16 v[244:247], v[84:87], v[52:55], v[244:247]
    v_mfma_f32_16x16x32_bf16 v[216:219], v[88:91], v[48:51], v[216:219]
    v_mfma_f32_16x16x32_bf16 v[248:251], v[88:91], v[52:55], v[248:251]
    v_mfma_f32_16x16x32_bf16 v[220:223], v[92:95], v[48:51], v[220:223]
    v_mfma_f32_16x16x32_bf16 v[252:255], v[92:95], v[52:55], v[252:255]
L_recurrent_scan__compressed_kv_cla__moe_arch_mod__prompt_kernel_snext_100:
    v_add_u32 v2, 8192, v2
    s_add_u32 s50, s50, 32
    s_sub_u32 s41, s41, 1
    s_cmp_lg_u32 s41, 0
    s_cbranch_scc1 L_recurrent_scan__compressed_kv_cla__moe_arch_mod__prompt_kernel_sunit_99
    s_sub_u32 s40, s40, 1
    s_cmp_lg_u32 s40, 0
    s_cbranch_scc1 L_recurrent_scan__compressed_kv_cla__moe_arch_mod__prompt_kernel_stile_98
    v_mov_b32 v20, v28
    s_nop 1
    v_permlane16_swap_b32 v28, v20
    s_nop 1
    v_add_f32 v28, v28, v20
    v_mov_b32 v20, v28
    s_nop 1
    v_permlane32_swap_b32 v28, v20
    s_nop 1
    v_add_f32 v28, v28, v20
    v_mov_b32 v20, v32
    s_nop 1
    v_permlane16_swap_b32 v32, v20
    s_nop 1
    v_add_f32 v32, v32, v20
    v_mov_b32 v20, v32
    s_nop 1
    v_permlane32_swap_b32 v32, v20
    s_nop 1
    v_add_f32 v32, v32, v20
    s_mov_b32 s36, 0x5d800000
    v_cmp_nge_f32 vcc, s36, v28
    s_nop 0
    s_or_b64 s[52:53], s[52:53], vcc
    v_cmp_nge_f32 vcc, s36, v32
    s_nop 0
    s_or_b64 s[52:53], s[52:53], vcc
    v_rcp_f32 v20, v28
    v_rcp_f32 v22, v32
    s_lshl_b32 s38, s39, 3
    s_and_b32 s37, s28, 3
    s_lshl_b32 s37, s37, 1
    s_add_u32 s38, s38, s37
    s_lshl_b32 s38, s38, 17
    s_lshl_b32 s37, s29, 12
    s_add_u32 s38, s38, s37
    v_mov_b32 v21, v20
    v_mov_b32 v23, v22
    v_mov_b32 v24, v7
    v_pk_mul_f32 v[192:193], v[192:193], v[20:21]
    v_pk_mul_f32 v[194:195], v[194:195], v[20:21]
    v_pk_mul_f32 v[196:197], v[196:197], v[20:21]
    v_pk_mul_f32 v[198:199], v[198:199], v[20:21]
    v_cvt_pk_bf16_f32 v192, v192, v193
    v_cvt_pk_bf16_f32 v193, v194, v195
    v_cvt_pk_bf16_f32 v194, v196, v197
    v_cvt_pk_bf16_f32 v195, v198, v199
    buffer_store_dwordx4 v[192:195], v24, s[16:19], s38 offen offset:0 sc1
    v_pk_mul_f32 v[200:201], v[200:201], v[20:21]
    v_pk_mul_f32 v[202:203], v[202:203], v[20:21]
    v_pk_mul_f32 v[204:205], v[204:205], v[20:21]
    v_pk_mul_f32 v[206:207], v[206:207], v[20:21]
    v_cvt_pk_bf16_f32 v200, v200, v201
    v_cvt_pk_bf16_f32 v201, v202, v203
    v_cvt_pk_bf16_f32 v202, v204, v205
    v_cvt_pk_bf16_f32 v203, v206, v207
    buffer_store_dwordx4 v[200:203], v24, s[16:19], s38 offen offset:1024 sc1
    v_pk_mul_f32 v[208:209], v[208:209], v[20:21]
    v_pk_mul_f32 v[210:211], v[210:211], v[20:21]
    v_pk_mul_f32 v[212:213], v[212:213], v[20:21]
    v_pk_mul_f32 v[214:215], v[214:215], v[20:21]
    v_cvt_pk_bf16_f32 v208, v208, v209
    v_cvt_pk_bf16_f32 v209, v210, v211
    v_cvt_pk_bf16_f32 v210, v212, v213
    v_cvt_pk_bf16_f32 v211, v214, v215
    buffer_store_dwordx4 v[208:211], v24, s[16:19], s38 offen offset:2048 sc1
    v_pk_mul_f32 v[216:217], v[216:217], v[20:21]
    v_pk_mul_f32 v[218:219], v[218:219], v[20:21]
    v_pk_mul_f32 v[220:221], v[220:221], v[20:21]
    v_pk_mul_f32 v[222:223], v[222:223], v[20:21]
    v_cvt_pk_bf16_f32 v216, v216, v217
    v_cvt_pk_bf16_f32 v217, v218, v219
    v_cvt_pk_bf16_f32 v218, v220, v221
    v_cvt_pk_bf16_f32 v219, v222, v223
    buffer_store_dwordx4 v[216:219], v24, s[16:19], s38 offen offset:3072 sc1
    s_add_u32 s38, s38, 131072
    v_pk_mul_f32 v[224:225], v[224:225], v[22:23]
    v_pk_mul_f32 v[226:227], v[226:227], v[22:23]
    v_pk_mul_f32 v[228:229], v[228:229], v[22:23]
    v_pk_mul_f32 v[230:231], v[230:231], v[22:23]
    v_cvt_pk_bf16_f32 v224, v224, v225
    v_cvt_pk_bf16_f32 v225, v226, v227
    v_cvt_pk_bf16_f32 v226, v228, v229
    v_cvt_pk_bf16_f32 v227, v230, v231
    buffer_store_dwordx4 v[224:227], v24, s[16:19], s38 offen offset:0 sc1
    v_pk_mul_f32 v[232:233], v[232:233], v[22:23]
    v_pk_mul_f32 v[234:235], v[234:235], v[22:23]
    v_pk_mul_f32 v[236:237], v[236:237], v[22:23]
    v_pk_mul_f32 v[238:239], v[238:239], v[22:23]
    v_cvt_pk_bf16_f32 v232, v232, v233
    v_cvt_pk_bf16_f32 v233, v234, v235
    v_cvt_pk_bf16_f32 v234, v236, v237
    v_cvt_pk_bf16_f32 v235, v238, v239
    buffer_store_dwordx4 v[232:235], v24, s[16:19], s38 offen offset:1024 sc1
    v_pk_mul_f32 v[240:241], v[240:241], v[22:23]
    v_pk_mul_f32 v[242:243], v[242:243], v[22:23]
    v_pk_mul_f32 v[244:245], v[244:245], v[22:23]
    v_pk_mul_f32 v[246:247], v[246:247], v[22:23]
    v_cvt_pk_bf16_f32 v240, v240, v241
    v_cvt_pk_bf16_f32 v241, v242, v243
    v_cvt_pk_bf16_f32 v242, v244, v245
    v_cvt_pk_bf16_f32 v243, v246, v247
    buffer_store_dwordx4 v[240:243], v24, s[16:19], s38 offen offset:2048 sc1
    v_pk_mul_f32 v[248:249], v[248:249], v[22:23]
    v_pk_mul_f32 v[250:251], v[250:251], v[22:23]
    v_pk_mul_f32 v[252:253], v[252:253], v[22:23]
    v_pk_mul_f32 v[254:255], v[254:255], v[22:23]
    v_cvt_pk_bf16_f32 v248, v248, v249
    v_cvt_pk_bf16_f32 v249, v250, v251
    v_cvt_pk_bf16_f32 v250, v252, v253
    v_cvt_pk_bf16_f32 v251, v254, v255
    buffer_store_dwordx4 v[248:251], v24, s[16:19], s38 offen offset:3072 sc1
    v_mov_b32 v96, v112
    v_mov_b32 v97, v113
    v_mov_b32 v98, v114
    v_mov_b32 v99, v115
    v_mov_b32 v100, v116
    v_mov_b32 v101, v117
    v_mov_b32 v102, v118
    v_mov_b32 v103, v119
    s_branch L_p3_done
L_recurrent_scan__compressed_kv_cla__moe_arch_mod__prompt_kernel_rare_1:
    s_mul_i32 s36, s28, 12288
    s_add_u32 s36, s36, 61865984
    v_lshl_add_u32 v16, v1, 4, s36
    v_mov_b32 v108, 0
    v_mov_b32 v109, 0
    v_mov_b32 v110, 0
    v_mov_b32 v111, 0
    global_store_dwordx4 v16, v[108:111], s[90:91] sc1
    v_add_u32 v16, 1024, v16
    global_store_dwordx4 v16, v[108:111], s[90:91] sc1
    v_add_u32 v16, 1024, v16
    global_store_dwordx4 v16, v[108:111], s[90:91] sc1
    v_add_u32 v16, 1024, v16
    global_store_dwordx4 v16, v[108:111], s[90:91] sc1
    v_add_u32 v16, 1024, v16
    global_store_dwordx4 v16, v[108:111], s[90:91] sc1
    v_add_u32 v16, 1024, v16
    global_store_dwordx4 v16, v[108:111], s[90:91] sc1
    v_add_u32 v16, 1024, v16
    global_store_dwordx4 v16, v[108:111], s[90:91] sc1
    v_add_u32 v16, 1024, v16
    global_store_dwordx4 v16, v[108:111], s[90:91] sc1
    v_add_u32 v16, 1024, v16
    global_store_dwordx4 v16, v[108:111], s[90:91] sc1
    v_add_u32 v16, 1024, v16
    global_store_dwordx4 v16, v[108:111], s[90:91] sc1
    v_add_u32 v16, 1024, v16
    global_store_dwordx4 v16, v[108:111], s[90:91] sc1
    v_add_u32 v16, 1024, v16
    global_store_dwordx4 v16, v[108:111], s[90:91] sc1
    v_add_u32 v16, 1024, v16
    s_branch L_recurrent_scan__compressed_kv_cla__moe_arch_mod__prompt_kernel_back_2
L_recurrent_scan__compressed_kv_cla__moe_arch_mod__prompt_kernel_rare_3:
    v_mov_b32 v19, 1
    s_mov_b64 exec, 1
    global_store_dword v118, v19, s[88:89] sc1
    s_mov_b64 exec, -1
    s_branch L_recurrent_scan__compressed_kv_cla__moe_arch_mod__prompt_kernel_back_4
L_recurrent_scan__compressed_kv_cla__moe_arch_mod__prompt_kernel_rare_5:
    v_lshrrev_b32 v3, 4, v1
    s_lshl_b32 s37, s28, 4
    v_add_u32 v19, s37, v3
    v_lshlrev_b32 v19, 13, v19
    s_lshl_b32 s37, s29, 8
    v_add_u32 v19, s37, v19
    v_and_b32 v16, 15, v1
    v_lshlrev_b32 v3, 1, v3
    v_xor_b32 v16, v16, v3
    v_lshl_add_u32 v2, v16, 4, v19
    v_add_u32 v3, 31744, v2
    v_xor_b32 v16, 8, v16
    v_lshl_add_u32 v4, v16, 4, v19
    v_add_u32 v4, 63488, v4
    v_add_u32 v5, 31744, v4
    s_mov_b32 s4, s96
    s_and_b32 s5, s97, 0xffff
    s_mov_b32 s6, 8388608
    s_mov_b32 s7, 0x20000
    s_mov_b32 s31, 0
    s_mov_b32 s40, 1048576
    s_mov_b64 s[8:9], s[4:5]
    s_mov_b32 s10, s6
    s_mov_b32 s32, 3145728
    v_mov_b32 v6, v2
    v_mov_b32 v7, v3
    v_mov_b32 v8, v4
    v_mov_b32 v9, v5
    s_branch L_recurrent_scan__compressed_kv_cla__moe_arch_mod__prompt_kernel_back_6
L_recurrent_scan__compressed_kv_cla__moe_arch_mod__prompt_kernel_w0_7:
    s_cmp_eq_u32 s35, 0
    s_cbranch_scc0 L_recurrent_scan__compressed_kv_cla__moe_arch_mod__prompt_kernel_swn_10
    v_and_b32 v16, 7, v1
    v_lshrrev_b32 v18, 3, v1
    v_mul_u32_u24 v19, 2064, v16
    v_lshl_add_u32 v19, v18, 4, v19
    s_lshl_b32 s36, s28, 8
    s_add_u32 s36, s36, 131072
    v_add_u32 v19, s36, v19
    ds_read_b128 v[120:123], v19
    ds_read_b128 v[124:127], v19 offset:128
    v_lshlrev_b32 v16, 4, v16
    v_lshl_add_u32 v16, v18, 8, v16
    s_lshr_b32 s36, s2, 1
    s_lshl_b32 s36, s36, 15
    s_and_b32 s37, s2, 1
    s_lshl_b32 s37, s37, 7
    s_add_u32 s36, s36, s37
    s_lshl_b32 s37, s28, 12
    s_add_u32 s36, s36, s37
    s_waitcnt lgkmcnt(0)
    buffer_store_dwordx4 v[120:123], v16, s[24:27], s36 offen sc1
    buffer_store_dwordx4 v[124:127], v16, s[24:27], s36 offen offset:2048 sc1
    s_waitcnt vmcnt(2)
    s_branch L_recurrent_scan__compressed_kv_cla__moe_arch_mod__prompt_kernel_swend_9
L_recurrent_scan__compressed_kv_cla__moe_arch_mod__prompt_kernel_swn_10:
    s_waitcnt vmcnt(2)
L_recurrent_scan__compressed_kv_cla__moe_arch_mod__prompt_kernel_swend_9:
    s_branch L_recurrent_scan__compressed_kv_cla__moe_arch_mod__prompt_kernel_w0b_8
L_recurrent_scan__compressed_kv_cla__moe_arch_mod__prompt_kernel_rare_11:
    s_add_u32 m0, s33, 131072
    s_mov_b32 s36, 2097152
    buffer_load_dwordx4 v2, s[4:7], s36 offen offset:0 lds
    buffer_load_dwordx4 v3, s[4:7], s36 offen offset:1024 lds
    buffer_load_dwordx4 v4, s[4:7], s36 offen offset:2048 lds
    buffer_load_dwordx4 v5, s[4:7], s36 offen offset:3072 lds
    s_branch L_recurrent_scan__compressed_kv_cla__moe_arch_mod__prompt_kernel_back_12
L_recurrent_scan__compressed_kv_cla__moe_arch_mod__prompt_kernel_rare_15:
    s_cmp_eq_u32 s35, 0
    s_cbranch_scc0 L_recurrent_scan__compressed_kv_cla__moe_arch_mod__prompt_kernel_swn_14
    global_load_dword v116, v118, s[88:89] sc1
    s_branch L_recurrent_scan__compressed_kv_cla__moe_arch_mod__prompt_kernel_swend_13
L_recurrent_scan__compressed_kv_cla__moe_arch_mod__prompt_kernel_swn_14:
    v_and_b32 v117, 15, v1
    v_add_u32 v117, 112, v117
    v_lshlrev_b32 v117, 7, v117
    global_load_dword v116, v117, s[90:91] sc1
L_recurrent_scan__compressed_kv_cla__moe_arch_mod__prompt_kernel_swend_13:
    s_branch L_recurrent_scan__compressed_kv_cla__moe_arch_mod__prompt_kernel_back_16
L_recurrent_scan__compressed_kv_cla__moe_arch_mod__prompt_kernel_rare_21:
    s_mov_b32 s61, 0x40000
L_recurrent_scan__compressed_kv_cla__moe_arch_mod__prompt_kernel_spin_19:
    s_sub_u32 s61, s61, 1
    s_cbranch_scc1 L_recurrent_scan__compressed_kv_cla__moe_arch_mod__prompt_kernel_spinx_20
    s_sleep 8
    global_load_dword v116, v118, s[88:89] sc1
    s_waitcnt vmcnt(0)
    v_readfirstlane_b32 s36, v116
    s_nop 0
    s_cmp_lt_u32 s36, 1
    s_cbranch_scc1 L_recurrent_scan__compressed_kv_cla__moe_arch_mod__prompt_kernel_spin_19
L_recurrent_scan__compressed_kv_cla__moe_arch_mod__prompt_kernel_spinx_20:
    s_branch L_recurrent_scan__compressed_kv_cla__moe_arch_mod__prompt_kernel_back_22
L_recurrent_scan__compressed_kv_cla__moe_arch_mod__prompt_kernel_w0_17:
    s_waitcnt vmcnt(0)
    s_cmp_eq_u32 s35, 0
    s_cbranch_scc0 L_recurrent_scan__compressed_kv_cla__moe_arch_mod__prompt_kernel_swn_26
    v_readfirstlane_b32 s36, v116
    s_nop 0
    s_cmp_lt_u32 s36, 1
    s_cbranch_scc1 L_recurrent_scan__compressed_kv_cla__moe_arch_mod__prompt_kernel_rare_21
L_recurrent_scan__compressed_kv_cla__moe_arch_mod__prompt_kernel_back_22:
    s_branch L_recurrent_scan__compressed_kv_cla__moe_arch_mod__prompt_kernel_swend_25
L_recurrent_scan__compressed_kv_cla__moe_arch_mod__prompt_kernel_swn_26:
    s_mov_b32 s61, 0x40000
L_recurrent_scan__compressed_kv_cla__moe_arch_mod__prompt_kernel_lspin_23:
    v_cmp_gt_u32 vcc, 16, v116
    s_nop 0
    s_cmp_eq_u64 vcc, 0
    s_cbranch_scc1 L_recurrent_scan__compressed_kv_cla__moe_arch_mod__prompt_kernel_lspinx_24
    s_sub_u32 s61, s61, 1
    s_cbranch_scc1 L_recurrent_scan__compressed_kv_cla__moe_arch_mod__prompt_kernel_lspinx_24
    s_sleep 8
    global_load_dword v116, v117, s[90:91] sc1
    s_waitcnt vmcnt(0)
    s_branch L_recurrent_scan__compressed_kv_cla__moe_arch_mod__prompt_kernel_lspin_23
L_recurrent_scan__compressed_kv_cla__moe_arch_mod__prompt_kernel_lspinx_24:
L_recurrent_scan__compressed_kv_cla__moe_arch_mod__prompt_kernel_swend_25:
    s_branch L_recurrent_scan__compressed_kv_cla__moe_arch_mod__prompt_kernel_w0b_18
L_recurrent_scan__compressed_kv_cla__moe_arch_mod__prompt_kernel_rare_27:
    s_lshr_b32 s36, s2, 4
    s_add_u32 s36, s36, 112
    s_lshl_b32 s36, s36, 7
    v_mov_b32 v16, s36
    v_mov_b32 v19, 1
    s_mov_b64 exec, 1
    global_atomic_add v16, v19, s[90:91]
    s_mov_b64 exec, -1
    s_nop 3
    s_branch L_recurrent_scan__compressed_kv_cla__moe_arch_mod__prompt_kernel_back_28
L_recurrent_scan__compressed_kv_cla__moe_arch_mod__prompt_kernel_w0_29:
    s_cmp_eq_u32 s35, 0
    s_cbranch_scc0 L_recurrent_scan__compressed_kv_cla__moe_arch_mod__prompt_kernel_swn_32
    s_waitcnt vmcnt(2)
    s_branch L_recurrent_scan__compressed_kv_cla__moe_arch_mod__prompt_kernel_swend_31
L_recurrent_scan__compressed_kv_cla__moe_arch_mod__prompt_kernel_swn_32:
    s_waitcnt vmcnt(2)
L_recurrent_scan__compressed_kv_cla__moe_arch_mod__prompt_kernel_swend_31:
    s_branch L_recurrent_scan__compressed_kv_cla__moe_arch_mod__prompt_kernel_w0b_30
L_recurrent_scan__compressed_kv_cla__moe_arch_mod__prompt_kernel_rare_33:
    s_add_u32 m0, s33, 131072
    s_mov_b32 s36, 2097152
    buffer_load_dwordx4 v2, s[4:7], s36 offen offset:0 lds
    buffer_load_dwordx4 v3, s[4:7], s36 offen offset:1024 lds
    buffer_load_dwordx4 v4, s[4:7], s36 offen offset:2048 lds
    buffer_load_dwordx4 v5, s[4:7], s36 offen offset:3072 lds
    s_branch L_recurrent_scan__compressed_kv_cla__moe_arch_mod__prompt_kernel_back_34
L_recurrent_scan__compressed_kv_cla__moe_arch_mod__prompt_kernel_rare_36:
    v_and_b32 v16, 7, v1
    v_lshrrev_b32 v18, 3, v1
    v_mul_u32_u24 v19, 2064, v16
    v_lshl_add_u32 v19, v18, 4, v19
    s_lshl_b32 s36, s28, 8
    s_add_u32 s36, s36, 131072
    v_add_u32 v19, s36, v19
    ds_read_b128 v[120:123], v19
    ds_read_b128 v[124:127], v19 offset:128
    v_lshlrev_b32 v16, 4, v16
    v_lshl_add_u32 v16, v18, 8, v16
    s_lshr_b32 s36, s2, 1
    s_lshl_b32 s36, s36, 15
    s_and_b32 s37, s2, 1
    s_lshl_b32 s37, s37, 7
    s_add_u32 s36, s36, s37
    s_lshl_b32 s37, s28, 12
    s_add_u32 s36, s36, s37
    s_waitcnt lgkmcnt(0)
    buffer_store_dwordx4 v[120:123], v16, s[24:27], s36 offen sc1
    buffer_store_dwordx4 v[124:127], v16, s[24:27], s36 offen offset:2048 sc1
    s_cmp_eq_u32 s28, 7
    s_cbranch_scc0 L_recurrent_scan__compressed_kv_cla__moe_arch_mod__prompt_kernel_l7_35
    v_and_b32 v120, 7, v1
    v_lshlrev_b32 v120, 3, v120
    v_add_u32 v121, 147712, v120
    ds_read_b64 v[122:123], v121
    ds_read_b32 v124, v121 offset:64
    s_lshl_b32 s36, s2, 6
    s_add_u32 s36, s36, 4194304
    s_lshl_b32 s37, s2, 3
    s_add_u32 s37, s37, 4276224
    s_waitcnt lgkmcnt(0)
    v_mov_b32 v126, v124
    s_nop 1
    v_max_u32_dpp v126, v126, v126 quad_perm:[1,0,3,2] row_mask:0xf bank_mask:0xf
    s_nop 1
    v_max_u32_dpp v126, v126, v126 quad_perm:[2,3,0,1] row_mask:0xf bank_mask:0xf
    s_nop 1
    v_max_u32_dpp v126, v126, v126 row_half_mirror row_mask:0xf bank_mask:0xf
    v_cmp_eq_u32 vcc, v126, v124
    s_nop 1
    v_cndmask_b32 v127, v124, v118, vcc
    s_nop 1
    v_max_u32_dpp v127, v127, v127 quad_perm:[1,0,3,2] row_mask:0xf bank_mask:0xf
    s_nop 1
    v_max_u32_dpp v127, v127, v127 quad_perm:[2,3,0,1] row_mask:0xf bank_mask:0xf
    s_nop 1
    v_max_u32_dpp v127, v127, v127 row_half_mirror row_mask:0xf bank_mask:0xf
    s_mov_b64 exec, 0xff
    buffer_store_dwordx2 v[122:123], v120, s[24:27], s36 offen sc1
    s_mov_b64 exec, 1
    buffer_store_dwordx2 v[126:127], v120, s[24:27], s37 offen sc1
    s_mov_b64 exec, -1
    s_nop 3
L_recurrent_scan__compressed_kv_cla__moe_arch_mod__prompt_kernel_l7_35:
    s_branch L_recurrent_scan__compressed_kv_cla__moe_arch_mod__prompt_kernel_back_37
L_recurrent_scan__compressed_kv_cla__moe_arch_mod__prompt_kernel_rare_40:
    v_lshrrev_b32 v3, 4, v1
    s_lshl_b32 s37, s28, 4
    v_add_u32 v19, s37, v3
    v_lshlrev_b32 v19, 13, v19
    s_lshl_b32 s37, s29, 8
    v_add_u32 v19, s37, v19
    v_and_b32 v16, 15, v1
    v_lshlrev_b32 v3, 1, v3
    v_xor_b32 v16, v16, v3
    v_lshl_add_u32 v2, v16, 4, v19
    v_add_u32 v3, 31744, v2
    v_xor_b32 v16, 8, v16
    v_lshl_add_u32 v4, v16, 4, v19
    v_add_u32 v4, 63488, v4
    v_add_u32 v5, 31744, v4
    s_mov_b32 s4, s96
    s_and_b32 s5, s97, 0xffff
    s_mov_b32 s6, 8388608
    s_mov_b32 s7, 0x20000
    s_mov_b32 s31, 0
    s_mov_b32 s40, 1048576
    s_mov_b64 s[8:9], s[4:5]
    s_mov_b32 s10, s6
    s_mov_b32 s32, 3145728
    v_mov_b32 v6, v2
    v_mov_b32 v7, v3
    v_mov_b32 v8, v4
    v_mov_b32 v9, v5
    s_branch L_recurrent_scan__compressed_kv_cla__moe_arch_mod__prompt_kernel_back_41
L_recurrent_scan__compressed_kv_cla__moe_arch_mod__prompt_kernel_rare_44:
    s_mov_b32 s61, 0x40000
L_recurrent_scan__compressed_kv_cla__moe_arch_mod__prompt_kernel_spin_42:
    s_sub_u32 s61, s61, 1
    s_cbranch_scc1 L_recurrent_scan__compressed_kv_cla__moe_arch_mod__prompt_kernel_spinx_43
    s_sleep 8
    global_load_dword v56, v57, s[90:91] sc1
    s_waitcnt vmcnt(0)
    v_readfirstlane_b32 s36, v56
    s_nop 0
    s_cmp_lt_u32 s36, 1
    s_cbranch_scc1 L_recurrent_scan__compressed_kv_cla__moe_arch_mod__prompt_kernel_spin_42
L_recurrent_scan__compressed_kv_cla__moe_arch_mod__prompt_kernel_spinx_43:
    s_branch L_recurrent_scan__compressed_kv_cla__moe_arch_mod__prompt_kernel_back_45
L_recurrent_scan__compressed_kv_cla__moe_arch_mod__prompt_kernel_rare_46:
    s_branch L_recurrent_scan__compressed_kv_cla__moe_arch_mod__prompt_kernel_back_47
L_recurrent_scan__compressed_kv_cla__moe_arch_mod__prompt_kernel_rare_48:
    s_waitcnt vmcnt(7)
    v_readfirstlane_b32 s36, v56
    s_nop 0
    s_cmp_lt_u32 s36, 1
    s_cbranch_scc1 L_recurrent_scan__compressed_kv_cla__moe_arch_mod__prompt_kernel_rare_44
L_recurrent_scan__compressed_kv_cla__moe_arch_mod__prompt_kernel_back_45:
    s_branch L_recurrent_scan__compressed_kv_cla__moe_arch_mod__prompt_kernel_back_49
L_recurrent_scan__compressed_kv_cla__moe_arch_mod__prompt_kernel_rare_50:
    s_add_u32 s36, s29, 64
    s_lshl_b32 s36, s36, 7
    v_mov_b32 v62, s36
    v_mov_b32 v63, 1
    s_mov_b64 exec, 1
    global_atomic_add v62, v63, s[90:91]
    s_mov_b64 exec, -1
    s_nop 3
    s_branch L_recurrent_scan__compressed_kv_cla__moe_arch_mod__prompt_kernel_back_51
L_recurrent_scan__compressed_kv_cla__moe_arch_mod__prompt_kernel_rare_52:
    s_add_u32 s36, s29, 64
    s_lshl_b32 s36, s36, 7
    v_mov_b32 v57, s36
    global_load_dword v56, v57, s[90:91] sc1
    s_branch L_recurrent_scan__compressed_kv_cla__moe_arch_mod__prompt_kernel_back_53
L_recurrent_scan__compressed_kv_cla__moe_arch_mod__prompt_kernel_rare_54:
    buffer_store_dwordx4 v[160:163], v58, s[16:19], s48 offen sc1
    buffer_store_dwordx4 v[164:167], v59, s[16:19], s48 offen sc1
    buffer_store_dwordx4 v[168:171], v60, s[16:19], s48 offen sc1
    buffer_store_dwordx4 v[172:175], v61, s[16:19], s48 offen sc1
    buffer_store_dwordx4 v[176:179], v58, s[16:19], s49 offen sc1
    buffer_store_dwordx4 v[180:183], v59, s[16:19], s49 offen sc1
    buffer_store_dwordx4 v[184:187], v60, s[16:19], s49 offen sc1
    buffer_store_dwordx4 v[188:191], v61, s[16:19], s49 offen sc1
    s_branch L_recurrent_scan__compressed_kv_cla__moe_arch_mod__prompt_kernel_back_55
L_recurrent_scan__compressed_kv_cla__moe_arch_mod__prompt_kernel_rare_56:
    s_lshl_b32 s36, s29, 7
    v_mov_b32 v13, s36
    global_load_dword v14, v13, s[90:91] sc1
    s_branch L_recurrent_scan__compressed_kv_cla__moe_arch_mod__prompt_kernel_back_57
L_recurrent_scan__compressed_kv_cla__moe_arch_mod__prompt_kernel_rare_64:
    s_mov_b32 s41, 32768
    s_cmp_eq_u32 s40, 15
    s_cbranch_scc0 L_recurrent_scan__compressed_kv_cla__moe_arch_mod__prompt_kernel_r_58
    s_mov_b32 s41, 65536
    s_mov_b32 s49, 0x1ffff
    s_sub_u32 s36, 0, s50
    s_cmp_lt_i32 s36, 0
    s_cbranch_scc1 L_recurrent_scan__compressed_kv_cla__moe_arch_mod__prompt_kernel_nm_63
    v_mov_b32 v20, 4048155338
    s_cmp_gt_i32 s36, 0
    s_cbranch_scc1 L_recurrent_scan__compressed_kv_cla__moe_arch_mod__prompt_kernel_mf_61
    v_cmp_gt_i32 s[20:21], 0, v18
    v_cmp_gt_i32 s[22:23], 1, v18
    v_cmp_gt_i32 s[62:63], 2, v18
    v_cmp_gt_i32 vcc, 3, v18
    v_mov_b32 v100, v20
    v_mov_b32 v101, v20
    v_mov_b32 v102, v20
    v_mov_b32 v103, v20
    v_cndmask_b32 v96, v96, v20, s[20:21]
    v_cndmask_b32 v97, v97, v20, s[22:23]
    v_cndmask_b32 v98, v98, v20, s[62:63]
    v_cndmask_b32 v99, v99, v20, vcc
    v_cndmask_b32 v108, v108, v20, s[20:21]
    v_cndmask_b32 v109, v109, v20, s[22:23]
    v_cndmask_b32 v110, v110, v20, s[62:63]
    v_cndmask_b32 v111, v111, v20, vcc
    s_branch L_recurrent_scan__compressed_kv_cla__moe_arch_mod__prompt_kernel_me_62
L_recurrent_scan__compressed_kv_cla__moe_arch_mod__prompt_kernel_mf_61:
    v_mov_b32 v96, v20
    v_mov_b32 v97, v20
    v_mov_b32 v98, v20
    v_mov_b32 v99, v20
    v_mov_b32 v100, v20
    v_mov_b32 v101, v20
    v_mov_b32 v102, v20
    v_mov_b32 v103, v20
    v_mov_b32 v104, v20
    v_mov_b32 v105, v20
    v_mov_b32 v106, v20
    v_mov_b32 v107, v20
    v_mov_b32 v108, v20
    v_mov_b32 v109, v20
    v_mov_b32 v110, v20
    v_mov_b32 v111, v20
L_recurrent_scan__compressed_kv_cla__moe_arch_mod__prompt_kernel_me_62:
L_recurrent_scan__compressed_kv_cla__moe_arch_mod__prompt_kernel_nm_63:
L_recurrent_scan__compressed_kv_cla__moe_arch_mod__prompt_kernel_r_58:
    s_branch L_recurrent_scan__compressed_kv_cla__moe_arch_mod__prompt_kernel_back_65
L_recurrent_scan__compressed_kv_cla__moe_arch_mod__prompt_kernel_rare_74:
    s_mov_b32 s61, 0x40000
L_recurrent_scan__compressed_kv_cla__moe_arch_mod__prompt_kernel_spin_72:
    s_sub_u32 s61, s61, 1
    s_cbranch_scc1 L_recurrent_scan__compressed_kv_cla__moe_arch_mod__prompt_kernel_spinx_73
    s_sleep 8
    global_load_dword v14, v13, s[90:91] sc1
    s_waitcnt vmcnt(0)
    v_readfirstlane_b32 s36, v14
    s_nop 0
    s_cmp_lt_u32 s36, 7
    s_cbranch_scc1 L_recurrent_scan__compressed_kv_cla__moe_arch_mod__prompt_kernel_spin_72
L_recurrent_scan__compressed_kv_cla__moe_arch_mod__prompt_kernel_spinx_73:
    s_branch L_recurrent_scan__compressed_kv_cla__moe_arch_mod__prompt_kernel_back_75
L_recurrent_scan__compressed_kv_cla__moe_arch_mod__prompt_kernel_rare_80:
    s_cmp_eq_u32 s40, 1
    s_cbranch_scc0 L_recurrent_scan__compressed_kv_cla__moe_arch_mod__prompt_kernel_swn_77
    v_readfirstlane_b32 s36, v14
    s_nop 0
    s_cmp_lt_u32 s36, 7
    s_cbranch_scc1 L_recurrent_scan__compressed_kv_cla__moe_arch_mod__prompt_kernel_rare_74
L_recurrent_scan__compressed_kv_cla__moe_arch_mod__prompt_kernel_back_75:
    s_branch L_recurrent_scan__compressed_kv_cla__moe_arch_mod__prompt_kernel_swend_76
L_recurrent_scan__compressed_kv_cla__moe_arch_mod__prompt_kernel_swn_77:
    s_cmp_eq_u32 s40, 2
    s_cbranch_scc0 L_recurrent_scan__compressed_kv_cla__moe_arch_mod__prompt_kernel_swn_78
    s_mov_b32 s36, 4276224
    buffer_load_dwordx4 v[160:163], v7, s[24:27], s36 offen offset:0 sc1
    buffer_load_dwordx4 v[164:167], v7, s[24:27], s36 offen offset:1024 sc1
    s_branch L_recurrent_scan__compressed_kv_cla__moe_arch_mod__prompt_kernel_swend_76
L_recurrent_scan__compressed_kv_cla__moe_arch_mod__prompt_kernel_swn_78:
    s_cmp_eq_u32 s40, 3
    s_cbranch_scc0 L_recurrent_scan__compressed_kv_cla__moe_arch_mod__prompt_kernel_swn_79
    v_max_u32 v24, v160, v161
    v_min_u32 v25, v160, v161
    v_med3_u32 v25, v24, v25, v162
    v_max_u32 v24, v24, v162
    v_med3_u32 v25, v24, v25, v163
    v_max_u32 v24, v24, v163
    v_med3_u32 v25, v24, v25, v164
    v_max_u32 v24, v24, v164
    v_med3_u32 v25, v24, v25, v165
    v_max_u32 v24, v24, v165
    v_med3_u32 v25, v24, v25, v166
    v_max_u32 v24, v24, v166
    v_med3_u32 v25, v24, v25, v167
    v_max_u32 v24, v24, v167
    v_mov_b32 v26, v24
    s_nop 1
    v_max_u32_dpp v26, v26, v26 quad_perm:[1,0,3,2] row_mask:0xf bank_mask:0xf
    s_nop 1
    v_max_u32_dpp v26, v26, v26 quad_perm:[2,3,0,1] row_mask:0xf bank_mask:0xf
    s_nop 1
    v_max_u32_dpp v26, v26, v26 row_half_mirror row_mask:0xf bank_mask:0xf
    s_nop 1
    v_max_u32_dpp v26, v26, v26 row_mirror row_mask:0xf bank_mask:0xf
    s_nop 0
    v_readlane_b32 s20, v26, 0
    v_readlane_b32 s21, v26, 16
    v_readlane_b32 s22, v26, 32
    v_readlane_b32 s23, v26, 48
    s_max_u32 s20, s20, s21
    s_max_u32 s22, s22, s23
    s_max_u32 s20, s20, s22
    s_mov_b32 s58, s20
    v_cmp_eq_u32 vcc, s58, v24
    s_nop 1
    v_cndmask_b32 v26, v24, v25, vcc
    s_nop 1
    v_max_u32_dpp v26, v26, v26 quad_perm:[1,0,3,2] row_mask:0xf bank_mask:0xf
    s_nop 1
    v_max_u32_dpp v26, v26, v26 quad_perm:[2,3,0,1] row_mask:0xf bank_mask:0xf
    s_nop 1
    v_max_u32_dpp v26, v26, v26 row_half_mirror row_mask:0xf bank_mask:0xf
    s_nop 1
    v_max_u32_dpp v26, v26, v26 row_mirror row_mask:0xf bank_mask:0xf
    s_nop 0
    v_readlane_b32 s20, v26, 0
    v_readlane_b32 s21, v26, 16
    v_readlane_b32 s22, v26, 32
    v_readlane_b32 s23, v26, 48
    s_max_u32 s20, s20, s21
    s_max_u32 s22, s22, s23
    s_max_u32 s20, s20, s22
    s_mov_b32 s59, s20
    s_and_b32 s36, s58, 0xffff
    s_sub_u32 s56, 0xffff, s36
    s_and_b32 s36, s59, 0xffff
    s_sub_u32 s57, 0xffff, s36
    v_and_b32 v24, 1, v1
    v_mov_b32 v25, s56
    v_mov_b32 v26, s57
    v_cmp_eq_u32 vcc, 1, v24
    s_nop 1
    v_cndmask_b32 v25, v25, v26, vcc
    v_lshrrev_b32 v26, 4, v25
    v_lshlrev_b32 v26, 15, v26
    v_and_b32 v25, 15, v25
    v_lshl_add_u32 v26, v25, 4, v26
    v_lshrrev_b32 v27, 4, v1
    v_lshl_add_u32 v26, v27, 8, v26
    s_and_b32 s36, s3, 3
    s_lshl_b32 s36, s36, 13
    s_add_u32 s37, s36, 4096
    s_mov_b32 exec_lo, 0x00030003
    s_mov_b32 exec_hi, 0x00030003
    buffer_load_dwordx4 v[160:163], v26, s[24:27], s36 offen offset:0 sc1
    buffer_load_dwordx4 v[164:167], v26, s[24:27], s36 offen offset:1024 sc1
    buffer_load_dwordx4 v[168:171], v26, s[24:27], s36 offen offset:2048 sc1
    buffer_load_dwordx4 v[172:175], v26, s[24:27], s36 offen offset:3072 sc1
    buffer_load_dwordx4 v[176:179], v26, s[24:27], s37 offen offset:0 sc1
    buffer_load_dwordx4 v[180:183], v26, s[24:27], s37 offen offset:1024 sc1
    buffer_load_dwordx4 v[184:187], v26, s[24:27], s37 offen offset:2048 sc1
    buffer_load_dwordx4 v[188:191], v26, s[24:27], s37 offen offset:3072 sc1
    s_mov_b64 exec, -1
    s_branch L_recurrent_scan__compressed_kv_cla__moe_arch_mod__prompt_kernel_swend_76
L_recurrent_scan__compressed_kv_cla__moe_arch_mod__prompt_kernel_swn_79:
    s_sub_u32 s38, s40, s60
    s_cmp_eq_u32 s38, 0
    s_cbranch_scc0 L_recurrent_scan__compressed_kv_cla__moe_arch_mod__prompt_kernel_swn_68
    s_and_b32 s20, s3, 3
    s_lshl_b32 s20, s20, 8
    s_lshl_b32 s21, s28, 5
    s_add_u32 s20, s20, s21
    s_lshr_b32 s21, s3, 2
    s_lshl_b32 s21, s21, 7
    v_lshrrev_b32 v25, 3, v1
    s_lshl_b32 s36, s28, 5
    s_add_u32 s36, s36, s20
    v_add_u32 v25, s36, v25
    v_mul_u32_u24 v25, 7168, v25
    v_add_u32 v25, s21, v25
    v_bfe_u32 v26, v1, 4, 1
    v_lshlrev_b32 v26, 1, v26
    v_and_b32 v27, 7, v1
    v_xor_b32 v26, v26, v27
    v_lshl_add_u32 v24, v26, 4, v25
    v_xor_b32 v26, 4, v26
    v_lshl_add_u32 v25, v26, 4, v25
    v_add_u32 v25, 56320, v25
    v_add_u32 v26, 112640, v24
    v_add_u32 v27, 112640, v25
    s_lshl_b32 s36, s28, 13
    s_add_u32 m0, s36, 131072
    s_mov_b32 s37, 229376
    buffer_load_dwordx4 v24, s[4:7], 0 offen offset:0 nt lds
    buffer_load_dwordx4 v25, s[4:7], 0 offen offset:1024 nt lds
    buffer_load_dwordx4 v26, s[4:7], 0 offen offset:2048 nt lds
    buffer_load_dwordx4 v27, s[4:7], 0 offen offset:3072 nt lds
    s_add_u32 m0, s36, 135168
    s_nop 0
    buffer_load_dwordx4 v24, s[4:7], s37 offen offset:0 nt lds
    buffer_load_dwordx4 v25, s[4:7], s37 offen offset:1024 nt lds
    buffer_load_dwordx4 v26, s[4:7], s37 offen offset:2048 nt lds
    buffer_load_dwordx4 v27, s[4:7], s37 offen offset:3072 nt lds
    s_branch L_recurrent_scan__compressed_kv_cla__moe_arch_mod__prompt_kernel_swend_67
L_recurrent_scan__compressed_kv_cla__moe_arch_mod__prompt_kernel_swn_68:
    s_cmp_eq_u32 s38, 2
    s_cbranch_scc0 L_recurrent_scan__compressed_kv_cla__moe_arch_mod__prompt_kernel_swn_69
    v_lshrrev_b32 v8, 4, v1
    v_bfe_u32 v5, v1, 2, 2
    v_lshl_add_u32 v5, v8, 3, v5
    v_lshlrev_b32 v5, 7, v5
    v_and_b32 v9, 3, v1
    v_lshl_add_u32 v5, v9, 3, v5
    v_bfe_u32 v9, v1, 3, 2
    v_xor_b32 v9, s28, v9
    v_lshl_add_u32 v5, v9, 5, v5
    v_add_u32 v5, 131072, v5
    ds_read_b64_tr_b16 v[14:15], v5 offset:0
    ds_read_b64_tr_b16 v[16:17], v5 offset:512
    ds_read_b64_tr_b16 v[20:21], v5 offset:4096
    ds_read_b64_tr_b16 v[22:23], v5 offset:4608
    ds_read_b64_tr_b16 v[24:25], v5 offset:8192
    ds_read_b64_tr_b16 v[26:27], v5 offset:8704
    s_and_b32 s36, s3, 3
    s_lshl_b32 s36, s36, 6
    s_lshr_b32 s37, s3, 2
    s_lshl_b32 s37, s37, 12
    s_add_u32 s36, s36, s37
    s_lshl_b32 s37, s28, 10
    s_add_u32 s36, s36, s37
    s_add_u32 s36, s36, 58720256
    v_and_b32 v9, 1, v1
    v_lshlrev_b32 v9, 4, v9
    v_lshl_add_u32 v9, v8, 8, v9
    s_waitcnt lgkmcnt(4)
    v_mfma_f32_16x16x32_bf16 v[10:13], v[14:17], v[160:163], 0
    ds_read_b64_tr_b16 v[14:15], v5 offset:12288
    ds_read_b64_tr_b16 v[16:17], v5 offset:12800
    s_waitcnt lgkmcnt(4)
    v_mfma_f32_16x16x32_bf16 v[10:13], v[20:23], v[164:167], v[10:13]
    ds_read_b64_tr_b16 v[20:21], v5 offset:16384
    ds_read_b64_tr_b16 v[22:23], v5 offset:16896
    s_waitcnt lgkmcnt(4)
    v_mfma_f32_16x16x32_bf16 v[10:13], v[24:27], v[168:171], v[10:13]
    ds_read_b64_tr_b16 v[24:25], v5 offset:20480
    ds_read_b64_tr_b16 v[26:27], v5 offset:20992
    s_waitcnt lgkmcnt(4)
    v_mfma_f32_16x16x32_bf16 v[10:13], v[14:17], v[172:175], v[10:13]
    ds_read_b64_tr_b16 v[14:15], v5 offset:24576
    ds_read_b64_tr_b16 v[16:17], v5 offset:25088
    s_waitcnt lgkmcnt(4)
    v_mfma_f32_16x16x32_bf16 v[10:13], v[20:23], v[176:179], v[10:13]
    ds_read_b64_tr_b16 v[20:21], v5 offset:28672
    ds_read_b64_tr_b16 v[22:23], v5 offset:29184
    s_waitcnt lgkmcnt(4)
    v_mfma_f32_16x16x32_bf16 v[10:13], v[24:27], v[180:183], v[10:13]
    s_waitcnt lgkmcnt(2)
    v_mfma_f32_16x16x32_bf16 v[10:13], v[14:17], v[184:187], v[10:13]
    s_waitcnt lgkmcnt(0)
    v_mfma_f32_16x16x32_bf16 v[10:13], v[20:23], v[188:191], v[10:13]
    s_nop 5
    s_mov_b32 exec_lo, 0x00030003
    s_mov_b32 exec_hi, 0x00030003
    buffer_store_dwordx4 v[10:13], v9, s[24:27], s36 offen sc1
    s_mov_b64 exec, -1
    s_nop 1
    s_branch L_recurrent_scan__compressed_kv_cla__moe_arch_mod__prompt_kernel_swend_67
L_recurrent_scan__compressed_kv_cla__moe_arch_mod__prompt_kernel_swn_69:
    s_cmp_eq_u32 s38, 3
    s_cbranch_scc0 L_recurrent_scan__compressed_kv_cla__moe_arch_mod__prompt_kernel_swn_70
    s_and_b32 s20, s3, 3
    s_lshl_b32 s20, s20, 8
    s_lshl_b32 s21, s28, 5
    s_add_u32 s20, s20, s21
    s_lshr_b32 s21, s3, 2
    s_lshl_b32 s21, s21, 7
    v_lshrrev_b32 v25, 3, v1
    s_lshl_b32 s36, s28, 5
    s_add_u32 s36, s36, s20
    v_add_u32 v25, s36, v25
    v_mul_u32_u24 v25, 7168, v25
    v_add_u32 v25, s21, v25
    v_bfe_u32 v26, v1, 4, 1
    v_lshlrev_b32 v26, 1, v26
    v_and_b32 v27, 7, v1
    v_xor_b32 v26, v26, v27
    v_lshl_add_u32 v24, v26, 4, v25
    v_xor_b32 v26, 4, v26
    v_lshl_add_u32 v25, v26, 4, v25
    v_add_u32 v25, 56320, v25
    v_add_u32 v26, 112640, v24
    v_add_u32 v27, 112640, v25
    s_lshl_b32 s36, s28, 13
    s_add_u32 m0, s36, 131072
    s_mov_b32 s37, 229376
    buffer_load_dwordx4 v24, s[8:11], 0 offen offset:0 nt lds
    buffer_load_dwordx4 v25, s[8:11], 0 offen offset:1024 nt lds
    buffer_load_dwordx4 v26, s[8:11], 0 offen offset:2048 nt lds
    buffer_load_dwordx4 v27, s[8:11], 0 offen offset:3072 nt lds
    s_add_u32 m0, s36, 135168
    s_nop 0
    buffer_load_dwordx4 v24, s[8:11], s37 offen offset:0 nt lds
    buffer_load_dwordx4 v25, s[8:11], s37 offen offset:1024 nt lds
    buffer_load_dwordx4 v26, s[8:11], s37 offen offset:2048 nt lds
    buffer_load_dwordx4 v27, s[8:11], s37 offen offset:3072 nt lds
    s_branch L_recurrent_scan__compressed_kv_cla__moe_arch_mod__prompt_kernel_swend_67
L_recurrent_scan__compressed_kv_cla__moe_arch_mod__prompt_kernel_swn_70:
    s_cmp_eq_u32 s38, 5
    s_cbranch_scc0 L_recurrent_scan__compressed_kv_cla__moe_arch_mod__prompt_kernel_swn_71
    v_lshrrev_b32 v8, 4, v1
    v_bfe_u32 v5, v1, 2, 2
    v_lshl_add_u32 v5, v8, 3, v5
    v_lshlrev_b32 v5, 7, v5
    v_and_b32 v9, 3, v1
    v_lshl_add_u32 v5, v9, 3, v5
    v_bfe_u32 v9, v1, 3, 2
    v_xor_b32 v9, s28, v9
    v_lshl_add_u32 v5, v9, 5, v5
    v_add_u32 v5, 131072, v5
    ds_read_b64_tr_b16 v[14:15], v5 offset:0
    ds_read_b64_tr_b16 v[16:17], v5 offset:512
    ds_read_b64_tr_b16 v[20:21], v5 offset:4096
    ds_read_b64_tr_b16 v[22:23], v5 offset:4608
    ds_read_b64_tr_b16 v[24:25], v5 offset:8192
    ds_read_b64_tr_b16 v[26:27], v5 offset:8704
    s_and_b32 s36, s3, 3
    s_lshl_b32 s36, s36, 6
    s_lshr_b32 s37, s3, 2
    s_lshl_b32 s37, s37, 12
    s_add_u32 s36, s36, s37
    s_lshl_b32 s37, s28, 10
    s_add_u32 s36, s36, s37
    s_add_u32 s36, s36, 58720288
    v_and_b32 v9, 1, v1
    v_lshlrev_b32 v9, 4, v9
    v_lshl_add_u32 v9, v8, 8, v9
    s_waitcnt lgkmcnt(4)
    v_mfma_f32_16x16x32_bf16 v[10:13], v[14:17], v[160:163], 0
    ds_read_b64_tr_b16 v[14:15], v5 offset:12288
    ds_read_b64_tr_b16 v[16:17], v5 offset:12800
    s_waitcnt lgkmcnt(4)
    v_mfma_f32_16x16x32_bf16 v[10:13], v[20:23], v[164:167], v[10:13]
    ds_read_b64_tr_b16 v[20:21], v5 offset:16384
    ds_read_b64_tr_b16 v[22:23], v5 offset:16896
    s_waitcnt lgkmcnt(4)
    v_mfma_f32_16x16x32_bf16 v[10:13], v[24:27], v[168:171], v[10:13]
    ds_read_b64_tr_b16 v[24:25], v5 offset:20480
    ds_read_b64_tr_b16 v[26:27], v5 offset:20992
    s_waitcnt lgkmcnt(4)
    v_mfma_f32_16x16x32_bf16 v[10:13], v[14:17], v[172:175], v[10:13]
    ds_read_b64_tr_b16 v[14:15], v5 offset:24576
    ds_read_b64_tr_b16 v[16:17], v5 offset:25088
    s_waitcnt lgkmcnt(4)
    v_mfma_f32_16x16x32_bf16 v[10:13], v[20:23], v[176:179], v[10:13]
    ds_read_b64_tr_b16 v[20:21], v5 offset:28672
    ds_read_b64_tr_b16 v[22:23], v5 offset:29184
    s_waitcnt lgkmcnt(4)
    v_mfma_f32_16x16x32_bf16 v[10:13], v[24:27], v[180:183], v[10:13]
    s_waitcnt lgkmcnt(2)
    v_mfma_f32_16x16x32_bf16 v[10:13], v[14:17], v[184:187], v[10:13]
    s_waitcnt lgkmcnt(0)
    v_mfma_f32_16x16x32_bf16 v[10:13], v[20:23], v[188:191], v[10:13]
    s_nop 5
    s_mov_b32 exec_lo, 0x00030003
    s_mov_b32 exec_hi, 0x00030003
    buffer_store_dwordx4 v[10:13], v9, s[24:27], s36 offen sc1
    s_mov_b64 exec, -1
    s_nop 1
    s_branch L_recurrent_scan__compressed_kv_cla__moe_arch_mod__prompt_kernel_swend_67
L_recurrent_scan__compressed_kv_cla__moe_arch_mod__prompt_kernel_swn_71:
    s_mul_i32 s36, s3, 2341
    s_lshr_b32 s36, s36, 16
    s_add_u32 s36, s36, 48
    s_lshl_b32 s36, s36, 7
    v_mov_b32 v20, s36
    v_mov_b32 v21, 1
    s_mov_b64 exec, 1
    global_atomic_add v20, v21, s[90:91]
    s_mov_b64 exec, -1
    s_nop 3
L_recurrent_scan__compressed_kv_cla__moe_arch_mod__prompt_kernel_swend_67:
L_recurrent_scan__compressed_kv_cla__moe_arch_mod__prompt_kernel_swend_76:
    s_branch L_recurrent_scan__compressed_kv_cla__moe_arch_mod__prompt_kernel_back_81
L_recurrent_scan__compressed_kv_cla__moe_arch_mod__prompt_kernel_rare_92:
    v_mov_b32 v20, 4048155338
    s_cmp_gt_i32 s36, 0
    s_cbranch_scc1 L_recurrent_scan__compressed_kv_cla__moe_arch_mod__prompt_kernel_mf_90
    v_cmp_gt_i32 s[20:21], 0, v18
    v_cmp_gt_i32 s[22:23], 1, v18
    v_cmp_gt_i32 s[62:63], 2, v18
    v_cmp_gt_i32 vcc, 3, v18
    v_mov_b32 v116, v20
    v_mov_b32 v117, v20
    v_mov_b32 v118, v20
    v_mov_b32 v119, v20
    v_cndmask_b32 v112, v112, v20, s[20:21]
    v_cndmask_b32 v113, v113, v20, s[22:23]
    v_cndmask_b32 v114, v114, v20, s[62:63]
    v_cndmask_b32 v115, v115, v20, vcc
    v_cndmask_b32 v124, v124, v20, s[20:21]
    v_cndmask_b32 v125, v125, v20, s[22:23]
    v_cndmask_b32 v126, v126, v20, s[62:63]
    v_cndmask_b32 v127, v127, v20, vcc
    s_branch L_recurrent_scan__compressed_kv_cla__moe_arch_mod__prompt_kernel_me_91
L_recurrent_scan__compressed_kv_cla__moe_arch_mod__prompt_kernel_mf_90:
    v_mov_b32 v112, v20
    v_mov_b32 v113, v20
    v_mov_b32 v114, v20
    v_mov_b32 v115, v20
    v_mov_b32 v116, v20
    v_mov_b32 v117, v20
    v_mov_b32 v118, v20
    v_mov_b32 v119, v20
    v_mov_b32 v120, v20
    v_mov_b32 v121, v20
    v_mov_b32 v122, v20
    v_mov_b32 v123, v20
    v_mov_b32 v124, v20
    v_mov_b32 v125, v20
    v_mov_b32 v126, v20
    v_mov_b32 v127, v20
L_recurrent_scan__compressed_kv_cla__moe_arch_mod__prompt_kernel_me_91:
    s_branch L_recurrent_scan__compressed_kv_cla__moe_arch_mod__prompt_kernel_back_93
L_recurrent_scan__compressed_kv_cla__moe_arch_mod__prompt_kernel_rare_96:
    s_mov_b32 s61, 0x40000
L_recurrent_scan__compressed_kv_cla__moe_arch_mod__prompt_kernel_spin_94:
    s_sub_u32 s61, s61, 1
    s_cbranch_scc1 L_recurrent_scan__compressed_kv_cla__moe_arch_mod__prompt_kernel_spinx_95
    s_sleep 8
    global_load_dword v11, v12, s[90:91] sc1
    s_waitcnt vmcnt(0)
    v_readfirstlane_b32 s36, v11
    s_nop 0
    s_cmp_lt_u32 s36, 28
    s_cbranch_scc1 L_recurrent_scan__compressed_kv_cla__moe_arch_mod__prompt_kernel_spin_94
L_recurrent_scan__compressed_kv_cla__moe_arch_mod__prompt_kernel_spinx_95:
    s_branch L_recurrent_scan__compressed_kv_cla__moe_arch_mod__prompt_kernel_back_97
L_recurrent_scan__compressed_kv_cla__moe_arch_mod__prompt_kernel_rare_103:
    v_mov_b32 v20, 4048155338
    s_cmp_gt_i32 s50, 0
    s_cbranch_scc1 L_recurrent_scan__compressed_kv_cla__moe_arch_mod__prompt_kernel_mf_101
    v_cmp_gt_i32 s[20:21], 0, v18
    v_cmp_gt_i32 s[22:23], 1, v18
    v_cmp_gt_i32 s[62:63], 2, v18
    v_cmp_gt_i32 vcc, 3, v18
    v_mov_b32 v100, v20
    v_mov_b32 v101, v20
    v_mov_b32 v102, v20
    v_mov_b32 v103, v20
    v_cndmask_b32 v96, v96, v20, s[20:21]
    v_cndmask_b32 v97, v97, v20, s[22:23]
    v_cndmask_b32 v98, v98, v20, s[62:63]
    v_cndmask_b32 v99, v99, v20, vcc
    v_cndmask_b32 v108, v108, v20, s[20:21]
    v_cndmask_b32 v109, v109, v20, s[22:23]
    v_cndmask_b32 v110, v110, v20, s[62:63]
    v_cndmask_b32 v111, v111, v20, vcc
    s_branch L_recurrent_scan__compressed_kv_cla__moe_arch_mod__prompt_kernel_me_102
L_recurrent_scan__compressed_kv_cla__moe_arch_mod__prompt_kernel_mf_101:
    v_mov_b32 v96, v20
    v_mov_b32 v97, v20
    v_mov_b32 v98, v20
    v_mov_b32 v99, v20
    v_mov_b32 v100, v20
    v_mov_b32 v101, v20
    v_mov_b32 v102, v20
    v_mov_b32 v103, v20
    v_mov_b32 v104, v20
    v_mov_b32 v105, v20
    v_mov_b32 v106, v20
    v_mov_b32 v107, v20
    v_mov_b32 v108, v20
    v_mov_b32 v109, v20
    v_mov_b32 v110, v20
    v_mov_b32 v111, v20
L_recurrent_scan__compressed_kv_cla__moe_arch_mod__prompt_kernel_me_102:
    s_branch L_recurrent_scan__compressed_kv_cla__moe_arch_mod__prompt_kernel_back_104
L_grp1:
    v_mov_b32 v20, 1040356334
    v_mov_b32 v21, v20
    s_and_b32 s37, s28, 3
    s_lshl_b32 s37, s37, 13
    v_lshlrev_b32 v7, 4, v1
    v_add_u32 v4, s37, v7
    v_add_u32 v19, 131072, v4
    v_add_u32 v6, 4096, v4
    s_add_u32 s43, s37, 32768
    s_add_u32 s44, s37, 98304
    v_pk_mul_f32 v[192:193], v[192:193], v[20:21]
    v_pk_mul_f32 v[194:195], v[194:195], v[20:21]
    v_pk_mul_f32 v[196:197], v[196:197], v[20:21]
    v_pk_mul_f32 v[198:199], v[198:199], v[20:21]
    v_cvt_pk_bf16_f32 v128, v192, v193
    v_cvt_pk_bf16_f32 v129, v194, v195
    v_cvt_pk_bf16_f32 v130, v196, v197
    v_cvt_pk_bf16_f32 v131, v198, v199
    v_pk_mul_f32 v[224:225], v[224:225], v[20:21]
    v_pk_mul_f32 v[226:227], v[226:227], v[20:21]
    v_pk_mul_f32 v[228:229], v[228:229], v[20:21]
    v_pk_mul_f32 v[230:231], v[230:231], v[20:21]
    v_cvt_pk_bf16_f32 v144, v224, v225
    v_cvt_pk_bf16_f32 v145, v226, v227
    v_cvt_pk_bf16_f32 v146, v228, v229
    v_cvt_pk_bf16_f32 v147, v230, v231
    v_pk_mul_f32 v[200:201], v[200:201], v[20:21]
    v_pk_mul_f32 v[202:203], v[202:203], v[20:21]
    v_pk_mul_f32 v[204:205], v[204:205], v[20:21]
    v_pk_mul_f32 v[206:207], v[206:207], v[20:21]
    v_cvt_pk_bf16_f32 v132, v200, v201
    v_cvt_pk_bf16_f32 v133, v202, v203
    v_cvt_pk_bf16_f32 v134, v204, v205
    v_cvt_pk_bf16_f32 v135, v206, v207
    v_pk_mul_f32 v[232:233], v[232:233], v[20:21]
    v_pk_mul_f32 v[234:235], v[234:235], v[20:21]
    v_pk_mul_f32 v[236:237], v[236:237], v[20:21]
    v_pk_mul_f32 v[238:239], v[238:239], v[20:21]
    v_cvt_pk_bf16_f32 v148, v232, v233
    v_cvt_pk_bf16_f32 v149, v234, v235
    v_cvt_pk_bf16_f32 v150, v236, v237
    v_cvt_pk_bf16_f32 v151, v238, v239
    v_pk_mul_f32 v[208:209], v[208:209], v[20:21]
    v_pk_mul_f32 v[210:211], v[210:211], v[20:21]
    v_pk_mul_f32 v[212:213], v[212:213], v[20:21]
    v_pk_mul_f32 v[214:215], v[214:215], v[20:21]
    v_cvt_pk_bf16_f32 v136, v208, v209
    v_cvt_pk_bf16_f32 v137, v210, v211
    v_cvt_pk_bf16_f32 v138, v212, v213
    v_cvt_pk_bf16_f32 v139, v214, v215
    v_pk_mul_f32 v[240:241], v[240:241], v[20:21]
    v_pk_mul_f32 v[242:243], v[242:243], v[20:21]
    v_pk_mul_f32 v[244:245], v[244:245], v[20:21]
    v_pk_mul_f32 v[246:247], v[246:247], v[20:21]
    v_cvt_pk_bf16_f32 v152, v240, v241
    v_cvt_pk_bf16_f32 v153, v242, v243
    v_cvt_pk_bf16_f32 v154, v244, v245
    v_cvt_pk_bf16_f32 v155, v246, v247
    v_pk_mul_f32 v[216:217], v[216:217], v[20:21]
    v_pk_mul_f32 v[218:219], v[218:219], v[20:21]
    v_pk_mul_f32 v[220:221], v[220:221], v[20:21]
    v_pk_mul_f32 v[222:223], v[222:223], v[20:21]
    v_cvt_pk_bf16_f32 v140, v216, v217
    v_cvt_pk_bf16_f32 v141, v218, v219
    v_cvt_pk_bf16_f32 v142, v220, v221
    v_cvt_pk_bf16_f32 v143, v222, v223
    v_pk_mul_f32 v[248:249], v[248:249], v[20:21]
    v_pk_mul_f32 v[250:251], v[250:251], v[20:21]
    v_pk_mul_f32 v[252:253], v[252:253], v[20:21]
    v_pk_mul_f32 v[254:255], v[254:255], v[20:21]
    v_cvt_pk_bf16_f32 v156, v248, v249
    v_cvt_pk_bf16_f32 v157, v250, v251
    v_cvt_pk_bf16_f32 v158, v252, v253
    v_cvt_pk_bf16_f32 v159, v254, v255
    v_mov_b32 v2, v7
    v_and_b32 v21, 15, v1
    v_lshrrev_b32 v22, 4, v1
    v_lshlrev_b32 v22, 2, v22
    v_sub_u32 v18, v21, v22
    s_mov_b32 s40, 0
    s_mov_b32 s41, 16384
    s_mov_b32 s49, 0xffff
    s_lshl_b32 s51, s30, 1
    s_add_u32 s51, s51, 1
    s_and_b32 s50, s28, 3
    s_lshl_b32 s50, s50, 5
    s_lshl_b32 s46, 3, s51
    s_lshr_b32 s46, s46, 1
    s_lshr_b32 s47, s46, 1
    s_or_b32 s47, s47, 0x8000
    s_lshl_b32 s42, 1, s51
    s_or_b32 s42, s42, 1
    s_mov_b64 s[52:53], 0
    s_waitcnt vmcnt(3) lgkmcnt(0)
    s_barrier
    ds_read_b128 v[64:67], v2 offset:0
    ds_read_b128 v[68:71], v2 offset:1024
    ds_read_b128 v[72:75], v2 offset:2048
    ds_read_b128 v[76:79], v2 offset:3072
    ds_read_b128 v[80:83], v2 offset:4096
    ds_read_b128 v[84:87], v2 offset:5120
    ds_read_b128 v[88:91], v2 offset:6144
    ds_read_b128 v[92:95], v2 offset:7168
    ds_read_b128 v[160:163], v19 offset:0
    ds_read_b128 v[164:167], v19 offset:1024
    ds_read_b128 v[168:171], v19 offset:2048
    ds_read_b128 v[172:175], v19 offset:3072
    ds_read_b128 v[176:179], v19 offset:4096
    ds_read_b128 v[180:183], v19 offset:5120
    ds_read_b128 v[184:187], v19 offset:6144
    ds_read_b128 v[188:191], v19 offset:7168
    v_mov_b32 v36, 0x3f803f80
    v_mov_b32 v37, 0x3f803f80
    v_mov_b32 v38, 0x3f803f80
    v_mov_b32 v39, 0x3f803f80
    s_add_u32 s16, s54, 41943040
    s_addc_u32 s17, s55, 0
    s_and_b32 s17, s17, 0xffff
    s_mov_b32 s18, 117440640
    s_mov_b32 s19, 0x20000
    s_cmp_eq_u32 s28, 4
    s_cbranch_scc1 L_recurrent_scan__compressed_kv_cla__moe_arch_mod__prompt_kernel_rare_143
L_recurrent_scan__compressed_kv_cla__moe_arch_mod__prompt_kernel_back_144:
    s_sub_u32 s36, s2, 160
    s_lshl_b32 s36, s36, 1
    s_and_b32 s37, s28, 1
    s_add_u32 s36, s36, s37
    s_min_u32 s36, s36, 1024
    s_mul_i32 s36, s36, 43776
    s_cmp_lt_u32 s28, 6
    s_cselect_b64 s[4:5], s[32:33], s[34:35]
    s_cselect_b32 s37, 32, 28
    s_lshl_b32 s37, s37, 18
    s_min_u32 s36, s36, s37
    s_sub_u32 s6, s37, s36
    s_min_u32 s6, s6, 43776
    s_add_u32 s4, s4, s36
    s_addc_u32 s5, s5, 0
    s_and_b32 s5, s5, 0xffff
    s_mov_b32 s7, 0x20000
    v_cmp_gt_u32 vcc, 32, v1
    v_lshlrev_b32 v13, 7, v1
    v_mov_b32 v12, 0x100000
    v_cndmask_b32 v13, v12, v13, vcc
    s_mov_b32 s48, 0
    s_cmp_eq_u32 s28, 5
    s_cselect_b32 s36, 0x1000, 0
    s_or_b32 s42, s42, s36
    s_waitcnt lgkmcnt(15)
    v_mfma_f32_16x16x32_bf16 v[96:99], v[64:67], v[128:131], 0
    v_mov_b64 v[192:193], 0
    v_mov_b64 v[194:195], 0
    v_mfma_f32_16x16x32_bf16 v[104:107], v[64:67], v[144:147], 0
    ds_read_b128 v[64:67], v2 offset:8192
    v_mov_b64 v[196:197], 0
    v_mov_b64 v[198:199], 0
    s_waitcnt lgkmcnt(15)
    v_mfma_f32_16x16x32_bf16 v[96:99], v[68:71], v[132:135], v[96:99]
    v_mov_b64 v[200:201], 0
    v_mov_b64 v[202:203], 0
    v_mfma_f32_16x16x32_bf16 v[104:107], v[68:71], v[148:151], v[104:107]
    ds_read_b128 v[68:71], v2 offset:9216
    v_mov_b64 v[204:205], 0
    v_mov_b64 v[206:207], 0
    s_waitcnt lgkmcnt(15)
    v_mfma_f32_16x16x32_bf16 v[96:99], v[72:75], v[136:139], v[96:99]
    v_mov_b64 v[208:209], 0
    v_mov_b64 v[210:211], 0
    v_mfma_f32_16x16x32_bf16 v[104:107], v[72:75], v[152:155], v[104:107]
    ds_read_b128 v[72:75], v2 offset:10240
    v_mov_b64 v[212:213], 0
    v_mov_b64 v[214:215], 0
    s_waitcnt lgkmcnt(15)
    v_mfma_f32_16x16x32_bf16 v[96:99], v[76:79], v[140:143], v[96:99]
    v_mov_b64 v[216:217], 0
    v_mov_b64 v[218:219], 0
    v_mfma_f32_16x16x32_bf16 v[104:107], v[76:79], v[156:159], v[104:107]
    ds_read_b128 v[76:79], v2 offset:11264
    v_mov_b64 v[220:221], 0
    s_waitcnt lgkmcnt(15)
    v_mfma_f32_16x16x32_bf16 v[100:103], v[80:83], v[128:131], 0
    v_mov_b64 v[222:223], 0
    v_mov_b64 v[224:225], 0
    v_mfma_f32_16x16x32_bf16 v[108:111], v[80:83], v[144:147], 0
    ds_read_b128 v[80:83], v2 offset:12288
    v_mov_b64 v[226:227], 0
    v_mov_b64 v[228:229], 0
    s_waitcnt lgkmcnt(15)
    v_mfma_f32_16x16x32_bf16 v[100:103], v[84:87], v[132:135], v[100:103]
    v_mov_b64 v[230:231], 0
    v_mov_b64 v[232:233], 0
    v_mfma_f32_16x16x32_bf16 v[108:111], v[84:87], v[148:151], v[108:111]
    ds_read_b128 v[84:87], v2 offset:13312
    v_mov_b64 v[234:235], 0
    v_mov_b64 v[236:237], 0
    s_waitcnt lgkmcnt(15)
    v_mfma_f32_16x16x32_bf16 v[100:103], v[88:91], v[136:139], v[100:103]
    v_mov_b64 v[238:239], 0
    v_mov_b64 v[240:241], 0
    v_mfma_f32_16x16x32_bf16 v[108:111], v[88:91], v[152:155], v[108:111]
    ds_read_b128 v[88:91], v2 offset:14336
    v_mov_b64 v[242:243], 0
    v_mov_b64 v[244:245], 0
    s_waitcnt lgkmcnt(15)
    v_mfma_f32_16x16x32_bf16 v[100:103], v[92:95], v[140:143], v[100:103]
    v_mov_b64 v[246:247], 0
    v_mfma_f32_16x16x32_bf16 v[108:111], v[92:95], v[156:159], v[108:111]
    ds_read_b128 v[92:95], v2 offset:15360
    v_mov_b64 v[248:249], 0
    v_mov_b64 v[250:251], 0
    v_mov_b64 v[252:253], 0
    v_mov_b64 v[254:255], 0
    v_mov_b64 v[28:29], 0
    v_mov_b64 v[30:31], 0
    v_mov_b64 v[32:33], 0
    v_mov_b64 v[34:35], 0
    s_add_u32 s36, s30, s50
    s_cmp_eq_u32 s36, 0
    s_cbranch_scc1 L_recurrent_scan__compressed_kv_cla__moe_arch_mod__prompt_kernel_rare_108
L_recurrent_scan__compressed_kv_cla__moe_arch_mod__prompt_kernel_back_109:
    v_max3_f32 v22, v96, v97, v98
    v_max3_f32 v23, v104, v105, v106
    v_max3_f32 v22, v22, v99, v100
    v_max3_f32 v23, v23, v107, v108
    v_max3_f32 v22, v22, v101, v102
    v_max3_f32 v23, v23, v109, v110
    v_max_f32 v22, v22, v103
    v_max_f32 v23, v23, v111
    v_mov_b32 v24, v22
    v_mov_b32 v25, v23
    s_nop 0
    v_permlane16_swap_b32 v22, v24
    v_permlane16_swap_b32 v23, v25
    s_nop 0
    v_max_f32 v22, v22, v24
    v_max_f32 v23, v23, v25
    v_mov_b32 v24, v22
    v_mov_b32 v25, v23
    s_nop 0
    v_permlane32_swap_b32 v22, v24
    v_permlane32_swap_b32 v23, v25
    s_nop 0
    v_max_f32 v22, v22, v24
    v_max_f32 v23, v23, v25
    v_sub_f32 v40, 0, v22
    v_sub_f32 v41, 0, v22
    v_sub_f32 v42, 0, v22
    v_sub_f32 v43, 0, v22
    v_sub_f32 v44, 0, v23
    v_sub_f32 v45, 0, v23
    v_sub_f32 v46, 0, v23
    v_sub_f32 v47, 0, v23
    v_add_f32 v96, v96, v40
    v_add_f32 v97, v97, v40
    s_waitcnt lgkmcnt(7)
    v_mfma_f32_16x16x32_bf16 v[112:115], v[64:67], v[128:131], v[40:43]
    v_exp_f32 v96, v96
    v_add_f32 v98, v98, v40
    v_mfma_f32_16x16x32_bf16 v[120:123], v[64:67], v[144:147], v[44:47]
    v_exp_f32 v97, v97
    v_add_f32 v99, v99, v40
    s_waitcnt lgkmcnt(6)
    v_mfma_f32_16x16x32_bf16 v[112:115], v[68:71], v[132:135], v[112:115]
    v_exp_f32 v98, v98
    v_add_f32 v104, v104, v44
    v_cvt_pk_bf16_f32 v48, v96, v97
    v_mfma_f32_16x16x32_bf16 v[120:123], v[68:71], v[148:151], v[120:123]
    ds_read_b128 v[64:67], v2 offset:16384
    v_exp_f32 v99, v99
    v_add_f32 v105, v105, v44
    s_waitcnt lgkmcnt(6)
    v_mfma_f32_16x16x32_bf16 v[112:115], v[72:75], v[136:139], v[112:115]
    v_exp_f32 v104, v104
    v_add_f32 v106, v106, v44
    v_cvt_pk_bf16_f32 v49, v98, v99
    v_mfma_f32_16x16x32_bf16 v[120:123], v[72:75], v[152:155], v[120:123]
    ds_read_b128 v[68:71], v2 offset:17408
    v_exp_f32 v105, v105
    v_add_f32 v107, v107, v44
    s_waitcnt lgkmcnt(6)
    v_mfma_f32_16x16x32_bf16 v[112:115], v[76:79], v[140:143], v[112:115]
    v_exp_f32 v106, v106
    v_add_f32 v100, v100, v40
    v_cvt_pk_bf16_f32 v52, v104, v105
    v_mfma_f32_16x16x32_bf16 v[120:123], v[76:79], v[156:159], v[120:123]
    ds_read_b128 v[72:75], v2 offset:18432
    v_exp_f32 v107, v107
    v_add_f32 v101, v101, v40
    s_waitcnt lgkmcnt(6)
    v_mfma_f32_16x16x32_bf16 v[116:119], v[80:83], v[128:131], v[40:43]
    v_exp_f32 v100, v100
    v_add_f32 v102, v102, v40
    v_cvt_pk_bf16_f32 v53, v106, v107
    v_mfma_f32_16x16x32_bf16 v[124:127], v[80:83], v[144:147], v[44:47]
    ds_read_b128 v[76:79], v2 offset:19456
    v_exp_f32 v101, v101
    v_add_f32 v103, v103, v40
    s_waitcnt lgkmcnt(6)
    v_mfma_f32_16x16x32_bf16 v[116:119], v[84:87], v[132:135], v[116:119]
    v_exp_f32 v102, v102
    v_add_f32 v108, v108, v44
    v_cvt_pk_bf16_f32 v50, v100, v101
    v_mfma_f32_16x16x32_bf16 v[124:127], v[84:87], v[148:151], v[124:127]
    ds_read_b128 v[80:83], v2 offset:20480
    v_exp_f32 v103, v103
    v_add_f32 v109, v109, v44
    s_waitcnt lgkmcnt(6)
    v_mfma_f32_16x16x32_bf16 v[116:119], v[88:91], v[136:139], v[116:119]
    v_exp_f32 v108, v108
    v_add_f32 v110, v110, v44
    v_cvt_pk_bf16_f32 v51, v102, v103
    v_mfma_f32_16x16x32_bf16 v[124:127], v[88:91], v[152:155], v[124:127]
    ds_read_b128 v[84:87], v2 offset:21504
    v_exp_f32 v109, v109
    v_add_f32 v111, v111, v44
    s_waitcnt lgkmcnt(6)
    v_mfma_f32_16x16x32_bf16 v[116:119], v[92:95], v[140:143], v[116:119]
    v_exp_f32 v110, v110
    v_cvt_pk_bf16_f32 v54, v108, v109
    v_mfma_f32_16x16x32_bf16 v[124:127], v[92:95], v[156:159], v[124:127]
    ds_read_b128 v[88:91], v2 offset:22528
    v_exp_f32 v111, v111
    v_add_u32 v3, 65536, v2
    v_add_u32 v2, s41, v2
    v_and_b32 v2, s49, v2
    v_cvt_pk_bf16_f32 v55, v110, v111
    s_waitcnt vmcnt(1)
    s_cmp_eq_u32 s28, 4
    s_cbranch_scc1 L_recurrent_scan__compressed_kv_cla__moe_arch_mod__prompt_kernel_pw_110
    s_waitcnt vmcnt(0)
L_recurrent_scan__compressed_kv_cla__moe_arch_mod__prompt_kernel_pw_110:
    s_barrier
    .p2align 6
L_body10:
    s_bitcmp1_b32 s46, s40
    s_cbranch_scc1 L_recurrent_scan__compressed_kv_cla__moe_arch_mod__prompt_kernel_rare_117
L_recurrent_scan__compressed_kv_cla__moe_arch_mod__prompt_kernel_back_118:
    s_waitcnt lgkmcnt(5)
    v_mfma_f32_16x16x32_bf16 v[96:99], v[64:67], v[128:131], v[40:43]
    v_exp_f32 v112, v112
    v_mfma_f32_16x16x32_bf16 v[104:107], v[64:67], v[144:147], v[44:47]
    ds_read_b128 v[92:95], v2 offset:7168
    v_mfma_f32_16x16x32_bf16 v[96:99], v[68:71], v[132:135], v[96:99]
    v_exp_f32 v113, v113
    v_mfma_f32_16x16x32_bf16 v[104:107], v[68:71], v[148:151], v[104:107]
    ds_read_b128 v[64:67], v3 offset:0
    s_waitcnt lgkmcnt(5)
    v_mfma_f32_16x16x32_bf16 v[96:99], v[72:75], v[136:139], v[96:99]
    v_exp_f32 v114, v114
    v_mfma_f32_16x16x32_bf16 v[104:107], v[72:75], v[152:155], v[104:107]
    ds_read_b128 v[68:71], v3 offset:1024
    v_cvt_pk_bf16_f32 v56, v112, v113
    v_mfma_f32_16x16x32_bf16 v[96:99], v[76:79], v[140:143], v[96:99]
    v_exp_f32 v115, v115
    v_mfma_f32_16x16x32_bf16 v[104:107], v[76:79], v[156:159], v[104:107]
    ds_read_b128 v[72:75], v3 offset:2048
    s_waitcnt lgkmcnt(5)
    v_mfma_f32_16x16x32_bf16 v[100:103], v[80:83], v[128:131], v[40:43]
    v_exp_f32 v120, v120
    v_mfma_f32_16x16x32_bf16 v[108:111], v[80:83], v[144:147], v[44:47]
    ds_read_b128 v[76:79], v3 offset:3072
    v_cvt_pk_bf16_f32 v57, v114, v115
    v_mfma_f32_16x16x32_bf16 v[100:103], v[84:87], v[132:135], v[100:103]
    v_exp_f32 v121, v121
    v_mfma_f32_16x16x32_bf16 v[108:111], v[84:87], v[148:151], v[108:111]
    ds_read_b128 v[80:83], v3 offset:4096
    s_waitcnt lgkmcnt(5)
    v_mfma_f32_16x16x32_bf16 v[100:103], v[88:91], v[136:139], v[100:103]
    v_exp_f32 v122, v122
    v_mfma_f32_16x16x32_bf16 v[108:111], v[88:91], v[152:155], v[108:111]
    ds_read_b128 v[84:87], v3 offset:5120
    v_cvt_pk_bf16_f32 v60, v120, v121
    v_mfma_f32_16x16x32_bf16 v[100:103], v[92:95], v[140:143], v[100:103]
    v_exp_f32 v123, v123
    v_mfma_f32_16x16x32_bf16 v[108:111], v[92:95], v[156:159], v[108:111]
    ds_read_b128 v[88:91], v3 offset:6144
    s_waitcnt lgkmcnt(5)
    v_mfma_f32_16x16x32_bf16 v[192:195], v[64:67], v[48:51], v[192:195]
    v_exp_f32 v116, v116
    v_mfma_f32_16x16x32_bf16 v[224:227], v[64:67], v[52:55], v[224:227]
    ds_read_b128 v[92:95], v3 offset:7168
    v_cvt_pk_bf16_f32 v61, v122, v123
    v_mfma_f32_16x16x32_bf16 v[196:199], v[68:71], v[48:51], v[196:199]
    v_exp_f32 v117, v117
    v_mfma_f32_16x16x32_bf16 v[228:231], v[68:71], v[52:55], v[228:231]
    ds_read_b128 v[64:67], v2 offset:8192
    s_bitcmp1_b32 s47, s40
    s_cbranch_scc1 L_recurrent_scan__compressed_kv_cla__moe_arch_mod__prompt_kernel_rare_122
L_recurrent_scan__compressed_kv_cla__moe_arch_mod__prompt_kernel_back_123:
    s_waitcnt lgkmcnt(5)
    v_mfma_f32_16x16x32_bf16 v[200:203], v[72:75], v[48:51], v[200:203]
    v_exp_f32 v118, v118
    v_mfma_f32_16x16x32_bf16 v[232:235], v[72:75], v[52:55], v[232:235]
    v_mfma_f32_16x16x32_bf16 v[28:31], v[36:39], v[48:51], v[28:31]
    ds_read_b128 v[68:71], v2 offset:9216
    v_cvt_pk_bf16_f32 v58, v116, v117
    v_mfma_f32_16x16x32_bf16 v[204:207], v[76:79], v[48:51], v[204:207]
    v_exp_f32 v119, v119
    v_mfma_f32_16x16x32_bf16 v[236:239], v[76:79], v[52:55], v[236:239]
    ds_read_b128 v[72:75], v2 offset:10240
    s_waitcnt lgkmcnt(5)
    v_mfma_f32_16x16x32_bf16 v[208:211], v[80:83], v[48:51], v[208:211]
    v_exp_f32 v124, v124
    buffer_load_dword v0, v13, s[4:7], s48 offen
    s_add_u32 s48, s48, 4096
    v_mfma_f32_16x16x32_bf16 v[240:243], v[80:83], v[52:55], v[240:243]
    ds_read_b128 v[76:79], v2 offset:11264
    v_cvt_pk_bf16_f32 v59, v118, v119
    v_mfma_f32_16x16x32_bf16 v[212:215], v[84:87], v[48:51], v[212:215]
    v_exp_f32 v125, v125
    v_mfma_f32_16x16x32_bf16 v[244:247], v[84:87], v[52:55], v[244:247]
    ds_read_b128 v[80:83], v2 offset:12288
    s_waitcnt lgkmcnt(5)
    v_mfma_f32_16x16x32_bf16 v[216:219], v[88:91], v[48:51], v[216:219]
    v_exp_f32 v126, v126
    v_mfma_f32_16x16x32_bf16 v[248:251], v[88:91], v[52:55], v[248:251]
    v_mfma_f32_16x16x32_bf16 v[32:35], v[36:39], v[52:55], v[32:35]
    ds_read_b128 v[84:87], v2 offset:13312
    v_cvt_pk_bf16_f32 v62, v124, v125
    v_mfma_f32_16x16x32_bf16 v[220:223], v[92:95], v[48:51], v[220:223]
    v_exp_f32 v127, v127
    v_mfma_f32_16x16x32_bf16 v[252:255], v[92:95], v[52:55], v[252:255]
    ds_read_b128 v[88:91], v2 offset:14336
    v_cvt_pk_bf16_f32 v63, v126, v127
    s_waitcnt lgkmcnt(5)
    v_mfma_f32_16x16x32_bf16 v[112:115], v[64:67], v[128:131], v[40:43]
    v_exp_f32 v96, v96
    v_mfma_f32_16x16x32_bf16 v[120:123], v[64:67], v[144:147], v[44:47]
    ds_read_b128 v[92:95], v2 offset:15360
    v_mfma_f32_16x16x32_bf16 v[112:115], v[68:71], v[132:135], v[112:115]
    v_exp_f32 v97, v97
    v_mfma_f32_16x16x32_bf16 v[120:123], v[68:71], v[148:151], v[120:123]
    ds_read_b128 v[64:67], v3 offset:8192
    s_waitcnt lgkmcnt(5)
    v_mfma_f32_16x16x32_bf16 v[112:115], v[72:75], v[136:139], v[112:115]
    v_exp_f32 v98, v98
    v_mfma_f32_16x16x32_bf16 v[120:123], v[72:75], v[152:155], v[120:123]
    ds_read_b128 v[68:71], v3 offset:9216
    v_cvt_pk_bf16_f32 v48, v96, v97
    v_mfma_f32_16x16x32_bf16 v[112:115], v[76:79], v[140:143], v[112:115]
    v_exp_f32 v99, v99
    v_mfma_f32_16x16x32_bf16 v[120:123], v[76:79], v[156:159], v[120:123]
    ds_read_b128 v[72:75], v3 offset:10240
    s_waitcnt lgkmcnt(5)
    v_mfma_f32_16x16x32_bf16 v[116:119], v[80:83], v[128:131], v[40:43]
    v_exp_f32 v104, v104
    v_mfma_f32_16x16x32_bf16 v[124:127], v[80:83], v[144:147], v[44:47]
    ds_read_b128 v[76:79], v3 offset:11264
    v_cvt_pk_bf16_f32 v49, v98, v99
    v_mfma_f32_16x16x32_bf16 v[116:119], v[84:87], v[132:135], v[116:119]
    v_exp_f32 v105, v105
    v_mfma_f32_16x16x32_bf16 v[124:127], v[84:87], v[148:151], v[124:127]
    ds_read_b128 v[80:83], v3 offset:12288
    s_waitcnt lgkmcnt(5)
    v_mfma_f32_16x16x32_bf16 v[116:119], v[88:91], v[136:139], v[116:119]
    v_exp_f32 v106, v106
    v_mfma_f32_16x16x32_bf16 v[124:127], v[88:91], v[152:155], v[124:127]
    ds_read_b128 v[84:87], v3 offset:13312
    v_cvt_pk_bf16_f32 v52, v104, v105
    v_mfma_f32_16x16x32_bf16 v[116:119], v[92:95], v[140:143], v[116:119]
    v_exp_f32 v107, v107
    v_mfma_f32_16x16x32_bf16 v[124:127], v[92:95], v[156:159], v[124:127]
    ds_read_b128 v[88:91], v3 offset:14336
    s_waitcnt lgkmcnt(5)
    v_mfma_f32_16x16x32_bf16 v[192:195], v[64:67], v[56:59], v[192:195]
    v_exp_f32 v100, v100
    v_mfma_f32_16x16x32_bf16 v[224:227], v[64:67], v[60:63], v[224:227]
    ds_read_b128 v[92:95], v3 offset:15360
    v_cvt_pk_bf16_f32 v53, v106, v107
    v_mfma_f32_16x16x32_bf16 v[196:199], v[68:71], v[56:59], v[196:199]
    v_exp_f32 v101, v101
    v_mfma_f32_16x16x32_bf16 v[228:231], v[68:71], v[60:63], v[228:231]
    v_add_u32 v3, 65536, v2
    v_add_u32 v2, s41, v2
    s_waitcnt lgkmcnt(4)
    v_mfma_f32_16x16x32_bf16 v[200:203], v[72:75], v[56:59], v[200:203]
    v_exp_f32 v102, v102
    v_and_b32 v2, s49, v2
    v_mfma_f32_16x16x32_bf16 v[232:235], v[72:75], v[60:63], v[232:235]
    v_mfma_f32_16x16x32_bf16 v[28:31], v[36:39], v[56:59], v[28:31]
    v_cvt_pk_bf16_f32 v50, v100, v101
    s_waitcnt lgkmcnt(0)
    s_barrier
    v_mfma_f32_16x16x32_bf16 v[204:207], v[76:79], v[56:59], v[204:207]
    v_exp_f32 v103, v103
    v_mfma_f32_16x16x32_bf16 v[236:239], v[76:79], v[60:63], v[236:239]
    ds_read_b128 v[68:71], v2 offset:1024
    ds_read_b128 v[64:67], v2 offset:0
    v_mfma_f32_16x16x32_bf16 v[208:211], v[80:83], v[56:59], v[208:211]
    v_exp_f32 v108, v108
    v_mfma_f32_16x16x32_bf16 v[240:243], v[80:83], v[60:63], v[240:243]
    ds_read_b128 v[76:79], v2 offset:3072
    ds_read_b128 v[72:75], v2 offset:2048
    v_cvt_pk_bf16_f32 v51, v102, v103
    v_mfma_f32_16x16x32_bf16 v[212:215], v[84:87], v[56:59], v[212:215]
    v_exp_f32 v109, v109
    v_mfma_f32_16x16x32_bf16 v[244:247], v[84:87], v[60:63], v[244:247]
    ds_read_b128 v[80:83], v2 offset:4096
    v_mfma_f32_16x16x32_bf16 v[216:219], v[88:91], v[56:59], v[216:219]
    v_exp_f32 v110, v110
    v_mfma_f32_16x16x32_bf16 v[248:251], v[88:91], v[60:63], v[248:251]
    v_mfma_f32_16x16x32_bf16 v[32:35], v[36:39], v[60:63], v[32:35]
    ds_read_b128 v[84:87], v2 offset:5120
    v_cvt_pk_bf16_f32 v54, v108, v109
    v_mfma_f32_16x16x32_bf16 v[220:223], v[92:95], v[56:59], v[220:223]
    v_exp_f32 v111, v111
    v_mfma_f32_16x16x32_bf16 v[252:255], v[92:95], v[60:63], v[252:255]
    ds_read_b128 v[88:91], v2 offset:6144
    v_cvt_pk_bf16_f32 v55, v110, v111
    s_bitcmp1_b32 s42, s40
    s_cbranch_scc1 L_recurrent_scan__compressed_kv_cla__moe_arch_mod__prompt_kernel_rare_150
L_recurrent_scan__compressed_kv_cla__moe_arch_mod__prompt_kernel_back_151:
    s_add_u32 s40, s40, 1
    s_cmp_lg_u32 s40, s51
    s_cbranch_scc1 L_body10
    v_mov_b32 v40, v14
    v_mov_b32 v41, v14
    v_mov_b32 v42, v14
    v_mov_b32 v43, v14
    v_mov_b32 v44, v15
    v_mov_b32 v45, v15
    v_mov_b32 v46, v15
    v_mov_b32 v47, v15
    s_nop 1
    .p2align 6
L_body11:
    s_bitcmp1_b32 s46, s40
    s_cbranch_scc1 L_recurrent_scan__compressed_kv_cla__moe_arch_mod__prompt_kernel_rare_135
L_recurrent_scan__compressed_kv_cla__moe_arch_mod__prompt_kernel_back_136:
    s_waitcnt lgkmcnt(5)
    v_mfma_f32_16x16x32_bf16 v[96:99], v[64:67], v[160:163], v[40:43]
    v_exp_f32 v112, v112
    v_mfma_f32_16x16x32_bf16 v[104:107], v[64:67], v[176:179], v[44:47]
    ds_read_b128 v[92:95], v2 offset:7168
    v_mfma_f32_16x16x32_bf16 v[96:99], v[68:71], v[164:167], v[96:99]
    v_exp_f32 v113, v113
    v_mfma_f32_16x16x32_bf16 v[104:107], v[68:71], v[180:183], v[104:107]
    ds_read_b128 v[64:67], v3 offset:0
    s_waitcnt lgkmcnt(5)
    v_mfma_f32_16x16x32_bf16 v[96:99], v[72:75], v[168:171], v[96:99]
    v_exp_f32 v114, v114
    v_mfma_f32_16x16x32_bf16 v[104:107], v[72:75], v[184:187], v[104:107]
    ds_read_b128 v[68:71], v3 offset:1024
    v_cvt_pk_bf16_f32 v56, v112, v113
    v_mfma_f32_16x16x32_bf16 v[96:99], v[76:79], v[172:175], v[96:99]
    v_exp_f32 v115, v115
    v_mfma_f32_16x16x32_bf16 v[104:107], v[76:79], v[188:191], v[104:107]
    ds_read_b128 v[72:75], v3 offset:2048
    s_waitcnt lgkmcnt(5)
    v_mfma_f32_16x16x32_bf16 v[100:103], v[80:83], v[160:163], v[40:43]
    v_exp_f32 v120, v120
    v_mfma_f32_16x16x32_bf16 v[108:111], v[80:83], v[176:179], v[44:47]
    ds_read_b128 v[76:79], v3 offset:3072
    v_cvt_pk_bf16_f32 v57, v114, v115
    v_mfma_f32_16x16x32_bf16 v[100:103], v[84:87], v[164:167], v[100:103]
    v_exp_f32 v121, v121
    v_mfma_f32_16x16x32_bf16 v[108:111], v[84:87], v[180:183], v[108:111]
    ds_read_b128 v[80:83], v3 offset:4096
    s_waitcnt lgkmcnt(5)
    v_mfma_f32_16x16x32_bf16 v[100:103], v[88:91], v[168:171], v[100:103]
    v_exp_f32 v122, v122
    v_mfma_f32_16x16x32_bf16 v[108:111], v[88:91], v[184:187], v[108:111]
    ds_read_b128 v[84:87], v3 offset:5120
    v_cvt_pk_bf16_f32 v60, v120, v121
    v_mfma_f32_16x16x32_bf16 v[100:103], v[92:95], v[172:175], v[100:103]
    v_exp_f32 v123, v123
    v_mfma_f32_16x16x32_bf16 v[108:111], v[92:95], v[188:191], v[108:111]
    ds_read_b128 v[88:91], v3 offset:6144
    s_waitcnt lgkmcnt(5)
    v_mfma_f32_16x16x32_bf16 v[192:195], v[64:67], v[48:51], v[192:195]
    v_exp_f32 v116, v116
    v_mfma_f32_16x16x32_bf16 v[224:227], v[64:67], v[52:55], v[224:227]
    ds_read_b128 v[92:95], v3 offset:7168
    v_cvt_pk_bf16_f32 v61, v122, v123
    v_mfma_f32_16x16x32_bf16 v[196:199], v[68:71], v[48:51], v[196:199]
    v_exp_f32 v117, v117
    v_mfma_f32_16x16x32_bf16 v[228:231], v[68:71], v[52:55], v[228:231]
    ds_read_b128 v[64:67], v2 offset:8192
    s_bitcmp1_b32 s47, s40
    s_cbranch_scc1 L_recurrent_scan__compressed_kv_cla__moe_arch_mod__prompt_kernel_rare_140
L_recurrent_scan__compressed_kv_cla__moe_arch_mod__prompt_kernel_back_141:
    s_waitcnt lgkmcnt(5)
    v_mfma_f32_16x16x32_bf16 v[200:203], v[72:75], v[48:51], v[200:203]
    v_exp_f32 v118, v118
    v_mfma_f32_16x16x32_bf16 v[232:235], v[72:75], v[52:55], v[232:235]
    v_mfma_f32_16x16x32_bf16 v[28:31], v[36:39], v[48:51], v[28:31]
    ds_read_b128 v[68:71], v2 offset:9216
    v_cvt_pk_bf16_f32 v58, v116, v117
    v_mfma_f32_16x16x32_bf16 v[204:207], v[76:79], v[48:51], v[204:207]
    v_exp_f32 v119, v119
    v_mfma_f32_16x16x32_bf16 v[236:239], v[76:79], v[52:55], v[236:239]
    ds_read_b128 v[72:75], v2 offset:10240
    s_waitcnt lgkmcnt(5)
    v_mfma_f32_16x16x32_bf16 v[208:211], v[80:83], v[48:51], v[208:211]
    v_exp_f32 v124, v124
    buffer_load_dword v0, v13, s[4:7], s48 offen
    s_add_u32 s48, s48, 4096
    v_mfma_f32_16x16x32_bf16 v[240:243], v[80:83], v[52:55], v[240:243]
    ds_read_b128 v[76:79], v2 offset:11264
    v_cvt_pk_bf16_f32 v59, v118, v119
    v_mfma_f32_16x16x32_bf16 v[212:215], v[84:87], v[48:51], v[212:215]
    v_exp_f32 v125, v125
    v_mfma_f32_16x16x32_bf16 v[244:247], v[84:87], v[52:55], v[244:247]
    ds_read_b128 v[80:83], v2 offset:12288
    s_waitcnt lgkmcnt(5)
    v_mfma_f32_16x16x32_bf16 v[216:219], v[88:91], v[48:51], v[216:219]
    v_exp_f32 v126, v126
    v_mfma_f32_16x16x32_bf16 v[248:251], v[88:91], v[52:55], v[248:251]
    v_mfma_f32_16x16x32_bf16 v[32:35], v[36:39], v[52:55], v[32:35]
    ds_read_b128 v[84:87], v2 offset:13312
    v_cvt_pk_bf16_f32 v62, v124, v125
    v_mfma_f32_16x16x32_bf16 v[220:223], v[92:95], v[48:51], v[220:223]
    v_exp_f32 v127, v127
    v_mfma_f32_16x16x32_bf16 v[252:255], v[92:95], v[52:55], v[252:255]
    ds_read_b128 v[88:91], v2 offset:14336
    v_cvt_pk_bf16_f32 v63, v126, v127
    s_waitcnt lgkmcnt(5)
    v_mfma_f32_16x16x32_bf16 v[112:115], v[64:67], v[160:163], v[40:43]
    v_exp_f32 v96, v96
    v_mfma_f32_16x16x32_bf16 v[120:123], v[64:67], v[176:179], v[44:47]
    ds_read_b128 v[92:95], v2 offset:15360
    v_mfma_f32_16x16x32_bf16 v[112:115], v[68:71], v[164:167], v[112:115]
    v_exp_f32 v97, v97
    v_mfma_f32_16x16x32_bf16 v[120:123], v[68:71], v[180:183], v[120:123]
    ds_read_b128 v[64:67], v3 offset:8192
    s_waitcnt lgkmcnt(5)
    v_mfma_f32_16x16x32_bf16 v[112:115], v[72:75], v[168:171], v[112:115]
    v_exp_f32 v98, v98
    v_mfma_f32_16x16x32_bf16 v[120:123], v[72:75], v[184:187], v[120:123]
    ds_read_b128 v[68:71], v3 offset:9216
    v_cvt_pk_bf16_f32 v48, v96, v97
    v_mfma_f32_16x16x32_bf16 v[112:115], v[76:79], v[172:175], v[112:115]
    v_exp_f32 v99, v99
    v_mfma_f32_16x16x32_bf16 v[120:123], v[76:79], v[188:191], v[120:123]
    ds_read_b128 v[72:75], v3 offset:10240
    s_waitcnt lgkmcnt(5)
    v_mfma_f32_16x16x32_bf16 v[116:119], v[80:83], v[160:163], v[40:43]
    v_exp_f32 v104, v104
    v_mfma_f32_16x16x32_bf16 v[124:127], v[80:83], v[176:179], v[44:47]
    ds_read_b128 v[76:79], v3 offset:11264
    v_cvt_pk_bf16_f32 v49, v98, v99
    v_mfma_f32_16x16x32_bf16 v[116:119], v[84:87], v[164:167], v[116:119]
    v_exp_f32 v105, v105
    v_mfma_f32_16x16x32_bf16 v[124:127], v[84:87], v[180:183], v[124:127]
    ds_read_b128 v[80:83], v3 offset:12288
    s_waitcnt lgkmcnt(5)
    v_mfma_f32_16x16x32_bf16 v[116:119], v[88:91], v[168:171], v[116:119]
    v_exp_f32 v106, v106
    v_mfma_f32_16x16x32_bf16 v[124:127], v[88:91], v[184:187], v[124:127]
    ds_read_b128 v[84:87], v3 offset:13312
    v_cvt_pk_bf16_f32 v52, v104, v105
    v_mfma_f32_16x16x32_bf16 v[116:119], v[92:95], v[172:175], v[116:119]
    v_exp_f32 v107, v107
    v_mfma_f32_16x16x32_bf16 v[124:127], v[92:95], v[188:191], v[124:127]
    ds_read_b128 v[88:91], v3 offset:14336
    s_waitcnt lgkmcnt(5)
    v_mfma_f32_16x16x32_bf16 v[192:195], v[64:67], v[56:59], v[192:195]
    v_exp_f32 v100, v100
    v_mfma_f32_16x16x32_bf16 v[224:227], v[64:67], v[60:63], v[224:227]
    ds_read_b128 v[92:95], v3 offset:15360
    v_cvt_pk_bf16_f32 v53, v106, v107
    v_mfma_f32_16x16x32_bf16 v[196:199], v[68:71], v[56:59], v[196:199]
    v_exp_f32 v101, v101
    v_mfma_f32_16x16x32_bf16 v[228:231], v[68:71], v[60:63], v[228:231]
    v_add_u32 v3, 65536, v2
    v_add_u32 v2, s41, v2
    s_waitcnt lgkmcnt(4)
    v_mfma_f32_16x16x32_bf16 v[200:203], v[72:75], v[56:59], v[200:203]
    v_exp_f32 v102, v102
    v_and_b32 v2, s49, v2
    v_mfma_f32_16x16x32_bf16 v[232:235], v[72:75], v[60:63], v[232:235]
    v_mfma_f32_16x16x32_bf16 v[28:31], v[36:39], v[56:59], v[28:31]
    v_cvt_pk_bf16_f32 v50, v100, v101
    s_waitcnt lgkmcnt(0)
    s_barrier
    v_mfma_f32_16x16x32_bf16 v[204:207], v[76:79], v[56:59], v[204:207]
    v_exp_f32 v103, v103
    v_mfma_f32_16x16x32_bf16 v[236:239], v[76:79], v[60:63], v[236:239]
    ds_read_b128 v[68:71], v2 offset:1024
    ds_read_b128 v[64:67], v2 offset:0
    v_mfma_f32_16x16x32_bf16 v[208:211], v[80:83], v[56:59], v[208:211]
    v_exp_f32 v108, v108
    v_mfma_f32_16x16x32_bf16 v[240:243], v[80:83], v[60:63], v[240:243]
    ds_read_b128 v[76:79], v2 offset:3072
    ds_read_b128 v[72:75], v2 offset:2048
    v_cvt_pk_bf16_f32 v51, v102, v103
    v_mfma_f32_16x16x32_bf16 v[212:215], v[84:87], v[56:59], v[212:215]
    v_exp_f32 v109, v109
    v_mfma_f32_16x16x32_bf16 v[244:247], v[84:87], v[60:63], v[244:247]
    ds_read_b128 v[80:83], v2 offset:4096
    v_mfma_f32_16x16x32_bf16 v[216:219], v[88:91], v[56:59], v[216:219]
    v_exp_f32 v110, v110
    v_mfma_f32_16x16x32_bf16 v[248:251], v[88:91], v[60:63], v[248:251]
    v_mfma_f32_16x16x32_bf16 v[32:35], v[36:39], v[60:63], v[32:35]
    ds_read_b128 v[84:87], v2 offset:5120
    v_cvt_pk_bf16_f32 v54, v108, v109
    v_mfma_f32_16x16x32_bf16 v[220:223], v[92:95], v[56:59], v[220:223]
    v_exp_f32 v111, v111
    v_mfma_f32_16x16x32_bf16 v[252:255], v[92:95], v[60:63], v[252:255]
    ds_read_b128 v[88:91], v2 offset:6144
    v_cvt_pk_bf16_f32 v55, v110, v111
    s_bitcmp1_b32 s42, s40
    s_cbranch_scc1 L_recurrent_scan__compressed_kv_cla__moe_arch_mod__prompt_kernel_rare_157
L_recurrent_scan__compressed_kv_cla__moe_arch_mod__prompt_kernel_back_158:
    s_add_u32 s40, s40, 1
    s_cmp_lg_u32 s40, 16
    s_cbranch_scc1 L_body11
    s_lshr_b32 s36, s2, 5
    s_add_u32 s36, s36, 48
    s_lshl_b32 s36, s36, 7
    v_mov_b32 v12, s36
    global_load_dword v11, v12, s[90:91] sc1
    s_sub_u32 s36, 96, s50
    s_cmp_lt_i32 s36, 0
    s_cbranch_scc0 L_recurrent_scan__compressed_kv_cla__moe_arch_mod__prompt_kernel_rare_127
L_recurrent_scan__compressed_kv_cla__moe_arch_mod__prompt_kernel_back_128:
    s_lshl_b32 s37, s28, 13
    v_add_u32 v5, s37, v7
    s_waitcnt lgkmcnt(5)
    v_mfma_f32_16x16x32_bf16 v[192:195], v[64:67], v[48:51], v[192:195]
    v_exp_f32 v112, v112
    v_mfma_f32_16x16x32_bf16 v[224:227], v[64:67], v[52:55], v[224:227]
    ds_read_b128 v[92:95], v3 offset:7168
    v_exp_f32 v113, v113
    v_mfma_f32_16x16x32_bf16 v[196:199], v[68:71], v[48:51], v[196:199]
    v_cvt_pk_bf16_f32 v56, v112, v113
    v_exp_f32 v114, v114
    v_mfma_f32_16x16x32_bf16 v[228:231], v[68:71], v[52:55], v[228:231]
    ds_read_b128 v[64:67], v3 offset:8192
    v_exp_f32 v115, v115
    s_waitcnt lgkmcnt(5)
    v_mfma_f32_16x16x32_bf16 v[200:203], v[72:75], v[48:51], v[200:203]
    v_cvt_pk_bf16_f32 v57, v114, v115
    v_exp_f32 v120, v120
    v_mfma_f32_16x16x32_bf16 v[232:235], v[72:75], v[52:55], v[232:235]
    v_mfma_f32_16x16x32_bf16 v[28:31], v[36:39], v[48:51], v[28:31]
    ds_read_b128 v[68:71], v3 offset:9216
    v_exp_f32 v121, v121
    v_mfma_f32_16x16x32_bf16 v[204:207], v[76:79], v[48:51], v[204:207]
    v_cvt_pk_bf16_f32 v60, v120, v121
    v_exp_f32 v122, v122
    v_mfma_f32_16x16x32_bf16 v[236:239], v[76:79], v[52:55], v[236:239]
    ds_read_b128 v[72:75], v3 offset:10240
    v_exp_f32 v123, v123
    s_waitcnt lgkmcnt(6)
    v_mfma_f32_16x16x32_bf16 v[208:211], v[80:83], v[48:51], v[208:211]
    v_cvt_pk_bf16_f32 v61, v122, v123
    v_exp_f32 v116, v116
    v_mfma_f32_16x16x32_bf16 v[240:243], v[80:83], v[52:55], v[240:243]
    ds_read_b128 v[76:79], v3 offset:11264
    v_exp_f32 v117, v117
    s_waitcnt lgkmcnt(6)
    v_mfma_f32_16x16x32_bf16 v[212:215], v[84:87], v[48:51], v[212:215]
    v_cvt_pk_bf16_f32 v58, v116, v117
    v_exp_f32 v118, v118
    v_mfma_f32_16x16x32_bf16 v[244:247], v[84:87], v[52:55], v[244:247]
    ds_read_b128 v[80:83], v3 offset:12288
    v_exp_f32 v119, v119
    s_waitcnt lgkmcnt(6)
    v_mfma_f32_16x16x32_bf16 v[216:219], v[88:91], v[48:51], v[216:219]
    v_cvt_pk_bf16_f32 v59, v118, v119
    v_exp_f32 v124, v124
    v_mfma_f32_16x16x32_bf16 v[248:251], v[88:91], v[52:55], v[248:251]
    v_mfma_f32_16x16x32_bf16 v[32:35], v[36:39], v[52:55], v[32:35]
    ds_read_b128 v[84:87], v3 offset:13312
    v_exp_f32 v125, v125
    s_waitcnt lgkmcnt(6)
    v_mfma_f32_16x16x32_bf16 v[220:223], v[92:95], v[48:51], v[220:223]
    v_cvt_pk_bf16_f32 v62, v124, v125
    v_exp_f32 v126, v126
    v_mfma_f32_16x16x32_bf16 v[252:255], v[92:95], v[52:55], v[252:255]
    ds_read_b128 v[88:91], v3 offset:14336
    v_exp_f32 v127, v127
    s_nop 0
    v_cvt_pk_bf16_f32 v63, v126, v127
    s_nop 1
    s_waitcnt lgkmcnt(6)
    v_mfma_f32_16x16x32_bf16 v[192:195], v[64:67], v[56:59], v[192:195]
    s_mov_b32 s4, s34
    s_and_b32 s5, s35, 0xffff
    s_mov_b32 s6, 7340032
    s_mov_b32 s7, 0x20000
    s_mov_b32 s8, s32
    v_mfma_f32_16x16x32_bf16 v[224:227], v[64:67], v[60:63], v[224:227]
    ds_read_b128 v[92:95], v3 offset:15360
    s_and_b32 s9, s33, 0xffff
    s_mov_b32 s10, 8388608
    s_mov_b32 s11, 0x20000
    s_lshr_b32 s38, s2, 4
    s_waitcnt lgkmcnt(6)
    v_mfma_f32_16x16x32_bf16 v[196:199], v[68:71], v[56:59], v[196:199]
    s_mul_i32 s38, s38, 224
    s_and_b32 s39, s2, 15
    s_lshl_b32 s39, s39, 7
    v_lshrrev_b32 v25, 3, v1
    s_lshl_b32 s36, s28, 5
    v_mfma_f32_16x16x32_bf16 v[228:231], v[68:71], v[60:63], v[228:231]
    s_add_u32 s36, s36, s38
    v_add_u32 v25, s36, v25
    v_mul_u32_u24 v25, 2048, v25
    v_add_u32 v25, s39, v25
    s_waitcnt lgkmcnt(5)
    v_mfma_f32_16x16x32_bf16 v[200:203], v[72:75], v[56:59], v[200:203]
    v_bfe_u32 v26, v1, 4, 1
    v_lshlrev_b32 v26, 1, v26
    v_and_b32 v27, 7, v1
    v_xor_b32 v26, v26, v27
    v_mfma_f32_16x16x32_bf16 v[232:235], v[72:75], v[60:63], v[232:235]
    v_mfma_f32_16x16x32_bf16 v[28:31], v[36:39], v[56:59], v[28:31]
    v_lshl_add_u32 v24, v26, 4, v25
    v_xor_b32 v26, 4, v26
    v_lshl_add_u32 v25, v26, 4, v25
    v_add_u32 v25, 15360, v25
    v_add_u32 v26, 30720, v24
    s_waitcnt lgkmcnt(4)
    v_mfma_f32_16x16x32_bf16 v[204:207], v[76:79], v[56:59], v[204:207]
    v_add_u32 v27, 30720, v25
    s_lshl_b32 s36, s28, 12
    s_add_u32 s36, s36, 131072
    s_cmp_lt_u32 s28, 7
    s_cselect_b32 m0, s36, 0x30000
    s_cselect_b32 s6, 7340032, 0
    v_mfma_f32_16x16x32_bf16 v[236:239], v[76:79], v[60:63], v[236:239]
    buffer_load_dwordx4 v24, s[4:7], 0 offen offset:0 lds
    buffer_load_dwordx4 v25, s[4:7], 0 offen offset:1024 lds
    buffer_load_dwordx4 v26, s[4:7], 0 offen offset:2048 lds
    buffer_load_dwordx4 v27, s[4:7], 0 offen offset:3072 lds
    s_waitcnt lgkmcnt(3)
    v_mfma_f32_16x16x32_bf16 v[208:211], v[80:83], v[56:59], v[208:211]
    v_mfma_f32_16x16x32_bf16 v[240:243], v[80:83], v[60:63], v[240:243]
    ds_write_b128 v5, v[192:195] offset:0
    s_waitcnt lgkmcnt(3)
    v_mfma_f32_16x16x32_bf16 v[212:215], v[84:87], v[56:59], v[212:215]
    v_mfma_f32_16x16x32_bf16 v[244:247], v[84:87], v[60:63], v[244:247]
    ds_write_b128 v5, v[196:199] offset:1024
    s_waitcnt lgkmcnt(3)
    v_mfma_f32_16x16x32_bf16 v[216:219], v[88:91], v[56:59], v[216:219]
    v_mfma_f32_16x16x32_bf16 v[248:251], v[88:91], v[60:63], v[248:251]
    v_mfma_f32_16x16x32_bf16 v[32:35], v[36:39], v[60:63], v[32:35]
    ds_write_b128 v5, v[200:203] offset:2048
    s_waitcnt lgkmcnt(3)
    v_mfma_f32_16x16x32_bf16 v[220:223], v[92:95], v[56:59], v[220:223]
    v_mfma_f32_16x16x32_bf16 v[252:255], v[92:95], v[60:63], v[252:255]
    ds_write_b128 v5, v[204:207] offset:3072
    ds_write_b128 v5, v[208:211] offset:4096
    ds_write_b128 v5, v[212:215] offset:5120
    v_xor_b32 v106, 32768, v5
    s_lshl_b32 s37, s28, 8
    s_add_u32 s37, s37, 159744
    v_lshl_add_u32 v107, v1, 2, s37
    v_xor_b32 v108, 1024, v107
    ds_write_b128 v5, v[216:219] offset:6144
    ds_write_b128 v5, v[220:223] offset:7168
    ds_write_b32 v107, v28
    s_mov_b32 s36, 0x5d800000
    v_cmp_nge_f32 vcc, s36, v28
    s_nop 0
    s_or_b64 s[52:53], s[52:53], vcc
    v_cmp_nge_f32 vcc, s36, v32
    s_nop 0
    s_or_b64 s[52:53], s[52:53], vcc
    s_or_b32 s36, s52, s53
    v_mov_b32 v110, s36
    s_lshl_b32 s37, s28, 2
    s_add_u32 s37, s37, 161792
    v_mov_b32 v111, s37
    ds_write_b32 v111, v110
    v_mov_b32 v112, 161856
    v_and_b32 v111, 7, v1
    v_lshlrev_b32 v111, 2, v111
    v_add_u32 v111, 161792, v111
    v_mov_b32 v113, v7
    s_sub_u32 s36, 15, s30
    s_lshl_b32 s38, s36, 3
    s_and_b32 s37, s28, 3
    s_lshl_b32 s37, s37, 1
    s_add_u32 s38, s38, s37
    s_add_u32 s38, s38, 1
    s_lshl_b32 s38, s38, 17
    s_lshl_b32 s37, s29, 12
    s_add_u32 s38, s38, s37
    s_waitcnt vmcnt(4)
    v_readfirstlane_b32 s36, v11
    s_nop 0
    s_cmp_lt_u32 s36, 28
    s_cbranch_scc1 L_recurrent_scan__compressed_kv_cla__moe_arch_mod__prompt_kernel_rare_161
L_recurrent_scan__compressed_kv_cla__moe_arch_mod__prompt_kernel_back_162:
    s_lshr_b32 s36, s2, 4
    s_mul_i32 s36, s36, 7
    s_min_u32 s37, s28, 6
    s_add_u32 s36, s36, s37
    s_lshl_b32 s36, s36, 11
    s_add_u32 s36, s36, 58720256
    v_and_b32 v11, 15, v1
    v_lshlrev_b32 v11, 4, v11
    v_lshrrev_b32 v12, 4, v1
    v_lshl_add_u32 v11, v12, 9, v11
    buffer_load_dwordx4 v[96:99], v11, s[24:27], s36 offen offset:0 sc1
    buffer_load_dwordx4 v[100:103], v11, s[24:27], s36 offen offset:256 sc1
    s_waitcnt lgkmcnt(0)
    s_barrier
    ds_read_b128 v[114:117], v112
    ds_read_b32 v110, v111
    ds_read_b32 v109, v108
    ds_read_b128 v[64:67], v106 offset:0
    ds_read_b128 v[68:71], v106 offset:1024
    ds_read_b128 v[72:75], v106 offset:2048
    ds_read_b128 v[76:79], v106 offset:3072
    ds_read_b128 v[80:83], v106 offset:4096
    ds_read_b128 v[84:87], v106 offset:5120
    ds_read_b128 v[88:91], v106 offset:6144
    ds_read_b128 v[92:95], v106 offset:7168
    s_waitcnt lgkmcnt(8)
    v_add_f32 v109, v109, v32
    v_cmp_ne_u32 s[52:53], 0, v110
    v_readfirstlane_b32 s56, v114
    v_readfirstlane_b32 s57, v115
    v_readfirstlane_b32 s58, v116
    v_readfirstlane_b32 s59, v117
    v_rcp_f32 v109, v109
    s_nop 0
    v_mov_b32 v108, v109
    s_waitcnt lgkmcnt(6)
    v_pk_add_f32 v[224:225], v[224:225], v[64:65]
    v_pk_add_f32 v[226:227], v[226:227], v[66:67]
    v_pk_add_f32 v[228:229], v[228:229], v[68:69]
    v_pk_add_f32 v[230:231], v[230:231], v[70:71]
    v_pk_mul_f32 v[224:225], v[224:225], v[108:109]
    v_pk_mul_f32 v[226:227], v[226:227], v[108:109]
    v_pk_mul_f32 v[228:229], v[228:229], v[108:109]
    v_pk_mul_f32 v[230:231], v[230:231], v[108:109]
    v_cvt_pk_bf16_f32 v48, v224, v225
    v_cvt_pk_bf16_f32 v49, v226, v227
    v_cvt_pk_bf16_f32 v50, v228, v229
    v_cvt_pk_bf16_f32 v51, v230, v231
    buffer_store_dwordx4 v[48:51], v113, s[16:19], s38 offen offset:0 sc1
    s_waitcnt lgkmcnt(4)
    v_pk_add_f32 v[232:233], v[232:233], v[72:73]
    v_pk_add_f32 v[234:235], v[234:235], v[74:75]
    v_pk_add_f32 v[236:237], v[236:237], v[76:77]
    v_pk_add_f32 v[238:239], v[238:239], v[78:79]
    v_pk_mul_f32 v[232:233], v[232:233], v[108:109]
    v_pk_mul_f32 v[234:235], v[234:235], v[108:109]
    v_pk_mul_f32 v[236:237], v[236:237], v[108:109]
    v_pk_mul_f32 v[238:239], v[238:239], v[108:109]
    v_cvt_pk_bf16_f32 v52, v232, v233
    v_cvt_pk_bf16_f32 v53, v234, v235
    v_cvt_pk_bf16_f32 v54, v236, v237
    v_cvt_pk_bf16_f32 v55, v238, v239
    buffer_store_dwordx4 v[52:55], v113, s[16:19], s38 offen offset:1024 sc1
    s_waitcnt lgkmcnt(2)
    v_pk_add_f32 v[240:241], v[240:241], v[80:81]
    v_pk_add_f32 v[242:243], v[242:243], v[82:83]
    v_pk_add_f32 v[244:245], v[244:245], v[84:85]
    v_pk_add_f32 v[246:247], v[246:247], v[86:87]
    v_pk_mul_f32 v[240:241], v[240:241], v[108:109]
    v_pk_mul_f32 v[242:243], v[242:243], v[108:109]
    v_pk_mul_f32 v[244:245], v[244:245], v[108:109]
    v_pk_mul_f32 v[246:247], v[246:247], v[108:109]
    v_cvt_pk_bf16_f32 v56, v240, v241
    v_cvt_pk_bf16_f32 v57, v242, v243
    v_cvt_pk_bf16_f32 v58, v244, v245
    v_cvt_pk_bf16_f32 v59, v246, v247
    buffer_store_dwordx4 v[56:59], v113, s[16:19], s38 offen offset:2048 sc1
    s_waitcnt lgkmcnt(0)
    v_pk_add_f32 v[248:249], v[248:249], v[88:89]
    v_pk_add_f32 v[250:251], v[250:251], v[90:91]
    v_pk_add_f32 v[252:253], v[252:253], v[92:93]
    v_pk_add_f32 v[254:255], v[254:255], v[94:95]
    v_pk_mul_f32 v[248:249], v[248:249], v[108:109]
    v_pk_mul_f32 v[250:251], v[250:251], v[108:109]
    v_pk_mul_f32 v[252:253], v[252:253], v[108:109]
    v_pk_mul_f32 v[254:255], v[254:255], v[108:109]
    v_cvt_pk_bf16_f32 v60, v248, v249
    v_cvt_pk_bf16_f32 v61, v250, v251
    v_cvt_pk_bf16_f32 v62, v252, v253
    v_cvt_pk_bf16_f32 v63, v254, v255
    buffer_store_dwordx4 v[60:63], v113, s[16:19], s38 offen offset:3072 sc1
    s_cmp_eq_u64 s[52:53], 0
    s_cbranch_scc1 L_p3_done
    s_waitcnt vmcnt(0)
    v_mov_b32 v112, v96
    v_mov_b32 v113, v97
    v_mov_b32 v114, v98
    v_mov_b32 v115, v99
    v_mov_b32 v116, v100
    v_mov_b32 v117, v101
    v_mov_b32 v118, v102
    v_mov_b32 v119, v103
    v_mov_b32 v192, 0
    v_mov_b32 v193, 0
    v_mov_b32 v194, 0
    v_mov_b32 v195, 0
    v_mov_b32 v196, 0
    v_mov_b32 v197, 0
    v_mov_b32 v198, 0
    v_mov_b32 v199, 0
    v_mov_b32 v200, 0
    v_mov_b32 v201, 0
    v_mov_b32 v202, 0
    v_mov_b32 v203, 0
    v_mov_b32 v204, 0
    v_mov_b32 v205, 0
    v_mov_b32 v206, 0
    v_mov_b32 v207, 0
    v_mov_b32 v208, 0
    v_mov_b32 v209, 0
    v_mov_b32 v210, 0
    v_mov_b32 v211, 0
    v_mov_b32 v212, 0
    v_mov_b32 v213, 0
    v_mov_b32 v214, 0
    v_mov_b32 v215, 0
    v_mov_b32 v216, 0
    v_mov_b32 v217, 0
    v_mov_b32 v218, 0
    v_mov_b32 v219, 0
    v_mov_b32 v220, 0
    v_mov_b32 v221, 0
    v_mov_b32 v222, 0
    v_mov_b32 v223, 0
    v_mov_b32 v224, 0
    v_mov_b32 v225, 0
    v_mov_b32 v226, 0
    v_mov_b32 v227, 0
    v_mov_b32 v228, 0
    v_mov_b32 v229, 0
    v_mov_b32 v230, 0
    v_mov_b32 v231, 0
    v_mov_b32 v232, 0
    v_mov_b32 v233, 0
    v_mov_b32 v234, 0
    v_mov_b32 v235, 0
    v_mov_b32 v236, 0
    v_mov_b32 v237, 0
    v_mov_b32 v238, 0
    v_mov_b32 v239, 0
    v_mov_b32 v240, 0
    v_mov_b32 v241, 0
    v_mov_b32 v242, 0
    v_mov_b32 v243, 0
    v_mov_b32 v244, 0
    v_mov_b32 v245, 0
    v_mov_b32 v246, 0
    v_mov_b32 v247, 0
    v_mov_b32 v248, 0
    v_mov_b32 v249, 0
    v_mov_b32 v250, 0
    v_mov_b32 v251, 0
    v_mov_b32 v252, 0
    v_mov_b32 v253, 0
    v_mov_b32 v254, 0
    v_mov_b32 v255, 0
    v_mov_b32 v28, 0
    v_mov_b32 v40, 4048155338
    v_mov_b32 v32, 0
    v_mov_b32 v41, 4048155338
    s_lshl_b32 s43, s28, 12
    v_add_u32 v4, s43, v7
    s_mov_b32 s46, s45
    s_sub_u32 s40, 16, s30
    s_mov_b32 s39, s30
    s_lshl_b32 s37, s39, 7
    s_and_b32 s36, s28, 3
    s_lshl_b32 s36, s36, 5
    s_add_u32 s36, s36, s37
    s_sub_u32 s50, 0, s36
L_recurrent_scan__compressed_kv_cla__moe_arch_mod__prompt_kernel_stile_163:
    s_waitcnt vmcnt(0) lgkmcnt(0)
    s_barrier
    s_mov_b32 m0, s43
    s_add_u32 s47, s46, 32768
    buffer_load_dwordx4 v4, s[12:15], s46 offen offset:0 sc1 lds
    buffer_load_dwordx4 v4, s[12:15], s46 offen offset:1024 sc1 lds
    buffer_load_dwordx4 v4, s[12:15], s46 offen offset:2048 sc1 lds
    buffer_load_dwordx4 v4, s[12:15], s46 offen offset:3072 sc1 lds
    s_add_u32 m0, s43, 32768
    s_add_u32 s46, s46, 65536
    buffer_load_dwordx4 v4, s[12:15], s47 offen offset:0 sc1 lds
    buffer_load_dwordx4 v4, s[12:15], s47 offen offset:1024 sc1 lds
    buffer_load_dwordx4 v4, s[12:15], s47 offen offset:2048 sc1 lds
    buffer_load_dwordx4 v4, s[12:15], s47 offen offset:3072 sc1 lds
    v_mov_b32 v2, v7
    s_mov_b32 s41, 4
    s_waitcnt vmcnt(0)
    s_barrier
L_recurrent_scan__compressed_kv_cla__moe_arch_mod__prompt_kernel_sunit_164:
    s_cmp_gt_i32 s50, 0
    s_cbranch_scc1 L_recurrent_scan__compressed_kv_cla__moe_arch_mod__prompt_kernel_snext_165
    ds_read_b128 v[64:67], v2 offset:0
    ds_read_b128 v[68:71], v2 offset:1024
    ds_read_b128 v[72:75], v2 offset:2048
    ds_read_b128 v[76:79], v2 offset:3072
    ds_read_b128 v[80:83], v2 offset:4096
    ds_read_b128 v[84:87], v2 offset:5120
    ds_read_b128 v[88:91], v2 offset:6144
    ds_read_b128 v[92:95], v2 offset:7168
    s_waitcnt lgkmcnt(0)
    v_mfma_f32_16x16x32_bf16 v[96:99], v[64:67], v[128:131], 0
    v_mfma_f32_16x16x32_bf16 v[104:107], v[64:67], v[144:147], 0
    v_mfma_f32_16x16x32_bf16 v[96:99], v[68:71], v[132:135], v[96:99]
    v_mfma_f32_16x16x32_bf16 v[104:107], v[68:71], v[148:151], v[104:107]
    v_mfma_f32_16x16x32_bf16 v[96:99], v[72:75], v[136:139], v[96:99]
    v_mfma_f32_16x16x32_bf16 v[104:107], v[72:75], v[152:155], v[104:107]
    v_mfma_f32_16x16x32_bf16 v[96:99], v[76:79], v[140:143], v[96:99]
    v_mfma_f32_16x16x32_bf16 v[104:107], v[76:79], v[156:159], v[104:107]
    v_mfma_f32_16x16x32_bf16 v[100:103], v[80:83], v[128:131], 0
    v_mfma_f32_16x16x32_bf16 v[108:111], v[80:83], v[144:147], 0
    v_mfma_f32_16x16x32_bf16 v[100:103], v[84:87], v[132:135], v[100:103]
    v_mfma_f32_16x16x32_bf16 v[108:111], v[84:87], v[148:151], v[108:111]
    v_mfma_f32_16x16x32_bf16 v[100:103], v[88:91], v[136:139], v[100:103]
    v_mfma_f32_16x16x32_bf16 v[108:111], v[88:91], v[152:155], v[108:111]
    v_mfma_f32_16x16x32_bf16 v[100:103], v[92:95], v[140:143], v[100:103]
    v_mfma_f32_16x16x32_bf16 v[108:111], v[92:95], v[156:159], v[108:111]
    ds_read_b128 v[64:67], v2 offset:32768
    ds_read_b128 v[68:71], v2 offset:33792
    ds_read_b128 v[72:75], v2 offset:34816
    ds_read_b128 v[76:79], v2 offset:35840
    ds_read_b128 v[80:83], v2 offset:36864
    ds_read_b128 v[84:87], v2 offset:37888
    ds_read_b128 v[88:91], v2 offset:38912
    ds_read_b128 v[92:95], v2 offset:39936
    s_nop 1
    s_cmp_lt_i32 s50, 0
    s_cbranch_scc0 L_recurrent_scan__compressed_kv_cla__moe_arch_mod__prompt_kernel_rare_168
L_recurrent_scan__compressed_kv_cla__moe_arch_mod__prompt_kernel_back_169:
    v_max3_f32 v22, v96, v97, v98
    v_max3_f32 v22, v22, v99, v100
    v_max3_f32 v22, v22, v101, v102
    v_max3_f32 v22, v22, v103, v40
    v_mov_b32 v24, v22
    s_nop 1
    v_permlane16_swap_b32 v22, v24
    s_nop 1
    v_max_f32 v22, v22, v24
    v_mov_b32 v24, v22
    s_nop 1
    v_permlane32_swap_b32 v22, v24
    s_nop 1
    v_max_f32 v22, v22, v24
    v_sub_f32 v25, v40, v22
    v_exp_f32 v25, v25
    v_mov_b32 v40, v22
    v_mul_f32 v28, v28, v25
    v_mul_f32 v192, v192, v25
    v_mul_f32 v193, v193, v25
    v_mul_f32 v194, v194, v25
    v_mul_f32 v195, v195, v25
    v_mul_f32 v196, v196, v25
    v_mul_f32 v197, v197, v25
    v_mul_f32 v198, v198, v25
    v_mul_f32 v199, v199, v25
    v_mul_f32 v200, v200, v25
    v_mul_f32 v201, v201, v25
    v_mul_f32 v202, v202, v25
    v_mul_f32 v203, v203, v25
    v_mul_f32 v204, v204, v25
    v_mul_f32 v205, v205, v25
    v_mul_f32 v206, v206, v25
    v_mul_f32 v207, v207, v25
    v_mul_f32 v208, v208, v25
    v_mul_f32 v209, v209, v25
    v_mul_f32 v210, v210, v25
    v_mul_f32 v211, v211, v25
    v_mul_f32 v212, v212, v25
    v_mul_f32 v213, v213, v25
    v_mul_f32 v214, v214, v25
    v_mul_f32 v215, v215, v25
    v_mul_f32 v216, v216, v25
    v_mul_f32 v217, v217, v25
    v_mul_f32 v218, v218, v25
    v_mul_f32 v219, v219, v25
    v_mul_f32 v220, v220, v25
    v_mul_f32 v221, v221, v25
    v_mul_f32 v222, v222, v25
    v_mul_f32 v223, v223, v25
    v_sub_f32 v96, v96, v22
    v_sub_f32 v97, v97, v22
    v_sub_f32 v98, v98, v22
    v_sub_f32 v99, v99, v22
    v_sub_f32 v100, v100, v22
    v_sub_f32 v101, v101, v22
    v_sub_f32 v102, v102, v22
    v_sub_f32 v103, v103, v22
    v_max3_f32 v23, v104, v105, v106
    v_max3_f32 v23, v23, v107, v108
    v_max3_f32 v23, v23, v109, v110
    v_max3_f32 v23, v23, v111, v41
    v_mov_b32 v24, v23
    s_nop 1
    v_permlane16_swap_b32 v23, v24
    s_nop 1
    v_max_f32 v23, v23, v24
    v_mov_b32 v24, v23
    s_nop 1
    v_permlane32_swap_b32 v23, v24
    s_nop 1
    v_max_f32 v23, v23, v24
    v_sub_f32 v25, v41, v23
    v_exp_f32 v25, v25
    v_mov_b32 v41, v23
    v_mul_f32 v32, v32, v25
    v_mul_f32 v224, v224, v25
    v_mul_f32 v225, v225, v25
    v_mul_f32 v226, v226, v25
    v_mul_f32 v227, v227, v25
    v_mul_f32 v228, v228, v25
    v_mul_f32 v229, v229, v25
    v_mul_f32 v230, v230, v25
    v_mul_f32 v231, v231, v25
    v_mul_f32 v232, v232, v25
    v_mul_f32 v233, v233, v25
    v_mul_f32 v234, v234, v25
    v_mul_f32 v235, v235, v25
    v_mul_f32 v236, v236, v25
    v_mul_f32 v237, v237, v25
    v_mul_f32 v238, v238, v25
    v_mul_f32 v239, v239, v25
    v_mul_f32 v240, v240, v25
    v_mul_f32 v241, v241, v25
    v_mul_f32 v242, v242, v25
    v_mul_f32 v243, v243, v25
    v_mul_f32 v244, v244, v25
    v_mul_f32 v245, v245, v25
    v_mul_f32 v246, v246, v25
    v_mul_f32 v247, v247, v25
    v_mul_f32 v248, v248, v25
    v_mul_f32 v249, v249, v25
    v_mul_f32 v250, v250, v25
    v_mul_f32 v251, v251, v25
    v_mul_f32 v252, v252, v25
    v_mul_f32 v253, v253, v25
    v_mul_f32 v254, v254, v25
    v_mul_f32 v255, v255, v25
    v_sub_f32 v104, v104, v23
    v_sub_f32 v105, v105, v23
    v_sub_f32 v106, v106, v23
    v_sub_f32 v107, v107, v23
    v_sub_f32 v108, v108, v23
    v_sub_f32 v109, v109, v23
    v_sub_f32 v110, v110, v23
    v_sub_f32 v111, v111, v23
    v_exp_f32 v96, v96
    v_exp_f32 v97, v97
    v_exp_f32 v98, v98
    v_exp_f32 v99, v99
    v_exp_f32 v104, v104
    v_exp_f32 v105, v105
    v_exp_f32 v106, v106
    v_exp_f32 v107, v107
    v_exp_f32 v100, v100
    v_exp_f32 v101, v101
    v_exp_f32 v102, v102
    v_exp_f32 v103, v103
    v_exp_f32 v108, v108
    v_exp_f32 v109, v109
    v_exp_f32 v110, v110
    v_exp_f32 v111, v111
    v_add_f32 v28, v28, v96
    v_add_f32 v28, v28, v97
    v_cvt_pk_bf16_f32 v48, v96, v97
    v_add_f32 v28, v28, v98
    v_add_f32 v28, v28, v99
    v_cvt_pk_bf16_f32 v49, v98, v99
    v_add_f32 v32, v32, v104
    v_add_f32 v32, v32, v105
    v_cvt_pk_bf16_f32 v52, v104, v105
    v_add_f32 v32, v32, v106
    v_add_f32 v32, v32, v107
    v_cvt_pk_bf16_f32 v53, v106, v107
    v_add_f32 v28, v28, v100
    v_add_f32 v28, v28, v101
    v_cvt_pk_bf16_f32 v50, v100, v101
    v_add_f32 v28, v28, v102
    v_add_f32 v28, v28, v103
    v_cvt_pk_bf16_f32 v51, v102, v103
    v_add_f32 v32, v32, v108
    v_add_f32 v32, v32, v109
    v_cvt_pk_bf16_f32 v54, v108, v109
    v_add_f32 v32, v32, v110
    v_add_f32 v32, v32, v111
    v_cvt_pk_bf16_f32 v55, v110, v111
    s_waitcnt lgkmcnt(0)
    s_nop 0
    v_mfma_f32_16x16x32_bf16 v[192:195], v[64:67], v[48:51], v[192:195]
    v_mfma_f32_16x16x32_bf16 v[224:227], v[64:67], v[52:55], v[224:227]
    v_mfma_f32_16x16x32_bf16 v[196:199], v[68:71], v[48:51], v[196:199]
    v_mfma_f32_16x16x32_bf16 v[228:231], v[68:71], v[52:55], v[228:231]
    v_mfma_f32_16x16x32_bf16 v[200:203], v[72:75], v[48:51], v[200:203]
    v_mfma_f32_16x16x32_bf16 v[232:235], v[72:75], v[52:55], v[232:235]
    v_mfma_f32_16x16x32_bf16 v[204:207], v[76:79], v[48:51], v[204:207]
    v_mfma_f32_16x16x32_bf16 v[236:239], v[76:79], v[52:55], v[236:239]
    v_mfma_f32_16x16x32_bf16 v[208:211], v[80:83], v[48:51], v[208:211]
    v_mfma_f32_16x16x32_bf16 v[240:243], v[80:83], v[52:55], v[240:243]
    v_mfma_f32_16x16x32_bf16 v[212:215], v[84:87], v[48:51], v[212:215]
    v_mfma_f32_16x16x32_bf16 v[244:247], v[84:87], v[52:55], v[244:247]
    v_mfma_f32_16x16x32_bf16 v[216:219], v[88:91], v[48:51], v[216:219]
    v_mfma_f32_16x16x32_bf16 v[248:251], v[88:91], v[52:55], v[248:251]
    v_mfma_f32_16x16x32_bf16 v[220:223], v[92:95], v[48:51], v[220:223]
    v_mfma_f32_16x16x32_bf16 v[252:255], v[92:95], v[52:55], v[252:255]
L_recurrent_scan__compressed_kv_cla__moe_arch_mod__prompt_kernel_snext_165:
    v_add_u32 v2, 8192, v2
    s_add_u32 s50, s50, 32
    s_sub_u32 s41, s41, 1
    s_cmp_lg_u32 s41, 0
    s_cbranch_scc1 L_recurrent_scan__compressed_kv_cla__moe_arch_mod__prompt_kernel_sunit_164
    s_sub_u32 s40, s40, 1
    s_cmp_lg_u32 s40, 0
    s_cbranch_scc1 L_recurrent_scan__compressed_kv_cla__moe_arch_mod__prompt_kernel_stile_163
    v_mov_b32 v20, v28
    s_nop 1
    v_permlane16_swap_b32 v28, v20
    s_nop 1
    v_add_f32 v28, v28, v20
    v_mov_b32 v20, v28
    s_nop 1
    v_permlane32_swap_b32 v28, v20
    s_nop 1
    v_add_f32 v28, v28, v20
    v_mov_b32 v20, v32
    s_nop 1
    v_permlane16_swap_b32 v32, v20
    s_nop 1
    v_add_f32 v32, v32, v20
    v_mov_b32 v20, v32
    s_nop 1
    v_permlane32_swap_b32 v32, v20
    s_nop 1
    v_add_f32 v32, v32, v20
    s_mov_b32 s36, 0x5d800000
    v_cmp_nge_f32 vcc, s36, v28
    s_nop 0
    s_or_b64 s[52:53], s[52:53], vcc
    v_cmp_nge_f32 vcc, s36, v32
    s_nop 0
    s_or_b64 s[52:53], s[52:53], vcc
    v_rcp_f32 v20, v28
    v_rcp_f32 v22, v32
    s_lshl_b32 s38, s39, 3
    s_and_b32 s37, s28, 3
    s_lshl_b32 s37, s37, 1
    s_add_u32 s38, s38, s37
    s_lshl_b32 s38, s38, 17
    s_lshl_b32 s37, s29, 12
    s_add_u32 s38, s38, s37
    v_mov_b32 v21, v20
    v_mov_b32 v23, v22
    v_mov_b32 v24, v7
    v_pk_mul_f32 v[192:193], v[192:193], v[20:21]
    v_pk_mul_f32 v[194:195], v[194:195], v[20:21]
    v_pk_mul_f32 v[196:197], v[196:197], v[20:21]
    v_pk_mul_f32 v[198:199], v[198:199], v[20:21]
    v_cvt_pk_bf16_f32 v192, v192, v193
    v_cvt_pk_bf16_f32 v193, v194, v195
    v_cvt_pk_bf16_f32 v194, v196, v197
    v_cvt_pk_bf16_f32 v195, v198, v199
    buffer_store_dwordx4 v[192:195], v24, s[16:19], s38 offen offset:0 sc1
    v_pk_mul_f32 v[200:201], v[200:201], v[20:21]
    v_pk_mul_f32 v[202:203], v[202:203], v[20:21]
    v_pk_mul_f32 v[204:205], v[204:205], v[20:21]
    v_pk_mul_f32 v[206:207], v[206:207], v[20:21]
    v_cvt_pk_bf16_f32 v200, v200, v201
    v_cvt_pk_bf16_f32 v201, v202, v203
    v_cvt_pk_bf16_f32 v202, v204, v205
    v_cvt_pk_bf16_f32 v203, v206, v207
    buffer_store_dwordx4 v[200:203], v24, s[16:19], s38 offen offset:1024 sc1
    v_pk_mul_f32 v[208:209], v[208:209], v[20:21]
    v_pk_mul_f32 v[210:211], v[210:211], v[20:21]
    v_pk_mul_f32 v[212:213], v[212:213], v[20:21]
    v_pk_mul_f32 v[214:215], v[214:215], v[20:21]
    v_cvt_pk_bf16_f32 v208, v208, v209
    v_cvt_pk_bf16_f32 v209, v210, v211
    v_cvt_pk_bf16_f32 v210, v212, v213
    v_cvt_pk_bf16_f32 v211, v214, v215
    buffer_store_dwordx4 v[208:211], v24, s[16:19], s38 offen offset:2048 sc1
    v_pk_mul_f32 v[216:217], v[216:217], v[20:21]
    v_pk_mul_f32 v[218:219], v[218:219], v[20:21]
    v_pk_mul_f32 v[220:221], v[220:221], v[20:21]
    v_pk_mul_f32 v[222:223], v[222:223], v[20:21]
    v_cvt_pk_bf16_f32 v216, v216, v217
    v_cvt_pk_bf16_f32 v217, v218, v219
    v_cvt_pk_bf16_f32 v218, v220, v221
    v_cvt_pk_bf16_f32 v219, v222, v223
    buffer_store_dwordx4 v[216:219], v24, s[16:19], s38 offen offset:3072 sc1
    s_add_u32 s38, s38, 131072
    v_pk_mul_f32 v[224:225], v[224:225], v[22:23]
    v_pk_mul_f32 v[226:227], v[226:227], v[22:23]
    v_pk_mul_f32 v[228:229], v[228:229], v[22:23]
    v_pk_mul_f32 v[230:231], v[230:231], v[22:23]
    v_cvt_pk_bf16_f32 v224, v224, v225
    v_cvt_pk_bf16_f32 v225, v226, v227
    v_cvt_pk_bf16_f32 v226, v228, v229
    v_cvt_pk_bf16_f32 v227, v230, v231
    buffer_store_dwordx4 v[224:227], v24, s[16:19], s38 offen offset:0 sc1
    v_pk_mul_f32 v[232:233], v[232:233], v[22:23]
    v_pk_mul_f32 v[234:235], v[234:235], v[22:23]
    v_pk_mul_f32 v[236:237], v[236:237], v[22:23]
    v_pk_mul_f32 v[238:239], v[238:239], v[22:23]
    v_cvt_pk_bf16_f32 v232, v232, v233
    v_cvt_pk_bf16_f32 v233, v234, v235
    v_cvt_pk_bf16_f32 v234, v236, v237
    v_cvt_pk_bf16_f32 v235, v238, v239
    buffer_store_dwordx4 v[232:235], v24, s[16:19], s38 offen offset:1024 sc1
    v_pk_mul_f32 v[240:241], v[240:241], v[22:23]
    v_pk_mul_f32 v[242:243], v[242:243], v[22:23]
    v_pk_mul_f32 v[244:245], v[244:245], v[22:23]
    v_pk_mul_f32 v[246:247], v[246:247], v[22:23]
    v_cvt_pk_bf16_f32 v240, v240, v241
    v_cvt_pk_bf16_f32 v241, v242, v243
    v_cvt_pk_bf16_f32 v242, v244, v245
    v_cvt_pk_bf16_f32 v243, v246, v247
    buffer_store_dwordx4 v[240:243], v24, s[16:19], s38 offen offset:2048 sc1
    v_pk_mul_f32 v[248:249], v[248:249], v[22:23]
    v_pk_mul_f32 v[250:251], v[250:251], v[22:23]
    v_pk_mul_f32 v[252:253], v[252:253], v[22:23]
    v_pk_mul_f32 v[254:255], v[254:255], v[22:23]
    v_cvt_pk_bf16_f32 v248, v248, v249
    v_cvt_pk_bf16_f32 v249, v250, v251
    v_cvt_pk_bf16_f32 v250, v252, v253
    v_cvt_pk_bf16_f32 v251, v254, v255
    buffer_store_dwordx4 v[248:251], v24, s[16:19], s38 offen offset:3072 sc1
    v_mov_b32 v96, v112
    v_mov_b32 v97, v113
    v_mov_b32 v98, v114
    v_mov_b32 v99, v115
    v_mov_b32 v100, v116
    v_mov_b32 v101, v117
    v_mov_b32 v102, v118
    v_mov_b32 v103, v119
    s_branch L_p3_done
L_recurrent_scan__compressed_kv_cla__moe_arch_mod__prompt_kernel_rare_108:
    s_cmp_lt_i32 s36, 0
    s_cbranch_scc1 L_recurrent_scan__compressed_kv_cla__moe_arch_mod__prompt_kernel_nm_107
    v_mov_b32 v20, 4048155338
    s_cmp_gt_i32 s36, 0
    s_cbranch_scc1 L_recurrent_scan__compressed_kv_cla__moe_arch_mod__prompt_kernel_mf_105
    v_cmp_gt_i32 s[20:21], 0, v18
    v_cmp_gt_i32 s[22:23], 1, v18
    v_cmp_gt_i32 s[62:63], 2, v18
    v_cmp_gt_i32 vcc, 3, v18
    v_mov_b32 v100, v20
    v_mov_b32 v101, v20
    v_mov_b32 v102, v20
    v_mov_b32 v103, v20
    v_cndmask_b32 v96, v96, v20, s[20:21]
    v_cndmask_b32 v97, v97, v20, s[22:23]
    v_cndmask_b32 v98, v98, v20, s[62:63]
    v_cndmask_b32 v99, v99, v20, vcc
    v_cndmask_b32 v108, v108, v20, s[20:21]
    v_cndmask_b32 v109, v109, v20, s[22:23]
    v_cndmask_b32 v110, v110, v20, s[62:63]
    v_cndmask_b32 v111, v111, v20, vcc
    s_branch L_recurrent_scan__compressed_kv_cla__moe_arch_mod__prompt_kernel_me_106
L_recurrent_scan__compressed_kv_cla__moe_arch_mod__prompt_kernel_mf_105:
    v_mov_b32 v96, v20
    v_mov_b32 v97, v20
    v_mov_b32 v98, v20
    v_mov_b32 v99, v20
    v_mov_b32 v100, v20
    v_mov_b32 v101, v20
    v_mov_b32 v102, v20
    v_mov_b32 v103, v20
    v_mov_b32 v104, v20
    v_mov_b32 v105, v20
    v_mov_b32 v106, v20
    v_mov_b32 v107, v20
    v_mov_b32 v108, v20
    v_mov_b32 v109, v20
    v_mov_b32 v110, v20
    v_mov_b32 v111, v20
L_recurrent_scan__compressed_kv_cla__moe_arch_mod__prompt_kernel_me_106:
L_recurrent_scan__compressed_kv_cla__moe_arch_mod__prompt_kernel_nm_107:
    s_branch L_recurrent_scan__compressed_kv_cla__moe_arch_mod__prompt_kernel_back_109
L_recurrent_scan__compressed_kv_cla__moe_arch_mod__prompt_kernel_rare_117:
    s_add_u32 s36, s40, 1
    s_sub_u32 s36, s36, s51
    s_cmp_lt_u32 s36, 2
    s_cbranch_scc0 L_recurrent_scan__compressed_kv_cla__moe_arch_mod__prompt_kernel_r_111
    s_lshl_b32 s36, s36, 6
    s_add_u32 s36, s36, 32
    s_sub_u32 s36, s36, s50
    s_cmp_lt_i32 s36, 0
    s_cbranch_scc1 L_recurrent_scan__compressed_kv_cla__moe_arch_mod__prompt_kernel_nm_116
    v_mov_b32 v20, 4048155338
    s_cmp_gt_i32 s36, 0
    s_cbranch_scc1 L_recurrent_scan__compressed_kv_cla__moe_arch_mod__prompt_kernel_mf_114
    v_cmp_gt_i32 s[20:21], 0, v18
    v_cmp_gt_i32 s[22:23], 1, v18
    v_cmp_gt_i32 s[62:63], 2, v18
    v_cmp_gt_i32 vcc, 3, v18
    v_mov_b32 v116, v20
    v_mov_b32 v117, v20
    v_mov_b32 v118, v20
    v_mov_b32 v119, v20
    v_cndmask_b32 v112, v112, v20, s[20:21]
    v_cndmask_b32 v113, v113, v20, s[22:23]
    v_cndmask_b32 v114, v114, v20, s[62:63]
    v_cndmask_b32 v115, v115, v20, vcc
    v_cndmask_b32 v124, v124, v20, s[20:21]
    v_cndmask_b32 v125, v125, v20, s[22:23]
    v_cndmask_b32 v126, v126, v20, s[62:63]
    v_cndmask_b32 v127, v127, v20, vcc
    s_branch L_recurrent_scan__compressed_kv_cla__moe_arch_mod__prompt_kernel_me_115
L_recurrent_scan__compressed_kv_cla__moe_arch_mod__prompt_kernel_mf_114:
    v_mov_b32 v112, v20
    v_mov_b32 v113, v20
    v_mov_b32 v114, v20
    v_mov_b32 v115, v20
    v_mov_b32 v116, v20
    v_mov_b32 v117, v20
    v_mov_b32 v118, v20
    v_mov_b32 v119, v20
    v_mov_b32 v120, v20
    v_mov_b32 v121, v20
    v_mov_b32 v122, v20
    v_mov_b32 v123, v20
    v_mov_b32 v124, v20
    v_mov_b32 v125, v20
    v_mov_b32 v126, v20
    v_mov_b32 v127, v20
L_recurrent_scan__compressed_kv_cla__moe_arch_mod__prompt_kernel_me_115:
L_recurrent_scan__compressed_kv_cla__moe_arch_mod__prompt_kernel_nm_116:
L_recurrent_scan__compressed_kv_cla__moe_arch_mod__prompt_kernel_r_111:
    s_branch L_recurrent_scan__compressed_kv_cla__moe_arch_mod__prompt_kernel_back_118
L_recurrent_scan__compressed_kv_cla__moe_arch_mod__prompt_kernel_rare_122:
    s_add_u32 s36, s40, 2
    s_sub_u32 s36, s36, s51
    s_cmp_eq_u32 s36, 1
    s_cselect_b32 s41, 0x8000, s41
    s_cmp_eq_u32 s40, 15
    s_cbranch_scc0 L_recurrent_scan__compressed_kv_cla__moe_arch_mod__prompt_kernel_r_112
    s_mov_b32 s41, 65536
    s_mov_b32 s49, 0x1ffff
    s_mov_b32 s36, 1
L_recurrent_scan__compressed_kv_cla__moe_arch_mod__prompt_kernel_r_112:
    s_cmp_lt_u32 s36, 2
    s_cbranch_scc0 L_recurrent_scan__compressed_kv_cla__moe_arch_mod__prompt_kernel_r_113
    s_lshl_b32 s36, s36, 6
    s_sub_u32 s36, s36, s50
    s_cmp_lt_i32 s36, 0
    s_cbranch_scc1 L_recurrent_scan__compressed_kv_cla__moe_arch_mod__prompt_kernel_nm_121
    v_mov_b32 v20, 4048155338
    s_cmp_gt_i32 s36, 0
    s_cbranch_scc1 L_recurrent_scan__compressed_kv_cla__moe_arch_mod__prompt_kernel_mf_119
    v_cmp_gt_i32 s[20:21], 0, v18
    v_cmp_gt_i32 s[22:23], 1, v18
    v_cmp_gt_i32 s[62:63], 2, v18
    v_cmp_gt_i32 vcc, 3, v18
    v_mov_b32 v100, v20
    v_mov_b32 v101, v20
    v_mov_b32 v102, v20
    v_mov_b32 v103, v20
    v_cndmask_b32 v96, v96, v20, s[20:21]
    v_cndmask_b32 v97, v97, v20, s[22:23]
    v_cndmask_b32 v98, v98, v20, s[62:63]
    v_cndmask_b32 v99, v99, v20, vcc
    v_cndmask_b32 v108, v108, v20, s[20:21]
    v_cndmask_b32 v109, v109, v20, s[22:23]
    v_cndmask_b32 v110, v110, v20, s[62:63]
    v_cndmask_b32 v111, v111, v20, vcc
    s_branch L_recurrent_scan__compressed_kv_cla__moe_arch_mod__prompt_kernel_me_120
L_recurrent_scan__compressed_kv_cla__moe_arch_mod__prompt_kernel_mf_119:
    v_mov_b32 v96, v20
    v_mov_b32 v97, v20
    v_mov_b32 v98, v20
    v_mov_b32 v99, v20
    v_mov_b32 v100, v20
    v_mov_b32 v101, v20
    v_mov_b32 v102, v20
    v_mov_b32 v103, v20
    v_mov_b32 v104, v20
    v_mov_b32 v105, v20
    v_mov_b32 v106, v20
    v_mov_b32 v107, v20
    v_mov_b32 v108, v20
    v_mov_b32 v109, v20
    v_mov_b32 v110, v20
    v_mov_b32 v111, v20
L_recurrent_scan__compressed_kv_cla__moe_arch_mod__prompt_kernel_me_120:
L_recurrent_scan__compressed_kv_cla__moe_arch_mod__prompt_kernel_nm_121:
L_recurrent_scan__compressed_kv_cla__moe_arch_mod__prompt_kernel_r_113:
    s_branch L_recurrent_scan__compressed_kv_cla__moe_arch_mod__prompt_kernel_back_123
L_recurrent_scan__compressed_kv_cla__moe_arch_mod__prompt_kernel_rare_127:
    v_mov_b32 v20, 4048155338
    s_cmp_gt_i32 s36, 0
    s_cbranch_scc1 L_recurrent_scan__compressed_kv_cla__moe_arch_mod__prompt_kernel_mf_125
    v_cmp_gt_i32 s[20:21], 0, v18
    v_cmp_gt_i32 s[22:23], 1, v18
    v_cmp_gt_i32 s[62:63], 2, v18
    v_cmp_gt_i32 vcc, 3, v18
    v_mov_b32 v116, v20
    v_mov_b32 v117, v20
    v_mov_b32 v118, v20
    v_mov_b32 v119, v20
    v_cndmask_b32 v112, v112, v20, s[20:21]
    v_cndmask_b32 v113, v113, v20, s[22:23]
    v_cndmask_b32 v114, v114, v20, s[62:63]
    v_cndmask_b32 v115, v115, v20, vcc
    v_cndmask_b32 v124, v124, v20, s[20:21]
    v_cndmask_b32 v125, v125, v20, s[22:23]
    v_cndmask_b32 v126, v126, v20, s[62:63]
    v_cndmask_b32 v127, v127, v20, vcc
    s_branch L_recurrent_scan__compressed_kv_cla__moe_arch_mod__prompt_kernel_me_126
L_recurrent_scan__compressed_kv_cla__moe_arch_mod__prompt_kernel_mf_125:
    v_mov_b32 v112, v20
    v_mov_b32 v113, v20
    v_mov_b32 v114, v20
    v_mov_b32 v115, v20
    v_mov_b32 v116, v20
    v_mov_b32 v117, v20
    v_mov_b32 v118, v20
    v_mov_b32 v119, v20
    v_mov_b32 v120, v20
    v_mov_b32 v121, v20
    v_mov_b32 v122, v20
    v_mov_b32 v123, v20
    v_mov_b32 v124, v20
    v_mov_b32 v125, v20
    v_mov_b32 v126, v20
    v_mov_b32 v127, v20
L_recurrent_scan__compressed_kv_cla__moe_arch_mod__prompt_kernel_me_126:
    s_branch L_recurrent_scan__compressed_kv_cla__moe_arch_mod__prompt_kernel_back_128
L_recurrent_scan__compressed_kv_cla__moe_arch_mod__prompt_kernel_rare_135:
    s_add_u32 s36, s40, 1
    s_sub_u32 s36, s36, s51
    s_cmp_lt_u32 s36, 2
    s_cbranch_scc0 L_recurrent_scan__compressed_kv_cla__moe_arch_mod__prompt_kernel_r_129
    s_lshl_b32 s36, s36, 6
    s_add_u32 s36, s36, 32
    s_sub_u32 s36, s36, s50
    s_cmp_lt_i32 s36, 0
    s_cbranch_scc1 L_recurrent_scan__compressed_kv_cla__moe_arch_mod__prompt_kernel_nm_134
    v_mov_b32 v20, 4048155338
    s_cmp_gt_i32 s36, 0
    s_cbranch_scc1 L_recurrent_scan__compressed_kv_cla__moe_arch_mod__prompt_kernel_mf_132
    v_cmp_gt_i32 s[20:21], 0, v18
    v_cmp_gt_i32 s[22:23], 1, v18
    v_cmp_gt_i32 s[62:63], 2, v18
    v_cmp_gt_i32 vcc, 3, v18
    v_mov_b32 v116, v20
    v_mov_b32 v117, v20
    v_mov_b32 v118, v20
    v_mov_b32 v119, v20
    v_cndmask_b32 v112, v112, v20, s[20:21]
    v_cndmask_b32 v113, v113, v20, s[22:23]
    v_cndmask_b32 v114, v114, v20, s[62:63]
    v_cndmask_b32 v115, v115, v20, vcc
    v_cndmask_b32 v124, v124, v20, s[20:21]
    v_cndmask_b32 v125, v125, v20, s[22:23]
    v_cndmask_b32 v126, v126, v20, s[62:63]
    v_cndmask_b32 v127, v127, v20, vcc
    s_branch L_recurrent_scan__compressed_kv_cla__moe_arch_mod__prompt_kernel_me_133
L_recurrent_scan__compressed_kv_cla__moe_arch_mod__prompt_kernel_mf_132:
    v_mov_b32 v112, v20
    v_mov_b32 v113, v20
    v_mov_b32 v114, v20
    v_mov_b32 v115, v20
    v_mov_b32 v116, v20
    v_mov_b32 v117, v20
    v_mov_b32 v118, v20
    v_mov_b32 v119, v20
    v_mov_b32 v120, v20
    v_mov_b32 v121, v20
    v_mov_b32 v122, v20
    v_mov_b32 v123, v20
    v_mov_b32 v124, v20
    v_mov_b32 v125, v20
    v_mov_b32 v126, v20
    v_mov_b32 v127, v20
L_recurrent_scan__compressed_kv_cla__moe_arch_mod__prompt_kernel_me_133:
L_recurrent_scan__compressed_kv_cla__moe_arch_mod__prompt_kernel_nm_134:
L_recurrent_scan__compressed_kv_cla__moe_arch_mod__prompt_kernel_r_129:
    s_branch L_recurrent_scan__compressed_kv_cla__moe_arch_mod__prompt_kernel_back_136
L_recurrent_scan__compressed_kv_cla__moe_arch_mod__prompt_kernel_rare_140:
    s_add_u32 s36, s40, 2
    s_sub_u32 s36, s36, s51
    s_cmp_eq_u32 s36, 1
    s_cselect_b32 s41, 0x8000, s41
    s_cmp_eq_u32 s40, 15
    s_cbranch_scc0 L_recurrent_scan__compressed_kv_cla__moe_arch_mod__prompt_kernel_r_130
    s_mov_b32 s41, 65536
    s_mov_b32 s49, 0x1ffff
    s_mov_b32 s36, 1
L_recurrent_scan__compressed_kv_cla__moe_arch_mod__prompt_kernel_r_130:
    s_cmp_lt_u32 s36, 2
    s_cbranch_scc0 L_recurrent_scan__compressed_kv_cla__moe_arch_mod__prompt_kernel_r_131
    s_lshl_b32 s36, s36, 6
    s_sub_u32 s36, s36, s50
    s_cmp_lt_i32 s36, 0
    s_cbranch_scc1 L_recurrent_scan__compressed_kv_cla__moe_arch_mod__prompt_kernel_nm_139
    v_mov_b32 v20, 4048155338
    s_cmp_gt_i32 s36, 0
    s_cbranch_scc1 L_recurrent_scan__compressed_kv_cla__moe_arch_mod__prompt_kernel_mf_137
    v_cmp_gt_i32 s[20:21], 0, v18
    v_cmp_gt_i32 s[22:23], 1, v18
    v_cmp_gt_i32 s[62:63], 2, v18
    v_cmp_gt_i32 vcc, 3, v18
    v_mov_b32 v100, v20
    v_mov_b32 v101, v20
    v_mov_b32 v102, v20
    v_mov_b32 v103, v20
    v_cndmask_b32 v96, v96, v20, s[20:21]
    v_cndmask_b32 v97, v97, v20, s[22:23]
    v_cndmask_b32 v98, v98, v20, s[62:63]
    v_cndmask_b32 v99, v99, v20, vcc
    v_cndmask_b32 v108, v108, v20, s[20:21]
    v_cndmask_b32 v109, v109, v20, s[22:23]
    v_cndmask_b32 v110, v110, v20, s[62:63]
    v_cndmask_b32 v111, v111, v20, vcc
    s_branch L_recurrent_scan__compressed_kv_cla__moe_arch_mod__prompt_kernel_me_138
L_recurrent_scan__compressed_kv_cla__moe_arch_mod__prompt_kernel_mf_137:
    v_mov_b32 v96, v20
    v_mov_b32 v97, v20
    v_mov_b32 v98, v20
    v_mov_b32 v99, v20
    v_mov_b32 v100, v20
    v_mov_b32 v101, v20
    v_mov_b32 v102, v20
    v_mov_b32 v103, v20
    v_mov_b32 v104, v20
    v_mov_b32 v105, v20
    v_mov_b32 v106, v20
    v_mov_b32 v107, v20
    v_mov_b32 v108, v20
    v_mov_b32 v109, v20
    v_mov_b32 v110, v20
    v_mov_b32 v111, v20
L_recurrent_scan__compressed_kv_cla__moe_arch_mod__prompt_kernel_me_138:
L_recurrent_scan__compressed_kv_cla__moe_arch_mod__prompt_kernel_nm_139:
L_recurrent_scan__compressed_kv_cla__moe_arch_mod__prompt_kernel_r_131:
    s_branch L_recurrent_scan__compressed_kv_cla__moe_arch_mod__prompt_kernel_back_141
L_recurrent_scan__compressed_kv_cla__moe_arch_mod__prompt_kernel_rare_143:
    s_lshl_b32 s36, s29, 7
    s_cmp_eq_u32 s30, 0
    s_cselect_b32 s37, 4, 0
    s_add_u32 s36, s36, s37
    v_mov_b32 v20, s36
    v_mov_b32 v21, 1
    s_mov_b64 exec, 1
    global_atomic_add v20, v21, s[90:91]
    s_mov_b64 exec, -1
    s_nop 3
    s_branch L_recurrent_scan__compressed_kv_cla__moe_arch_mod__prompt_kernel_back_144
L_recurrent_scan__compressed_kv_cla__moe_arch_mod__prompt_kernel_rare_150:
    s_cmp_eq_u32 s40, 12
    s_cbranch_scc0 L_recurrent_scan__compressed_kv_cla__moe_arch_mod__prompt_kernel_bh_148
    s_getpc_b64 s[36:37]
L_recurrent_scan__compressed_kv_cla__moe_arch_mod__prompt_kernel_pc_149:
    s_sub_u32 s36, s36, L_recurrent_scan__compressed_kv_cla__moe_arch_mod__prompt_kernel_pc_149-L_pc
    s_subb_u32 s37, s37, 0
    s_lshr_b32 s38, s2, 3
    s_lshl_b32 s38, s38, 7
    v_lshl_add_u32 v26, v1, 12, s38
    v_min_u32 v26, L_end-L_pc-4, v26
    v_mov_b32 v27, s37
    v_add_co_u32 v26, vcc, s36, v26
    s_mov_b64 exec, 0xffff
    s_nop 0
    v_addc_co_u32 v27, vcc, 0, v27, vcc
    global_load_dword v0, v[26:27], off
    s_mov_b64 exec, -1
    s_nop 1
L_recurrent_scan__compressed_kv_cla__moe_arch_mod__prompt_kernel_bh_148:
    s_cmp_eq_u32 s40, 0
    s_cbranch_scc0 L_recurrent_scan__compressed_kv_cla__moe_arch_mod__prompt_kernel_nm_145
    ds_read_b64 v[14:15], v19
    s_waitcnt lgkmcnt(0)
L_recurrent_scan__compressed_kv_cla__moe_arch_mod__prompt_kernel_nm_145:
    s_branch L_recurrent_scan__compressed_kv_cla__moe_arch_mod__prompt_kernel_back_151
L_recurrent_scan__compressed_kv_cla__moe_arch_mod__prompt_kernel_rare_157:
    s_cmp_eq_u32 s40, 12
    s_cbranch_scc0 L_recurrent_scan__compressed_kv_cla__moe_arch_mod__prompt_kernel_bh_155
    s_getpc_b64 s[36:37]
L_recurrent_scan__compressed_kv_cla__moe_arch_mod__prompt_kernel_pc_156:
    s_sub_u32 s36, s36, L_recurrent_scan__compressed_kv_cla__moe_arch_mod__prompt_kernel_pc_156-L_pc
    s_subb_u32 s37, s37, 0
    s_lshr_b32 s38, s2, 3
    s_lshl_b32 s38, s38, 7
    v_lshl_add_u32 v26, v1, 12, s38
    v_min_u32 v26, L_end-L_pc-4, v26
    v_mov_b32 v27, s37
    v_add_co_u32 v26, vcc, s36, v26
    s_mov_b64 exec, 0xffff
    s_nop 0
    v_addc_co_u32 v27, vcc, 0, v27, vcc
    global_load_dword v0, v[26:27], off
    s_mov_b64 exec, -1
    s_nop 1
L_recurrent_scan__compressed_kv_cla__moe_arch_mod__prompt_kernel_bh_155:
    s_cmp_eq_u32 s40, s51
    s_cbranch_scc0 L_recurrent_scan__compressed_kv_cla__moe_arch_mod__prompt_kernel_ne_154
    s_nop 4
    s_mov_b32 s36, 0x5d800000
    v_cmp_nge_f32 vcc, s36, v28
    s_nop 0
    s_or_b64 s[52:53], s[52:53], vcc
    v_cmp_nge_f32 vcc, s36, v32
    s_nop 0
    s_or_b64 s[52:53], s[52:53], vcc
    v_rcp_f32 v20, v28
    v_rcp_f32 v22, v32
    s_lshl_b32 s38, s30, 3
    s_and_b32 s37, s28, 3
    s_lshl_b32 s37, s37, 1
    s_add_u32 s38, s38, s37
    s_lshl_b32 s38, s38, 17
    s_lshl_b32 s37, s29, 12
    s_add_u32 s38, s38, s37
    v_mov_b32 v21, v20
    v_mov_b32 v23, v22
    v_mov_b32 v24, v7
    v_pk_mul_f32 v[192:193], v[192:193], v[20:21]
    v_pk_mul_f32 v[194:195], v[194:195], v[20:21]
    v_pk_mul_f32 v[196:197], v[196:197], v[20:21]
    v_pk_mul_f32 v[198:199], v[198:199], v[20:21]
    v_cvt_pk_bf16_f32 v192, v192, v193
    v_cvt_pk_bf16_f32 v193, v194, v195
    v_cvt_pk_bf16_f32 v194, v196, v197
    v_cvt_pk_bf16_f32 v195, v198, v199
    buffer_store_dwordx4 v[192:195], v24, s[16:19], s38 offen offset:0 sc1
    v_mov_b32 v196, 0
    v_mov_b32 v197, 0
    v_mov_b32 v198, 0
    v_mov_b32 v199, 0
    v_mov_b32 v192, 0
    v_mov_b32 v193, 0
    v_mov_b32 v194, 0
    v_mov_b32 v195, 0
    v_mov_b32 v28, 0
    v_pk_mul_f32 v[200:201], v[200:201], v[20:21]
    v_pk_mul_f32 v[202:203], v[202:203], v[20:21]
    v_pk_mul_f32 v[204:205], v[204:205], v[20:21]
    v_pk_mul_f32 v[206:207], v[206:207], v[20:21]
    v_cvt_pk_bf16_f32 v200, v200, v201
    v_cvt_pk_bf16_f32 v201, v202, v203
    v_cvt_pk_bf16_f32 v202, v204, v205
    v_cvt_pk_bf16_f32 v203, v206, v207
    buffer_store_dwordx4 v[200:203], v24, s[16:19], s38 offen offset:1024 sc1
    v_mov_b32 v204, 0
    v_mov_b32 v205, 0
    v_mov_b32 v206, 0
    v_mov_b32 v207, 0
    v_mov_b32 v200, 0
    v_mov_b32 v201, 0
    v_mov_b32 v202, 0
    v_mov_b32 v203, 0
    v_mov_b32 v29, 0
    v_pk_mul_f32 v[208:209], v[208:209], v[20:21]
    v_pk_mul_f32 v[210:211], v[210:211], v[20:21]
    v_pk_mul_f32 v[212:213], v[212:213], v[20:21]
    v_pk_mul_f32 v[214:215], v[214:215], v[20:21]
    v_cvt_pk_bf16_f32 v208, v208, v209
    v_cvt_pk_bf16_f32 v209, v210, v211
    v_cvt_pk_bf16_f32 v210, v212, v213
    v_cvt_pk_bf16_f32 v211, v214, v215
    buffer_store_dwordx4 v[208:211], v24, s[16:19], s38 offen offset:2048 sc1
    v_mov_b32 v212, 0
    v_mov_b32 v213, 0
    v_mov_b32 v214, 0
    v_mov_b32 v215, 0
    v_mov_b32 v208, 0
    v_mov_b32 v209, 0
    v_mov_b32 v210, 0
    v_mov_b32 v211, 0
    v_mov_b32 v30, 0
    v_pk_mul_f32 v[216:217], v[216:217], v[20:21]
    v_pk_mul_f32 v[218:219], v[218:219], v[20:21]
    v_pk_mul_f32 v[220:221], v[220:221], v[20:21]
    v_pk_mul_f32 v[222:223], v[222:223], v[20:21]
    v_cvt_pk_bf16_f32 v216, v216, v217
    v_cvt_pk_bf16_f32 v217, v218, v219
    v_cvt_pk_bf16_f32 v218, v220, v221
    v_cvt_pk_bf16_f32 v219, v222, v223
    buffer_store_dwordx4 v[216:219], v24, s[16:19], s38 offen offset:3072 sc1
    v_mov_b32 v220, 0
    v_mov_b32 v221, 0
    v_mov_b32 v222, 0
    v_mov_b32 v223, 0
    v_mov_b32 v216, 0
    v_mov_b32 v217, 0
    v_mov_b32 v218, 0
    v_mov_b32 v219, 0
    v_mov_b32 v31, 0
    s_add_u32 s38, s38, 131072
    v_pk_mul_f32 v[224:225], v[224:225], v[22:23]
    v_pk_mul_f32 v[226:227], v[226:227], v[22:23]
    v_pk_mul_f32 v[228:229], v[228:229], v[22:23]
    v_pk_mul_f32 v[230:231], v[230:231], v[22:23]
    v_cvt_pk_bf16_f32 v224, v224, v225
    v_cvt_pk_bf16_f32 v225, v226, v227
    v_cvt_pk_bf16_f32 v226, v228, v229
    v_cvt_pk_bf16_f32 v227, v230, v231
    buffer_store_dwordx4 v[224:227], v24, s[16:19], s38 offen offset:0 sc1
    v_mov_b32 v228, 0
    v_mov_b32 v229, 0
    v_mov_b32 v230, 0
    v_mov_b32 v231, 0
    v_mov_b32 v224, 0
    v_mov_b32 v225, 0
    v_mov_b32 v226, 0
    v_mov_b32 v227, 0
    v_mov_b32 v32, 0
    v_pk_mul_f32 v[232:233], v[232:233], v[22:23]
    v_pk_mul_f32 v[234:235], v[234:235], v[22:23]
    v_pk_mul_f32 v[236:237], v[236:237], v[22:23]
    v_pk_mul_f32 v[238:239], v[238:239], v[22:23]
    v_cvt_pk_bf16_f32 v232, v232, v233
    v_cvt_pk_bf16_f32 v233, v234, v235
    v_cvt_pk_bf16_f32 v234, v236, v237
    v_cvt_pk_bf16_f32 v235, v238, v239
    buffer_store_dwordx4 v[232:235], v24, s[16:19], s38 offen offset:1024 sc1
    v_mov_b32 v236, 0
    v_mov_b32 v237, 0
    v_mov_b32 v238, 0
    v_mov_b32 v239, 0
    v_mov_b32 v232, 0
    v_mov_b32 v233, 0
    v_mov_b32 v234, 0
    v_mov_b32 v235, 0
    v_mov_b32 v33, 0
    v_pk_mul_f32 v[240:241], v[240:241], v[22:23]
    v_pk_mul_f32 v[242:243], v[242:243], v[22:23]
    v_pk_mul_f32 v[244:245], v[244:245], v[22:23]
    v_pk_mul_f32 v[246:247], v[246:247], v[22:23]
    v_cvt_pk_bf16_f32 v240, v240, v241
    v_cvt_pk_bf16_f32 v241, v242, v243
    v_cvt_pk_bf16_f32 v242, v244, v245
    v_cvt_pk_bf16_f32 v243, v246, v247
    buffer_store_dwordx4 v[240:243], v24, s[16:19], s38 offen offset:2048 sc1
    v_mov_b32 v244, 0
    v_mov_b32 v245, 0
    v_mov_b32 v246, 0
    v_mov_b32 v247, 0
    v_mov_b32 v240, 0
    v_mov_b32 v241, 0
    v_mov_b32 v242, 0
    v_mov_b32 v243, 0
    v_mov_b32 v34, 0
    v_pk_mul_f32 v[248:249], v[248:249], v[22:23]
    v_pk_mul_f32 v[250:251], v[250:251], v[22:23]
    v_pk_mul_f32 v[252:253], v[252:253], v[22:23]
    v_pk_mul_f32 v[254:255], v[254:255], v[22:23]
    v_cvt_pk_bf16_f32 v248, v248, v249
    v_cvt_pk_bf16_f32 v249, v250, v251
    v_cvt_pk_bf16_f32 v250, v252, v253
    v_cvt_pk_bf16_f32 v251, v254, v255
    buffer_store_dwordx4 v[248:251], v24, s[16:19], s38 offen offset:3072 sc1
    v_mov_b32 v252, 0
    v_mov_b32 v253, 0
    v_mov_b32 v254, 0
    v_mov_b32 v255, 0
    v_mov_b32 v248, 0
    v_mov_b32 v249, 0
    v_mov_b32 v250, 0
    v_mov_b32 v251, 0
    v_mov_b32 v35, 0
L_recurrent_scan__compressed_kv_cla__moe_arch_mod__prompt_kernel_ne_154:
    s_branch L_recurrent_scan__compressed_kv_cla__moe_arch_mod__prompt_kernel_back_158
L_recurrent_scan__compressed_kv_cla__moe_arch_mod__prompt_kernel_rare_161:
    s_mov_b32 s61, 0x40000
L_recurrent_scan__compressed_kv_cla__moe_arch_mod__prompt_kernel_spin_159:
    s_sub_u32 s61, s61, 1
    s_cbranch_scc1 L_recurrent_scan__compressed_kv_cla__moe_arch_mod__prompt_kernel_spinx_160
    s_sleep 8
    global_load_dword v11, v12, s[90:91] sc1
    s_waitcnt vmcnt(0)
    v_readfirstlane_b32 s36, v11
    s_nop 0
    s_cmp_lt_u32 s36, 28
    s_cbranch_scc1 L_recurrent_scan__compressed_kv_cla__moe_arch_mod__prompt_kernel_spin_159
L_recurrent_scan__compressed_kv_cla__moe_arch_mod__prompt_kernel_spinx_160:
    s_branch L_recurrent_scan__compressed_kv_cla__moe_arch_mod__prompt_kernel_back_162
L_recurrent_scan__compressed_kv_cla__moe_arch_mod__prompt_kernel_rare_168:
    v_mov_b32 v20, 4048155338
    s_cmp_gt_i32 s50, 0
    s_cbranch_scc1 L_recurrent_scan__compressed_kv_cla__moe_arch_mod__prompt_kernel_mf_166
    v_cmp_gt_i32 s[20:21], 0, v18
    v_cmp_gt_i32 s[22:23], 1, v18
    v_cmp_gt_i32 s[62:63], 2, v18
    v_cmp_gt_i32 vcc, 3, v18
    v_mov_b32 v100, v20
    v_mov_b32 v101, v20
    v_mov_b32 v102, v20
    v_mov_b32 v103, v20
    v_cndmask_b32 v96, v96, v20, s[20:21]
    v_cndmask_b32 v97, v97, v20, s[22:23]
    v_cndmask_b32 v98, v98, v20, s[62:63]
    v_cndmask_b32 v99, v99, v20, vcc
    v_cndmask_b32 v108, v108, v20, s[20:21]
    v_cndmask_b32 v109, v109, v20, s[22:23]
    v_cndmask_b32 v110, v110, v20, s[62:63]
    v_cndmask_b32 v111, v111, v20, vcc
    s_branch L_recurrent_scan__compressed_kv_cla__moe_arch_mod__prompt_kernel_me_167
L_recurrent_scan__compressed_kv_cla__moe_arch_mod__prompt_kernel_mf_166:
    v_mov_b32 v96, v20
    v_mov_b32 v97, v20
    v_mov_b32 v98, v20
    v_mov_b32 v99, v20
    v_mov_b32 v100, v20
    v_mov_b32 v101, v20
    v_mov_b32 v102, v20
    v_mov_b32 v103, v20
    v_mov_b32 v104, v20
    v_mov_b32 v105, v20
    v_mov_b32 v106, v20
    v_mov_b32 v107, v20
    v_mov_b32 v108, v20
    v_mov_b32 v109, v20
    v_mov_b32 v110, v20
    v_mov_b32 v111, v20
L_recurrent_scan__compressed_kv_cla__moe_arch_mod__prompt_kernel_me_167:
    s_branch L_recurrent_scan__compressed_kv_cla__moe_arch_mod__prompt_kernel_back_169
L_p3_done:
    s_and_b32 s36, s29, 28
    s_sub_u32 s40, 47, s30
    s_lshl_b32 s40, s40, 7
    s_add_u32 s40, s40, s36
    s_add_u32 s41, s30, 32
    s_lshl_b32 s41, s41, 7
    s_add_u32 s41, s41, s36
    s_lshr_b32 s63, s29, 4
    s_lshl_b32 s36, s30, 2
    s_lshr_b32 s30, 0x76534210, s36
    s_and_b32 s30, s30, 7
    s_and_b32 s36, s30, 4
    s_add_u32 s43, s30, s36
    s_lshl_b32 s36, s63, 2
    s_add_u32 s30, s43, s36
    s_and_b32 s29, s29, 15
    s_and_b32 s36, s28, 3
    s_lshl_b32 s37, s29, 2
    s_add_u32 s36, s36, s37
    s_lshl_b32 s36, s36, 18
    s_lshr_b32 s37, s28, 2
    s_lshl_b32 s37, s37, 12
    s_add_u32 s36, s36, s37
    s_lshl_b32 s37, s63, 16
    s_add_u32 s36, s36, s37
    s_lshr_b32 s37, s28, 2
    s_lshl_b32 s37, s37, 17
    s_add_u32 s36, s36, s37
    v_lshl_add_u32 v2, v1, 4, s36
    v_xor_b32 v3, 131072, v2
    v_lshrrev_b32 v19, 4, v1
    s_lshr_b32 s36, s28, 2
    s_lshl_b32 s36, s36, 7
    s_and_b32 s37, s28, 3
    s_lshl_b32 s37, s37, 4
    s_add_u32 s36, s36, s37
    s_lshl_b32 s33, s36, 8
    s_lshl_b32 s37, s63, 11
    s_add_u32 s36, s36, s37
    v_add_u32 v18, s36, v19
    v_lshlrev_b32 v18, 11, v18
    s_lshl_b32 s36, s43, 7
    v_add_u32 v18, s36, v18
    v_lshlrev_b32 v20, 1, v19
    v_and_b32 v21, 7, v1
    v_xor_b32 v20, v20, v21
    v_lshl_add_u32 v18, v20, 4, v18
    v_and_b32 v21, 8, v1
    v_lshl_add_u32 v6, v21, 6, v18
    v_xor_b32 v21, 8, v21
    v_lshl_add_u32 v7, v21, 6, v18
    v_add_u32 v7, 7168, v7
    v_add_u32 v8, 14336, v6
    v_add_u32 v9, 14336, v7
    s_add_u32 s36, s2, 1
    s_mov_b32 s62, 0
    s_mov_b32 s31, 0
    s_mov_b32 s32, 0
    s_add_u32 s4, s54, 41943040
    s_addc_u32 s5, s55, 0
    s_and_b32 s5, s5, 0xffff
    s_mov_b32 s6, 117440640
    s_mov_b32 s7, 0x20000
    s_mov_b32 s16, s96
    s_and_b32 s17, s97, 0xffff
    s_mov_b32 s18, 4194304
    s_mov_b32 s19, 0x20000
    s_mov_b32 s20, s98
    s_and_b32 s21, s99, 0xffff
    s_mov_b32 s22, 4194304
    s_mov_b32 s23, 0x20000
    s_lshl_b32 s36, s29, 7
    s_and_b32 s37, s28, 3
    s_lshl_b32 s37, s37, 5
    s_add_u32 s36, s36, s37
    s_lshr_b32 s37, s28, 2
    s_lshl_b32 s37, s37, 4
    s_add_u32 s38, s36, s37
    v_and_b32 v63, 15, v1
    v_add_u32 v14, s38, v63
    v_lshlrev_b32 v16, 3, v14
    v_lshrrev_b32 v15, 3, v1
    v_add_u32 v15, s38, v15
    v_lshlrev_b32 v15, 11, v15
    v_and_b32 v4, 7, v1
    v_lshl_add_u32 v15, v4, 4, v15
    s_lshl_b32 s36, s30, 7
    v_add_u32 v15, s36, v15
    s_lshl_b32 s36, s28, 12
    s_add_u32 s42, s36, 131072
    v_lshl_add_u32 v63, v63, 7, s42
    v_lshl_add_u32 v63, v19, 3, v63
    v_bfe_u32 v20, v1, 2, 2
    v_lshl_add_u32 v18, v19, 2, v20
    v_and_b32 v20, 7, v18
    s_lshl_b32 s36, s63, 2
    s_xor_b32 s36, s36, 4
    v_xor_b32 v20, s36, v20
    v_lshlrev_b32 v18, 8, v18
    s_lshr_b32 s36, s28, 2
    s_lshl_b32 s36, s36, 15
    s_add_u32 s36, s36, 65536
    v_add_u32 v18, s36, v18
    v_and_b32 v21, 3, v1
    v_lshl_add_u32 v18, v21, 3, v18
    v_xor_b32 v21, 0, v20
    v_lshl_add_u32 v50, v21, 5, v18
    v_xor_b32 v21, 1, v20
    v_lshl_add_u32 v51, v21, 5, v18
    v_xor_b32 v21, 2, v20
    v_lshl_add_u32 v52, v21, 5, v18
    v_xor_b32 v21, 3, v20
    v_lshl_add_u32 v53, v21, 5, v18
    v_xor_b32 v21, 4, v20
    v_lshl_add_u32 v54, v21, 5, v18
    v_xor_b32 v21, 5, v20
    v_lshl_add_u32 v55, v21, 5, v18
    v_xor_b32 v21, 6, v20
    v_lshl_add_u32 v56, v21, 5, v18
    v_xor_b32 v21, 7, v20
    v_lshl_add_u32 v57, v21, 5, v18
    s_waitcnt vmcnt(0)
    s_barrier
    s_cmp_eq_u32 s28, 0
    s_cbranch_scc1 L_recurrent_scan__compressed_kv_cla__moe_arch_mod__prompt_kernel_rare_170
L_recurrent_scan__compressed_kv_cla__moe_arch_mod__prompt_kernel_back_171:
    s_bitcmp1_b32 0x70, s28
    s_cbranch_scc1 L_recurrent_scan__compressed_kv_cla__moe_arch_mod__prompt_kernel_f2m_198
L_recurrent_scan__compressed_kv_cla__moe_arch_mod__prompt_kernel_f2a_199:
    s_add_u32 m0, s33, 65536
    s_mov_b32 s32, 0
    buffer_load_dwordx4 v6, s[8:11], s32 offen offset:0 lds
    buffer_load_dwordx4 v7, s[8:11], s32 offen offset:1024 lds
    buffer_load_dwordx4 v8, s[8:11], s32 offen offset:2048 lds
    buffer_load_dwordx4 v9, s[8:11], s32 offen offset:3072 lds
    s_add_u32 m0, s33, 81920
    s_mov_b32 s32, 131072
    buffer_load_dwordx4 v6, s[8:11], s32 offen offset:0 lds
    buffer_load_dwordx4 v7, s[8:11], s32 offen offset:1024 lds
    buffer_load_dwordx4 v8, s[8:11], s32 offen offset:2048 lds
    buffer_load_dwordx4 v9, s[8:11], s32 offen offset:3072 lds
    s_add_u32 m0, s33, 0
    s_mov_b32 s32, 524288
    buffer_load_dwordx4 v6, s[8:11], s32 offen offset:0 lds
    buffer_load_dwordx4 v7, s[8:11], s32 offen offset:1024 lds
    buffer_load_dwordx4 v8, s[8:11], s32 offen offset:2048 lds
    buffer_load_dwordx4 v9, s[8:11], s32 offen offset:3072 lds
    s_add_u32 m0, s33, 16384
    s_mov_b32 s32, 655360
    buffer_load_dwordx4 v6, s[8:11], s32 offen offset:0 lds
    buffer_load_dwordx4 v7, s[8:11], s32 offen offset:1024 lds
    buffer_load_dwordx4 v8, s[8:11], s32 offen offset:2048 lds
    buffer_load_dwordx4 v9, s[8:11], s32 offen offset:3072 lds
    s_cmp_lt_u32 s28, 4
    s_cbranch_scc1 L_recurrent_scan__compressed_kv_cla__moe_arch_mod__prompt_kernel_f2m_198
L_recurrent_scan__compressed_kv_cla__moe_arch_mod__prompt_kernel_f2b_200:
    s_mov_b32 s60, 31
    s_cmp_eq_u32 s28, 3
    s_cbranch_scc0 L_recurrent_scan__compressed_kv_cla__moe_arch_mod__prompt_kernel_w7j_201
    v_min_u32 v58, 3, v1
    s_lshl_b32 s36, s63, 2
    v_add_u32 v58, s36, v58
    s_add_u32 s36, s29, 32
    s_lshl_b32 s36, s36, 7
    v_lshl_add_u32 v58, v58, 2, s36
    s_mov_b32 s44, 3
    s_mov_b32 s61, 0x40000
L_recurrent_scan__compressed_kv_cla__moe_arch_mod__prompt_kernel_cspin_202:
    s_sub_u32 s61, s61, 1
    s_cbranch_scc1 L_recurrent_scan__compressed_kv_cla__moe_arch_mod__prompt_kernel_cspinx_203
    global_load_dword v59, v58, s[90:91] sc1
    s_waitcnt vmcnt(0)
L_recurrent_scan__compressed_kv_cla__moe_arch_mod__prompt_kernel_cchk_204:
    v_cmp_le_u32 vcc, 4, v59
    s_nop 0
    s_and_b32 s60, vcc_lo, 31
    s_and_b32 s36, s60, s44
    s_cmp_eq_u32 s36, s44
    s_cbranch_scc1 L_recurrent_scan__compressed_kv_cla__moe_arch_mod__prompt_kernel_cspinx_203
    s_sleep 6
    s_branch L_recurrent_scan__compressed_kv_cla__moe_arch_mod__prompt_kernel_cspin_202
L_recurrent_scan__compressed_kv_cla__moe_arch_mod__prompt_kernel_cspinx_203:
    s_lshl_b32 s44, s44, 1
    s_or_b32 s44, s44, 1
    s_and_b32 s44, s44, 31
L_recurrent_scan__compressed_kv_cla__moe_arch_mod__prompt_kernel_w7j_201:
    s_waitcnt vmcnt(12)
    s_waitcnt lgkmcnt(0)
    s_barrier
    s_mov_b32 s31, 0
    buffer_load_dwordx4 v[128:131], v2, s[4:7], s31 offen offset:0 sc1
    buffer_load_dwordx4 v[132:135], v3, s[4:7], s31 offen offset:0 sc1
    buffer_load_dwordx4 v[136:139], v2, s[4:7], s31 offen offset:1024 sc1
    buffer_load_dwordx4 v[140:143], v3, s[4:7], s31 offen offset:1024 sc1
    buffer_load_dwordx4 v[144:147], v2, s[4:7], s31 offen offset:2048 sc1
    buffer_load_dwordx4 v[148:151], v3, s[4:7], s31 offen offset:2048 sc1
    buffer_load_dwordx4 v[152:155], v2, s[4:7], s31 offen offset:3072 sc1
    buffer_load_dwordx4 v[156:159], v3, s[4:7], s31 offen offset:3072 sc1
    s_mov_b32 s31, 8192
    s_cmp_lt_u32 s28, 4
    s_cbranch_scc0 L_recurrent_scan__compressed_kv_cla__moe_arch_mod__prompt_kernel_g_172
    s_lshl_b32 s36, s28, 10
    s_add_u32 s36, s36, 131072
    v_lshl_add_u32 v28, v1, 4, s36
    ds_read_b128 v[96:99], v28 offset:0
    ds_read_b128 v[100:103], v28 offset:4096
    ds_read_b128 v[104:107], v28 offset:8192
    ds_read_b128 v[108:111], v28 offset:12288
    ds_read_b128 v[112:115], v28 offset:16384
    ds_read_b128 v[116:119], v28 offset:20480
    ds_read_b128 v[120:123], v28 offset:24576
    s_lshr_b32 s36, s2, 4
    s_lshl_b32 s36, s36, 13
    s_and_b32 s37, s2, 15
    s_lshl_b32 s37, s37, 8
    s_add_u32 s36, s36, s37
    s_lshl_b32 s37, s28, 6
    s_add_u32 s36, s36, s37
    s_add_u32 s36, s36, 59768832
    v_and_b32 v28, 1, v1
    v_lshlrev_b32 v28, 12, v28
    v_lshl_add_u32 v28, v19, 4, v28
    s_waitcnt lgkmcnt(0)
    v_add_f32 v96, v96, v100
    v_add_f32 v97, v97, v101
    v_add_f32 v98, v98, v102
    v_add_f32 v99, v99, v103
    v_add_f32 v96, v96, v104
    v_add_f32 v97, v97, v105
    v_add_f32 v98, v98, v106
    v_add_f32 v99, v99, v107
    v_add_f32 v96, v96, v108
    v_add_f32 v97, v97, v109
    v_add_f32 v98, v98, v110
    v_add_f32 v99, v99, v111
    v_add_f32 v96, v96, v112
    v_add_f32 v97, v97, v113
    v_add_f32 v98, v98, v114
    v_add_f32 v99, v99, v115
    v_add_f32 v96, v96, v116
    v_add_f32 v97, v97, v117
    v_add_f32 v98, v98, v118
    v_add_f32 v99, v99, v119
    v_add_f32 v96, v96, v120
    v_add_f32 v97, v97, v121
    v_add_f32 v98, v98, v122
    v_add_f32 v99, v99, v123
    s_mov_b32 exec_lo, 0x00030003
    s_mov_b32 exec_hi, 0x00030003
    buffer_store_dwordx4 v[96:99], v28, s[24:27], s36 offen sc1
    s_mov_b64 exec, -1
    s_nop 3
L_recurrent_scan__compressed_kv_cla__moe_arch_mod__prompt_kernel_g_172:
    v_lshlrev_b32 v22, 4, v1
    v_mov_b32 v18, v22
    v_add_u32 v20, s42, v22
    v_xor_b32 v21, 16384, v20
    s_lshl_b32 s36, s2, 15
    s_lshl_b32 s37, s28, 12
    s_add_u32 s36, s36, s37
    s_add_u32 s36, s36, 67108864
    s_mov_b32 s41, s36
    s_xor_b32 s39, s36, 131072
    s_add_u32 s40, s2, 128
    s_lshl_b32 s40, s40, 7
    ds_read_b64_tr_b16 v[64:65], v50 offset:0
    ds_read_b64_tr_b16 v[66:67], v50 offset:4096
    ds_read_b64_tr_b16 v[68:69], v51 offset:0
    ds_read_b64_tr_b16 v[70:71], v51 offset:4096
    ds_read_b64_tr_b16 v[72:73], v52 offset:0
    ds_read_b64_tr_b16 v[74:75], v52 offset:4096
    ds_read_b64_tr_b16 v[76:77], v53 offset:0
    ds_read_b64_tr_b16 v[78:79], v53 offset:4096
    ds_read_b64_tr_b16 v[80:81], v54 offset:0
    ds_read_b64_tr_b16 v[82:83], v54 offset:4096
    ds_read_b64_tr_b16 v[84:85], v55 offset:0
    ds_read_b64_tr_b16 v[86:87], v55 offset:4096
    s_waitcnt vmcnt(6)
    buffer_load_dwordx4 v[160:163], v2, s[4:7], s31 offen offset:0 sc1
    buffer_load_dwordx4 v[164:167], v3, s[4:7], s31 offen offset:0 sc1
    buffer_load_dwordx4 v[168:171], v2, s[4:7], s31 offen offset:1024 sc1
    buffer_load_dwordx4 v[172:175], v3, s[4:7], s31 offen offset:1024 sc1
    s_waitcnt lgkmcnt(8)
    v_mfma_f32_16x16x32_bf16 v[192:195], v[64:67], v[128:131], 0
    ds_read_b64_tr_b16 v[88:89], v56 offset:0
    buffer_load_dwordx4 v[176:179], v2, s[4:7], s31 offen offset:2048 sc1
    v_mfma_f32_16x16x32_bf16 v[224:227], v[64:67], v[132:135], 0
    ds_read_b64_tr_b16 v[90:91], v56 offset:4096
    v_mfma_f32_16x16x32_bf16 v[196:199], v[68:71], v[128:131], 0
    ds_read_b64_tr_b16 v[92:93], v57 offset:0
    v_mfma_f32_16x16x32_bf16 v[228:231], v[68:71], v[132:135], 0
    ds_read_b64_tr_b16 v[94:95], v57 offset:4096
    s_waitcnt lgkmcnt(8)
    v_mfma_f32_16x16x32_bf16 v[200:203], v[72:75], v[128:131], 0
    ds_read_b64_tr_b16 v[64:65], v50 offset:8192
    buffer_load_dwordx4 v[180:183], v3, s[4:7], s31 offen offset:2048 sc1
    v_mfma_f32_16x16x32_bf16 v[232:235], v[72:75], v[132:135], 0
    ds_read_b64_tr_b16 v[66:67], v50 offset:12288
    v_mfma_f32_16x16x32_bf16 v[204:207], v[76:79], v[128:131], 0
    ds_read_b64_tr_b16 v[68:69], v51 offset:8192
    v_mfma_f32_16x16x32_bf16 v[236:239], v[76:79], v[132:135], 0
    ds_read_b64_tr_b16 v[70:71], v51 offset:12288
    s_waitcnt lgkmcnt(8)
    v_mfma_f32_16x16x32_bf16 v[208:211], v[80:83], v[128:131], 0
    ds_read_b64_tr_b16 v[72:73], v52 offset:8192
    buffer_load_dwordx4 v[184:187], v2, s[4:7], s31 offen offset:3072 sc1
    v_mfma_f32_16x16x32_bf16 v[240:243], v[80:83], v[132:135], 0
    ds_read_b64_tr_b16 v[74:75], v52 offset:12288
    v_mfma_f32_16x16x32_bf16 v[212:215], v[84:87], v[128:131], 0
    ds_read_b64_tr_b16 v[76:77], v53 offset:8192
    v_mfma_f32_16x16x32_bf16 v[244:247], v[84:87], v[132:135], 0
    ds_read_b64_tr_b16 v[78:79], v53 offset:12288
    s_waitcnt lgkmcnt(8)
    v_mfma_f32_16x16x32_bf16 v[216:219], v[88:91], v[128:131], 0
    ds_read_b64_tr_b16 v[80:81], v54 offset:8192
    buffer_load_dwordx4 v[188:191], v3, s[4:7], s31 offen offset:3072 sc1
    v_mfma_f32_16x16x32_bf16 v[248:251], v[88:91], v[132:135], 0
    ds_read_b64_tr_b16 v[82:83], v54 offset:12288
    v_mfma_f32_16x16x32_bf16 v[220:223], v[92:95], v[128:131], 0
    ds_read_b64_tr_b16 v[84:85], v55 offset:8192
    v_mfma_f32_16x16x32_bf16 v[252:255], v[92:95], v[132:135], 0
    ds_read_b64_tr_b16 v[86:87], v55 offset:12288
    s_waitcnt lgkmcnt(8)
    s_waitcnt vmcnt(12)
    v_mfma_f32_16x16x32_bf16 v[192:195], v[64:67], v[136:139], v[192:195]
    ds_read_b64_tr_b16 v[88:89], v56 offset:8192
    v_mfma_f32_16x16x32_bf16 v[224:227], v[64:67], v[140:143], v[224:227]
    ds_read_b64_tr_b16 v[90:91], v56 offset:12288
    s_mov_b32 s31, 16384
    buffer_load_dwordx4 v[128:131], v2, s[4:7], s31 offen offset:0 sc1
    v_mfma_f32_16x16x32_bf16 v[196:199], v[68:71], v[136:139], v[196:199]
    ds_read_b64_tr_b16 v[92:93], v57 offset:8192
    v_mfma_f32_16x16x32_bf16 v[228:231], v[68:71], v[140:143], v[228:231]
    ds_read_b64_tr_b16 v[94:95], v57 offset:12288
    s_waitcnt lgkmcnt(8)
    v_mfma_f32_16x16x32_bf16 v[200:203], v[72:75], v[136:139], v[200:203]
    v_mfma_f32_16x16x32_bf16 v[232:235], v[72:75], v[140:143], v[232:235]
    buffer_load_dwordx4 v[132:135], v3, s[4:7], s31 offen offset:0 sc1
    v_mfma_f32_16x16x32_bf16 v[204:207], v[76:79], v[136:139], v[204:207]
    v_mfma_f32_16x16x32_bf16 v[236:239], v[76:79], v[140:143], v[236:239]
    s_waitcnt lgkmcnt(0)
    s_barrier
    v_mfma_f32_16x16x32_bf16 v[208:211], v[80:83], v[136:139], v[208:211]
    ds_read_b64_tr_b16 v[64:65], v50 offset:16384
    ds_read_b64_tr_b16 v[66:67], v50 offset:20480
    v_mfma_f32_16x16x32_bf16 v[240:243], v[80:83], v[140:143], v[240:243]
    ds_read_b64_tr_b16 v[68:69], v51 offset:16384
    ds_read_b64_tr_b16 v[70:71], v51 offset:20480
    s_add_u32 m0, s33, 65536
    s_mov_b32 s32, 1048576
    buffer_load_dwordx4 v6, s[8:11], s32 offen offset:0 lds
    v_mfma_f32_16x16x32_bf16 v[212:215], v[84:87], v[136:139], v[212:215]
    ds_read_b64_tr_b16 v[72:73], v52 offset:16384
    ds_read_b64_tr_b16 v[74:75], v52 offset:20480
    v_mfma_f32_16x16x32_bf16 v[244:247], v[84:87], v[140:143], v[244:247]
    ds_read_b64_tr_b16 v[76:77], v53 offset:16384
    ds_read_b64_tr_b16 v[78:79], v53 offset:20480
    v_mfma_f32_16x16x32_bf16 v[216:219], v[88:91], v[136:139], v[216:219]
    ds_read_b64_tr_b16 v[80:81], v54 offset:16384
    ds_read_b64_tr_b16 v[82:83], v54 offset:20480
    v_mfma_f32_16x16x32_bf16 v[248:251], v[88:91], v[140:143], v[248:251]
    buffer_load_dwordx4 v7, s[8:11], s32 offen offset:1024 lds
    v_mfma_f32_16x16x32_bf16 v[220:223], v[92:95], v[136:139], v[220:223]
    ds_read_b64_tr_b16 v[84:85], v55 offset:16384
    ds_read_b64_tr_b16 v[86:87], v55 offset:20480
    v_mfma_f32_16x16x32_bf16 v[252:255], v[92:95], v[140:143], v[252:255]
    s_waitcnt lgkmcnt(8)
    s_waitcnt vmcnt(14)
    v_mfma_f32_16x16x32_bf16 v[192:195], v[64:67], v[144:147], v[192:195]
    ds_read_b64_tr_b16 v[88:89], v56 offset:16384
    v_mfma_f32_16x16x32_bf16 v[224:227], v[64:67], v[148:151], v[224:227]
    ds_read_b64_tr_b16 v[90:91], v56 offset:20480
    v_mfma_f32_16x16x32_bf16 v[196:199], v[68:71], v[144:147], v[196:199]
    ds_read_b64_tr_b16 v[92:93], v57 offset:16384
    buffer_load_dwordx4 v8, s[8:11], s32 offen offset:2048 lds
    v_mfma_f32_16x16x32_bf16 v[228:231], v[68:71], v[148:151], v[228:231]
    ds_read_b64_tr_b16 v[94:95], v57 offset:20480
    s_waitcnt lgkmcnt(8)
    v_mfma_f32_16x16x32_bf16 v[200:203], v[72:75], v[144:147], v[200:203]
    ds_read_b64_tr_b16 v[64:65], v50 offset:24576
    v_mfma_f32_16x16x32_bf16 v[232:235], v[72:75], v[148:151], v[232:235]
    ds_read_b64_tr_b16 v[66:67], v50 offset:28672
    v_xor_b32 v50, 65536, v50
    v_mfma_f32_16x16x32_bf16 v[204:207], v[76:79], v[144:147], v[204:207]
    ds_read_b64_tr_b16 v[68:69], v51 offset:24576
    buffer_load_dwordx4 v9, s[8:11], s32 offen offset:3072 lds
    v_mfma_f32_16x16x32_bf16 v[236:239], v[76:79], v[148:151], v[236:239]
    ds_read_b64_tr_b16 v[70:71], v51 offset:28672
    v_xor_b32 v51, 65536, v51
    s_waitcnt lgkmcnt(8)
    v_mfma_f32_16x16x32_bf16 v[208:211], v[80:83], v[144:147], v[208:211]
    ds_read_b64_tr_b16 v[72:73], v52 offset:24576
    v_mfma_f32_16x16x32_bf16 v[240:243], v[80:83], v[148:151], v[240:243]
    ds_read_b64_tr_b16 v[74:75], v52 offset:28672
    v_xor_b32 v52, 65536, v52
    v_mfma_f32_16x16x32_bf16 v[212:215], v[84:87], v[144:147], v[212:215]
    ds_read_b64_tr_b16 v[76:77], v53 offset:24576
    buffer_load_dwordx4 v[136:139], v2, s[4:7], s31 offen offset:1024 sc1
    v_mfma_f32_16x16x32_bf16 v[244:247], v[84:87], v[148:151], v[244:247]
    ds_read_b64_tr_b16 v[78:79], v53 offset:28672
    v_xor_b32 v53, 65536, v53
    s_waitcnt lgkmcnt(8)
    v_mfma_f32_16x16x32_bf16 v[216:219], v[88:91], v[144:147], v[216:219]
    ds_read_b64_tr_b16 v[80:81], v54 offset:24576
    v_mfma_f32_16x16x32_bf16 v[248:251], v[88:91], v[148:151], v[248:251]
    ds_read_b64_tr_b16 v[82:83], v54 offset:28672
    v_xor_b32 v54, 65536, v54
    v_mfma_f32_16x16x32_bf16 v[220:223], v[92:95], v[144:147], v[220:223]
    ds_read_b64_tr_b16 v[84:85], v55 offset:24576
    buffer_load_dwordx4 v[140:143], v3, s[4:7], s31 offen offset:1024 sc1
    v_mfma_f32_16x16x32_bf16 v[252:255], v[92:95], v[148:151], v[252:255]
    ds_read_b64_tr_b16 v[86:87], v55 offset:28672
    v_xor_b32 v55, 65536, v55
    s_waitcnt lgkmcnt(8)
    s_waitcnt vmcnt(16)
    v_mfma_f32_16x16x32_bf16 v[192:195], v[64:67], v[152:155], v[192:195]
    ds_read_b64_tr_b16 v[88:89], v56 offset:24576
    v_mfma_f32_16x16x32_bf16 v[224:227], v[64:67], v[156:159], v[224:227]
    ds_read_b64_tr_b16 v[90:91], v56 offset:28672
    v_xor_b32 v56, 65536, v56
    v_mfma_f32_16x16x32_bf16 v[196:199], v[68:71], v[152:155], v[196:199]
    ds_read_b64_tr_b16 v[92:93], v57 offset:24576
    v_mfma_f32_16x16x32_bf16 v[228:231], v[68:71], v[156:159], v[228:231]
    ds_read_b64_tr_b16 v[94:95], v57 offset:28672
    v_xor_b32 v57, 65536, v57
    buffer_load_dwordx4 v[144:147], v2, s[4:7], s31 offen offset:2048 sc1
    s_waitcnt lgkmcnt(8)
    v_mfma_f32_16x16x32_bf16 v[200:203], v[72:75], v[152:155], v[200:203]
    v_mfma_f32_16x16x32_bf16 v[232:235], v[72:75], v[156:159], v[232:235]
    v_mfma_f32_16x16x32_bf16 v[204:207], v[76:79], v[152:155], v[204:207]
    v_mfma_f32_16x16x32_bf16 v[236:239], v[76:79], v[156:159], v[236:239]
    buffer_load_dwordx4 v[148:151], v3, s[4:7], s31 offen offset:2048 sc1
    s_waitcnt lgkmcnt(0)
    s_barrier
    v_mfma_f32_16x16x32_bf16 v[208:211], v[80:83], v[152:155], v[208:211]
    ds_read_b64_tr_b16 v[64:65], v50 offset:0
    ds_read_b64_tr_b16 v[66:67], v50 offset:4096
    v_mfma_f32_16x16x32_bf16 v[240:243], v[80:83], v[156:159], v[240:243]
    ds_read_b64_tr_b16 v[68:69], v51 offset:0
    ds_read_b64_tr_b16 v[70:71], v51 offset:4096
    v_mfma_f32_16x16x32_bf16 v[212:215], v[84:87], v[152:155], v[212:215]
    ds_read_b64_tr_b16 v[72:73], v52 offset:0
    ds_read_b64_tr_b16 v[74:75], v52 offset:4096
    v_mfma_f32_16x16x32_bf16 v[244:247], v[84:87], v[156:159], v[244:247]
    ds_read_b64_tr_b16 v[76:77], v53 offset:0
    ds_read_b64_tr_b16 v[78:79], v53 offset:4096
    s_add_u32 m0, s33, 81920
    s_mov_b32 s32, 1179648
    buffer_load_dwordx4 v6, s[8:11], s32 offen offset:0 lds
    v_mfma_f32_16x16x32_bf16 v[216:219], v[88:91], v[152:155], v[216:219]
    ds_read_b64_tr_b16 v[80:81], v54 offset:0
    ds_read_b64_tr_b16 v[82:83], v54 offset:4096
    v_mfma_f32_16x16x32_bf16 v[248:251], v[88:91], v[156:159], v[248:251]
    v_mfma_f32_16x16x32_bf16 v[220:223], v[92:95], v[152:155], v[220:223]
    ds_read_b64_tr_b16 v[84:85], v55 offset:0
    ds_read_b64_tr_b16 v[86:87], v55 offset:4096
    v_mfma_f32_16x16x32_bf16 v[252:255], v[92:95], v[156:159], v[252:255]
    buffer_load_dwordx4 v7, s[8:11], s32 offen offset:1024 lds
    s_waitcnt lgkmcnt(8)
    s_waitcnt vmcnt(18)
    v_mfma_f32_16x16x32_bf16 v[192:195], v[64:67], v[160:163], v[192:195]
    ds_read_b64_tr_b16 v[88:89], v56 offset:0
    v_mfma_f32_16x16x32_bf16 v[224:227], v[64:67], v[164:167], v[224:227]
    ds_read_b64_tr_b16 v[90:91], v56 offset:4096
    v_mfma_f32_16x16x32_bf16 v[196:199], v[68:71], v[160:163], v[196:199]
    ds_read_b64_tr_b16 v[92:93], v57 offset:0
    v_mfma_f32_16x16x32_bf16 v[228:231], v[68:71], v[164:167], v[228:231]
    ds_read_b64_tr_b16 v[94:95], v57 offset:4096
    s_waitcnt lgkmcnt(8)
    v_mfma_f32_16x16x32_bf16 v[200:203], v[72:75], v[160:163], v[200:203]
    ds_read_b64_tr_b16 v[64:65], v50 offset:8192
    buffer_load_dwordx4 v8, s[8:11], s32 offen offset:2048 lds
    v_mfma_f32_16x16x32_bf16 v[232:235], v[72:75], v[164:167], v[232:235]
    ds_read_b64_tr_b16 v[66:67], v50 offset:12288
    v_mfma_f32_16x16x32_bf16 v[204:207], v[76:79], v[160:163], v[204:207]
    ds_read_b64_tr_b16 v[68:69], v51 offset:8192
    v_mfma_f32_16x16x32_bf16 v[236:239], v[76:79], v[164:167], v[236:239]
    ds_read_b64_tr_b16 v[70:71], v51 offset:12288
    s_waitcnt lgkmcnt(8)
    v_mfma_f32_16x16x32_bf16 v[208:211], v[80:83], v[160:163], v[208:211]
    ds_read_b64_tr_b16 v[72:73], v52 offset:8192
    buffer_load_dwordx4 v9, s[8:11], s32 offen offset:3072 lds
    v_mfma_f32_16x16x32_bf16 v[240:243], v[80:83], v[164:167], v[240:243]
    ds_read_b64_tr_b16 v[74:75], v52 offset:12288
    v_mfma_f32_16x16x32_bf16 v[212:215], v[84:87], v[160:163], v[212:215]
    ds_read_b64_tr_b16 v[76:77], v53 offset:8192
    v_mfma_f32_16x16x32_bf16 v[244:247], v[84:87], v[164:167], v[244:247]
    ds_read_b64_tr_b16 v[78:79], v53 offset:12288
    s_waitcnt lgkmcnt(8)
    v_mfma_f32_16x16x32_bf16 v[216:219], v[88:91], v[160:163], v[216:219]
    ds_read_b64_tr_b16 v[80:81], v54 offset:8192
    buffer_load_dwordx4 v[152:155], v2, s[4:7], s31 offen offset:3072 sc1
    v_mfma_f32_16x16x32_bf16 v[248:251], v[88:91], v[164:167], v[248:251]
    ds_read_b64_tr_b16 v[82:83], v54 offset:12288
    v_mfma_f32_16x16x32_bf16 v[220:223], v[92:95], v[160:163], v[220:223]
    ds_read_b64_tr_b16 v[84:85], v55 offset:8192
    v_mfma_f32_16x16x32_bf16 v[252:255], v[92:95], v[164:167], v[252:255]
    ds_read_b64_tr_b16 v[86:87], v55 offset:12288
    s_waitcnt lgkmcnt(8)
    s_waitcnt vmcnt(19)
    v_mfma_f32_16x16x32_bf16 v[192:195], v[64:67], v[168:171], v[192:195]
    ds_read_b64_tr_b16 v[88:89], v56 offset:8192
    buffer_load_dwordx4 v[156:159], v3, s[4:7], s31 offen offset:3072 sc1
    v_mfma_f32_16x16x32_bf16 v[224:227], v[64:67], v[172:175], v[224:227]
    ds_read_b64_tr_b16 v[90:91], v56 offset:12288
    v_mfma_f32_16x16x32_bf16 v[196:199], v[68:71], v[168:171], v[196:199]
    ds_read_b64_tr_b16 v[92:93], v57 offset:8192
    v_mfma_f32_16x16x32_bf16 v[228:231], v[68:71], v[172:175], v[228:231]
    ds_read_b64_tr_b16 v[94:95], v57 offset:12288
    s_waitcnt lgkmcnt(8)
    v_mfma_f32_16x16x32_bf16 v[200:203], v[72:75], v[168:171], v[200:203]
    v_mfma_f32_16x16x32_bf16 v[232:235], v[72:75], v[172:175], v[232:235]
    s_mov_b32 s31, 24576
    buffer_load_dwordx4 v[160:163], v2, s[4:7], s31 offen offset:0 sc1
    v_mfma_f32_16x16x32_bf16 v[204:207], v[76:79], v[168:171], v[204:207]
    v_mfma_f32_16x16x32_bf16 v[236:239], v[76:79], v[172:175], v[236:239]
    s_waitcnt lgkmcnt(0)
    s_barrier
    v_mfma_f32_16x16x32_bf16 v[208:211], v[80:83], v[168:171], v[208:211]
    ds_read_b64_tr_b16 v[64:65], v50 offset:16384
    ds_read_b64_tr_b16 v[66:67], v50 offset:20480
    v_mfma_f32_16x16x32_bf16 v[240:243], v[80:83], v[172:175], v[240:243]
    ds_read_b64_tr_b16 v[68:69], v51 offset:16384
    ds_read_b64_tr_b16 v[70:71], v51 offset:20480
    s_add_u32 m0, s33, 0
    s_mov_b32 s32, 1572864
    buffer_load_dwordx4 v6, s[8:11], s32 offen offset:0 lds
    v_mfma_f32_16x16x32_bf16 v[212:215], v[84:87], v[168:171], v[212:215]
    ds_read_b64_tr_b16 v[72:73], v52 offset:16384
    ds_read_b64_tr_b16 v[74:75], v52 offset:20480
    s_cmp_eq_u32 s28, 0
    s_cbranch_scc1 L_recurrent_scan__compressed_kv_cla__moe_arch_mod__prompt_kernel_rare_174
L_recurrent_scan__compressed_kv_cla__moe_arch_mod__prompt_kernel_back_175:
    v_mfma_f32_16x16x32_bf16 v[244:247], v[84:87], v[172:175], v[244:247]
    ds_read_b64_tr_b16 v[76:77], v53 offset:16384
    ds_read_b64_tr_b16 v[78:79], v53 offset:20480
    v_mfma_f32_16x16x32_bf16 v[216:219], v[88:91], v[168:171], v[216:219]
    ds_read_b64_tr_b16 v[80:81], v54 offset:16384
    ds_read_b64_tr_b16 v[82:83], v54 offset:20480
    v_mfma_f32_16x16x32_bf16 v[248:251], v[88:91], v[172:175], v[248:251]
    buffer_load_dwordx4 v7, s[8:11], s32 offen offset:1024 lds
    v_mfma_f32_16x16x32_bf16 v[220:223], v[92:95], v[168:171], v[220:223]
    ds_read_b64_tr_b16 v[84:85], v55 offset:16384
    ds_read_b64_tr_b16 v[86:87], v55 offset:20480
    v_mfma_f32_16x16x32_bf16 v[252:255], v[92:95], v[172:175], v[252:255]
    s_waitcnt lgkmcnt(8)
    s_waitcnt vmcnt(21)
    v_mfma_f32_16x16x32_bf16 v[192:195], v[64:67], v[176:179], v[192:195]
    ds_read_b64_tr_b16 v[88:89], v56 offset:16384
    v_mfma_f32_16x16x32_bf16 v[224:227], v[64:67], v[180:183], v[224:227]
    ds_read_b64_tr_b16 v[90:91], v56 offset:20480
    buffer_load_dwordx4 v8, s[8:11], s32 offen offset:2048 lds
    v_mfma_f32_16x16x32_bf16 v[196:199], v[68:71], v[176:179], v[196:199]
    ds_read_b64_tr_b16 v[92:93], v57 offset:16384
    v_mfma_f32_16x16x32_bf16 v[228:231], v[68:71], v[180:183], v[228:231]
    ds_read_b64_tr_b16 v[94:95], v57 offset:20480
    s_waitcnt lgkmcnt(8)
    v_mfma_f32_16x16x32_bf16 v[200:203], v[72:75], v[176:179], v[200:203]
    ds_read_b64_tr_b16 v[64:65], v50 offset:24576
    v_mfma_f32_16x16x32_bf16 v[232:235], v[72:75], v[180:183], v[232:235]
    ds_read_b64_tr_b16 v[66:67], v50 offset:28672
    v_xor_b32 v50, 65536, v50
    v_mfma_f32_16x16x32_bf16 v[204:207], v[76:79], v[176:179], v[204:207]
    ds_read_b64_tr_b16 v[68:69], v51 offset:24576
    buffer_load_dwordx4 v9, s[8:11], s32 offen offset:3072 lds
    v_mfma_f32_16x16x32_bf16 v[236:239], v[76:79], v[180:183], v[236:239]
    ds_read_b64_tr_b16 v[70:71], v51 offset:28672
    v_xor_b32 v51, 65536, v51
    s_waitcnt lgkmcnt(8)
    v_mfma_f32_16x16x32_bf16 v[208:211], v[80:83], v[176:179], v[208:211]
    ds_read_b64_tr_b16 v[72:73], v52 offset:24576
    v_mfma_f32_16x16x32_bf16 v[240:243], v[80:83], v[180:183], v[240:243]
    ds_read_b64_tr_b16 v[74:75], v52 offset:28672
    v_xor_b32 v52, 65536, v52
    v_mfma_f32_16x16x32_bf16 v[212:215], v[84:87], v[176:179], v[212:215]
    ds_read_b64_tr_b16 v[76:77], v53 offset:24576
    buffer_load_dwordx4 v[164:167], v3, s[4:7], s31 offen offset:0 sc1
    v_mfma_f32_16x16x32_bf16 v[244:247], v[84:87], v[180:183], v[244:247]
    ds_read_b64_tr_b16 v[78:79], v53 offset:28672
    v_xor_b32 v53, 65536, v53
    s_waitcnt lgkmcnt(8)
    v_mfma_f32_16x16x32_bf16 v[216:219], v[88:91], v[176:179], v[216:219]
    ds_read_b64_tr_b16 v[80:81], v54 offset:24576
    v_mfma_f32_16x16x32_bf16 v[248:251], v[88:91], v[180:183], v[248:251]
    ds_read_b64_tr_b16 v[82:83], v54 offset:28672
    v_xor_b32 v54, 65536, v54
    v_mfma_f32_16x16x32_bf16 v[220:223], v[92:95], v[176:179], v[220:223]
    ds_read_b64_tr_b16 v[84:85], v55 offset:24576
    buffer_load_dwordx4 v[168:171], v2, s[4:7], s31 offen offset:1024 sc1
    v_mfma_f32_16x16x32_bf16 v[252:255], v[92:95], v[180:183], v[252:255]
    ds_read_b64_tr_b16 v[86:87], v55 offset:28672
    v_xor_b32 v55, 65536, v55
    s_waitcnt lgkmcnt(8)
    s_waitcnt vmcnt(23)
    v_mfma_f32_16x16x32_bf16 v[192:195], v[64:67], v[184:187], v[192:195]
    ds_read_b64_tr_b16 v[88:89], v56 offset:24576
    v_mfma_f32_16x16x32_bf16 v[224:227], v[64:67], v[188:191], v[224:227]
    ds_read_b64_tr_b16 v[90:91], v56 offset:28672
    v_xor_b32 v56, 65536, v56
    v_mfma_f32_16x16x32_bf16 v[196:199], v[68:71], v[184:187], v[196:199]
    ds_read_b64_tr_b16 v[92:93], v57 offset:24576
    v_mfma_f32_16x16x32_bf16 v[228:231], v[68:71], v[188:191], v[228:231]
    ds_read_b64_tr_b16 v[94:95], v57 offset:28672
    v_xor_b32 v57, 65536, v57
    buffer_load_dwordx4 v[172:175], v3, s[4:7], s31 offen offset:1024 sc1
    s_waitcnt lgkmcnt(8)
    v_mfma_f32_16x16x32_bf16 v[200:203], v[72:75], v[184:187], v[200:203]
    v_mfma_f32_16x16x32_bf16 v[232:235], v[72:75], v[188:191], v[232:235]
    v_mfma_f32_16x16x32_bf16 v[204:207], v[76:79], v[184:187], v[204:207]
    v_mfma_f32_16x16x32_bf16 v[236:239], v[76:79], v[188:191], v[236:239]
    buffer_load_dwordx4 v[176:179], v2, s[4:7], s31 offen offset:2048 sc1
    s_waitcnt lgkmcnt(0)
    s_waitcnt vmcnt(19)
    s_barrier
    v_mfma_f32_16x16x32_bf16 v[208:211], v[80:83], v[184:187], v[208:211]
    ds_read_b64_tr_b16 v[64:65], v50 offset:0
    ds_read_b64_tr_b16 v[66:67], v50 offset:4096
    v_mfma_f32_16x16x32_bf16 v[240:243], v[80:83], v[188:191], v[240:243]
    ds_read_b64_tr_b16 v[68:69], v51 offset:0
    ds_read_b64_tr_b16 v[70:71], v51 offset:4096
    s_cmp_lt_u32 s60, 31
    s_cbranch_scc1 L_recurrent_scan__compressed_kv_cla__moe_arch_mod__prompt_kernel_rare_176
L_recurrent_scan__compressed_kv_cla__moe_arch_mod__prompt_kernel_back_177:
    v_mfma_f32_16x16x32_bf16 v[212:215], v[84:87], v[184:187], v[212:215]
    ds_read_b64_tr_b16 v[72:73], v52 offset:0
    ds_read_b64_tr_b16 v[74:75], v52 offset:4096
    v_mfma_f32_16x16x32_bf16 v[244:247], v[84:87], v[188:191], v[244:247]
    ds_read_b64_tr_b16 v[76:77], v53 offset:0
    ds_read_b64_tr_b16 v[78:79], v53 offset:4096
    s_add_u32 m0, s33, 16384
    s_mov_b32 s32, 1703936
    buffer_load_dwordx4 v6, s[8:11], s32 offen offset:0 lds
    v_mfma_f32_16x16x32_bf16 v[216:219], v[88:91], v[184:187], v[216:219]
    ds_read_b64_tr_b16 v[80:81], v54 offset:0
    ds_read_b64_tr_b16 v[82:83], v54 offset:4096
    v_mfma_f32_16x16x32_bf16 v[248:251], v[88:91], v[188:191], v[248:251]
    v_mfma_f32_16x16x32_bf16 v[220:223], v[92:95], v[184:187], v[220:223]
    ds_read_b64_tr_b16 v[84:85], v55 offset:0
    ds_read_b64_tr_b16 v[86:87], v55 offset:4096
    v_mfma_f32_16x16x32_bf16 v[252:255], v[92:95], v[188:191], v[252:255]
    buffer_load_dwordx4 v7, s[8:11], s32 offen offset:1024 lds
    s_waitcnt lgkmcnt(8)
    v_mfma_f32_16x16x32_bf16 v[192:195], v[64:67], v[128:131], v[192:195]
    ds_read_b64_tr_b16 v[88:89], v56 offset:0
    v_mfma_f32_16x16x32_bf16 v[224:227], v[64:67], v[132:135], v[224:227]
    ds_read_b64_tr_b16 v[90:91], v56 offset:4096
    v_mfma_f32_16x16x32_bf16 v[196:199], v[68:71], v[128:131], v[196:199]
    ds_read_b64_tr_b16 v[92:93], v57 offset:0
    v_mfma_f32_16x16x32_bf16 v[228:231], v[68:71], v[132:135], v[228:231]
    ds_read_b64_tr_b16 v[94:95], v57 offset:4096
    s_waitcnt lgkmcnt(8)
    v_mfma_f32_16x16x32_bf16 v[200:203], v[72:75], v[128:131], v[200:203]
    ds_read_b64_tr_b16 v[64:65], v50 offset:8192
    buffer_load_dwordx4 v8, s[8:11], s32 offen offset:2048 lds
    v_mfma_f32_16x16x32_bf16 v[232:235], v[72:75], v[132:135], v[232:235]
    ds_read_b64_tr_b16 v[66:67], v50 offset:12288
    v_mfma_f32_16x16x32_bf16 v[204:207], v[76:79], v[128:131], v[204:207]
    ds_read_b64_tr_b16 v[68:69], v51 offset:8192
    v_mfma_f32_16x16x32_bf16 v[236:239], v[76:79], v[132:135], v[236:239]
    ds_read_b64_tr_b16 v[70:71], v51 offset:12288
    s_waitcnt lgkmcnt(8)
    v_mfma_f32_16x16x32_bf16 v[208:211], v[80:83], v[128:131], v[208:211]
    ds_read_b64_tr_b16 v[72:73], v52 offset:8192
    buffer_load_dwordx4 v9, s[8:11], s32 offen offset:3072 lds
    v_mfma_f32_16x16x32_bf16 v[240:243], v[80:83], v[132:135], v[240:243]
    ds_read_b64_tr_b16 v[74:75], v52 offset:12288
    v_mfma_f32_16x16x32_bf16 v[212:215], v[84:87], v[128:131], v[212:215]
    ds_read_b64_tr_b16 v[76:77], v53 offset:8192
    v_mfma_f32_16x16x32_bf16 v[244:247], v[84:87], v[132:135], v[244:247]
    ds_read_b64_tr_b16 v[78:79], v53 offset:12288
    s_waitcnt lgkmcnt(8)
    v_mfma_f32_16x16x32_bf16 v[216:219], v[88:91], v[128:131], v[216:219]
    ds_read_b64_tr_b16 v[80:81], v54 offset:8192
    buffer_load_dwordx4 v[180:183], v3, s[4:7], s31 offen offset:2048 sc1
    v_mfma_f32_16x16x32_bf16 v[248:251], v[88:91], v[132:135], v[248:251]
    ds_read_b64_tr_b16 v[82:83], v54 offset:12288
    v_mfma_f32_16x16x32_bf16 v[220:223], v[92:95], v[128:131], v[220:223]
    ds_read_b64_tr_b16 v[84:85], v55 offset:8192
    v_mfma_f32_16x16x32_bf16 v[252:255], v[92:95], v[132:135], v[252:255]
    ds_read_b64_tr_b16 v[86:87], v55 offset:12288
    s_waitcnt lgkmcnt(8)
    s_waitcnt vmcnt(22)
    v_mfma_f32_16x16x32_bf16 v[192:195], v[64:67], v[136:139], v[192:195]
    ds_read_b64_tr_b16 v[88:89], v56 offset:8192
    buffer_load_dwordx4 v[184:187], v2, s[4:7], s31 offen offset:3072 sc1
    v_mfma_f32_16x16x32_bf16 v[224:227], v[64:67], v[140:143], v[224:227]
    ds_read_b64_tr_b16 v[90:91], v56 offset:12288
    v_mfma_f32_16x16x32_bf16 v[196:199], v[68:71], v[136:139], v[196:199]
    ds_read_b64_tr_b16 v[92:93], v57 offset:8192
    v_mfma_f32_16x16x32_bf16 v[228:231], v[68:71], v[140:143], v[228:231]
    ds_read_b64_tr_b16 v[94:95], v57 offset:12288
    s_waitcnt lgkmcnt(8)
    v_mfma_f32_16x16x32_bf16 v[200:203], v[72:75], v[136:139], v[200:203]
    v_mfma_f32_16x16x32_bf16 v[232:235], v[72:75], v[140:143], v[232:235]
    buffer_load_dwordx4 v[188:191], v3, s[4:7], s31 offen offset:3072 sc1
    v_mfma_f32_16x16x32_bf16 v[204:207], v[76:79], v[136:139], v[204:207]
    v_mfma_f32_16x16x32_bf16 v[236:239], v[76:79], v[140:143], v[236:239]
    s_cmp_lt_u32 s60, 31
    s_cbranch_scc1 L_recurrent_scan__compressed_kv_cla__moe_arch_mod__prompt_kernel_rare_181
L_recurrent_scan__compressed_kv_cla__moe_arch_mod__prompt_kernel_back_182:
    s_waitcnt lgkmcnt(0)
    s_waitcnt vmcnt(18)
    s_barrier
    v_mfma_f32_16x16x32_bf16 v[208:211], v[80:83], v[136:139], v[208:211]
    ds_read_b64_tr_b16 v[64:65], v50 offset:16384
    ds_read_b64_tr_b16 v[66:67], v50 offset:20480
    v_mfma_f32_16x16x32_bf16 v[240:243], v[80:83], v[140:143], v[240:243]
    ds_read_b64_tr_b16 v[68:69], v51 offset:16384
    ds_read_b64_tr_b16 v[70:71], v51 offset:20480
    s_add_u32 m0, s33, 65536
    s_mov_b32 s32, 2097152
    buffer_load_dwordx4 v6, s[8:11], s32 offen offset:0 lds
    v_mfma_f32_16x16x32_bf16 v[212:215], v[84:87], v[136:139], v[212:215]
    ds_read_b64_tr_b16 v[72:73], v52 offset:16384
    ds_read_b64_tr_b16 v[74:75], v52 offset:20480
    v_mfma_f32_16x16x32_bf16 v[244:247], v[84:87], v[140:143], v[244:247]
    ds_read_b64_tr_b16 v[76:77], v53 offset:16384
    ds_read_b64_tr_b16 v[78:79], v53 offset:20480
    v_mfma_f32_16x16x32_bf16 v[216:219], v[88:91], v[136:139], v[216:219]
    ds_read_b64_tr_b16 v[80:81], v54 offset:16384
    ds_read_b64_tr_b16 v[82:83], v54 offset:20480
    v_mfma_f32_16x16x32_bf16 v[248:251], v[88:91], v[140:143], v[248:251]
    buffer_load_dwordx4 v7, s[8:11], s32 offen offset:1024 lds
    v_mfma_f32_16x16x32_bf16 v[220:223], v[92:95], v[136:139], v[220:223]
    ds_read_b64_tr_b16 v[84:85], v55 offset:16384
    ds_read_b64_tr_b16 v[86:87], v55 offset:20480
    v_mfma_f32_16x16x32_bf16 v[252:255], v[92:95], v[140:143], v[252:255]
    s_waitcnt lgkmcnt(8)
    v_mfma_f32_16x16x32_bf16 v[192:195], v[64:67], v[144:147], v[192:195]
    ds_read_b64_tr_b16 v[88:89], v56 offset:16384
    v_mfma_f32_16x16x32_bf16 v[224:227], v[64:67], v[148:151], v[224:227]
    ds_read_b64_tr_b16 v[90:91], v56 offset:20480
    buffer_load_dwordx4 v8, s[8:11], s32 offen offset:2048 lds
    v_mfma_f32_16x16x32_bf16 v[196:199], v[68:71], v[144:147], v[196:199]
    ds_read_b64_tr_b16 v[92:93], v57 offset:16384
    v_mfma_f32_16x16x32_bf16 v[228:231], v[68:71], v[148:151], v[228:231]
    ds_read_b64_tr_b16 v[94:95], v57 offset:20480
    s_waitcnt lgkmcnt(8)
    v_mfma_f32_16x16x32_bf16 v[200:203], v[72:75], v[144:147], v[200:203]
    ds_read_b64_tr_b16 v[64:65], v50 offset:24576
    v_mfma_f32_16x16x32_bf16 v[232:235], v[72:75], v[148:151], v[232:235]
    ds_read_b64_tr_b16 v[66:67], v50 offset:28672
    v_xor_b32 v50, 65536, v50
    v_mfma_f32_16x16x32_bf16 v[204:207], v[76:79], v[144:147], v[204:207]
    ds_read_b64_tr_b16 v[68:69], v51 offset:24576
    buffer_load_dwordx4 v9, s[8:11], s32 offen offset:3072 lds
    v_mfma_f32_16x16x32_bf16 v[236:239], v[76:79], v[148:151], v[236:239]
    ds_read_b64_tr_b16 v[70:71], v51 offset:28672
    v_xor_b32 v51, 65536, v51
    s_waitcnt lgkmcnt(8)
    v_mfma_f32_16x16x32_bf16 v[208:211], v[80:83], v[144:147], v[208:211]
    ds_read_b64_tr_b16 v[72:73], v52 offset:24576
    v_mfma_f32_16x16x32_bf16 v[240:243], v[80:83], v[148:151], v[240:243]
    ds_read_b64_tr_b16 v[74:75], v52 offset:28672
    v_xor_b32 v52, 65536, v52
    v_mfma_f32_16x16x32_bf16 v[212:215], v[84:87], v[144:147], v[212:215]
    ds_read_b64_tr_b16 v[76:77], v53 offset:24576
    s_mov_b32 s31, 32768
    buffer_load_dwordx4 v[128:131], v2, s[4:7], s31 offen offset:0 sc1
    v_mfma_f32_16x16x32_bf16 v[244:247], v[84:87], v[148:151], v[244:247]
    ds_read_b64_tr_b16 v[78:79], v53 offset:28672
    v_xor_b32 v53, 65536, v53
    s_waitcnt lgkmcnt(8)
    v_mfma_f32_16x16x32_bf16 v[216:219], v[88:91], v[144:147], v[216:219]
    ds_read_b64_tr_b16 v[80:81], v54 offset:24576
    v_mfma_f32_16x16x32_bf16 v[248:251], v[88:91], v[148:151], v[248:251]
    ds_read_b64_tr_b16 v[82:83], v54 offset:28672
    v_xor_b32 v54, 65536, v54
    v_mfma_f32_16x16x32_bf16 v[220:223], v[92:95], v[144:147], v[220:223]
    ds_read_b64_tr_b16 v[84:85], v55 offset:24576
    buffer_load_dwordx4 v[132:135], v3, s[4:7], s31 offen offset:0 sc1
    v_mfma_f32_16x16x32_bf16 v[252:255], v[92:95], v[148:151], v[252:255]
    ds_read_b64_tr_b16 v[86:87], v55 offset:28672
    v_xor_b32 v55, 65536, v55
    s_waitcnt lgkmcnt(8)
    s_waitcnt vmcnt(22)
    v_mfma_f32_16x16x32_bf16 v[192:195], v[64:67], v[152:155], v[192:195]
    ds_read_b64_tr_b16 v[88:89], v56 offset:24576
    v_mfma_f32_16x16x32_bf16 v[224:227], v[64:67], v[156:159], v[224:227]
    ds_read_b64_tr_b16 v[90:91], v56 offset:28672
    v_xor_b32 v56, 65536, v56
    v_mfma_f32_16x16x32_bf16 v[196:199], v[68:71], v[152:155], v[196:199]
    ds_read_b64_tr_b16 v[92:93], v57 offset:24576
    buffer_load_dwordx4 v[136:139], v2, s[4:7], s31 offen offset:1024 sc1
    v_mfma_f32_16x16x32_bf16 v[228:231], v[68:71], v[156:159], v[228:231]
    ds_read_b64_tr_b16 v[94:95], v57 offset:28672
    v_xor_b32 v57, 65536, v57
    s_waitcnt lgkmcnt(8)
    v_mfma_f32_16x16x32_bf16 v[200:203], v[72:75], v[152:155], v[200:203]
    v_mfma_f32_16x16x32_bf16 v[232:235], v[72:75], v[156:159], v[232:235]
    v_mfma_f32_16x16x32_bf16 v[204:207], v[76:79], v[152:155], v[204:207]
    v_mfma_f32_16x16x32_bf16 v[236:239], v[76:79], v[156:159], v[236:239]
    buffer_load_dwordx4 v[140:143], v3, s[4:7], s31 offen offset:1024 sc1
    s_waitcnt lgkmcnt(0)
    s_waitcnt vmcnt(19)
    s_barrier
    v_mfma_f32_16x16x32_bf16 v[208:211], v[80:83], v[152:155], v[208:211]
    ds_read_b64_tr_b16 v[64:65], v50 offset:0
    ds_read_b64_tr_b16 v[66:67], v50 offset:4096
    v_mfma_f32_16x16x32_bf16 v[240:243], v[80:83], v[156:159], v[240:243]
    ds_read_b64_tr_b16 v[68:69], v51 offset:0
    ds_read_b64_tr_b16 v[70:71], v51 offset:4096
    v_mfma_f32_16x16x32_bf16 v[212:215], v[84:87], v[152:155], v[212:215]
    ds_read_b64_tr_b16 v[72:73], v52 offset:0
    ds_read_b64_tr_b16 v[74:75], v52 offset:4096
    v_mfma_f32_16x16x32_bf16 v[244:247], v[84:87], v[156:159], v[244:247]
    ds_read_b64_tr_b16 v[76:77], v53 offset:0
    ds_read_b64_tr_b16 v[78:79], v53 offset:4096
    s_add_u32 m0, s33, 81920
    s_mov_b32 s32, 2228224
    buffer_load_dwordx4 v6, s[8:11], s32 offen offset:0 lds
    v_mfma_f32_16x16x32_bf16 v[216:219], v[88:91], v[152:155], v[216:219]
    ds_read_b64_tr_b16 v[80:81], v54 offset:0
    ds_read_b64_tr_b16 v[82:83], v54 offset:4096
    v_mfma_f32_16x16x32_bf16 v[248:251], v[88:91], v[156:159], v[248:251]
    v_mfma_f32_16x16x32_bf16 v[220:223], v[92:95], v[152:155], v[220:223]
    ds_read_b64_tr_b16 v[84:85], v55 offset:0
    ds_read_b64_tr_b16 v[86:87], v55 offset:4096
    v_mfma_f32_16x16x32_bf16 v[252:255], v[92:95], v[156:159], v[252:255]
    buffer_load_dwordx4 v7, s[8:11], s32 offen offset:1024 lds
    s_waitcnt lgkmcnt(8)
    s_waitcnt vmcnt(20)
    v_mfma_f32_16x16x32_bf16 v[192:195], v[64:67], v[160:163], v[192:195]
    ds_read_b64_tr_b16 v[88:89], v56 offset:0
    v_mfma_f32_16x16x32_bf16 v[224:227], v[64:67], v[164:167], v[224:227]
    ds_read_b64_tr_b16 v[90:91], v56 offset:4096
    v_mfma_f32_16x16x32_bf16 v[196:199], v[68:71], v[160:163], v[196:199]
    ds_read_b64_tr_b16 v[92:93], v57 offset:0
    v_mfma_f32_16x16x32_bf16 v[228:231], v[68:71], v[164:167], v[228:231]
    ds_read_b64_tr_b16 v[94:95], v57 offset:4096
    buffer_load_dwordx4 v8, s[8:11], s32 offen offset:2048 lds
    s_waitcnt lgkmcnt(8)
    v_mfma_f32_16x16x32_bf16 v[200:203], v[72:75], v[160:163], v[200:203]
    ds_read_b64_tr_b16 v[64:65], v50 offset:8192
    v_mfma_f32_16x16x32_bf16 v[232:235], v[72:75], v[164:167], v[232:235]
    ds_read_b64_tr_b16 v[66:67], v50 offset:12288
    v_mfma_f32_16x16x32_bf16 v[204:207], v[76:79], v[160:163], v[204:207]
    ds_read_b64_tr_b16 v[68:69], v51 offset:8192
    v_mfma_f32_16x16x32_bf16 v[236:239], v[76:79], v[164:167], v[236:239]
    ds_read_b64_tr_b16 v[70:71], v51 offset:12288
    s_waitcnt lgkmcnt(8)
    v_mfma_f32_16x16x32_bf16 v[208:211], v[80:83], v[160:163], v[208:211]
    ds_read_b64_tr_b16 v[72:73], v52 offset:8192
    buffer_load_dwordx4 v9, s[8:11], s32 offen offset:3072 lds
    v_mfma_f32_16x16x32_bf16 v[240:243], v[80:83], v[164:167], v[240:243]
    ds_read_b64_tr_b16 v[74:75], v52 offset:12288
    v_mfma_f32_16x16x32_bf16 v[212:215], v[84:87], v[160:163], v[212:215]
    ds_read_b64_tr_b16 v[76:77], v53 offset:8192
    v_mfma_f32_16x16x32_bf16 v[244:247], v[84:87], v[164:167], v[244:247]
    ds_read_b64_tr_b16 v[78:79], v53 offset:12288
    s_waitcnt lgkmcnt(8)
    v_mfma_f32_16x16x32_bf16 v[216:219], v[88:91], v[160:163], v[216:219]
    ds_read_b64_tr_b16 v[80:81], v54 offset:8192
    buffer_load_dwordx4 v[144:147], v2, s[4:7], s31 offen offset:2048 sc1
    v_mfma_f32_16x16x32_bf16 v[248:251], v[88:91], v[164:167], v[248:251]
    ds_read_b64_tr_b16 v[82:83], v54 offset:12288
    v_mfma_f32_16x16x32_bf16 v[220:223], v[92:95], v[160:163], v[220:223]
    ds_read_b64_tr_b16 v[84:85], v55 offset:8192
    v_mfma_f32_16x16x32_bf16 v[252:255], v[92:95], v[164:167], v[252:255]
    ds_read_b64_tr_b16 v[86:87], v55 offset:12288
    s_waitcnt lgkmcnt(8)
    s_waitcnt vmcnt(21)
    v_mfma_f32_16x16x32_bf16 v[192:195], v[64:67], v[168:171], v[192:195]
    ds_read_b64_tr_b16 v[88:89], v56 offset:8192
    buffer_load_dwordx4 v[148:151], v3, s[4:7], s31 offen offset:2048 sc1
    v_mfma_f32_16x16x32_bf16 v[224:227], v[64:67], v[172:175], v[224:227]
    ds_read_b64_tr_b16 v[90:91], v56 offset:12288
    v_mfma_f32_16x16x32_bf16 v[196:199], v[68:71], v[168:171], v[196:199]
    ds_read_b64_tr_b16 v[92:93], v57 offset:8192
    v_mfma_f32_16x16x32_bf16 v[228:231], v[68:71], v[172:175], v[228:231]
    ds_read_b64_tr_b16 v[94:95], v57 offset:12288
    s_waitcnt lgkmcnt(8)
    v_mfma_f32_16x16x32_bf16 v[200:203], v[72:75], v[168:171], v[200:203]
    buffer_load_dwordx4 v[152:155], v2, s[4:7], s31 offen offset:3072 sc1
    v_mfma_f32_16x16x32_bf16 v[232:235], v[72:75], v[172:175], v[232:235]
    v_mfma_f32_16x16x32_bf16 v[204:207], v[76:79], v[168:171], v[204:207]
    v_mfma_f32_16x16x32_bf16 v[236:239], v[76:79], v[172:175], v[236:239]
    s_waitcnt lgkmcnt(0)
    s_waitcnt vmcnt(18)
    s_barrier
    v_mfma_f32_16x16x32_bf16 v[208:211], v[80:83], v[168:171], v[208:211]
    ds_read_b64_tr_b16 v[64:65], v50 offset:16384
    ds_read_b64_tr_b16 v[66:67], v50 offset:20480
    v_mfma_f32_16x16x32_bf16 v[240:243], v[80:83], v[172:175], v[240:243]
    ds_read_b64_tr_b16 v[68:69], v51 offset:16384
    ds_read_b64_tr_b16 v[70:71], v51 offset:20480
    s_add_u32 m0, s33, 0
    s_mov_b32 s32, 2621440
    buffer_load_dwordx4 v6, s[8:11], s32 offen offset:0 lds
    v_mfma_f32_16x16x32_bf16 v[212:215], v[84:87], v[168:171], v[212:215]
    ds_read_b64_tr_b16 v[72:73], v52 offset:16384
    ds_read_b64_tr_b16 v[74:75], v52 offset:20480
    v_mfma_f32_16x16x32_bf16 v[244:247], v[84:87], v[172:175], v[244:247]
    ds_read_b64_tr_b16 v[76:77], v53 offset:16384
    ds_read_b64_tr_b16 v[78:79], v53 offset:20480
    v_mfma_f32_16x16x32_bf16 v[216:219], v[88:91], v[168:171], v[216:219]
    ds_read_b64_tr_b16 v[80:81], v54 offset:16384
    ds_read_b64_tr_b16 v[82:83], v54 offset:20480
    v_mfma_f32_16x16x32_bf16 v[248:251], v[88:91], v[172:175], v[248:251]
    buffer_load_dwordx4 v[156:159], v3, s[4:7], s31 offen offset:3072 sc1
    v_mfma_f32_16x16x32_bf16 v[220:223], v[92:95], v[168:171], v[220:223]
    ds_read_b64_tr_b16 v[84:85], v55 offset:16384
    ds_read_b64_tr_b16 v[86:87], v55 offset:20480
    v_mfma_f32_16x16x32_bf16 v[252:255], v[92:95], v[172:175], v[252:255]
    s_waitcnt lgkmcnt(8)
    s_waitcnt vmcnt(19)
    v_mfma_f32_16x16x32_bf16 v[192:195], v[64:67], v[176:179], v[192:195]
    ds_read_b64_tr_b16 v[88:89], v56 offset:16384
    v_mfma_f32_16x16x32_bf16 v[224:227], v[64:67], v[180:183], v[224:227]
    ds_read_b64_tr_b16 v[90:91], v56 offset:20480
    buffer_load_dwordx4 v7, s[8:11], s32 offen offset:1024 lds
    v_mfma_f32_16x16x32_bf16 v[196:199], v[68:71], v[176:179], v[196:199]
    ds_read_b64_tr_b16 v[92:93], v57 offset:16384
    v_mfma_f32_16x16x32_bf16 v[228:231], v[68:71], v[180:183], v[228:231]
    ds_read_b64_tr_b16 v[94:95], v57 offset:20480
    s_waitcnt lgkmcnt(8)
    v_mfma_f32_16x16x32_bf16 v[200:203], v[72:75], v[176:179], v[200:203]
    ds_read_b64_tr_b16 v[64:65], v50 offset:24576
    v_mfma_f32_16x16x32_bf16 v[232:235], v[72:75], v[180:183], v[232:235]
    ds_read_b64_tr_b16 v[66:67], v50 offset:28672
    v_xor_b32 v50, 65536, v50
    v_mfma_f32_16x16x32_bf16 v[204:207], v[76:79], v[176:179], v[204:207]
    ds_read_b64_tr_b16 v[68:69], v51 offset:24576
    buffer_load_dwordx4 v8, s[8:11], s32 offen offset:2048 lds
    v_mfma_f32_16x16x32_bf16 v[236:239], v[76:79], v[180:183], v[236:239]
    ds_read_b64_tr_b16 v[70:71], v51 offset:28672
    v_xor_b32 v51, 65536, v51
    s_waitcnt lgkmcnt(8)
    v_mfma_f32_16x16x32_bf16 v[208:211], v[80:83], v[176:179], v[208:211]
    ds_read_b64_tr_b16 v[72:73], v52 offset:24576
    v_mfma_f32_16x16x32_bf16 v[240:243], v[80:83], v[180:183], v[240:243]
    ds_read_b64_tr_b16 v[74:75], v52 offset:28672
    v_xor_b32 v52, 65536, v52
    v_mfma_f32_16x16x32_bf16 v[212:215], v[84:87], v[176:179], v[212:215]
    ds_read_b64_tr_b16 v[76:77], v53 offset:24576
    buffer_load_dwordx4 v9, s[8:11], s32 offen offset:3072 lds
    v_mfma_f32_16x16x32_bf16 v[244:247], v[84:87], v[180:183], v[244:247]
    ds_read_b64_tr_b16 v[78:79], v53 offset:28672
    v_xor_b32 v53, 65536, v53
    s_waitcnt lgkmcnt(8)
    v_mfma_f32_16x16x32_bf16 v[216:219], v[88:91], v[176:179], v[216:219]
    ds_read_b64_tr_b16 v[80:81], v54 offset:24576
    v_mfma_f32_16x16x32_bf16 v[248:251], v[88:91], v[180:183], v[248:251]
    ds_read_b64_tr_b16 v[82:83], v54 offset:28672
    v_xor_b32 v54, 65536, v54
    v_mfma_f32_16x16x32_bf16 v[220:223], v[92:95], v[176:179], v[220:223]
    ds_read_b64_tr_b16 v[84:85], v55 offset:24576
    s_mov_b32 s31, 40960
    buffer_load_dwordx4 v[160:163], v2, s[4:7], s31 offen offset:0 sc1
    v_mfma_f32_16x16x32_bf16 v[252:255], v[92:95], v[180:183], v[252:255]
    ds_read_b64_tr_b16 v[86:87], v55 offset:28672
    v_xor_b32 v55, 65536, v55
    s_waitcnt lgkmcnt(8)
    s_waitcnt vmcnt(21)
    v_mfma_f32_16x16x32_bf16 v[192:195], v[64:67], v[184:187], v[192:195]
    ds_read_b64_tr_b16 v[88:89], v56 offset:24576
    v_mfma_f32_16x16x32_bf16 v[224:227], v[64:67], v[188:191], v[224:227]
    ds_read_b64_tr_b16 v[90:91], v56 offset:28672
    v_xor_b32 v56, 65536, v56
    v_mfma_f32_16x16x32_bf16 v[196:199], v[68:71], v[184:187], v[196:199]
    ds_read_b64_tr_b16 v[92:93], v57 offset:24576
    buffer_load_dwordx4 v[164:167], v3, s[4:7], s31 offen offset:0 sc1
    v_mfma_f32_16x16x32_bf16 v[228:231], v[68:71], v[188:191], v[228:231]
    ds_read_b64_tr_b16 v[94:95], v57 offset:28672
    v_xor_b32 v57, 65536, v57
    s_waitcnt lgkmcnt(8)
    v_mfma_f32_16x16x32_bf16 v[200:203], v[72:75], v[184:187], v[200:203]
    v_mfma_f32_16x16x32_bf16 v[232:235], v[72:75], v[188:191], v[232:235]
    v_mfma_f32_16x16x32_bf16 v[204:207], v[76:79], v[184:187], v[204:207]
    v_mfma_f32_16x16x32_bf16 v[236:239], v[76:79], v[188:191], v[236:239]
    buffer_load_dwordx4 v[168:171], v2, s[4:7], s31 offen offset:1024 sc1
    s_waitcnt lgkmcnt(0)
    s_waitcnt vmcnt(19)
    s_barrier
    v_mfma_f32_16x16x32_bf16 v[208:211], v[80:83], v[184:187], v[208:211]
    ds_read_b64_tr_b16 v[64:65], v50 offset:0
    ds_read_b64_tr_b16 v[66:67], v50 offset:4096
    v_mfma_f32_16x16x32_bf16 v[240:243], v[80:83], v[188:191], v[240:243]
    ds_read_b64_tr_b16 v[68:69], v51 offset:0
    ds_read_b64_tr_b16 v[70:71], v51 offset:4096
    s_cmp_lt_u32 s60, 31
    s_cbranch_scc1 L_recurrent_scan__compressed_kv_cla__moe_arch_mod__prompt_kernel_rare_183
L_recurrent_scan__compressed_kv_cla__moe_arch_mod__prompt_kernel_back_184:
    v_mfma_f32_16x16x32_bf16 v[212:215], v[84:87], v[184:187], v[212:215]
    ds_read_b64_tr_b16 v[72:73], v52 offset:0
    ds_read_b64_tr_b16 v[74:75], v52 offset:4096
    s_sub_u32 s36, s56, s38
    s_sub_u32 s37, s57, s38
    s_min_u32 s36, s36, s37
    s_cmp_lt_u32 s36, 16
    s_cbranch_scc1 L_recurrent_scan__compressed_kv_cla__moe_arch_mod__prompt_kernel_rare_190
L_recurrent_scan__compressed_kv_cla__moe_arch_mod__prompt_kernel_back_191:
    v_mfma_f32_16x16x32_bf16 v[244:247], v[84:87], v[188:191], v[244:247]
    ds_read_b64_tr_b16 v[76:77], v53 offset:0
    ds_read_b64_tr_b16 v[78:79], v53 offset:4096
    s_add_u32 m0, s33, 16384
    s_mov_b32 s32, 2752512
    buffer_load_dwordx4 v6, s[8:11], s32 offen offset:0 lds
    v_mfma_f32_16x16x32_bf16 v[216:219], v[88:91], v[184:187], v[216:219]
    ds_read_b64_tr_b16 v[80:81], v54 offset:0
    ds_read_b64_tr_b16 v[82:83], v54 offset:4096
    v_mfma_f32_16x16x32_bf16 v[248:251], v[88:91], v[188:191], v[248:251]
    v_mfma_f32_16x16x32_bf16 v[220:223], v[92:95], v[184:187], v[220:223]
    ds_read_b64_tr_b16 v[84:85], v55 offset:0
    ds_read_b64_tr_b16 v[86:87], v55 offset:4096
    v_mfma_f32_16x16x32_bf16 v[252:255], v[92:95], v[188:191], v[252:255]
    buffer_load_dwordx4 v[172:175], v3, s[4:7], s31 offen offset:1024 sc1
    s_waitcnt lgkmcnt(8)
    s_waitcnt vmcnt(19)
    v_mfma_f32_16x16x32_bf16 v[192:195], v[64:67], v[128:131], v[192:195]
    ds_read_b64_tr_b16 v[88:89], v56 offset:0
    v_mfma_f32_16x16x32_bf16 v[224:227], v[64:67], v[132:135], v[224:227]
    ds_read_b64_tr_b16 v[90:91], v56 offset:4096
    v_mfma_f32_16x16x32_bf16 v[196:199], v[68:71], v[128:131], v[196:199]
    ds_read_b64_tr_b16 v[92:93], v57 offset:0
    v_mfma_f32_16x16x32_bf16 v[228:231], v[68:71], v[132:135], v[228:231]
    ds_read_b64_tr_b16 v[94:95], v57 offset:4096
    buffer_load_dwordx4 v7, s[8:11], s32 offen offset:1024 lds
    s_waitcnt lgkmcnt(8)
    v_mfma_f32_16x16x32_bf16 v[200:203], v[72:75], v[128:131], v[200:203]
    ds_read_b64_tr_b16 v[64:65], v50 offset:8192
    v_mfma_f32_16x16x32_bf16 v[232:235], v[72:75], v[132:135], v[232:235]
    ds_read_b64_tr_b16 v[66:67], v50 offset:12288
    v_mfma_f32_16x16x32_bf16 v[204:207], v[76:79], v[128:131], v[204:207]
    ds_read_b64_tr_b16 v[68:69], v51 offset:8192
    v_mfma_f32_16x16x32_bf16 v[236:239], v[76:79], v[132:135], v[236:239]
    ds_read_b64_tr_b16 v[70:71], v51 offset:12288
    s_waitcnt lgkmcnt(8)
    v_mfma_f32_16x16x32_bf16 v[208:211], v[80:83], v[128:131], v[208:211]
    ds_read_b64_tr_b16 v[72:73], v52 offset:8192
    buffer_load_dwordx4 v8, s[8:11], s32 offen offset:2048 lds
    v_mfma_f32_16x16x32_bf16 v[240:243], v[80:83], v[132:135], v[240:243]
    ds_read_b64_tr_b16 v[74:75], v52 offset:12288
    v_mfma_f32_16x16x32_bf16 v[212:215], v[84:87], v[128:131], v[212:215]
    ds_read_b64_tr_b16 v[76:77], v53 offset:8192
    v_mfma_f32_16x16x32_bf16 v[244:247], v[84:87], v[132:135], v[244:247]
    ds_read_b64_tr_b16 v[78:79], v53 offset:12288
    s_waitcnt lgkmcnt(8)
    v_mfma_f32_16x16x32_bf16 v[216:219], v[88:91], v[128:131], v[216:219]
    ds_read_b64_tr_b16 v[80:81], v54 offset:8192
    buffer_load_dwordx4 v9, s[8:11], s32 offen offset:3072 lds
    v_mfma_f32_16x16x32_bf16 v[248:251], v[88:91], v[132:135], v[248:251]
    ds_read_b64_tr_b16 v[82:83], v54 offset:12288
    v_mfma_f32_16x16x32_bf16 v[220:223], v[92:95], v[128:131], v[220:223]
    ds_read_b64_tr_b16 v[84:85], v55 offset:8192
    v_mfma_f32_16x16x32_bf16 v[252:255], v[92:95], v[132:135], v[252:255]
    ds_read_b64_tr_b16 v[86:87], v55 offset:12288
    s_waitcnt lgkmcnt(8)
    s_waitcnt vmcnt(20)
    v_mfma_f32_16x16x32_bf16 v[192:195], v[64:67], v[136:139], v[192:195]
    ds_read_b64_tr_b16 v[88:89], v56 offset:8192
    buffer_load_dwordx4 v[176:179], v2, s[4:7], s31 offen offset:2048 sc1
    v_mfma_f32_16x16x32_bf16 v[224:227], v[64:67], v[140:143], v[224:227]
    ds_read_b64_tr_b16 v[90:91], v56 offset:12288
    v_mfma_f32_16x16x32_bf16 v[196:199], v[68:71], v[136:139], v[196:199]
    ds_read_b64_tr_b16 v[92:93], v57 offset:8192
    v_mfma_f32_16x16x32_bf16 v[228:231], v[68:71], v[140:143], v[228:231]
    ds_read_b64_tr_b16 v[94:95], v57 offset:12288
    s_waitcnt lgkmcnt(8)
    v_mfma_f32_16x16x32_bf16 v[200:203], v[72:75], v[136:139], v[200:203]
    buffer_load_dwordx4 v[180:183], v3, s[4:7], s31 offen offset:2048 sc1
    v_mfma_f32_16x16x32_bf16 v[232:235], v[72:75], v[140:143], v[232:235]
    v_mfma_f32_16x16x32_bf16 v[204:207], v[76:79], v[136:139], v[204:207]
    v_mfma_f32_16x16x32_bf16 v[236:239], v[76:79], v[140:143], v[236:239]
    s_cmp_lt_u32 s60, 31
    s_cbranch_scc1 L_recurrent_scan__compressed_kv_cla__moe_arch_mod__prompt_kernel_rare_188
L_recurrent_scan__compressed_kv_cla__moe_arch_mod__prompt_kernel_back_189:
    s_waitcnt lgkmcnt(0)
    s_waitcnt vmcnt(18)
    s_barrier
    v_mfma_f32_16x16x32_bf16 v[208:211], v[80:83], v[136:139], v[208:211]
    ds_read_b64_tr_b16 v[64:65], v50 offset:16384
    ds_read_b64_tr_b16 v[66:67], v50 offset:20480
    v_mfma_f32_16x16x32_bf16 v[240:243], v[80:83], v[140:143], v[240:243]
    s_mov_b32 m0, s42
    s_mov_b32 s36, 15360
    buffer_load_dwordx4 v15, s[16:19], 0 offen lds
    buffer_load_dwordx4 v15, s[16:19], s36 offen offset:1024 lds
    s_mov_b32 s36, 4194304
    buffer_load_dwordx2 v[48:49], v16, s[24:27], s36 offen sc1
    ds_read_b64_tr_b16 v[68:69], v51 offset:16384
    ds_read_b64_tr_b16 v[70:71], v51 offset:20480
    s_add_u32 m0, s33, 65536
    s_mov_b32 s32, 3145728
    buffer_load_dwordx4 v6, s[8:11], s32 offen offset:0 lds
    v_mfma_f32_16x16x32_bf16 v[212:215], v[84:87], v[136:139], v[212:215]
    ds_read_b64_tr_b16 v[72:73], v52 offset:16384
    ds_read_b64_tr_b16 v[74:75], v52 offset:20480
    v_mfma_f32_16x16x32_bf16 v[244:247], v[84:87], v[140:143], v[244:247]
    ds_read_b64_tr_b16 v[76:77], v53 offset:16384
    ds_read_b64_tr_b16 v[78:79], v53 offset:20480
    v_mfma_f32_16x16x32_bf16 v[216:219], v[88:91], v[136:139], v[216:219]
    ds_read_b64_tr_b16 v[80:81], v54 offset:16384
    ds_read_b64_tr_b16 v[82:83], v54 offset:20480
    v_mfma_f32_16x16x32_bf16 v[248:251], v[88:91], v[140:143], v[248:251]
    buffer_load_dwordx4 v[184:187], v2, s[4:7], s31 offen offset:3072 sc1
    v_mfma_f32_16x16x32_bf16 v[220:223], v[92:95], v[136:139], v[220:223]
    ds_read_b64_tr_b16 v[84:85], v55 offset:16384
    ds_read_b64_tr_b16 v[86:87], v55 offset:20480
    v_mfma_f32_16x16x32_bf16 v[252:255], v[92:95], v[140:143], v[252:255]
    s_waitcnt lgkmcnt(8)
    s_waitcnt vmcnt(21)
    v_mfma_f32_16x16x32_bf16 v[192:195], v[64:67], v[144:147], v[192:195]
    ds_read_b64_tr_b16 v[88:89], v56 offset:16384
    v_mfma_f32_16x16x32_bf16 v[224:227], v[64:67], v[148:151], v[224:227]
    ds_read_b64_tr_b16 v[90:91], v56 offset:20480
    buffer_load_dwordx4 v[188:191], v3, s[4:7], s31 offen offset:3072 sc1
    v_mfma_f32_16x16x32_bf16 v[196:199], v[68:71], v[144:147], v[196:199]
    ds_read_b64_tr_b16 v[92:93], v57 offset:16384
    v_mfma_f32_16x16x32_bf16 v[228:231], v[68:71], v[148:151], v[228:231]
    ds_read_b64_tr_b16 v[94:95], v57 offset:20480
    s_waitcnt lgkmcnt(8)
    v_mfma_f32_16x16x32_bf16 v[200:203], v[72:75], v[144:147], v[200:203]
    ds_read_b64_tr_b16 v[64:65], v50 offset:24576
    v_mfma_f32_16x16x32_bf16 v[232:235], v[72:75], v[148:151], v[232:235]
    ds_read_b64_tr_b16 v[66:67], v50 offset:28672
    v_xor_b32 v50, 65536, v50
    buffer_load_dwordx4 v7, s[8:11], s32 offen offset:1024 lds
    v_mfma_f32_16x16x32_bf16 v[204:207], v[76:79], v[144:147], v[204:207]
    ds_read_b64_tr_b16 v[68:69], v51 offset:24576
    v_mfma_f32_16x16x32_bf16 v[236:239], v[76:79], v[148:151], v[236:239]
    ds_read_b64_tr_b16 v[70:71], v51 offset:28672
    v_xor_b32 v51, 65536, v51
    s_waitcnt lgkmcnt(8)
    v_mfma_f32_16x16x32_bf16 v[208:211], v[80:83], v[144:147], v[208:211]
    ds_read_b64_tr_b16 v[72:73], v52 offset:24576
    v_mfma_f32_16x16x32_bf16 v[240:243], v[80:83], v[148:151], v[240:243]
    ds_read_b64_tr_b16 v[74:75], v52 offset:28672
    v_xor_b32 v52, 65536, v52
    v_mfma_f32_16x16x32_bf16 v[212:215], v[84:87], v[144:147], v[212:215]
    ds_read_b64_tr_b16 v[76:77], v53 offset:24576
    buffer_load_dwordx4 v8, s[8:11], s32 offen offset:2048 lds
    v_mfma_f32_16x16x32_bf16 v[244:247], v[84:87], v[148:151], v[244:247]
    ds_read_b64_tr_b16 v[78:79], v53 offset:28672
    v_xor_b32 v53, 65536, v53
    s_waitcnt lgkmcnt(8)
    v_mfma_f32_16x16x32_bf16 v[216:219], v[88:91], v[144:147], v[216:219]
    ds_read_b64_tr_b16 v[80:81], v54 offset:24576
    s_cmp_eq_u32 s28, 0
    s_cbranch_scc0 L_recurrent_scan__compressed_kv_cla__moe_arch_mod__prompt_kernel_g_197
    s_mov_b32 s43, s38
    s_getpc_b64 s[36:37]
L_recurrent_scan__compressed_kv_cla__moe_arch_mod__prompt_kernel_pc_196:
    s_sub_u32 s36, s36, L_recurrent_scan__compressed_kv_cla__moe_arch_mod__prompt_kernel_pc_196-L_pc
    s_subb_u32 s37, s37, 0
    s_lshr_b32 s38, s2, 3
    s_lshl_b32 s38, s38, 7
    v_lshl_add_u32 v4, v1, 12, s38
    v_min_u32 v4, L_end-L_pc-4, v4
    v_mov_b32 v5, s37
    v_add_co_u32 v4, vcc, s36, v4
    s_mov_b64 exec, 0xffff
    s_nop 0
    v_addc_co_u32 v5, vcc, 0, v5, vcc
    global_load_dword v0, v[4:5], off
    s_mov_b64 exec, -1
    s_nop 1
    s_mov_b32 s38, s43
L_recurrent_scan__compressed_kv_cla__moe_arch_mod__prompt_kernel_g_197:
    v_mfma_f32_16x16x32_bf16 v[248:251], v[88:91], v[148:151], v[248:251]
    ds_read_b64_tr_b16 v[82:83], v54 offset:28672
    v_xor_b32 v54, 65536, v54
    v_mfma_f32_16x16x32_bf16 v[220:223], v[92:95], v[144:147], v[220:223]
    ds_read_b64_tr_b16 v[84:85], v55 offset:24576
    buffer_load_dwordx4 v9, s[8:11], s32 offen offset:3072 lds
    v_mfma_f32_16x16x32_bf16 v[252:255], v[92:95], v[148:151], v[252:255]
    ds_read_b64_tr_b16 v[86:87], v55 offset:28672
    v_xor_b32 v55, 65536, v55
    s_waitcnt lgkmcnt(8)
    s_waitcnt vmcnt(22)
    v_mfma_f32_16x16x32_bf16 v[192:195], v[64:67], v[152:155], v[192:195]
    ds_read_b64_tr_b16 v[88:89], v56 offset:24576
    v_mfma_f32_16x16x32_bf16 v[224:227], v[64:67], v[156:159], v[224:227]
    ds_read_b64_tr_b16 v[90:91], v56 offset:28672
    v_xor_b32 v56, 65536, v56
    v_mfma_f32_16x16x32_bf16 v[196:199], v[68:71], v[152:155], v[196:199]
    ds_read_b64_tr_b16 v[92:93], v57 offset:24576
    s_mov_b32 s31, 49152
    buffer_load_dwordx4 v[128:131], v2, s[4:7], s31 offen offset:0 sc1
    v_mfma_f32_16x16x32_bf16 v[228:231], v[68:71], v[156:159], v[228:231]
    ds_read_b64_tr_b16 v[94:95], v57 offset:28672
    v_xor_b32 v57, 65536, v57
    s_waitcnt lgkmcnt(8)
    v_mfma_f32_16x16x32_bf16 v[200:203], v[72:75], v[152:155], v[200:203]
    v_mfma_f32_16x16x32_bf16 v[232:235], v[72:75], v[156:159], v[232:235]
    v_mfma_f32_16x16x32_bf16 v[204:207], v[76:79], v[152:155], v[204:207]
    buffer_load_dwordx4 v[132:135], v3, s[4:7], s31 offen offset:0 sc1
    s_sub_u32 s36, s56, s38
    s_sub_u32 s37, s57, s38
    s_min_u32 s36, s36, s37
    s_cmp_lt_u32 s36, 16
    s_cbranch_scc1 L_recurrent_scan__compressed_kv_cla__moe_arch_mod__prompt_kernel_rare_192
L_recurrent_scan__compressed_kv_cla__moe_arch_mod__prompt_kernel_back_193:
    v_mfma_f32_16x16x32_bf16 v[236:239], v[76:79], v[156:159], v[236:239]
    s_waitcnt lgkmcnt(0)
    s_waitcnt vmcnt(21)
    s_barrier
    v_mfma_f32_16x16x32_bf16 v[208:211], v[80:83], v[152:155], v[208:211]
    ds_read_b64_tr_b16 v[64:65], v50 offset:0
    ds_read_b64_tr_b16 v[66:67], v50 offset:4096
    v_mfma_f32_16x16x32_bf16 v[240:243], v[80:83], v[156:159], v[240:243]
    ds_read_b64_tr_b16 v[68:69], v51 offset:0
    ds_read_b64_tr_b16 v[70:71], v51 offset:4096
    v_mfma_f32_16x16x32_bf16 v[212:215], v[84:87], v[152:155], v[212:215]
    ds_read_b64_tr_b16 v[72:73], v52 offset:0
    ds_read_b64_tr_b16 v[74:75], v52 offset:4096
    v_mfma_f32_16x16x32_bf16 v[244:247], v[84:87], v[156:159], v[244:247]
    ds_read_b64_tr_b16 v[76:77], v53 offset:0
    ds_read_b64_tr_b16 v[78:79], v53 offset:4096
    s_add_u32 m0, s33, 81920
    s_mov_b32 s32, 3276800
    buffer_load_dwordx4 v6, s[8:11], s32 offen offset:0 lds
    v_mfma_f32_16x16x32_bf16 v[216:219], v[88:91], v[152:155], v[216:219]
    ds_read_b64_tr_b16 v[80:81], v54 offset:0
    ds_read_b64_tr_b16 v[82:83], v54 offset:4096
    v_mfma_f32_16x16x32_bf16 v[248:251], v[88:91], v[156:159], v[248:251]
    v_mfma_f32_16x16x32_bf16 v[220:223], v[92:95], v[152:155], v[220:223]
    ds_read_b64_tr_b16 v[84:85], v55 offset:0
    ds_read_b64_tr_b16 v[86:87], v55 offset:4096
    v_mfma_f32_16x16x32_bf16 v[252:255], v[92:95], v[156:159], v[252:255]
    buffer_load_dwordx4 v7, s[8:11], s32 offen offset:1024 lds
    s_waitcnt lgkmcnt(8)
    s_waitcnt vmcnt(21)
    v_mfma_f32_16x16x32_bf16 v[192:195], v[64:67], v[160:163], v[192:195]
    ds_read_b64_tr_b16 v[88:89], v56 offset:0
    v_mfma_f32_16x16x32_bf16 v[224:227], v[64:67], v[164:167], v[224:227]
    ds_read_b64_tr_b16 v[90:91], v56 offset:4096
    v_mfma_f32_16x16x32_bf16 v[196:199], v[68:71], v[160:163], v[196:199]
    ds_read_b64_tr_b16 v[92:93], v57 offset:0
    v_mfma_f32_16x16x32_bf16 v[228:231], v[68:71], v[164:167], v[228:231]
    ds_read_b64_tr_b16 v[94:95], v57 offset:4096
    buffer_load_dwordx4 v[136:139], v2, s[4:7], s31 offen offset:1024 sc1
    s_waitcnt lgkmcnt(8)
    v_mfma_f32_16x16x32_bf16 v[200:203], v[72:75], v[160:163], v[200:203]
    ds_read_b64_tr_b16 v[64:65], v50 offset:8192
    v_mfma_f32_16x16x32_bf16 v[232:235], v[72:75], v[164:167], v[232:235]
    ds_read_b64_tr_b16 v[66:67], v50 offset:12288
    v_mfma_f32_16x16x32_bf16 v[204:207], v[76:79], v[160:163], v[204:207]
    ds_read_b64_tr_b16 v[68:69], v51 offset:8192
    v_mfma_f32_16x16x32_bf16 v[236:239], v[76:79], v[164:167], v[236:239]
    ds_read_b64_tr_b16 v[70:71], v51 offset:12288
    s_waitcnt lgkmcnt(8)
    v_mfma_f32_16x16x32_bf16 v[208:211], v[80:83], v[160:163], v[208:211]
    ds_read_b64_tr_b16 v[72:73], v52 offset:8192
    buffer_load_dwordx4 v[140:143], v3, s[4:7], s31 offen offset:1024 sc1
    v_mfma_f32_16x16x32_bf16 v[240:243], v[80:83], v[164:167], v[240:243]
    ds_read_b64_tr_b16 v[74:75], v52 offset:12288
    v_mfma_f32_16x16x32_bf16 v[212:215], v[84:87], v[160:163], v[212:215]
    ds_read_b64_tr_b16 v[76:77], v53 offset:8192
    v_mfma_f32_16x16x32_bf16 v[244:247], v[84:87], v[164:167], v[244:247]
    ds_read_b64_tr_b16 v[78:79], v53 offset:12288
    s_waitcnt lgkmcnt(8)
    v_mfma_f32_16x16x32_bf16 v[216:219], v[88:91], v[160:163], v[216:219]
    ds_read_b64_tr_b16 v[80:81], v54 offset:8192
    buffer_load_dwordx4 v8, s[8:11], s32 offen offset:2048 lds
    v_mfma_f32_16x16x32_bf16 v[248:251], v[88:91], v[164:167], v[248:251]
    ds_read_b64_tr_b16 v[82:83], v54 offset:12288
    v_mfma_f32_16x16x32_bf16 v[220:223], v[92:95], v[160:163], v[220:223]
    ds_read_b64_tr_b16 v[84:85], v55 offset:8192
    v_mfma_f32_16x16x32_bf16 v[252:255], v[92:95], v[164:167], v[252:255]
    ds_read_b64_tr_b16 v[86:87], v55 offset:12288
    s_waitcnt lgkmcnt(8)
    s_waitcnt vmcnt(21)
    v_mfma_f32_16x16x32_bf16 v[192:195], v[64:67], v[168:171], v[192:195]
    ds_read_b64_tr_b16 v[88:89], v56 offset:8192
    buffer_load_dwordx4 v9, s[8:11], s32 offen offset:3072 lds
    v_mfma_f32_16x16x32_bf16 v[224:227], v[64:67], v[172:175], v[224:227]
    ds_read_b64_tr_b16 v[90:91], v56 offset:12288
    v_mfma_f32_16x16x32_bf16 v[196:199], v[68:71], v[168:171], v[196:199]
    ds_read_b64_tr_b16 v[92:93], v57 offset:8192
    v_mfma_f32_16x16x32_bf16 v[228:231], v[68:71], v[172:175], v[228:231]
    ds_read_b64_tr_b16 v[94:95], v57 offset:12288
    s_waitcnt lgkmcnt(8)
    v_mfma_f32_16x16x32_bf16 v[200:203], v[72:75], v[168:171], v[200:203]
    buffer_load_dwordx4 v[144:147], v2, s[4:7], s31 offen offset:2048 sc1
    v_mfma_f32_16x16x32_bf16 v[232:235], v[72:75], v[172:175], v[232:235]
    v_mfma_f32_16x16x32_bf16 v[204:207], v[76:79], v[168:171], v[204:207]
    v_mfma_f32_16x16x32_bf16 v[236:239], v[76:79], v[172:175], v[236:239]
    s_waitcnt lgkmcnt(0)
    s_waitcnt vmcnt(20)
    s_barrier
    v_mfma_f32_16x16x32_bf16 v[208:211], v[80:83], v[168:171], v[208:211]
    ds_read_b64_tr_b16 v[64:65], v50 offset:16384
    ds_read_b64_tr_b16 v[66:67], v50 offset:20480
    v_mfma_f32_16x16x32_bf16 v[240:243], v[80:83], v[172:175], v[240:243]
    ds_read_b64_tr_b16 v[68:69], v51 offset:16384
    ds_read_b64_tr_b16 v[70:71], v51 offset:20480
    s_add_u32 m0, s33, 0
    s_mov_b32 s32, 3670016
    buffer_load_dwordx4 v6, s[8:11], s32 offen offset:0 lds
    v_mfma_f32_16x16x32_bf16 v[212:215], v[84:87], v[168:171], v[212:215]
    ds_read_b64_tr_b16 v[72:73], v52 offset:16384
    ds_read_b64_tr_b16 v[74:75], v52 offset:20480
    v_mfma_f32_16x16x32_bf16 v[244:247], v[84:87], v[172:175], v[244:247]
    ds_read_b64_tr_b16 v[76:77], v53 offset:16384
    ds_read_b64_tr_b16 v[78:79], v53 offset:20480
    v_mfma_f32_16x16x32_bf16 v[216:219], v[88:91], v[168:171], v[216:219]
    ds_read_b64_tr_b16 v[80:81], v54 offset:16384
    ds_read_b64_tr_b16 v[82:83], v54 offset:20480
    v_mfma_f32_16x16x32_bf16 v[248:251], v[88:91], v[172:175], v[248:251]
    buffer_load_dwordx4 v7, s[8:11], s32 offen offset:1024 lds
    v_mfma_f32_16x16x32_bf16 v[220:223], v[92:95], v[168:171], v[220:223]
    ds_read_b64_tr_b16 v[84:85], v55 offset:16384
    ds_read_b64_tr_b16 v[86:87], v55 offset:20480
    v_mfma_f32_16x16x32_bf16 v[252:255], v[92:95], v[172:175], v[252:255]
    s_waitcnt lgkmcnt(8)
    s_waitcnt vmcnt(20)
    v_mfma_f32_16x16x32_bf16 v[192:195], v[64:67], v[176:179], v[192:195]
    ds_read_b64_tr_b16 v[88:89], v56 offset:16384
    v_mfma_f32_16x16x32_bf16 v[224:227], v[64:67], v[180:183], v[224:227]
    ds_read_b64_tr_b16 v[90:91], v56 offset:20480
    buffer_load_dwordx4 v[148:151], v3, s[4:7], s31 offen offset:2048 sc1
    v_mfma_f32_16x16x32_bf16 v[196:199], v[68:71], v[176:179], v[196:199]
    ds_read_b64_tr_b16 v[92:93], v57 offset:16384
    v_mfma_f32_16x16x32_bf16 v[228:231], v[68:71], v[180:183], v[228:231]
    ds_read_b64_tr_b16 v[94:95], v57 offset:20480
    s_waitcnt lgkmcnt(8)
    v_mfma_f32_16x16x32_bf16 v[200:203], v[72:75], v[176:179], v[200:203]
    ds_read_b64_tr_b16 v[64:65], v50 offset:24576
    v_mfma_f32_16x16x32_bf16 v[232:235], v[72:75], v[180:183], v[232:235]
    ds_read_b64_tr_b16 v[66:67], v50 offset:28672
    v_xor_b32 v50, 65536, v50
    buffer_load_dwordx4 v8, s[8:11], s32 offen offset:2048 lds
    v_mfma_f32_16x16x32_bf16 v[204:207], v[76:79], v[176:179], v[204:207]
    ds_read_b64_tr_b16 v[68:69], v51 offset:24576
    v_mfma_f32_16x16x32_bf16 v[236:239], v[76:79], v[180:183], v[236:239]
    ds_read_b64_tr_b16 v[70:71], v51 offset:28672
    v_xor_b32 v51, 65536, v51
    s_waitcnt lgkmcnt(8)
    v_mfma_f32_16x16x32_bf16 v[208:211], v[80:83], v[176:179], v[208:211]
    ds_read_b64_tr_b16 v[72:73], v52 offset:24576
    v_mfma_f32_16x16x32_bf16 v[240:243], v[80:83], v[180:183], v[240:243]
    ds_read_b64_tr_b16 v[74:75], v52 offset:28672
    v_xor_b32 v52, 65536, v52
    v_mfma_f32_16x16x32_bf16 v[212:215], v[84:87], v[176:179], v[212:215]
    ds_read_b64_tr_b16 v[76:77], v53 offset:24576
    buffer_load_dwordx4 v9, s[8:11], s32 offen offset:3072 lds
    v_mfma_f32_16x16x32_bf16 v[244:247], v[84:87], v[180:183], v[244:247]
    ds_read_b64_tr_b16 v[78:79], v53 offset:28672
    v_xor_b32 v53, 65536, v53
    s_waitcnt lgkmcnt(8)
    v_mfma_f32_16x16x32_bf16 v[216:219], v[88:91], v[176:179], v[216:219]
    ds_read_b64_tr_b16 v[80:81], v54 offset:24576
    v_mfma_f32_16x16x32_bf16 v[248:251], v[88:91], v[180:183], v[248:251]
    ds_read_b64_tr_b16 v[82:83], v54 offset:28672
    v_xor_b32 v54, 65536, v54
    v_mfma_f32_16x16x32_bf16 v[220:223], v[92:95], v[176:179], v[220:223]
    ds_read_b64_tr_b16 v[84:85], v55 offset:24576
    buffer_load_dwordx4 v[152:155], v2, s[4:7], s31 offen offset:3072 sc1
    v_mfma_f32_16x16x32_bf16 v[252:255], v[92:95], v[180:183], v[252:255]
    ds_read_b64_tr_b16 v[86:87], v55 offset:28672
    v_xor_b32 v55, 65536, v55
    s_waitcnt lgkmcnt(8)
    s_waitcnt vmcnt(18)
    v_mfma_f32_16x16x32_bf16 v[192:195], v[64:67], v[184:187], v[192:195]
    ds_read_b64_tr_b16 v[88:89], v56 offset:24576
    v_mfma_f32_16x16x32_bf16 v[224:227], v[64:67], v[188:191], v[224:227]
    ds_read_b64_tr_b16 v[90:91], v56 offset:28672
    v_xor_b32 v56, 65536, v56
    v_mfma_f32_16x16x32_bf16 v[196:199], v[68:71], v[184:187], v[196:199]
    ds_read_b64_tr_b16 v[92:93], v57 offset:24576
    buffer_load_dwordx4 v[156:159], v3, s[4:7], s31 offen offset:3072 sc1
    v_mfma_f32_16x16x32_bf16 v[228:231], v[68:71], v[188:191], v[228:231]
    ds_read_b64_tr_b16 v[94:95], v57 offset:28672
    v_xor_b32 v57, 65536, v57
    s_waitcnt lgkmcnt(8)
    v_mfma_f32_16x16x32_bf16 v[200:203], v[72:75], v[184:187], v[200:203]
    s_sub_u32 s36, s56, s38
    s_sub_u32 s37, s57, s38
    s_min_u32 s36, s36, s37
    s_cmp_lt_u32 s36, 16
    s_cbranch_scc1 L_recurrent_scan__compressed_kv_cla__moe_arch_mod__prompt_kernel_rare_194
L_recurrent_scan__compressed_kv_cla__moe_arch_mod__prompt_kernel_back_195:
    v_mfma_f32_16x16x32_bf16 v[232:235], v[72:75], v[188:191], v[232:235]
    v_mfma_f32_16x16x32_bf16 v[204:207], v[76:79], v[184:187], v[204:207]
    s_mov_b32 s31, 57344
    buffer_load_dwordx4 v[160:163], v2, s[4:7], s31 offen offset:0 sc1
    v_mfma_f32_16x16x32_bf16 v[236:239], v[76:79], v[188:191], v[236:239]
    s_waitcnt lgkmcnt(0)
    s_waitcnt vmcnt(17)
    s_barrier
    v_mfma_f32_16x16x32_bf16 v[208:211], v[80:83], v[184:187], v[208:211]
    ds_read_b64_tr_b16 v[64:65], v50 offset:0
    ds_read_b64_tr_b16 v[66:67], v50 offset:4096
    v_mfma_f32_16x16x32_bf16 v[240:243], v[80:83], v[188:191], v[240:243]
    ds_read_b64_tr_b16 v[68:69], v51 offset:0
    ds_read_b64_tr_b16 v[70:71], v51 offset:4096
    v_mfma_f32_16x16x32_bf16 v[212:215], v[84:87], v[184:187], v[212:215]
    ds_read_b64_tr_b16 v[72:73], v52 offset:0
    ds_read_b64_tr_b16 v[74:75], v52 offset:4096
    v_mfma_f32_16x16x32_bf16 v[244:247], v[84:87], v[188:191], v[244:247]
    ds_read_b64_tr_b16 v[76:77], v53 offset:0
    ds_read_b64_tr_b16 v[78:79], v53 offset:4096
    s_add_u32 m0, s33, 16384
    s_mov_b32 s32, 3801088
    buffer_load_dwordx4 v6, s[8:11], s32 offen offset:0 lds
    v_mfma_f32_16x16x32_bf16 v[216:219], v[88:91], v[184:187], v[216:219]
    ds_read_b64_tr_b16 v[80:81], v54 offset:0
    ds_read_b64_tr_b16 v[82:83], v54 offset:4096
    v_mfma_f32_16x16x32_bf16 v[248:251], v[88:91], v[188:191], v[248:251]
    v_mfma_f32_16x16x32_bf16 v[220:223], v[92:95], v[184:187], v[220:223]
    ds_read_b64_tr_b16 v[84:85], v55 offset:0
    ds_read_b64_tr_b16 v[86:87], v55 offset:4096
    v_mfma_f32_16x16x32_bf16 v[252:255], v[92:95], v[188:191], v[252:255]
    buffer_load_dwordx4 v7, s[8:11], s32 offen offset:1024 lds
    s_waitcnt lgkmcnt(8)
    s_waitcnt vmcnt(17)
    v_mfma_f32_16x16x32_bf16 v[192:195], v[64:67], v[128:131], v[192:195]
    ds_read_b64_tr_b16 v[88:89], v56 offset:0
    v_mfma_f32_16x16x32_bf16 v[224:227], v[64:67], v[132:135], v[224:227]
    ds_read_b64_tr_b16 v[90:91], v56 offset:4096
    v_mfma_f32_16x16x32_bf16 v[196:199], v[68:71], v[128:131], v[196:199]
    ds_read_b64_tr_b16 v[92:93], v57 offset:0
    v_mfma_f32_16x16x32_bf16 v[228:231], v[68:71], v[132:135], v[228:231]
    ds_read_b64_tr_b16 v[94:95], v57 offset:4096
    buffer_load_dwordx4 v[164:167], v3, s[4:7], s31 offen offset:0 sc1
    s_waitcnt lgkmcnt(8)
    v_mfma_f32_16x16x32_bf16 v[200:203], v[72:75], v[128:131], v[200:203]
    ds_read_b64_tr_b16 v[64:65], v50 offset:8192
    v_mfma_f32_16x16x32_bf16 v[232:235], v[72:75], v[132:135], v[232:235]
    ds_read_b64_tr_b16 v[66:67], v50 offset:12288
    v_mfma_f32_16x16x32_bf16 v[204:207], v[76:79], v[128:131], v[204:207]
    ds_read_b64_tr_b16 v[68:69], v51 offset:8192
    v_mfma_f32_16x16x32_bf16 v[236:239], v[76:79], v[132:135], v[236:239]
    ds_read_b64_tr_b16 v[70:71], v51 offset:12288
    buffer_load_dwordx4 v8, s[8:11], s32 offen offset:2048 lds
    s_waitcnt lgkmcnt(8)
    v_mfma_f32_16x16x32_bf16 v[208:211], v[80:83], v[128:131], v[208:211]
    ds_read_b64_tr_b16 v[72:73], v52 offset:8192
    v_mfma_f32_16x16x32_bf16 v[240:243], v[80:83], v[132:135], v[240:243]
    ds_read_b64_tr_b16 v[74:75], v52 offset:12288
    v_mfma_f32_16x16x32_bf16 v[212:215], v[84:87], v[128:131], v[212:215]
    ds_read_b64_tr_b16 v[76:77], v53 offset:8192
    v_mfma_f32_16x16x32_bf16 v[244:247], v[84:87], v[132:135], v[244:247]
    ds_read_b64_tr_b16 v[78:79], v53 offset:12288
    s_waitcnt lgkmcnt(8)
    v_mfma_f32_16x16x32_bf16 v[216:219], v[88:91], v[128:131], v[216:219]
    ds_read_b64_tr_b16 v[80:81], v54 offset:8192
    buffer_load_dwordx4 v9, s[8:11], s32 offen offset:3072 lds
    v_mfma_f32_16x16x32_bf16 v[248:251], v[88:91], v[132:135], v[248:251]
    ds_read_b64_tr_b16 v[82:83], v54 offset:12288
    v_mfma_f32_16x16x32_bf16 v[220:223], v[92:95], v[128:131], v[220:223]
    ds_read_b64_tr_b16 v[84:85], v55 offset:8192
    v_mfma_f32_16x16x32_bf16 v[252:255], v[92:95], v[132:135], v[252:255]
    ds_read_b64_tr_b16 v[86:87], v55 offset:12288
    s_waitcnt lgkmcnt(8)
    s_waitcnt vmcnt(16)
    v_mfma_f32_16x16x32_bf16 v[192:195], v[64:67], v[136:139], v[192:195]
    ds_read_b64_tr_b16 v[88:89], v56 offset:8192
    buffer_load_dwordx4 v[168:171], v2, s[4:7], s31 offen offset:1024 sc1
    v_mfma_f32_16x16x32_bf16 v[224:227], v[64:67], v[140:143], v[224:227]
    ds_read_b64_tr_b16 v[90:91], v56 offset:12288
    v_mfma_f32_16x16x32_bf16 v[196:199], v[68:71], v[136:139], v[196:199]
    ds_read_b64_tr_b16 v[92:93], v57 offset:8192
    v_mfma_f32_16x16x32_bf16 v[228:231], v[68:71], v[140:143], v[228:231]
    ds_read_b64_tr_b16 v[94:95], v57 offset:12288
    s_waitcnt vmcnt(15)
    s_barrier
    s_waitcnt lgkmcnt(8)
    v_mfma_f32_16x16x32_bf16 v[200:203], v[72:75], v[136:139], v[200:203]
    ds_read_b64_tr_b16 v[64:65], v50 offset:16384
    buffer_load_dwordx4 v[172:175], v3, s[4:7], s31 offen offset:1024 sc1
    v_mfma_f32_16x16x32_bf16 v[232:235], v[72:75], v[140:143], v[232:235]
    ds_read_b64_tr_b16 v[66:67], v50 offset:20480
    v_mfma_f32_16x16x32_bf16 v[204:207], v[76:79], v[136:139], v[204:207]
    ds_read_b64_tr_b16 v[68:69], v51 offset:16384
    v_mfma_f32_16x16x32_bf16 v[236:239], v[76:79], v[140:143], v[236:239]
    ds_read_b64_tr_b16 v[70:71], v51 offset:20480
    s_waitcnt lgkmcnt(8)
    v_mfma_f32_16x16x32_bf16 v[208:211], v[80:83], v[136:139], v[208:211]
    ds_read_b64_tr_b16 v[72:73], v52 offset:16384
    buffer_load_dwordx4 v[176:179], v2, s[4:7], s31 offen offset:2048 sc1
    v_mfma_f32_16x16x32_bf16 v[240:243], v[80:83], v[140:143], v[240:243]
    ds_read_b64_tr_b16 v[74:75], v52 offset:20480
    v_mfma_f32_16x16x32_bf16 v[212:215], v[84:87], v[136:139], v[212:215]
    ds_read_b64_tr_b16 v[76:77], v53 offset:16384
    v_mfma_f32_16x16x32_bf16 v[244:247], v[84:87], v[140:143], v[244:247]
    ds_read_b64_tr_b16 v[78:79], v53 offset:20480
    s_waitcnt lgkmcnt(8)
    v_mfma_f32_16x16x32_bf16 v[216:219], v[88:91], v[136:139], v[216:219]
    ds_read_b64_tr_b16 v[80:81], v50 offset:24576
    v_mfma_f32_16x16x32_bf16 v[248:251], v[88:91], v[140:143], v[248:251]
    ds_read_b64_tr_b16 v[82:83], v50 offset:28672
    v_xor_b32 v50, 65536, v50
    buffer_load_dwordx4 v[180:183], v3, s[4:7], s31 offen offset:2048 sc1
    v_mfma_f32_16x16x32_bf16 v[220:223], v[92:95], v[136:139], v[220:223]
    ds_read_b64_tr_b16 v[84:85], v51 offset:24576
    v_mfma_f32_16x16x32_bf16 v[252:255], v[92:95], v[140:143], v[252:255]
    ds_read_b64_tr_b16 v[86:87], v51 offset:28672
    v_xor_b32 v51, 65536, v51
    s_waitcnt lgkmcnt(8)
    s_waitcnt vmcnt(14)
    v_mfma_f32_16x16x32_bf16 v[192:195], v[64:67], v[144:147], v[192:195]
    ds_read_b64_tr_b16 v[88:89], v52 offset:24576
    v_mfma_f32_16x16x32_bf16 v[224:227], v[64:67], v[148:151], v[224:227]
    ds_read_b64_tr_b16 v[90:91], v52 offset:28672
    v_xor_b32 v52, 65536, v52
    buffer_load_dwordx4 v[184:187], v2, s[4:7], s31 offen offset:3072 sc1
    v_mfma_f32_16x16x32_bf16 v[196:199], v[68:71], v[144:147], v[196:199]
    ds_read_b64_tr_b16 v[92:93], v53 offset:24576
    v_mfma_f32_16x16x32_bf16 v[228:231], v[68:71], v[148:151], v[228:231]
    ds_read_b64_tr_b16 v[94:95], v53 offset:28672
    v_xor_b32 v53, 65536, v53
    s_waitcnt vmcnt(13)
    s_barrier
    s_waitcnt lgkmcnt(8)
    v_mfma_f32_16x16x32_bf16 v[200:203], v[72:75], v[144:147], v[200:203]
    ds_read_b64_tr_b16 v[64:65], v50 offset:0
    v_mfma_f32_16x16x32_bf16 v[232:235], v[72:75], v[148:151], v[232:235]
    ds_read_b64_tr_b16 v[66:67], v50 offset:4096
    buffer_load_dwordx4 v[188:191], v3, s[4:7], s31 offen offset:3072 sc1
    v_mfma_f32_16x16x32_bf16 v[204:207], v[76:79], v[144:147], v[204:207]
    ds_read_b64_tr_b16 v[68:69], v51 offset:0
    v_mfma_f32_16x16x32_bf16 v[236:239], v[76:79], v[148:151], v[236:239]
    ds_read_b64_tr_b16 v[70:71], v51 offset:4096
    s_waitcnt lgkmcnt(8)
    s_waitcnt vmcnt(12)
    v_mfma_f32_16x16x32_bf16 v[192:195], v[80:83], v[152:155], v[192:195]
    ds_read_b64_tr_b16 v[72:73], v52 offset:0
    v_mfma_f32_16x16x32_bf16 v[224:227], v[80:83], v[156:159], v[224:227]
    ds_read_b64_tr_b16 v[74:75], v52 offset:4096
    v_mfma_f32_16x16x32_bf16 v[196:199], v[84:87], v[152:155], v[196:199]
    ds_read_b64_tr_b16 v[76:77], v53 offset:0
    v_mfma_f32_16x16x32_bf16 v[228:231], v[84:87], v[156:159], v[228:231]
    ds_read_b64_tr_b16 v[78:79], v53 offset:4096
    s_waitcnt lgkmcnt(8)
    v_mfma_f32_16x16x32_bf16 v[200:203], v[88:91], v[152:155], v[200:203]
    ds_read_b64_tr_b16 v[80:81], v50 offset:8192
    v_mfma_f32_16x16x32_bf16 v[232:235], v[88:91], v[156:159], v[232:235]
    ds_read_b64_tr_b16 v[82:83], v50 offset:12288
    v_mfma_f32_16x16x32_bf16 v[204:207], v[92:95], v[152:155], v[204:207]
    ds_read_b64_tr_b16 v[84:85], v51 offset:8192
    v_mfma_f32_16x16x32_bf16 v[236:239], v[92:95], v[156:159], v[236:239]
    ds_read_b64_tr_b16 v[86:87], v51 offset:12288
    s_waitcnt lgkmcnt(8)
    s_waitcnt vmcnt(8)
    v_mfma_f32_16x16x32_bf16 v[192:195], v[64:67], v[160:163], v[192:195]
    ds_read_b64_tr_b16 v[88:89], v52 offset:8192
    v_mfma_f32_16x16x32_bf16 v[224:227], v[64:67], v[164:167], v[224:227]
    ds_read_b64_tr_b16 v[90:91], v52 offset:12288
    v_mfma_f32_16x16x32_bf16 v[196:199], v[68:71], v[160:163], v[196:199]
    ds_read_b64_tr_b16 v[92:93], v53 offset:8192
    v_mfma_f32_16x16x32_bf16 v[228:231], v[68:71], v[164:167], v[228:231]
    ds_read_b64_tr_b16 v[94:95], v53 offset:12288
    s_waitcnt vmcnt(6)
    s_barrier
    s_waitcnt lgkmcnt(8)
    v_mfma_f32_16x16x32_bf16 v[200:203], v[72:75], v[160:163], v[200:203]
    ds_read_b64_tr_b16 v[64:65], v50 offset:16384
    v_mfma_f32_16x16x32_bf16 v[232:235], v[72:75], v[164:167], v[232:235]
    ds_read_b64_tr_b16 v[66:67], v50 offset:20480
    v_mfma_f32_16x16x32_bf16 v[204:207], v[76:79], v[160:163], v[204:207]
    ds_read_b64_tr_b16 v[68:69], v51 offset:16384
    v_mfma_f32_16x16x32_bf16 v[236:239], v[76:79], v[164:167], v[236:239]
    ds_read_b64_tr_b16 v[70:71], v51 offset:20480
    s_waitcnt lgkmcnt(8)
    s_waitcnt vmcnt(4)
    v_mfma_f32_16x16x32_bf16 v[192:195], v[80:83], v[168:171], v[192:195]
    ds_read_b64_tr_b16 v[72:73], v52 offset:16384
    v_mfma_f32_16x16x32_bf16 v[224:227], v[80:83], v[172:175], v[224:227]
    ds_read_b64_tr_b16 v[74:75], v52 offset:20480
    v_mfma_f32_16x16x32_bf16 v[196:199], v[84:87], v[168:171], v[196:199]
    ds_read_b64_tr_b16 v[76:77], v53 offset:16384
    v_mfma_f32_16x16x32_bf16 v[228:231], v[84:87], v[172:175], v[228:231]
    ds_read_b64_tr_b16 v[78:79], v53 offset:20480
    s_waitcnt lgkmcnt(8)
    v_mfma_f32_16x16x32_bf16 v[200:203], v[88:91], v[168:171], v[200:203]
    ds_read_b64_tr_b16 v[80:81], v50 offset:24576
    s_xor_b32 s37, s40, 512
    v_mov_b32 v5, s37
    ds_read_b64 v[40:41], v63 offset:0
    ds_read_b64 v[42:43], v63 offset:32
    ds_read_b64 v[44:45], v63 offset:64
    ds_read_b64 v[46:47], v63 offset:96
    v_mfma_f32_16x16x32_bf16 v[232:235], v[88:91], v[172:175], v[232:235]
    ds_read_b64_tr_b16 v[82:83], v50 offset:28672
    v_mfma_f32_16x16x32_bf16 v[204:207], v[92:95], v[168:171], v[204:207]
    ds_read_b64_tr_b16 v[84:85], v51 offset:24576
    v_mfma_f32_16x16x32_bf16 v[236:239], v[92:95], v[172:175], v[236:239]
    ds_read_b64_tr_b16 v[86:87], v51 offset:28672
    s_waitcnt lgkmcnt(12)
    s_waitcnt vmcnt(2)
    v_mfma_f32_16x16x32_bf16 v[192:195], v[64:67], v[176:179], v[192:195]
    ds_read_b64_tr_b16 v[88:89], v52 offset:24576
    v_mfma_f32_16x16x32_bf16 v[224:227], v[64:67], v[180:183], v[224:227]
    ds_read_b64_tr_b16 v[90:91], v52 offset:28672
    v_mfma_f32_16x16x32_bf16 v[196:199], v[68:71], v[176:179], v[196:199]
    ds_read_b64_tr_b16 v[92:93], v53 offset:24576
    v_mfma_f32_16x16x32_bf16 v[228:231], v[68:71], v[180:183], v[228:231]
    ds_read_b64_tr_b16 v[94:95], v53 offset:28672
    s_waitcnt lgkmcnt(12)
    v_mfma_f32_16x16x32_bf16 v[200:203], v[72:75], v[176:179], v[200:203]
    ds_read_b64_tr_b16 v[64:65], v54 offset:16384
    v_mfma_f32_16x16x32_bf16 v[232:235], v[72:75], v[180:183], v[232:235]
    ds_read_b64_tr_b16 v[66:67], v54 offset:20480
    v_mfma_f32_16x16x32_bf16 v[204:207], v[76:79], v[176:179], v[204:207]
    ds_read_b64_tr_b16 v[68:69], v55 offset:16384
    v_mfma_f32_16x16x32_bf16 v[236:239], v[76:79], v[180:183], v[236:239]
    ds_read_b64_tr_b16 v[70:71], v55 offset:20480
    s_waitcnt lgkmcnt(8)
    s_waitcnt vmcnt(0)
    v_mfma_f32_16x16x32_bf16 v[192:195], v[80:83], v[184:187], v[192:195]
    ds_read_b64_tr_b16 v[72:73], v56 offset:16384
    v_mfma_f32_16x16x32_bf16 v[224:227], v[80:83], v[188:191], v[224:227]
    ds_read_b64_tr_b16 v[74:75], v56 offset:20480
    v_mfma_f32_16x16x32_bf16 v[196:199], v[84:87], v[184:187], v[196:199]
    ds_read_b64_tr_b16 v[76:77], v57 offset:16384
    v_mfma_f32_16x16x32_bf16 v[228:231], v[84:87], v[188:191], v[228:231]
    ds_read_b64_tr_b16 v[78:79], v57 offset:20480
    s_waitcnt lgkmcnt(8)
    v_mfma_f32_16x16x32_bf16 v[200:203], v[88:91], v[184:187], v[200:203]
    ds_read_b64_tr_b16 v[80:81], v54 offset:24576
    v_mfma_f32_16x16x32_bf16 v[232:235], v[88:91], v[188:191], v[232:235]
    ds_read_b64_tr_b16 v[82:83], v54 offset:28672
    v_xor_b32 v54, 65536, v54
    v_mfma_f32_16x16x32_bf16 v[204:207], v[92:95], v[184:187], v[204:207]
    ds_read_b64_tr_b16 v[84:85], v55 offset:24576
    v_mfma_f32_16x16x32_bf16 v[236:239], v[92:95], v[188:191], v[236:239]
    ds_read_b64_tr_b16 v[86:87], v55 offset:28672
    v_xor_b32 v55, 65536, v55
    s_waitcnt lgkmcnt(8)
    v_mfma_f32_16x16x32_bf16 v[208:211], v[64:67], v[144:147], v[208:211]
    ds_read_b64_tr_b16 v[88:89], v56 offset:24576
    v_mfma_f32_16x16x32_bf16 v[240:243], v[64:67], v[148:151], v[240:243]
    ds_read_b64_tr_b16 v[90:91], v56 offset:28672
    v_xor_b32 v56, 65536, v56
    v_mfma_f32_16x16x32_bf16 v[212:215], v[68:71], v[144:147], v[212:215]
    ds_read_b64_tr_b16 v[92:93], v57 offset:24576
    ds_write_b128 v20, v[224:227] offset:0
    v_mfma_f32_16x16x32_bf16 v[244:247], v[68:71], v[148:151], v[244:247]
    ds_read_b64_tr_b16 v[94:95], v57 offset:28672
    v_xor_b32 v57, 65536, v57
    ds_write_b128 v20, v[228:231] offset:1024
    s_waitcnt lgkmcnt(10)
    v_mfma_f32_16x16x32_bf16 v[216:219], v[72:75], v[144:147], v[216:219]
    ds_read_b64_tr_b16 v[64:65], v54 offset:0
    ds_write_b128 v20, v[232:235] offset:2048
    v_mfma_f32_16x16x32_bf16 v[248:251], v[72:75], v[148:151], v[248:251]
    ds_read_b64_tr_b16 v[66:67], v54 offset:4096
    ds_write_b128 v20, v[236:239] offset:3072
    v_mfma_f32_16x16x32_bf16 v[220:223], v[76:79], v[144:147], v[220:223]
    ds_read_b64_tr_b16 v[68:69], v55 offset:0
    v_mfma_f32_16x16x32_bf16 v[252:255], v[76:79], v[148:151], v[252:255]
    ds_read_b64_tr_b16 v[70:71], v55 offset:4096
    s_waitcnt lgkmcnt(12)
    v_mfma_f32_16x16x32_bf16 v[208:211], v[80:83], v[152:155], v[208:211]
    ds_read_b64_tr_b16 v[72:73], v56 offset:0
    v_mfma_f32_16x16x32_bf16 v[240:243], v[80:83], v[156:159], v[240:243]
    ds_read_b64_tr_b16 v[74:75], v56 offset:4096
    v_mfma_f32_16x16x32_bf16 v[212:215], v[84:87], v[152:155], v[212:215]
    ds_read_b64_tr_b16 v[76:77], v57 offset:0
    s_waitcnt lgkmcnt(5)
    s_barrier
    v_mfma_f32_16x16x32_bf16 v[244:247], v[84:87], v[156:159], v[244:247]
    ds_read_b64_tr_b16 v[78:79], v57 offset:4096
    ds_read_b128 v[224:227], v21 offset:0
    ds_read_b128 v[228:231], v21 offset:1024
    v_mfma_f32_16x16x32_bf16 v[216:219], v[88:91], v[152:155], v[216:219]
    ds_read_b64_tr_b16 v[80:81], v54 offset:8192
    ds_read_b128 v[232:235], v21 offset:2048
    ds_read_b128 v[236:239], v21 offset:3072
    v_mfma_f32_16x16x32_bf16 v[248:251], v[88:91], v[156:159], v[248:251]
    ds_read_b64_tr_b16 v[82:83], v54 offset:12288
    v_mfma_f32_16x16x32_bf16 v[220:223], v[92:95], v[152:155], v[220:223]
    ds_read_b64_tr_b16 v[84:85], v55 offset:8192
    v_mfma_f32_16x16x32_bf16 v[252:255], v[92:95], v[156:159], v[252:255]
    ds_read_b64_tr_b16 v[86:87], v55 offset:12288
    s_waitcnt lgkmcnt(12)
    v_mfma_f32_16x16x32_bf16 v[208:211], v[64:67], v[160:163], v[208:211]
    ds_read_b64_tr_b16 v[88:89], v56 offset:8192
    s_waitcnt lgkmcnt(8)
    v_add_f32 v192, v192, v224
    v_add_f32 v193, v193, v225
    v_mfma_f32_16x16x32_bf16 v[240:243], v[64:67], v[164:167], v[240:243]
    ds_read_b64_tr_b16 v[90:91], v56 offset:12288
    v_add_f32 v194, v194, v226
    v_add_f32 v195, v195, v227
    buffer_store_dwordx4 v[192:195], v18, s[24:27], s41 offen offset:0 sc1
    v_mfma_f32_16x16x32_bf16 v[212:215], v[68:71], v[160:163], v[212:215]
    ds_read_b64_tr_b16 v[92:93], v57 offset:8192
    s_waitcnt lgkmcnt(9)
    v_add_f32 v196, v196, v228
    v_add_f32 v197, v197, v229
    v_mfma_f32_16x16x32_bf16 v[244:247], v[68:71], v[164:167], v[244:247]
    ds_read_b64_tr_b16 v[94:95], v57 offset:12288
    v_add_f32 v198, v198, v230
    v_add_f32 v199, v199, v231
    buffer_store_dwordx4 v[196:199], v18, s[24:27], s41 offen offset:1024 sc1
    v_mfma_f32_16x16x32_bf16 v[216:219], v[72:75], v[160:163], v[216:219]
    ds_read_b64_tr_b16 v[64:65], v54 offset:16384
    s_waitcnt lgkmcnt(9)
    v_add_f32 v200, v200, v232
    v_add_f32 v201, v201, v233
    v_mfma_f32_16x16x32_bf16 v[248:251], v[72:75], v[164:167], v[248:251]
    ds_read_b64_tr_b16 v[66:67], v54 offset:20480
    v_add_f32 v202, v202, v234
    v_add_f32 v203, v203, v235
    buffer_store_dwordx4 v[200:203], v18, s[24:27], s41 offen offset:2048 sc1
    v_mfma_f32_16x16x32_bf16 v[220:223], v[76:79], v[160:163], v[220:223]
    ds_read_b64_tr_b16 v[68:69], v55 offset:16384
    s_waitcnt lgkmcnt(10)
    v_add_f32 v204, v204, v236
    v_add_f32 v205, v205, v237
    v_mfma_f32_16x16x32_bf16 v[252:255], v[76:79], v[164:167], v[252:255]
    ds_read_b64_tr_b16 v[70:71], v55 offset:20480
    v_add_f32 v206, v206, v238
    v_add_f32 v207, v207, v239
    buffer_store_dwordx4 v[204:207], v18, s[24:27], s41 offen offset:3072 sc1
    s_waitcnt lgkmcnt(8)
    v_mfma_f32_16x16x32_bf16 v[208:211], v[80:83], v[168:171], v[208:211]
    ds_read_b64_tr_b16 v[72:73], v56 offset:16384
    v_mfma_f32_16x16x32_bf16 v[240:243], v[80:83], v[172:175], v[240:243]
    ds_read_b64_tr_b16 v[74:75], v56 offset:20480
    v_mfma_f32_16x16x32_bf16 v[212:215], v[84:87], v[168:171], v[212:215]
    ds_read_b64_tr_b16 v[76:77], v57 offset:16384
    v_mfma_f32_16x16x32_bf16 v[244:247], v[84:87], v[172:175], v[244:247]
    ds_read_b64_tr_b16 v[78:79], v57 offset:20480
    s_waitcnt lgkmcnt(8)
    v_mfma_f32_16x16x32_bf16 v[216:219], v[88:91], v[168:171], v[216:219]
    ds_read_b64_tr_b16 v[80:81], v54 offset:24576
    v_mfma_f32_16x16x32_bf16 v[248:251], v[88:91], v[172:175], v[248:251]
    ds_read_b64_tr_b16 v[82:83], v54 offset:28672
    v_mfma_f32_16x16x32_bf16 v[220:223], v[92:95], v[168:171], v[220:223]
    ds_read_b64_tr_b16 v[84:85], v55 offset:24576
    v_mfma_f32_16x16x32_bf16 v[252:255], v[92:95], v[172:175], v[252:255]
    ds_read_b64_tr_b16 v[86:87], v55 offset:28672
    s_waitcnt lgkmcnt(8)
    v_mfma_f32_16x16x32_bf16 v[208:211], v[64:67], v[176:179], v[208:211]
    ds_read_b64_tr_b16 v[88:89], v56 offset:24576
    v_mfma_f32_16x16x32_bf16 v[240:243], v[64:67], v[180:183], v[240:243]
    ds_read_b64_tr_b16 v[90:91], v56 offset:28672
    v_mfma_f32_16x16x32_bf16 v[212:215], v[68:71], v[176:179], v[212:215]
    ds_read_b64_tr_b16 v[92:93], v57 offset:24576
    v_mfma_f32_16x16x32_bf16 v[244:247], v[68:71], v[180:183], v[244:247]
    ds_read_b64_tr_b16 v[94:95], v57 offset:28672
    s_waitcnt lgkmcnt(8)
    v_mfma_f32_16x16x32_bf16 v[216:219], v[72:75], v[176:179], v[216:219]
    v_mfma_f32_16x16x32_bf16 v[248:251], v[72:75], v[180:183], v[248:251]
    v_mfma_f32_16x16x32_bf16 v[220:223], v[76:79], v[176:179], v[220:223]
    v_mfma_f32_16x16x32_bf16 v[252:255], v[76:79], v[180:183], v[252:255]
    s_waitcnt lgkmcnt(4)
    v_mfma_f32_16x16x32_bf16 v[208:211], v[80:83], v[184:187], v[208:211]
    v_mfma_f32_16x16x32_bf16 v[240:243], v[80:83], v[188:191], v[240:243]
    v_mfma_f32_16x16x32_bf16 v[212:215], v[84:87], v[184:187], v[212:215]
    s_lshr_b32 s36, s28, 2
    s_lshl_b32 s36, s36, 15
    s_and_b32 s37, s28, 3
    v_mfma_f32_16x16x32_bf16 v[244:247], v[84:87], v[188:191], v[244:247]
    s_lshl_b32 s37, s37, 12
    s_add_u32 s36, s36, s37
    s_add_u32 s36, s36, 65536
    s_waitcnt lgkmcnt(0)
    v_mfma_f32_16x16x32_bf16 v[216:219], v[88:91], v[184:187], v[216:219]
    v_add_u32 v20, s36, v22
    v_xor_b32 v21, 32768, v20
    v_mfma_f32_16x16x32_bf16 v[248:251], v[88:91], v[188:191], v[248:251]
    v_mfma_f32_16x16x32_bf16 v[220:223], v[92:95], v[184:187], v[220:223]
    v_mfma_f32_16x16x32_bf16 v[252:255], v[92:95], v[188:191], v[252:255]
    s_waitcnt vmcnt(0)
    v_mov_b32 v4, s40
    v_mov_b32 v13, 1
    s_mov_b64 exec, 1
    global_atomic_add v4, v13, s[90:91]
    s_mov_b64 exec, -1
    s_nop 3
    s_nop 4
    ds_write_b128 v20, v[240:243] offset:0
    ds_write_b128 v20, v[244:247] offset:1024
    ds_write_b128 v20, v[248:251] offset:2048
    ds_write_b128 v20, v[252:255] offset:3072
    v_lshlrev_b32 v96, 16, v40
    v_and_b32 v97, 0xffff0000, v40
    v_sub_f32 v112, v96, v48
    v_sub_f32 v113, v97, v48
    v_cvt_pk_bf16_f32 v10, v112, v113
    v_lshlrev_b32 v112, 16, v10
    v_and_b32 v113, 0xffff0000, v10
    v_mul_f32 v112, v112, v49
    v_mul_f32 v113, v113, v49
    v_cvt_pk_bf16_f32 v10, v112, v113
    v_lshlrev_b32 v112, 16, v10
    v_and_b32 v113, 0xffff0000, v10
    v_mul_f32 v11, 0xbfb8aa3b, v112
    v_mul_f32 v12, 0xbfb8aa3b, v113
    v_exp_f32 v11, v11
    v_exp_f32 v12, v12
    s_nop 0
    v_add_f32 v11, 1.0, v11
    v_add_f32 v12, 1.0, v12
    v_rcp_f32 v11, v11
    v_rcp_f32 v12, v12
    s_nop 0
    v_mul_f32 v112, v112, v11
    v_mul_f32 v113, v113, v12
    v_cvt_pk_bf16_f32 v10, v112, v113
    v_lshlrev_b32 v112, 16, v10
    v_and_b32 v113, 0xffff0000, v10
    v_lshlrev_b32 v98, 16, v41
    v_and_b32 v99, 0xffff0000, v41
    v_sub_f32 v114, v98, v48
    v_sub_f32 v115, v99, v48
    v_cvt_pk_bf16_f32 v10, v114, v115
    v_lshlrev_b32 v114, 16, v10
    v_and_b32 v115, 0xffff0000, v10
    v_mul_f32 v114, v114, v49
    v_mul_f32 v115, v115, v49
    v_cvt_pk_bf16_f32 v10, v114, v115
    v_lshlrev_b32 v114, 16, v10
    v_and_b32 v115, 0xffff0000, v10
    v_mul_f32 v11, 0xbfb8aa3b, v114
    v_mul_f32 v12, 0xbfb8aa3b, v115
    v_exp_f32 v11, v11
    v_exp_f32 v12, v12
    s_nop 0
    v_add_f32 v11, 1.0, v11
    v_add_f32 v12, 1.0, v12
    v_rcp_f32 v11, v11
    v_rcp_f32 v12, v12
    s_nop 0
    v_mul_f32 v114, v114, v11
    v_mul_f32 v115, v115, v12
    v_cvt_pk_bf16_f32 v10, v114, v115
    v_lshlrev_b32 v114, 16, v10
    v_and_b32 v115, 0xffff0000, v10
    v_lshlrev_b32 v100, 16, v42
    v_and_b32 v101, 0xffff0000, v42
    v_sub_f32 v116, v100, v48
    v_sub_f32 v117, v101, v48
    v_cvt_pk_bf16_f32 v10, v116, v117
    v_lshlrev_b32 v116, 16, v10
    v_and_b32 v117, 0xffff0000, v10
    v_mul_f32 v116, v116, v49
    v_mul_f32 v117, v117, v49
    v_cvt_pk_bf16_f32 v10, v116, v117
    v_lshlrev_b32 v116, 16, v10
    v_and_b32 v117, 0xffff0000, v10
    v_mul_f32 v11, 0xbfb8aa3b, v116
    v_mul_f32 v12, 0xbfb8aa3b, v117
    v_exp_f32 v11, v11
    v_exp_f32 v12, v12
    s_nop 0
    v_add_f32 v11, 1.0, v11
    v_add_f32 v12, 1.0, v12
    v_rcp_f32 v11, v11
    v_rcp_f32 v12, v12
    s_nop 0
    v_mul_f32 v116, v116, v11
    v_mul_f32 v117, v117, v12
    v_cvt_pk_bf16_f32 v10, v116, v117
    v_lshlrev_b32 v116, 16, v10
    v_and_b32 v117, 0xffff0000, v10
    v_lshlrev_b32 v102, 16, v43
    v_and_b32 v103, 0xffff0000, v43
    v_sub_f32 v118, v102, v48
    v_sub_f32 v119, v103, v48
    v_cvt_pk_bf16_f32 v10, v118, v119
    v_lshlrev_b32 v118, 16, v10
    v_and_b32 v119, 0xffff0000, v10
    v_mul_f32 v118, v118, v49
    v_mul_f32 v119, v119, v49
    v_cvt_pk_bf16_f32 v10, v118, v119
    v_lshlrev_b32 v118, 16, v10
    v_and_b32 v119, 0xffff0000, v10
    v_mul_f32 v11, 0xbfb8aa3b, v118
    v_mul_f32 v12, 0xbfb8aa3b, v119
    v_exp_f32 v11, v11
    v_exp_f32 v12, v12
    s_nop 0
    v_add_f32 v11, 1.0, v11
    v_add_f32 v12, 1.0, v12
    v_rcp_f32 v11, v11
    v_rcp_f32 v12, v12
    s_nop 0
    v_mul_f32 v118, v118, v11
    v_mul_f32 v119, v119, v12
    v_cvt_pk_bf16_f32 v10, v118, v119
    v_lshlrev_b32 v118, 16, v10
    v_and_b32 v119, 0xffff0000, v10
    s_cmp_eq_u32 s28, 3
    s_cbranch_scc1 L_recurrent_scan__compressed_kv_cla__moe_arch_mod__prompt_kernel_rare_207
L_recurrent_scan__compressed_kv_cla__moe_arch_mod__prompt_kernel_back_208:
    s_waitcnt lgkmcnt(0)
    s_barrier
    buffer_load_dwordx4 v[64:67], v18, s[24:27], s39 offen offset:0 sc1
    buffer_load_dwordx4 v[68:71], v18, s[24:27], s39 offen offset:1024 sc1
    buffer_load_dwordx4 v[72:75], v18, s[24:27], s39 offen offset:2048 sc1
    buffer_load_dwordx4 v[76:79], v18, s[24:27], s39 offen offset:3072 sc1
    ds_read_b128 v[128:131], v21 offset:0
    ds_read_b128 v[132:135], v21 offset:1024
    ds_read_b128 v[136:139], v21 offset:2048
    ds_read_b128 v[140:143], v21 offset:3072
    s_waitcnt lgkmcnt(3)
    v_pk_add_f32 v[128:129], v[128:129], v[208:209]
    v_pk_add_f32 v[130:131], v[130:131], v[210:211]
    s_waitcnt lgkmcnt(2)
    v_pk_add_f32 v[132:133], v[132:133], v[212:213]
    v_pk_add_f32 v[134:135], v[134:135], v[214:215]
    s_waitcnt lgkmcnt(1)
    v_pk_add_f32 v[136:137], v[136:137], v[216:217]
    v_pk_add_f32 v[138:139], v[138:139], v[218:219]
    s_waitcnt lgkmcnt(0)
    v_pk_add_f32 v[140:141], v[140:141], v[220:221]
    v_pk_add_f32 v[142:143], v[142:143], v[222:223]
    v_lshlrev_b32 v104, 16, v44
    v_and_b32 v105, 0xffff0000, v44
    v_sub_f32 v120, v104, v48
    v_sub_f32 v121, v105, v48
    v_cvt_pk_bf16_f32 v10, v120, v121
    v_lshlrev_b32 v120, 16, v10
    v_and_b32 v121, 0xffff0000, v10
    v_mul_f32 v120, v120, v49
    v_mul_f32 v121, v121, v49
    v_cvt_pk_bf16_f32 v10, v120, v121
    v_lshlrev_b32 v120, 16, v10
    v_and_b32 v121, 0xffff0000, v10
    v_mul_f32 v11, 0xbfb8aa3b, v120
    v_mul_f32 v12, 0xbfb8aa3b, v121
    v_exp_f32 v11, v11
    v_exp_f32 v12, v12
    s_nop 0
    v_add_f32 v11, 1.0, v11
    v_add_f32 v12, 1.0, v12
    v_rcp_f32 v11, v11
    v_rcp_f32 v12, v12
    s_nop 0
    v_mul_f32 v120, v120, v11
    v_mul_f32 v121, v121, v12
    v_cvt_pk_bf16_f32 v10, v120, v121
    v_lshlrev_b32 v120, 16, v10
    v_and_b32 v121, 0xffff0000, v10
    v_lshlrev_b32 v106, 16, v45
    v_and_b32 v107, 0xffff0000, v45
    v_sub_f32 v122, v106, v48
    v_sub_f32 v123, v107, v48
    v_cvt_pk_bf16_f32 v10, v122, v123
    v_lshlrev_b32 v122, 16, v10
    v_and_b32 v123, 0xffff0000, v10
    v_mul_f32 v122, v122, v49
    v_mul_f32 v123, v123, v49
    v_cvt_pk_bf16_f32 v10, v122, v123
    v_lshlrev_b32 v122, 16, v10
    v_and_b32 v123, 0xffff0000, v10
    v_mul_f32 v11, 0xbfb8aa3b, v122
    v_mul_f32 v12, 0xbfb8aa3b, v123
    v_exp_f32 v11, v11
    v_exp_f32 v12, v12
    s_nop 0
    v_add_f32 v11, 1.0, v11
    v_add_f32 v12, 1.0, v12
    v_rcp_f32 v11, v11
    v_rcp_f32 v12, v12
    s_nop 0
    v_mul_f32 v122, v122, v11
    v_mul_f32 v123, v123, v12
    v_cvt_pk_bf16_f32 v10, v122, v123
    v_lshlrev_b32 v122, 16, v10
    v_and_b32 v123, 0xffff0000, v10
    v_lshlrev_b32 v108, 16, v46
    v_and_b32 v109, 0xffff0000, v46
    v_sub_f32 v124, v108, v48
    v_sub_f32 v125, v109, v48
    v_cvt_pk_bf16_f32 v10, v124, v125
    v_lshlrev_b32 v124, 16, v10
    v_and_b32 v125, 0xffff0000, v10
    v_mul_f32 v124, v124, v49
    v_mul_f32 v125, v125, v49
    v_cvt_pk_bf16_f32 v10, v124, v125
    v_lshlrev_b32 v124, 16, v10
    v_and_b32 v125, 0xffff0000, v10
    v_mul_f32 v11, 0xbfb8aa3b, v124
    v_mul_f32 v12, 0xbfb8aa3b, v125
    v_exp_f32 v11, v11
    v_exp_f32 v12, v12
    s_nop 0
    v_add_f32 v11, 1.0, v11
    v_add_f32 v12, 1.0, v12
    v_rcp_f32 v11, v11
    v_rcp_f32 v12, v12
    s_nop 0
    v_mul_f32 v124, v124, v11
    v_mul_f32 v125, v125, v12
    v_cvt_pk_bf16_f32 v10, v124, v125
    v_lshlrev_b32 v124, 16, v10
    v_and_b32 v125, 0xffff0000, v10
    v_lshlrev_b32 v110, 16, v47
    v_and_b32 v111, 0xffff0000, v47
    v_sub_f32 v126, v110, v48
    v_sub_f32 v127, v111, v48
    v_cvt_pk_bf16_f32 v10, v126, v127
    v_lshlrev_b32 v126, 16, v10
    v_and_b32 v127, 0xffff0000, v10
    v_mul_f32 v126, v126, v49
    v_mul_f32 v127, v127, v49
    v_cvt_pk_bf16_f32 v10, v126, v127
    v_lshlrev_b32 v126, 16, v10
    v_and_b32 v127, 0xffff0000, v10
    v_mul_f32 v11, 0xbfb8aa3b, v126
    v_mul_f32 v12, 0xbfb8aa3b, v127
    v_exp_f32 v11, v11
    v_exp_f32 v12, v12
    s_nop 0
    v_add_f32 v11, 1.0, v11
    v_add_f32 v12, 1.0, v12
    v_rcp_f32 v11, v11
    v_rcp_f32 v12, v12
    s_nop 0
    v_mul_f32 v126, v126, v11
    v_mul_f32 v127, v127, v12
    v_cvt_pk_bf16_f32 v10, v126, v127
    v_lshlrev_b32 v126, 16, v10
    v_and_b32 v127, 0xffff0000, v10
    s_sub_u32 s36, s56, s38
    s_sub_u32 s37, s57, s38
    s_min_u32 s36, s36, s37
    s_cmp_lt_u32 s36, 16
    s_cbranch_scc1 L_recurrent_scan__compressed_kv_cla__moe_arch_mod__prompt_kernel_rare_209
L_recurrent_scan__compressed_kv_cla__moe_arch_mod__prompt_kernel_back_210:
    s_waitcnt vmcnt(3)
    v_pk_add_f32 v[128:129], v[128:129], v[64:65]
    v_cvt_pk_bf16_f32 v23, v128, v129
    v_lshlrev_b32 v128, 16, v23
    v_and_b32 v129, 0xffff0000, v23
    v_pk_mul_f32 v[128:129], v[128:129], v[112:113]
    v_cvt_pk_bf16_f32 v23, v128, v129
    v_lshlrev_b32 v128, 16, v23
    v_and_b32 v129, 0xffff0000, v23
    v_pk_add_f32 v[128:129], v[128:129], v[96:97]
    v_cvt_pk_bf16_f32 v80, v128, v129
    v_pk_add_f32 v[130:131], v[130:131], v[66:67]
    v_cvt_pk_bf16_f32 v23, v130, v131
    v_lshlrev_b32 v130, 16, v23
    v_and_b32 v131, 0xffff0000, v23
    v_pk_mul_f32 v[130:131], v[130:131], v[114:115]
    v_cvt_pk_bf16_f32 v23, v130, v131
    v_lshlrev_b32 v130, 16, v23
    v_and_b32 v131, 0xffff0000, v23
    v_pk_add_f32 v[130:131], v[130:131], v[98:99]
    v_cvt_pk_bf16_f32 v81, v130, v131
    ds_write_b64 v63, v[80:81] offset:0
    s_waitcnt vmcnt(2)
    v_pk_add_f32 v[132:133], v[132:133], v[68:69]
    v_cvt_pk_bf16_f32 v23, v132, v133
    v_lshlrev_b32 v132, 16, v23
    v_and_b32 v133, 0xffff0000, v23
    v_pk_mul_f32 v[132:133], v[132:133], v[116:117]
    v_cvt_pk_bf16_f32 v23, v132, v133
    v_lshlrev_b32 v132, 16, v23
    v_and_b32 v133, 0xffff0000, v23
    v_pk_add_f32 v[132:133], v[132:133], v[100:101]
    v_cvt_pk_bf16_f32 v82, v132, v133
    v_pk_add_f32 v[134:135], v[134:135], v[70:71]
    v_cvt_pk_bf16_f32 v23, v134, v135
    v_lshlrev_b32 v134, 16, v23
    v_and_b32 v135, 0xffff0000, v23
    v_pk_mul_f32 v[134:135], v[134:135], v[118:119]
    v_cvt_pk_bf16_f32 v23, v134, v135
    v_lshlrev_b32 v134, 16, v23
    v_and_b32 v135, 0xffff0000, v23
    v_pk_add_f32 v[134:135], v[134:135], v[102:103]
    v_cvt_pk_bf16_f32 v83, v134, v135
    ds_write_b64 v63, v[82:83] offset:32
    s_waitcnt vmcnt(1)
    v_pk_add_f32 v[136:137], v[136:137], v[72:73]
    v_cvt_pk_bf16_f32 v23, v136, v137
    v_lshlrev_b32 v136, 16, v23
    v_and_b32 v137, 0xffff0000, v23
    v_pk_mul_f32 v[136:137], v[136:137], v[120:121]
    v_cvt_pk_bf16_f32 v23, v136, v137
    v_lshlrev_b32 v136, 16, v23
    v_and_b32 v137, 0xffff0000, v23
    v_pk_add_f32 v[136:137], v[136:137], v[104:105]
    v_cvt_pk_bf16_f32 v84, v136, v137
    v_pk_add_f32 v[138:139], v[138:139], v[74:75]
    v_cvt_pk_bf16_f32 v23, v138, v139
    v_lshlrev_b32 v138, 16, v23
    v_and_b32 v139, 0xffff0000, v23
    v_pk_mul_f32 v[138:139], v[138:139], v[122:123]
    v_cvt_pk_bf16_f32 v23, v138, v139
    v_lshlrev_b32 v138, 16, v23
    v_and_b32 v139, 0xffff0000, v23
    v_pk_add_f32 v[138:139], v[138:139], v[106:107]
    v_cvt_pk_bf16_f32 v85, v138, v139
    ds_write_b64 v63, v[84:85] offset:64
    s_waitcnt vmcnt(0)
    v_pk_add_f32 v[140:141], v[140:141], v[76:77]
    v_cvt_pk_bf16_f32 v23, v140, v141
    v_lshlrev_b32 v140, 16, v23
    v_and_b32 v141, 0xffff0000, v23
    v_pk_mul_f32 v[140:141], v[140:141], v[124:125]
    v_cvt_pk_bf16_f32 v23, v140, v141
    v_lshlrev_b32 v140, 16, v23
    v_and_b32 v141, 0xffff0000, v23
    v_pk_add_f32 v[140:141], v[140:141], v[108:109]
    v_cvt_pk_bf16_f32 v86, v140, v141
    v_pk_add_f32 v[142:143], v[142:143], v[78:79]
    v_cvt_pk_bf16_f32 v23, v142, v143
    v_lshlrev_b32 v142, 16, v23
    v_and_b32 v143, 0xffff0000, v23
    v_pk_mul_f32 v[142:143], v[142:143], v[126:127]
    v_cvt_pk_bf16_f32 v23, v142, v143
    v_lshlrev_b32 v142, 16, v23
    v_and_b32 v143, 0xffff0000, v23
    v_pk_add_f32 v[142:143], v[142:143], v[110:111]
    v_cvt_pk_bf16_f32 v87, v142, v143
    ds_write_b64 v63, v[86:87] offset:96
    v_add_u32 v22, s42, v22
    s_mov_b32 s36, 16384
    s_waitcnt lgkmcnt(0)
    ds_read_b128 v[64:67], v22
    ds_read_b128 v[68:71], v22 offset:1024
    s_waitcnt lgkmcnt(1)
    buffer_store_dwordx4 v[64:67], v15, s[20:23], 0 offen sc1
    s_waitcnt lgkmcnt(0)
    buffer_store_dwordx4 v[68:71], v15, s[20:23], s36 offen sc1
    s_endpgm
L_recurrent_scan__compressed_kv_cla__moe_arch_mod__prompt_kernel_rare_170:
    v_mov_b32 v26, s40
    v_mov_b32 v28, 1
    v_writelane_b32 v26, s41, 1
    s_mov_b64 exec, 3
    global_atomic_add v26, v28, s[90:91]
    s_mov_b64 exec, -1
    s_branch L_recurrent_scan__compressed_kv_cla__moe_arch_mod__prompt_kernel_back_171
L_recurrent_scan__compressed_kv_cla__moe_arch_mod__prompt_kernel_rare_174:
    s_and_b32 s36, s2, 15
    s_add_u32 s36, s36, 96
    s_lshl_b32 s36, s36, 7
    v_mov_b32 v26, s36
    v_mov_b32 v27, 1
    s_mov_b64 exec, 1
    global_atomic_add v26, v27, s[90:91]
    s_mov_b64 exec, -1
    s_nop 3
    s_branch L_recurrent_scan__compressed_kv_cla__moe_arch_mod__prompt_kernel_back_175
L_recurrent_scan__compressed_kv_cla__moe_arch_mod__prompt_kernel_rare_176:
    global_load_dword v59, v58, s[90:91] sc1
    s_branch L_recurrent_scan__compressed_kv_cla__moe_arch_mod__prompt_kernel_back_177
L_recurrent_scan__compressed_kv_cla__moe_arch_mod__prompt_kernel_rare_181:
    s_mov_b32 s61, 0x40000
    s_waitcnt vmcnt(7)
    s_branch L_recurrent_scan__compressed_kv_cla__moe_arch_mod__prompt_kernel_cchk_180
L_recurrent_scan__compressed_kv_cla__moe_arch_mod__prompt_kernel_cspin_178:
    s_sub_u32 s61, s61, 1
    s_cbranch_scc1 L_recurrent_scan__compressed_kv_cla__moe_arch_mod__prompt_kernel_cspinx_179
    global_load_dword v59, v58, s[90:91] sc1
    s_waitcnt vmcnt(0)
L_recurrent_scan__compressed_kv_cla__moe_arch_mod__prompt_kernel_cchk_180:
    v_cmp_le_u32 vcc, 4, v59
    s_nop 0
    s_and_b32 s60, vcc_lo, 31
    s_and_b32 s36, s60, s44
    s_cmp_eq_u32 s36, s44
    s_cbranch_scc1 L_recurrent_scan__compressed_kv_cla__moe_arch_mod__prompt_kernel_cspinx_179
    s_sleep 6
    s_branch L_recurrent_scan__compressed_kv_cla__moe_arch_mod__prompt_kernel_cspin_178
L_recurrent_scan__compressed_kv_cla__moe_arch_mod__prompt_kernel_cspinx_179:
    s_lshl_b32 s44, s44, 1
    s_or_b32 s44, s44, 1
    s_and_b32 s44, s44, 31
    s_branch L_recurrent_scan__compressed_kv_cla__moe_arch_mod__prompt_kernel_back_182
L_recurrent_scan__compressed_kv_cla__moe_arch_mod__prompt_kernel_rare_183:
    global_load_dword v59, v58, s[90:91] sc1
    s_branch L_recurrent_scan__compressed_kv_cla__moe_arch_mod__prompt_kernel_back_184
L_recurrent_scan__compressed_kv_cla__moe_arch_mod__prompt_kernel_rare_188:
    s_mov_b32 s61, 0x40000
    s_waitcnt vmcnt(7)
    s_branch L_recurrent_scan__compressed_kv_cla__moe_arch_mod__prompt_kernel_cchk_187
L_recurrent_scan__compressed_kv_cla__moe_arch_mod__prompt_kernel_cspin_185:
    s_sub_u32 s61, s61, 1
    s_cbranch_scc1 L_recurrent_scan__compressed_kv_cla__moe_arch_mod__prompt_kernel_cspinx_186
    global_load_dword v59, v58, s[90:91] sc1
    s_waitcnt vmcnt(0)
L_recurrent_scan__compressed_kv_cla__moe_arch_mod__prompt_kernel_cchk_187:
    v_cmp_le_u32 vcc, 4, v59
    s_nop 0
    s_and_b32 s60, vcc_lo, 31
    s_and_b32 s36, s60, s44
    s_cmp_eq_u32 s36, s44
    s_cbranch_scc1 L_recurrent_scan__compressed_kv_cla__moe_arch_mod__prompt_kernel_cspinx_186
    s_sleep 6
    s_branch L_recurrent_scan__compressed_kv_cla__moe_arch_mod__prompt_kernel_cspin_185
L_recurrent_scan__compressed_kv_cla__moe_arch_mod__prompt_kernel_cspinx_186:
    s_lshl_b32 s44, s44, 1
    s_or_b32 s44, s44, 1
    s_and_b32 s44, s44, 31
    s_branch L_recurrent_scan__compressed_kv_cla__moe_arch_mod__prompt_kernel_back_189
L_recurrent_scan__compressed_kv_cla__moe_arch_mod__prompt_kernel_rare_190:
    s_add_u32 s36, s30, 96
    s_lshl_b32 s36, s36, 7
    v_mov_b32 v60, s36
    global_load_dword v61, v60, s[90:91] sc1
    s_branch L_recurrent_scan__compressed_kv_cla__moe_arch_mod__prompt_kernel_back_191
L_recurrent_scan__compressed_kv_cla__moe_arch_mod__prompt_kernel_rt1_rare_3:
    s_mov_b32 s61, 0x40000
L_recurrent_scan__compressed_kv_cla__moe_arch_mod__prompt_kernel_rt1_spin_1:
    s_sub_u32 s61, s61, 1
    s_cbranch_scc1 L_recurrent_scan__compressed_kv_cla__moe_arch_mod__prompt_kernel_rt1_spinx_2
    s_sleep 1
    global_load_dword v61, v60, s[90:91] sc1
    s_waitcnt vmcnt(0)
    v_readfirstlane_b32 s36, v61
    s_nop 0
    s_cmp_lt_u32 s36, 16
    s_cbranch_scc1 L_recurrent_scan__compressed_kv_cla__moe_arch_mod__prompt_kernel_rt1_spin_1
L_recurrent_scan__compressed_kv_cla__moe_arch_mod__prompt_kernel_rt1_spinx_2:
    s_branch L_recurrent_scan__compressed_kv_cla__moe_arch_mod__prompt_kernel_rt1_back_4
L_recurrent_scan__compressed_kv_cla__moe_arch_mod__prompt_kernel_rare_192:
    s_waitcnt vmcnt(14)
    v_readfirstlane_b32 s36, v61
    s_nop 0
    s_cmp_lt_u32 s36, 16
    s_cbranch_scc1 L_recurrent_scan__compressed_kv_cla__moe_arch_mod__prompt_kernel_rt1_rare_3
L_recurrent_scan__compressed_kv_cla__moe_arch_mod__prompt_kernel_rt1_back_4:
    s_lshl_b32 s37, s30, 8
    s_add_u32 s36, s37, 59768832
    s_add_u32 s37, s36, 4096
    v_and_b32 v60, 15, v1
    v_lshlrev_b32 v60, 13, v60
    v_lshl_add_u32 v60, v19, 4, v60
    buffer_load_dwordx4 v[96:99], v60, s[24:27], s36 offen offset:0 sc1
    buffer_load_dwordx4 v[100:103], v60, s[24:27], s36 offen offset:64 sc1
    buffer_load_dwordx4 v[104:107], v60, s[24:27], s36 offen offset:128 sc1
    buffer_load_dwordx4 v[108:111], v60, s[24:27], s36 offen offset:192 sc1
    buffer_load_dwordx4 v[112:115], v60, s[24:27], s37 offen offset:0 sc1
    buffer_load_dwordx4 v[116:119], v60, s[24:27], s37 offen offset:64 sc1
    buffer_load_dwordx4 v[120:123], v60, s[24:27], s37 offen offset:128 sc1
    buffer_load_dwordx4 v[124:127], v60, s[24:27], s37 offen offset:192 sc1
    s_branch L_recurrent_scan__compressed_kv_cla__moe_arch_mod__prompt_kernel_back_193
L_recurrent_scan__compressed_kv_cla__moe_arch_mod__prompt_kernel_rare_194:
    v_mov_b64 v[24:25], 0
    v_mov_b64 v[26:27], 0
    v_mov_b64 v[28:29], 0
    v_mov_b64 v[30:31], 0
    v_mov_b64 v[32:33], 0
    v_mov_b64 v[34:35], 0
    v_mov_b64 v[36:37], 0
    v_mov_b64 v[38:39], 0
    s_waitcnt vmcnt(14)
    s_sub_u32 s36, s56, s38
    s_cmp_lt_u32 s36, 16
    s_cbranch_scc0 L_recurrent_scan__compressed_kv_cla__moe_arch_mod__prompt_kernel_rt2_noy_1
    s_and_b32 s36, s58, 0xffff0000
    s_cmp_lt_i32 s36, 0
    s_cselect_b32 s37, 0x80000000, -1
    s_xor_b32 s36, s36, s37
    s_and_b32 s36, s36, 0xffff0000
    v_mov_b32 v62, s36
    v_mul_f32 v62, 0xbfb8aa3b, v62
    v_exp_f32 v62, v62
    s_nop 0
    v_add_f32 v62, 1.0, v62
    v_rcp_f32 v62, v62
    s_nop 0
    v_cvt_pk_bf16_f32 v62, v62, v62
    v_lshlrev_b32 v62, 16, v62
    v_add_f32_dpp v96, v96, v96 quad_perm:[1,0,3,2] row_mask:0xf bank_mask:0xf
    v_add_f32_dpp v97, v97, v97 quad_perm:[1,0,3,2] row_mask:0xf bank_mask:0xf
    v_add_f32_dpp v98, v98, v98 quad_perm:[1,0,3,2] row_mask:0xf bank_mask:0xf
    v_add_f32_dpp v99, v99, v99 quad_perm:[1,0,3,2] row_mask:0xf bank_mask:0xf
    v_add_f32_dpp v100, v100, v100 quad_perm:[1,0,3,2] row_mask:0xf bank_mask:0xf
    v_add_f32_dpp v101, v101, v101 quad_perm:[1,0,3,2] row_mask:0xf bank_mask:0xf
    v_add_f32_dpp v102, v102, v102 quad_perm:[1,0,3,2] row_mask:0xf bank_mask:0xf
    v_add_f32_dpp v103, v103, v103 quad_perm:[1,0,3,2] row_mask:0xf bank_mask:0xf
    v_add_f32_dpp v104, v104, v104 quad_perm:[1,0,3,2] row_mask:0xf bank_mask:0xf
    v_add_f32_dpp v105, v105, v105 quad_perm:[1,0,3,2] row_mask:0xf bank_mask:0xf
    v_add_f32_dpp v106, v106, v106 quad_perm:[1,0,3,2] row_mask:0xf bank_mask:0xf
    v_add_f32_dpp v107, v107, v107 quad_perm:[1,0,3,2] row_mask:0xf bank_mask:0xf
    v_add_f32_dpp v108, v108, v108 quad_perm:[1,0,3,2] row_mask:0xf bank_mask:0xf
    v_add_f32_dpp v109, v109, v109 quad_perm:[1,0,3,2] row_mask:0xf bank_mask:0xf
    v_add_f32_dpp v110, v110, v110 quad_perm:[1,0,3,2] row_mask:0xf bank_mask:0xf
    v_add_f32_dpp v111, v111, v111 quad_perm:[1,0,3,2] row_mask:0xf bank_mask:0xf
    v_add_f32_dpp v96, v96, v96 quad_perm:[2,3,0,1] row_mask:0xf bank_mask:0xf
    v_add_f32_dpp v97, v97, v97 quad_perm:[2,3,0,1] row_mask:0xf bank_mask:0xf
    v_add_f32_dpp v98, v98, v98 quad_perm:[2,3,0,1] row_mask:0xf bank_mask:0xf
    v_add_f32_dpp v99, v99, v99 quad_perm:[2,3,0,1] row_mask:0xf bank_mask:0xf
    v_add_f32_dpp v100, v100, v100 quad_perm:[2,3,0,1] row_mask:0xf bank_mask:0xf
    v_add_f32_dpp v101, v101, v101 quad_perm:[2,3,0,1] row_mask:0xf bank_mask:0xf
    v_add_f32_dpp v102, v102, v102 quad_perm:[2,3,0,1] row_mask:0xf bank_mask:0xf
    v_add_f32_dpp v103, v103, v103 quad_perm:[2,3,0,1] row_mask:0xf bank_mask:0xf
    v_add_f32_dpp v104, v104, v104 quad_perm:[2,3,0,1] row_mask:0xf bank_mask:0xf
    v_add_f32_dpp v105, v105, v105 quad_perm:[2,3,0,1] row_mask:0xf bank_mask:0xf
    v_add_f32_dpp v106, v106, v106 quad_perm:[2,3,0,1] row_mask:0xf bank_mask:0xf
    v_add_f32_dpp v107, v107, v107 quad_perm:[2,3,0,1] row_mask:0xf bank_mask:0xf
    v_add_f32_dpp v108, v108, v108 quad_perm:[2,3,0,1] row_mask:0xf bank_mask:0xf
    v_add_f32_dpp v109, v109, v109 quad_perm:[2,3,0,1] row_mask:0xf bank_mask:0xf
    v_add_f32_dpp v110, v110, v110 quad_perm:[2,3,0,1] row_mask:0xf bank_mask:0xf
    v_add_f32_dpp v111, v111, v111 quad_perm:[2,3,0,1] row_mask:0xf bank_mask:0xf
    v_add_f32_dpp v96, v96, v96 row_half_mirror row_mask:0xf bank_mask:0xf
    v_add_f32_dpp v97, v97, v97 row_half_mirror row_mask:0xf bank_mask:0xf
    v_add_f32_dpp v98, v98, v98 row_half_mirror row_mask:0xf bank_mask:0xf
    v_add_f32_dpp v99, v99, v99 row_half_mirror row_mask:0xf bank_mask:0xf
    v_add_f32_dpp v100, v100, v100 row_half_mirror row_mask:0xf bank_mask:0xf
    v_add_f32_dpp v101, v101, v101 row_half_mirror row_mask:0xf bank_mask:0xf
    v_add_f32_dpp v102, v102, v102 row_half_mirror row_mask:0xf bank_mask:0xf
    v_add_f32_dpp v103, v103, v103 row_half_mirror row_mask:0xf bank_mask:0xf
    v_add_f32_dpp v104, v104, v104 row_half_mirror row_mask:0xf bank_mask:0xf
    v_add_f32_dpp v105, v105, v105 row_half_mirror row_mask:0xf bank_mask:0xf
    v_add_f32_dpp v106, v106, v106 row_half_mirror row_mask:0xf bank_mask:0xf
    v_add_f32_dpp v107, v107, v107 row_half_mirror row_mask:0xf bank_mask:0xf
    v_add_f32_dpp v108, v108, v108 row_half_mirror row_mask:0xf bank_mask:0xf
    v_add_f32_dpp v109, v109, v109 row_half_mirror row_mask:0xf bank_mask:0xf
    v_add_f32_dpp v110, v110, v110 row_half_mirror row_mask:0xf bank_mask:0xf
    v_add_f32_dpp v111, v111, v111 row_half_mirror row_mask:0xf bank_mask:0xf
    v_add_f32_dpp v96, v96, v96 row_mirror row_mask:0xf bank_mask:0xf
    v_add_f32_dpp v97, v97, v97 row_mirror row_mask:0xf bank_mask:0xf
    v_add_f32_dpp v98, v98, v98 row_mirror row_mask:0xf bank_mask:0xf
    v_add_f32_dpp v99, v99, v99 row_mirror row_mask:0xf bank_mask:0xf
    v_add_f32_dpp v100, v100, v100 row_mirror row_mask:0xf bank_mask:0xf
    v_add_f32_dpp v101, v101, v101 row_mirror row_mask:0xf bank_mask:0xf
    v_add_f32_dpp v102, v102, v102 row_mirror row_mask:0xf bank_mask:0xf
    v_add_f32_dpp v103, v103, v103 row_mirror row_mask:0xf bank_mask:0xf
    v_add_f32_dpp v104, v104, v104 row_mirror row_mask:0xf bank_mask:0xf
    v_add_f32_dpp v105, v105, v105 row_mirror row_mask:0xf bank_mask:0xf
    v_add_f32_dpp v106, v106, v106 row_mirror row_mask:0xf bank_mask:0xf
    v_add_f32_dpp v107, v107, v107 row_mirror row_mask:0xf bank_mask:0xf
    v_add_f32_dpp v108, v108, v108 row_mirror row_mask:0xf bank_mask:0xf
    v_add_f32_dpp v109, v109, v109 row_mirror row_mask:0xf bank_mask:0xf
    v_add_f32_dpp v110, v110, v110 row_mirror row_mask:0xf bank_mask:0xf
    v_add_f32_dpp v111, v111, v111 row_mirror row_mask:0xf bank_mask:0xf
    v_cmp_eq_u32 vcc, s56, v14
    v_cvt_pk_bf16_f32 v61, v96, v97
    v_lshlrev_b32 v96, 16, v61
    v_and_b32 v97, 0xffff0000, v61
    v_mul_f32 v96, v62, v96
    v_mul_f32 v97, v62, v97
    v_cvt_pk_bf16_f32 v61, v96, v97
    v_lshlrev_b32 v96, 16, v61
    v_and_b32 v97, 0xffff0000, v61
    v_cndmask_b32 v24, v24, v96, vcc
    v_cndmask_b32 v25, v25, v97, vcc
    v_cvt_pk_bf16_f32 v61, v98, v99
    v_lshlrev_b32 v98, 16, v61
    v_and_b32 v99, 0xffff0000, v61
    v_mul_f32 v98, v62, v98
    v_mul_f32 v99, v62, v99
    v_cvt_pk_bf16_f32 v61, v98, v99
    v_lshlrev_b32 v98, 16, v61
    v_and_b32 v99, 0xffff0000, v61
    v_cndmask_b32 v26, v26, v98, vcc
    v_cndmask_b32 v27, v27, v99, vcc
    v_cvt_pk_bf16_f32 v61, v100, v101
    v_lshlrev_b32 v100, 16, v61
    v_and_b32 v101, 0xffff0000, v61
    v_mul_f32 v100, v62, v100
    v_mul_f32 v101, v62, v101
    v_cvt_pk_bf16_f32 v61, v100, v101
    v_lshlrev_b32 v100, 16, v61
    v_and_b32 v101, 0xffff0000, v61
    v_cndmask_b32 v28, v28, v100, vcc
    v_cndmask_b32 v29, v29, v101, vcc
    v_cvt_pk_bf16_f32 v61, v102, v103
    v_lshlrev_b32 v102, 16, v61
    v_and_b32 v103, 0xffff0000, v61
    v_mul_f32 v102, v62, v102
    v_mul_f32 v103, v62, v103
    v_cvt_pk_bf16_f32 v61, v102, v103
    v_lshlrev_b32 v102, 16, v61
    v_and_b32 v103, 0xffff0000, v61
    v_cndmask_b32 v30, v30, v102, vcc
    v_cndmask_b32 v31, v31, v103, vcc
    v_cvt_pk_bf16_f32 v61, v104, v105
    v_lshlrev_b32 v104, 16, v61
    v_and_b32 v105, 0xffff0000, v61
    v_mul_f32 v104, v62, v104
    v_mul_f32 v105, v62, v105
    v_cvt_pk_bf16_f32 v61, v104, v105
    v_lshlrev_b32 v104, 16, v61
    v_and_b32 v105, 0xffff0000, v61
    v_cndmask_b32 v32, v32, v104, vcc
    v_cndmask_b32 v33, v33, v105, vcc
    v_cvt_pk_bf16_f32 v61, v106, v107
    v_lshlrev_b32 v106, 16, v61
    v_and_b32 v107, 0xffff0000, v61
    v_mul_f32 v106, v62, v106
    v_mul_f32 v107, v62, v107
    v_cvt_pk_bf16_f32 v61, v106, v107
    v_lshlrev_b32 v106, 16, v61
    v_and_b32 v107, 0xffff0000, v61
    v_cndmask_b32 v34, v34, v106, vcc
    v_cndmask_b32 v35, v35, v107, vcc
    v_cvt_pk_bf16_f32 v61, v108, v109
    v_lshlrev_b32 v108, 16, v61
    v_and_b32 v109, 0xffff0000, v61
    v_mul_f32 v108, v62, v108
    v_mul_f32 v109, v62, v109
    v_cvt_pk_bf16_f32 v61, v108, v109
    v_lshlrev_b32 v108, 16, v61
    v_and_b32 v109, 0xffff0000, v61
    v_cndmask_b32 v36, v36, v108, vcc
    v_cndmask_b32 v37, v37, v109, vcc
    v_cvt_pk_bf16_f32 v61, v110, v111
    v_lshlrev_b32 v110, 16, v61
    v_and_b32 v111, 0xffff0000, v61
    v_mul_f32 v110, v62, v110
    v_mul_f32 v111, v62, v111
    v_cvt_pk_bf16_f32 v61, v110, v111
    v_lshlrev_b32 v110, 16, v61
    v_and_b32 v111, 0xffff0000, v61
    v_cndmask_b32 v38, v38, v110, vcc
    v_cndmask_b32 v39, v39, v111, vcc
L_recurrent_scan__compressed_kv_cla__moe_arch_mod__prompt_kernel_rt2_noy_1:
    s_sub_u32 s36, s57, s38
    s_cmp_lt_u32 s36, 16
    s_cbranch_scc0 L_recurrent_scan__compressed_kv_cla__moe_arch_mod__prompt_kernel_rt2_noy_2
    s_and_b32 s36, s59, 0xffff0000
    s_cmp_lt_i32 s36, 0
    s_cselect_b32 s37, 0x80000000, -1
    s_xor_b32 s36, s36, s37
    s_and_b32 s36, s36, 0xffff0000
    v_mov_b32 v62, s36
    v_mul_f32 v62, 0xbfb8aa3b, v62
    v_exp_f32 v62, v62
    s_nop 0
    v_add_f32 v62, 1.0, v62
    v_rcp_f32 v62, v62
    s_nop 0
    v_cvt_pk_bf16_f32 v62, v62, v62
    v_lshlrev_b32 v62, 16, v62
    v_add_f32_dpp v112, v112, v112 quad_perm:[1,0,3,2] row_mask:0xf bank_mask:0xf
    v_add_f32_dpp v113, v113, v113 quad_perm:[1,0,3,2] row_mask:0xf bank_mask:0xf
    v_add_f32_dpp v114, v114, v114 quad_perm:[1,0,3,2] row_mask:0xf bank_mask:0xf
    v_add_f32_dpp v115, v115, v115 quad_perm:[1,0,3,2] row_mask:0xf bank_mask:0xf
    v_add_f32_dpp v116, v116, v116 quad_perm:[1,0,3,2] row_mask:0xf bank_mask:0xf
    v_add_f32_dpp v117, v117, v117 quad_perm:[1,0,3,2] row_mask:0xf bank_mask:0xf
    v_add_f32_dpp v118, v118, v118 quad_perm:[1,0,3,2] row_mask:0xf bank_mask:0xf
    v_add_f32_dpp v119, v119, v119 quad_perm:[1,0,3,2] row_mask:0xf bank_mask:0xf
    v_add_f32_dpp v120, v120, v120 quad_perm:[1,0,3,2] row_mask:0xf bank_mask:0xf
    v_add_f32_dpp v121, v121, v121 quad_perm:[1,0,3,2] row_mask:0xf bank_mask:0xf
    v_add_f32_dpp v122, v122, v122 quad_perm:[1,0,3,2] row_mask:0xf bank_mask:0xf
    v_add_f32_dpp v123, v123, v123 quad_perm:[1,0,3,2] row_mask:0xf bank_mask:0xf
    v_add_f32_dpp v124, v124, v124 quad_perm:[1,0,3,2] row_mask:0xf bank_mask:0xf
    v_add_f32_dpp v125, v125, v125 quad_perm:[1,0,3,2] row_mask:0xf bank_mask:0xf
    v_add_f32_dpp v126, v126, v126 quad_perm:[1,0,3,2] row_mask:0xf bank_mask:0xf
    v_add_f32_dpp v127, v127, v127 quad_perm:[1,0,3,2] row_mask:0xf bank_mask:0xf
    v_add_f32_dpp v112, v112, v112 quad_perm:[2,3,0,1] row_mask:0xf bank_mask:0xf
    v_add_f32_dpp v113, v113, v113 quad_perm:[2,3,0,1] row_mask:0xf bank_mask:0xf
    v_add_f32_dpp v114, v114, v114 quad_perm:[2,3,0,1] row_mask:0xf bank_mask:0xf
    v_add_f32_dpp v115, v115, v115 quad_perm:[2,3,0,1] row_mask:0xf bank_mask:0xf
    v_add_f32_dpp v116, v116, v116 quad_perm:[2,3,0,1] row_mask:0xf bank_mask:0xf
    v_add_f32_dpp v117, v117, v117 quad_perm:[2,3,0,1] row_mask:0xf bank_mask:0xf
    v_add_f32_dpp v118, v118, v118 quad_perm:[2,3,0,1] row_mask:0xf bank_mask:0xf
    v_add_f32_dpp v119, v119, v119 quad_perm:[2,3,0,1] row_mask:0xf bank_mask:0xf
    v_add_f32_dpp v120, v120, v120 quad_perm:[2,3,0,1] row_mask:0xf bank_mask:0xf
    v_add_f32_dpp v121, v121, v121 quad_perm:[2,3,0,1] row_mask:0xf bank_mask:0xf
    v_add_f32_dpp v122, v122, v122 quad_perm:[2,3,0,1] row_mask:0xf bank_mask:0xf
    v_add_f32_dpp v123, v123, v123 quad_perm:[2,3,0,1] row_mask:0xf bank_mask:0xf
    v_add_f32_dpp v124, v124, v124 quad_perm:[2,3,0,1] row_mask:0xf bank_mask:0xf
    v_add_f32_dpp v125, v125, v125 quad_perm:[2,3,0,1] row_mask:0xf bank_mask:0xf
    v_add_f32_dpp v126, v126, v126 quad_perm:[2,3,0,1] row_mask:0xf bank_mask:0xf
    v_add_f32_dpp v127, v127, v127 quad_perm:[2,3,0,1] row_mask:0xf bank_mask:0xf
    v_add_f32_dpp v112, v112, v112 row_half_mirror row_mask:0xf bank_mask:0xf
    v_add_f32_dpp v113, v113, v113 row_half_mirror row_mask:0xf bank_mask:0xf
    v_add_f32_dpp v114, v114, v114 row_half_mirror row_mask:0xf bank_mask:0xf
    v_add_f32_dpp v115, v115, v115 row_half_mirror row_mask:0xf bank_mask:0xf
    v_add_f32_dpp v116, v116, v116 row_half_mirror row_mask:0xf bank_mask:0xf
    v_add_f32_dpp v117, v117, v117 row_half_mirror row_mask:0xf bank_mask:0xf
    v_add_f32_dpp v118, v118, v118 row_half_mirror row_mask:0xf bank_mask:0xf
    v_add_f32_dpp v119, v119, v119 row_half_mirror row_mask:0xf bank_mask:0xf
    v_add_f32_dpp v120, v120, v120 row_half_mirror row_mask:0xf bank_mask:0xf
    v_add_f32_dpp v121, v121, v121 row_half_mirror row_mask:0xf bank_mask:0xf
    v_add_f32_dpp v122, v122, v122 row_half_mirror row_mask:0xf bank_mask:0xf
    v_add_f32_dpp v123, v123, v123 row_half_mirror row_mask:0xf bank_mask:0xf
    v_add_f32_dpp v124, v124, v124 row_half_mirror row_mask:0xf bank_mask:0xf
    v_add_f32_dpp v125, v125, v125 row_half_mirror row_mask:0xf bank_mask:0xf
    v_add_f32_dpp v126, v126, v126 row_half_mirror row_mask:0xf bank_mask:0xf
    v_add_f32_dpp v127, v127, v127 row_half_mirror row_mask:0xf bank_mask:0xf
    v_add_f32_dpp v112, v112, v112 row_mirror row_mask:0xf bank_mask:0xf
    v_add_f32_dpp v113, v113, v113 row_mirror row_mask:0xf bank_mask:0xf
    v_add_f32_dpp v114, v114, v114 row_mirror row_mask:0xf bank_mask:0xf
    v_add_f32_dpp v115, v115, v115 row_mirror row_mask:0xf bank_mask:0xf
    v_add_f32_dpp v116, v116, v116 row_mirror row_mask:0xf bank_mask:0xf
    v_add_f32_dpp v117, v117, v117 row_mirror row_mask:0xf bank_mask:0xf
    v_add_f32_dpp v118, v118, v118 row_mirror row_mask:0xf bank_mask:0xf
    v_add_f32_dpp v119, v119, v119 row_mirror row_mask:0xf bank_mask:0xf
    v_add_f32_dpp v120, v120, v120 row_mirror row_mask:0xf bank_mask:0xf
    v_add_f32_dpp v121, v121, v121 row_mirror row_mask:0xf bank_mask:0xf
    v_add_f32_dpp v122, v122, v122 row_mirror row_mask:0xf bank_mask:0xf
    v_add_f32_dpp v123, v123, v123 row_mirror row_mask:0xf bank_mask:0xf
    v_add_f32_dpp v124, v124, v124 row_mirror row_mask:0xf bank_mask:0xf
    v_add_f32_dpp v125, v125, v125 row_mirror row_mask:0xf bank_mask:0xf
    v_add_f32_dpp v126, v126, v126 row_mirror row_mask:0xf bank_mask:0xf
    v_add_f32_dpp v127, v127, v127 row_mirror row_mask:0xf bank_mask:0xf
    v_cmp_eq_u32 vcc, s57, v14
    v_cvt_pk_bf16_f32 v61, v112, v113
    v_lshlrev_b32 v112, 16, v61
    v_and_b32 v113, 0xffff0000, v61
    v_mul_f32 v112, v62, v112
    v_mul_f32 v113, v62, v113
    v_cvt_pk_bf16_f32 v61, v112, v113
    v_lshlrev_b32 v112, 16, v61
    v_and_b32 v113, 0xffff0000, v61
    v_cndmask_b32 v24, v24, v112, vcc
    v_cndmask_b32 v25, v25, v113, vcc
    v_cvt_pk_bf16_f32 v61, v114, v115
    v_lshlrev_b32 v114, 16, v61
    v_and_b32 v115, 0xffff0000, v61
    v_mul_f32 v114, v62, v114
    v_mul_f32 v115, v62, v115
    v_cvt_pk_bf16_f32 v61, v114, v115
    v_lshlrev_b32 v114, 16, v61
    v_and_b32 v115, 0xffff0000, v61
    v_cndmask_b32 v26, v26, v114, vcc
    v_cndmask_b32 v27, v27, v115, vcc
    v_cvt_pk_bf16_f32 v61, v116, v117
    v_lshlrev_b32 v116, 16, v61
    v_and_b32 v117, 0xffff0000, v61
    v_mul_f32 v116, v62, v116
    v_mul_f32 v117, v62, v117
    v_cvt_pk_bf16_f32 v61, v116, v117
    v_lshlrev_b32 v116, 16, v61
    v_and_b32 v117, 0xffff0000, v61
    v_cndmask_b32 v28, v28, v116, vcc
    v_cndmask_b32 v29, v29, v117, vcc
    v_cvt_pk_bf16_f32 v61, v118, v119
    v_lshlrev_b32 v118, 16, v61
    v_and_b32 v119, 0xffff0000, v61
    v_mul_f32 v118, v62, v118
    v_mul_f32 v119, v62, v119
    v_cvt_pk_bf16_f32 v61, v118, v119
    v_lshlrev_b32 v118, 16, v61
    v_and_b32 v119, 0xffff0000, v61
    v_cndmask_b32 v30, v30, v118, vcc
    v_cndmask_b32 v31, v31, v119, vcc
    v_cvt_pk_bf16_f32 v61, v120, v121
    v_lshlrev_b32 v120, 16, v61
    v_and_b32 v121, 0xffff0000, v61
    v_mul_f32 v120, v62, v120
    v_mul_f32 v121, v62, v121
    v_cvt_pk_bf16_f32 v61, v120, v121
    v_lshlrev_b32 v120, 16, v61
    v_and_b32 v121, 0xffff0000, v61
    v_cndmask_b32 v32, v32, v120, vcc
    v_cndmask_b32 v33, v33, v121, vcc
    v_cvt_pk_bf16_f32 v61, v122, v123
    v_lshlrev_b32 v122, 16, v61
    v_and_b32 v123, 0xffff0000, v61
    v_mul_f32 v122, v62, v122
    v_mul_f32 v123, v62, v123
    v_cvt_pk_bf16_f32 v61, v122, v123
    v_lshlrev_b32 v122, 16, v61
    v_and_b32 v123, 0xffff0000, v61
    v_cndmask_b32 v34, v34, v122, vcc
    v_cndmask_b32 v35, v35, v123, vcc
    v_cvt_pk_bf16_f32 v61, v124, v125
    v_lshlrev_b32 v124, 16, v61
    v_and_b32 v125, 0xffff0000, v61
    v_mul_f32 v124, v62, v124
    v_mul_f32 v125, v62, v125
    v_cvt_pk_bf16_f32 v61, v124, v125
    v_lshlrev_b32 v124, 16, v61
    v_and_b32 v125, 0xffff0000, v61
    v_cndmask_b32 v36, v36, v124, vcc
    v_cndmask_b32 v37, v37, v125, vcc
    v_cvt_pk_bf16_f32 v61, v126, v127
    v_lshlrev_b32 v126, 16, v61
    v_and_b32 v127, 0xffff0000, v61
    v_mul_f32 v126, v62, v126
    v_mul_f32 v127, v62, v127
    v_cvt_pk_bf16_f32 v61, v126, v127
    v_lshlrev_b32 v126, 16, v61
    v_and_b32 v127, 0xffff0000, v61
    v_cndmask_b32 v38, v38, v126, vcc
    v_cndmask_b32 v39, v39, v127, vcc
L_recurrent_scan__compressed_kv_cla__moe_arch_mod__prompt_kernel_rt2_noy_2:
    s_branch L_recurrent_scan__compressed_kv_cla__moe_arch_mod__prompt_kernel_back_195
L_recurrent_scan__compressed_kv_cla__moe_arch_mod__prompt_kernel_f2m_198:
    v_lshrrev_b32 v28, 4, v1
    v_bfe_u32 v26, v1, 2, 2
    v_lshl_add_u32 v26, v28, 3, v26
    v_lshlrev_b32 v26, 7, v26
    v_and_b32 v27, 3, v1
    v_lshl_add_u32 v26, v27, 3, v26
    v_bfe_u32 v27, v1, 3, 2
    s_lshl_b32 s36, s28, 12
    s_add_u32 s36, s36, 131072
    v_add_u32 v26, s36, v26
    v_xor_b32 v28, 0, v27
    v_lshl_add_u32 v28, v28, 5, v26
    ds_read_b64_tr_b16 v[112:113], v28 offset:0
    ds_read_b64_tr_b16 v[114:115], v28 offset:512
    v_xor_b32 v28, 1, v27
    v_lshl_add_u32 v28, v28, 5, v26
    ds_read_b64_tr_b16 v[116:117], v28 offset:0
    ds_read_b64_tr_b16 v[118:119], v28 offset:512
    v_xor_b32 v28, 2, v27
    v_lshl_add_u32 v28, v28, 5, v26
    ds_read_b64_tr_b16 v[120:121], v28 offset:0
    ds_read_b64_tr_b16 v[122:123], v28 offset:512
    v_xor_b32 v28, 3, v27
    v_lshl_add_u32 v28, v28, 5, v26
    ds_read_b64_tr_b16 v[124:125], v28 offset:0
    ds_read_b64_tr_b16 v[126:127], v28 offset:512
    v_add_f32_dpp v96, v96, v96 row_ror:4 row_mask:0xf bank_mask:0xf
    v_add_f32_dpp v97, v97, v97 row_ror:4 row_mask:0xf bank_mask:0xf
    v_add_f32_dpp v98, v98, v98 row_ror:4 row_mask:0xf bank_mask:0xf
    v_add_f32_dpp v99, v99, v99 row_ror:4 row_mask:0xf bank_mask:0xf
    v_add_f32_dpp v100, v100, v100 row_ror:4 row_mask:0xf bank_mask:0xf
    v_add_f32_dpp v101, v101, v101 row_ror:4 row_mask:0xf bank_mask:0xf
    v_add_f32_dpp v102, v102, v102 row_ror:4 row_mask:0xf bank_mask:0xf
    v_add_f32_dpp v103, v103, v103 row_ror:4 row_mask:0xf bank_mask:0xf
    v_add_f32_dpp v96, v96, v96 row_ror:8 row_mask:0xf bank_mask:0xf
    v_add_f32_dpp v97, v97, v97 row_ror:8 row_mask:0xf bank_mask:0xf
    v_add_f32_dpp v98, v98, v98 row_ror:8 row_mask:0xf bank_mask:0xf
    v_add_f32_dpp v99, v99, v99 row_ror:8 row_mask:0xf bank_mask:0xf
    v_add_f32_dpp v100, v100, v100 row_ror:8 row_mask:0xf bank_mask:0xf
    v_add_f32_dpp v101, v101, v101 row_ror:8 row_mask:0xf bank_mask:0xf
    v_add_f32_dpp v102, v102, v102 row_ror:8 row_mask:0xf bank_mask:0xf
    v_add_f32_dpp v103, v103, v103 row_ror:8 row_mask:0xf bank_mask:0xf
    v_cvt_pk_bf16_f32 v29, v96, v97
    v_lshlrev_b32 v96, 16, v29
    v_and_b32 v97, 0xffff0000, v29
    v_cvt_pk_bf16_f32 v29, v98, v99
    v_lshlrev_b32 v98, 16, v29
    v_and_b32 v99, 0xffff0000, v29
    v_cvt_pk_bf16_f32 v29, v100, v101
    v_lshlrev_b32 v100, 16, v29
    v_and_b32 v101, 0xffff0000, v29
    v_cvt_pk_bf16_f32 v29, v102, v103
    v_lshlrev_b32 v102, 16, v29
    v_and_b32 v103, 0xffff0000, v29
    v_mul_f32 v104, 0xbfb8aa3b, v96
    v_mul_f32 v105, 0xbfb8aa3b, v97
    v_mul_f32 v106, 0xbfb8aa3b, v98
    v_mul_f32 v107, 0xbfb8aa3b, v99
    v_mul_f32 v108, 0xbfb8aa3b, v100
    v_mul_f32 v109, 0xbfb8aa3b, v101
    v_mul_f32 v110, 0xbfb8aa3b, v102
    v_mul_f32 v111, 0xbfb8aa3b, v103
    v_exp_f32 v104, v104
    v_exp_f32 v105, v105
    v_exp_f32 v106, v106
    v_exp_f32 v107, v107
    v_exp_f32 v108, v108
    v_exp_f32 v109, v109
    v_exp_f32 v110, v110
    v_exp_f32 v111, v111
    v_add_f32 v104, 1.0, v104
    v_add_f32 v105, 1.0, v105
    v_add_f32 v106, 1.0, v106
    v_add_f32 v107, 1.0, v107
    v_add_f32 v108, 1.0, v108
    v_add_f32 v109, 1.0, v109
    v_add_f32 v110, 1.0, v110
    v_add_f32 v111, 1.0, v111
    v_rcp_f32 v104, v104
    v_rcp_f32 v105, v105
    v_rcp_f32 v106, v106
    v_rcp_f32 v107, v107
    v_rcp_f32 v108, v108
    v_rcp_f32 v109, v109
    v_rcp_f32 v110, v110
    v_rcp_f32 v111, v111
    v_mul_f32 v104, v96, v104
    v_mul_f32 v105, v97, v105
    v_mul_f32 v106, v98, v106
    v_mul_f32 v107, v99, v107
    v_mul_f32 v108, v100, v108
    v_mul_f32 v109, v101, v109
    v_mul_f32 v110, v102, v110
    v_mul_f32 v111, v103, v111
    v_cvt_pk_bf16_f32 v29, v104, v105
    v_lshlrev_b32 v104, 16, v29
    v_and_b32 v105, 0xffff0000, v29
    v_cvt_pk_bf16_f32 v29, v106, v107
    v_lshlrev_b32 v106, 16, v29
    v_and_b32 v107, 0xffff0000, v29
    v_cvt_pk_bf16_f32 v29, v108, v109
    v_lshlrev_b32 v108, 16, v29
    v_and_b32 v109, 0xffff0000, v29
    v_cvt_pk_bf16_f32 v29, v110, v111
    v_lshlrev_b32 v110, 16, v29
    v_and_b32 v111, 0xffff0000, v29
    v_mul_f32_dpp v96, v96, v104 quad_perm:[2,3,0,1] row_mask:0xf bank_mask:0xf
    v_mul_f32_dpp v97, v97, v105 quad_perm:[2,3,0,1] row_mask:0xf bank_mask:0xf
    v_mul_f32_dpp v98, v98, v106 quad_perm:[2,3,0,1] row_mask:0xf bank_mask:0xf
    v_mul_f32_dpp v99, v99, v107 quad_perm:[2,3,0,1] row_mask:0xf bank_mask:0xf
    v_mul_f32_dpp v100, v100, v108 quad_perm:[2,3,0,1] row_mask:0xf bank_mask:0xf
    v_mul_f32_dpp v101, v101, v109 quad_perm:[2,3,0,1] row_mask:0xf bank_mask:0xf
    v_mul_f32_dpp v102, v102, v110 quad_perm:[2,3,0,1] row_mask:0xf bank_mask:0xf
    v_mul_f32_dpp v103, v103, v111 quad_perm:[2,3,0,1] row_mask:0xf bank_mask:0xf
    v_cvt_pk_bf16_f32 v36, v96, v97
    v_cvt_pk_bf16_f32 v37, v98, v99
    v_cvt_pk_bf16_f32 v38, v100, v101
    v_cvt_pk_bf16_f32 v39, v102, v103
    s_waitcnt lgkmcnt(0)
    v_lshl_add_u32 v28, v1, 4, s36
    v_mfma_f32_16x16x32_bf16 v[96:99], v[112:115], v[36:39], 0
    v_mfma_f32_16x16x32_bf16 v[100:103], v[116:119], v[36:39], 0
    v_mfma_f32_16x16x32_bf16 v[104:107], v[120:123], v[36:39], 0
    v_mfma_f32_16x16x32_bf16 v[108:111], v[124:127], v[36:39], 0
    s_nop 7
    ds_write_b128 v28, v[96:99] offset:0
    ds_write_b128 v28, v[100:103] offset:1024
    ds_write_b128 v28, v[104:107] offset:2048
    ds_write_b128 v28, v[108:111] offset:3072
    s_cmp_lt_u32 s28, 4
    s_cbranch_scc1 L_recurrent_scan__compressed_kv_cla__moe_arch_mod__prompt_kernel_f2b_200
    s_branch L_recurrent_scan__compressed_kv_cla__moe_arch_mod__prompt_kernel_f2a_199
L_recurrent_scan__compressed_kv_cla__moe_arch_mod__prompt_kernel_rare_207:
    s_mov_b32 s61, 0x40000
L_recurrent_scan__compressed_kv_cla__moe_arch_mod__prompt_kernel_spin_205:
    s_sub_u32 s61, s61, 1
    s_cbranch_scc1 L_recurrent_scan__compressed_kv_cla__moe_arch_mod__prompt_kernel_spinx_206
    s_sleep 1
    global_load_dword v23, v5, s[90:91] sc1
    s_waitcnt vmcnt(0)
    v_readfirstlane_b32 s36, v23
    s_nop 0
    s_cmp_lt_u32 s36, 8
    s_cbranch_scc1 L_recurrent_scan__compressed_kv_cla__moe_arch_mod__prompt_kernel_spin_205
L_recurrent_scan__compressed_kv_cla__moe_arch_mod__prompt_kernel_spinx_206:
    s_branch L_recurrent_scan__compressed_kv_cla__moe_arch_mod__prompt_kernel_back_208
L_recurrent_scan__compressed_kv_cla__moe_arch_mod__prompt_kernel_rare_209:
    v_lshlrev_b32 v96, 16, v40
    v_and_b32 v97, 0xffff0000, v40
    v_sub_f32 v112, v96, v48
    v_sub_f32 v113, v97, v48
    v_cvt_pk_bf16_f32 v10, v112, v113
    v_lshlrev_b32 v112, 16, v10
    v_and_b32 v113, 0xffff0000, v10
    v_mul_f32 v112, v112, v49
    v_mul_f32 v113, v113, v49
    v_cvt_pk_bf16_f32 v10, v112, v113
    v_lshlrev_b32 v112, 16, v10
    v_and_b32 v113, 0xffff0000, v10
    v_add_f32 v112, v112, v24
    v_add_f32 v113, v113, v25
    v_cvt_pk_bf16_f32 v10, v112, v113
    v_lshlrev_b32 v112, 16, v10
    v_and_b32 v113, 0xffff0000, v10
    v_mul_f32 v11, 0xbfb8aa3b, v112
    v_mul_f32 v12, 0xbfb8aa3b, v113
    v_exp_f32 v11, v11
    v_exp_f32 v12, v12
    s_nop 0
    v_add_f32 v11, 1.0, v11
    v_add_f32 v12, 1.0, v12
    v_rcp_f32 v11, v11
    v_rcp_f32 v12, v12
    s_nop 0
    v_mul_f32 v112, v112, v11
    v_mul_f32 v113, v113, v12
    v_cvt_pk_bf16_f32 v10, v112, v113
    v_lshlrev_b32 v112, 16, v10
    v_and_b32 v113, 0xffff0000, v10
    v_lshlrev_b32 v98, 16, v41
    v_and_b32 v99, 0xffff0000, v41
    v_sub_f32 v114, v98, v48
    v_sub_f32 v115, v99, v48
    v_cvt_pk_bf16_f32 v10, v114, v115
    v_lshlrev_b32 v114, 16, v10
    v_and_b32 v115, 0xffff0000, v10
    v_mul_f32 v114, v114, v49
    v_mul_f32 v115, v115, v49
    v_cvt_pk_bf16_f32 v10, v114, v115
    v_lshlrev_b32 v114, 16, v10
    v_and_b32 v115, 0xffff0000, v10
    v_add_f32 v114, v114, v26
    v_add_f32 v115, v115, v27
    v_cvt_pk_bf16_f32 v10, v114, v115
    v_lshlrev_b32 v114, 16, v10
    v_and_b32 v115, 0xffff0000, v10
    v_mul_f32 v11, 0xbfb8aa3b, v114
    v_mul_f32 v12, 0xbfb8aa3b, v115
    v_exp_f32 v11, v11
    v_exp_f32 v12, v12
    s_nop 0
    v_add_f32 v11, 1.0, v11
    v_add_f32 v12, 1.0, v12
    v_rcp_f32 v11, v11
    v_rcp_f32 v12, v12
    s_nop 0
    v_mul_f32 v114, v114, v11
    v_mul_f32 v115, v115, v12
    v_cvt_pk_bf16_f32 v10, v114, v115
    v_lshlrev_b32 v114, 16, v10
    v_and_b32 v115, 0xffff0000, v10
    v_lshlrev_b32 v100, 16, v42
    v_and_b32 v101, 0xffff0000, v42
    v_sub_f32 v116, v100, v48
    v_sub_f32 v117, v101, v48
    v_cvt_pk_bf16_f32 v10, v116, v117
    v_lshlrev_b32 v116, 16, v10
    v_and_b32 v117, 0xffff0000, v10
    v_mul_f32 v116, v116, v49
    v_mul_f32 v117, v117, v49
    v_cvt_pk_bf16_f32 v10, v116, v117
    v_lshlrev_b32 v116, 16, v10
    v_and_b32 v117, 0xffff0000, v10
    v_add_f32 v116, v116, v28
    v_add_f32 v117, v117, v29
    v_cvt_pk_bf16_f32 v10, v116, v117
    v_lshlrev_b32 v116, 16, v10
    v_and_b32 v117, 0xffff0000, v10
    v_mul_f32 v11, 0xbfb8aa3b, v116
    v_mul_f32 v12, 0xbfb8aa3b, v117
    v_exp_f32 v11, v11
    v_exp_f32 v12, v12
    s_nop 0
    v_add_f32 v11, 1.0, v11
    v_add_f32 v12, 1.0, v12
    v_rcp_f32 v11, v11
    v_rcp_f32 v12, v12
    s_nop 0
    v_mul_f32 v116, v116, v11
    v_mul_f32 v117, v117, v12
    v_cvt_pk_bf16_f32 v10, v116, v117
    v_lshlrev_b32 v116, 16, v10
    v_and_b32 v117, 0xffff0000, v10
    v_lshlrev_b32 v102, 16, v43
    v_and_b32 v103, 0xffff0000, v43
    v_sub_f32 v118, v102, v48
    v_sub_f32 v119, v103, v48
    v_cvt_pk_bf16_f32 v10, v118, v119
    v_lshlrev_b32 v118, 16, v10
    v_and_b32 v119, 0xffff0000, v10
    v_mul_f32 v118, v118, v49
    v_mul_f32 v119, v119, v49
    v_cvt_pk_bf16_f32 v10, v118, v119
    v_lshlrev_b32 v118, 16, v10
    v_and_b32 v119, 0xffff0000, v10
    v_add_f32 v118, v118, v30
    v_add_f32 v119, v119, v31
    v_cvt_pk_bf16_f32 v10, v118, v119
    v_lshlrev_b32 v118, 16, v10
    v_and_b32 v119, 0xffff0000, v10
    v_mul_f32 v11, 0xbfb8aa3b, v118
    v_mul_f32 v12, 0xbfb8aa3b, v119
    v_exp_f32 v11, v11
    v_exp_f32 v12, v12
    s_nop 0
    v_add_f32 v11, 1.0, v11
    v_add_f32 v12, 1.0, v12
    v_rcp_f32 v11, v11
    v_rcp_f32 v12, v12
    s_nop 0
    v_mul_f32 v118, v118, v11
    v_mul_f32 v119, v119, v12
    v_cvt_pk_bf16_f32 v10, v118, v119
    v_lshlrev_b32 v118, 16, v10
    v_and_b32 v119, 0xffff0000, v10
    v_lshlrev_b32 v104, 16, v44
    v_and_b32 v105, 0xffff0000, v44
    v_sub_f32 v120, v104, v48
    v_sub_f32 v121, v105, v48
    v_cvt_pk_bf16_f32 v10, v120, v121
    v_lshlrev_b32 v120, 16, v10
    v_and_b32 v121, 0xffff0000, v10
    v_mul_f32 v120, v120, v49
    v_mul_f32 v121, v121, v49
    v_cvt_pk_bf16_f32 v10, v120, v121
    v_lshlrev_b32 v120, 16, v10
    v_and_b32 v121, 0xffff0000, v10
    v_add_f32 v120, v120, v32
    v_add_f32 v121, v121, v33
    v_cvt_pk_bf16_f32 v10, v120, v121
    v_lshlrev_b32 v120, 16, v10
    v_and_b32 v121, 0xffff0000, v10
    v_mul_f32 v11, 0xbfb8aa3b, v120
    v_mul_f32 v12, 0xbfb8aa3b, v121
    v_exp_f32 v11, v11
    v_exp_f32 v12, v12
    s_nop 0
    v_add_f32 v11, 1.0, v11
    v_add_f32 v12, 1.0, v12
    v_rcp_f32 v11, v11
    v_rcp_f32 v12, v12
    s_nop 0
    v_mul_f32 v120, v120, v11
    v_mul_f32 v121, v121, v12
    v_cvt_pk_bf16_f32 v10, v120, v121
    v_lshlrev_b32 v120, 16, v10
    v_and_b32 v121, 0xffff0000, v10
    v_lshlrev_b32 v106, 16, v45
    v_and_b32 v107, 0xffff0000, v45
    v_sub_f32 v122, v106, v48
    v_sub_f32 v123, v107, v48
    v_cvt_pk_bf16_f32 v10, v122, v123
    v_lshlrev_b32 v122, 16, v10
    v_and_b32 v123, 0xffff0000, v10
    v_mul_f32 v122, v122, v49
    v_mul_f32 v123, v123, v49
    v_cvt_pk_bf16_f32 v10, v122, v123
    v_lshlrev_b32 v122, 16, v10
    v_and_b32 v123, 0xffff0000, v10
    v_add_f32 v122, v122, v34
    v_add_f32 v123, v123, v35
    v_cvt_pk_bf16_f32 v10, v122, v123
    v_lshlrev_b32 v122, 16, v10
    v_and_b32 v123, 0xffff0000, v10
    v_mul_f32 v11, 0xbfb8aa3b, v122
    v_mul_f32 v12, 0xbfb8aa3b, v123
    v_exp_f32 v11, v11
    v_exp_f32 v12, v12
    s_nop 0
    v_add_f32 v11, 1.0, v11
    v_add_f32 v12, 1.0, v12
    v_rcp_f32 v11, v11
    v_rcp_f32 v12, v12
    s_nop 0
    v_mul_f32 v122, v122, v11
    v_mul_f32 v123, v123, v12
    v_cvt_pk_bf16_f32 v10, v122, v123
    v_lshlrev_b32 v122, 16, v10
    v_and_b32 v123, 0xffff0000, v10
    v_lshlrev_b32 v108, 16, v46
    v_and_b32 v109, 0xffff0000, v46
    v_sub_f32 v124, v108, v48
    v_sub_f32 v125, v109, v48
    v_cvt_pk_bf16_f32 v10, v124, v125
    v_lshlrev_b32 v124, 16, v10
    v_and_b32 v125, 0xffff0000, v10
    v_mul_f32 v124, v124, v49
    v_mul_f32 v125, v125, v49
    v_cvt_pk_bf16_f32 v10, v124, v125
    v_lshlrev_b32 v124, 16, v10
    v_and_b32 v125, 0xffff0000, v10
    v_add_f32 v124, v124, v36
    v_add_f32 v125, v125, v37
    v_cvt_pk_bf16_f32 v10, v124, v125
    v_lshlrev_b32 v124, 16, v10
    v_and_b32 v125, 0xffff0000, v10
    v_mul_f32 v11, 0xbfb8aa3b, v124
    v_mul_f32 v12, 0xbfb8aa3b, v125
    v_exp_f32 v11, v11
    v_exp_f32 v12, v12
    s_nop 0
    v_add_f32 v11, 1.0, v11
    v_add_f32 v12, 1.0, v12
    v_rcp_f32 v11, v11
    v_rcp_f32 v12, v12
    s_nop 0
    v_mul_f32 v124, v124, v11
    v_mul_f32 v125, v125, v12
    v_cvt_pk_bf16_f32 v10, v124, v125
    v_lshlrev_b32 v124, 16, v10
    v_and_b32 v125, 0xffff0000, v10
    v_lshlrev_b32 v110, 16, v47
    v_and_b32 v111, 0xffff0000, v47
    v_sub_f32 v126, v110, v48
    v_sub_f32 v127, v111, v48
    v_cvt_pk_bf16_f32 v10, v126, v127
    v_lshlrev_b32 v126, 16, v10
    v_and_b32 v127, 0xffff0000, v10
    v_mul_f32 v126, v126, v49
    v_mul_f32 v127, v127, v49
    v_cvt_pk_bf16_f32 v10, v126, v127
    v_lshlrev_b32 v126, 16, v10
    v_and_b32 v127, 0xffff0000, v10
    v_add_f32 v126, v126, v38
    v_add_f32 v127, v127, v39
    v_cvt_pk_bf16_f32 v10, v126, v127
    v_lshlrev_b32 v126, 16, v10
    v_and_b32 v127, 0xffff0000, v10
    v_mul_f32 v11, 0xbfb8aa3b, v126
    v_mul_f32 v12, 0xbfb8aa3b, v127
    v_exp_f32 v11, v11
    v_exp_f32 v12, v12
    s_nop 0
    v_add_f32 v11, 1.0, v11
    v_add_f32 v12, 1.0, v12
    v_rcp_f32 v11, v11
    v_rcp_f32 v12, v12
    s_nop 0
    v_mul_f32 v126, v126, v11
    v_mul_f32 v127, v127, v12
    v_cvt_pk_bf16_f32 v10, v126, v127
    v_lshlrev_b32 v126, 16, v10
    v_and_b32 v127, 0xffff0000, v10
    s_branch L_recurrent_scan__compressed_kv_cla__moe_arch_mod__prompt_kernel_back_210
L_end:
    s_endpgm
.section .rodata,"a"
.p2align 6
.amdhsa_kernel recurrent_scan__compressed_kv_cla__moe_arch_mod__prompt_kernel
  .amdhsa_next_free_vgpr 256
  .amdhsa_next_free_sgpr 102
  .amdhsa_accum_offset 256
  .amdhsa_group_segment_fixed_size 0
  .amdhsa_kernarg_size 112
  .amdhsa_user_sgpr_count 2
  .amdhsa_user_sgpr_kernarg_segment_ptr 1
  .amdhsa_system_sgpr_workgroup_id_x 1
.end_amdhsa_kernel
```
